```python
import torch

def _softmax(x, axis=-1):
    return torch.softmax(x, dim=axis)
def _gelu(x):
    return torch.nn.functional.gelu(x, approximate="tanh")
def _silu(x):
    return torch.nn.functional.silu(x)
def _sigmoid(x):
    return torch.sigmoid(x)
def _layernorm(x, axis=-1, eps=1e-5):
    m = x.mean(dim=axis, keepdim=True)
    v = x.var(dim=axis, keepdim=True, unbiased=False)
    return (x - m) / torch.sqrt(v + eps)
def _scatter_add(tgt, idx, src, axis=0):
    return tgt.clone().index_add_(axis, idx, src)
def _segment_sum(src, seg, n):
    out = torch.zeros((n,) + src.shape[1:], dtype=src.dtype)
    return out.index_add_(0, seg, src)
def _pad(x, pw):
    flat = tuple(v for pair in reversed(pw) for v in pair)
    return torch.nn.functional.pad(x, flat)

kernel_name = 'parallel_sum__spectral_fnet__moe_arch_mod__prompt'

def setup_inputs():

    _w = (lambda a: (lambda t: t.to(torch.bfloat16) if t.is_floating_point() else t)(torch.as_tensor(a)))
    def _A_setup():
        B, S, D = 1, 2048, 1024
        ns = torch.arange(S)[:, None] * torch.arange(S)[None, :]
        nd = torch.arange(D)[:, None] * torch.arange(D)[None, :]
        Ws_re = torch.cos(-2.0 * torch.pi * ns / S).to(float)
        Ws_im = torch.sin(-2.0 * torch.pi * ns / S).to(float)
        Wd_re = torch.cos(-2.0 * torch.pi * nd / D).to(float)
        Wd_im = torch.sin(-2.0 * torch.pi * nd / D).to(float)
        return {
            "x": _w((lambda *s: torch.randn(*s, dtype=torch.bfloat16) * 0.05)(B, S, D)),
            "dft_seq_re": _w(Ws_re),
            "dft_seq_im": _w(Ws_im),
            "dft_hid_re": _w(Wd_re),
            "dft_hid_im": _w(Wd_im),
        }
    _A_in = _A_setup()

    def _B_setup():
        B, S, D, F, C = 1, 2048, 1024, 3584, 2
        return {
            "x": _w((lambda *s: torch.randn(*s, dtype=torch.bfloat16) * 0.05)(B, S, D)),
            "w_r": _w((lambda *s: torch.randn(*s, dtype=torch.bfloat16) * 1.6)(D)),
            "w_gate": _w((lambda *s: torch.randn(*s, dtype=torch.bfloat16) * 0.4)(D, F)),
            "w_up": _w((lambda *s: torch.randn(*s, dtype=torch.bfloat16) * 0.4)(D, F)),
            "w_down": _w((lambda *s: torch.randn(*s, dtype=torch.bfloat16) * 0.4)(F, D)),
        }
    _B_in = _B_setup()

    return {
        "A_x": _A_in["x"],
        "A_dft_seq_re": _A_in["dft_seq_re"],
        "A_dft_seq_im": _A_in["dft_seq_im"],
        "A_dft_hid_re": _A_in["dft_hid_re"],
        "A_dft_hid_im": _A_in["dft_hid_im"],
        "B_x": _B_in["x"],
        "B_w_r": _B_in["w_r"],
        "B_w_gate": _B_in["w_gate"],
        "B_w_up": _B_in["w_up"],
        "B_w_down": _B_in["w_down"],
    }

def reference(A_x, A_dft_seq_re, A_dft_seq_im, A_dft_hid_re, A_dft_hid_im, B_x, B_w_r, B_w_gate, B_w_up, B_w_down):
    def _A_ref(x, dft_seq_re, dft_seq_im, dft_hid_re, dft_hid_im):
        a = torch.einsum("bsd,ed->bse", x, dft_hid_re)
        b = torch.einsum("bsd,ed->bse", x, dft_hid_im)
        y = torch.einsum("ts,bse->bte", dft_seq_re, a) - torch.einsum("ts,bse->bte", dft_seq_im, b)
        return y

    def _B_ref(x, w_r, w_gate, w_up, w_down):
        B, S, D = x.shape
        C = 2
        r = x @ w_r
        idx = torch.argsort(-r, axis=-1)[:, :C]
        idx_e = (lambda x, n, axis: torch.repeat_interleave(x, n, dim=axis))(idx.reshape(B, C, 1), D, axis=2)
        x_sel = (lambda x, i, axis: torch.take_along_dim(x, i, dim=axis))(x, idx_e, axis=1)
        g = _silu(x_sel @ w_gate)
        u = x_sel @ w_up
        y = (g * u) @ w_down
        r_sel = _sigmoid((lambda x, i, axis: torch.take_along_dim(x, i, dim=axis))(r, idx, axis=1))
        y = y * r_sel.reshape(B, C, 1)
        b_off = (torch.arange(B) * S).reshape(B, 1)
        flat_idx = (idx + b_off).reshape(B * C)
        zero = (x * 0.0).reshape(B * S, D)
        upd = _scatter_add(zero, flat_idx, y.reshape(B * C, D), axis=0)
        return x + upd.reshape(B, S, D)

    x = A_x
    xn = _layernorm(x, axis=-1)
    return x + _A_ref(xn, A_dft_seq_re, A_dft_seq_im, A_dft_hid_re, A_dft_hid_im) + _B_ref(xn, B_w_r, B_w_gate, B_w_up, B_w_down)
```

```asm
; @launch kernel=k1_kernel grid=(512,1,1) block=(256,1,1) lds=0
; @launch kernel=k2_kernel grid=(2048,1,1) block=(64,1,1) lds=0
; @launch kernel=k3_kernel grid=(2048,1,1) block=(64,1,1) lds=0
; @launch kernel=k4_kernel grid=(28,1,1) block=(1024,1,1) lds=32768
; @launch kernel=k5_kernel grid=(8,1,1) block=(896,1,1) lds=16384
.amdgcn_target "amdgcn-amd-amdhsa--gfx950"
.text
.globl k1_kernel
.p2align 8
.type k1_kernel,@function
k1_kernel:
  s_cmp_ge_u32 s2, 512
  s_cbranch_scc1 L1_end
  s_load_dwordx2 s[4:5], s[0:1], 0
  s_load_dwordx2 s[6:7], s[0:1], 48
  s_load_dwordx2 s[8:9], s[0:1], 96
  v_and_b32 v62, 63, v0
  v_lshlrev_b32 v63, 2, v62
  v_lshrrev_b32 v1, 6, v0
  s_lshl_b32 s3, s2, 2
  v_add_u32 v1, s3, v1
  v_lshlrev_b32 v2, 11, v1
  v_lshl_add_u32 v2, v62, 5, v2
  v_lshlrev_b32 v3, 5, v62
  s_waitcnt lgkmcnt(0)
  global_load_dwordx4 v[4:7], v2, s[4:5]
  global_load_dwordx4 v[8:11], v2, s[4:5] offset:16
  global_load_dwordx4 v[12:15], v3, s[6:7]
  global_load_dwordx4 v[16:19], v3, s[6:7] offset:16
  s_waitcnt vmcnt(0)
  v_lshlrev_b32 v20, 16, v4
  v_and_b32 v21, 0xffff0000, v4
  v_lshlrev_b32 v36, 16, v12
  v_and_b32 v37, 0xffff0000, v12
  v_lshlrev_b32 v22, 16, v5
  v_and_b32 v23, 0xffff0000, v5
  v_lshlrev_b32 v38, 16, v13
  v_and_b32 v39, 0xffff0000, v13
  v_lshlrev_b32 v24, 16, v6
  v_and_b32 v25, 0xffff0000, v6
  v_lshlrev_b32 v40, 16, v14
  v_and_b32 v41, 0xffff0000, v14
  v_lshlrev_b32 v26, 16, v7
  v_and_b32 v27, 0xffff0000, v7
  v_lshlrev_b32 v42, 16, v15
  v_and_b32 v43, 0xffff0000, v15
  v_lshlrev_b32 v28, 16, v8
  v_and_b32 v29, 0xffff0000, v8
  v_lshlrev_b32 v44, 16, v16
  v_and_b32 v45, 0xffff0000, v16
  v_lshlrev_b32 v30, 16, v9
  v_and_b32 v31, 0xffff0000, v9
  v_lshlrev_b32 v46, 16, v17
  v_and_b32 v47, 0xffff0000, v17
  v_lshlrev_b32 v32, 16, v10
  v_and_b32 v33, 0xffff0000, v10
  v_lshlrev_b32 v48, 16, v18
  v_and_b32 v49, 0xffff0000, v18
  v_lshlrev_b32 v34, 16, v11
  v_and_b32 v35, 0xffff0000, v11
  v_lshlrev_b32 v50, 16, v19
  v_and_b32 v51, 0xffff0000, v19
  v_mov_b32 v52, 0
  v_add_f32 v52, v52, v20
  v_add_f32 v52, v52, v21
  v_add_f32 v52, v52, v22
  v_add_f32 v52, v52, v23
  v_add_f32 v52, v52, v24
  v_add_f32 v52, v52, v25
  v_add_f32 v52, v52, v26
  v_add_f32 v52, v52, v27
  v_add_f32 v52, v52, v28
  v_add_f32 v52, v52, v29
  v_add_f32 v52, v52, v30
  v_add_f32 v52, v52, v31
  v_add_f32 v52, v52, v32
  v_add_f32 v52, v52, v33
  v_add_f32 v52, v52, v34
  v_add_f32 v52, v52, v35
  v_xor_b32 v53, 4, v63
  ds_bpermute_b32 v53, v53, v52
  s_waitcnt lgkmcnt(0)
  v_add_f32 v52, v52, v53
  v_xor_b32 v53, 8, v63
  ds_bpermute_b32 v53, v53, v52
  s_waitcnt lgkmcnt(0)
  v_add_f32 v52, v52, v53
  v_xor_b32 v53, 16, v63
  ds_bpermute_b32 v53, v53, v52
  s_waitcnt lgkmcnt(0)
  v_add_f32 v52, v52, v53
  v_xor_b32 v53, 32, v63
  ds_bpermute_b32 v53, v53, v52
  s_waitcnt lgkmcnt(0)
  v_add_f32 v52, v52, v53
  v_xor_b32 v53, 64, v63
  ds_bpermute_b32 v53, v53, v52
  s_waitcnt lgkmcnt(0)
  v_add_f32 v52, v52, v53
  v_xor_b32 v53, 128, v63
  ds_bpermute_b32 v53, v53, v52
  s_waitcnt lgkmcnt(0)
  v_add_f32 v52, v52, v53
  v_mul_f32 v52, 0x3a800000, v52
  v_mov_b32 v54, 0
  v_sub_f32 v55, v20, v52
  v_fmac_f32 v54, v55, v55
  v_sub_f32 v55, v21, v52
  v_fmac_f32 v54, v55, v55
  v_sub_f32 v55, v22, v52
  v_fmac_f32 v54, v55, v55
  v_sub_f32 v55, v23, v52
  v_fmac_f32 v54, v55, v55
  v_sub_f32 v55, v24, v52
  v_fmac_f32 v54, v55, v55
  v_sub_f32 v55, v25, v52
  v_fmac_f32 v54, v55, v55
  v_sub_f32 v55, v26, v52
  v_fmac_f32 v54, v55, v55
  v_sub_f32 v55, v27, v52
  v_fmac_f32 v54, v55, v55
  v_sub_f32 v55, v28, v52
  v_fmac_f32 v54, v55, v55
  v_sub_f32 v55, v29, v52
  v_fmac_f32 v54, v55, v55
  v_sub_f32 v55, v30, v52
  v_fmac_f32 v54, v55, v55
  v_sub_f32 v55, v31, v52
  v_fmac_f32 v54, v55, v55
  v_sub_f32 v55, v32, v52
  v_fmac_f32 v54, v55, v55
  v_sub_f32 v55, v33, v52
  v_fmac_f32 v54, v55, v55
  v_sub_f32 v55, v34, v52
  v_fmac_f32 v54, v55, v55
  v_sub_f32 v55, v35, v52
  v_fmac_f32 v54, v55, v55
  v_xor_b32 v53, 4, v63
  ds_bpermute_b32 v53, v53, v54
  s_waitcnt lgkmcnt(0)
  v_add_f32 v54, v54, v53
  v_xor_b32 v53, 8, v63
  ds_bpermute_b32 v53, v53, v54
  s_waitcnt lgkmcnt(0)
  v_add_f32 v54, v54, v53
  v_xor_b32 v53, 16, v63
  ds_bpermute_b32 v53, v53, v54
  s_waitcnt lgkmcnt(0)
  v_add_f32 v54, v54, v53
  v_xor_b32 v53, 32, v63
  ds_bpermute_b32 v53, v53, v54
  s_waitcnt lgkmcnt(0)
  v_add_f32 v54, v54, v53
  v_xor_b32 v53, 64, v63
  ds_bpermute_b32 v53, v53, v54
  s_waitcnt lgkmcnt(0)
  v_add_f32 v54, v54, v53
  v_xor_b32 v53, 128, v63
  ds_bpermute_b32 v53, v53, v54
  s_waitcnt lgkmcnt(0)
  v_add_f32 v54, v54, v53
  v_mul_f32 v54, 0x3a800000, v54
  v_cvt_pk_bf16_f32 v52, v52, v52
  v_and_b32 v52, 0xffff0000, v52
  v_cvt_pk_bf16_f32 v54, v54, v54
  v_and_b32 v54, 0xffff0000, v54
  v_add_f32 v54, 0x3727c5ac, v54
  v_cvt_pk_bf16_f32 v54, v54, v54
  v_and_b32 v54, 0xffff0000, v54
  v_sqrt_f32 v54, v54
  s_nop 0
  v_cvt_pk_bf16_f32 v54, v54, v54
  v_and_b32 v54, 0xffff0000, v54
  v_rcp_f32 v54, v54
  v_mov_b32 v56, 0
  v_sub_f32 v20, v20, v52
  v_cvt_pk_bf16_f32 v20, v20, v20
  v_and_b32 v20, 0xffff0000, v20
  v_mul_f32 v20, v20, v54
  v_cvt_pk_bf16_f32 v20, v20, v20
  v_and_b32 v20, 0xffff0000, v20
  v_fmac_f32 v56, v20, v36
  v_sub_f32 v21, v21, v52
  v_cvt_pk_bf16_f32 v21, v21, v21
  v_and_b32 v21, 0xffff0000, v21
  v_mul_f32 v21, v21, v54
  v_cvt_pk_bf16_f32 v21, v21, v21
  v_and_b32 v21, 0xffff0000, v21
  v_fmac_f32 v56, v21, v37
  v_sub_f32 v22, v22, v52
  v_cvt_pk_bf16_f32 v22, v22, v22
  v_and_b32 v22, 0xffff0000, v22
  v_mul_f32 v22, v22, v54
  v_cvt_pk_bf16_f32 v22, v22, v22
  v_and_b32 v22, 0xffff0000, v22
  v_fmac_f32 v56, v22, v38
  v_sub_f32 v23, v23, v52
  v_cvt_pk_bf16_f32 v23, v23, v23
  v_and_b32 v23, 0xffff0000, v23
  v_mul_f32 v23, v23, v54
  v_cvt_pk_bf16_f32 v23, v23, v23
  v_and_b32 v23, 0xffff0000, v23
  v_fmac_f32 v56, v23, v39
  v_sub_f32 v24, v24, v52
  v_cvt_pk_bf16_f32 v24, v24, v24
  v_and_b32 v24, 0xffff0000, v24
  v_mul_f32 v24, v24, v54
  v_cvt_pk_bf16_f32 v24, v24, v24
  v_and_b32 v24, 0xffff0000, v24
  v_fmac_f32 v56, v24, v40
  v_sub_f32 v25, v25, v52
  v_cvt_pk_bf16_f32 v25, v25, v25
  v_and_b32 v25, 0xffff0000, v25
  v_mul_f32 v25, v25, v54
  v_cvt_pk_bf16_f32 v25, v25, v25
  v_and_b32 v25, 0xffff0000, v25
  v_fmac_f32 v56, v25, v41
  v_sub_f32 v26, v26, v52
  v_cvt_pk_bf16_f32 v26, v26, v26
  v_and_b32 v26, 0xffff0000, v26
  v_mul_f32 v26, v26, v54
  v_cvt_pk_bf16_f32 v26, v26, v26
  v_and_b32 v26, 0xffff0000, v26
  v_fmac_f32 v56, v26, v42
  v_sub_f32 v27, v27, v52
  v_cvt_pk_bf16_f32 v27, v27, v27
  v_and_b32 v27, 0xffff0000, v27
  v_mul_f32 v27, v27, v54
  v_cvt_pk_bf16_f32 v27, v27, v27
  v_and_b32 v27, 0xffff0000, v27
  v_fmac_f32 v56, v27, v43
  v_sub_f32 v28, v28, v52
  v_cvt_pk_bf16_f32 v28, v28, v28
  v_and_b32 v28, 0xffff0000, v28
  v_mul_f32 v28, v28, v54
  v_cvt_pk_bf16_f32 v28, v28, v28
  v_and_b32 v28, 0xffff0000, v28
  v_fmac_f32 v56, v28, v44
  v_sub_f32 v29, v29, v52
  v_cvt_pk_bf16_f32 v29, v29, v29
  v_and_b32 v29, 0xffff0000, v29
  v_mul_f32 v29, v29, v54
  v_cvt_pk_bf16_f32 v29, v29, v29
  v_and_b32 v29, 0xffff0000, v29
  v_fmac_f32 v56, v29, v45
  v_sub_f32 v30, v30, v52
  v_cvt_pk_bf16_f32 v30, v30, v30
  v_and_b32 v30, 0xffff0000, v30
  v_mul_f32 v30, v30, v54
  v_cvt_pk_bf16_f32 v30, v30, v30
  v_and_b32 v30, 0xffff0000, v30
  v_fmac_f32 v56, v30, v46
  v_sub_f32 v31, v31, v52
  v_cvt_pk_bf16_f32 v31, v31, v31
  v_and_b32 v31, 0xffff0000, v31
  v_mul_f32 v31, v31, v54
  v_cvt_pk_bf16_f32 v31, v31, v31
  v_and_b32 v31, 0xffff0000, v31
  v_fmac_f32 v56, v31, v47
  v_sub_f32 v32, v32, v52
  v_cvt_pk_bf16_f32 v32, v32, v32
  v_and_b32 v32, 0xffff0000, v32
  v_mul_f32 v32, v32, v54
  v_cvt_pk_bf16_f32 v32, v32, v32
  v_and_b32 v32, 0xffff0000, v32
  v_fmac_f32 v56, v32, v48
  v_sub_f32 v33, v33, v52
  v_cvt_pk_bf16_f32 v33, v33, v33
  v_and_b32 v33, 0xffff0000, v33
  v_mul_f32 v33, v33, v54
  v_cvt_pk_bf16_f32 v33, v33, v33
  v_and_b32 v33, 0xffff0000, v33
  v_fmac_f32 v56, v33, v49
  v_sub_f32 v34, v34, v52
  v_cvt_pk_bf16_f32 v34, v34, v34
  v_and_b32 v34, 0xffff0000, v34
  v_mul_f32 v34, v34, v54
  v_cvt_pk_bf16_f32 v34, v34, v34
  v_and_b32 v34, 0xffff0000, v34
  v_fmac_f32 v56, v34, v50
  v_sub_f32 v35, v35, v52
  v_cvt_pk_bf16_f32 v35, v35, v35
  v_and_b32 v35, 0xffff0000, v35
  v_mul_f32 v35, v35, v54
  v_cvt_pk_bf16_f32 v35, v35, v35
  v_and_b32 v35, 0xffff0000, v35
  v_fmac_f32 v56, v35, v51
  v_xor_b32 v53, 4, v63
  ds_bpermute_b32 v53, v53, v56
  s_waitcnt lgkmcnt(0)
  v_add_f32 v56, v56, v53
  v_xor_b32 v53, 8, v63
  ds_bpermute_b32 v53, v53, v56
  s_waitcnt lgkmcnt(0)
  v_add_f32 v56, v56, v53
  v_xor_b32 v53, 16, v63
  ds_bpermute_b32 v53, v53, v56
  s_waitcnt lgkmcnt(0)
  v_add_f32 v56, v56, v53
  v_xor_b32 v53, 32, v63
  ds_bpermute_b32 v53, v53, v56
  s_waitcnt lgkmcnt(0)
  v_add_f32 v56, v56, v53
  v_xor_b32 v53, 64, v63
  ds_bpermute_b32 v53, v53, v56
  s_waitcnt lgkmcnt(0)
  v_add_f32 v56, v56, v53
  v_xor_b32 v53, 128, v63
  ds_bpermute_b32 v53, v53, v56
  s_waitcnt lgkmcnt(0)
  v_add_f32 v56, v56, v53
  v_cvt_pk_bf16_f32 v4, v20, v21
  v_cvt_pk_bf16_f32 v5, v22, v23
  v_cvt_pk_bf16_f32 v6, v24, v25
  v_cvt_pk_bf16_f32 v7, v26, v27
  v_cvt_pk_bf16_f32 v8, v28, v29
  v_cvt_pk_bf16_f32 v9, v30, v31
  v_cvt_pk_bf16_f32 v10, v32, v33
  v_cvt_pk_bf16_f32 v11, v34, v35
  global_store_dwordx4 v2, v[4:7], s[8:9]
  global_store_dwordx4 v2, v[8:11], s[8:9] offset:16
  v_cvt_pk_bf16_f32 v56, v56, v56
  v_ashrrev_i32 v57, 31, v56
  v_or_b32 v57, 0x80000000, v57
  v_xor_b32 v56, v56, v57
  v_and_b32 v56, 0xffff0000, v56
  v_sub_u32 v58, 0xffff, v1
  v_or_b32 v56, v56, v58
  v_lshlrev_b32 v59, 2, v1
  v_add_u32 v59, 4194304, v59
  v_cmp_eq_u32 vcc, 0, v62
  s_and_saveexec_b64 s[10:11], vcc
  s_cbranch_execz L1_end
  global_store_dword v59, v56, s[8:9]
L1_end:
  s_endpgm
.section .rodata,"a"
.p2align 6
.amdhsa_kernel k1_kernel
  .amdhsa_next_free_vgpr 64
  .amdhsa_next_free_sgpr 102
  .amdhsa_accum_offset 64
  .amdhsa_group_segment_fixed_size 0
  .amdhsa_kernarg_size 104
  .amdhsa_user_sgpr_count 2
  .amdhsa_user_sgpr_kernarg_segment_ptr 1
  .amdhsa_system_sgpr_workgroup_id_x 1
.end_amdhsa_kernel
.text
.globl k2_kernel
.p2align 8
.type k2_kernel,@function
k2_kernel:
  s_cmp_ge_u32 s2, 2048
  s_cbranch_scc1 L2_end
  s_load_dwordx4 s[4:7], s[0:1], 24
  s_load_dwordx2 s[8:9], s[0:1], 96
  s_and_b32 s10, s2, 31
  s_lshr_b32 s11, s2, 5
  s_lshl_b32 s10, s10, 5
  s_lshl_b32 s11, s11, 5
  v_and_b32 v4, 31, v0
  v_lshrrev_b32 v5, 5, v0
  v_add_u32 v2, s10, v4
  v_lshlrev_b32 v2, 11, v2
  v_lshl_add_u32 v2, v5, 4, v2
  v_add_u32 v3, s11, v4
  v_lshlrev_b32 v3, 11, v3
  v_lshl_add_u32 v3, v5, 4, v3
  s_waitcnt lgkmcnt(0)
  v_mov_b32 v32, 0
  v_mov_b32 v33, 0
  v_mov_b32 v34, 0
  v_mov_b32 v35, 0
  v_mov_b32 v36, 0
  v_mov_b32 v37, 0
  v_mov_b32 v38, 0
  v_mov_b32 v39, 0
  v_mov_b32 v40, 0
  v_mov_b32 v41, 0
  v_mov_b32 v42, 0
  v_mov_b32 v43, 0
  v_mov_b32 v44, 0
  v_mov_b32 v45, 0
  v_mov_b32 v46, 0
  v_mov_b32 v47, 0
  v_mov_b32 v48, 0
  v_mov_b32 v49, 0
  v_mov_b32 v50, 0
  v_mov_b32 v51, 0
  v_mov_b32 v52, 0
  v_mov_b32 v53, 0
  v_mov_b32 v54, 0
  v_mov_b32 v55, 0
  v_mov_b32 v56, 0
  v_mov_b32 v57, 0
  v_mov_b32 v58, 0
  v_mov_b32 v59, 0
  v_mov_b32 v60, 0
  v_mov_b32 v61, 0
  v_mov_b32 v62, 0
  v_mov_b32 v63, 0
  s_mov_b32 s20, 0
L2_loop:
  global_load_dwordx4 v[64:67], v2, s[4:5] offset:0
  global_load_dwordx4 v[68:71], v2, s[6:7] offset:0
  global_load_dwordx4 v[72:75], v3, s[8:9] offset:0
  global_load_dwordx4 v[80:83], v2, s[4:5] offset:32
  global_load_dwordx4 v[84:87], v2, s[6:7] offset:32
  global_load_dwordx4 v[88:91], v3, s[8:9] offset:32
  global_load_dwordx4 v[96:99], v2, s[4:5] offset:64
  global_load_dwordx4 v[100:103], v2, s[6:7] offset:64
  global_load_dwordx4 v[104:107], v3, s[8:9] offset:64
  global_load_dwordx4 v[112:115], v2, s[4:5] offset:96
  global_load_dwordx4 v[116:119], v2, s[6:7] offset:96
  global_load_dwordx4 v[120:123], v3, s[8:9] offset:96
  v_add_u32 v2, 128, v2
  v_add_u32 v3, 128, v3
  s_waitcnt vmcnt(0)
  v_mfma_f32_32x32x16_bf16 v[32:47], v[64:67], v[72:75], v[32:47]
  v_mfma_f32_32x32x16_bf16 v[48:63], v[68:71], v[72:75], v[48:63]
  v_mfma_f32_32x32x16_bf16 v[32:47], v[80:83], v[88:91], v[32:47]
  v_mfma_f32_32x32x16_bf16 v[48:63], v[84:87], v[88:91], v[48:63]
  v_mfma_f32_32x32x16_bf16 v[32:47], v[96:99], v[104:107], v[32:47]
  v_mfma_f32_32x32x16_bf16 v[48:63], v[100:103], v[104:107], v[48:63]
  v_mfma_f32_32x32x16_bf16 v[32:47], v[112:115], v[120:123], v[32:47]
  v_mfma_f32_32x32x16_bf16 v[48:63], v[116:119], v[120:123], v[48:63]
  s_add_u32 s20, s20, 1
  s_cmp_lt_u32 s20, 16
  s_cbranch_scc1 L2_loop
  s_nop 15
  v_lshl_add_u32 v6, v5, 2, s10
  v_lshlrev_b32 v6, 12, v6
  v_add_u32 v7, s11, v4
  v_lshl_add_u32 v6, v7, 1, v6
  v_add_u32 v8, 8388608, v6
  v_cvt_pk_bf16_f32 v9, v32, v32
  global_store_short v8, v9, s[8:9]
  v_add_u32 v10, 12582912, v6
  v_cvt_pk_bf16_f32 v11, -v48, -v48
  global_store_short v10, v11, s[8:9]
  s_nop 1
  v_add_u32 v8, 8392704, v6
  v_cvt_pk_bf16_f32 v9, v33, v33
  global_store_short v8, v9, s[8:9]
  v_add_u32 v10, 12587008, v6
  v_cvt_pk_bf16_f32 v11, -v49, -v49
  global_store_short v10, v11, s[8:9]
  s_nop 1
  v_add_u32 v8, 8396800, v6
  v_cvt_pk_bf16_f32 v9, v34, v34
  global_store_short v8, v9, s[8:9]
  v_add_u32 v10, 12591104, v6
  v_cvt_pk_bf16_f32 v11, -v50, -v50
  global_store_short v10, v11, s[8:9]
  s_nop 1
  v_add_u32 v8, 8400896, v6
  v_cvt_pk_bf16_f32 v9, v35, v35
  global_store_short v8, v9, s[8:9]
  v_add_u32 v10, 12595200, v6
  v_cvt_pk_bf16_f32 v11, -v51, -v51
  global_store_short v10, v11, s[8:9]
  s_nop 1
  v_add_u32 v8, 8421376, v6
  v_cvt_pk_bf16_f32 v9, v36, v36
  global_store_short v8, v9, s[8:9]
  v_add_u32 v10, 12615680, v6
  v_cvt_pk_bf16_f32 v11, -v52, -v52
  global_store_short v10, v11, s[8:9]
  s_nop 1
  v_add_u32 v8, 8425472, v6
  v_cvt_pk_bf16_f32 v9, v37, v37
  global_store_short v8, v9, s[8:9]
  v_add_u32 v10, 12619776, v6
  v_cvt_pk_bf16_f32 v11, -v53, -v53
  global_store_short v10, v11, s[8:9]
  s_nop 1
  v_add_u32 v8, 8429568, v6
  v_cvt_pk_bf16_f32 v9, v38, v38
  global_store_short v8, v9, s[8:9]
  v_add_u32 v10, 12623872, v6
  v_cvt_pk_bf16_f32 v11, -v54, -v54
  global_store_short v10, v11, s[8:9]
  s_nop 1
  v_add_u32 v8, 8433664, v6
  v_cvt_pk_bf16_f32 v9, v39, v39
  global_store_short v8, v9, s[8:9]
  v_add_u32 v10, 12627968, v6
  v_cvt_pk_bf16_f32 v11, -v55, -v55
  global_store_short v10, v11, s[8:9]
  s_nop 1
  v_add_u32 v8, 8454144, v6
  v_cvt_pk_bf16_f32 v9, v40, v40
  global_store_short v8, v9, s[8:9]
  v_add_u32 v10, 12648448, v6
  v_cvt_pk_bf16_f32 v11, -v56, -v56
  global_store_short v10, v11, s[8:9]
  s_nop 1
  v_add_u32 v8, 8458240, v6
  v_cvt_pk_bf16_f32 v9, v41, v41
  global_store_short v8, v9, s[8:9]
  v_add_u32 v10, 12652544, v6
  v_cvt_pk_bf16_f32 v11, -v57, -v57
  global_store_short v10, v11, s[8:9]
  s_nop 1
  v_add_u32 v8, 8462336, v6
  v_cvt_pk_bf16_f32 v9, v42, v42
  global_store_short v8, v9, s[8:9]
  v_add_u32 v10, 12656640, v6
  v_cvt_pk_bf16_f32 v11, -v58, -v58
  global_store_short v10, v11, s[8:9]
  s_nop 1
  v_add_u32 v8, 8466432, v6
  v_cvt_pk_bf16_f32 v9, v43, v43
  global_store_short v8, v9, s[8:9]
  v_add_u32 v10, 12660736, v6
  v_cvt_pk_bf16_f32 v11, -v59, -v59
  global_store_short v10, v11, s[8:9]
  s_nop 1
  v_add_u32 v8, 8486912, v6
  v_cvt_pk_bf16_f32 v9, v44, v44
  global_store_short v8, v9, s[8:9]
  v_add_u32 v10, 12681216, v6
  v_cvt_pk_bf16_f32 v11, -v60, -v60
  global_store_short v10, v11, s[8:9]
  s_nop 1
  v_add_u32 v8, 8491008, v6
  v_cvt_pk_bf16_f32 v9, v45, v45
  global_store_short v8, v9, s[8:9]
  v_add_u32 v10, 12685312, v6
  v_cvt_pk_bf16_f32 v11, -v61, -v61
  global_store_short v10, v11, s[8:9]
  s_nop 1
  v_add_u32 v8, 8495104, v6
  v_cvt_pk_bf16_f32 v9, v46, v46
  global_store_short v8, v9, s[8:9]
  v_add_u32 v10, 12689408, v6
  v_cvt_pk_bf16_f32 v11, -v62, -v62
  global_store_short v10, v11, s[8:9]
  s_nop 1
  v_add_u32 v8, 8499200, v6
  v_cvt_pk_bf16_f32 v9, v47, v47
  global_store_short v8, v9, s[8:9]
  v_add_u32 v10, 12693504, v6
  v_cvt_pk_bf16_f32 v11, -v63, -v63
  global_store_short v10, v11, s[8:9]
  s_nop 1
L2_end:
  s_endpgm
.section .rodata,"a"
.p2align 6
.amdhsa_kernel k2_kernel
  .amdhsa_next_free_vgpr 128
  .amdhsa_next_free_sgpr 102
  .amdhsa_accum_offset 128
  .amdhsa_group_segment_fixed_size 0
  .amdhsa_kernarg_size 104
  .amdhsa_user_sgpr_count 2
  .amdhsa_user_sgpr_kernarg_segment_ptr 1
  .amdhsa_system_sgpr_workgroup_id_x 1
.end_amdhsa_kernel
.text
.globl k3_kernel
.p2align 8
.type k3_kernel,@function
k3_kernel:
  s_cmp_ge_u32 s2, 2048
  s_cbranch_scc1 L3_end
  s_load_dwordx2 s[14:15], s[0:1], 0
  s_load_dwordx4 s[4:7], s[0:1], 8
  s_load_dwordx2 s[8:9], s[0:1], 96
  s_load_dwordx2 s[16:17], s[0:1], 80
  s_and_b32 s10, s2, 31
  s_lshr_b32 s11, s2, 5
  s_lshl_b32 s10, s10, 5
  s_lshl_b32 s11, s11, 5
  v_and_b32 v4, 31, v0
  v_lshrrev_b32 v5, 5, v0
  v_add_u32 v2, s11, v4
  v_lshlrev_b32 v2, 12, v2
  v_lshl_add_u32 v2, v5, 4, v2
  v_add_u32 v3, s10, v4
  v_lshlrev_b32 v3, 12, v3
  v_lshl_add_u32 v3, v5, 4, v3
  s_waitcnt lgkmcnt(0)
  s_add_u32 s12, s8, 8388608
  s_addc_u32 s13, s9, 0
  s_add_u32 s18, s8, 12582912
  s_addc_u32 s19, s9, 0
  v_mov_b32 v32, 0
  v_mov_b32 v33, 0
  v_mov_b32 v34, 0
  v_mov_b32 v35, 0
  v_mov_b32 v36, 0
  v_mov_b32 v37, 0
  v_mov_b32 v38, 0
  v_mov_b32 v39, 0
  v_mov_b32 v40, 0
  v_mov_b32 v41, 0
  v_mov_b32 v42, 0
  v_mov_b32 v43, 0
  v_mov_b32 v44, 0
  v_mov_b32 v45, 0
  v_mov_b32 v46, 0
  v_mov_b32 v47, 0
  v_mov_b32 v48, 0
  v_mov_b32 v49, 0
  v_mov_b32 v50, 0
  v_mov_b32 v51, 0
  v_mov_b32 v52, 0
  v_mov_b32 v53, 0
  v_mov_b32 v54, 0
  v_mov_b32 v55, 0
  v_mov_b32 v56, 0
  v_mov_b32 v57, 0
  v_mov_b32 v58, 0
  v_mov_b32 v59, 0
  v_mov_b32 v60, 0
  v_mov_b32 v61, 0
  v_mov_b32 v62, 0
  v_mov_b32 v63, 0
  s_mov_b32 s20, 0
L3_loop:
  global_load_dwordx4 v[64:67], v2, s[4:5] offset:0
  global_load_dwordx4 v[68:71], v2, s[6:7] offset:0
  global_load_dwordx4 v[72:75], v3, s[12:13] offset:0
  global_load_dwordx4 v[76:79], v3, s[18:19] offset:0
  global_load_dwordx4 v[80:83], v2, s[4:5] offset:32
  global_load_dwordx4 v[84:87], v2, s[6:7] offset:32
  global_load_dwordx4 v[88:91], v3, s[12:13] offset:32
  global_load_dwordx4 v[92:95], v3, s[18:19] offset:32
  global_load_dwordx4 v[96:99], v2, s[4:5] offset:64
  global_load_dwordx4 v[100:103], v2, s[6:7] offset:64
  global_load_dwordx4 v[104:107], v3, s[12:13] offset:64
  global_load_dwordx4 v[108:111], v3, s[18:19] offset:64
  global_load_dwordx4 v[112:115], v2, s[4:5] offset:96
  global_load_dwordx4 v[116:119], v2, s[6:7] offset:96
  global_load_dwordx4 v[120:123], v3, s[12:13] offset:96
  global_load_dwordx4 v[124:127], v3, s[18:19] offset:96
  v_add_u32 v2, 128, v2
  v_add_u32 v3, 128, v3
  s_waitcnt vmcnt(0)
  v_mfma_f32_32x32x16_bf16 v[32:47], v[64:67], v[72:75], v[32:47]
  v_mfma_f32_32x32x16_bf16 v[32:47], v[68:71], v[76:79], v[32:47]
  v_mfma_f32_32x32x16_bf16 v[32:47], v[80:83], v[88:91], v[32:47]
  v_mfma_f32_32x32x16_bf16 v[32:47], v[84:87], v[92:95], v[32:47]
  v_mfma_f32_32x32x16_bf16 v[32:47], v[96:99], v[104:107], v[32:47]
  v_mfma_f32_32x32x16_bf16 v[32:47], v[100:103], v[108:111], v[32:47]
  v_mfma_f32_32x32x16_bf16 v[32:47], v[112:115], v[120:123], v[32:47]
  v_mfma_f32_32x32x16_bf16 v[32:47], v[116:119], v[124:127], v[32:47]
  s_add_u32 s20, s20, 1
  s_cmp_lt_u32 s20, 32
  s_cbranch_scc1 L3_loop
  s_nop 15
  v_lshl_add_u32 v6, v5, 2, s11
  v_lshlrev_b32 v6, 11, v6
  v_add_u32 v7, s10, v4
  v_lshl_add_u32 v6, v7, 1, v6
  v_add_u32 v64, 0, v6
  global_load_ushort v80, v64, s[14:15]
  global_load_ushort v96, v64, s[8:9]
  v_add_u32 v65, 2048, v6
  global_load_ushort v81, v65, s[14:15]
  global_load_ushort v97, v65, s[8:9]
  v_add_u32 v66, 4096, v6
  global_load_ushort v82, v66, s[14:15]
  global_load_ushort v98, v66, s[8:9]
  v_add_u32 v67, 6144, v6
  global_load_ushort v83, v67, s[14:15]
  global_load_ushort v99, v67, s[8:9]
  v_add_u32 v68, 16384, v6
  global_load_ushort v84, v68, s[14:15]
  global_load_ushort v100, v68, s[8:9]
  v_add_u32 v69, 18432, v6
  global_load_ushort v85, v69, s[14:15]
  global_load_ushort v101, v69, s[8:9]
  v_add_u32 v70, 20480, v6
  global_load_ushort v86, v70, s[14:15]
  global_load_ushort v102, v70, s[8:9]
  v_add_u32 v71, 22528, v6
  global_load_ushort v87, v71, s[14:15]
  global_load_ushort v103, v71, s[8:9]
  v_add_u32 v72, 32768, v6
  global_load_ushort v88, v72, s[14:15]
  global_load_ushort v104, v72, s[8:9]
  v_add_u32 v73, 34816, v6
  global_load_ushort v89, v73, s[14:15]
  global_load_ushort v105, v73, s[8:9]
  v_add_u32 v74, 36864, v6
  global_load_ushort v90, v74, s[14:15]
  global_load_ushort v106, v74, s[8:9]
  v_add_u32 v75, 38912, v6
  global_load_ushort v91, v75, s[14:15]
  global_load_ushort v107, v75, s[8:9]
  v_add_u32 v76, 49152, v6
  global_load_ushort v92, v76, s[14:15]
  global_load_ushort v108, v76, s[8:9]
  v_add_u32 v77, 51200, v6
  global_load_ushort v93, v77, s[14:15]
  global_load_ushort v109, v77, s[8:9]
  v_add_u32 v78, 53248, v6
  global_load_ushort v94, v78, s[14:15]
  global_load_ushort v110, v78, s[8:9]
  v_add_u32 v79, 55296, v6
  global_load_ushort v95, v79, s[14:15]
  global_load_ushort v111, v79, s[8:9]
  s_waitcnt vmcnt(0)
  v_lshlrev_b32 v80, 16, v80
  v_lshlrev_b32 v96, 16, v96
  v_add_f32 v9, v32, v80
  v_add_f32 v9, v9, v96
  v_cvt_pk_bf16_f32 v112, v9, v9
  global_store_short v64, v112, s[16:17]
  v_lshlrev_b32 v81, 16, v81
  v_lshlrev_b32 v97, 16, v97
  v_add_f32 v9, v33, v81
  v_add_f32 v9, v9, v97
  v_cvt_pk_bf16_f32 v113, v9, v9
  global_store_short v65, v113, s[16:17]
  v_lshlrev_b32 v82, 16, v82
  v_lshlrev_b32 v98, 16, v98
  v_add_f32 v9, v34, v82
  v_add_f32 v9, v9, v98
  v_cvt_pk_bf16_f32 v114, v9, v9
  global_store_short v66, v114, s[16:17]
  v_lshlrev_b32 v83, 16, v83
  v_lshlrev_b32 v99, 16, v99
  v_add_f32 v9, v35, v83
  v_add_f32 v9, v9, v99
  v_cvt_pk_bf16_f32 v115, v9, v9
  global_store_short v67, v115, s[16:17]
  v_lshlrev_b32 v84, 16, v84
  v_lshlrev_b32 v100, 16, v100
  v_add_f32 v9, v36, v84
  v_add_f32 v9, v9, v100
  v_cvt_pk_bf16_f32 v116, v9, v9
  global_store_short v68, v116, s[16:17]
  v_lshlrev_b32 v85, 16, v85
  v_lshlrev_b32 v101, 16, v101
  v_add_f32 v9, v37, v85
  v_add_f32 v9, v9, v101
  v_cvt_pk_bf16_f32 v117, v9, v9
  global_store_short v69, v117, s[16:17]
  v_lshlrev_b32 v86, 16, v86
  v_lshlrev_b32 v102, 16, v102
  v_add_f32 v9, v38, v86
  v_add_f32 v9, v9, v102
  v_cvt_pk_bf16_f32 v118, v9, v9
  global_store_short v70, v118, s[16:17]
  v_lshlrev_b32 v87, 16, v87
  v_lshlrev_b32 v103, 16, v103
  v_add_f32 v9, v39, v87
  v_add_f32 v9, v9, v103
  v_cvt_pk_bf16_f32 v119, v9, v9
  global_store_short v71, v119, s[16:17]
  v_lshlrev_b32 v88, 16, v88
  v_lshlrev_b32 v104, 16, v104
  v_add_f32 v9, v40, v88
  v_add_f32 v9, v9, v104
  v_cvt_pk_bf16_f32 v120, v9, v9
  global_store_short v72, v120, s[16:17]
  v_lshlrev_b32 v89, 16, v89
  v_lshlrev_b32 v105, 16, v105
  v_add_f32 v9, v41, v89
  v_add_f32 v9, v9, v105
  v_cvt_pk_bf16_f32 v121, v9, v9
  global_store_short v73, v121, s[16:17]
  v_lshlrev_b32 v90, 16, v90
  v_lshlrev_b32 v106, 16, v106
  v_add_f32 v9, v42, v90
  v_add_f32 v9, v9, v106
  v_cvt_pk_bf16_f32 v122, v9, v9
  global_store_short v74, v122, s[16:17]
  v_lshlrev_b32 v91, 16, v91
  v_lshlrev_b32 v107, 16, v107
  v_add_f32 v9, v43, v91
  v_add_f32 v9, v9, v107
  v_cvt_pk_bf16_f32 v123, v9, v9
  global_store_short v75, v123, s[16:17]
  v_lshlrev_b32 v92, 16, v92
  v_lshlrev_b32 v108, 16, v108
  v_add_f32 v9, v44, v92
  v_add_f32 v9, v9, v108
  v_cvt_pk_bf16_f32 v124, v9, v9
  global_store_short v76, v124, s[16:17]
  v_lshlrev_b32 v93, 16, v93
  v_lshlrev_b32 v109, 16, v109
  v_add_f32 v9, v45, v93
  v_add_f32 v9, v9, v109
  v_cvt_pk_bf16_f32 v125, v9, v9
  global_store_short v77, v125, s[16:17]
  v_lshlrev_b32 v94, 16, v94
  v_lshlrev_b32 v110, 16, v110
  v_add_f32 v9, v46, v94
  v_add_f32 v9, v9, v110
  v_cvt_pk_bf16_f32 v126, v9, v9
  global_store_short v78, v126, s[16:17]
  v_lshlrev_b32 v95, 16, v95
  v_lshlrev_b32 v111, 16, v111
  v_add_f32 v9, v47, v95
  v_add_f32 v9, v9, v111
  v_cvt_pk_bf16_f32 v127, v9, v9
  global_store_short v79, v127, s[16:17]
L3_end:
  s_endpgm
.section .rodata,"a"
.p2align 6
.amdhsa_kernel k3_kernel
  .amdhsa_next_free_vgpr 128
  .amdhsa_next_free_sgpr 102
  .amdhsa_accum_offset 128
  .amdhsa_group_segment_fixed_size 0
  .amdhsa_kernarg_size 104
  .amdhsa_user_sgpr_count 2
  .amdhsa_user_sgpr_kernarg_segment_ptr 1
  .amdhsa_system_sgpr_workgroup_id_x 1
.end_amdhsa_kernel
.text
.globl k4_kernel
.p2align 8
.type k4_kernel,@function
k4_kernel:
  s_cmp_ge_u32 s2, 28
  s_cbranch_scc1 L4_end
  s_load_dwordx4 s[4:7], s[0:1], 56
  s_load_dwordx2 s[8:9], s[0:1], 96
  v_and_b32 v62, 63, v0
  v_lshlrev_b32 v63, 2, v62
  v_lshrrev_b32 v61, 6, v0
  s_nop 0
  v_readfirstlane_b32 s3, v61
  s_waitcnt lgkmcnt(0)
  v_lshlrev_b32 v4, 7, v62
  v_add_u32 v4, 4194304, v4
  global_load_dwordx4 v[8:11], v4, s[8:9] offset:0
  global_load_dwordx4 v[12:15], v4, s[8:9] offset:16
  global_load_dwordx4 v[16:19], v4, s[8:9] offset:32
  global_load_dwordx4 v[20:23], v4, s[8:9] offset:48
  global_load_dwordx4 v[24:27], v4, s[8:9] offset:64
  global_load_dwordx4 v[28:31], v4, s[8:9] offset:80
  global_load_dwordx4 v[32:35], v4, s[8:9] offset:96
  global_load_dwordx4 v[36:39], v4, s[8:9] offset:112
  s_waitcnt vmcnt(0)
  v_mov_b32 v5, 0
  v_mov_b32 v6, 0
  v_med3_u32 v6, v5, v6, v8
  v_max_u32 v5, v5, v8
  v_med3_u32 v6, v5, v6, v9
  v_max_u32 v5, v5, v9
  v_med3_u32 v6, v5, v6, v10
  v_max_u32 v5, v5, v10
  v_med3_u32 v6, v5, v6, v11
  v_max_u32 v5, v5, v11
  v_med3_u32 v6, v5, v6, v12
  v_max_u32 v5, v5, v12
  v_med3_u32 v6, v5, v6, v13
  v_max_u32 v5, v5, v13
  v_med3_u32 v6, v5, v6, v14
  v_max_u32 v5, v5, v14
  v_med3_u32 v6, v5, v6, v15
  v_max_u32 v5, v5, v15
  v_med3_u32 v6, v5, v6, v16
  v_max_u32 v5, v5, v16
  v_med3_u32 v6, v5, v6, v17
  v_max_u32 v5, v5, v17
  v_med3_u32 v6, v5, v6, v18
  v_max_u32 v5, v5, v18
  v_med3_u32 v6, v5, v6, v19
  v_max_u32 v5, v5, v19
  v_med3_u32 v6, v5, v6, v20
  v_max_u32 v5, v5, v20
  v_med3_u32 v6, v5, v6, v21
  v_max_u32 v5, v5, v21
  v_med3_u32 v6, v5, v6, v22
  v_max_u32 v5, v5, v22
  v_med3_u32 v6, v5, v6, v23
  v_max_u32 v5, v5, v23
  v_med3_u32 v6, v5, v6, v24
  v_max_u32 v5, v5, v24
  v_med3_u32 v6, v5, v6, v25
  v_max_u32 v5, v5, v25
  v_med3_u32 v6, v5, v6, v26
  v_max_u32 v5, v5, v26
  v_med3_u32 v6, v5, v6, v27
  v_max_u32 v5, v5, v27
  v_med3_u32 v6, v5, v6, v28
  v_max_u32 v5, v5, v28
  v_med3_u32 v6, v5, v6, v29
  v_max_u32 v5, v5, v29
  v_med3_u32 v6, v5, v6, v30
  v_max_u32 v5, v5, v30
  v_med3_u32 v6, v5, v6, v31
  v_max_u32 v5, v5, v31
  v_med3_u32 v6, v5, v6, v32
  v_max_u32 v5, v5, v32
  v_med3_u32 v6, v5, v6, v33
  v_max_u32 v5, v5, v33
  v_med3_u32 v6, v5, v6, v34
  v_max_u32 v5, v5, v34
  v_med3_u32 v6, v5, v6, v35
  v_max_u32 v5, v5, v35
  v_med3_u32 v6, v5, v6, v36
  v_max_u32 v5, v5, v36
  v_med3_u32 v6, v5, v6, v37
  v_max_u32 v5, v5, v37
  v_med3_u32 v6, v5, v6, v38
  v_max_u32 v5, v5, v38
  v_med3_u32 v6, v5, v6, v39
  v_max_u32 v5, v5, v39
  v_xor_b32 v7, 4, v63
  ds_bpermute_b32 v8, v7, v5
  ds_bpermute_b32 v9, v7, v6
  s_waitcnt lgkmcnt(0)
  v_max_u32 v6, v6, v9
  v_min_u32 v9, v5, v8
  v_max_u32 v6, v6, v9
  v_max_u32 v5, v5, v8
  v_xor_b32 v7, 8, v63
  ds_bpermute_b32 v8, v7, v5
  ds_bpermute_b32 v9, v7, v6
  s_waitcnt lgkmcnt(0)
  v_max_u32 v6, v6, v9
  v_min_u32 v9, v5, v8
  v_max_u32 v6, v6, v9
  v_max_u32 v5, v5, v8
  v_xor_b32 v7, 16, v63
  ds_bpermute_b32 v8, v7, v5
  ds_bpermute_b32 v9, v7, v6
  s_waitcnt lgkmcnt(0)
  v_max_u32 v6, v6, v9
  v_min_u32 v9, v5, v8
  v_max_u32 v6, v6, v9
  v_max_u32 v5, v5, v8
  v_xor_b32 v7, 32, v63
  ds_bpermute_b32 v8, v7, v5
  ds_bpermute_b32 v9, v7, v6
  s_waitcnt lgkmcnt(0)
  v_max_u32 v6, v6, v9
  v_min_u32 v9, v5, v8
  v_max_u32 v6, v6, v9
  v_max_u32 v5, v5, v8
  v_xor_b32 v7, 64, v63
  ds_bpermute_b32 v8, v7, v5
  ds_bpermute_b32 v9, v7, v6
  s_waitcnt lgkmcnt(0)
  v_max_u32 v6, v6, v9
  v_min_u32 v9, v5, v8
  v_max_u32 v6, v6, v9
  v_max_u32 v5, v5, v8
  v_xor_b32 v7, 128, v63
  ds_bpermute_b32 v8, v7, v5
  ds_bpermute_b32 v9, v7, v6
  s_waitcnt lgkmcnt(0)
  v_max_u32 v6, v6, v9
  v_min_u32 v9, v5, v8
  v_max_u32 v6, v6, v9
  v_max_u32 v5, v5, v8
  s_nop 1
  v_readfirstlane_b32 s20, v5
  v_readfirstlane_b32 s21, v6
  s_nop 3
  s_and_b32 s22, s20, 0xffff
  s_sub_u32 s22, 0xffff, s22
  s_and_b32 s23, s21, 0xffff
  s_sub_u32 s23, 0xffff, s23
  s_lshl_b32 s24, s3, 7
  s_lshl_b32 s25, s22, 11
  s_add_u32 s25, s25, s24
  s_lshl_b32 s26, s23, 11
  s_add_u32 s26, s26, s24
  v_lshl_add_u32 v4, v62, 1, s25
  v_lshl_add_u32 v5, v62, 1, s26
  global_load_ushort v40, v4, s[8:9]
  global_load_ushort v41, v5, s[8:9]
  s_mul_i32 s27, s3, 458752
  s_lshl_b32 s28, s2, 8
  s_add_u32 s27, s27, s28
  v_add_u32 v4, s27, v63
  s_waitcnt vmcnt(0)
  v_lshlrev_b32 v40, 16, v40
  v_lshlrev_b32 v41, 16, v41
  v_mov_b32 v44, 0
  v_mov_b32 v45, 0
  v_mov_b32 v46, 0
  v_mov_b32 v47, 0
  v_mov_b32 v48, 0
  v_mov_b32 v49, 0
  v_mov_b32 v50, 0
  v_mov_b32 v51, 0
  global_load_dword v8, v4, s[4:5]
  global_load_dword v24, v4, s[6:7]
  v_add_u32 v4, 7168, v4
  global_load_dword v9, v4, s[4:5]
  global_load_dword v25, v4, s[6:7]
  v_add_u32 v4, 7168, v4
  global_load_dword v10, v4, s[4:5]
  global_load_dword v26, v4, s[6:7]
  v_add_u32 v4, 7168, v4
  global_load_dword v11, v4, s[4:5]
  global_load_dword v27, v4, s[6:7]
  v_add_u32 v4, 7168, v4
  global_load_dword v12, v4, s[4:5]
  global_load_dword v28, v4, s[6:7]
  v_add_u32 v4, 7168, v4
  global_load_dword v13, v4, s[4:5]
  global_load_dword v29, v4, s[6:7]
  v_add_u32 v4, 7168, v4
  global_load_dword v14, v4, s[4:5]
  global_load_dword v30, v4, s[6:7]
  v_add_u32 v4, 7168, v4
  global_load_dword v15, v4, s[4:5]
  global_load_dword v31, v4, s[6:7]
  v_add_u32 v4, 7168, v4
  global_load_dword v16, v4, s[4:5]
  global_load_dword v32, v4, s[6:7]
  v_add_u32 v4, 7168, v4
  global_load_dword v17, v4, s[4:5]
  global_load_dword v33, v4, s[6:7]
  v_add_u32 v4, 7168, v4
  global_load_dword v18, v4, s[4:5]
  global_load_dword v34, v4, s[6:7]
  v_add_u32 v4, 7168, v4
  global_load_dword v19, v4, s[4:5]
  global_load_dword v35, v4, s[6:7]
  v_add_u32 v4, 7168, v4
  global_load_dword v20, v4, s[4:5]
  global_load_dword v36, v4, s[6:7]
  v_add_u32 v4, 7168, v4
  global_load_dword v21, v4, s[4:5]
  global_load_dword v37, v4, s[6:7]
  v_add_u32 v4, 7168, v4
  global_load_dword v22, v4, s[4:5]
  global_load_dword v38, v4, s[6:7]
  v_add_u32 v4, 7168, v4
  global_load_dword v23, v4, s[4:5]
  global_load_dword v39, v4, s[6:7]
  v_add_u32 v4, 7168, v4
  s_waitcnt vmcnt(0)
  v_readlane_b32 s30, v40, 0
  v_readlane_b32 s31, v41, 0
  v_lshlrev_b32 v52, 16, v8
  v_and_b32 v53, 0xffff0000, v8
  v_fmac_f32 v44, s30, v52
  v_fmac_f32 v45, s30, v53
  v_fmac_f32 v46, s31, v52
  v_fmac_f32 v47, s31, v53
  v_lshlrev_b32 v52, 16, v24
  v_and_b32 v53, 0xffff0000, v24
  v_fmac_f32 v48, s30, v52
  v_fmac_f32 v49, s30, v53
  v_fmac_f32 v50, s31, v52
  v_fmac_f32 v51, s31, v53
  v_readlane_b32 s30, v40, 1
  v_readlane_b32 s31, v41, 1
  v_lshlrev_b32 v52, 16, v9
  v_and_b32 v53, 0xffff0000, v9
  v_fmac_f32 v44, s30, v52
  v_fmac_f32 v45, s30, v53
  v_fmac_f32 v46, s31, v52
  v_fmac_f32 v47, s31, v53
  v_lshlrev_b32 v52, 16, v25
  v_and_b32 v53, 0xffff0000, v25
  v_fmac_f32 v48, s30, v52
  v_fmac_f32 v49, s30, v53
  v_fmac_f32 v50, s31, v52
  v_fmac_f32 v51, s31, v53
  v_readlane_b32 s30, v40, 2
  v_readlane_b32 s31, v41, 2
  v_lshlrev_b32 v52, 16, v10
  v_and_b32 v53, 0xffff0000, v10
  v_fmac_f32 v44, s30, v52
  v_fmac_f32 v45, s30, v53
  v_fmac_f32 v46, s31, v52
  v_fmac_f32 v47, s31, v53
  v_lshlrev_b32 v52, 16, v26
  v_and_b32 v53, 0xffff0000, v26
  v_fmac_f32 v48, s30, v52
  v_fmac_f32 v49, s30, v53
  v_fmac_f32 v50, s31, v52
  v_fmac_f32 v51, s31, v53
  v_readlane_b32 s30, v40, 3
  v_readlane_b32 s31, v41, 3
  v_lshlrev_b32 v52, 16, v11
  v_and_b32 v53, 0xffff0000, v11
  v_fmac_f32 v44, s30, v52
  v_fmac_f32 v45, s30, v53
  v_fmac_f32 v46, s31, v52
  v_fmac_f32 v47, s31, v53
  v_lshlrev_b32 v52, 16, v27
  v_and_b32 v53, 0xffff0000, v27
  v_fmac_f32 v48, s30, v52
  v_fmac_f32 v49, s30, v53
  v_fmac_f32 v50, s31, v52
  v_fmac_f32 v51, s31, v53
  v_readlane_b32 s30, v40, 4
  v_readlane_b32 s31, v41, 4
  v_lshlrev_b32 v52, 16, v12
  v_and_b32 v53, 0xffff0000, v12
  v_fmac_f32 v44, s30, v52
  v_fmac_f32 v45, s30, v53
  v_fmac_f32 v46, s31, v52
  v_fmac_f32 v47, s31, v53
  v_lshlrev_b32 v52, 16, v28
  v_and_b32 v53, 0xffff0000, v28
  v_fmac_f32 v48, s30, v52
  v_fmac_f32 v49, s30, v53
  v_fmac_f32 v50, s31, v52
  v_fmac_f32 v51, s31, v53
  v_readlane_b32 s30, v40, 5
  v_readlane_b32 s31, v41, 5
  v_lshlrev_b32 v52, 16, v13
  v_and_b32 v53, 0xffff0000, v13
  v_fmac_f32 v44, s30, v52
  v_fmac_f32 v45, s30, v53
  v_fmac_f32 v46, s31, v52
  v_fmac_f32 v47, s31, v53
  v_lshlrev_b32 v52, 16, v29
  v_and_b32 v53, 0xffff0000, v29
  v_fmac_f32 v48, s30, v52
  v_fmac_f32 v49, s30, v53
  v_fmac_f32 v50, s31, v52
  v_fmac_f32 v51, s31, v53
  v_readlane_b32 s30, v40, 6
  v_readlane_b32 s31, v41, 6
  v_lshlrev_b32 v52, 16, v14
  v_and_b32 v53, 0xffff0000, v14
  v_fmac_f32 v44, s30, v52
  v_fmac_f32 v45, s30, v53
  v_fmac_f32 v46, s31, v52
  v_fmac_f32 v47, s31, v53
  v_lshlrev_b32 v52, 16, v30
  v_and_b32 v53, 0xffff0000, v30
  v_fmac_f32 v48, s30, v52
  v_fmac_f32 v49, s30, v53
  v_fmac_f32 v50, s31, v52
  v_fmac_f32 v51, s31, v53
  v_readlane_b32 s30, v40, 7
  v_readlane_b32 s31, v41, 7
  v_lshlrev_b32 v52, 16, v15
  v_and_b32 v53, 0xffff0000, v15
  v_fmac_f32 v44, s30, v52
  v_fmac_f32 v45, s30, v53
  v_fmac_f32 v46, s31, v52
  v_fmac_f32 v47, s31, v53
  v_lshlrev_b32 v52, 16, v31
  v_and_b32 v53, 0xffff0000, v31
  v_fmac_f32 v48, s30, v52
  v_fmac_f32 v49, s30, v53
  v_fmac_f32 v50, s31, v52
  v_fmac_f32 v51, s31, v53
  v_readlane_b32 s30, v40, 8
  v_readlane_b32 s31, v41, 8
  v_lshlrev_b32 v52, 16, v16
  v_and_b32 v53, 0xffff0000, v16
  v_fmac_f32 v44, s30, v52
  v_fmac_f32 v45, s30, v53
  v_fmac_f32 v46, s31, v52
  v_fmac_f32 v47, s31, v53
  v_lshlrev_b32 v52, 16, v32
  v_and_b32 v53, 0xffff0000, v32
  v_fmac_f32 v48, s30, v52
  v_fmac_f32 v49, s30, v53
  v_fmac_f32 v50, s31, v52
  v_fmac_f32 v51, s31, v53
  v_readlane_b32 s30, v40, 9
  v_readlane_b32 s31, v41, 9
  v_lshlrev_b32 v52, 16, v17
  v_and_b32 v53, 0xffff0000, v17
  v_fmac_f32 v44, s30, v52
  v_fmac_f32 v45, s30, v53
  v_fmac_f32 v46, s31, v52
  v_fmac_f32 v47, s31, v53
  v_lshlrev_b32 v52, 16, v33
  v_and_b32 v53, 0xffff0000, v33
  v_fmac_f32 v48, s30, v52
  v_fmac_f32 v49, s30, v53
  v_fmac_f32 v50, s31, v52
  v_fmac_f32 v51, s31, v53
  v_readlane_b32 s30, v40, 10
  v_readlane_b32 s31, v41, 10
  v_lshlrev_b32 v52, 16, v18
  v_and_b32 v53, 0xffff0000, v18
  v_fmac_f32 v44, s30, v52
  v_fmac_f32 v45, s30, v53
  v_fmac_f32 v46, s31, v52
  v_fmac_f32 v47, s31, v53
  v_lshlrev_b32 v52, 16, v34
  v_and_b32 v53, 0xffff0000, v34
  v_fmac_f32 v48, s30, v52
  v_fmac_f32 v49, s30, v53
  v_fmac_f32 v50, s31, v52
  v_fmac_f32 v51, s31, v53
  v_readlane_b32 s30, v40, 11
  v_readlane_b32 s31, v41, 11
  v_lshlrev_b32 v52, 16, v19
  v_and_b32 v53, 0xffff0000, v19
  v_fmac_f32 v44, s30, v52
  v_fmac_f32 v45, s30, v53
  v_fmac_f32 v46, s31, v52
  v_fmac_f32 v47, s31, v53
  v_lshlrev_b32 v52, 16, v35
  v_and_b32 v53, 0xffff0000, v35
  v_fmac_f32 v48, s30, v52
  v_fmac_f32 v49, s30, v53
  v_fmac_f32 v50, s31, v52
  v_fmac_f32 v51, s31, v53
  v_readlane_b32 s30, v40, 12
  v_readlane_b32 s31, v41, 12
  v_lshlrev_b32 v52, 16, v20
  v_and_b32 v53, 0xffff0000, v20
  v_fmac_f32 v44, s30, v52
  v_fmac_f32 v45, s30, v53
  v_fmac_f32 v46, s31, v52
  v_fmac_f32 v47, s31, v53
  v_lshlrev_b32 v52, 16, v36
  v_and_b32 v53, 0xffff0000, v36
  v_fmac_f32 v48, s30, v52
  v_fmac_f32 v49, s30, v53
  v_fmac_f32 v50, s31, v52
  v_fmac_f32 v51, s31, v53
  v_readlane_b32 s30, v40, 13
  v_readlane_b32 s31, v41, 13
  v_lshlrev_b32 v52, 16, v21
  v_and_b32 v53, 0xffff0000, v21
  v_fmac_f32 v44, s30, v52
  v_fmac_f32 v45, s30, v53
  v_fmac_f32 v46, s31, v52
  v_fmac_f32 v47, s31, v53
  v_lshlrev_b32 v52, 16, v37
  v_and_b32 v53, 0xffff0000, v37
  v_fmac_f32 v48, s30, v52
  v_fmac_f32 v49, s30, v53
  v_fmac_f32 v50, s31, v52
  v_fmac_f32 v51, s31, v53
  v_readlane_b32 s30, v40, 14
  v_readlane_b32 s31, v41, 14
  v_lshlrev_b32 v52, 16, v22
  v_and_b32 v53, 0xffff0000, v22
  v_fmac_f32 v44, s30, v52
  v_fmac_f32 v45, s30, v53
  v_fmac_f32 v46, s31, v52
  v_fmac_f32 v47, s31, v53
  v_lshlrev_b32 v52, 16, v38
  v_and_b32 v53, 0xffff0000, v38
  v_fmac_f32 v48, s30, v52
  v_fmac_f32 v49, s30, v53
  v_fmac_f32 v50, s31, v52
  v_fmac_f32 v51, s31, v53
  v_readlane_b32 s30, v40, 15
  v_readlane_b32 s31, v41, 15
  v_lshlrev_b32 v52, 16, v23
  v_and_b32 v53, 0xffff0000, v23
  v_fmac_f32 v44, s30, v52
  v_fmac_f32 v45, s30, v53
  v_fmac_f32 v46, s31, v52
  v_fmac_f32 v47, s31, v53
  v_lshlrev_b32 v52, 16, v39
  v_and_b32 v53, 0xffff0000, v39
  v_fmac_f32 v48, s30, v52
  v_fmac_f32 v49, s30, v53
  v_fmac_f32 v50, s31, v52
  v_fmac_f32 v51, s31, v53
  global_load_dword v8, v4, s[4:5]
  global_load_dword v24, v4, s[6:7]
  v_add_u32 v4, 7168, v4
  global_load_dword v9, v4, s[4:5]
  global_load_dword v25, v4, s[6:7]
  v_add_u32 v4, 7168, v4
  global_load_dword v10, v4, s[4:5]
  global_load_dword v26, v4, s[6:7]
  v_add_u32 v4, 7168, v4
  global_load_dword v11, v4, s[4:5]
  global_load_dword v27, v4, s[6:7]
  v_add_u32 v4, 7168, v4
  global_load_dword v12, v4, s[4:5]
  global_load_dword v28, v4, s[6:7]
  v_add_u32 v4, 7168, v4
  global_load_dword v13, v4, s[4:5]
  global_load_dword v29, v4, s[6:7]
  v_add_u32 v4, 7168, v4
  global_load_dword v14, v4, s[4:5]
  global_load_dword v30, v4, s[6:7]
  v_add_u32 v4, 7168, v4
  global_load_dword v15, v4, s[4:5]
  global_load_dword v31, v4, s[6:7]
  v_add_u32 v4, 7168, v4
  global_load_dword v16, v4, s[4:5]
  global_load_dword v32, v4, s[6:7]
  v_add_u32 v4, 7168, v4
  global_load_dword v17, v4, s[4:5]
  global_load_dword v33, v4, s[6:7]
  v_add_u32 v4, 7168, v4
  global_load_dword v18, v4, s[4:5]
  global_load_dword v34, v4, s[6:7]
  v_add_u32 v4, 7168, v4
  global_load_dword v19, v4, s[4:5]
  global_load_dword v35, v4, s[6:7]
  v_add_u32 v4, 7168, v4
  global_load_dword v20, v4, s[4:5]
  global_load_dword v36, v4, s[6:7]
  v_add_u32 v4, 7168, v4
  global_load_dword v21, v4, s[4:5]
  global_load_dword v37, v4, s[6:7]
  v_add_u32 v4, 7168, v4
  global_load_dword v22, v4, s[4:5]
  global_load_dword v38, v4, s[6:7]
  v_add_u32 v4, 7168, v4
  global_load_dword v23, v4, s[4:5]
  global_load_dword v39, v4, s[6:7]
  v_add_u32 v4, 7168, v4
  s_waitcnt vmcnt(0)
  v_readlane_b32 s30, v40, 16
  v_readlane_b32 s31, v41, 16
  v_lshlrev_b32 v52, 16, v8
  v_and_b32 v53, 0xffff0000, v8
  v_fmac_f32 v44, s30, v52
  v_fmac_f32 v45, s30, v53
  v_fmac_f32 v46, s31, v52
  v_fmac_f32 v47, s31, v53
  v_lshlrev_b32 v52, 16, v24
  v_and_b32 v53, 0xffff0000, v24
  v_fmac_f32 v48, s30, v52
  v_fmac_f32 v49, s30, v53
  v_fmac_f32 v50, s31, v52
  v_fmac_f32 v51, s31, v53
  v_readlane_b32 s30, v40, 17
  v_readlane_b32 s31, v41, 17
  v_lshlrev_b32 v52, 16, v9
  v_and_b32 v53, 0xffff0000, v9
  v_fmac_f32 v44, s30, v52
  v_fmac_f32 v45, s30, v53
  v_fmac_f32 v46, s31, v52
  v_fmac_f32 v47, s31, v53
  v_lshlrev_b32 v52, 16, v25
  v_and_b32 v53, 0xffff0000, v25
  v_fmac_f32 v48, s30, v52
  v_fmac_f32 v49, s30, v53
  v_fmac_f32 v50, s31, v52
  v_fmac_f32 v51, s31, v53
  v_readlane_b32 s30, v40, 18
  v_readlane_b32 s31, v41, 18
  v_lshlrev_b32 v52, 16, v10
  v_and_b32 v53, 0xffff0000, v10
  v_fmac_f32 v44, s30, v52
  v_fmac_f32 v45, s30, v53
  v_fmac_f32 v46, s31, v52
  v_fmac_f32 v47, s31, v53
  v_lshlrev_b32 v52, 16, v26
  v_and_b32 v53, 0xffff0000, v26
  v_fmac_f32 v48, s30, v52
  v_fmac_f32 v49, s30, v53
  v_fmac_f32 v50, s31, v52
  v_fmac_f32 v51, s31, v53
  v_readlane_b32 s30, v40, 19
  v_readlane_b32 s31, v41, 19
  v_lshlrev_b32 v52, 16, v11
  v_and_b32 v53, 0xffff0000, v11
  v_fmac_f32 v44, s30, v52
  v_fmac_f32 v45, s30, v53
  v_fmac_f32 v46, s31, v52
  v_fmac_f32 v47, s31, v53
  v_lshlrev_b32 v52, 16, v27
  v_and_b32 v53, 0xffff0000, v27
  v_fmac_f32 v48, s30, v52
  v_fmac_f32 v49, s30, v53
  v_fmac_f32 v50, s31, v52
  v_fmac_f32 v51, s31, v53
  v_readlane_b32 s30, v40, 20
  v_readlane_b32 s31, v41, 20
  v_lshlrev_b32 v52, 16, v12
  v_and_b32 v53, 0xffff0000, v12
  v_fmac_f32 v44, s30, v52
  v_fmac_f32 v45, s30, v53
  v_fmac_f32 v46, s31, v52
  v_fmac_f32 v47, s31, v53
  v_lshlrev_b32 v52, 16, v28
  v_and_b32 v53, 0xffff0000, v28
  v_fmac_f32 v48, s30, v52
  v_fmac_f32 v49, s30, v53
  v_fmac_f32 v50, s31, v52
  v_fmac_f32 v51, s31, v53
  v_readlane_b32 s30, v40, 21
  v_readlane_b32 s31, v41, 21
  v_lshlrev_b32 v52, 16, v13
  v_and_b32 v53, 0xffff0000, v13
  v_fmac_f32 v44, s30, v52
  v_fmac_f32 v45, s30, v53
  v_fmac_f32 v46, s31, v52
  v_fmac_f32 v47, s31, v53
  v_lshlrev_b32 v52, 16, v29
  v_and_b32 v53, 0xffff0000, v29
  v_fmac_f32 v48, s30, v52
  v_fmac_f32 v49, s30, v53
  v_fmac_f32 v50, s31, v52
  v_fmac_f32 v51, s31, v53
  v_readlane_b32 s30, v40, 22
  v_readlane_b32 s31, v41, 22
  v_lshlrev_b32 v52, 16, v14
  v_and_b32 v53, 0xffff0000, v14
  v_fmac_f32 v44, s30, v52
  v_fmac_f32 v45, s30, v53
  v_fmac_f32 v46, s31, v52
  v_fmac_f32 v47, s31, v53
  v_lshlrev_b32 v52, 16, v30
  v_and_b32 v53, 0xffff0000, v30
  v_fmac_f32 v48, s30, v52
  v_fmac_f32 v49, s30, v53
  v_fmac_f32 v50, s31, v52
  v_fmac_f32 v51, s31, v53
  v_readlane_b32 s30, v40, 23
  v_readlane_b32 s31, v41, 23
  v_lshlrev_b32 v52, 16, v15
  v_and_b32 v53, 0xffff0000, v15
  v_fmac_f32 v44, s30, v52
  v_fmac_f32 v45, s30, v53
  v_fmac_f32 v46, s31, v52
  v_fmac_f32 v47, s31, v53
  v_lshlrev_b32 v52, 16, v31
  v_and_b32 v53, 0xffff0000, v31
  v_fmac_f32 v48, s30, v52
  v_fmac_f32 v49, s30, v53
  v_fmac_f32 v50, s31, v52
  v_fmac_f32 v51, s31, v53
  v_readlane_b32 s30, v40, 24
  v_readlane_b32 s31, v41, 24
  v_lshlrev_b32 v52, 16, v16
  v_and_b32 v53, 0xffff0000, v16
  v_fmac_f32 v44, s30, v52
  v_fmac_f32 v45, s30, v53
  v_fmac_f32 v46, s31, v52
  v_fmac_f32 v47, s31, v53
  v_lshlrev_b32 v52, 16, v32
  v_and_b32 v53, 0xffff0000, v32
  v_fmac_f32 v48, s30, v52
  v_fmac_f32 v49, s30, v53
  v_fmac_f32 v50, s31, v52
  v_fmac_f32 v51, s31, v53
  v_readlane_b32 s30, v40, 25
  v_readlane_b32 s31, v41, 25
  v_lshlrev_b32 v52, 16, v17
  v_and_b32 v53, 0xffff0000, v17
  v_fmac_f32 v44, s30, v52
  v_fmac_f32 v45, s30, v53
  v_fmac_f32 v46, s31, v52
  v_fmac_f32 v47, s31, v53
  v_lshlrev_b32 v52, 16, v33
  v_and_b32 v53, 0xffff0000, v33
  v_fmac_f32 v48, s30, v52
  v_fmac_f32 v49, s30, v53
  v_fmac_f32 v50, s31, v52
  v_fmac_f32 v51, s31, v53
  v_readlane_b32 s30, v40, 26
  v_readlane_b32 s31, v41, 26
  v_lshlrev_b32 v52, 16, v18
  v_and_b32 v53, 0xffff0000, v18
  v_fmac_f32 v44, s30, v52
  v_fmac_f32 v45, s30, v53
  v_fmac_f32 v46, s31, v52
  v_fmac_f32 v47, s31, v53
  v_lshlrev_b32 v52, 16, v34
  v_and_b32 v53, 0xffff0000, v34
  v_fmac_f32 v48, s30, v52
  v_fmac_f32 v49, s30, v53
  v_fmac_f32 v50, s31, v52
  v_fmac_f32 v51, s31, v53
  v_readlane_b32 s30, v40, 27
  v_readlane_b32 s31, v41, 27
  v_lshlrev_b32 v52, 16, v19
  v_and_b32 v53, 0xffff0000, v19
  v_fmac_f32 v44, s30, v52
  v_fmac_f32 v45, s30, v53
  v_fmac_f32 v46, s31, v52
  v_fmac_f32 v47, s31, v53
  v_lshlrev_b32 v52, 16, v35
  v_and_b32 v53, 0xffff0000, v35
  v_fmac_f32 v48, s30, v52
  v_fmac_f32 v49, s30, v53
  v_fmac_f32 v50, s31, v52
  v_fmac_f32 v51, s31, v53
  v_readlane_b32 s30, v40, 28
  v_readlane_b32 s31, v41, 28
  v_lshlrev_b32 v52, 16, v20
  v_and_b32 v53, 0xffff0000, v20
  v_fmac_f32 v44, s30, v52
  v_fmac_f32 v45, s30, v53
  v_fmac_f32 v46, s31, v52
  v_fmac_f32 v47, s31, v53
  v_lshlrev_b32 v52, 16, v36
  v_and_b32 v53, 0xffff0000, v36
  v_fmac_f32 v48, s30, v52
  v_fmac_f32 v49, s30, v53
  v_fmac_f32 v50, s31, v52
  v_fmac_f32 v51, s31, v53
  v_readlane_b32 s30, v40, 29
  v_readlane_b32 s31, v41, 29
  v_lshlrev_b32 v52, 16, v21
  v_and_b32 v53, 0xffff0000, v21
  v_fmac_f32 v44, s30, v52
  v_fmac_f32 v45, s30, v53
  v_fmac_f32 v46, s31, v52
  v_fmac_f32 v47, s31, v53
  v_lshlrev_b32 v52, 16, v37
  v_and_b32 v53, 0xffff0000, v37
  v_fmac_f32 v48, s30, v52
  v_fmac_f32 v49, s30, v53
  v_fmac_f32 v50, s31, v52
  v_fmac_f32 v51, s31, v53
  v_readlane_b32 s30, v40, 30
  v_readlane_b32 s31, v41, 30
  v_lshlrev_b32 v52, 16, v22
  v_and_b32 v53, 0xffff0000, v22
  v_fmac_f32 v44, s30, v52
  v_fmac_f32 v45, s30, v53
  v_fmac_f32 v46, s31, v52
  v_fmac_f32 v47, s31, v53
  v_lshlrev_b32 v52, 16, v38
  v_and_b32 v53, 0xffff0000, v38
  v_fmac_f32 v48, s30, v52
  v_fmac_f32 v49, s30, v53
  v_fmac_f32 v50, s31, v52
  v_fmac_f32 v51, s31, v53
  v_readlane_b32 s30, v40, 31
  v_readlane_b32 s31, v41, 31
  v_lshlrev_b32 v52, 16, v23
  v_and_b32 v53, 0xffff0000, v23
  v_fmac_f32 v44, s30, v52
  v_fmac_f32 v45, s30, v53
  v_fmac_f32 v46, s31, v52
  v_fmac_f32 v47, s31, v53
  v_lshlrev_b32 v52, 16, v39
  v_and_b32 v53, 0xffff0000, v39
  v_fmac_f32 v48, s30, v52
  v_fmac_f32 v49, s30, v53
  v_fmac_f32 v50, s31, v52
  v_fmac_f32 v51, s31, v53
  global_load_dword v8, v4, s[4:5]
  global_load_dword v24, v4, s[6:7]
  v_add_u32 v4, 7168, v4
  global_load_dword v9, v4, s[4:5]
  global_load_dword v25, v4, s[6:7]
  v_add_u32 v4, 7168, v4
  global_load_dword v10, v4, s[4:5]
  global_load_dword v26, v4, s[6:7]
  v_add_u32 v4, 7168, v4
  global_load_dword v11, v4, s[4:5]
  global_load_dword v27, v4, s[6:7]
  v_add_u32 v4, 7168, v4
  global_load_dword v12, v4, s[4:5]
  global_load_dword v28, v4, s[6:7]
  v_add_u32 v4, 7168, v4
  global_load_dword v13, v4, s[4:5]
  global_load_dword v29, v4, s[6:7]
  v_add_u32 v4, 7168, v4
  global_load_dword v14, v4, s[4:5]
  global_load_dword v30, v4, s[6:7]
  v_add_u32 v4, 7168, v4
  global_load_dword v15, v4, s[4:5]
  global_load_dword v31, v4, s[6:7]
  v_add_u32 v4, 7168, v4
  global_load_dword v16, v4, s[4:5]
  global_load_dword v32, v4, s[6:7]
  v_add_u32 v4, 7168, v4
  global_load_dword v17, v4, s[4:5]
  global_load_dword v33, v4, s[6:7]
  v_add_u32 v4, 7168, v4
  global_load_dword v18, v4, s[4:5]
  global_load_dword v34, v4, s[6:7]
  v_add_u32 v4, 7168, v4
  global_load_dword v19, v4, s[4:5]
  global_load_dword v35, v4, s[6:7]
  v_add_u32 v4, 7168, v4
  global_load_dword v20, v4, s[4:5]
  global_load_dword v36, v4, s[6:7]
  v_add_u32 v4, 7168, v4
  global_load_dword v21, v4, s[4:5]
  global_load_dword v37, v4, s[6:7]
  v_add_u32 v4, 7168, v4
  global_load_dword v22, v4, s[4:5]
  global_load_dword v38, v4, s[6:7]
  v_add_u32 v4, 7168, v4
  global_load_dword v23, v4, s[4:5]
  global_load_dword v39, v4, s[6:7]
  v_add_u32 v4, 7168, v4
  s_waitcnt vmcnt(0)
  v_readlane_b32 s30, v40, 32
  v_readlane_b32 s31, v41, 32
  v_lshlrev_b32 v52, 16, v8
  v_and_b32 v53, 0xffff0000, v8
  v_fmac_f32 v44, s30, v52
  v_fmac_f32 v45, s30, v53
  v_fmac_f32 v46, s31, v52
  v_fmac_f32 v47, s31, v53
  v_lshlrev_b32 v52, 16, v24
  v_and_b32 v53, 0xffff0000, v24
  v_fmac_f32 v48, s30, v52
  v_fmac_f32 v49, s30, v53
  v_fmac_f32 v50, s31, v52
  v_fmac_f32 v51, s31, v53
  v_readlane_b32 s30, v40, 33
  v_readlane_b32 s31, v41, 33
  v_lshlrev_b32 v52, 16, v9
  v_and_b32 v53, 0xffff0000, v9
  v_fmac_f32 v44, s30, v52
  v_fmac_f32 v45, s30, v53
  v_fmac_f32 v46, s31, v52
  v_fmac_f32 v47, s31, v53
  v_lshlrev_b32 v52, 16, v25
  v_and_b32 v53, 0xffff0000, v25
  v_fmac_f32 v48, s30, v52
  v_fmac_f32 v49, s30, v53
  v_fmac_f32 v50, s31, v52
  v_fmac_f32 v51, s31, v53
  v_readlane_b32 s30, v40, 34
  v_readlane_b32 s31, v41, 34
  v_lshlrev_b32 v52, 16, v10
  v_and_b32 v53, 0xffff0000, v10
  v_fmac_f32 v44, s30, v52
  v_fmac_f32 v45, s30, v53
  v_fmac_f32 v46, s31, v52
  v_fmac_f32 v47, s31, v53
  v_lshlrev_b32 v52, 16, v26
  v_and_b32 v53, 0xffff0000, v26
  v_fmac_f32 v48, s30, v52
  v_fmac_f32 v49, s30, v53
  v_fmac_f32 v50, s31, v52
  v_fmac_f32 v51, s31, v53
  v_readlane_b32 s30, v40, 35
  v_readlane_b32 s31, v41, 35
  v_lshlrev_b32 v52, 16, v11
  v_and_b32 v53, 0xffff0000, v11
  v_fmac_f32 v44, s30, v52
  v_fmac_f32 v45, s30, v53
  v_fmac_f32 v46, s31, v52
  v_fmac_f32 v47, s31, v53
  v_lshlrev_b32 v52, 16, v27
  v_and_b32 v53, 0xffff0000, v27
  v_fmac_f32 v48, s30, v52
  v_fmac_f32 v49, s30, v53
  v_fmac_f32 v50, s31, v52
  v_fmac_f32 v51, s31, v53
  v_readlane_b32 s30, v40, 36
  v_readlane_b32 s31, v41, 36
  v_lshlrev_b32 v52, 16, v12
  v_and_b32 v53, 0xffff0000, v12
  v_fmac_f32 v44, s30, v52
  v_fmac_f32 v45, s30, v53
  v_fmac_f32 v46, s31, v52
  v_fmac_f32 v47, s31, v53
  v_lshlrev_b32 v52, 16, v28
  v_and_b32 v53, 0xffff0000, v28
  v_fmac_f32 v48, s30, v52
  v_fmac_f32 v49, s30, v53
  v_fmac_f32 v50, s31, v52
  v_fmac_f32 v51, s31, v53
  v_readlane_b32 s30, v40, 37
  v_readlane_b32 s31, v41, 37
  v_lshlrev_b32 v52, 16, v13
  v_and_b32 v53, 0xffff0000, v13
  v_fmac_f32 v44, s30, v52
  v_fmac_f32 v45, s30, v53
  v_fmac_f32 v46, s31, v52
  v_fmac_f32 v47, s31, v53
  v_lshlrev_b32 v52, 16, v29
  v_and_b32 v53, 0xffff0000, v29
  v_fmac_f32 v48, s30, v52
  v_fmac_f32 v49, s30, v53
  v_fmac_f32 v50, s31, v52
  v_fmac_f32 v51, s31, v53
  v_readlane_b32 s30, v40, 38
  v_readlane_b32 s31, v41, 38
  v_lshlrev_b32 v52, 16, v14
  v_and_b32 v53, 0xffff0000, v14
  v_fmac_f32 v44, s30, v52
  v_fmac_f32 v45, s30, v53
  v_fmac_f32 v46, s31, v52
  v_fmac_f32 v47, s31, v53
  v_lshlrev_b32 v52, 16, v30
  v_and_b32 v53, 0xffff0000, v30
  v_fmac_f32 v48, s30, v52
  v_fmac_f32 v49, s30, v53
  v_fmac_f32 v50, s31, v52
  v_fmac_f32 v51, s31, v53
  v_readlane_b32 s30, v40, 39
  v_readlane_b32 s31, v41, 39
  v_lshlrev_b32 v52, 16, v15
  v_and_b32 v53, 0xffff0000, v15
  v_fmac_f32 v44, s30, v52
  v_fmac_f32 v45, s30, v53
  v_fmac_f32 v46, s31, v52
  v_fmac_f32 v47, s31, v53
  v_lshlrev_b32 v52, 16, v31
  v_and_b32 v53, 0xffff0000, v31
  v_fmac_f32 v48, s30, v52
  v_fmac_f32 v49, s30, v53
  v_fmac_f32 v50, s31, v52
  v_fmac_f32 v51, s31, v53
  v_readlane_b32 s30, v40, 40
  v_readlane_b32 s31, v41, 40
  v_lshlrev_b32 v52, 16, v16
  v_and_b32 v53, 0xffff0000, v16
  v_fmac_f32 v44, s30, v52
  v_fmac_f32 v45, s30, v53
  v_fmac_f32 v46, s31, v52
  v_fmac_f32 v47, s31, v53
  v_lshlrev_b32 v52, 16, v32
  v_and_b32 v53, 0xffff0000, v32
  v_fmac_f32 v48, s30, v52
  v_fmac_f32 v49, s30, v53
  v_fmac_f32 v50, s31, v52
  v_fmac_f32 v51, s31, v53
  v_readlane_b32 s30, v40, 41
  v_readlane_b32 s31, v41, 41
  v_lshlrev_b32 v52, 16, v17
  v_and_b32 v53, 0xffff0000, v17
  v_fmac_f32 v44, s30, v52
  v_fmac_f32 v45, s30, v53
  v_fmac_f32 v46, s31, v52
  v_fmac_f32 v47, s31, v53
  v_lshlrev_b32 v52, 16, v33
  v_and_b32 v53, 0xffff0000, v33
  v_fmac_f32 v48, s30, v52
  v_fmac_f32 v49, s30, v53
  v_fmac_f32 v50, s31, v52
  v_fmac_f32 v51, s31, v53
  v_readlane_b32 s30, v40, 42
  v_readlane_b32 s31, v41, 42
  v_lshlrev_b32 v52, 16, v18
  v_and_b32 v53, 0xffff0000, v18
  v_fmac_f32 v44, s30, v52
  v_fmac_f32 v45, s30, v53
  v_fmac_f32 v46, s31, v52
  v_fmac_f32 v47, s31, v53
  v_lshlrev_b32 v52, 16, v34
  v_and_b32 v53, 0xffff0000, v34
  v_fmac_f32 v48, s30, v52
  v_fmac_f32 v49, s30, v53
  v_fmac_f32 v50, s31, v52
  v_fmac_f32 v51, s31, v53
  v_readlane_b32 s30, v40, 43
  v_readlane_b32 s31, v41, 43
  v_lshlrev_b32 v52, 16, v19
  v_and_b32 v53, 0xffff0000, v19
  v_fmac_f32 v44, s30, v52
  v_fmac_f32 v45, s30, v53
  v_fmac_f32 v46, s31, v52
  v_fmac_f32 v47, s31, v53
  v_lshlrev_b32 v52, 16, v35
  v_and_b32 v53, 0xffff0000, v35
  v_fmac_f32 v48, s30, v52
  v_fmac_f32 v49, s30, v53
  v_fmac_f32 v50, s31, v52
  v_fmac_f32 v51, s31, v53
  v_readlane_b32 s30, v40, 44
  v_readlane_b32 s31, v41, 44
  v_lshlrev_b32 v52, 16, v20
  v_and_b32 v53, 0xffff0000, v20
  v_fmac_f32 v44, s30, v52
  v_fmac_f32 v45, s30, v53
  v_fmac_f32 v46, s31, v52
  v_fmac_f32 v47, s31, v53
  v_lshlrev_b32 v52, 16, v36
  v_and_b32 v53, 0xffff0000, v36
  v_fmac_f32 v48, s30, v52
  v_fmac_f32 v49, s30, v53
  v_fmac_f32 v50, s31, v52
  v_fmac_f32 v51, s31, v53
  v_readlane_b32 s30, v40, 45
  v_readlane_b32 s31, v41, 45
  v_lshlrev_b32 v52, 16, v21
  v_and_b32 v53, 0xffff0000, v21
  v_fmac_f32 v44, s30, v52
  v_fmac_f32 v45, s30, v53
  v_fmac_f32 v46, s31, v52
  v_fmac_f32 v47, s31, v53
  v_lshlrev_b32 v52, 16, v37
  v_and_b32 v53, 0xffff0000, v37
  v_fmac_f32 v48, s30, v52
  v_fmac_f32 v49, s30, v53
  v_fmac_f32 v50, s31, v52
  v_fmac_f32 v51, s31, v53
  v_readlane_b32 s30, v40, 46
  v_readlane_b32 s31, v41, 46
  v_lshlrev_b32 v52, 16, v22
  v_and_b32 v53, 0xffff0000, v22
  v_fmac_f32 v44, s30, v52
  v_fmac_f32 v45, s30, v53
  v_fmac_f32 v46, s31, v52
  v_fmac_f32 v47, s31, v53
  v_lshlrev_b32 v52, 16, v38
  v_and_b32 v53, 0xffff0000, v38
  v_fmac_f32 v48, s30, v52
  v_fmac_f32 v49, s30, v53
  v_fmac_f32 v50, s31, v52
  v_fmac_f32 v51, s31, v53
  v_readlane_b32 s30, v40, 47
  v_readlane_b32 s31, v41, 47
  v_lshlrev_b32 v52, 16, v23
  v_and_b32 v53, 0xffff0000, v23
  v_fmac_f32 v44, s30, v52
  v_fmac_f32 v45, s30, v53
  v_fmac_f32 v46, s31, v52
  v_fmac_f32 v47, s31, v53
  v_lshlrev_b32 v52, 16, v39
  v_and_b32 v53, 0xffff0000, v39
  v_fmac_f32 v48, s30, v52
  v_fmac_f32 v49, s30, v53
  v_fmac_f32 v50, s31, v52
  v_fmac_f32 v51, s31, v53
  global_load_dword v8, v4, s[4:5]
  global_load_dword v24, v4, s[6:7]
  v_add_u32 v4, 7168, v4
  global_load_dword v9, v4, s[4:5]
  global_load_dword v25, v4, s[6:7]
  v_add_u32 v4, 7168, v4
  global_load_dword v10, v4, s[4:5]
  global_load_dword v26, v4, s[6:7]
  v_add_u32 v4, 7168, v4
  global_load_dword v11, v4, s[4:5]
  global_load_dword v27, v4, s[6:7]
  v_add_u32 v4, 7168, v4
  global_load_dword v12, v4, s[4:5]
  global_load_dword v28, v4, s[6:7]
  v_add_u32 v4, 7168, v4
  global_load_dword v13, v4, s[4:5]
  global_load_dword v29, v4, s[6:7]
  v_add_u32 v4, 7168, v4
  global_load_dword v14, v4, s[4:5]
  global_load_dword v30, v4, s[6:7]
  v_add_u32 v4, 7168, v4
  global_load_dword v15, v4, s[4:5]
  global_load_dword v31, v4, s[6:7]
  v_add_u32 v4, 7168, v4
  global_load_dword v16, v4, s[4:5]
  global_load_dword v32, v4, s[6:7]
  v_add_u32 v4, 7168, v4
  global_load_dword v17, v4, s[4:5]
  global_load_dword v33, v4, s[6:7]
  v_add_u32 v4, 7168, v4
  global_load_dword v18, v4, s[4:5]
  global_load_dword v34, v4, s[6:7]
  v_add_u32 v4, 7168, v4
  global_load_dword v19, v4, s[4:5]
  global_load_dword v35, v4, s[6:7]
  v_add_u32 v4, 7168, v4
  global_load_dword v20, v4, s[4:5]
  global_load_dword v36, v4, s[6:7]
  v_add_u32 v4, 7168, v4
  global_load_dword v21, v4, s[4:5]
  global_load_dword v37, v4, s[6:7]
  v_add_u32 v4, 7168, v4
  global_load_dword v22, v4, s[4:5]
  global_load_dword v38, v4, s[6:7]
  v_add_u32 v4, 7168, v4
  global_load_dword v23, v4, s[4:5]
  global_load_dword v39, v4, s[6:7]
  v_add_u32 v4, 7168, v4
  s_waitcnt vmcnt(0)
  v_readlane_b32 s30, v40, 48
  v_readlane_b32 s31, v41, 48
  v_lshlrev_b32 v52, 16, v8
  v_and_b32 v53, 0xffff0000, v8
  v_fmac_f32 v44, s30, v52
  v_fmac_f32 v45, s30, v53
  v_fmac_f32 v46, s31, v52
  v_fmac_f32 v47, s31, v53
  v_lshlrev_b32 v52, 16, v24
  v_and_b32 v53, 0xffff0000, v24
  v_fmac_f32 v48, s30, v52
  v_fmac_f32 v49, s30, v53
  v_fmac_f32 v50, s31, v52
  v_fmac_f32 v51, s31, v53
  v_readlane_b32 s30, v40, 49
  v_readlane_b32 s31, v41, 49
  v_lshlrev_b32 v52, 16, v9
  v_and_b32 v53, 0xffff0000, v9
  v_fmac_f32 v44, s30, v52
  v_fmac_f32 v45, s30, v53
  v_fmac_f32 v46, s31, v52
  v_fmac_f32 v47, s31, v53
  v_lshlrev_b32 v52, 16, v25
  v_and_b32 v53, 0xffff0000, v25
  v_fmac_f32 v48, s30, v52
  v_fmac_f32 v49, s30, v53
  v_fmac_f32 v50, s31, v52
  v_fmac_f32 v51, s31, v53
  v_readlane_b32 s30, v40, 50
  v_readlane_b32 s31, v41, 50
  v_lshlrev_b32 v52, 16, v10
  v_and_b32 v53, 0xffff0000, v10
  v_fmac_f32 v44, s30, v52
  v_fmac_f32 v45, s30, v53
  v_fmac_f32 v46, s31, v52
  v_fmac_f32 v47, s31, v53
  v_lshlrev_b32 v52, 16, v26
  v_and_b32 v53, 0xffff0000, v26
  v_fmac_f32 v48, s30, v52
  v_fmac_f32 v49, s30, v53
  v_fmac_f32 v50, s31, v52
  v_fmac_f32 v51, s31, v53
  v_readlane_b32 s30, v40, 51
  v_readlane_b32 s31, v41, 51
  v_lshlrev_b32 v52, 16, v11
  v_and_b32 v53, 0xffff0000, v11
  v_fmac_f32 v44, s30, v52
  v_fmac_f32 v45, s30, v53
  v_fmac_f32 v46, s31, v52
  v_fmac_f32 v47, s31, v53
  v_lshlrev_b32 v52, 16, v27
  v_and_b32 v53, 0xffff0000, v27
  v_fmac_f32 v48, s30, v52
  v_fmac_f32 v49, s30, v53
  v_fmac_f32 v50, s31, v52
  v_fmac_f32 v51, s31, v53
  v_readlane_b32 s30, v40, 52
  v_readlane_b32 s31, v41, 52
  v_lshlrev_b32 v52, 16, v12
  v_and_b32 v53, 0xffff0000, v12
  v_fmac_f32 v44, s30, v52
  v_fmac_f32 v45, s30, v53
  v_fmac_f32 v46, s31, v52
  v_fmac_f32 v47, s31, v53
  v_lshlrev_b32 v52, 16, v28
  v_and_b32 v53, 0xffff0000, v28
  v_fmac_f32 v48, s30, v52
  v_fmac_f32 v49, s30, v53
  v_fmac_f32 v50, s31, v52
  v_fmac_f32 v51, s31, v53
  v_readlane_b32 s30, v40, 53
  v_readlane_b32 s31, v41, 53
  v_lshlrev_b32 v52, 16, v13
  v_and_b32 v53, 0xffff0000, v13
  v_fmac_f32 v44, s30, v52
  v_fmac_f32 v45, s30, v53
  v_fmac_f32 v46, s31, v52
  v_fmac_f32 v47, s31, v53
  v_lshlrev_b32 v52, 16, v29
  v_and_b32 v53, 0xffff0000, v29
  v_fmac_f32 v48, s30, v52
  v_fmac_f32 v49, s30, v53
  v_fmac_f32 v50, s31, v52
  v_fmac_f32 v51, s31, v53
  v_readlane_b32 s30, v40, 54
  v_readlane_b32 s31, v41, 54
  v_lshlrev_b32 v52, 16, v14
  v_and_b32 v53, 0xffff0000, v14
  v_fmac_f32 v44, s30, v52
  v_fmac_f32 v45, s30, v53
  v_fmac_f32 v46, s31, v52
  v_fmac_f32 v47, s31, v53
  v_lshlrev_b32 v52, 16, v30
  v_and_b32 v53, 0xffff0000, v30
  v_fmac_f32 v48, s30, v52
  v_fmac_f32 v49, s30, v53
  v_fmac_f32 v50, s31, v52
  v_fmac_f32 v51, s31, v53
  v_readlane_b32 s30, v40, 55
  v_readlane_b32 s31, v41, 55
  v_lshlrev_b32 v52, 16, v15
  v_and_b32 v53, 0xffff0000, v15
  v_fmac_f32 v44, s30, v52
  v_fmac_f32 v45, s30, v53
  v_fmac_f32 v46, s31, v52
  v_fmac_f32 v47, s31, v53
  v_lshlrev_b32 v52, 16, v31
  v_and_b32 v53, 0xffff0000, v31
  v_fmac_f32 v48, s30, v52
  v_fmac_f32 v49, s30, v53
  v_fmac_f32 v50, s31, v52
  v_fmac_f32 v51, s31, v53
  v_readlane_b32 s30, v40, 56
  v_readlane_b32 s31, v41, 56
  v_lshlrev_b32 v52, 16, v16
  v_and_b32 v53, 0xffff0000, v16
  v_fmac_f32 v44, s30, v52
  v_fmac_f32 v45, s30, v53
  v_fmac_f32 v46, s31, v52
  v_fmac_f32 v47, s31, v53
  v_lshlrev_b32 v52, 16, v32
  v_and_b32 v53, 0xffff0000, v32
  v_fmac_f32 v48, s30, v52
  v_fmac_f32 v49, s30, v53
  v_fmac_f32 v50, s31, v52
  v_fmac_f32 v51, s31, v53
  v_readlane_b32 s30, v40, 57
  v_readlane_b32 s31, v41, 57
  v_lshlrev_b32 v52, 16, v17
  v_and_b32 v53, 0xffff0000, v17
  v_fmac_f32 v44, s30, v52
  v_fmac_f32 v45, s30, v53
  v_fmac_f32 v46, s31, v52
  v_fmac_f32 v47, s31, v53
  v_lshlrev_b32 v52, 16, v33
  v_and_b32 v53, 0xffff0000, v33
  v_fmac_f32 v48, s30, v52
  v_fmac_f32 v49, s30, v53
  v_fmac_f32 v50, s31, v52
  v_fmac_f32 v51, s31, v53
  v_readlane_b32 s30, v40, 58
  v_readlane_b32 s31, v41, 58
  v_lshlrev_b32 v52, 16, v18
  v_and_b32 v53, 0xffff0000, v18
  v_fmac_f32 v44, s30, v52
  v_fmac_f32 v45, s30, v53
  v_fmac_f32 v46, s31, v52
  v_fmac_f32 v47, s31, v53
  v_lshlrev_b32 v52, 16, v34
  v_and_b32 v53, 0xffff0000, v34
  v_fmac_f32 v48, s30, v52
  v_fmac_f32 v49, s30, v53
  v_fmac_f32 v50, s31, v52
  v_fmac_f32 v51, s31, v53
  v_readlane_b32 s30, v40, 59
  v_readlane_b32 s31, v41, 59
  v_lshlrev_b32 v52, 16, v19
  v_and_b32 v53, 0xffff0000, v19
  v_fmac_f32 v44, s30, v52
  v_fmac_f32 v45, s30, v53
  v_fmac_f32 v46, s31, v52
  v_fmac_f32 v47, s31, v53
  v_lshlrev_b32 v52, 16, v35
  v_and_b32 v53, 0xffff0000, v35
  v_fmac_f32 v48, s30, v52
  v_fmac_f32 v49, s30, v53
  v_fmac_f32 v50, s31, v52
  v_fmac_f32 v51, s31, v53
  v_readlane_b32 s30, v40, 60
  v_readlane_b32 s31, v41, 60
  v_lshlrev_b32 v52, 16, v20
  v_and_b32 v53, 0xffff0000, v20
  v_fmac_f32 v44, s30, v52
  v_fmac_f32 v45, s30, v53
  v_fmac_f32 v46, s31, v52
  v_fmac_f32 v47, s31, v53
  v_lshlrev_b32 v52, 16, v36
  v_and_b32 v53, 0xffff0000, v36
  v_fmac_f32 v48, s30, v52
  v_fmac_f32 v49, s30, v53
  v_fmac_f32 v50, s31, v52
  v_fmac_f32 v51, s31, v53
  v_readlane_b32 s30, v40, 61
  v_readlane_b32 s31, v41, 61
  v_lshlrev_b32 v52, 16, v21
  v_and_b32 v53, 0xffff0000, v21
  v_fmac_f32 v44, s30, v52
  v_fmac_f32 v45, s30, v53
  v_fmac_f32 v46, s31, v52
  v_fmac_f32 v47, s31, v53
  v_lshlrev_b32 v52, 16, v37
  v_and_b32 v53, 0xffff0000, v37
  v_fmac_f32 v48, s30, v52
  v_fmac_f32 v49, s30, v53
  v_fmac_f32 v50, s31, v52
  v_fmac_f32 v51, s31, v53
  v_readlane_b32 s30, v40, 62
  v_readlane_b32 s31, v41, 62
  v_lshlrev_b32 v52, 16, v22
  v_and_b32 v53, 0xffff0000, v22
  v_fmac_f32 v44, s30, v52
  v_fmac_f32 v45, s30, v53
  v_fmac_f32 v46, s31, v52
  v_fmac_f32 v47, s31, v53
  v_lshlrev_b32 v52, 16, v38
  v_and_b32 v53, 0xffff0000, v38
  v_fmac_f32 v48, s30, v52
  v_fmac_f32 v49, s30, v53
  v_fmac_f32 v50, s31, v52
  v_fmac_f32 v51, s31, v53
  v_readlane_b32 s30, v40, 63
  v_readlane_b32 s31, v41, 63
  v_lshlrev_b32 v52, 16, v23
  v_and_b32 v53, 0xffff0000, v23
  v_fmac_f32 v44, s30, v52
  v_fmac_f32 v45, s30, v53
  v_fmac_f32 v46, s31, v52
  v_fmac_f32 v47, s31, v53
  v_lshlrev_b32 v52, 16, v39
  v_and_b32 v53, 0xffff0000, v39
  v_fmac_f32 v48, s30, v52
  v_fmac_f32 v49, s30, v53
  v_fmac_f32 v50, s31, v52
  v_fmac_f32 v51, s31, v53
  v_lshlrev_b32 v4, 5, v0
  ds_write_b128 v4, v[44:47]
  ds_write_b128 v4, v[48:51] offset:16
  s_waitcnt lgkmcnt(0)
  s_barrier
  s_cmp_lg_u32 s3, 0
  s_cbranch_scc1 L4_end
  ds_read_b128 v[8:11], v4 offset:2048
  ds_read_b128 v[12:15], v4 offset:2064
  s_waitcnt lgkmcnt(0)
  v_add_f32 v44, v44, v8
  v_add_f32 v45, v45, v9
  v_add_f32 v46, v46, v10
  v_add_f32 v47, v47, v11
  v_add_f32 v48, v48, v12
  v_add_f32 v49, v49, v13
  v_add_f32 v50, v50, v14
  v_add_f32 v51, v51, v15
  ds_read_b128 v[8:11], v4 offset:4096
  ds_read_b128 v[12:15], v4 offset:4112
  s_waitcnt lgkmcnt(0)
  v_add_f32 v44, v44, v8
  v_add_f32 v45, v45, v9
  v_add_f32 v46, v46, v10
  v_add_f32 v47, v47, v11
  v_add_f32 v48, v48, v12
  v_add_f32 v49, v49, v13
  v_add_f32 v50, v50, v14
  v_add_f32 v51, v51, v15
  ds_read_b128 v[8:11], v4 offset:6144
  ds_read_b128 v[12:15], v4 offset:6160
  s_waitcnt lgkmcnt(0)
  v_add_f32 v44, v44, v8
  v_add_f32 v45, v45, v9
  v_add_f32 v46, v46, v10
  v_add_f32 v47, v47, v11
  v_add_f32 v48, v48, v12
  v_add_f32 v49, v49, v13
  v_add_f32 v50, v50, v14
  v_add_f32 v51, v51, v15
  ds_read_b128 v[8:11], v4 offset:8192
  ds_read_b128 v[12:15], v4 offset:8208
  s_waitcnt lgkmcnt(0)
  v_add_f32 v44, v44, v8
  v_add_f32 v45, v45, v9
  v_add_f32 v46, v46, v10
  v_add_f32 v47, v47, v11
  v_add_f32 v48, v48, v12
  v_add_f32 v49, v49, v13
  v_add_f32 v50, v50, v14
  v_add_f32 v51, v51, v15
  ds_read_b128 v[8:11], v4 offset:10240
  ds_read_b128 v[12:15], v4 offset:10256
  s_waitcnt lgkmcnt(0)
  v_add_f32 v44, v44, v8
  v_add_f32 v45, v45, v9
  v_add_f32 v46, v46, v10
  v_add_f32 v47, v47, v11
  v_add_f32 v48, v48, v12
  v_add_f32 v49, v49, v13
  v_add_f32 v50, v50, v14
  v_add_f32 v51, v51, v15
  ds_read_b128 v[8:11], v4 offset:12288
  ds_read_b128 v[12:15], v4 offset:12304
  s_waitcnt lgkmcnt(0)
  v_add_f32 v44, v44, v8
  v_add_f32 v45, v45, v9
  v_add_f32 v46, v46, v10
  v_add_f32 v47, v47, v11
  v_add_f32 v48, v48, v12
  v_add_f32 v49, v49, v13
  v_add_f32 v50, v50, v14
  v_add_f32 v51, v51, v15
  ds_read_b128 v[8:11], v4 offset:14336
  ds_read_b128 v[12:15], v4 offset:14352
  s_waitcnt lgkmcnt(0)
  v_add_f32 v44, v44, v8
  v_add_f32 v45, v45, v9
  v_add_f32 v46, v46, v10
  v_add_f32 v47, v47, v11
  v_add_f32 v48, v48, v12
  v_add_f32 v49, v49, v13
  v_add_f32 v50, v50, v14
  v_add_f32 v51, v51, v15
  ds_read_b128 v[8:11], v4 offset:16384
  ds_read_b128 v[12:15], v4 offset:16400
  s_waitcnt lgkmcnt(0)
  v_add_f32 v44, v44, v8
  v_add_f32 v45, v45, v9
  v_add_f32 v46, v46, v10
  v_add_f32 v47, v47, v11
  v_add_f32 v48, v48, v12
  v_add_f32 v49, v49, v13
  v_add_f32 v50, v50, v14
  v_add_f32 v51, v51, v15
  ds_read_b128 v[8:11], v4 offset:18432
  ds_read_b128 v[12:15], v4 offset:18448
  s_waitcnt lgkmcnt(0)
  v_add_f32 v44, v44, v8
  v_add_f32 v45, v45, v9
  v_add_f32 v46, v46, v10
  v_add_f32 v47, v47, v11
  v_add_f32 v48, v48, v12
  v_add_f32 v49, v49, v13
  v_add_f32 v50, v50, v14
  v_add_f32 v51, v51, v15
  ds_read_b128 v[8:11], v4 offset:20480
  ds_read_b128 v[12:15], v4 offset:20496
  s_waitcnt lgkmcnt(0)
  v_add_f32 v44, v44, v8
  v_add_f32 v45, v45, v9
  v_add_f32 v46, v46, v10
  v_add_f32 v47, v47, v11
  v_add_f32 v48, v48, v12
  v_add_f32 v49, v49, v13
  v_add_f32 v50, v50, v14
  v_add_f32 v51, v51, v15
  ds_read_b128 v[8:11], v4 offset:22528
  ds_read_b128 v[12:15], v4 offset:22544
  s_waitcnt lgkmcnt(0)
  v_add_f32 v44, v44, v8
  v_add_f32 v45, v45, v9
  v_add_f32 v46, v46, v10
  v_add_f32 v47, v47, v11
  v_add_f32 v48, v48, v12
  v_add_f32 v49, v49, v13
  v_add_f32 v50, v50, v14
  v_add_f32 v51, v51, v15
  ds_read_b128 v[8:11], v4 offset:24576
  ds_read_b128 v[12:15], v4 offset:24592
  s_waitcnt lgkmcnt(0)
  v_add_f32 v44, v44, v8
  v_add_f32 v45, v45, v9
  v_add_f32 v46, v46, v10
  v_add_f32 v47, v47, v11
  v_add_f32 v48, v48, v12
  v_add_f32 v49, v49, v13
  v_add_f32 v50, v50, v14
  v_add_f32 v51, v51, v15
  ds_read_b128 v[8:11], v4 offset:26624
  ds_read_b128 v[12:15], v4 offset:26640
  s_waitcnt lgkmcnt(0)
  v_add_f32 v44, v44, v8
  v_add_f32 v45, v45, v9
  v_add_f32 v46, v46, v10
  v_add_f32 v47, v47, v11
  v_add_f32 v48, v48, v12
  v_add_f32 v49, v49, v13
  v_add_f32 v50, v50, v14
  v_add_f32 v51, v51, v15
  ds_read_b128 v[8:11], v4 offset:28672
  ds_read_b128 v[12:15], v4 offset:28688
  s_waitcnt lgkmcnt(0)
  v_add_f32 v44, v44, v8
  v_add_f32 v45, v45, v9
  v_add_f32 v46, v46, v10
  v_add_f32 v47, v47, v11
  v_add_f32 v48, v48, v12
  v_add_f32 v49, v49, v13
  v_add_f32 v50, v50, v14
  v_add_f32 v51, v51, v15
  ds_read_b128 v[8:11], v4 offset:30720
  ds_read_b128 v[12:15], v4 offset:30736
  s_waitcnt lgkmcnt(0)
  v_add_f32 v44, v44, v8
  v_add_f32 v45, v45, v9
  v_add_f32 v46, v46, v10
  v_add_f32 v47, v47, v11
  v_add_f32 v48, v48, v12
  v_add_f32 v49, v49, v13
  v_add_f32 v50, v50, v14
  v_add_f32 v51, v51, v15
  v_cvt_pk_bf16_f32 v44, v44, v44
  v_and_b32 v44, 0xffff0000, v44
  v_cvt_pk_bf16_f32 v48, v48, v48
  v_and_b32 v48, 0xffff0000, v48
  v_mul_f32 v8, 0xbfb8aa3b, v44
  v_exp_f32 v8, v8
  s_nop 0
  v_add_f32 v8, 1.0, v8
  v_rcp_f32 v8, v8
  s_nop 0
  v_mul_f32 v44, v44, v8
  v_cvt_pk_bf16_f32 v44, v44, v44
  v_and_b32 v44, 0xffff0000, v44
  v_mul_f32 v44, v44, v48
  v_cvt_pk_bf16_f32 v44, v44, v44
  v_and_b32 v44, 0xffff0000, v44
  v_cvt_pk_bf16_f32 v45, v45, v45
  v_and_b32 v45, 0xffff0000, v45
  v_cvt_pk_bf16_f32 v49, v49, v49
  v_and_b32 v49, 0xffff0000, v49
  v_mul_f32 v8, 0xbfb8aa3b, v45
  v_exp_f32 v8, v8
  s_nop 0
  v_add_f32 v8, 1.0, v8
  v_rcp_f32 v8, v8
  s_nop 0
  v_mul_f32 v45, v45, v8
  v_cvt_pk_bf16_f32 v45, v45, v45
  v_and_b32 v45, 0xffff0000, v45
  v_mul_f32 v45, v45, v49
  v_cvt_pk_bf16_f32 v45, v45, v45
  v_and_b32 v45, 0xffff0000, v45
  v_cvt_pk_bf16_f32 v46, v46, v46
  v_and_b32 v46, 0xffff0000, v46
  v_cvt_pk_bf16_f32 v50, v50, v50
  v_and_b32 v50, 0xffff0000, v50
  v_mul_f32 v8, 0xbfb8aa3b, v46
  v_exp_f32 v8, v8
  s_nop 0
  v_add_f32 v8, 1.0, v8
  v_rcp_f32 v8, v8
  s_nop 0
  v_mul_f32 v46, v46, v8
  v_cvt_pk_bf16_f32 v46, v46, v46
  v_and_b32 v46, 0xffff0000, v46
  v_mul_f32 v46, v46, v50
  v_cvt_pk_bf16_f32 v46, v46, v46
  v_and_b32 v46, 0xffff0000, v46
  v_cvt_pk_bf16_f32 v47, v47, v47
  v_and_b32 v47, 0xffff0000, v47
  v_cvt_pk_bf16_f32 v51, v51, v51
  v_and_b32 v51, 0xffff0000, v51
  v_mul_f32 v8, 0xbfb8aa3b, v47
  v_exp_f32 v8, v8
  s_nop 0
  v_add_f32 v8, 1.0, v8
  v_rcp_f32 v8, v8
  s_nop 0
  v_mul_f32 v47, v47, v8
  v_cvt_pk_bf16_f32 v47, v47, v47
  v_and_b32 v47, 0xffff0000, v47
  v_mul_f32 v47, v47, v51
  v_cvt_pk_bf16_f32 v47, v47, v47
  v_and_b32 v47, 0xffff0000, v47
  s_lshl_b32 s28, s2, 9
  s_add_u32 s28, s28, 16777216
  v_lshl_add_u32 v4, v62, 3, s28
  global_store_dwordx2 v4, v[44:45], s[8:9]
  v_add_u32 v4, 14336, v4
  global_store_dwordx2 v4, v[46:47], s[8:9]
L4_end:
  s_endpgm
.section .rodata,"a"
.p2align 6
.amdhsa_kernel k4_kernel
  .amdhsa_next_free_vgpr 64
  .amdhsa_next_free_sgpr 102
  .amdhsa_accum_offset 64
  .amdhsa_group_segment_fixed_size 0
  .amdhsa_kernarg_size 104
  .amdhsa_user_sgpr_count 2
  .amdhsa_user_sgpr_kernarg_segment_ptr 1
  .amdhsa_system_sgpr_workgroup_id_x 1
.end_amdhsa_kernel
.text
.globl k5_kernel
.p2align 8
.type k5_kernel,@function
k5_kernel:
  s_cmp_ge_u32 s2, 8
  s_cbranch_scc1 L5_end
  s_load_dwordx4 s[4:7], s[0:1], 72
  s_load_dwordx2 s[8:9], s[0:1], 96
  v_and_b32 v62, 63, v0
  v_lshlrev_b32 v63, 2, v62
  v_lshrrev_b32 v61, 6, v0
  s_nop 0
  v_readfirstlane_b32 s3, v61
  s_waitcnt lgkmcnt(0)
  v_lshlrev_b32 v4, 7, v62
  v_add_u32 v4, 4194304, v4
  global_load_dwordx4 v[8:11], v4, s[8:9] offset:0
  global_load_dwordx4 v[12:15], v4, s[8:9] offset:16
  global_load_dwordx4 v[16:19], v4, s[8:9] offset:32
  global_load_dwordx4 v[20:23], v4, s[8:9] offset:48
  global_load_dwordx4 v[24:27], v4, s[8:9] offset:64
  global_load_dwordx4 v[28:31], v4, s[8:9] offset:80
  global_load_dwordx4 v[32:35], v4, s[8:9] offset:96
  global_load_dwordx4 v[36:39], v4, s[8:9] offset:112
  s_waitcnt vmcnt(0)
  v_mov_b32 v5, 0
  v_mov_b32 v6, 0
  v_med3_u32 v6, v5, v6, v8
  v_max_u32 v5, v5, v8
  v_med3_u32 v6, v5, v6, v9
  v_max_u32 v5, v5, v9
  v_med3_u32 v6, v5, v6, v10
  v_max_u32 v5, v5, v10
  v_med3_u32 v6, v5, v6, v11
  v_max_u32 v5, v5, v11
  v_med3_u32 v6, v5, v6, v12
  v_max_u32 v5, v5, v12
  v_med3_u32 v6, v5, v6, v13
  v_max_u32 v5, v5, v13
  v_med3_u32 v6, v5, v6, v14
  v_max_u32 v5, v5, v14
  v_med3_u32 v6, v5, v6, v15
  v_max_u32 v5, v5, v15
  v_med3_u32 v6, v5, v6, v16
  v_max_u32 v5, v5, v16
  v_med3_u32 v6, v5, v6, v17
  v_max_u32 v5, v5, v17
  v_med3_u32 v6, v5, v6, v18
  v_max_u32 v5, v5, v18
  v_med3_u32 v6, v5, v6, v19
  v_max_u32 v5, v5, v19
  v_med3_u32 v6, v5, v6, v20
  v_max_u32 v5, v5, v20
  v_med3_u32 v6, v5, v6, v21
  v_max_u32 v5, v5, v21
  v_med3_u32 v6, v5, v6, v22
  v_max_u32 v5, v5, v22
  v_med3_u32 v6, v5, v6, v23
  v_max_u32 v5, v5, v23
  v_med3_u32 v6, v5, v6, v24
  v_max_u32 v5, v5, v24
  v_med3_u32 v6, v5, v6, v25
  v_max_u32 v5, v5, v25
  v_med3_u32 v6, v5, v6, v26
  v_max_u32 v5, v5, v26
  v_med3_u32 v6, v5, v6, v27
  v_max_u32 v5, v5, v27
  v_med3_u32 v6, v5, v6, v28
  v_max_u32 v5, v5, v28
  v_med3_u32 v6, v5, v6, v29
  v_max_u32 v5, v5, v29
  v_med3_u32 v6, v5, v6, v30
  v_max_u32 v5, v5, v30
  v_med3_u32 v6, v5, v6, v31
  v_max_u32 v5, v5, v31
  v_med3_u32 v6, v5, v6, v32
  v_max_u32 v5, v5, v32
  v_med3_u32 v6, v5, v6, v33
  v_max_u32 v5, v5, v33
  v_med3_u32 v6, v5, v6, v34
  v_max_u32 v5, v5, v34
  v_med3_u32 v6, v5, v6, v35
  v_max_u32 v5, v5, v35
  v_med3_u32 v6, v5, v6, v36
  v_max_u32 v5, v5, v36
  v_med3_u32 v6, v5, v6, v37
  v_max_u32 v5, v5, v37
  v_med3_u32 v6, v5, v6, v38
  v_max_u32 v5, v5, v38
  v_med3_u32 v6, v5, v6, v39
  v_max_u32 v5, v5, v39
  v_xor_b32 v7, 4, v63
  ds_bpermute_b32 v8, v7, v5
  ds_bpermute_b32 v9, v7, v6
  s_waitcnt lgkmcnt(0)
  v_max_u32 v6, v6, v9
  v_min_u32 v9, v5, v8
  v_max_u32 v6, v6, v9
  v_max_u32 v5, v5, v8
  v_xor_b32 v7, 8, v63
  ds_bpermute_b32 v8, v7, v5
  ds_bpermute_b32 v9, v7, v6
  s_waitcnt lgkmcnt(0)
  v_max_u32 v6, v6, v9
  v_min_u32 v9, v5, v8
  v_max_u32 v6, v6, v9
  v_max_u32 v5, v5, v8
  v_xor_b32 v7, 16, v63
  ds_bpermute_b32 v8, v7, v5
  ds_bpermute_b32 v9, v7, v6
  s_waitcnt lgkmcnt(0)
  v_max_u32 v6, v6, v9
  v_min_u32 v9, v5, v8
  v_max_u32 v6, v6, v9
  v_max_u32 v5, v5, v8
  v_xor_b32 v7, 32, v63
  ds_bpermute_b32 v8, v7, v5
  ds_bpermute_b32 v9, v7, v6
  s_waitcnt lgkmcnt(0)
  v_max_u32 v6, v6, v9
  v_min_u32 v9, v5, v8
  v_max_u32 v6, v6, v9
  v_max_u32 v5, v5, v8
  v_xor_b32 v7, 64, v63
  ds_bpermute_b32 v8, v7, v5
  ds_bpermute_b32 v9, v7, v6
  s_waitcnt lgkmcnt(0)
  v_max_u32 v6, v6, v9
  v_min_u32 v9, v5, v8
  v_max_u32 v6, v6, v9
  v_max_u32 v5, v5, v8
  v_xor_b32 v7, 128, v63
  ds_bpermute_b32 v8, v7, v5
  ds_bpermute_b32 v9, v7, v6
  s_waitcnt lgkmcnt(0)
  v_max_u32 v6, v6, v9
  v_min_u32 v9, v5, v8
  v_max_u32 v6, v6, v9
  v_max_u32 v5, v5, v8
  s_nop 1
  v_readfirstlane_b32 s20, v5
  v_readfirstlane_b32 s21, v6
  s_nop 3
  s_and_b32 s22, s20, 0xffff
  s_sub_u32 s22, 0xffff, s22
  s_and_b32 s23, s21, 0xffff
  s_sub_u32 s23, 0xffff, s23
  s_mul_i32 s27, s3, 524288
  s_lshl_b32 s28, s2, 8
  s_add_u32 s27, s27, s28
  v_add_u32 v4, s27, v63
  s_lshl_b32 s24, s3, 10
  s_add_u32 s24, s24, 16777216
  v_add_u32 v5, s24, v63
  v_add_u32 v6, 14336, v5
  v_mov_b32 v44, 0
  v_mov_b32 v45, 0
  v_mov_b32 v46, 0
  v_mov_b32 v47, 0
  s_mov_b32 s29, 0
L5_loop:
  global_load_dword v40, v5, s[8:9]
  global_load_dword v41, v6, s[8:9]
  v_add_u32 v5, 256, v5
  v_add_u32 v6, 256, v6
  global_load_dword v8, v4, s[4:5]
  v_add_u32 v4, 2048, v4
  global_load_dword v9, v4, s[4:5]
  v_add_u32 v4, 2048, v4
  global_load_dword v10, v4, s[4:5]
  v_add_u32 v4, 2048, v4
  global_load_dword v11, v4, s[4:5]
  v_add_u32 v4, 2048, v4
  global_load_dword v12, v4, s[4:5]
  v_add_u32 v4, 2048, v4
  global_load_dword v13, v4, s[4:5]
  v_add_u32 v4, 2048, v4
  global_load_dword v14, v4, s[4:5]
  v_add_u32 v4, 2048, v4
  global_load_dword v15, v4, s[4:5]
  v_add_u32 v4, 2048, v4
  global_load_dword v16, v4, s[4:5]
  v_add_u32 v4, 2048, v4
  global_load_dword v17, v4, s[4:5]
  v_add_u32 v4, 2048, v4
  global_load_dword v18, v4, s[4:5]
  v_add_u32 v4, 2048, v4
  global_load_dword v19, v4, s[4:5]
  v_add_u32 v4, 2048, v4
  global_load_dword v20, v4, s[4:5]
  v_add_u32 v4, 2048, v4
  global_load_dword v21, v4, s[4:5]
  v_add_u32 v4, 2048, v4
  global_load_dword v22, v4, s[4:5]
  v_add_u32 v4, 2048, v4
  global_load_dword v23, v4, s[4:5]
  v_add_u32 v4, 2048, v4
  global_load_dword v24, v4, s[4:5]
  v_add_u32 v4, 2048, v4
  global_load_dword v25, v4, s[4:5]
  v_add_u32 v4, 2048, v4
  global_load_dword v26, v4, s[4:5]
  v_add_u32 v4, 2048, v4
  global_load_dword v27, v4, s[4:5]
  v_add_u32 v4, 2048, v4
  global_load_dword v28, v4, s[4:5]
  v_add_u32 v4, 2048, v4
  global_load_dword v29, v4, s[4:5]
  v_add_u32 v4, 2048, v4
  global_load_dword v30, v4, s[4:5]
  v_add_u32 v4, 2048, v4
  global_load_dword v31, v4, s[4:5]
  v_add_u32 v4, 2048, v4
  global_load_dword v32, v4, s[4:5]
  v_add_u32 v4, 2048, v4
  global_load_dword v33, v4, s[4:5]
  v_add_u32 v4, 2048, v4
  global_load_dword v34, v4, s[4:5]
  v_add_u32 v4, 2048, v4
  global_load_dword v35, v4, s[4:5]
  v_add_u32 v4, 2048, v4
  global_load_dword v36, v4, s[4:5]
  v_add_u32 v4, 2048, v4
  global_load_dword v37, v4, s[4:5]
  v_add_u32 v4, 2048, v4
  global_load_dword v38, v4, s[4:5]
  v_add_u32 v4, 2048, v4
  global_load_dword v39, v4, s[4:5]
  v_add_u32 v4, 2048, v4
  s_waitcnt vmcnt(0)
  v_readlane_b32 s30, v40, 0
  v_readlane_b32 s31, v41, 0
  v_lshlrev_b32 v52, 16, v8
  v_and_b32 v53, 0xffff0000, v8
  v_fmac_f32 v44, s30, v52
  v_fmac_f32 v45, s30, v53
  v_fmac_f32 v46, s31, v52
  v_fmac_f32 v47, s31, v53
  v_readlane_b32 s30, v40, 1
  v_readlane_b32 s31, v41, 1
  v_lshlrev_b32 v52, 16, v9
  v_and_b32 v53, 0xffff0000, v9
  v_fmac_f32 v44, s30, v52
  v_fmac_f32 v45, s30, v53
  v_fmac_f32 v46, s31, v52
  v_fmac_f32 v47, s31, v53
  v_readlane_b32 s30, v40, 2
  v_readlane_b32 s31, v41, 2
  v_lshlrev_b32 v52, 16, v10
  v_and_b32 v53, 0xffff0000, v10
  v_fmac_f32 v44, s30, v52
  v_fmac_f32 v45, s30, v53
  v_fmac_f32 v46, s31, v52
  v_fmac_f32 v47, s31, v53
  v_readlane_b32 s30, v40, 3
  v_readlane_b32 s31, v41, 3
  v_lshlrev_b32 v52, 16, v11
  v_and_b32 v53, 0xffff0000, v11
  v_fmac_f32 v44, s30, v52
  v_fmac_f32 v45, s30, v53
  v_fmac_f32 v46, s31, v52
  v_fmac_f32 v47, s31, v53
  v_readlane_b32 s30, v40, 4
  v_readlane_b32 s31, v41, 4
  v_lshlrev_b32 v52, 16, v12
  v_and_b32 v53, 0xffff0000, v12
  v_fmac_f32 v44, s30, v52
  v_fmac_f32 v45, s30, v53
  v_fmac_f32 v46, s31, v52
  v_fmac_f32 v47, s31, v53
  v_readlane_b32 s30, v40, 5
  v_readlane_b32 s31, v41, 5
  v_lshlrev_b32 v52, 16, v13
  v_and_b32 v53, 0xffff0000, v13
  v_fmac_f32 v44, s30, v52
  v_fmac_f32 v45, s30, v53
  v_fmac_f32 v46, s31, v52
  v_fmac_f32 v47, s31, v53
  v_readlane_b32 s30, v40, 6
  v_readlane_b32 s31, v41, 6
  v_lshlrev_b32 v52, 16, v14
  v_and_b32 v53, 0xffff0000, v14
  v_fmac_f32 v44, s30, v52
  v_fmac_f32 v45, s30, v53
  v_fmac_f32 v46, s31, v52
  v_fmac_f32 v47, s31, v53
  v_readlane_b32 s30, v40, 7
  v_readlane_b32 s31, v41, 7
  v_lshlrev_b32 v52, 16, v15
  v_and_b32 v53, 0xffff0000, v15
  v_fmac_f32 v44, s30, v52
  v_fmac_f32 v45, s30, v53
  v_fmac_f32 v46, s31, v52
  v_fmac_f32 v47, s31, v53
  v_readlane_b32 s30, v40, 8
  v_readlane_b32 s31, v41, 8
  v_lshlrev_b32 v52, 16, v16
  v_and_b32 v53, 0xffff0000, v16
  v_fmac_f32 v44, s30, v52
  v_fmac_f32 v45, s30, v53
  v_fmac_f32 v46, s31, v52
  v_fmac_f32 v47, s31, v53
  v_readlane_b32 s30, v40, 9
  v_readlane_b32 s31, v41, 9
  v_lshlrev_b32 v52, 16, v17
  v_and_b32 v53, 0xffff0000, v17
  v_fmac_f32 v44, s30, v52
  v_fmac_f32 v45, s30, v53
  v_fmac_f32 v46, s31, v52
  v_fmac_f32 v47, s31, v53
  v_readlane_b32 s30, v40, 10
  v_readlane_b32 s31, v41, 10
  v_lshlrev_b32 v52, 16, v18
  v_and_b32 v53, 0xffff0000, v18
  v_fmac_f32 v44, s30, v52
  v_fmac_f32 v45, s30, v53
  v_fmac_f32 v46, s31, v52
  v_fmac_f32 v47, s31, v53
  v_readlane_b32 s30, v40, 11
  v_readlane_b32 s31, v41, 11
  v_lshlrev_b32 v52, 16, v19
  v_and_b32 v53, 0xffff0000, v19
  v_fmac_f32 v44, s30, v52
  v_fmac_f32 v45, s30, v53
  v_fmac_f32 v46, s31, v52
  v_fmac_f32 v47, s31, v53
  v_readlane_b32 s30, v40, 12
  v_readlane_b32 s31, v41, 12
  v_lshlrev_b32 v52, 16, v20
  v_and_b32 v53, 0xffff0000, v20
  v_fmac_f32 v44, s30, v52
  v_fmac_f32 v45, s30, v53
  v_fmac_f32 v46, s31, v52
  v_fmac_f32 v47, s31, v53
  v_readlane_b32 s30, v40, 13
  v_readlane_b32 s31, v41, 13
  v_lshlrev_b32 v52, 16, v21
  v_and_b32 v53, 0xffff0000, v21
  v_fmac_f32 v44, s30, v52
  v_fmac_f32 v45, s30, v53
  v_fmac_f32 v46, s31, v52
  v_fmac_f32 v47, s31, v53
  v_readlane_b32 s30, v40, 14
  v_readlane_b32 s31, v41, 14
  v_lshlrev_b32 v52, 16, v22
  v_and_b32 v53, 0xffff0000, v22
  v_fmac_f32 v44, s30, v52
  v_fmac_f32 v45, s30, v53
  v_fmac_f32 v46, s31, v52
  v_fmac_f32 v47, s31, v53
  v_readlane_b32 s30, v40, 15
  v_readlane_b32 s31, v41, 15
  v_lshlrev_b32 v52, 16, v23
  v_and_b32 v53, 0xffff0000, v23
  v_fmac_f32 v44, s30, v52
  v_fmac_f32 v45, s30, v53
  v_fmac_f32 v46, s31, v52
  v_fmac_f32 v47, s31, v53
  v_readlane_b32 s30, v40, 16
  v_readlane_b32 s31, v41, 16
  v_lshlrev_b32 v52, 16, v24
  v_and_b32 v53, 0xffff0000, v24
  v_fmac_f32 v44, s30, v52
  v_fmac_f32 v45, s30, v53
  v_fmac_f32 v46, s31, v52
  v_fmac_f32 v47, s31, v53
  v_readlane_b32 s30, v40, 17
  v_readlane_b32 s31, v41, 17
  v_lshlrev_b32 v52, 16, v25
  v_and_b32 v53, 0xffff0000, v25
  v_fmac_f32 v44, s30, v52
  v_fmac_f32 v45, s30, v53
  v_fmac_f32 v46, s31, v52
  v_fmac_f32 v47, s31, v53
  v_readlane_b32 s30, v40, 18
  v_readlane_b32 s31, v41, 18
  v_lshlrev_b32 v52, 16, v26
  v_and_b32 v53, 0xffff0000, v26
  v_fmac_f32 v44, s30, v52
  v_fmac_f32 v45, s30, v53
  v_fmac_f32 v46, s31, v52
  v_fmac_f32 v47, s31, v53
  v_readlane_b32 s30, v40, 19
  v_readlane_b32 s31, v41, 19
  v_lshlrev_b32 v52, 16, v27
  v_and_b32 v53, 0xffff0000, v27
  v_fmac_f32 v44, s30, v52
  v_fmac_f32 v45, s30, v53
  v_fmac_f32 v46, s31, v52
  v_fmac_f32 v47, s31, v53
  v_readlane_b32 s30, v40, 20
  v_readlane_b32 s31, v41, 20
  v_lshlrev_b32 v52, 16, v28
  v_and_b32 v53, 0xffff0000, v28
  v_fmac_f32 v44, s30, v52
  v_fmac_f32 v45, s30, v53
  v_fmac_f32 v46, s31, v52
  v_fmac_f32 v47, s31, v53
  v_readlane_b32 s30, v40, 21
  v_readlane_b32 s31, v41, 21
  v_lshlrev_b32 v52, 16, v29
  v_and_b32 v53, 0xffff0000, v29
  v_fmac_f32 v44, s30, v52
  v_fmac_f32 v45, s30, v53
  v_fmac_f32 v46, s31, v52
  v_fmac_f32 v47, s31, v53
  v_readlane_b32 s30, v40, 22
  v_readlane_b32 s31, v41, 22
  v_lshlrev_b32 v52, 16, v30
  v_and_b32 v53, 0xffff0000, v30
  v_fmac_f32 v44, s30, v52
  v_fmac_f32 v45, s30, v53
  v_fmac_f32 v46, s31, v52
  v_fmac_f32 v47, s31, v53
  v_readlane_b32 s30, v40, 23
  v_readlane_b32 s31, v41, 23
  v_lshlrev_b32 v52, 16, v31
  v_and_b32 v53, 0xffff0000, v31
  v_fmac_f32 v44, s30, v52
  v_fmac_f32 v45, s30, v53
  v_fmac_f32 v46, s31, v52
  v_fmac_f32 v47, s31, v53
  v_readlane_b32 s30, v40, 24
  v_readlane_b32 s31, v41, 24
  v_lshlrev_b32 v52, 16, v32
  v_and_b32 v53, 0xffff0000, v32
  v_fmac_f32 v44, s30, v52
  v_fmac_f32 v45, s30, v53
  v_fmac_f32 v46, s31, v52
  v_fmac_f32 v47, s31, v53
  v_readlane_b32 s30, v40, 25
  v_readlane_b32 s31, v41, 25
  v_lshlrev_b32 v52, 16, v33
  v_and_b32 v53, 0xffff0000, v33
  v_fmac_f32 v44, s30, v52
  v_fmac_f32 v45, s30, v53
  v_fmac_f32 v46, s31, v52
  v_fmac_f32 v47, s31, v53
  v_readlane_b32 s30, v40, 26
  v_readlane_b32 s31, v41, 26
  v_lshlrev_b32 v52, 16, v34
  v_and_b32 v53, 0xffff0000, v34
  v_fmac_f32 v44, s30, v52
  v_fmac_f32 v45, s30, v53
  v_fmac_f32 v46, s31, v52
  v_fmac_f32 v47, s31, v53
  v_readlane_b32 s30, v40, 27
  v_readlane_b32 s31, v41, 27
  v_lshlrev_b32 v52, 16, v35
  v_and_b32 v53, 0xffff0000, v35
  v_fmac_f32 v44, s30, v52
  v_fmac_f32 v45, s30, v53
  v_fmac_f32 v46, s31, v52
  v_fmac_f32 v47, s31, v53
  v_readlane_b32 s30, v40, 28
  v_readlane_b32 s31, v41, 28
  v_lshlrev_b32 v52, 16, v36
  v_and_b32 v53, 0xffff0000, v36
  v_fmac_f32 v44, s30, v52
  v_fmac_f32 v45, s30, v53
  v_fmac_f32 v46, s31, v52
  v_fmac_f32 v47, s31, v53
  v_readlane_b32 s30, v40, 29
  v_readlane_b32 s31, v41, 29
  v_lshlrev_b32 v52, 16, v37
  v_and_b32 v53, 0xffff0000, v37
  v_fmac_f32 v44, s30, v52
  v_fmac_f32 v45, s30, v53
  v_fmac_f32 v46, s31, v52
  v_fmac_f32 v47, s31, v53
  v_readlane_b32 s30, v40, 30
  v_readlane_b32 s31, v41, 30
  v_lshlrev_b32 v52, 16, v38
  v_and_b32 v53, 0xffff0000, v38
  v_fmac_f32 v44, s30, v52
  v_fmac_f32 v45, s30, v53
  v_fmac_f32 v46, s31, v52
  v_fmac_f32 v47, s31, v53
  v_readlane_b32 s30, v40, 31
  v_readlane_b32 s31, v41, 31
  v_lshlrev_b32 v52, 16, v39
  v_and_b32 v53, 0xffff0000, v39
  v_fmac_f32 v44, s30, v52
  v_fmac_f32 v45, s30, v53
  v_fmac_f32 v46, s31, v52
  v_fmac_f32 v47, s31, v53
  global_load_dword v8, v4, s[4:5]
  v_add_u32 v4, 2048, v4
  global_load_dword v9, v4, s[4:5]
  v_add_u32 v4, 2048, v4
  global_load_dword v10, v4, s[4:5]
  v_add_u32 v4, 2048, v4
  global_load_dword v11, v4, s[4:5]
  v_add_u32 v4, 2048, v4
  global_load_dword v12, v4, s[4:5]
  v_add_u32 v4, 2048, v4
  global_load_dword v13, v4, s[4:5]
  v_add_u32 v4, 2048, v4
  global_load_dword v14, v4, s[4:5]
  v_add_u32 v4, 2048, v4
  global_load_dword v15, v4, s[4:5]
  v_add_u32 v4, 2048, v4
  global_load_dword v16, v4, s[4:5]
  v_add_u32 v4, 2048, v4
  global_load_dword v17, v4, s[4:5]
  v_add_u32 v4, 2048, v4
  global_load_dword v18, v4, s[4:5]
  v_add_u32 v4, 2048, v4
  global_load_dword v19, v4, s[4:5]
  v_add_u32 v4, 2048, v4
  global_load_dword v20, v4, s[4:5]
  v_add_u32 v4, 2048, v4
  global_load_dword v21, v4, s[4:5]
  v_add_u32 v4, 2048, v4
  global_load_dword v22, v4, s[4:5]
  v_add_u32 v4, 2048, v4
  global_load_dword v23, v4, s[4:5]
  v_add_u32 v4, 2048, v4
  global_load_dword v24, v4, s[4:5]
  v_add_u32 v4, 2048, v4
  global_load_dword v25, v4, s[4:5]
  v_add_u32 v4, 2048, v4
  global_load_dword v26, v4, s[4:5]
  v_add_u32 v4, 2048, v4
  global_load_dword v27, v4, s[4:5]
  v_add_u32 v4, 2048, v4
  global_load_dword v28, v4, s[4:5]
  v_add_u32 v4, 2048, v4
  global_load_dword v29, v4, s[4:5]
  v_add_u32 v4, 2048, v4
  global_load_dword v30, v4, s[4:5]
  v_add_u32 v4, 2048, v4
  global_load_dword v31, v4, s[4:5]
  v_add_u32 v4, 2048, v4
  global_load_dword v32, v4, s[4:5]
  v_add_u32 v4, 2048, v4
  global_load_dword v33, v4, s[4:5]
  v_add_u32 v4, 2048, v4
  global_load_dword v34, v4, s[4:5]
  v_add_u32 v4, 2048, v4
  global_load_dword v35, v4, s[4:5]
  v_add_u32 v4, 2048, v4
  global_load_dword v36, v4, s[4:5]
  v_add_u32 v4, 2048, v4
  global_load_dword v37, v4, s[4:5]
  v_add_u32 v4, 2048, v4
  global_load_dword v38, v4, s[4:5]
  v_add_u32 v4, 2048, v4
  global_load_dword v39, v4, s[4:5]
  v_add_u32 v4, 2048, v4
  s_waitcnt vmcnt(0)
  v_readlane_b32 s30, v40, 32
  v_readlane_b32 s31, v41, 32
  v_lshlrev_b32 v52, 16, v8
  v_and_b32 v53, 0xffff0000, v8
  v_fmac_f32 v44, s30, v52
  v_fmac_f32 v45, s30, v53
  v_fmac_f32 v46, s31, v52
  v_fmac_f32 v47, s31, v53
  v_readlane_b32 s30, v40, 33
  v_readlane_b32 s31, v41, 33
  v_lshlrev_b32 v52, 16, v9
  v_and_b32 v53, 0xffff0000, v9
  v_fmac_f32 v44, s30, v52
  v_fmac_f32 v45, s30, v53
  v_fmac_f32 v46, s31, v52
  v_fmac_f32 v47, s31, v53
  v_readlane_b32 s30, v40, 34
  v_readlane_b32 s31, v41, 34
  v_lshlrev_b32 v52, 16, v10
  v_and_b32 v53, 0xffff0000, v10
  v_fmac_f32 v44, s30, v52
  v_fmac_f32 v45, s30, v53
  v_fmac_f32 v46, s31, v52
  v_fmac_f32 v47, s31, v53
  v_readlane_b32 s30, v40, 35
  v_readlane_b32 s31, v41, 35
  v_lshlrev_b32 v52, 16, v11
  v_and_b32 v53, 0xffff0000, v11
  v_fmac_f32 v44, s30, v52
  v_fmac_f32 v45, s30, v53
  v_fmac_f32 v46, s31, v52
  v_fmac_f32 v47, s31, v53
  v_readlane_b32 s30, v40, 36
  v_readlane_b32 s31, v41, 36
  v_lshlrev_b32 v52, 16, v12
  v_and_b32 v53, 0xffff0000, v12
  v_fmac_f32 v44, s30, v52
  v_fmac_f32 v45, s30, v53
  v_fmac_f32 v46, s31, v52
  v_fmac_f32 v47, s31, v53
  v_readlane_b32 s30, v40, 37
  v_readlane_b32 s31, v41, 37
  v_lshlrev_b32 v52, 16, v13
  v_and_b32 v53, 0xffff0000, v13
  v_fmac_f32 v44, s30, v52
  v_fmac_f32 v45, s30, v53
  v_fmac_f32 v46, s31, v52
  v_fmac_f32 v47, s31, v53
  v_readlane_b32 s30, v40, 38
  v_readlane_b32 s31, v41, 38
  v_lshlrev_b32 v52, 16, v14
  v_and_b32 v53, 0xffff0000, v14
  v_fmac_f32 v44, s30, v52
  v_fmac_f32 v45, s30, v53
  v_fmac_f32 v46, s31, v52
  v_fmac_f32 v47, s31, v53
  v_readlane_b32 s30, v40, 39
  v_readlane_b32 s31, v41, 39
  v_lshlrev_b32 v52, 16, v15
  v_and_b32 v53, 0xffff0000, v15
  v_fmac_f32 v44, s30, v52
  v_fmac_f32 v45, s30, v53
  v_fmac_f32 v46, s31, v52
  v_fmac_f32 v47, s31, v53
  v_readlane_b32 s30, v40, 40
  v_readlane_b32 s31, v41, 40
  v_lshlrev_b32 v52, 16, v16
  v_and_b32 v53, 0xffff0000, v16
  v_fmac_f32 v44, s30, v52
  v_fmac_f32 v45, s30, v53
  v_fmac_f32 v46, s31, v52
  v_fmac_f32 v47, s31, v53
  v_readlane_b32 s30, v40, 41
  v_readlane_b32 s31, v41, 41
  v_lshlrev_b32 v52, 16, v17
  v_and_b32 v53, 0xffff0000, v17
  v_fmac_f32 v44, s30, v52
  v_fmac_f32 v45, s30, v53
  v_fmac_f32 v46, s31, v52
  v_fmac_f32 v47, s31, v53
  v_readlane_b32 s30, v40, 42
  v_readlane_b32 s31, v41, 42
  v_lshlrev_b32 v52, 16, v18
  v_and_b32 v53, 0xffff0000, v18
  v_fmac_f32 v44, s30, v52
  v_fmac_f32 v45, s30, v53
  v_fmac_f32 v46, s31, v52
  v_fmac_f32 v47, s31, v53
  v_readlane_b32 s30, v40, 43
  v_readlane_b32 s31, v41, 43
  v_lshlrev_b32 v52, 16, v19
  v_and_b32 v53, 0xffff0000, v19
  v_fmac_f32 v44, s30, v52
  v_fmac_f32 v45, s30, v53
  v_fmac_f32 v46, s31, v52
  v_fmac_f32 v47, s31, v53
  v_readlane_b32 s30, v40, 44
  v_readlane_b32 s31, v41, 44
  v_lshlrev_b32 v52, 16, v20
  v_and_b32 v53, 0xffff0000, v20
  v_fmac_f32 v44, s30, v52
  v_fmac_f32 v45, s30, v53
  v_fmac_f32 v46, s31, v52
  v_fmac_f32 v47, s31, v53
  v_readlane_b32 s30, v40, 45
  v_readlane_b32 s31, v41, 45
  v_lshlrev_b32 v52, 16, v21
  v_and_b32 v53, 0xffff0000, v21
  v_fmac_f32 v44, s30, v52
  v_fmac_f32 v45, s30, v53
  v_fmac_f32 v46, s31, v52
  v_fmac_f32 v47, s31, v53
  v_readlane_b32 s30, v40, 46
  v_readlane_b32 s31, v41, 46
  v_lshlrev_b32 v52, 16, v22
  v_and_b32 v53, 0xffff0000, v22
  v_fmac_f32 v44, s30, v52
  v_fmac_f32 v45, s30, v53
  v_fmac_f32 v46, s31, v52
  v_fmac_f32 v47, s31, v53
  v_readlane_b32 s30, v40, 47
  v_readlane_b32 s31, v41, 47
  v_lshlrev_b32 v52, 16, v23
  v_and_b32 v53, 0xffff0000, v23
  v_fmac_f32 v44, s30, v52
  v_fmac_f32 v45, s30, v53
  v_fmac_f32 v46, s31, v52
  v_fmac_f32 v47, s31, v53
  v_readlane_b32 s30, v40, 48
  v_readlane_b32 s31, v41, 48
  v_lshlrev_b32 v52, 16, v24
  v_and_b32 v53, 0xffff0000, v24
  v_fmac_f32 v44, s30, v52
  v_fmac_f32 v45, s30, v53
  v_fmac_f32 v46, s31, v52
  v_fmac_f32 v47, s31, v53
  v_readlane_b32 s30, v40, 49
  v_readlane_b32 s31, v41, 49
  v_lshlrev_b32 v52, 16, v25
  v_and_b32 v53, 0xffff0000, v25
  v_fmac_f32 v44, s30, v52
  v_fmac_f32 v45, s30, v53
  v_fmac_f32 v46, s31, v52
  v_fmac_f32 v47, s31, v53
  v_readlane_b32 s30, v40, 50
  v_readlane_b32 s31, v41, 50
  v_lshlrev_b32 v52, 16, v26
  v_and_b32 v53, 0xffff0000, v26
  v_fmac_f32 v44, s30, v52
  v_fmac_f32 v45, s30, v53
  v_fmac_f32 v46, s31, v52
  v_fmac_f32 v47, s31, v53
  v_readlane_b32 s30, v40, 51
  v_readlane_b32 s31, v41, 51
  v_lshlrev_b32 v52, 16, v27
  v_and_b32 v53, 0xffff0000, v27
  v_fmac_f32 v44, s30, v52
  v_fmac_f32 v45, s30, v53
  v_fmac_f32 v46, s31, v52
  v_fmac_f32 v47, s31, v53
  v_readlane_b32 s30, v40, 52
  v_readlane_b32 s31, v41, 52
  v_lshlrev_b32 v52, 16, v28
  v_and_b32 v53, 0xffff0000, v28
  v_fmac_f32 v44, s30, v52
  v_fmac_f32 v45, s30, v53
  v_fmac_f32 v46, s31, v52
  v_fmac_f32 v47, s31, v53
  v_readlane_b32 s30, v40, 53
  v_readlane_b32 s31, v41, 53
  v_lshlrev_b32 v52, 16, v29
  v_and_b32 v53, 0xffff0000, v29
  v_fmac_f32 v44, s30, v52
  v_fmac_f32 v45, s30, v53
  v_fmac_f32 v46, s31, v52
  v_fmac_f32 v47, s31, v53
  v_readlane_b32 s30, v40, 54
  v_readlane_b32 s31, v41, 54
  v_lshlrev_b32 v52, 16, v30
  v_and_b32 v53, 0xffff0000, v30
  v_fmac_f32 v44, s30, v52
  v_fmac_f32 v45, s30, v53
  v_fmac_f32 v46, s31, v52
  v_fmac_f32 v47, s31, v53
  v_readlane_b32 s30, v40, 55
  v_readlane_b32 s31, v41, 55
  v_lshlrev_b32 v52, 16, v31
  v_and_b32 v53, 0xffff0000, v31
  v_fmac_f32 v44, s30, v52
  v_fmac_f32 v45, s30, v53
  v_fmac_f32 v46, s31, v52
  v_fmac_f32 v47, s31, v53
  v_readlane_b32 s30, v40, 56
  v_readlane_b32 s31, v41, 56
  v_lshlrev_b32 v52, 16, v32
  v_and_b32 v53, 0xffff0000, v32
  v_fmac_f32 v44, s30, v52
  v_fmac_f32 v45, s30, v53
  v_fmac_f32 v46, s31, v52
  v_fmac_f32 v47, s31, v53
  v_readlane_b32 s30, v40, 57
  v_readlane_b32 s31, v41, 57
  v_lshlrev_b32 v52, 16, v33
  v_and_b32 v53, 0xffff0000, v33
  v_fmac_f32 v44, s30, v52
  v_fmac_f32 v45, s30, v53
  v_fmac_f32 v46, s31, v52
  v_fmac_f32 v47, s31, v53
  v_readlane_b32 s30, v40, 58
  v_readlane_b32 s31, v41, 58
  v_lshlrev_b32 v52, 16, v34
  v_and_b32 v53, 0xffff0000, v34
  v_fmac_f32 v44, s30, v52
  v_fmac_f32 v45, s30, v53
  v_fmac_f32 v46, s31, v52
  v_fmac_f32 v47, s31, v53
  v_readlane_b32 s30, v40, 59
  v_readlane_b32 s31, v41, 59
  v_lshlrev_b32 v52, 16, v35
  v_and_b32 v53, 0xffff0000, v35
  v_fmac_f32 v44, s30, v52
  v_fmac_f32 v45, s30, v53
  v_fmac_f32 v46, s31, v52
  v_fmac_f32 v47, s31, v53
  v_readlane_b32 s30, v40, 60
  v_readlane_b32 s31, v41, 60
  v_lshlrev_b32 v52, 16, v36
  v_and_b32 v53, 0xffff0000, v36
  v_fmac_f32 v44, s30, v52
  v_fmac_f32 v45, s30, v53
  v_fmac_f32 v46, s31, v52
  v_fmac_f32 v47, s31, v53
  v_readlane_b32 s30, v40, 61
  v_readlane_b32 s31, v41, 61
  v_lshlrev_b32 v52, 16, v37
  v_and_b32 v53, 0xffff0000, v37
  v_fmac_f32 v44, s30, v52
  v_fmac_f32 v45, s30, v53
  v_fmac_f32 v46, s31, v52
  v_fmac_f32 v47, s31, v53
  v_readlane_b32 s30, v40, 62
  v_readlane_b32 s31, v41, 62
  v_lshlrev_b32 v52, 16, v38
  v_and_b32 v53, 0xffff0000, v38
  v_fmac_f32 v44, s30, v52
  v_fmac_f32 v45, s30, v53
  v_fmac_f32 v46, s31, v52
  v_fmac_f32 v47, s31, v53
  v_readlane_b32 s30, v40, 63
  v_readlane_b32 s31, v41, 63
  v_lshlrev_b32 v52, 16, v39
  v_and_b32 v53, 0xffff0000, v39
  v_fmac_f32 v44, s30, v52
  v_fmac_f32 v45, s30, v53
  v_fmac_f32 v46, s31, v52
  v_fmac_f32 v47, s31, v53
  s_add_u32 s29, s29, 1
  s_cmp_lt_u32 s29, 4
  s_cbranch_scc1 L5_loop
  v_lshlrev_b32 v4, 4, v0
  ds_write_b128 v4, v[44:47]
  s_waitcnt lgkmcnt(0)
  s_barrier
  s_cmp_lg_u32 s3, 0
  s_cbranch_scc1 L5_end
  ds_read_b128 v[8:11], v4 offset:1024
  s_waitcnt lgkmcnt(0)
  v_add_f32 v44, v44, v8
  v_add_f32 v45, v45, v9
  v_add_f32 v46, v46, v10
  v_add_f32 v47, v47, v11
  ds_read_b128 v[8:11], v4 offset:2048
  s_waitcnt lgkmcnt(0)
  v_add_f32 v44, v44, v8
  v_add_f32 v45, v45, v9
  v_add_f32 v46, v46, v10
  v_add_f32 v47, v47, v11
  ds_read_b128 v[8:11], v4 offset:3072
  s_waitcnt lgkmcnt(0)
  v_add_f32 v44, v44, v8
  v_add_f32 v45, v45, v9
  v_add_f32 v46, v46, v10
  v_add_f32 v47, v47, v11
  ds_read_b128 v[8:11], v4 offset:4096
  s_waitcnt lgkmcnt(0)
  v_add_f32 v44, v44, v8
  v_add_f32 v45, v45, v9
  v_add_f32 v46, v46, v10
  v_add_f32 v47, v47, v11
  ds_read_b128 v[8:11], v4 offset:5120
  s_waitcnt lgkmcnt(0)
  v_add_f32 v44, v44, v8
  v_add_f32 v45, v45, v9
  v_add_f32 v46, v46, v10
  v_add_f32 v47, v47, v11
  ds_read_b128 v[8:11], v4 offset:6144
  s_waitcnt lgkmcnt(0)
  v_add_f32 v44, v44, v8
  v_add_f32 v45, v45, v9
  v_add_f32 v46, v46, v10
  v_add_f32 v47, v47, v11
  ds_read_b128 v[8:11], v4 offset:7168
  s_waitcnt lgkmcnt(0)
  v_add_f32 v44, v44, v8
  v_add_f32 v45, v45, v9
  v_add_f32 v46, v46, v10
  v_add_f32 v47, v47, v11
  ds_read_b128 v[8:11], v4 offset:8192
  s_waitcnt lgkmcnt(0)
  v_add_f32 v44, v44, v8
  v_add_f32 v45, v45, v9
  v_add_f32 v46, v46, v10
  v_add_f32 v47, v47, v11
  ds_read_b128 v[8:11], v4 offset:9216
  s_waitcnt lgkmcnt(0)
  v_add_f32 v44, v44, v8
  v_add_f32 v45, v45, v9
  v_add_f32 v46, v46, v10
  v_add_f32 v47, v47, v11
  ds_read_b128 v[8:11], v4 offset:10240
  s_waitcnt lgkmcnt(0)
  v_add_f32 v44, v44, v8
  v_add_f32 v45, v45, v9
  v_add_f32 v46, v46, v10
  v_add_f32 v47, v47, v11
  ds_read_b128 v[8:11], v4 offset:11264
  s_waitcnt lgkmcnt(0)
  v_add_f32 v44, v44, v8
  v_add_f32 v45, v45, v9
  v_add_f32 v46, v46, v10
  v_add_f32 v47, v47, v11
  ds_read_b128 v[8:11], v4 offset:12288
  s_waitcnt lgkmcnt(0)
  v_add_f32 v44, v44, v8
  v_add_f32 v45, v45, v9
  v_add_f32 v46, v46, v10
  v_add_f32 v47, v47, v11
  ds_read_b128 v[8:11], v4 offset:13312
  s_waitcnt lgkmcnt(0)
  v_add_f32 v44, v44, v8
  v_add_f32 v45, v45, v9
  v_add_f32 v46, v46, v10
  v_add_f32 v47, v47, v11
  s_and_b32 s30, s20, 0xffff0000
  s_ashr_i32 s31, s30, 31
  s_not_b32 s31, s31
  s_or_b32 s31, s31, 0x80000000
  s_xor_b32 s30, s30, s31
  s_and_b32 s30, s30, 0xffff0000
  v_mov_b32 v8, s30
  v_mul_f32 v8, 0xbfb8aa3b, v8
  v_exp_f32 v8, v8
  s_nop 0
  v_add_f32 v8, 1.0, v8
  v_rcp_f32 v8, v8
  s_nop 0
  v_cvt_pk_bf16_f32 v8, v8, v8
  v_and_b32 v8, 0xffff0000, v8
  s_lshl_b32 s30, s22, 11
  s_add_u32 s30, s30, s28
  v_add_u32 v9, s30, v63
  global_load_dword v10, v9, s[6:7]
  s_waitcnt vmcnt(0)
  v_lshlrev_b32 v11, 16, v10
  v_and_b32 v12, 0xffff0000, v10
  v_cvt_pk_bf16_f32 v44, v44, v44
  v_and_b32 v44, 0xffff0000, v44
  v_cvt_pk_bf16_f32 v45, v45, v45
  v_and_b32 v45, 0xffff0000, v45
  v_fmac_f32 v11, v44, v8
  v_fmac_f32 v12, v45, v8
  v_cvt_pk_bf16_f32 v11, v11, v12
  global_store_dword v9, v11, s[6:7]
  s_nop 1
  s_and_b32 s30, s21, 0xffff0000
  s_ashr_i32 s31, s30, 31
  s_not_b32 s31, s31
  s_or_b32 s31, s31, 0x80000000
  s_xor_b32 s30, s30, s31
  s_and_b32 s30, s30, 0xffff0000
  v_mov_b32 v8, s30
  v_mul_f32 v8, 0xbfb8aa3b, v8
  v_exp_f32 v8, v8
  s_nop 0
  v_add_f32 v8, 1.0, v8
  v_rcp_f32 v8, v8
  s_nop 0
  v_cvt_pk_bf16_f32 v8, v8, v8
  v_and_b32 v8, 0xffff0000, v8
  s_lshl_b32 s30, s23, 11
  s_add_u32 s30, s30, s28
  v_add_u32 v9, s30, v63
  global_load_dword v10, v9, s[6:7]
  s_waitcnt vmcnt(0)
  v_lshlrev_b32 v11, 16, v10
  v_and_b32 v12, 0xffff0000, v10
  v_cvt_pk_bf16_f32 v46, v46, v46
  v_and_b32 v46, 0xffff0000, v46
  v_cvt_pk_bf16_f32 v47, v47, v47
  v_and_b32 v47, 0xffff0000, v47
  v_fmac_f32 v11, v46, v8
  v_fmac_f32 v12, v47, v8
  v_cvt_pk_bf16_f32 v11, v11, v12
  global_store_dword v9, v11, s[6:7]
  s_nop 1
L5_end:
  s_endpgm
.section .rodata,"a"
.p2align 6
.amdhsa_kernel k5_kernel
  .amdhsa_next_free_vgpr 64
  .amdhsa_next_free_sgpr 102
  .amdhsa_accum_offset 64
  .amdhsa_group_segment_fixed_size 0
  .amdhsa_kernarg_size 104
  .amdhsa_user_sgpr_count 2
  .amdhsa_user_sgpr_kernarg_segment_ptr 1
  .amdhsa_system_sgpr_workgroup_id_x 1
.end_amdhsa_kernel
```

```asm
; @launch grid=(256,1,1) block=(512,1,1) lds=139520
.amdgcn_target "amdgcn-amd-amdhsa--gfx950"
.text
.globl parallel_sum__spectral_fnet__moe_arch_mod__prompt_kernel
.p2align 8
.type parallel_sum__spectral_fnet__moe_arch_mod__prompt_kernel,@function
parallel_sum__spectral_fnet__moe_arch_mod__prompt_kernel:
  s_cmp_ge_u32 s2, 256
  s_cbranch_scc1 L_end
  s_load_dwordx2 s[4:5], s[0:1], 0
  s_load_dwordx2 s[8:9], s[0:1], 96
  s_load_dwordx2 s[12:13], s[0:1], 80
  v_lshrrev_b32 v3, 6, v0
  v_and_b32 v1, 63, v0
  s_mov_b32 s6, 0x400000
  v_readfirstlane_b32 s3, v3
  s_mov_b32 s7, 0x20000
  s_mov_b32 s10, 8388608
  s_mov_b32 s11, 0x20000
  s_mov_b32 s19, 0x20000
  s_mov_b32 s22, 7340032
  s_mov_b32 s23, 0x20000
  v_lshlrev_b32 v2, 4, v1
  s_cmp_ge_u32 s2, 128
  s_cbranch_scc1 L_ffn0
  s_load_dwordx2 s[16:17], s[0:1], 48
  s_load_dwordx2 s[20:21], s[0:1], 72
  s_lshl_b32 s30, s3, 8
  s_add_u32 s30, s30, s2
  s_cmp_eq_u32 s2, 0
  s_cselect_b32 s32, 896, 0
  s_cmp_ge_u32 s3, 4
  s_cselect_b32 s32, s32, 0
  s_sub_u32 s30, s30, s32
  s_sub_u32 s31, 2048, s30
  s_cmp_eq_u32 s30, 0
  s_cselect_b32 s31, 1024, s31
  s_lshl_b32 s32, s30, 11
  s_lshl_b32 s33, s31, 11
  s_lshl_b32 m0, s3, 12
  s_lshl_b32 s34, s3, 8
  v_lshlrev_b32 v4, 2, v1
  s_mov_b32 s18, 2048
  s_waitcnt lgkmcnt(0)
  buffer_load_dwordx4 v2, s[4:7], s32 offen lds
  buffer_load_dwordx4 v2, s[4:7], s32 offen offset:1024 lds
  s_add_u32 m0, m0, 2048
  s_add_u32 s35, s34, 32768
  buffer_load_dwordx4 v2, s[4:7], s33 offen lds
  buffer_load_dwordx4 v2, s[4:7], s33 offen offset:1024 lds
  s_mov_b32 m0, s35
  buffer_load_dword v3, off, s[8:11], 0 sc1
  buffer_load_dword v4, s[16:19], s34 offen lds
  s_branch L_fft1
L_ffn0:
  s_load_dwordx2 s[16:17], s[0:1], 56
  s_load_dwordx2 s[20:21], s[0:1], 64
  s_mov_b32 s18, 7340032
  s_sub_u32 s30, s2, 128
  s_lshr_b32 s31, s30, 4
  s_and_b32 s32, s30, 15
  s_lshl_b32 s33, s32, 3
  s_add_u32 s33, s33, s3
  s_mul_i32 s33, s33, 57344
  s_mul_i32 s34, s31, 896
  s_add_u32 s33, s33, s34
  s_and_b32 s34, s3, 3
  s_mul_i32 s34, s34, 3712
  s_lshr_b32 s35, s3, 2
  s_mul_i32 s35, s35, 29696
  s_add_u32 m0, s34, s35
  s_waitcnt lgkmcnt(0)
  buffer_load_dword v3, off, s[8:11], 0 sc1
  s_mov_b32 exec_hi, 0x00ffffff
  buffer_load_dwordx4 v2, s[16:19], s33 offen lds
  s_add_u32 m0, m0, 59392
  s_nop 0
  buffer_load_dwordx4 v2, s[20:23], s33 offen lds
  s_sub_u32 m0, m0, 58464
  s_add_u32 s33, s33, 7168
  buffer_load_dwordx4 v2, s[16:19], s33 offen lds
  s_add_u32 m0, m0, 59392
  s_nop 0
  buffer_load_dwordx4 v2, s[20:23], s33 offen lds
  s_sub_u32 m0, m0, 58464
  s_add_u32 s33, s33, 7168
  buffer_load_dwordx4 v2, s[16:19], s33 offen lds
  s_add_u32 m0, m0, 59392
  s_nop 0
  buffer_load_dwordx4 v2, s[20:23], s33 offen lds
  s_sub_u32 m0, m0, 58464
  s_add_u32 s33, s33, 7168
  buffer_load_dwordx4 v2, s[16:19], s33 offen lds
  s_add_u32 m0, m0, 59392
  s_nop 0
  buffer_load_dwordx4 v2, s[20:23], s33 offen lds
  s_sub_u32 m0, m0, 47328
  s_add_u32 s33, s33, 7168
  buffer_load_dwordx4 v2, s[16:19], s33 offen lds
  s_add_u32 m0, m0, 59392
  s_nop 0
  buffer_load_dwordx4 v2, s[20:23], s33 offen lds
  s_sub_u32 m0, m0, 58464
  s_add_u32 s33, s33, 7168
  buffer_load_dwordx4 v2, s[16:19], s33 offen lds
  s_add_u32 m0, m0, 59392
  s_nop 0
  buffer_load_dwordx4 v2, s[20:23], s33 offen lds
  s_sub_u32 m0, m0, 58464
  s_add_u32 s33, s33, 7168
  buffer_load_dwordx4 v2, s[16:19], s33 offen lds
  s_add_u32 m0, m0, 59392
  s_nop 0
  buffer_load_dwordx4 v2, s[20:23], s33 offen lds
  s_sub_u32 m0, m0, 58464
  s_add_u32 s33, s33, 7168
  buffer_load_dwordx4 v2, s[16:19], s33 offen lds
  s_add_u32 m0, m0, 59392
  s_nop 0
  buffer_load_dwordx4 v2, s[20:23], s33 offen lds
  s_mov_b32 exec_hi, -1
  s_branch L_ffn1
L_fft1:
  s_mov_b32 s14, 0x400000
  s_mov_b32 s15, 0x20000
  s_and_b32 s40, s2, 7
  s_bfe_u32 s41, s2, 0x10003
  s_lshr_b32 s42, s2, 4
  s_and_b32 s43, s2, 15
  v_lshrrev_b32 v16, 3, v0
  v_and_b32 v17, 7, v0
  v_lshl_add_u32 v16, v16, 4, s43
  s_lshl_b32 s44, s42, 7
  v_lshl_add_u32 v18, v17, 4, s44
  v_lshl_add_u32 v172, v16, 11, v18
  v_add_u32 v174, 0x200000, v172
  v_sub_u32 v16, 1024, v16
  v_sub_u32 v18, 2032, v18
  v_lshl_add_u32 v175, v16, 11, v18
  v_add_u32 v173, 0x200000, v175
  v_and_b32 v173, 0x3fffff, v173
  v_and_b32 v16, 31, v1
  v_lshrrev_b32 v17, 5, v1
  v_and_b32 v18, 3, v1
  v_bfe_u32 v19, v1, 2, 1
  v_bfe_u32 v20, v1, 3, 1
  v_mad_u32_u24 v18, v19, 7, v18
  v_lshl_add_u32 v18, v20, 2, v18
  v_add_u32 v18, 1, v18
  v_cmp_eq_u32 vcc, 11, v16
  v_cvt_f32_u32 v18, v18
  v_mov_b32 v19, 0xc2000000
  v_cndmask_b32 v11, 0, v19, vcc
  v_cndmask_b32 v18, v18, 0, vcc
  v_cmp_eq_u32 vcc, 27, v16
  v_mov_b32 v19, 0x41800000
  s_and_b32 s36, s3, 3
  v_cndmask_b32 v18, v18, v19, vcc
  v_lshlrev_b32 v19, 27, v1
  v_and_b32 v19, 0x80000000, v19
  v_or_b32 v18, v18, v19
  s_lshl_b32 s37, s36, 3
  v_lshl_add_u32 v19, v17, 2, s37
  v_cvt_f32_u32 v19, v19
  s_lshl_b32 s37, s36, 10
  v_add_u32 v20, s37, v2
  s_cmp_ge_u32 s3, 4
  s_cbranch_scc1 L_cg2
  v_mul_f32 v21, 0x3a800000, v18
  v_mul_f32 v22, v19, v21
  v_cos_f32 v24, v22
  v_sin_f32 v28, v22
  v_add_f32 v22, v22, v21
  v_cos_f32 v25, v22
  v_sin_f32 v29, v22
  v_add_f32 v22, v22, v21
  v_cos_f32 v26, v22
  v_sin_f32 v30, v22
  v_add_f32 v22, v22, v21
  v_cos_f32 v27, v22
  v_sin_f32 v31, v22
  ds_write_b128 v20, v[24:27] offset:34816
  ds_write_b128 v20, v[28:31] offset:38912
  s_lshr_b32 s37, s36, 1
  s_and_b32 s38, s36, 1
  s_lshl_b32 s39, s37, 4
  s_lshl_b32 s44, s38, 2
  s_add_u32 s39, s39, s44
  v_lshl_add_u32 v19, v17, 3, s39
  v_cvt_f32_u32 v19, v19
  v_mul_f32 v21, 0x3d000000, v18
  v_mul_f32 v22, v19, v21
  s_lshl_b32 s37, s37, 10
  s_lshl_b32 s38, s38, 3
  s_add_u32 s37, s37, s38
  v_add_u32 v20, s37, v2
  v_fract_f32 v23, v22
  v_add_f32 v22, v22, v21
  v_cos_f32 v156, v23
  v_sin_f32 v160, v23
  v_fract_f32 v23, v22
  v_add_f32 v22, v22, v21
  v_cos_f32 v157, v23
  v_sin_f32 v161, v23
  v_fract_f32 v23, v22
  v_add_f32 v22, v22, v21
  v_cos_f32 v158, v23
  v_sin_f32 v162, v23
  v_fract_f32 v23, v22
  v_add_f32 v22, v22, v21
  v_cos_f32 v159, v23
  v_sin_f32 v163, v23
  v_add_f32 v164, v156, v160
  v_sub_f32 v168, v156, v160
  v_add_f32 v165, v157, v161
  v_sub_f32 v169, v157, v161
  v_add_f32 v166, v158, v162
  v_sub_f32 v170, v158, v162
  v_add_f32 v167, v159, v163
  v_sub_f32 v171, v159, v163
  v_cvt_pk_bf16_f32 v156, v164, v165
  v_cvt_pk_bf16_f32 v157, v166, v167
  v_cvt_pk_bf16_f32 v158, v168, v169
  v_cvt_pk_bf16_f32 v159, v170, v171
  ds_write_b64 v20, v[156:157] offset:43008
  ds_write_b64 v20, v[158:159] offset:45056
  s_branch L_cg3
L_cg2:
  v_cvt_f32_u32 v21, v16
  v_mul_f32 v21, 0x3d000000, v21
  v_mul_f32 v22, v19, v21
  v_fract_f32 v23, v22
  v_add_f32 v22, v22, v21
  v_cos_f32 v156, v23
  v_sin_f32 v160, v23
  v_fract_f32 v23, v22
  v_add_f32 v22, v22, v21
  v_cos_f32 v157, v23
  v_sin_f32 v161, v23
  v_fract_f32 v23, v22
  v_add_f32 v22, v22, v21
  v_cos_f32 v158, v23
  v_sin_f32 v162, v23
  v_fract_f32 v23, v22
  v_add_f32 v22, v22, v21
  v_cos_f32 v159, v23
  v_sin_f32 v163, v23
  s_lshl_b32 s37, s36, 6
  v_add_u32 v23, s37, v1
  v_cvt_f32_u32 v22, v23
  v_mul_f32 v22, 0x3b800000, v22
  v_cos_f32 v24, v22
  v_sin_f32 v25, v22
  v_cvt_pk_f16_f32 v28, v156, v157
  v_cvt_pk_f16_f32 v29, v158, v159
  v_cvt_pk_f16_f32 v30, v160, v161
  v_cvt_pk_f16_f32 v31, v162, v163
  ds_write_b128 v20, v[28:31] offset:47104
  v_mul_f32 v24, 0x3d000000, v24
  v_mul_f32 v25, 0xbd000000, v25
  v_lshlrev_b32 v23, 2, v23
  v_cvt_pk_f16_f32 v24, v24, v25
  ds_write_b32 v23, v24 offset:52224
  s_cmp_lg_u32 s3, 4
  s_cbranch_scc1 L_cg3
  s_cmp_eq_u32 s2, 0
  s_mov_b32 s37, 1024
  s_cmov_b32 s37, 128
  s_mov_b32 s38, 2048
  s_cmov_b32 s38, 1024
  s_cselect_b32 s39, 0, 0xbe800000
  s_cselect_b32 s48, 0xaaaa5555, -1
  s_cselect_b32 s49, 0x5555, 0
  s_mov_b32 s50, s48
  s_mov_b32 s51, 0
  v_bfe_u32 v19, v1, 4, 1
  v_mul_u32_u24 v19, s37, v19
  v_mad_u32_u24 v19, v17, s38, v19
  v_add_u32 v19, s2, v19
  v_bfe_u32 v20, v1, 1, 3
  v_mul_u32_u24 v19, v19, v20
  v_cvt_f32_u32 v19, v19
  v_cvt_f32_u32 v21, v20
  v_and_b32 v20, 1, v1
  v_cvt_f32_u32 v20, v20
  v_mul_f32 v21, 0.125, v21
  v_mul_f32 v20, s39, v20
  v_add_f32 v20, 0.125, v20
  v_fmac_f32 v20, 0x3a000000, v19
  v_mov_b32 v19, 0x3eb504f3
  v_cndmask_b32 v22, 0, v19, s[48:49]
  v_cndmask_b32 v19, 0, v19, s[50:51]
  v_fract_f32 v23, v20
  v_add_f32 v20, v20, v21
  v_cos_f32 v156, v23
  v_sin_f32 v157, v23
  v_fract_f32 v23, v20
  v_add_f32 v20, v20, v21
  v_cos_f32 v158, v23
  v_sin_f32 v159, v23
  v_fract_f32 v23, v20
  v_add_f32 v20, v20, v21
  v_cos_f32 v160, v23
  v_sin_f32 v161, v23
  v_fract_f32 v23, v20
  v_add_f32 v20, v20, v21
  v_cos_f32 v162, v23
  v_sin_f32 v163, v23
  v_mul_f32 v156, v22, v156
  v_mul_f32 v157, v22, v157
  v_cvt_pk_f16_f32 v24, v156, v157
  v_mul_f32 v158, v19, v158
  v_mul_f32 v159, v19, v159
  v_cvt_pk_f16_f32 v25, v158, v159
  v_mul_f32 v160, v19, v160
  v_mul_f32 v161, v19, v161
  v_cvt_pk_f16_f32 v26, v160, v161
  v_mul_f32 v162, v19, v162
  v_mul_f32 v163, v19, v163
  v_cvt_pk_f16_f32 v27, v162, v163
  ds_write_b128 v2, v[24:27] offset:51200
L_cg3:
  s_lshl_b32 s37, s36, 6
  s_add_u32 s37, s37, s41
  v_lshl_add_u32 v19, v16, 1, s37
  v_lshlrev_b32 v20, 2, v19
  v_mul_u32_u24 v21, v20, v17
  v_lshlrev_b32 v21, 2, v21
  v_add_u32 v19, 1, v19
  v_lshlrev_b32 v19, 30, v19
  v_and_b32 v19, 0x80000000, v19
  v_or_b32 v19, 0x28002800, v19
  v_mul_u32_u24 v23, 5, v20
  s_waitcnt lgkmcnt(0)
  s_barrier
  ds_read_b128 v[112:115], v2 offset:43008
  ds_read_b128 v[116:119], v2 offset:44032
  ds_read_b128 v[120:123], v2 offset:45056
  ds_read_b128 v[124:127], v2 offset:46080
  ds_read_b128 v[64:67], v2 offset:34816
  ds_read_b128 v[68:71], v2 offset:35840
  ds_read_b128 v[72:75], v2 offset:36864
  ds_read_b128 v[76:79], v2 offset:37888
  ds_read_b128 v[80:83], v2 offset:38912
  ds_read_b128 v[84:87], v2 offset:39936
  ds_read_b128 v[88:91], v2 offset:40960
  ds_read_b128 v[92:95], v2 offset:41984
  ds_read_b128 v[96:99], v2 offset:47104
  ds_read_b128 v[100:103], v2 offset:48128
  ds_read_b128 v[104:107], v2 offset:49152
  ds_read_b128 v[108:111], v2 offset:50176
  ds_read_b128 v[128:131], v2 offset:51200
  v_and_b32 v22, 0x3fc, v21
  ds_read_b32 v32, v22 offset:52224
  v_add_u32 v21, v21, v20
  v_and_b32 v22, 0x3fc, v21
  ds_read_b32 v33, v22 offset:52224
  v_add_u32 v21, v21, v20
  v_and_b32 v22, 0x3fc, v21
  ds_read_b32 v34, v22 offset:52224
  v_add_u32 v21, v21, v20
  v_and_b32 v22, 0x3fc, v21
  ds_read_b32 v35, v22 offset:52224
  v_add_u32 v21, v21, v23
  v_and_b32 v22, 0x3fc, v21
  ds_read_b32 v36, v22 offset:52224
  v_add_u32 v21, v21, v20
  v_and_b32 v22, 0x3fc, v21
  ds_read_b32 v37, v22 offset:52224
  v_add_u32 v21, v21, v20
  v_and_b32 v22, 0x3fc, v21
  ds_read_b32 v38, v22 offset:52224
  v_add_u32 v21, v21, v20
  v_and_b32 v22, 0x3fc, v21
  ds_read_b32 v39, v22 offset:52224
  v_add_u32 v21, v21, v23
  v_and_b32 v22, 0x3fc, v21
  ds_read_b32 v40, v22 offset:52224
  v_add_u32 v21, v21, v20
  v_and_b32 v22, 0x3fc, v21
  ds_read_b32 v41, v22 offset:52224
  v_add_u32 v21, v21, v20
  v_and_b32 v22, 0x3fc, v21
  ds_read_b32 v42, v22 offset:52224
  v_add_u32 v21, v21, v20
  v_and_b32 v22, 0x3fc, v21
  ds_read_b32 v43, v22 offset:52224
  v_add_u32 v21, v21, v23
  v_and_b32 v22, 0x3fc, v21
  ds_read_b32 v44, v22 offset:52224
  v_add_u32 v21, v21, v20
  v_and_b32 v22, 0x3fc, v21
  ds_read_b32 v45, v22 offset:52224
  v_add_u32 v21, v21, v20
  v_and_b32 v22, 0x3fc, v21
  ds_read_b32 v46, v22 offset:52224
  v_add_u32 v21, v21, v20
  v_and_b32 v22, 0x3fc, v21
  ds_read_b32 v47, v22 offset:52224
  v_add_u32 v21, v21, v23
  v_and_b32 v22, 0x3fc, v21
  ds_read_b32 v48, v22 offset:52224
  v_add_u32 v21, v21, v20
  v_and_b32 v22, 0x3fc, v21
  ds_read_b32 v49, v22 offset:52224
  v_add_u32 v21, v21, v20
  v_and_b32 v22, 0x3fc, v21
  ds_read_b32 v50, v22 offset:52224
  v_add_u32 v21, v21, v20
  v_and_b32 v22, 0x3fc, v21
  ds_read_b32 v51, v22 offset:52224
  v_add_u32 v21, v21, v23
  v_and_b32 v22, 0x3fc, v21
  ds_read_b32 v52, v22 offset:52224
  v_add_u32 v21, v21, v20
  v_and_b32 v22, 0x3fc, v21
  ds_read_b32 v53, v22 offset:52224
  v_add_u32 v21, v21, v20
  v_and_b32 v22, 0x3fc, v21
  ds_read_b32 v54, v22 offset:52224
  v_add_u32 v21, v21, v20
  v_and_b32 v22, 0x3fc, v21
  ds_read_b32 v55, v22 offset:52224
  v_add_u32 v21, v21, v23
  v_and_b32 v22, 0x3fc, v21
  ds_read_b32 v56, v22 offset:52224
  v_add_u32 v21, v21, v20
  v_and_b32 v22, 0x3fc, v21
  ds_read_b32 v57, v22 offset:52224
  v_add_u32 v21, v21, v20
  v_and_b32 v22, 0x3fc, v21
  ds_read_b32 v58, v22 offset:52224
  v_add_u32 v21, v21, v20
  v_and_b32 v22, 0x3fc, v21
  ds_read_b32 v59, v22 offset:52224
  v_add_u32 v21, v21, v23
  v_and_b32 v22, 0x3fc, v21
  ds_read_b32 v60, v22 offset:52224
  v_add_u32 v21, v21, v20
  v_and_b32 v22, 0x3fc, v21
  ds_read_b32 v61, v22 offset:52224
  v_add_u32 v21, v21, v20
  v_and_b32 v22, 0x3fc, v21
  ds_read_b32 v62, v22 offset:52224
  v_add_u32 v21, v21, v20
  v_and_b32 v22, 0x3fc, v21
  ds_read_b32 v63, v22 offset:52224
  s_mov_b32 s48, 0xfffe0001
  s_mov_b32 s49, 0xfffe0001
  s_mov_b32 s50, 0xffff0000
  s_mov_b32 s51, 0xffff0000
  s_mov_b32 s52, 0xfffe0001
  s_mov_b32 s53, 0x0
  s_mov_b32 s54, 0x10000
  s_mov_b32 s55, 0x0
  v_bfe_u32 v20, v1, 2, 2
  v_and_b32 v21, 3, v1
  v_lshl_add_u32 v22, v17, 3, v20
  v_bfe_u32 v23, v1, 4, 1
  v_lshlrev_b32 v22, 6, v22
  v_lshl_add_u32 v22, v23, 5, v22
  v_lshl_add_u32 v5, v21, 3, v22
  s_lshl_b32 s37, s3, 12
  v_add_u32 v4, s37, v5
  v_sub_u32 v22, 32, v16
  v_min_u32 v22, v22, v16
  v_and_b32 v22, 15, v22
  v_lshlrev_b32 v22, 4, v22
  v_lshl_add_u32 v22, v17, 8, v22
  s_mul_i32 s37, s3, 2176
  s_add_u32 s37, s37, 55552
  v_add_u32 v22, s37, v22
  v_add_u32 v24, 1616, v22
  v_cndmask_b32 v6, v22, v24, s[50:51]
  v_add_u32 v24, 1088, v22
  v_add_u32 v25, 528, v22
  v_cndmask_b32 v7, v25, v24, s[48:49]
  v_cndmask_b32 v8, v6, v7, s[52:53]
  s_add_u32 s38, s37, 1042
  v_mov_b32 v24, s38
  v_cndmask_b32 v8, v8, v24, s[54:55]
  v_sub_u32 v24, 33, v16
  v_and_b32 v24, 15, v24
  s_add_u32 s38, s37, 1616
  v_lshl_add_u32 v24, v24, 4, s38
  v_cndmask_b32 v9, v7, v24, s[52:53]
  s_cmp_eq_u32 s2, 0
  s_cselect_b32 s38, -2176, 0
  v_mul_u32_u24 v24, 8704, v23
  v_mov_b32 v25, s38
  s_mov_b32 s48, 0x0
  s_mov_b32 s49, 0xffff
  s_mov_b32 s50, 0x0
  s_mov_b32 s51, 0xffff0000
  v_cndmask_b32 v24, v24, v25, s[48:49]
  v_cndmask_b32 v148, v24, 0, s[50:51]
  v_mul_u32_u24 v24, 1088, v20
  v_add_u32 v24, v24, v148
  v_and_b32 v25, 1, v1
  v_mul_u32_u24 v25, 528, v25
  v_add_u32 v21, 1, v21
  v_lshrrev_b32 v21, 1, v21
  s_lshl_b32 s37, s3, 1
  v_add_u32 v21, s37, v21
  v_and_b32 v21, 15, v21
  v_lshl_add_u32 v21, v21, 4, v25
  s_mov_b32 s37, 55552
  v_add3_u32 v10, v21, v24, s37
  v_lshrrev_b32 v21, 4, v1
  v_and_b32 v24, 15, v1
  v_lshlrev_b32 v24, 4, v24
  v_lshl_add_u32 v12, v21, 12, v24
  v_mov_b32 v13, 0xfffcfffc
  v_mov_b32 v21, s30
  v_mov_b32 v24, s31
  v_cmp_eq_u32 vcc, 0, v17
  v_and_b32 v25, 7, v1
  v_lshlrev_b32 v26, 5, v25
  v_cndmask_b32 v21, v24, v21, vcc
  v_sub_u32 v14, 0xffff, v21
  v_and_b32 v24, 15, v21
  v_lshrrev_b32 v21, 4, v21
  v_lshlrev_b32 v21, 3, v21
  v_lshl_add_u32 v15, v24, 10, v21
  v_cmp_eq_u32 vcc, 7, v25
  v_add_u32 v26, 55598, v26
  v_mov_b32 v24, 56608
  v_mov_b32 v27, 1088
  v_cndmask_b32 v26, v26, v24, vcc
  v_cndmask_b32 v27, v27, 0, vcc
  v_add_u32 v30, v26, v148
  v_add_u32 v31, v30, v27
  s_lshl_b32 s37, s3, 3
  v_lshl_add_u32 v29, v17, 2, s37
  s_waitcnt lgkmcnt(0)
  v_mov_b32_dpp v32, v19 quad_perm:[0,1,2,3] row_mask:0x3 bank_mask:0xf
  v_mov_b32 v16, 0
  v_mov_b32 v17, 0
  v_mov_b32 v18, 0
  v_mov_b32 v20, 0
  v_mov_b32 v21, 0
  v_mov_b32 v22, 0
  v_mov_b32 v23, 0
  s_mov_b32 s37, 0x3f803f80
  s_waitcnt vmcnt(0)
  ds_read_b64_tr_b16 v[132:133], v4 offset:0
  ds_read_b64_tr_b16 v[134:135], v4 offset:256
  ds_read_b64_tr_b16 v[136:137], v4 offset:1024
  ds_read_b64_tr_b16 v[138:139], v4 offset:1280
  ds_read_b64_tr_b16 v[140:141], v4 offset:2048
  ds_read_b64_tr_b16 v[142:143], v4 offset:2304
  ds_read_b64_tr_b16 v[144:145], v4 offset:3072
  ds_read_b64_tr_b16 v[146:147], v4 offset:3328
  s_barrier
  ds_read_b64_tr_b16 v[148:149], v5 offset:32768
  ds_read_b64_tr_b16 v[150:151], v5 offset:33024
  ds_read_b64_tr_b16 v[152:153], v5 offset:33792
  ds_read_b64_tr_b16 v[154:155], v5 offset:34048
  v_readfirstlane_b32 s24, v3
  s_add_u32 s24, s24, 1
  s_and_b32 s29, s24, 0xff
  s_waitcnt lgkmcnt(8)
  v_mfma_f32_32x32x16_bf16 v[176:191], v[132:135], v[112:115], 0
  v_dot2c_f32_bf16 v16, s37, v132
  v_dot2c_f32_bf16 v18, v132, v132
  v_dot2c_f32_bf16 v16, s37, v133
  v_dot2c_f32_bf16 v18, v133, v133
  v_dot2c_f32_bf16 v16, s37, v134
  v_dot2c_f32_bf16 v18, v134, v134
  v_dot2c_f32_bf16 v16, s37, v135
  v_dot2c_f32_bf16 v18, v135, v135
  v_mfma_f32_32x32x16_bf16 v[176:191], v[136:139], v[116:119], v[176:191]
  v_dot2c_f32_bf16 v16, s37, v136
  v_dot2c_f32_bf16 v18, v136, v136
  v_dot2c_f32_bf16 v16, s37, v137
  v_dot2c_f32_bf16 v18, v137, v137
  v_dot2c_f32_bf16 v16, s37, v138
  v_dot2c_f32_bf16 v18, v138, v138
  v_dot2c_f32_bf16 v16, s37, v139
  v_dot2c_f32_bf16 v18, v139, v139
  s_waitcnt lgkmcnt(4)
  v_mfma_f32_32x32x16_bf16 v[192:207], v[132:135], v[120:123], 0
  v_dot2c_f32_bf16 v17, s37, v140
  v_dot2c_f32_bf16 v20, v140, v140
  v_dot2c_f32_bf16 v17, s37, v141
  v_dot2c_f32_bf16 v20, v141, v141
  v_dot2c_f32_bf16 v17, s37, v142
  v_dot2c_f32_bf16 v20, v142, v142
  v_dot2c_f32_bf16 v17, s37, v143
  v_dot2c_f32_bf16 v20, v143, v143
  v_mfma_f32_32x32x16_bf16 v[192:207], v[136:139], v[124:127], v[192:207]
  v_dot2c_f32_bf16 v17, s37, v144
  v_dot2c_f32_bf16 v20, v144, v144
  v_dot2c_f32_bf16 v17, s37, v145
  v_dot2c_f32_bf16 v20, v145, v145
  v_dot2c_f32_bf16 v17, s37, v146
  v_dot2c_f32_bf16 v20, v146, v146
  v_dot2c_f32_bf16 v17, s37, v147
  v_dot2c_f32_bf16 v20, v147, v147
  s_waitcnt lgkmcnt(0)
  v_mfma_f32_32x32x16_bf16 v[208:223], v[140:143], v[112:115], 0
  v_dot2c_f32_bf16 v21, v148, v132
  v_dot2c_f32_bf16 v22, v148, v140
  v_dot2c_f32_bf16 v23, s37, v148
  v_dot2c_f32_bf16 v21, v149, v133
  v_dot2c_f32_bf16 v22, v149, v141
  v_dot2c_f32_bf16 v23, s37, v149
  v_mfma_f32_32x32x16_bf16 v[208:223], v[144:147], v[116:119], v[208:223]
  v_dot2c_f32_bf16 v21, v150, v134
  v_dot2c_f32_bf16 v22, v150, v142
  v_dot2c_f32_bf16 v23, s37, v150
  v_dot2c_f32_bf16 v21, v151, v135
  v_dot2c_f32_bf16 v22, v151, v143
  v_dot2c_f32_bf16 v23, s37, v151
  v_mfma_f32_32x32x16_bf16 v[224:239], v[140:143], v[120:123], 0
  v_dot2c_f32_bf16 v21, v152, v136
  v_dot2c_f32_bf16 v22, v152, v144
  v_dot2c_f32_bf16 v23, s37, v152
  v_dot2c_f32_bf16 v21, v153, v137
  v_dot2c_f32_bf16 v22, v153, v145
  v_dot2c_f32_bf16 v23, s37, v153
  v_mfma_f32_32x32x16_bf16 v[224:239], v[144:147], v[124:127], v[224:239]
  v_dot2c_f32_bf16 v21, v154, v138
  v_dot2c_f32_bf16 v22, v154, v146
  v_dot2c_f32_bf16 v23, s37, v154
  v_dot2c_f32_bf16 v21, v155, v139
  v_dot2c_f32_bf16 v22, v155, v147
  v_dot2c_f32_bf16 v23, s37, v155
  v_permlane32_swap_b32 v16, v17
  v_permlane32_swap_b32 v18, v20
  s_nop 0
  v_mov_b32 v24, v23
  v_permlane32_swap_b32 v21, v22
  v_add_f32 v16, v16, v17
  v_permlane32_swap_b32 v23, v24
  v_add_f32 v18, v18, v20
  v_add_f32 v21, v21, v22
  v_add_f32 v23, v23, v24
  v_permlane16_swap_b32 v16, v18
  s_nop 0
  v_permlane16_swap_b32 v21, v23
  v_add_f32 v16, v16, v18
  v_add_f32 v21, v21, v23
  s_nop 0
  v_add_f32_dpp v18, v16, v16 row_ror:8 row_mask:0xf bank_mask:0x3
  s_nop 1
  v_add_f32_dpp v18, v21, v21 row_ror:8 row_mask:0xf bank_mask:0xc
  s_nop 1
  v_add_f32_dpp v18, v18, v18 row_half_mirror row_mask:0xf bank_mask:0xf
  s_nop 1
  v_add_f32_dpp v18, v18, v18 quad_perm:[2,3,0,1] row_mask:0xf bank_mask:0xf
  s_nop 1
  v_add_f32_dpp v18, v18, v18 quad_perm:[1,0,3,2] row_mask:0xf bank_mask:0xf
  v_mov_b32 v20, v18
  s_nop 1
  v_permlane16_swap_b32 v18, v20
  v_mul_f32 v16, 0x3a800000, v18
  v_mul_f32 v17, 0x3a800000, v20
  v_mov_b32_dpp v21, v18 row_ror:8 row_mask:0xf bank_mask:0xf
  v_fma_f32 v17, -v16, v16, v17
  v_mov_b32_dpp v23, v20 row_ror:8 row_mask:0xf bank_mask:0xf
  v_max_f32 v17, 0, v17
  v_cvt_pk_bf16_f32 v17, v17, v17
  v_and_b32 v17, 0xffff0000, v17
  v_add_f32 v17, 0x3727c5ac, v17
  v_cvt_pk_bf16_f32 v17, v17, v17
  v_and_b32 v17, 0xffff0000, v17
  v_sqrt_f32 v17, v17
  v_mov_b32 v27, s24
  v_cvt_pk_bf16_f32 v26, v16, v17
  v_and_b32 v17, 0xffff0000, v26
  v_rcp_f32 v17, v17
  v_lshlrev_b32 v16, 16, v26
  v_fma_f32 v21, -v16, v23, v21
  v_mul_f32 v21, v21, v17
  v_mul_f32 v16, v16, v17
  v_cvt_pk_bf16_f32 v21, v21, v21
  v_readlane_b32 s56, v17, 0
  v_ashrrev_i32 v23, 31, v21
  v_or_b32 v23, 0x80000000, v23
  v_xor_b32 v21, v21, v23
  v_and_b32 v21, 0xffff0000, v21
  v_or_b32 v21, v21, v14
  s_mov_b32 s37, 8192
  s_mov_b32 exec_lo, 0x1
  s_mov_b32 exec_hi, 0x1
  ds_write_b32 v29, v21 offset:53248
  buffer_store_dwordx2 v[26:27], v15, s[8:11], s37 offen sc1
  s_mov_b64 exec, -1
  v_readlane_b32 s57, v17, 32
  v_readlane_b32 s58, v16, 0
  v_readlane_b32 s59, v16, 32
  v_and_b32 v16, 15, v1
  v_lshlrev_b32 v16, 2, v16
  s_waitcnt lgkmcnt(0)
  s_barrier
  s_cmp_lg_u32 s3, 7
  s_cbranch_scc1 L_nocand
  ds_read_b32 v20, v16 offset:53248
  v_mov_b32 v22, s24
  s_lshl_b32 s37, s2, 4
  s_add_u32 s37, s37, 4096
  s_waitcnt lgkmcnt(0)
  v_min_u32_dpp v21, v20, v20 row_ror:8 row_mask:0xf bank_mask:0xf
  v_max_u32_dpp v20, v20, v20 row_ror:8 row_mask:0xf bank_mask:0xf
  s_nop 1
  v_min_u32_dpp v23, v20, v20 row_ror:4 row_mask:0xf bank_mask:0xf
  v_max_u32_dpp v21, v21, v21 row_ror:4 row_mask:0xf bank_mask:0xf
  v_max_u32_dpp v20, v20, v20 row_ror:4 row_mask:0xf bank_mask:0xf
  v_max_u32 v21, v21, v23
  s_nop 0
  v_min_u32_dpp v23, v20, v20 row_ror:2 row_mask:0xf bank_mask:0xf
  v_max_u32_dpp v21, v21, v21 row_ror:2 row_mask:0xf bank_mask:0xf
  v_max_u32_dpp v20, v20, v20 row_ror:2 row_mask:0xf bank_mask:0xf
  v_max_u32 v21, v21, v23
  s_nop 0
  v_min_u32_dpp v23, v20, v20 row_ror:1 row_mask:0xf bank_mask:0xf
  v_max_u32_dpp v21, v21, v21 row_ror:1 row_mask:0xf bank_mask:0xf
  v_max_u32_dpp v20, v20, v20 row_ror:1 row_mask:0xf bank_mask:0xf
  v_max_u32 v21, v21, v23
  s_mov_b64 exec, 1
  buffer_store_dwordx4 v[20:23], off, s[8:11], s37 sc1
  s_mov_b64 exec, -1
L_nocand:
  s_and_b32 s37, s24, 0x3333
  s_and_b32 s38, s24, 0xcccc
  s_lshl_b32 s38, s38, 14
  s_or_b32 s37, s37, s38
  s_and_b32 s25, s37, 0x30003
  s_lshr_b32 s38, s37, 4
  s_and_b32 s26, s38, 0x30003
  s_lshr_b32 s38, s37, 8
  s_and_b32 s27, s38, 0x30003
  s_lshr_b32 s38, s37, 12
  s_and_b32 s28, s38, 0x30003
  s_mov_b32 s60, s57
  s_mov_b32 s61, s59
  s_or_b32 s62, s2, s3
  s_cmp_eq_u32 s62, 0
  s_cselect_b32 s57, 0, s57
  s_cselect_b32 s59, 0, s59
L_job:
  v_mul_f32 v18, s58, v11
  v_mul_f32 v19, s59, v11
  v_add_f32 v16, v18, v19
  v_sub_f32 v17, v18, v19
  v_pk_fma_f32 v[156:157], v[176:177], s[56:57], v[16:17] op_sel:[0,0,0] op_sel_hi:[1,0,0]
  v_pk_fma_f32 v[158:159], v[192:193], s[56:57], v[16:17] op_sel:[0,0,1] op_sel_hi:[1,0,1]
  v_pk_fma_f32 v[156:157], v[224:225], s[56:57], v[156:157] op_sel:[0,1,0] op_sel_hi:[1,1,1]
  v_pk_fma_f32 v[158:159], v[208:209], s[56:57], v[158:159] op_sel:[0,1,0] op_sel_hi:[1,1,1] neg_lo:[1,0,0] neg_hi:[1,0,0]
  v_pk_mul_f32 v[162:163], v[156:157], v[80:81]
  v_pk_mul_f32 v[160:161], v[158:159], v[80:81]
  v_pk_fma_f32 v[162:163], v[158:159], v[64:65], v[162:163] neg_lo:[0,0,1] neg_hi:[0,0,1]
  v_pk_fma_f32 v[160:161], v[156:157], v[64:65], v[160:161]
  v_cvt_pk_f16_f32 v134, v162, v163
  v_cvt_pk_f16_f32 v132, v160, v161
  v_pk_fma_f32 v[164:165], v[178:179], s[56:57], v[16:17] op_sel:[0,0,0] op_sel_hi:[1,0,0]
  v_pk_fma_f32 v[166:167], v[194:195], s[56:57], v[16:17] op_sel:[0,0,1] op_sel_hi:[1,0,1]
  v_pk_fma_f32 v[164:165], v[226:227], s[56:57], v[164:165] op_sel:[0,1,0] op_sel_hi:[1,1,1]
  v_pk_fma_f32 v[166:167], v[210:211], s[56:57], v[166:167] op_sel:[0,1,0] op_sel_hi:[1,1,1] neg_lo:[1,0,0] neg_hi:[1,0,0]
  v_pk_mul_f32 v[170:171], v[164:165], v[82:83]
  v_pk_mul_f32 v[168:169], v[166:167], v[82:83]
  v_pk_fma_f32 v[170:171], v[166:167], v[66:67], v[170:171] neg_lo:[0,0,1] neg_hi:[0,0,1]
  v_pk_fma_f32 v[168:169], v[164:165], v[66:67], v[168:169]
  v_cvt_pk_f16_f32 v135, v170, v171
  v_cvt_pk_f16_f32 v133, v168, v169
  v_pk_fma_f32 v[156:157], v[180:181], s[56:57], v[16:17] op_sel:[0,0,0] op_sel_hi:[1,0,0]
  v_pk_fma_f32 v[158:159], v[196:197], s[56:57], v[16:17] op_sel:[0,0,1] op_sel_hi:[1,0,1]
  v_pk_fma_f32 v[156:157], v[228:229], s[56:57], v[156:157] op_sel:[0,1,0] op_sel_hi:[1,1,1]
  v_pk_fma_f32 v[158:159], v[212:213], s[56:57], v[158:159] op_sel:[0,1,0] op_sel_hi:[1,1,1] neg_lo:[1,0,0] neg_hi:[1,0,0]
  v_pk_mul_f32 v[162:163], v[156:157], v[84:85]
  v_pk_mul_f32 v[160:161], v[158:159], v[84:85]
  v_pk_fma_f32 v[162:163], v[158:159], v[68:69], v[162:163] neg_lo:[0,0,1] neg_hi:[0,0,1]
  v_pk_fma_f32 v[160:161], v[156:157], v[68:69], v[160:161]
  v_cvt_pk_f16_f32 v138, v162, v163
  v_cvt_pk_f16_f32 v136, v160, v161
  v_mfma_f32_32x32x16_f16 v[112:127], v[132:135], v[96:99], 0
  v_pk_fma_f32 v[164:165], v[182:183], s[56:57], v[16:17] op_sel:[0,0,0] op_sel_hi:[1,0,0]
  v_pk_fma_f32 v[166:167], v[198:199], s[56:57], v[16:17] op_sel:[0,0,1] op_sel_hi:[1,0,1]
  v_pk_fma_f32 v[164:165], v[230:231], s[56:57], v[164:165] op_sel:[0,1,0] op_sel_hi:[1,1,1]
  v_pk_fma_f32 v[166:167], v[214:215], s[56:57], v[166:167] op_sel:[0,1,0] op_sel_hi:[1,1,1] neg_lo:[1,0,0] neg_hi:[1,0,0]
  v_pk_mul_f32 v[170:171], v[164:165], v[86:87]
  v_pk_mul_f32 v[168:169], v[166:167], v[86:87]
  v_pk_fma_f32 v[170:171], v[166:167], v[70:71], v[170:171] neg_lo:[0,0,1] neg_hi:[0,0,1]
  v_pk_fma_f32 v[168:169], v[164:165], v[70:71], v[168:169]
  v_cvt_pk_f16_f32 v139, v170, v171
  v_cvt_pk_f16_f32 v137, v168, v169
  v_pk_fma_f32 v[156:157], v[184:185], s[56:57], v[16:17] op_sel:[0,0,0] op_sel_hi:[1,0,0]
  v_pk_fma_f32 v[158:159], v[200:201], s[56:57], v[16:17] op_sel:[0,0,1] op_sel_hi:[1,0,1]
  v_pk_fma_f32 v[156:157], v[232:233], s[56:57], v[156:157] op_sel:[0,1,0] op_sel_hi:[1,1,1]
  v_pk_fma_f32 v[158:159], v[216:217], s[56:57], v[158:159] op_sel:[0,1,0] op_sel_hi:[1,1,1] neg_lo:[1,0,0] neg_hi:[1,0,0]
  v_pk_mul_f32 v[162:163], v[156:157], v[88:89]
  v_pk_mul_f32 v[160:161], v[158:159], v[88:89]
  v_pk_fma_f32 v[162:163], v[158:159], v[72:73], v[162:163] neg_lo:[0,0,1] neg_hi:[0,0,1]
  v_pk_fma_f32 v[160:161], v[156:157], v[72:73], v[160:161]
  v_cvt_pk_f16_f32 v142, v162, v163
  v_cvt_pk_f16_f32 v140, v160, v161
  v_mfma_f32_32x32x16_f16 v[112:127], v[136:139], v[100:103], v[112:127]
  v_pk_fma_f32 v[164:165], v[186:187], s[56:57], v[16:17] op_sel:[0,0,0] op_sel_hi:[1,0,0]
  v_pk_fma_f32 v[166:167], v[202:203], s[56:57], v[16:17] op_sel:[0,0,1] op_sel_hi:[1,0,1]
  v_pk_fma_f32 v[164:165], v[234:235], s[56:57], v[164:165] op_sel:[0,1,0] op_sel_hi:[1,1,1]
  v_pk_fma_f32 v[166:167], v[218:219], s[56:57], v[166:167] op_sel:[0,1,0] op_sel_hi:[1,1,1] neg_lo:[1,0,0] neg_hi:[1,0,0]
  v_pk_mul_f32 v[170:171], v[164:165], v[90:91]
  v_pk_mul_f32 v[168:169], v[166:167], v[90:91]
  v_pk_fma_f32 v[170:171], v[166:167], v[74:75], v[170:171] neg_lo:[0,0,1] neg_hi:[0,0,1]
  v_pk_fma_f32 v[168:169], v[164:165], v[74:75], v[168:169]
  v_cvt_pk_f16_f32 v143, v170, v171
  v_cvt_pk_f16_f32 v141, v168, v169
  v_pk_fma_f32 v[156:157], v[188:189], s[56:57], v[16:17] op_sel:[0,0,0] op_sel_hi:[1,0,0]
  v_pk_fma_f32 v[158:159], v[204:205], s[56:57], v[16:17] op_sel:[0,0,1] op_sel_hi:[1,0,1]
  v_pk_fma_f32 v[156:157], v[236:237], s[56:57], v[156:157] op_sel:[0,1,0] op_sel_hi:[1,1,1]
  v_pk_fma_f32 v[158:159], v[220:221], s[56:57], v[158:159] op_sel:[0,1,0] op_sel_hi:[1,1,1] neg_lo:[1,0,0] neg_hi:[1,0,0]
  v_pk_mul_f32 v[162:163], v[156:157], v[92:93]
  v_pk_mul_f32 v[160:161], v[158:159], v[92:93]
  v_pk_fma_f32 v[162:163], v[158:159], v[76:77], v[162:163] neg_lo:[0,0,1] neg_hi:[0,0,1]
  v_pk_fma_f32 v[160:161], v[156:157], v[76:77], v[160:161]
  v_cvt_pk_f16_f32 v146, v162, v163
  v_cvt_pk_f16_f32 v144, v160, v161
  v_mfma_f32_32x32x16_f16 v[112:127], v[140:143], v[104:107], v[112:127]
  v_pk_fma_f32 v[164:165], v[190:191], s[56:57], v[16:17] op_sel:[0,0,0] op_sel_hi:[1,0,0]
  v_pk_fma_f32 v[166:167], v[206:207], s[56:57], v[16:17] op_sel:[0,0,1] op_sel_hi:[1,0,1]
  v_pk_fma_f32 v[164:165], v[238:239], s[56:57], v[164:165] op_sel:[0,1,0] op_sel_hi:[1,1,1]
  v_pk_fma_f32 v[166:167], v[222:223], s[56:57], v[166:167] op_sel:[0,1,0] op_sel_hi:[1,1,1] neg_lo:[1,0,0] neg_hi:[1,0,0]
  v_pk_mul_f32 v[170:171], v[164:165], v[94:95]
  v_pk_mul_f32 v[168:169], v[166:167], v[94:95]
  v_pk_fma_f32 v[170:171], v[166:167], v[78:79], v[170:171] neg_lo:[0,0,1] neg_hi:[0,0,1]
  v_pk_fma_f32 v[168:169], v[164:165], v[78:79], v[168:169]
  v_cvt_pk_f16_f32 v147, v170, v171
  v_cvt_pk_f16_f32 v145, v168, v169
  s_nop 1
  v_mfma_f32_32x32x16_f16 v[112:127], v[144:147], v[108:111], v[112:127]
  s_nop 11
  v_cvt_pk_f16_f32 v148, v112, v113
  v_cvt_pk_f16_f32 v149, v114, v115
  v_cvt_pk_f16_f32 v150, v116, v117
  v_cvt_pk_f16_f32 v151, v118, v119
  v_cvt_pk_f16_f32 v152, v120, v121
  v_cvt_pk_f16_f32 v153, v122, v123
  v_cvt_pk_f16_f32 v154, v124, v125
  v_cvt_pk_f16_f32 v155, v126, v127
  ds_write_b128 v6, v[148:151]
  ds_write_b128 v7, v[152:155]
  ds_write_b16_d16_hi v8, v151 offset:14
  ds_write_b16_d16_hi v9, v155 offset:14
  s_cmp_lg_u32 s62, 0
  s_cbranch_scc1 L_jobx
  s_mov_b32 s62, 1
  s_mov_b32 s56, 0
  s_mov_b32 s58, 0
  s_mov_b32 s57, s60
  s_mov_b32 s59, s61
  v_subrev_u32 v6, 2176, v6
  v_subrev_u32 v7, 2176, v7
  v_subrev_u32 v8, 2176, v8
  v_subrev_u32 v9, 2176, v9
  s_branch L_job
L_jobx:
  s_lshl_b32 s37, s2, 14
  s_lshl_b32 s38, s3, 8
  s_add_u32 s37, s37, s38
  s_add_u32 s37, s37, 1048576
  s_waitcnt lgkmcnt(0)
  s_barrier
  ds_read_b64_tr_b16 v[132:133], v10 offset:0
  ds_read_b64_tr_b16 v[134:135], v10 offset:4352
  ds_read_b64_tr_b16 v[136:137], v10 offset:8
  ds_read_b64_tr_b16 v[138:139], v10 offset:4360
  ds_read_b64_tr_b16 v[140:141], v10 offset:256
  ds_read_b64_tr_b16 v[142:143], v10 offset:4608
  ds_read_b64_tr_b16 v[144:145], v10 offset:264
  ds_read_b64_tr_b16 v[146:147], v10 offset:4616
  s_waitcnt lgkmcnt(6)
  v_mfma_f32_16x16x32_f16 v[156:159], v[128:131], v[132:135], 0
  s_waitcnt lgkmcnt(4)
  v_mfma_f32_16x16x32_f16 v[160:163], v[128:131], v[136:139], 0
  s_waitcnt lgkmcnt(2)
  v_mfma_f32_16x16x32_f16 v[164:167], v[128:131], v[140:143], 0
  s_waitcnt lgkmcnt(0)
  v_mfma_f32_16x16x32_f16 v[168:171], v[128:131], v[144:147], 0
  s_nop 3
  v_cvt_pk_f16_f32 v148, v156, v160
  s_nop 2
  v_cvt_pk_f16_f32 v149, v164, v168
  v_cvt_pk_f16_f32 v150, v157, v161
  v_cvt_pk_f16_f32 v151, v165, v169
  v_add_u32 v148, 0x20002, v148
  v_add_u32 v149, 0x20002, v149
  v_add_u32 v150, 0x20002, v150
  v_add_u32 v151, 0x20002, v151
  v_and_or_b32 v148, v148, v13, s25
  v_and_or_b32 v149, v149, v13, s26
  v_and_or_b32 v150, v150, v13, s27
  v_and_or_b32 v151, v151, v13, s28
  buffer_store_dwordx4 v[148:151], v12, s[8:11], s37 offen offset:0 sc1
  v_cvt_pk_f16_f32 v152, v158, v162
  v_cvt_pk_f16_f32 v153, v166, v170
  v_cvt_pk_f16_f32 v154, v159, v163
  v_cvt_pk_f16_f32 v155, v167, v171
  v_add_u32 v152, 0x20002, v152
  v_add_u32 v153, 0x20002, v153
  v_add_u32 v154, 0x20002, v154
  v_add_u32 v155, 0x20002, v155
  v_and_or_b32 v152, v152, v13, s25
  v_and_or_b32 v153, v153, v13, s26
  v_and_or_b32 v154, v154, v13, s27
  v_and_or_b32 v155, v155, v13, s28
  buffer_store_dwordx4 v[152:155], v12, s[8:11], s37 offen offset:2048 sc1
  s_cmp_lg_u32 s3, 6
  s_cbranch_scc1 L_noext
  ds_read_u16 v176, v30 offset:0
  ds_read_u16 v177, v31 offset:0
  ds_read_u16 v178, v30 offset:2176
  ds_read_u16 v179, v31 offset:2176
  ds_read_u16 v180, v30 offset:4352
  ds_read_u16 v181, v31 offset:4352
  ds_read_u16 v182, v30 offset:6528
  ds_read_u16 v183, v31 offset:6528
  v_lshrrev_b32 v16, 4, v1
  v_and_b32 v17, 15, v1
  v_lshlrev_b32 v16, 14, v16
  v_lshl_add_u32 v16, v17, 10, v16
  s_lshl_b32 s37, s2, 3
  s_add_u32 s37, s37, 65536
  s_add_u32 s38, s37, 8192
  v_mov_b32 v193, s24
  v_mov_b32 v195, s24
  s_waitcnt lgkmcnt(0)
  v_lshl_or_b32 v184, v177, 16, v176
  v_lshl_or_b32 v185, v179, 16, v178
  v_lshl_or_b32 v186, v181, 16, v180
  v_lshl_or_b32 v187, v183, 16, v182
  s_nop 1
  v_mfma_f32_16x16x32_f16 v[188:191], v[128:131], v[184:187], 0
  s_nop 7
  v_cvt_pk_f16_f32 v192, v188, v189
  v_cvt_pk_f16_f32 v194, v190, v191
  s_mov_b32 exec_lo, 0xff00ff
  s_mov_b32 exec_hi, 0xff00ff
  buffer_store_dwordx2 v[192:193], v16, s[8:11], s37 offen sc1
  buffer_store_dwordx2 v[194:195], v16, s[8:11], s38 offen sc1
  s_mov_b64 exec, -1
L_noext:
  s_cmp_ge_u32 s2, 112
  s_cbranch_scc1 Lwd_1
  s_and_b32 s37, s3, 1
  s_lshl_b32 s37, s37, 2
  s_lshr_b32 s38, s3, 1
  s_add_u32 s37, s37, s38
  s_mul_i32 s37, s37, 8320
  s_add_u32 m0, s37, 72960
  s_lshl_b32 s37, s2, 3
  s_add_u32 s37, s37, s3
  s_lshl_b32 s37, s37, 13
  buffer_load_dwordx4 v2, s[20:23], s37 offen lds
  buffer_load_dwordx4 v2, s[20:23], s37 offen offset:1024 lds
  s_add_u32 m0, m0, 2080
  s_add_u32 s37, s37, 2048
  buffer_load_dwordx4 v2, s[20:23], s37 offen lds
  buffer_load_dwordx4 v2, s[20:23], s37 offen offset:1024 lds
  s_add_u32 m0, m0, 2080
  s_add_u32 s37, s37, 2048
  buffer_load_dwordx4 v2, s[20:23], s37 offen lds
  buffer_load_dwordx4 v2, s[20:23], s37 offen offset:1024 lds
  s_add_u32 m0, m0, 2080
  s_add_u32 s37, s37, 2048
  buffer_load_dwordx4 v2, s[20:23], s37 offen lds
  buffer_load_dwordx4 v2, s[20:23], s37 offen offset:1024 lds
Lwd_1:
  buffer_load_dwordx4 v[240:243], v172, s[4:7], 0 offen
  buffer_load_dwordx4 v[244:247], v173, s[4:7], 0 offen
  buffer_load_dwordx4 v[248:251], v174, s[4:7], 0 offen
  buffer_load_dwordx4 v[252:255], v175, s[4:7], 0 offen
  v_bfe_u32 v16, v172, 11, 4
  v_lshrrev_b32 v17, 15, v172
  v_lshlrev_b32 v17, 3, v17
  v_lshl_add_u32 v20, v16, 10, v17
  v_bfe_u32 v16, v173, 11, 4
  v_lshrrev_b32 v17, 15, v173
  v_lshlrev_b32 v17, 3, v17
  v_lshl_add_u32 v21, v16, 10, v17
  v_bfe_u32 v16, v174, 11, 4
  v_lshrrev_b32 v17, 15, v174
  v_lshlrev_b32 v17, 3, v17
  v_lshl_add_u32 v22, v16, 10, v17
  v_bfe_u32 v16, v175, 11, 4
  v_lshrrev_b32 v17, 15, v175
  v_lshlrev_b32 v17, 3, v17
  v_lshl_add_u32 v23, v16, 10, v17
  s_mov_b32 s44, 8192
  s_mov_b32 s45, 4096
  buffer_load_dwordx2 v[112:113], v20, s[8:11], s44 offen sc1
  buffer_load_dwordx2 v[114:115], v21, s[8:11], s44 offen sc1
  buffer_load_dwordx2 v[116:117], v22, s[8:11], s44 offen sc1
  buffer_load_dwordx2 v[118:119], v23, s[8:11], s44 offen sc1
  v_lshrrev_b32 v16, 4, v0
  v_and_b32 v17, 15, v0
  v_lshlrev_b32 v17, 4, v17
  v_lshl_add_u32 v4, v16, 14, v17
  v_sub_u32 v18, 96, v16
  v_lshl_add_u32 v6, v18, 14, v17
  v_add_u32 v18, 32, v18
  v_cmp_eq_u32 vcc, 0, v16
  v_and_b32 v19, 1, v16
  v_lshlrev_b32 v19, 6, v19
  v_cndmask_b32 v18, v18, 64, vcc
  v_lshl_add_u32 v5, v18, 14, v17
  v_xor_b32 v17, v17, v19
  v_lshl_add_u32 v7, v16, 8, v17
  s_lshl_b32 s48, s40, 11
  s_lshl_b32 s49, s42, 8
  s_add_u32 s48, s48, s49
  s_add_u32 s48, s48, 1048576
  s_add_u32 s49, s48, 524288
  s_cmp_eq_u32 s41, 0
  s_mov_b32 s50, 0xbc00bc00
  s_cmov_b32 s50, 0x3c003c00
  s_lshr_b32 s51, s3, 2
  s_and_b32 s52, s3, 3
  v_and_b32 v16, 1, v1
  v_bfe_u32 v17, v1, 1, 1
  v_bfe_u32 v18, v1, 4, 1
  v_lshl_add_u32 v16, v16, 3, v17
  v_lshl_add_u32 v16, v18, 1, v16
  s_lshl_b32 s37, s51, 2
  v_add_lshl_u32 v16, v16, s37, 4
  v_bfe_u32 v17, v1, 2, 1
  v_lshl_add_u32 v16, v17, 3, v16
  v_bfe_u32 v17, v1, 3, 1
  v_lshlrev_b32 v18, 6, v17
  v_xor_b32 v16, v16, v18
  v_lshrrev_b32 v18, 5, v1
  v_lshl_add_u32 v17, v18, 2, v17
  v_lshl_add_u32 v8, v17, 8, v16
  v_lshlrev_b32 v13, 4, v18
  v_lshl_add_u32 v16, v18, 1, s51
  v_lshlrev_b32 v16, 1, v16
  v_and_b32 v17, 7, v1
  v_xor_b32 v16, v16, v17
  v_and_b32 v18, 31, v1
  s_lshl_b32 s37, s52, 5
  v_add_lshl_u32 v18, v18, s37, 7
  v_lshl_add_u32 v9, v16, 4, v18
  v_lshrrev_b32 v16, 3, v0
  v_and_b32 v18, 7, v16
  v_xor_b32 v19, v17, v18
  v_lshlrev_b32 v19, 4, v19
  v_lshl_add_u32 v10, v16, 7, v19
  v_add_u32 v19, 1, v17
  v_xor_b32 v19, v19, v18
  v_lshlrev_b32 v19, 4, v19
  v_lshl_add_u32 v19, v16, 7, v19
  v_add_u32 v19, 16896, v19
  v_cmp_eq_u32 vcc, 7, v17
  v_lshlrev_b32 v16, 1, v16
  v_add_u32 v16, 16640, v16
  v_add_u32 v18, 128, v16
  v_add_u32 v17, 8192, v19
  v_cndmask_b32 v11, v19, v16, vcc
  v_cndmask_b32 v14, v17, v18, vcc
  v_mov_b32 v12, 0x40000000
  s_mov_b32 s63, 0
  s_waitcnt vmcnt(0)
  s_branch P_2_c
P_2:
  buffer_load_dwordx2 v[112:113], v20, s[8:11], s44 offen sc1
  buffer_load_dwordx2 v[114:115], v21, s[8:11], s44 offen sc1
  buffer_load_dwordx2 v[116:117], v22, s[8:11], s44 offen sc1
  buffer_load_dwordx2 v[118:119], v23, s[8:11], s44 offen sc1
  s_waitcnt vmcnt(0)
P_2_c:
  v_xor_b32 v113, s24, v113
  v_xor_b32 v115, s24, v115
  v_xor_b32 v117, s24, v117
  v_xor_b32 v119, s24, v119
  v_or3_b32 v16, v113, v115, v117
  v_or_b32 v16, v16, v119
  v_cmp_ne_u32 vcc, 0, v16
  s_cbranch_vccz P_2_x
  s_add_u32 s63, s63, 1
  s_cmp_lt_u32 s63, 65536
  s_cbranch_scc1 P_2
P_2_x:
  v_and_b32 v16, 0xffff0000, v112
  v_rcp_f32 v16, v16
  v_lshlrev_b32 v17, 16, v112
  v_mul_f32 v17, v17, v16
  v_add_f32 v16, 1.0, v16
  v_lshlrev_b32 v64, 16, v240
  v_and_b32 v65, 0xffff0000, v240
  v_pk_fma_f32 v[64:65], v[64:65], v[16:17], v[16:17] op_sel:[0,0,1] op_sel_hi:[1,0,1] neg_lo:[0,0,1] neg_hi:[0,0,1]
  v_lshlrev_b32 v66, 16, v241
  v_and_b32 v67, 0xffff0000, v241
  v_pk_fma_f32 v[66:67], v[66:67], v[16:17], v[16:17] op_sel:[0,0,1] op_sel_hi:[1,0,1] neg_lo:[0,0,1] neg_hi:[0,0,1]
  v_lshlrev_b32 v68, 16, v242
  v_and_b32 v69, 0xffff0000, v242
  v_pk_fma_f32 v[68:69], v[68:69], v[16:17], v[16:17] op_sel:[0,0,1] op_sel_hi:[1,0,1] neg_lo:[0,0,1] neg_hi:[0,0,1]
  v_lshlrev_b32 v70, 16, v243
  v_and_b32 v71, 0xffff0000, v243
  v_pk_fma_f32 v[70:71], v[70:71], v[16:17], v[16:17] op_sel:[0,0,1] op_sel_hi:[1,0,1] neg_lo:[0,0,1] neg_hi:[0,0,1]
  v_and_b32 v16, 0xffff0000, v114
  v_rcp_f32 v16, v16
  v_lshlrev_b32 v17, 16, v114
  v_mul_f32 v17, v17, v16
  v_add_f32 v16, 1.0, v16
  v_lshlrev_b32 v72, 16, v244
  v_and_b32 v73, 0xffff0000, v244
  v_pk_fma_f32 v[72:73], v[72:73], v[16:17], v[16:17] op_sel:[0,0,1] op_sel_hi:[1,0,1] neg_lo:[0,0,1] neg_hi:[0,0,1]
  v_lshlrev_b32 v74, 16, v245
  v_and_b32 v75, 0xffff0000, v245
  v_pk_fma_f32 v[74:75], v[74:75], v[16:17], v[16:17] op_sel:[0,0,1] op_sel_hi:[1,0,1] neg_lo:[0,0,1] neg_hi:[0,0,1]
  v_lshlrev_b32 v76, 16, v246
  v_and_b32 v77, 0xffff0000, v246
  v_pk_fma_f32 v[76:77], v[76:77], v[16:17], v[16:17] op_sel:[0,0,1] op_sel_hi:[1,0,1] neg_lo:[0,0,1] neg_hi:[0,0,1]
  v_lshlrev_b32 v78, 16, v247
  v_and_b32 v79, 0xffff0000, v247
  v_pk_fma_f32 v[78:79], v[78:79], v[16:17], v[16:17] op_sel:[0,0,1] op_sel_hi:[1,0,1] neg_lo:[0,0,1] neg_hi:[0,0,1]
  v_and_b32 v16, 0xffff0000, v116
  v_rcp_f32 v16, v16
  v_lshlrev_b32 v17, 16, v116
  v_mul_f32 v17, v17, v16
  v_add_f32 v16, 1.0, v16
  v_lshlrev_b32 v80, 16, v248
  v_and_b32 v81, 0xffff0000, v248
  v_pk_fma_f32 v[80:81], v[80:81], v[16:17], v[16:17] op_sel:[0,0,1] op_sel_hi:[1,0,1] neg_lo:[0,0,1] neg_hi:[0,0,1]
  v_lshlrev_b32 v82, 16, v249
  v_and_b32 v83, 0xffff0000, v249
  v_pk_fma_f32 v[82:83], v[82:83], v[16:17], v[16:17] op_sel:[0,0,1] op_sel_hi:[1,0,1] neg_lo:[0,0,1] neg_hi:[0,0,1]
  v_lshlrev_b32 v84, 16, v250
  v_and_b32 v85, 0xffff0000, v250
  v_pk_fma_f32 v[84:85], v[84:85], v[16:17], v[16:17] op_sel:[0,0,1] op_sel_hi:[1,0,1] neg_lo:[0,0,1] neg_hi:[0,0,1]
  v_lshlrev_b32 v86, 16, v251
  v_and_b32 v87, 0xffff0000, v251
  v_pk_fma_f32 v[86:87], v[86:87], v[16:17], v[16:17] op_sel:[0,0,1] op_sel_hi:[1,0,1] neg_lo:[0,0,1] neg_hi:[0,0,1]
  v_and_b32 v16, 0xffff0000, v118
  v_rcp_f32 v16, v16
  v_lshlrev_b32 v17, 16, v118
  v_mul_f32 v17, v17, v16
  v_add_f32 v16, 1.0, v16
  v_lshlrev_b32 v88, 16, v252
  v_and_b32 v89, 0xffff0000, v252
  v_pk_fma_f32 v[88:89], v[88:89], v[16:17], v[16:17] op_sel:[0,0,1] op_sel_hi:[1,0,1] neg_lo:[0,0,1] neg_hi:[0,0,1]
  v_lshlrev_b32 v90, 16, v253
  v_and_b32 v91, 0xffff0000, v253
  v_pk_fma_f32 v[90:91], v[90:91], v[16:17], v[16:17] op_sel:[0,0,1] op_sel_hi:[1,0,1] neg_lo:[0,0,1] neg_hi:[0,0,1]
  v_lshlrev_b32 v92, 16, v254
  v_and_b32 v93, 0xffff0000, v254
  v_pk_fma_f32 v[92:93], v[92:93], v[16:17], v[16:17] op_sel:[0,0,1] op_sel_hi:[1,0,1] neg_lo:[0,0,1] neg_hi:[0,0,1]
  v_lshlrev_b32 v94, 16, v255
  v_and_b32 v95, 0xffff0000, v255
  v_pk_fma_f32 v[94:95], v[94:95], v[16:17], v[16:17] op_sel:[0,0,1] op_sel_hi:[1,0,1] neg_lo:[0,0,1] neg_hi:[0,0,1]
  s_cmp_lg_u32 s3, 7
  s_cbranch_scc1 L_y1
  s_mov_b32 s63, 0
P_3:
  buffer_load_dwordx4 v[120:123], v2, s[8:11], s45 offen sc1
  buffer_load_dwordx4 v[124:127], v2, s[8:11], s45 offen offset:1024 sc1
  s_waitcnt vmcnt(0)
P_3_c:
  v_xor_b32 v122, s24, v122
  v_xor_b32 v126, s24, v126
  v_or_b32 v123, v122, v126
  v_cmp_ne_u32 vcc, 0, v123
  s_cbranch_vccz P_3_x
  s_add_u32 s63, s63, 1
  s_cmp_lt_u32 s63, 65536
  s_cbranch_scc1 P_3
P_3_x:
  v_max_u32 v122, v120, v124
  v_min_u32 v126, v120, v124
  v_max3_u32 v123, v126, v121, v125
  s_nop 0
  v_min_u32_dpp v126, v122, v122 row_ror:8 row_mask:0xf bank_mask:0xf
  v_max_u32_dpp v123, v123, v123 row_ror:8 row_mask:0xf bank_mask:0xf
  v_max_u32_dpp v122, v122, v122 row_ror:8 row_mask:0xf bank_mask:0xf
  v_max_u32 v123, v123, v126
  s_nop 0
  v_min_u32_dpp v126, v122, v122 row_ror:4 row_mask:0xf bank_mask:0xf
  v_max_u32_dpp v123, v123, v123 row_ror:4 row_mask:0xf bank_mask:0xf
  v_max_u32_dpp v122, v122, v122 row_ror:4 row_mask:0xf bank_mask:0xf
  v_max_u32 v123, v123, v126
  s_nop 0
  v_min_u32_dpp v126, v122, v122 row_ror:2 row_mask:0xf bank_mask:0xf
  v_max_u32_dpp v123, v123, v123 row_ror:2 row_mask:0xf bank_mask:0xf
  v_max_u32_dpp v122, v122, v122 row_ror:2 row_mask:0xf bank_mask:0xf
  v_max_u32 v123, v123, v126
  s_nop 0
  v_min_u32_dpp v126, v122, v122 row_ror:1 row_mask:0xf bank_mask:0xf
  v_max_u32_dpp v123, v123, v123 row_ror:1 row_mask:0xf bank_mask:0xf
  v_max_u32_dpp v122, v122, v122 row_ror:1 row_mask:0xf bank_mask:0xf
  v_max_u32 v123, v123, v126
  s_nop 0
  v_min_u32_dpp v126, v122, v122 row_bcast:15 row_mask:0xa bank_mask:0xf
  v_max_u32_dpp v123, v123, v123 row_bcast:15 row_mask:0xa bank_mask:0xf
  v_max_u32_dpp v122, v122, v122 row_bcast:15 row_mask:0xa bank_mask:0xf
  v_max_u32 v123, v123, v126
  s_nop 0
  v_min_u32_dpp v126, v122, v122 row_bcast:31 row_mask:0xc bank_mask:0xf
  v_max_u32_dpp v123, v123, v123 row_bcast:31 row_mask:0xc bank_mask:0xf
  v_max_u32_dpp v122, v122, v122 row_bcast:31 row_mask:0xc bank_mask:0xf
  v_max_u32 v123, v123, v126
  v_readlane_b32 s46, v122, 63
  v_readlane_b32 s47, v123, 63
  s_nop 0
  v_mov_b32 v16, s46
  v_mov_b32 v17, s47
  v_mov_b32 v18, 0
  ds_write_b64 v18, v[16:17] offset:53312
L_y1:
  s_cmp_lg_u32 s3, 6
  s_cbranch_scc1 L_y2
  v_lshlrev_b32 v18, 3, v1
  v_sub_u32 v19, 1024, v18
  v_mov_b32 v20, 512
  v_cmp_eq_u32 vcc, 0, v1
  s_lshl_b32 s37, s40, 13
  s_lshl_b32 s38, s42, 10
  s_add_u32 s37, s37, s38
  s_add_u32 s37, s37, 65536
  v_cndmask_b32 v19, v19, v20, vcc
  s_mov_b32 s63, 0
P_4:
  buffer_load_dwordx2 v[120:121], v18, s[8:11], s37 offen sc1
  buffer_load_dwordx2 v[122:123], v19, s[8:11], s37 offen sc1
  s_waitcnt vmcnt(0)
P_4_c:
  v_xor_b32 v121, s24, v121
  v_xor_b32 v123, s24, v123
  v_or_b32 v16, v121, v123
  v_cmp_ne_u32 vcc, 0, v16
  s_cbranch_vccz P_4_x
  s_add_u32 s63, s63, 1
  s_cmp_lt_u32 s63, 65536
  s_cbranch_scc1 P_4
P_4_x:
  s_cmp_eq_u32 s41, 0
  s_mov_b32 s38, 0x07060100
  s_cmov_b32 s38, 0x05040100
  v_lshrrev_b32 v17, 16, v120
  v_perm_b32 v16, v122, v120, s38
  s_mov_b64 exec, 1
  v_mov_b32 v120, v16
  v_mov_b32 v122, v17
  s_mov_b64 exec, -1
  v_lshrrev_b32 v18, 1, v18
  v_pk_fma_f16 v120, v122, s50, v120 neg_hi:[0,1,0]
  ds_write_b32 v18, v120 offset:16384
L_y2:
  s_mov_b32 s63, 0
P_5:
  buffer_load_dwordx4 v[96:99], v4, s[8:11], s48 offen sc1
  buffer_load_dwordx4 v[100:103], v5, s[8:11], s48 offen sc1
  buffer_load_dwordx4 v[104:107], v4, s[8:11], s49 offen sc1
  buffer_load_dwordx4 v[108:111], v6, s[8:11], s48 offen sc1
  s_waitcnt vmcnt(0)
P_5_c:
  v_xor_b32 v96, s25, v96
  v_xor_b32 v97, s26, v97
  v_xor_b32 v98, s27, v98
  v_xor_b32 v99, s28, v99
  v_xor_b32 v100, s25, v100
  v_xor_b32 v101, s26, v101
  v_xor_b32 v102, s27, v102
  v_xor_b32 v103, s28, v103
  v_xor_b32 v104, s25, v104
  v_xor_b32 v105, s26, v105
  v_xor_b32 v106, s27, v106
  v_xor_b32 v107, s28, v107
  v_xor_b32 v108, s25, v108
  v_xor_b32 v109, s26, v109
  v_xor_b32 v110, s27, v110
  v_xor_b32 v111, s28, v111
  v_or3_b32 v16, v96, v97, v98
  v_or3_b32 v16, v16, v99, v100
  v_or3_b32 v16, v16, v101, v102
  v_or3_b32 v16, v16, v103, v104
  v_or3_b32 v16, v16, v105, v106
  v_or3_b32 v16, v16, v107, v108
  v_or3_b32 v16, v16, v109, v110
  v_or_b32 v16, v16, v111
  v_and_b32 v16, 0x30003, v16
  v_cmp_ne_u32 vcc, 0, v16
  s_cbranch_vccz P_5_x
  s_add_u32 s63, s63, 1
  s_cmp_lt_u32 s63, 65536
  s_cbranch_scc1 P_5
P_5_x:
  s_cmp_lg_u32 s3, 0
  s_cbranch_scc1 L_y3
  s_cmp_eq_u32 s41, 0
  s_cselect_b64 vcc, 0, -1
  s_mov_b32 exec_lo, 0xffff
  s_mov_b32 exec_hi, 0x0
  v_cndmask_b32 v16, v100, v102, vcc
  v_cndmask_b32 v17, v101, v103, vcc
  v_mov_b32 v100, v98
  v_mov_b32 v101, v99
  v_mov_b32 v98, v16
  v_mov_b32 v99, v17
  v_mov_b32 v102, 0
  v_mov_b32 v103, 0
  s_mov_b64 exec, -1
L_y3:
  v_pk_fma_f16 v96, v100, s50, v96
  v_pk_fma_f16 v97, v101, s50, v97
  v_pk_fma_f16 v98, v102, s50, v98 neg_lo:[0,1,0] neg_hi:[0,1,0]
  v_pk_fma_f16 v99, v103, s50, v99 neg_lo:[0,1,0] neg_hi:[0,1,0]
  ds_write_b128 v7, v[96:99] offset:0
  v_pk_fma_f16 v104, v108, s50, v104
  v_pk_fma_f16 v105, v109, s50, v105
  v_pk_fma_f16 v106, v110, s50, v106 neg_lo:[0,1,0] neg_hi:[0,1,0]
  v_pk_fma_f16 v107, v111, s50, v107 neg_lo:[0,1,0] neg_hi:[0,1,0]
  ds_write_b128 v7, v[104:107] offset:8192
  v_mov_b32 v18, 0
  v_mov_b32 v19, 0
  s_waitcnt lgkmcnt(0)
  s_barrier
  ds_read_b64 v[16:17], v18 offset:53312
  s_cmp_lg_u32 s51, 0
  s_cbranch_scc1 L_y4
  ds_read_b64_tr_b16 v[132:133], v8 offset:0
  ds_read_b64_tr_b16 v[134:135], v8 offset:512
  ds_read_b64_tr_b16 v[136:137], v8 offset:2048
  ds_read_b64_tr_b16 v[138:139], v8 offset:2560
  ds_read_b64_tr_b16 v[140:141], v8 offset:4096
  ds_read_b64_tr_b16 v[142:143], v8 offset:4608
  ds_read_b64_tr_b16 v[144:145], v8 offset:6144
  ds_read_b64_tr_b16 v[146:147], v8 offset:6656
  ds_read_b64_tr_b16 v[148:149], v8 offset:8192
  ds_read_b64_tr_b16 v[150:151], v8 offset:8704
  ds_read_b64_tr_b16 v[152:153], v8 offset:10240
  ds_read_b64_tr_b16 v[154:155], v8 offset:10752
  ds_read_b64_tr_b16 v[156:157], v8 offset:12288
  ds_read_b64_tr_b16 v[158:159], v8 offset:12800
  s_waitcnt lgkmcnt(12)
  v_mfma_f32_32x32x16_f16 v[208:223], v[132:135], v[32:35], 0
  ds_read_b64_tr_b16 v[160:161], v8 offset:14336
  ds_read_b64_tr_b16 v[162:163], v8 offset:14848
  s_waitcnt lgkmcnt(12)
  v_mfma_f32_32x32x16_f16 v[208:223], v[136:139], v[36:39], v[208:223]
  s_waitcnt lgkmcnt(10)
  v_mfma_f32_32x32x16_f16 v[208:223], v[140:143], v[40:43], v[208:223]
  s_waitcnt lgkmcnt(8)
  v_mfma_f32_32x32x16_f16 v[208:223], v[144:147], v[44:47], v[208:223]
  v_readfirstlane_b32 s46, v16
  v_readfirstlane_b32 s47, v17
  s_and_b32 s46, s46, 0xffff
  s_and_b32 s47, s47, 0xffff
  s_sub_u32 s46, 0xffff, s46
  s_sub_u32 s47, 0xffff, s47
  v_lshrrev_b32 v16, 11, v172
  v_cmp_eq_u32 s[52:53], s46, v16
  v_cmp_eq_u32 vcc, s47, v16
  s_or_b64 s[52:53], s[52:53], vcc
  v_cndmask_b32 v20, v172, v12, s[52:53]
  v_lshrrev_b32 v16, 11, v173
  v_cmp_eq_u32 s[54:55], s46, v16
  v_cmp_eq_u32 vcc, s47, v16
  s_or_b64 s[54:55], s[54:55], vcc
  v_cndmask_b32 v21, v173, v12, s[54:55]
  v_lshrrev_b32 v16, 11, v174
  v_cmp_eq_u32 s[56:57], s46, v16
  v_cmp_eq_u32 vcc, s47, v16
  s_or_b64 s[56:57], s[56:57], vcc
  v_cndmask_b32 v22, v174, v12, s[56:57]
  v_lshrrev_b32 v16, 11, v175
  v_cmp_eq_u32 s[58:59], s46, v16
  v_cmp_eq_u32 vcc, s47, v16
  s_or_b64 s[58:59], s[58:59], vcc
  v_cndmask_b32 v23, v175, v12, s[58:59]
  s_waitcnt lgkmcnt(6)
  v_mfma_f32_32x32x16_f16 v[208:223], v[148:151], v[48:51], v[208:223]
  s_waitcnt lgkmcnt(4)
  v_mfma_f32_32x32x16_f16 v[208:223], v[152:155], v[52:55], v[208:223]
  s_waitcnt lgkmcnt(2)
  v_mfma_f32_32x32x16_f16 v[208:223], v[156:159], v[56:59], v[208:223]
  s_waitcnt lgkmcnt(0)
  v_mfma_f32_32x32x16_f16 v[208:223], v[160:163], v[60:63], v[208:223]
  s_nop 11
  v_cvt_pk_f16_f32 v112, v221, v208
  v_cvt_pk_f16_f32 v113, v212, v216
  v_cvt_pk_f16_f32 v114, v220, v209
  v_cvt_pk_f16_f32 v115, v213, v217
  v_cvt_pk_f16_f32 v116, v210, v214
  v_cvt_pk_f16_f32 v117, v218, v222
  v_cvt_pk_f16_f32 v118, v211, v215
  v_cvt_pk_f16_f32 v119, v219, v223
  v_xor_b32 v16, 16, v9
  ds_write_b128 v9, v[112:115] offset:16896
  ds_write_b128 v16, v[116:119] offset:16896
  s_branch L_y5
L_y4:
  ds_read_b64_tr_b16 v[132:133], v8 offset:0
  ds_read_b64_tr_b16 v[134:135], v8 offset:512
  ds_read_b128 v[176:179], v13 offset:16384
  ds_read_b64_tr_b16 v[136:137], v8 offset:2048
  ds_read_b64_tr_b16 v[138:139], v8 offset:2560
  ds_read_b128 v[180:183], v13 offset:16416
  ds_read_b64_tr_b16 v[140:141], v8 offset:4096
  ds_read_b64_tr_b16 v[142:143], v8 offset:4608
  ds_read_b128 v[184:187], v13 offset:16448
  ds_read_b64_tr_b16 v[144:145], v8 offset:6144
  ds_read_b64_tr_b16 v[146:147], v8 offset:6656
  ds_read_b128 v[188:191], v13 offset:16480
  s_waitcnt lgkmcnt(10)
  v_mfma_f32_32x32x16_f16 v[208:223], v[132:135], v[32:35], 0
  ds_read_b64_tr_b16 v[148:149], v8 offset:8192
  ds_read_b64_tr_b16 v[150:151], v8 offset:8704
  ds_read_b128 v[192:195], v13 offset:16512
  v_readfirstlane_b32 s46, v16
  v_readfirstlane_b32 s47, v17
  s_and_b32 s46, s46, 0xffff
  s_and_b32 s47, s47, 0xffff
  s_sub_u32 s46, 0xffff, s46
  s_sub_u32 s47, 0xffff, s47
  v_lshrrev_b32 v16, 11, v172
  v_cmp_eq_u32 s[52:53], s46, v16
  v_cmp_eq_u32 vcc, s47, v16
  s_or_b64 s[52:53], s[52:53], vcc
  v_cndmask_b32 v20, v172, v12, s[52:53]
  v_lshrrev_b32 v16, 11, v173
  v_cmp_eq_u32 s[54:55], s46, v16
  v_cmp_eq_u32 vcc, s47, v16
  s_or_b64 s[54:55], s[54:55], vcc
  v_cndmask_b32 v21, v173, v12, s[54:55]
  v_lshrrev_b32 v16, 11, v174
  v_cmp_eq_u32 s[56:57], s46, v16
  v_cmp_eq_u32 vcc, s47, v16
  s_or_b64 s[56:57], s[56:57], vcc
  v_cndmask_b32 v22, v174, v12, s[56:57]
  v_lshrrev_b32 v16, 11, v175
  v_cmp_eq_u32 s[58:59], s46, v16
  v_cmp_eq_u32 vcc, s47, v16
  s_or_b64 s[58:59], s[58:59], vcc
  v_cndmask_b32 v23, v175, v12, s[58:59]
  s_waitcnt lgkmcnt(10)
  v_mfma_f32_32x32x16_f16 v[208:223], v[136:139], v[36:39], v[208:223]
  ds_read_b64_tr_b16 v[152:153], v8 offset:10240
  ds_read_b64_tr_b16 v[154:155], v8 offset:10752
  ds_read_b128 v[196:199], v13 offset:16544
  v_dot2c_f32_f16 v18, v32, v176
  v_dot2c_f32_f16 v19, v33, v177
  v_dot2c_f32_f16 v18, v34, v178
  v_dot2c_f32_f16 v19, v35, v179
  s_waitcnt lgkmcnt(10)
  v_mfma_f32_32x32x16_f16 v[208:223], v[140:143], v[40:43], v[208:223]
  ds_read_b64_tr_b16 v[156:157], v8 offset:12288
  ds_read_b64_tr_b16 v[158:159], v8 offset:12800
  ds_read_b128 v[200:203], v13 offset:16576
  v_dot2c_f32_f16 v18, v36, v180
  v_dot2c_f32_f16 v19, v37, v181
  v_dot2c_f32_f16 v18, v38, v182
  v_dot2c_f32_f16 v19, v39, v183
  s_waitcnt lgkmcnt(10)
  v_mfma_f32_32x32x16_f16 v[208:223], v[144:147], v[44:47], v[208:223]
  ds_read_b64_tr_b16 v[160:161], v8 offset:14336
  ds_read_b64_tr_b16 v[162:163], v8 offset:14848
  ds_read_b128 v[204:207], v13 offset:16608
  v_dot2c_f32_f16 v18, v40, v184
  v_dot2c_f32_f16 v19, v41, v185
  v_dot2c_f32_f16 v18, v42, v186
  v_dot2c_f32_f16 v19, v43, v187
  s_waitcnt lgkmcnt(10)
  v_mfma_f32_32x32x16_f16 v[208:223], v[148:151], v[48:51], v[208:223]
  v_dot2c_f32_f16 v18, v44, v188
  v_dot2c_f32_f16 v19, v45, v189
  v_dot2c_f32_f16 v18, v46, v190
  v_dot2c_f32_f16 v19, v47, v191
  s_waitcnt lgkmcnt(7)
  v_mfma_f32_32x32x16_f16 v[208:223], v[152:155], v[52:55], v[208:223]
  v_dot2c_f32_f16 v18, v48, v192
  v_dot2c_f32_f16 v19, v49, v193
  v_dot2c_f32_f16 v18, v50, v194
  v_dot2c_f32_f16 v19, v51, v195
  s_waitcnt lgkmcnt(4)
  v_mfma_f32_32x32x16_f16 v[208:223], v[156:159], v[56:59], v[208:223]
  v_dot2c_f32_f16 v18, v52, v196
  v_dot2c_f32_f16 v19, v53, v197
  v_dot2c_f32_f16 v18, v54, v198
  v_dot2c_f32_f16 v19, v55, v199
  s_waitcnt lgkmcnt(1)
  v_mfma_f32_32x32x16_f16 v[208:223], v[160:163], v[60:63], v[208:223]
  v_dot2c_f32_f16 v18, v56, v200
  v_dot2c_f32_f16 v19, v57, v201
  v_dot2c_f32_f16 v18, v58, v202
  v_dot2c_f32_f16 v19, v59, v203
  s_waitcnt lgkmcnt(0)
  v_dot2c_f32_f16 v18, v60, v204
  v_dot2c_f32_f16 v19, v61, v205
  v_dot2c_f32_f16 v18, v62, v206
  v_dot2c_f32_f16 v19, v63, v207
  v_and_b32 v17, 31, v1
  s_and_b32 s37, s3, 3
  s_lshl_b32 s37, s37, 5
  v_add_lshl_u32 v17, v17, s37, 1
  v_add_f32 v18, v18, v19
  v_mov_b32 v19, v18
  s_nop 1
  v_permlane32_swap_b32 v18, v19
  v_add_f32 v18, v18, v19
  v_cvt_f16_f32 v18, v18
  ds_write_b16 v17, v18 offset:16640
  v_cvt_pk_f16_f32 v112, v221, v223
  v_cvt_pk_f16_f32 v113, v219, v215
  v_cvt_pk_f16_f32 v114, v211, v222
  v_cvt_pk_f16_f32 v115, v218, v214
  v_cvt_pk_f16_f32 v116, v210, v217
  v_cvt_pk_f16_f32 v117, v213, v209
  v_cvt_pk_f16_f32 v118, v220, v216
  v_cvt_pk_f16_f32 v119, v212, v208
  v_xor_b32 v16, 16, v9
  ds_write_b128 v9, v[112:115] offset:16896
  ds_write_b128 v16, v[116:119] offset:16896
L_y5:
  s_mov_b32 s37, 0x42800000
  s_waitcnt lgkmcnt(0)
  s_barrier
  ds_read_b128 v[96:99], v10 offset:16896
  ds_read_u16 v100, v11
  ds_read_b128 v[104:107], v10 offset:25088
  ds_read_u16 v108, v14
  v_bfe_u32 v16, v1, 2, 4
  v_mul_u32_u24 v16, 2080, v16
  v_and_b32 v17, 3, v1
  s_lshl_b32 s38, s3, 8
  s_add_u32 s38, s38, 72960
  v_lshl_add_u32 v17, v17, 3, s38
  v_add_u32 v15, v16, v17
  s_waitcnt lgkmcnt(3)
  v_fma_mix_f32 v64, v96, s37, v64 op_sel:[0,0,0] op_sel_hi:[1,0,0]
  v_fma_mix_f32 v65, v96, s37, v65 op_sel:[1,0,0] op_sel_hi:[1,0,0]
  v_fma_mix_f32 v66, v97, s37, v66 op_sel:[0,0,0] op_sel_hi:[1,0,0]
  v_fma_mix_f32 v67, v97, s37, v67 op_sel:[1,0,0] op_sel_hi:[1,0,0]
  v_fma_mix_f32 v68, v98, s37, v68 op_sel:[0,0,0] op_sel_hi:[1,0,0]
  v_fma_mix_f32 v69, v98, s37, v69 op_sel:[1,0,0] op_sel_hi:[1,0,0]
  v_fma_mix_f32 v70, v99, s37, v70 op_sel:[0,0,0] op_sel_hi:[1,0,0]
  v_fma_mix_f32 v71, v99, s37, v71 op_sel:[1,0,0] op_sel_hi:[1,0,0]
  v_cvt_pk_bf16_f32 v132, v64, v65
  v_cvt_pk_bf16_f32 v133, v66, v67
  v_cvt_pk_bf16_f32 v134, v68, v69
  v_cvt_pk_bf16_f32 v135, v70, v71
  buffer_store_dwordx4 v[132:135], v20, s[12:15], 0 offen
  s_waitcnt lgkmcnt(2)
  v_fma_mix_f32 v72, v100, s37, v72 op_sel:[0,0,0] op_sel_hi:[1,0,0]
  v_fma_mix_f32 v73, v99, s37, v73 op_sel:[1,0,0] op_sel_hi:[1,0,0]
  v_fma_mix_f32 v74, v99, s37, v74 op_sel:[0,0,0] op_sel_hi:[1,0,0]
  v_fma_mix_f32 v75, v98, s37, v75 op_sel:[1,0,0] op_sel_hi:[1,0,0]
  v_fma_mix_f32 v76, v98, s37, v76 op_sel:[0,0,0] op_sel_hi:[1,0,0]
  v_fma_mix_f32 v77, v97, s37, v77 op_sel:[1,0,0] op_sel_hi:[1,0,0]
  v_fma_mix_f32 v78, v97, s37, v78 op_sel:[0,0,0] op_sel_hi:[1,0,0]
  v_fma_mix_f32 v79, v96, s37, v79 op_sel:[1,0,0] op_sel_hi:[1,0,0]
  v_cvt_pk_bf16_f32 v136, v72, v73
  v_cvt_pk_bf16_f32 v137, v74, v75
  v_cvt_pk_bf16_f32 v138, v76, v77
  v_cvt_pk_bf16_f32 v139, v78, v79
  buffer_store_dwordx4 v[136:139], v21, s[12:15], 0 offen
  s_waitcnt lgkmcnt(1)
  v_fma_mix_f32 v80, v104, s37, v80 op_sel:[0,0,0] op_sel_hi:[1,0,0]
  v_fma_mix_f32 v81, v104, s37, v81 op_sel:[1,0,0] op_sel_hi:[1,0,0]
  v_fma_mix_f32 v82, v105, s37, v82 op_sel:[0,0,0] op_sel_hi:[1,0,0]
  v_fma_mix_f32 v83, v105, s37, v83 op_sel:[1,0,0] op_sel_hi:[1,0,0]
  v_fma_mix_f32 v84, v106, s37, v84 op_sel:[0,0,0] op_sel_hi:[1,0,0]
  v_fma_mix_f32 v85, v106, s37, v85 op_sel:[1,0,0] op_sel_hi:[1,0,0]
  v_fma_mix_f32 v86, v107, s37, v86 op_sel:[0,0,0] op_sel_hi:[1,0,0]
  v_fma_mix_f32 v87, v107, s37, v87 op_sel:[1,0,0] op_sel_hi:[1,0,0]
  v_cvt_pk_bf16_f32 v140, v80, v81
  v_cvt_pk_bf16_f32 v141, v82, v83
  v_cvt_pk_bf16_f32 v142, v84, v85
  v_cvt_pk_bf16_f32 v143, v86, v87
  buffer_store_dwordx4 v[140:143], v22, s[12:15], 0 offen
  s_waitcnt lgkmcnt(0)
  v_fma_mix_f32 v88, v108, s37, v88 op_sel:[0,0,0] op_sel_hi:[1,0,0]
  v_fma_mix_f32 v89, v107, s37, v89 op_sel:[1,0,0] op_sel_hi:[1,0,0]
  v_fma_mix_f32 v90, v107, s37, v90 op_sel:[0,0,0] op_sel_hi:[1,0,0]
  v_fma_mix_f32 v91, v106, s37, v91 op_sel:[1,0,0] op_sel_hi:[1,0,0]
  v_fma_mix_f32 v92, v106, s37, v92 op_sel:[0,0,0] op_sel_hi:[1,0,0]
  v_fma_mix_f32 v93, v105, s37, v93 op_sel:[1,0,0] op_sel_hi:[1,0,0]
  v_fma_mix_f32 v94, v105, s37, v94 op_sel:[0,0,0] op_sel_hi:[1,0,0]
  v_fma_mix_f32 v95, v104, s37, v95 op_sel:[1,0,0] op_sel_hi:[1,0,0]
  v_cvt_pk_bf16_f32 v144, v88, v89
  v_cvt_pk_bf16_f32 v145, v90, v91
  v_cvt_pk_bf16_f32 v146, v92, v93
  v_cvt_pk_bf16_f32 v147, v94, v95
  buffer_store_dwordx4 v[144:147], v23, s[12:15], 0 offen
  s_cmp_lg_u64 s[52:53], 0
  s_cbranch_scc1 L_sel0
L_selx0:
  s_cmp_lg_u64 s[54:55], 0
  s_cbranch_scc1 L_sel1
L_selx1:
  s_cmp_lg_u64 s[56:57], 0
  s_cbranch_scc1 L_sel2
L_selx2:
  s_cmp_lg_u64 s[58:59], 0
  s_cbranch_scc1 L_sel3
L_selx3:
  s_cmp_ge_u32 s2, 112
  s_cbranch_scc1 L_fin
  s_mul_i32 s37, s2, 4682
  s_lshr_b32 s37, s37, 16
  s_mul_i32 s38, s37, 14
  s_sub_u32 s38, s2, s38
  s_mul_i32 s37, s37, 114688
  s_lshl_b32 s38, s38, 9
  s_add_u32 s37, s37, s38
  s_add_u32 s37, s37, 3145728
  v_lshrrev_b32 v16, 5, v0
  v_and_b32 v17, 31, v0
  v_mul_u32_u24 v16, 7168, v16
  v_lshl_add_u32 v4, v17, 4, v16
  buffer_load_dwordx4 v[24:27], v4, s[8:11], s37 offen sc1
  ds_read_b64_tr_b16 v[224:225], v15 offset:0
  ds_read_b64_tr_b16 v[226:227], v15 offset:33280
  ds_read_b64_tr_b16 v[228:229], v15 offset:32
  ds_read_b64_tr_b16 v[230:231], v15 offset:33312
  ds_read_b64_tr_b16 v[232:233], v15 offset:64
  ds_read_b64_tr_b16 v[234:235], v15 offset:33344
  ds_read_b64_tr_b16 v[236:237], v15 offset:96
  ds_read_b64_tr_b16 v[238:239], v15 offset:33376
  ds_read_b64_tr_b16 v[240:241], v15 offset:128
  ds_read_b64_tr_b16 v[242:243], v15 offset:33408
  ds_read_b64_tr_b16 v[244:245], v15 offset:160
  ds_read_b64_tr_b16 v[246:247], v15 offset:33440
  ds_read_b64_tr_b16 v[248:249], v15 offset:192
  ds_read_b64_tr_b16 v[250:251], v15 offset:33472
  ds_read_b64_tr_b16 v[252:253], v15 offset:224
  ds_read_b64_tr_b16 v[254:255], v15 offset:33504
  v_lshlrev_b32 v5, 3, v0
  v_lshlrev_b32 v6, 3, v1
  v_lshlrev_b32 v7, 1, v0
  v_and_b32 v16, 1, v1
  v_and_b32 v17, 48, v1
  v_lshl_add_u32 v16, v16, 6, v17
  s_lshl_b32 s38, s3, 7
  v_add_u32 v8, s38, v16
  v_mov_b32 v9, 0xffffff00
  s_lshl_b32 s38, s2, 13
  s_lshl_b32 s39, s3, 10
  s_add_u32 s38, s38, s39
  s_add_u32 s38, s38, 4194304
  s_mov_b32 s63, 0
  s_waitcnt vmcnt(0)
  s_branch P_6_c
P_6:
  buffer_load_dwordx4 v[24:27], v4, s[8:11], s37 offen sc1
  s_waitcnt vmcnt(0)
P_6_c:
  v_xor_b32 v24, s29, v24
  v_xor_b32 v25, s29, v25
  v_xor_b32 v26, s29, v26
  v_xor_b32 v27, s29, v27
  v_or3_b32 v16, v24, v25, v26
  v_or_b32 v16, v16, v27
  v_and_b32 v16, 0xff, v16
  v_cmp_ne_u32 vcc, 0, v16
  s_cbranch_vccz P_6_x
  s_add_u32 s63, s63, 1
  s_cmp_lt_u32 s63, 65536
  s_cbranch_scc1 P_6
P_6_x:
  v_permlane32_swap_b32 v24, v25
  v_permlane32_swap_b32 v26, v27
  v_add_f32 v24, v24, v25
  v_add_f32 v25, v26, v27
  ds_write_b64 v5, v[24:25] offset:34816
  s_waitcnt lgkmcnt(0)
  s_barrier
  ds_read_b64 v[32:33], v6 offset:34816
  ds_read_b64 v[34:35], v6 offset:35328
  ds_read_b64 v[36:37], v6 offset:35840
  ds_read_b64 v[38:39], v6 offset:36352
  ds_read_b64 v[40:41], v6 offset:36864
  ds_read_b64 v[42:43], v6 offset:37376
  ds_read_b64 v[44:45], v6 offset:37888
  ds_read_b64 v[46:47], v6 offset:38400
  s_waitcnt lgkmcnt(6)
  v_pk_add_f32 v[32:33], v[32:33], v[34:35]
  s_waitcnt lgkmcnt(4)
  v_pk_add_f32 v[36:37], v[36:37], v[38:39]
  s_waitcnt lgkmcnt(2)
  v_pk_add_f32 v[40:41], v[40:41], v[42:43]
  s_waitcnt lgkmcnt(0)
  v_pk_add_f32 v[44:45], v[44:45], v[46:47]
  v_pk_add_f32 v[32:33], v[32:33], v[36:37]
  v_pk_add_f32 v[40:41], v[40:41], v[44:45]
  v_pk_add_f32 v[32:33], v[32:33], v[40:41]
  v_cvt_pk_bf16_f32 v33, v32, v33
  v_lshlrev_b32 v32, 16, v33
  v_mul_f32 v34, 0xbfb8aa3b, v32
  v_exp_f32 v34, v34
  v_and_b32 v33, 0xffff0000, v33
  v_add_f32 v34, 1.0, v34
  v_rcp_f32 v34, v34
  s_nop 0
  v_mul_f32 v32, v32, v34
  v_cvt_pk_bf16_f32 v32, v32, v32
  v_and_b32 v32, 0xffff0000, v32
  v_mul_f32 v32, v32, v33
  v_cvt_pk_bf16_f32 v32, v32, v32
  ds_write_b16 v7, v32 offset:38912
  ds_read_b128 v[36:39], v8 offset:38912
  s_waitcnt lgkmcnt(0)
  v_mfma_f32_16x16x32_bf16 v[64:67], v[36:39], v[224:227], 0
  v_mfma_f32_16x16x32_bf16 v[68:71], v[36:39], v[228:231], 0
  v_mfma_f32_16x16x32_bf16 v[72:75], v[36:39], v[232:235], 0
  v_mfma_f32_16x16x32_bf16 v[76:79], v[36:39], v[236:239], 0
  v_mfma_f32_16x16x32_bf16 v[80:83], v[36:39], v[240:243], 0
  v_mfma_f32_16x16x32_bf16 v[84:87], v[36:39], v[244:247], 0
  v_mfma_f32_16x16x32_bf16 v[88:91], v[36:39], v[248:251], 0
  v_mfma_f32_16x16x32_bf16 v[92:95], v[36:39], v[252:255], 0
  s_nop 0
  v_mov_b32 v40, v64
  s_nop 1
  v_mov_b32_dpp v40, v72 quad_perm:[0,1,2,3] row_mask:0x2 bank_mask:0xf
  s_nop 1
  v_mov_b32_dpp v40, v80 quad_perm:[0,1,2,3] row_mask:0x4 bank_mask:0xf
  s_nop 1
  v_mov_b32_dpp v40, v88 quad_perm:[0,1,2,3] row_mask:0x8 bank_mask:0xf
  v_mov_b32 v41, v65
  s_nop 1
  v_mov_b32_dpp v41, v73 quad_perm:[0,1,2,3] row_mask:0x2 bank_mask:0xf
  s_nop 1
  v_mov_b32_dpp v41, v81 quad_perm:[0,1,2,3] row_mask:0x4 bank_mask:0xf
  s_nop 1
  v_mov_b32_dpp v41, v89 quad_perm:[0,1,2,3] row_mask:0x8 bank_mask:0xf
  v_mov_b32 v42, v68
  s_nop 1
  v_mov_b32_dpp v42, v76 quad_perm:[0,1,2,3] row_mask:0x2 bank_mask:0xf
  s_nop 1
  v_mov_b32_dpp v42, v84 quad_perm:[0,1,2,3] row_mask:0x4 bank_mask:0xf
  s_nop 1
  v_mov_b32_dpp v42, v92 quad_perm:[0,1,2,3] row_mask:0x8 bank_mask:0xf
  v_mov_b32 v43, v69
  s_nop 1
  v_mov_b32_dpp v43, v77 quad_perm:[0,1,2,3] row_mask:0x2 bank_mask:0xf
  s_nop 1
  v_mov_b32_dpp v43, v85 quad_perm:[0,1,2,3] row_mask:0x4 bank_mask:0xf
  s_nop 1
  v_mov_b32_dpp v43, v93 quad_perm:[0,1,2,3] row_mask:0x8 bank_mask:0xf
  v_and_or_b32 v40, v40, v9, s29
  v_and_or_b32 v41, v41, v9, s29
  v_and_or_b32 v42, v42, v9, s29
  v_and_or_b32 v43, v43, v9, s29
  buffer_store_dwordx4 v[40:43], v2, s[8:11], s38 offen sc1
  s_branch L_fin
L_sel0:
  s_mov_b64 exec, s[52:53]
  v_lshrrev_b32 v16, 11, v172
  v_and_b32 v17, 2047, v172
  v_cmp_eq_u32 vcc, s47, v16
  v_lshlrev_b32 v17, 1, v17
  v_add_u32 v16, 4096, v17
  v_mov_b32 v18, 0xffffff00
  v_cndmask_b32 v16, v17, v16, vcc
  s_mov_b32 s38, 32768
  v_and_or_b32 v64, v64, v18, s29
  v_and_or_b32 v65, v65, v18, s29
  v_and_or_b32 v66, v66, v18, s29
  v_and_or_b32 v67, v67, v18, s29
  v_and_or_b32 v68, v68, v18, s29
  v_and_or_b32 v69, v69, v18, s29
  v_and_or_b32 v70, v70, v18, s29
  v_and_or_b32 v71, v71, v18, s29
  buffer_store_dwordx4 v[64:67], v16, s[8:11], s38 offen sc1
  buffer_store_dwordx4 v[68:71], v16, s[8:11], s38 offen offset:16 sc1
  s_mov_b64 exec, -1
  s_branch L_selx0
L_sel1:
  s_mov_b64 exec, s[54:55]
  v_lshrrev_b32 v16, 11, v173
  v_and_b32 v17, 2047, v173
  v_cmp_eq_u32 vcc, s47, v16
  v_lshlrev_b32 v17, 1, v17
  v_add_u32 v16, 4096, v17
  v_mov_b32 v18, 0xffffff00
  v_cndmask_b32 v16, v17, v16, vcc
  s_mov_b32 s38, 32768
  v_and_or_b32 v72, v72, v18, s29
  v_and_or_b32 v73, v73, v18, s29
  v_and_or_b32 v74, v74, v18, s29
  v_and_or_b32 v75, v75, v18, s29
  v_and_or_b32 v76, v76, v18, s29
  v_and_or_b32 v77, v77, v18, s29
  v_and_or_b32 v78, v78, v18, s29
  v_and_or_b32 v79, v79, v18, s29
  buffer_store_dwordx4 v[72:75], v16, s[8:11], s38 offen sc1
  buffer_store_dwordx4 v[76:79], v16, s[8:11], s38 offen offset:16 sc1
  s_mov_b64 exec, -1
  s_branch L_selx1
L_sel2:
  s_mov_b64 exec, s[56:57]
  v_lshrrev_b32 v16, 11, v174
  v_and_b32 v17, 2047, v174
  v_cmp_eq_u32 vcc, s47, v16
  v_lshlrev_b32 v17, 1, v17
  v_add_u32 v16, 4096, v17
  v_mov_b32 v18, 0xffffff00
  v_cndmask_b32 v16, v17, v16, vcc
  s_mov_b32 s38, 32768
  v_and_or_b32 v80, v80, v18, s29
  v_and_or_b32 v81, v81, v18, s29
  v_and_or_b32 v82, v82, v18, s29
  v_and_or_b32 v83, v83, v18, s29
  v_and_or_b32 v84, v84, v18, s29
  v_and_or_b32 v85, v85, v18, s29
  v_and_or_b32 v86, v86, v18, s29
  v_and_or_b32 v87, v87, v18, s29
  buffer_store_dwordx4 v[80:83], v16, s[8:11], s38 offen sc1
  buffer_store_dwordx4 v[84:87], v16, s[8:11], s38 offen offset:16 sc1
  s_mov_b64 exec, -1
  s_branch L_selx2
L_sel3:
  s_mov_b64 exec, s[58:59]
  v_lshrrev_b32 v16, 11, v175
  v_and_b32 v17, 2047, v175
  v_cmp_eq_u32 vcc, s47, v16
  v_lshlrev_b32 v17, 1, v17
  v_add_u32 v16, 4096, v17
  v_mov_b32 v18, 0xffffff00
  v_cndmask_b32 v16, v17, v16, vcc
  s_mov_b32 s38, 32768
  v_and_or_b32 v88, v88, v18, s29
  v_and_or_b32 v89, v89, v18, s29
  v_and_or_b32 v90, v90, v18, s29
  v_and_or_b32 v91, v91, v18, s29
  v_and_or_b32 v92, v92, v18, s29
  v_and_or_b32 v93, v93, v18, s29
  v_and_or_b32 v94, v94, v18, s29
  v_and_or_b32 v95, v95, v18, s29
  buffer_store_dwordx4 v[88:91], v16, s[8:11], s38 offen sc1
  buffer_store_dwordx4 v[92:95], v16, s[8:11], s38 offen offset:16 sc1
  s_mov_b64 exec, -1
  s_branch L_selx3
L_ffn1:
  s_mov_b32 s14, 0x400000
  s_mov_b32 s15, 0x20000
  s_mov_b32 s45, 4096
  s_cmp_lg_u32 s3, 7
  s_cbranch_scc1 L_f1
  buffer_load_dwordx4 v[32:35], v2, s[8:11], s45 offen sc1
  buffer_load_dwordx4 v[36:39], v2, s[8:11], s45 offen offset:1024 sc1
  s_waitcnt vmcnt(18)
  v_readfirstlane_b32 s24, v3
  s_add_u32 s24, s24, 1
  s_and_b32 s29, s24, 0xff
  s_waitcnt vmcnt(2)
  s_barrier
  s_mov_b32 s63, 0
  s_waitcnt vmcnt(0)
  s_branch P_7_c
P_7:
  buffer_load_dwordx4 v[32:35], v2, s[8:11], s45 offen sc1
  buffer_load_dwordx4 v[36:39], v2, s[8:11], s45 offen offset:1024 sc1
  s_waitcnt vmcnt(0)
P_7_c:
  v_xor_b32 v34, s24, v34
  v_xor_b32 v38, s24, v38
  v_or_b32 v35, v34, v38
  v_cmp_ne_u32 vcc, 0, v35
  s_cbranch_vccz P_7_x
  s_add_u32 s63, s63, 1
  s_cmp_lt_u32 s63, 65536
  s_cbranch_scc1 P_7
P_7_x:
  v_max_u32 v34, v32, v36
  v_min_u32 v38, v32, v36
  v_max3_u32 v35, v38, v33, v37
  s_nop 0
  v_min_u32_dpp v38, v34, v34 row_ror:8 row_mask:0xf bank_mask:0xf
  v_max_u32_dpp v35, v35, v35 row_ror:8 row_mask:0xf bank_mask:0xf
  v_max_u32_dpp v34, v34, v34 row_ror:8 row_mask:0xf bank_mask:0xf
  v_max_u32 v35, v35, v38
  s_nop 0
  v_min_u32_dpp v38, v34, v34 row_ror:4 row_mask:0xf bank_mask:0xf
  v_max_u32_dpp v35, v35, v35 row_ror:4 row_mask:0xf bank_mask:0xf
  v_max_u32_dpp v34, v34, v34 row_ror:4 row_mask:0xf bank_mask:0xf
  v_max_u32 v35, v35, v38
  s_nop 0
  v_min_u32_dpp v38, v34, v34 row_ror:2 row_mask:0xf bank_mask:0xf
  v_max_u32_dpp v35, v35, v35 row_ror:2 row_mask:0xf bank_mask:0xf
  v_max_u32_dpp v34, v34, v34 row_ror:2 row_mask:0xf bank_mask:0xf
  v_max_u32 v35, v35, v38
  s_nop 0
  v_min_u32_dpp v38, v34, v34 row_ror:1 row_mask:0xf bank_mask:0xf
  v_max_u32_dpp v35, v35, v35 row_ror:1 row_mask:0xf bank_mask:0xf
  v_max_u32_dpp v34, v34, v34 row_ror:1 row_mask:0xf bank_mask:0xf
  v_max_u32 v35, v35, v38
  s_nop 0
  v_min_u32_dpp v38, v34, v34 row_bcast:15 row_mask:0xa bank_mask:0xf
  v_max_u32_dpp v35, v35, v35 row_bcast:15 row_mask:0xa bank_mask:0xf
  v_max_u32_dpp v34, v34, v34 row_bcast:15 row_mask:0xa bank_mask:0xf
  v_max_u32 v35, v35, v38
  s_nop 0
  v_min_u32_dpp v38, v34, v34 row_bcast:31 row_mask:0xc bank_mask:0xf
  v_max_u32_dpp v35, v35, v35 row_bcast:31 row_mask:0xc bank_mask:0xf
  v_max_u32_dpp v34, v34, v34 row_bcast:31 row_mask:0xc bank_mask:0xf
  v_max_u32 v35, v35, v38
  v_readlane_b32 s46, v34, 63
  v_readlane_b32 s47, v35, 63
  s_and_b32 s36, s46, 0xffff
  s_sub_u32 s36, 0xffff, s36
  s_and_b32 s37, s47, 0xffff
  s_sub_u32 s37, 0xffff, s37
  s_lshl_b32 s38, s36, 11
  s_lshl_b32 s39, s37, 11
  s_lshl_b32 s40, s32, 7
  s_add_u32 s38, s38, s40
  s_add_u32 s39, s39, s40
  s_mov_b32 m0, 118784
  s_mov_b32 exec_lo, 0xff
  s_mov_b32 exec_hi, 0x0
  buffer_load_dwordx4 v2, s[4:7], s38 offen lds
  s_mov_b32 m0, 118912
  s_and_b32 s40, s36, 15
  buffer_load_dwordx4 v2, s[4:7], s39 offen lds
  s_lshl_b32 s40, s40, 10
  s_lshr_b32 s36, s36, 4
  s_lshl_b32 s36, s36, 3
  s_add_u32 s36, s36, s40
  s_add_u32 s36, s36, 8192
  s_and_b32 s40, s37, 15
  s_lshl_b32 s40, s40, 10
  s_lshr_b32 s37, s37, 4
  s_lshl_b32 s37, s37, 3
  s_add_u32 s37, s37, s40
  s_add_u32 s37, s37, 8192
  s_mov_b64 exec, 1
  s_mov_b32 s62, 0
P_8:
  buffer_load_dwordx2 v[40:41], off, s[8:11], s36 sc1
  buffer_load_dwordx2 v[42:43], off, s[8:11], s37 sc1
  s_waitcnt vmcnt(0)
P_8_c:
  v_xor_b32 v41, s24, v41
  v_xor_b32 v43, s24, v43
  v_or_b32 v16, v41, v43
  v_cmp_ne_u32 vcc, 0, v16
  s_cbranch_vccz P_8_x
  s_add_u32 s62, s62, 1
  s_cmp_lt_u32 s62, 65536
  s_cbranch_scc1 P_8
P_8_x:
  v_and_b32 v44, 0xffff0000, v40
  v_and_b32 v45, 0xffff0000, v42
  v_rcp_f32 v44, v44
  v_rcp_f32 v45, v45
  v_lshlrev_b32 v46, 16, v40
  v_lshlrev_b32 v47, 16, v42
  v_mov_b32 v40, s46
  v_mov_b32 v41, s47
  v_mov_b32 v42, 119040
  v_mul_f32 v46, v46, v44
  v_mul_f32 v47, v47, v45
  ds_write_b64 v42, v[40:41] offset:16
  ds_write_b128 v42, v[44:47]
  s_waitcnt lgkmcnt(0)
  s_mov_b64 exec, -1
  s_barrier
  s_branch L_f2
L_f1:
  v_bfe_u32 v16, v1, 2, 4
  v_mul_u32_u24 v16, 928, v16
  v_and_b32 v17, 3, v1
  s_lshl_b32 s36, s3, 7
  v_lshl_add_u32 v17, v17, 3, s36
  v_add_u32 v4, v16, v17
  v_add_u32 v5, 59392, v4
  v_and_b32 v16, 1, v1
  v_and_b32 v17, 48, v1
  v_lshl_add_u32 v6, v16, 7, v17
  v_add_u32 v6, 118784, v6
  v_mov_b32 v7, 119040
  v_mov_b32 v9, 0xffffff00
  s_mul_i32 s36, s30, 7168
  s_lshl_b32 s37, s3, 10
  s_add_u32 s36, s36, s37
  s_add_u32 s36, s36, 3145728
  v_mov_b32 v12, 0x3f803f80
  v_mov_b32 v13, 0x3f803f80
  v_mov_b32 v14, 0x3f803f80
  v_mov_b32 v15, 0x3f803f80
  s_waitcnt vmcnt(16)
  v_readfirstlane_b32 s24, v3
  s_add_u32 s24, s24, 1
  s_and_b32 s29, s24, 0xff
  s_waitcnt vmcnt(0)
  s_barrier
  ds_read_b64_tr_b16 v[64:65], v4 offset:0
  ds_read_b64_tr_b16 v[66:67], v4 offset:14848
  ds_read_b64_tr_b16 v[68:69], v4 offset:29696
  ds_read_b64_tr_b16 v[70:71], v4 offset:44544
  ds_read_b64_tr_b16 v[72:73], v5 offset:0
  ds_read_b64_tr_b16 v[74:75], v5 offset:14848
  ds_read_b64_tr_b16 v[76:77], v5 offset:29696
  ds_read_b64_tr_b16 v[78:79], v5 offset:44544
  ds_read_b64_tr_b16 v[80:81], v4 offset:32
  ds_read_b64_tr_b16 v[82:83], v4 offset:14880
  ds_read_b64_tr_b16 v[84:85], v4 offset:29728
  ds_read_b64_tr_b16 v[86:87], v4 offset:44576
  ds_read_b64_tr_b16 v[88:89], v5 offset:32
  ds_read_b64_tr_b16 v[90:91], v5 offset:14880
  ds_read_b64_tr_b16 v[92:93], v5 offset:29728
  ds_read_b64_tr_b16 v[94:95], v5 offset:44576
  ds_read_b64_tr_b16 v[96:97], v4 offset:64
  ds_read_b64_tr_b16 v[98:99], v4 offset:14912
  ds_read_b64_tr_b16 v[100:101], v4 offset:29760
  ds_read_b64_tr_b16 v[102:103], v4 offset:44608
  ds_read_b64_tr_b16 v[104:105], v5 offset:64
  ds_read_b64_tr_b16 v[106:107], v5 offset:14912
  ds_read_b64_tr_b16 v[108:109], v5 offset:29760
  ds_read_b64_tr_b16 v[110:111], v5 offset:44608
  ds_read_b64_tr_b16 v[112:113], v4 offset:96
  ds_read_b64_tr_b16 v[114:115], v4 offset:14944
  ds_read_b64_tr_b16 v[116:117], v4 offset:29792
  ds_read_b64_tr_b16 v[118:119], v4 offset:44640
  ds_read_b64_tr_b16 v[120:121], v5 offset:96
  ds_read_b64_tr_b16 v[122:123], v5 offset:14944
  ds_read_b64_tr_b16 v[124:125], v5 offset:29792
  ds_read_b64_tr_b16 v[126:127], v5 offset:44640
  s_waitcnt lgkmcnt(0)
  v_mfma_f32_16x16x32_bf16 v[128:131], v[12:15], v[64:67], 0
  v_mfma_f32_16x16x32_bf16 v[128:131], v[12:15], v[68:71], v[128:131]
  v_mfma_f32_16x16x32_bf16 v[132:135], v[12:15], v[72:75], 0
  v_mfma_f32_16x16x32_bf16 v[132:135], v[12:15], v[76:79], v[132:135]
  v_mfma_f32_16x16x32_bf16 v[136:139], v[12:15], v[80:83], 0
  v_mfma_f32_16x16x32_bf16 v[136:139], v[12:15], v[84:87], v[136:139]
  v_mfma_f32_16x16x32_bf16 v[140:143], v[12:15], v[88:91], 0
  v_mfma_f32_16x16x32_bf16 v[140:143], v[12:15], v[92:95], v[140:143]
  v_mfma_f32_16x16x32_bf16 v[144:147], v[12:15], v[96:99], 0
  v_mfma_f32_16x16x32_bf16 v[144:147], v[12:15], v[100:103], v[144:147]
  v_mfma_f32_16x16x32_bf16 v[148:151], v[12:15], v[104:107], 0
  v_mfma_f32_16x16x32_bf16 v[148:151], v[12:15], v[108:111], v[148:151]
  v_mfma_f32_16x16x32_bf16 v[152:155], v[12:15], v[112:115], 0
  v_mfma_f32_16x16x32_bf16 v[152:155], v[12:15], v[116:119], v[152:155]
  v_mfma_f32_16x16x32_bf16 v[156:159], v[12:15], v[120:123], 0
  v_mfma_f32_16x16x32_bf16 v[156:159], v[12:15], v[124:127], v[156:159]
  v_mov_b32 v16, v128
  s_nop 1
  v_mov_b32_dpp v16, v136 quad_perm:[0,1,2,3] row_mask:0x2 bank_mask:0xf
  s_nop 1
  v_mov_b32_dpp v16, v144 quad_perm:[0,1,2,3] row_mask:0x4 bank_mask:0xf
  s_nop 1
  v_mov_b32_dpp v16, v152 quad_perm:[0,1,2,3] row_mask:0x8 bank_mask:0xf
  v_mov_b32 v17, v132
  s_nop 1
  v_mov_b32_dpp v17, v140 quad_perm:[0,1,2,3] row_mask:0x2 bank_mask:0xf
  s_nop 1
  v_mov_b32_dpp v17, v148 quad_perm:[0,1,2,3] row_mask:0x4 bank_mask:0xf
  s_nop 1
  v_mov_b32_dpp v17, v156 quad_perm:[0,1,2,3] row_mask:0x8 bank_mask:0xf
  s_barrier
  ds_read_b128 v[20:23], v6
  ds_read_b128 v[24:27], v6 offset:64
  ds_read_b128 v[28:31], v7
  s_waitcnt lgkmcnt(2)
  v_mfma_f32_16x16x32_bf16 v[160:163], v[20:23], v[64:67], 0
  v_mfma_f32_16x16x32_bf16 v[164:167], v[20:23], v[72:75], 0
  v_mfma_f32_16x16x32_bf16 v[168:171], v[20:23], v[80:83], 0
  v_mfma_f32_16x16x32_bf16 v[172:175], v[20:23], v[88:91], 0
  v_mfma_f32_16x16x32_bf16 v[176:179], v[20:23], v[96:99], 0
  v_mfma_f32_16x16x32_bf16 v[180:183], v[20:23], v[104:107], 0
  v_mfma_f32_16x16x32_bf16 v[184:187], v[20:23], v[112:115], 0
  v_mfma_f32_16x16x32_bf16 v[188:191], v[20:23], v[120:123], 0
  s_waitcnt lgkmcnt(0)
  v_mfma_f32_16x16x32_bf16 v[160:163], v[24:27], v[68:71], v[160:163]
  v_pk_mul_f32 v[32:33], v[30:31], v[16:17] op_sel:[0,0] op_sel_hi:[1,0] neg_lo:[1,0] neg_hi:[1,0]
  s_nop 1
  v_mfma_f32_16x16x32_bf16 v[164:167], v[24:27], v[76:79], v[164:167]
  v_mul_f32 v34, -v30, v17
  v_mul_f32 v35, -v31, v17
  v_mfma_f32_16x16x32_bf16 v[168:171], v[24:27], v[84:87], v[168:171]
  v_mfma_f32_16x16x32_bf16 v[172:175], v[24:27], v[92:95], v[172:175]
  v_mfma_f32_16x16x32_bf16 v[176:179], v[24:27], v[100:103], v[176:179]
  v_mfma_f32_16x16x32_bf16 v[180:183], v[24:27], v[108:111], v[180:183]
  v_mfma_f32_16x16x32_bf16 v[184:187], v[24:27], v[116:119], v[184:187]
  v_mfma_f32_16x16x32_bf16 v[188:191], v[24:27], v[124:127], v[188:191]
  v_mov_b32 v40, v160
  s_nop 1
  v_mov_b32_dpp v40, v168 quad_perm:[0,1,2,3] row_mask:0x2 bank_mask:0xf
  s_nop 1
  v_mov_b32_dpp v40, v176 quad_perm:[0,1,2,3] row_mask:0x4 bank_mask:0xf
  s_nop 1
  v_mov_b32_dpp v40, v184 quad_perm:[0,1,2,3] row_mask:0x8 bank_mask:0xf
  v_mov_b32 v41, v161
  s_nop 1
  v_mov_b32_dpp v41, v169 quad_perm:[0,1,2,3] row_mask:0x2 bank_mask:0xf
  s_nop 1
  v_mov_b32_dpp v41, v177 quad_perm:[0,1,2,3] row_mask:0x4 bank_mask:0xf
  s_nop 1
  v_mov_b32_dpp v41, v185 quad_perm:[0,1,2,3] row_mask:0x8 bank_mask:0xf
  v_mov_b32 v42, v164
  s_nop 1
  v_mov_b32_dpp v42, v172 quad_perm:[0,1,2,3] row_mask:0x2 bank_mask:0xf
  s_nop 1
  v_mov_b32_dpp v42, v180 quad_perm:[0,1,2,3] row_mask:0x4 bank_mask:0xf
  s_nop 1
  v_mov_b32_dpp v42, v188 quad_perm:[0,1,2,3] row_mask:0x8 bank_mask:0xf
  v_mov_b32 v43, v165
  s_nop 1
  v_mov_b32_dpp v43, v173 quad_perm:[0,1,2,3] row_mask:0x2 bank_mask:0xf
  s_nop 1
  v_mov_b32_dpp v43, v181 quad_perm:[0,1,2,3] row_mask:0x4 bank_mask:0xf
  s_nop 1
  v_mov_b32_dpp v43, v189 quad_perm:[0,1,2,3] row_mask:0x8 bank_mask:0xf
  v_pk_fma_f32 v[40:41], v[40:41], v[28:29], v[32:33]
  v_pk_fma_f32 v[42:43], v[42:43], v[28:29], v[34:35]
  v_and_or_b32 v40, v40, v9, s29
  v_and_or_b32 v41, v41, v9, s29
  v_and_or_b32 v42, v42, v9, s29
  v_and_or_b32 v43, v43, v9, s29
  buffer_store_dwordx4 v[40:43], v2, s[8:11], s36 offen sc1
L_f2:
  s_cmp_ge_u32 s30, 64
  s_cbranch_scc1 L_fin
  v_lshrrev_b32 v16, 3, v0
  v_and_b32 v17, 7, v0
  v_lshlrev_b32 v16, 13, v16
  v_lshl_add_u32 v4, v17, 4, v16
  s_lshl_b32 s36, s30, 7
  s_add_u32 s36, s36, 4194304
  s_add_u32 s37, s36, 524288
  v_lshlrev_b32 v5, 2, v0
  v_lshlrev_b32 v6, 2, v1
  v_mov_b32 v8, -1
  s_cmp_lg_u32 s3, 0
  s_cbranch_scc1 L_r1
  v_lshrrev_b32 v18, 5, v1
  v_lshlrev_b32 v19, 2, v18
  v_add_u32 v19, 119056, v19
  ds_read_b32 v19, v19
  s_lshr_b32 s38, s30, 1
  s_lshl_b32 s38, s38, 5
  s_and_b32 s39, s30, 1
  s_lshl_b32 s39, s39, 3
  s_add_u32 s38, s38, s39
  v_and_b32 v16, 16, v1
  v_add3_u32 v17, v17, v16, s38
  v_lshlrev_b32 v16, 12, v18
  v_lshl_add_u32 v7, v17, 2, v16
  s_mov_b32 s38, 32768
  s_waitcnt lgkmcnt(0)
  v_ashrrev_i32 v16, 31, v19
  v_not_b32 v16, v16
  v_or_b32 v16, 0x80000000, v16
  v_xor_b32 v16, v16, v19
  v_and_b32 v16, 0xffff0000, v16
  v_mul_f32 v16, 0xbfb8aa3b, v16
  v_exp_f32 v16, v16
  v_and_b32 v19, 0xffff, v19
  v_add_f32 v16, 1.0, v16
  v_rcp_f32 v16, v16
  v_sub_u32 v19, 0xffff, v19
  v_lshlrev_b32 v19, 11, v19
  v_lshl_add_u32 v8, v17, 1, v19
  v_cvt_pk_bf16_f32 v16, v16, v16
  v_and_b32 v10, 0xffff0000, v16
  s_mov_b32 s61, 0
P_9:
  buffer_load_dword v11, v7, s[8:11], s38 offen sc1
  s_waitcnt vmcnt(0)
P_9_c:
  v_xor_b32 v11, s29, v11
  v_mov_b32 v16, v11
  v_and_b32 v16, 0xff, v16
  v_cmp_ne_u32 vcc, 0, v16
  s_cbranch_vccz P_9_x
  s_add_u32 s61, s61, 1
  s_cmp_lt_u32 s61, 65536
  s_cbranch_scc1 P_9
P_9_x:
L_r1:
  s_cmp_ge_u32 s3, 6
  s_cbranch_scc1 L_r2
  s_mov_b32 s60, 0
P_10:
  buffer_load_dwordx4 v[20:23], v4, s[8:11], s36 offen sc1
  buffer_load_dwordx4 v[24:27], v4, s[8:11], s37 offen sc1
  s_waitcnt vmcnt(0)
P_10_c:
  v_xor_b32 v20, s29, v20
  v_xor_b32 v21, s29, v21
  v_xor_b32 v22, s29, v22
  v_xor_b32 v23, s29, v23
  v_xor_b32 v24, s29, v24
  v_xor_b32 v25, s29, v25
  v_xor_b32 v26, s29, v26
  v_xor_b32 v27, s29, v27
  v_or3_b32 v16, v20, v21, v22
  v_or3_b32 v16, v16, v23, v24
  v_or3_b32 v16, v16, v25, v26
  v_or_b32 v16, v16, v27
  v_and_b32 v16, 0xff, v16
  v_cmp_ne_u32 vcc, 0, v16
  s_cbranch_vccz P_10_x
  s_add_u32 s60, s60, 1
  s_cmp_lt_u32 s60, 65536
  s_cbranch_scc1 P_10
P_10_x:
  v_pk_add_f32 v[20:21], v[20:21], v[24:25]
  v_pk_add_f32 v[22:23], v[22:23], v[26:27]
  s_branch L_r3
L_r2:
  s_mov_b32 s60, 0
P_11:
  buffer_load_dwordx4 v[20:23], v4, s[8:11], s36 offen sc1
  s_waitcnt vmcnt(0)
P_11_c:
  v_xor_b32 v20, s29, v20
  v_xor_b32 v21, s29, v21
  v_xor_b32 v22, s29, v22
  v_xor_b32 v23, s29, v23
  v_or3_b32 v16, v20, v21, v22
  v_or_b32 v16, v16, v23
  v_and_b32 v16, 0xff, v16
  v_cmp_ne_u32 vcc, 0, v16
  s_cbranch_vccz P_11_x
  s_add_u32 s60, s60, 1
  s_cmp_lt_u32 s60, 65536
  s_cbranch_scc1 P_11
P_11_x:
L_r3:
  v_permlane32_swap_b32 v20, v21
  v_permlane32_swap_b32 v22, v23
  v_add_f32 v20, v20, v21
  v_add_f32 v22, v22, v23
  s_nop 1
  v_permlane16_swap_b32 v20, v22
  v_add_f32 v20, v20, v22
  s_nop 1
  v_add_f32_dpp v20, v20, v20 row_ror:8 row_mask:0xf bank_mask:0xf
  ds_write_b32 v5, v20 offset:0
  s_waitcnt lgkmcnt(0)
  s_barrier
  s_cmp_lg_u32 s3, 0
  s_cbranch_scc1 L_fin
  ds_read2st64_b32 v[20:21], v6 offset0:0 offset1:1
  ds_read2st64_b32 v[22:23], v6 offset0:2 offset1:3
  ds_read2st64_b32 v[24:25], v6 offset0:4 offset1:5
  ds_read2st64_b32 v[26:27], v6 offset0:6 offset1:7
  s_waitcnt lgkmcnt(2)
  v_pk_add_f32 v[20:21], v[20:21], v[22:23]
  s_waitcnt lgkmcnt(0)
  v_pk_add_f32 v[24:25], v[24:25], v[26:27]
  v_pk_add_f32 v[20:21], v[20:21], v[24:25]
  v_add_f32 v20, v20, v21
  v_cvt_pk_bf16_f32 v20, v20, v20
  v_and_b32 v20, 0xffff0000, v20
  v_mul_f32 v20, v20, v10
  v_cvt_pk_bf16_f32 v20, v20, v20
  v_and_b32 v20, 0xffff0000, v20
  v_add_f32 v20, v20, v11
  v_cvt_pk_bf16_f32 v20, v20, v20
  s_mov_b32 exec_lo, 0xff00ff
  s_mov_b32 exec_hi, 0xff00ff
  buffer_store_short v20, v8, s[12:15], 0 offen
  s_cmp_lg_u32 s30, 0
  s_cbranch_scc1 L_fin
  v_mov_b32 v16, s24
  s_mov_b64 exec, 1
  buffer_store_dword v16, off, s[8:11], 0 sc1
L_fin:
L_end:
  s_endpgm
.section .rodata,"a"
.p2align 6
.amdhsa_kernel parallel_sum__spectral_fnet__moe_arch_mod__prompt_kernel
  .amdhsa_next_free_vgpr 256
  .amdhsa_next_free_sgpr 102
  .amdhsa_accum_offset 256
  .amdhsa_group_segment_fixed_size 0
  .amdhsa_kernarg_size 104
  .amdhsa_user_sgpr_count 2
  .amdhsa_user_sgpr_kernarg_segment_ptr 1
  .amdhsa_system_sgpr_workgroup_id_x 1
.end_amdhsa_kernel
```

```asm
; @launch grid=(256,1,1) block=(512,1,1) lds=159552
.amdgcn_target "amdgcn-amd-amdhsa--gfx950"
.text
.globl parallel_sum__spectral_fnet__moe_arch_mod__prompt_kernel
.p2align 8
.type parallel_sum__spectral_fnet__moe_arch_mod__prompt_kernel,@function
parallel_sum__spectral_fnet__moe_arch_mod__prompt_kernel:
  s_load_dwordx2 s[4:5], s[0:1], 0
  s_load_dwordx2 s[8:9], s[0:1], 96
  s_load_dwordx2 s[12:13], s[0:1], 80
  s_getpc_b64 s[26:27]
L_pc:
  s_add_u32 s16, s26, L_tab@rel32@lo+4
  s_addc_u32 s17, s27, L_tab@rel32@hi+12
  v_lshrrev_b32 v3, 6, v0
  v_and_b32 v1, 63, v0
  s_mov_b32 s7, 0x20000
  v_readfirstlane_b32 s3, v3
  s_mov_b32 s11, 0x20000
  s_mov_b32 s19, 0x20000
  s_mov_b32 s23, 0x20000
  v_lshlrev_b32 v2, 4, v1
  s_mov_b32 s18, 85888
  s_cmp_ge_u32 s2, 128
  s_cbranch_scc1 L_ffn0
  s_load_dwordx2 s[20:21], s[0:1], 48
  s_mov_b32 s18, 217088
  s_lshl_b32 s30, s3, 8
  v_and_b32 v16, 15, v1
  v_lshrrev_b32 v17, 4, v1
  v_cmp_eq_u32 vcc, 4, v16
  v_mov_b32 v64, 0x3f803f80
  v_lshl_add_u32 v18, v17, 4, s30
  s_add_u32 s30, s30, s2
  s_cmp_eq_u32 s2, 0
  s_cselect_b32 s32, 896, 0
  v_cndmask_b32_e64 v32, 0, v64, vcc
  s_cmp_ge_u32 s3, 4
  s_cselect_b32 s32, s32, 0
  s_sub_u32 s30, s30, s32
  s_sub_u32 s31, 2048, s30
  s_cmp_eq_u32 s30, 0
  s_cselect_b32 s31, 1024, s31
  s_lshl_b32 s32, s30, 11
  s_lshl_b32 s33, s31, 11
  s_mul_i32 s34, s3, 4128
  s_mov_b32 s6, 0x400000
  s_mov_b32 s22, 2048
  s_lshl_b32 s38, s3, 9
  s_add_u32 m0, s38, 35328
  s_mov_b32 exec_hi, 0
  buffer_load_dwordx4 v2, s[16:19], s38 offen lds
  s_mov_b32 exec_hi, -1
  s_lshl_b32 s46, s3, 11
  s_add_u32 s39, s46, 39424
  s_add_u32 s46, s46, 4096
  s_cmp_eq_u32 s2, 0
  s_cselect_b32 s37, 2048, 0
  s_add_u32 s37, s37, s46
  s_cmp_eq_u32 s3, 6
  s_cselect_b32 s46, s37, s46
  s_lshl_b32 s37, s2, 10
  s_add_u32 s37, s37, 86016
  s_cmp_eq_u32 s3, 7
  s_cselect_b32 s46, s37, s46
  s_mov_b32 m0, s39
  s_nop 0
  buffer_load_dwordx4 v2, s[16:19], s46 offen lds
  buffer_load_dwordx4 v2, s[16:19], s46 offen offset:1024 lds
  v_mov_b32 v33, v32
  v_mov_b32 v34, v32
  v_mov_b32 v35, v32
  v_mov_b32 v36, v32
  v_mov_b32 v37, v32
  v_mov_b32 v38, v32
  v_mov_b32 v39, v32
  v_mov_b32 v40, v32
  v_mov_b32 v41, v32
  v_mov_b32 v42, v32
  v_mov_b32 v43, v32
  v_mov_b32 v44, v32
  v_mov_b32 v45, v32
  v_mov_b32 v46, v32
  v_mov_b32 v47, v32
  s_mov_b32 m0, s34
  s_waitcnt lgkmcnt(0)
  s_mov_b32 exec_lo, 0x01010101
  s_mov_b32 exec_hi, 0x01010101
  buffer_load_dwordx4 v[32:35], v18, s[20:23], 0 offen offset:0
  buffer_load_dwordx4 v[36:39], v18, s[20:23], 0 offen offset:64
  buffer_load_dwordx4 v[40:43], v18, s[20:23], 0 offen offset:128
  buffer_load_dwordx4 v[44:47], v18, s[20:23], 0 offen offset:192
  s_mov_b64 exec, -1
  buffer_load_dwordx4 v2, s[4:7], s32 offen lds
  buffer_load_dwordx4 v2, s[4:7], s32 offen offset:1024 lds
  s_add_u32 m0, m0, 2064
  s_load_dword s24, s[8:9], 0
  buffer_load_dwordx4 v2, s[4:7], s33 offen lds
  buffer_load_dwordx4 v2, s[4:7], s33 offen offset:1024 lds
  s_branch L_fft1
L_ffn0:
  s_cmp_ge_u32 s2, 256
  s_cbranch_scc1 L_end
  s_sub_u32 s30, s2, 128
  s_lshr_b32 s31, s30, 3
  s_lshl_b32 s31, s31, 13
  s_sub_u32 s32, s31, 16384
  s_cselect_b32 s31, s31, s32
  s_cselect_b64 s[16:17], s[26:27], s[16:17]
  s_cselect_b32 s32, L_end-L_pc, s18
  v_and_b32 v4, 0x1f8, v0
  v_lshl_add_u32 v4, v4, 4, s31
  v_min_u32 v4, s32, v4
  global_load_dword v57, v4, s[16:17]
  s_load_dwordx2 s[38:39], s[0:1], 48
  v_and_b32 v58, 0x7f0, v0
  v_lshlrev_b32 v58, 2, v58
  s_load_dwordx4 s[16:19], s[0:1], 56
  s_load_dwordx2 s[40:41], s[0:1], 72
  s_lshr_b32 s31, s30, 4
  s_and_b32 s32, s30, 15
  s_lshl_b32 s33, s32, 3
  s_add_u32 s33, s33, s3
  s_mul_i32 s33, s33, 57344
  s_mul_i32 s34, s31, 896
  s_add_u32 s33, s33, s34
  s_and_b32 s34, s3, 3
  s_mul_i32 s34, s34, 3712
  s_lshr_b32 s35, s3, 2
  s_mul_i32 s35, s35, 29696
  s_add_u32 m0, s34, s35
  s_mov_b32 s22, 7340032
  s_mov_b32 exec_hi, 0x00ffffff
  s_waitcnt lgkmcnt(0)
  s_mov_b64 s[20:21], s[18:19]
  s_mov_b32 s18, 7340032
  s_mov_b32 s19, 0x20000
  s_load_dword s24, s[8:9], 0
  s_cmp_lt_u32 s30, 8
  s_cbranch_scc0 L_npr
  global_load_dword v59, v58, s[38:39]
L_npr:
  s_waitcnt vmcnt(0)
  buffer_load_dwordx4 v2, s[16:19], s33 offen lds
  s_add_u32 m0, m0, 59392
  s_nop 0
  buffer_load_dwordx4 v2, s[20:23], s33 offen lds
  s_sub_u32 m0, m0, 58464
  s_add_u32 s33, s33, 7168
  buffer_load_dwordx4 v2, s[16:19], s33 offen lds
  s_add_u32 m0, m0, 59392
  s_nop 0
  buffer_load_dwordx4 v2, s[20:23], s33 offen lds
  s_sub_u32 m0, m0, 58464
  s_add_u32 s33, s33, 7168
  buffer_load_dwordx4 v2, s[16:19], s33 offen lds
  s_add_u32 m0, m0, 59392
  s_nop 0
  buffer_load_dwordx4 v2, s[20:23], s33 offen lds
  s_sub_u32 m0, m0, 58464
  s_add_u32 s33, s33, 7168
  buffer_load_dwordx4 v2, s[16:19], s33 offen lds
  s_add_u32 m0, m0, 59392
  s_nop 0
  buffer_load_dwordx4 v2, s[20:23], s33 offen lds
  s_sub_u32 m0, m0, 47328
  s_add_u32 s33, s33, 7168
  buffer_load_dwordx4 v2, s[16:19], s33 offen lds
  s_add_u32 m0, m0, 59392
  s_nop 0
  buffer_load_dwordx4 v2, s[20:23], s33 offen lds
  s_sub_u32 m0, m0, 58464
  s_add_u32 s33, s33, 7168
  buffer_load_dwordx4 v2, s[16:19], s33 offen lds
  s_add_u32 m0, m0, 59392
  s_nop 0
  buffer_load_dwordx4 v2, s[20:23], s33 offen lds
  s_sub_u32 m0, m0, 58464
  s_add_u32 s33, s33, 7168
  buffer_load_dwordx4 v2, s[16:19], s33 offen lds
  s_add_u32 m0, m0, 59392
  s_nop 0
  buffer_load_dwordx4 v2, s[20:23], s33 offen lds
  s_sub_u32 m0, m0, 58464
  s_add_u32 s33, s33, 7168
  buffer_load_dwordx4 v2, s[16:19], s33 offen lds
  s_add_u32 m0, m0, 59392
  s_nop 0
  buffer_load_dwordx4 v2, s[20:23], s33 offen lds
  s_mov_b32 exec_hi, -1
  s_branch L_ffn1
L_fft1:
  s_bfe_u32 s41, s2, 0x10003
  s_load_dwordx2 s[30:31], s[0:1], 72
  s_and_b32 s40, s2, 7
  s_lshr_b32 s42, s2, 4
  s_and_b32 s43, s2, 15
  v_lshrrev_b32 v19, 3, v0
  v_and_b32 v20, 7, v0
  v_lshl_add_u32 v19, v19, 4, s43
  s_lshl_b32 s44, s42, 7
  v_lshl_add_u32 v20, v20, 4, s44
  v_lshl_add_u32 v172, v19, 11, v20
  v_sub_u32 v19, 1024, v19
  v_sub_u32 v20, 2032, v20
  v_add_u32 v174, 0x200000, v172
  v_lshl_add_u32 v175, v19, 11, v20
  v_add_u32 v173, 0x200000, v175
  v_and_b32 v173, 0x3fffff, v173
  v_mul_u32_u24 v5, 2064, v16
  v_add_u32 v5, v5, v18
  s_mov_b32 s36, 55808
  v_lshl_add_u32 v8, v1, 5, s36
  v_lshrrev_b32 v19, 3, v1
  v_add_u32 v19, s3, v19
  v_and_b32 v20, 7, v19
  v_lshl_add_u32 v6, v20, 2, v8
  v_lshlrev_b32 v21, 1, v17
  v_sub_u32 v19, v19, v21
  v_add_u32 v19, 6, v19
  v_and_b32 v19, 7, v19
  v_lshlrev_b32 v19, 2, v19
  v_lshl_add_u32 v20, v16, 5, v19
  v_add_u32 v20, 57344, v20
  v_add_u32 v21, 2048, v6
  s_mov_b32 s36, 0x00f0000f
  s_mov_b32 s37, 0xf0000f00
  v_cndmask_b32_e64 v7, v21, v20, s[36:37]
  v_bfe_u32 v20, v1, 2, 2
  v_and_b32 v21, 3, v1
  v_lshrrev_b32 v22, 5, v1
  v_lshl_add_u32 v22, v22, 3, v20
  v_and_b32 v23, 1, v17
  v_lshlrev_b32 v22, 6, v22
  v_lshl_add_u32 v22, v23, 5, v22
  v_lshl_add_u32 v22, v21, 3, v22
  v_add_u32 v4, s34, v22
  v_mov_b32 v65, v64
  v_mov_b32 v66, v64
  v_mov_b32 v67, v64
  v_mov_b32 v11, 0xfffcfffc
  s_mov_b32 s10, 8388608
  s_mov_b32 s14, 0x400000
  s_mov_b32 s15, 0x20000
  s_lshl_b32 s34, s3, 1
  s_add_u32 s35, s34, 17
  s_add_u32 s34, s34, 16
  s_mov_b32 s48, 0x22222222
  s_mov_b32 s49, 0x22222222
  s_mov_b32 s50, 0x44444444
  s_mov_b32 s51, 0x44444444
  s_mov_b32 s52, 0x88888888
  s_mov_b32 s53, 0x88888888
  v_lshrrev_b32 v20, 1, v16
  v_lshlrev_b32 v20, 8, v20
  s_cmp_eq_u32 s2, 0
  s_cselect_b32 s36, 896, 0
  s_cselect_b32 s55, 0x10000, 0
  s_mov_b32 s54, 0xffff0000
  v_bfe_u32 v21, v1, 3, 1
  v_mul_u32_u24 v21, s36, v21
  v_add_u32 v20, s2, v20
  v_sub_u32 v20, v20, v21
  v_sub_u32 v21, 0x800, v20
  v_cmp_eq_u32 vcc, 0, v20
  v_mov_b32 v22, 0x400
  s_mov_b32 s36, 0xaaaaaaaa
  s_mov_b32 s37, s36
  v_cndmask_b32_e64 v21, v21, v22, vcc
  v_cndmask_b32_e64 v20, v20, v21, s[36:37]
  v_sub_u32 v9, 0xffff, v20
  v_and_b32 v21, 15, v20
  v_and_b32 v20, 0x7f0, v20
  v_lshl_add_u32 v10, v21, 12, v20
  v_mov_b32 v21, 0x800
  s_nop 1
  v_mov_b32_dpp v10, v21 quad_perm:[0,1,2,3] row_mask:0xd bank_mask:0xf
  s_waitcnt vmcnt(0)
  v_mfma_f32_16x16x32_bf16 v[76:79], v[32:35], v[64:67], 0
  v_mfma_f32_16x16x32_bf16 v[76:79], v[36:39], v[64:67], v[76:79]
  v_mfma_f32_16x16x32_bf16 v[76:79], v[40:43], v[64:67], v[76:79]
  v_mfma_f32_16x16x32_bf16 v[76:79], v[44:47], v[64:67], v[76:79]
  s_waitcnt lgkmcnt(0)
  s_barrier
  ds_read_b128 v[48:51], v5 offset:0
  ds_read_b128 v[52:55], v5 offset:64
  ds_read_b128 v[56:59], v5 offset:128
  ds_read_b128 v[60:63], v5 offset:192
  ds_read_b64_tr_b16 v[132:133], v4 offset:0
  ds_read_b64_tr_b16 v[134:135], v4 offset:256
  ds_read_b64_tr_b16 v[136:137], v4 offset:1024
  ds_read_b64_tr_b16 v[138:139], v4 offset:1280
  ds_read_b128 v[112:115], v2 offset:35328
  ds_read_b128 v[116:119], v2 offset:36352
  s_add_u32 s24, s24, 1
  s_and_b32 s29, s24, 0xff
  s_waitcnt lgkmcnt(9)
  v_mfma_f32_16x16x32_bf16 v[72:75], v[48:51], v[48:51], 0
  v_mfma_f32_16x16x32_bf16 v[68:71], v[32:35], v[48:51], 0
  s_waitcnt lgkmcnt(8)
  v_mfma_f32_16x16x32_bf16 v[72:75], v[52:55], v[52:55], v[72:75]
  v_mfma_f32_16x16x32_bf16 v[68:71], v[36:39], v[52:55], v[68:71]
  s_waitcnt lgkmcnt(7)
  v_mfma_f32_16x16x32_bf16 v[72:75], v[56:59], v[56:59], v[72:75]
  v_mfma_f32_16x16x32_bf16 v[68:71], v[40:43], v[56:59], v[68:71]
  s_waitcnt lgkmcnt(6)
  v_mfma_f32_16x16x32_bf16 v[72:75], v[60:63], v[60:63], v[72:75]
  v_mfma_f32_16x16x32_bf16 v[68:71], v[44:47], v[60:63], v[68:71]
  ds_read_b128 v[120:123], v2 offset:37376
  ds_read_b128 v[124:127], v2 offset:38400
  ds_read_b64_tr_b16 v[140:141], v4 offset:2064
  ds_read_b64_tr_b16 v[142:143], v4 offset:2320
  ds_read_b64_tr_b16 v[144:145], v4 offset:3088
  ds_read_b64_tr_b16 v[146:147], v4 offset:3344
  s_nop 0
  v_cndmask_b32_e64 v72, v72, v73, s[48:49]
  v_cndmask_b32_e64 v74, v74, v75, s[52:53]
  v_mov_b32_dpp v68, v76 quad_perm:[0,1,2,3] row_mask:0x4 bank_mask:0xf
  s_or_b64 s[50:51], s[50:51], s[52:53]
  ds_write_b32 v6, v68
  v_cndmask_b32_e64 v72, v72, v74, s[50:51]
  ds_write_b32 v7, v72
  s_waitcnt lgkmcnt(8)
  v_mfma_f32_32x32x16_bf16 v[176:191], v[132:135], v[112:115], 0
  v_mfma_f32_32x32x16_bf16 v[176:191], v[136:139], v[116:119], v[176:191]
  s_waitcnt vmcnt(0) lgkmcnt(0)
  s_barrier
  ds_read_b128 v[28:31], v8
  ds_read_b128 v[68:71], v8 offset:16
  ds_read_b128 v[20:23], v2 offset:51712
  ds_read_b128 v[12:15], v2 offset:47616
  ds_read_b128 v[80:83], v2 offset:39424
  ds_read_b128 v[84:87], v2 offset:40448
  ds_read_b128 v[88:91], v2 offset:41472
  ds_read_b128 v[92:95], v2 offset:42496
  ds_read_b128 v[96:99], v2 offset:43520
  ds_read_b128 v[100:103], v2 offset:44544
  ds_read_b128 v[104:107], v2 offset:45568
  ds_read_b128 v[108:111], v2 offset:46592
  ds_read_b128 v[128:131], v2 offset:53760
  ds_read_b128 v[24:27], v2 offset:52736
  s_cmp_eq_u32 s3, 7
  s_cbranch_scc1 L_cw
  v_mfma_f32_32x32x16_bf16 v[192:207], v[132:135], v[120:123], 0
  s_waitcnt lgkmcnt(12)
  v_pk_add_f32 v[28:29], v[28:29], v[30:31]
  v_pk_add_f32 v[68:69], v[68:69], v[70:71]
  v_pk_add_f32 v[28:29], v[28:29], v[68:69]
  v_add_f32 v68, v28, v29
  v_add_f32 v31, v28, v29
  s_nop 1
  v_permlane32_swap_b32 v68, v31
  v_mfma_f32_32x32x16_bf16 v[192:207], v[136:139], v[124:127], v[192:207]
  v_mov_b32 v69, v31
  v_mul_f32 v29, 0x3a800000, v68
  v_mul_f32 v31, 0x3a800000, v31
  v_fma_f32 v31, -v29, v29, v31
  v_max_f32 v31, 0, v31
  v_mfma_f32_32x32x16_bf16 v[208:223], v[140:143], v[112:115], 0
  v_cvt_pk_bf16_f32 v31, v31, v31
  v_and_b32 v31, 0xffff0000, v31
  v_add_f32 v31, 0x3727c5ac, v31
  v_cvt_pk_bf16_f32 v31, v31, v31
  v_and_b32 v31, 0xffff0000, v31
  v_sqrt_f32 v31, v31
  v_mfma_f32_32x32x16_bf16 v[208:223], v[144:147], v[116:119], v[208:223]
  v_mov_b32 v18, s24
  v_cvt_pk_bf16_f32 v19, v29, v31
  v_and_b32 v16, 0xffff0000, v19
  v_rcp_f32 v16, v16
  v_lshlrev_b32 v17, 16, v19
  v_mfma_f32_32x32x16_bf16 v[224:239], v[140:143], v[120:123], 0
  v_mul_f32 v17, v17, v16
  v_readlane_b32 s56, v16, s34
  v_readlane_b32 s57, v16, s35
  v_readlane_b32 s58, v17, s34
  v_readlane_b32 s59, v17, s35
  v_mfma_f32_32x32x16_bf16 v[224:239], v[144:147], v[124:127], v[224:239]
L_nocand:
  s_mov_b32 s60, s57
  s_mov_b32 s61, s59
  s_or_b32 s62, s2, s3
  s_cselect_b32 s57, s57, 0
  s_cselect_b32 s59, s59, 0
  s_mul_i32 s36, s3, 2176
  s_lshl_b32 s37, s3, 5
  s_waitcnt lgkmcnt(10)
  v_add_u32 v21, s37, v21
  v_add_u32 v12, s36, v12
  v_add_u32 v13, s36, v13
  v_add_u32 v14, s36, v14
  v_add_u32 v15, s36, v15
  v_and_b32 v21, 0xff, v21
  v_add_u32 v20, v20, v21
L_job:
  v_mul_f32 v18, s58, v23
  v_mul_f32 v19, s59, v23
  v_add_f32 v16, v18, v19
  v_sub_f32 v17, v18, v19
  v_pk_fma_f32 v[156:157], v[176:177], s[56:57], v[16:17] op_sel:[0,0,0] op_sel_hi:[1,0,0]
  v_pk_fma_f32 v[158:159], v[192:193], s[56:57], v[16:17] op_sel:[0,0,1] op_sel_hi:[1,0,1]
  v_pk_fma_f32 v[156:157], v[224:225], s[56:57], v[156:157] op_sel:[0,1,0] op_sel_hi:[1,1,1]
  v_pk_fma_f32 v[158:159], v[208:209], s[56:57], v[158:159] op_sel:[0,1,0] op_sel_hi:[1,1,1] neg_lo:[1,0,0] neg_hi:[1,0,0]
  s_waitcnt lgkmcnt(2)
  v_cvt_pk_f16_f32 v160, v156, v157
  v_cvt_pk_f16_f32 v161, v158, v159
  v_pk_mul_f16 v162, v160, v80
  v_pk_mul_f16 v163, v161, v80
  v_pk_fma_f16 v132, v161, v82, v162
  v_pk_fma_f16 v134, v160, v82, v163 neg_lo:[1,0,0] neg_hi:[1,0,0]
  v_pk_fma_f32 v[164:165], v[178:179], s[56:57], v[16:17] op_sel:[0,0,0] op_sel_hi:[1,0,0]
  v_pk_fma_f32 v[166:167], v[194:195], s[56:57], v[16:17] op_sel:[0,0,1] op_sel_hi:[1,0,1]
  v_pk_fma_f32 v[164:165], v[226:227], s[56:57], v[164:165] op_sel:[0,1,0] op_sel_hi:[1,1,1]
  v_pk_fma_f32 v[166:167], v[210:211], s[56:57], v[166:167] op_sel:[0,1,0] op_sel_hi:[1,1,1] neg_lo:[1,0,0] neg_hi:[1,0,0]
  v_cvt_pk_f16_f32 v168, v164, v165
  v_cvt_pk_f16_f32 v169, v166, v167
  v_pk_mul_f16 v170, v168, v81
  v_pk_mul_f16 v171, v169, v81
  v_pk_fma_f16 v133, v169, v83, v170
  v_pk_fma_f16 v135, v168, v83, v171 neg_lo:[1,0,0] neg_hi:[1,0,0]
  v_pk_fma_f32 v[156:157], v[180:181], s[56:57], v[16:17] op_sel:[0,0,0] op_sel_hi:[1,0,0]
  v_pk_fma_f32 v[158:159], v[196:197], s[56:57], v[16:17] op_sel:[0,0,1] op_sel_hi:[1,0,1]
  v_pk_fma_f32 v[156:157], v[228:229], s[56:57], v[156:157] op_sel:[0,1,0] op_sel_hi:[1,1,1]
  v_pk_fma_f32 v[158:159], v[212:213], s[56:57], v[158:159] op_sel:[0,1,0] op_sel_hi:[1,1,1] neg_lo:[1,0,0] neg_hi:[1,0,0]
  s_nop 1
  v_mfma_f32_32x32x16_f16 v[112:127], v[132:135], v[96:99], 0
  v_cvt_pk_f16_f32 v160, v156, v157
  v_cvt_pk_f16_f32 v161, v158, v159
  v_pk_mul_f16 v162, v160, v84
  v_pk_mul_f16 v163, v161, v84
  v_pk_fma_f16 v136, v161, v86, v162
  v_pk_fma_f16 v138, v160, v86, v163 neg_lo:[1,0,0] neg_hi:[1,0,0]
  v_pk_fma_f32 v[164:165], v[182:183], s[56:57], v[16:17] op_sel:[0,0,0] op_sel_hi:[1,0,0]
  v_pk_fma_f32 v[166:167], v[198:199], s[56:57], v[16:17] op_sel:[0,0,1] op_sel_hi:[1,0,1]
  v_pk_fma_f32 v[164:165], v[230:231], s[56:57], v[164:165] op_sel:[0,1,0] op_sel_hi:[1,1,1]
  v_pk_fma_f32 v[166:167], v[214:215], s[56:57], v[166:167] op_sel:[0,1,0] op_sel_hi:[1,1,1] neg_lo:[1,0,0] neg_hi:[1,0,0]
  v_cvt_pk_f16_f32 v168, v164, v165
  v_cvt_pk_f16_f32 v169, v166, v167
  v_pk_mul_f16 v170, v168, v85
  v_pk_mul_f16 v171, v169, v85
  v_pk_fma_f16 v137, v169, v87, v170
  v_pk_fma_f16 v139, v168, v87, v171 neg_lo:[1,0,0] neg_hi:[1,0,0]
  v_pk_fma_f32 v[156:157], v[184:185], s[56:57], v[16:17] op_sel:[0,0,0] op_sel_hi:[1,0,0]
  v_pk_fma_f32 v[158:159], v[200:201], s[56:57], v[16:17] op_sel:[0,0,1] op_sel_hi:[1,0,1]
  v_pk_fma_f32 v[156:157], v[232:233], s[56:57], v[156:157] op_sel:[0,1,0] op_sel_hi:[1,1,1]
  v_pk_fma_f32 v[158:159], v[216:217], s[56:57], v[158:159] op_sel:[0,1,0] op_sel_hi:[1,1,1] neg_lo:[1,0,0] neg_hi:[1,0,0]
  s_nop 1
  v_mfma_f32_32x32x16_f16 v[112:127], v[136:139], v[100:103], v[112:127]
  v_cvt_pk_f16_f32 v160, v156, v157
  v_cvt_pk_f16_f32 v161, v158, v159
  v_pk_mul_f16 v162, v160, v88
  v_pk_mul_f16 v163, v161, v88
  v_pk_fma_f16 v140, v161, v90, v162
  v_pk_fma_f16 v142, v160, v90, v163 neg_lo:[1,0,0] neg_hi:[1,0,0]
  v_pk_fma_f32 v[164:165], v[186:187], s[56:57], v[16:17] op_sel:[0,0,0] op_sel_hi:[1,0,0]
  v_pk_fma_f32 v[166:167], v[202:203], s[56:57], v[16:17] op_sel:[0,0,1] op_sel_hi:[1,0,1]
  v_pk_fma_f32 v[164:165], v[234:235], s[56:57], v[164:165] op_sel:[0,1,0] op_sel_hi:[1,1,1]
  v_pk_fma_f32 v[166:167], v[218:219], s[56:57], v[166:167] op_sel:[0,1,0] op_sel_hi:[1,1,1] neg_lo:[1,0,0] neg_hi:[1,0,0]
  v_cvt_pk_f16_f32 v168, v164, v165
  v_cvt_pk_f16_f32 v169, v166, v167
  v_pk_mul_f16 v170, v168, v89
  v_pk_mul_f16 v171, v169, v89
  v_pk_fma_f16 v141, v169, v91, v170
  v_pk_fma_f16 v143, v168, v91, v171 neg_lo:[1,0,0] neg_hi:[1,0,0]
  v_pk_fma_f32 v[156:157], v[188:189], s[56:57], v[16:17] op_sel:[0,0,0] op_sel_hi:[1,0,0]
  v_pk_fma_f32 v[158:159], v[204:205], s[56:57], v[16:17] op_sel:[0,0,1] op_sel_hi:[1,0,1]
  v_pk_fma_f32 v[156:157], v[236:237], s[56:57], v[156:157] op_sel:[0,1,0] op_sel_hi:[1,1,1]
  v_pk_fma_f32 v[158:159], v[220:221], s[56:57], v[158:159] op_sel:[0,1,0] op_sel_hi:[1,1,1] neg_lo:[1,0,0] neg_hi:[1,0,0]
  s_nop 1
  v_mfma_f32_32x32x16_f16 v[112:127], v[140:143], v[104:107], v[112:127]
  v_cvt_pk_f16_f32 v160, v156, v157
  v_cvt_pk_f16_f32 v161, v158, v159
  v_pk_mul_f16 v162, v160, v92
  v_pk_mul_f16 v163, v161, v92
  v_pk_fma_f16 v144, v161, v94, v162
  v_pk_fma_f16 v146, v160, v94, v163 neg_lo:[1,0,0] neg_hi:[1,0,0]
  v_pk_fma_f32 v[164:165], v[190:191], s[56:57], v[16:17] op_sel:[0,0,0] op_sel_hi:[1,0,0]
  v_pk_fma_f32 v[166:167], v[206:207], s[56:57], v[16:17] op_sel:[0,0,1] op_sel_hi:[1,0,1]
  v_pk_fma_f32 v[164:165], v[238:239], s[56:57], v[164:165] op_sel:[0,1,0] op_sel_hi:[1,1,1]
  v_pk_fma_f32 v[166:167], v[222:223], s[56:57], v[166:167] op_sel:[0,1,0] op_sel_hi:[1,1,1] neg_lo:[1,0,0] neg_hi:[1,0,0]
  v_cvt_pk_f16_f32 v168, v164, v165
  v_cvt_pk_f16_f32 v169, v166, v167
  v_pk_mul_f16 v170, v168, v93
  v_pk_mul_f16 v171, v169, v93
  v_pk_fma_f16 v145, v169, v95, v170
  v_pk_fma_f16 v147, v168, v95, v171 neg_lo:[1,0,0] neg_hi:[1,0,0]
  s_nop 1
  v_mfma_f32_32x32x16_f16 v[112:127], v[144:147], v[108:111], v[112:127]
  s_and_b32 s37, s24, 0x3333
  s_and_b32 s38, s24, 0xcccc
  s_lshl_b32 s38, s38, 14
  s_or_b32 s37, s37, s38
  s_and_b32 s25, s37, 0x30003
  s_lshr_b32 s38, s37, 4
  s_and_b32 s26, s38, 0x30003
  s_lshr_b32 s38, s37, 8
  s_and_b32 s27, s38, 0x30003
  s_lshr_b32 s38, s37, 12
  s_and_b32 s28, s38, 0x30003
  s_nop 0
  v_cvt_pk_f16_f32 v148, v112, v113
  v_cvt_pk_f16_f32 v149, v114, v115
  v_cvt_pk_f16_f32 v150, v116, v117
  v_cvt_pk_f16_f32 v151, v118, v119
  ds_write_b128 v12, v[148:151]
  v_cvt_pk_f16_f32 v152, v120, v121
  v_cvt_pk_f16_f32 v153, v122, v123
  v_cvt_pk_f16_f32 v154, v124, v125
  v_cvt_pk_f16_f32 v155, v126, v127
  ds_write_b128 v13, v[152:155]
  ds_write_b16_d16_hi v14, v151
  ds_write_b16_d16_hi v15, v155
  s_cmp_lg_u32 s62, 0
  s_cbranch_scc0 L_job2
L_jobx:
  s_lshl_b32 s37, s2, 14
  s_lshl_b32 s38, s3, 8
  s_add_u32 s37, s37, s38
  s_add_u32 s37, s37, 1048576
  s_waitcnt lgkmcnt(0)
  s_barrier
  ds_read_b64_tr_b16 v[132:133], v20 offset:0
  ds_read_b64_tr_b16 v[134:135], v20 offset:4352
  ds_read_b64_tr_b16 v[136:137], v20 offset:8
  ds_read_b64_tr_b16 v[138:139], v20 offset:4360
  ds_read_b64_tr_b16 v[140:141], v20 offset:256
  ds_read_b64_tr_b16 v[142:143], v20 offset:4608
  ds_read_b64_tr_b16 v[144:145], v20 offset:264
  ds_read_b64_tr_b16 v[146:147], v20 offset:4616
  s_cmp_lg_u32 s3, 6
  s_cbranch_scc1 L_noext0
  ds_read_u16 v176, v24 offset:0
  ds_read_u16 v180, v25 offset:0
  ds_read_u16 v177, v24 offset:2176
  ds_read_u16 v181, v25 offset:2176
  ds_read_u16 v178, v24 offset:4352
  ds_read_u16 v182, v25 offset:4352
  ds_read_u16 v179, v24 offset:6528
  ds_read_u16 v183, v25 offset:6528
  s_lshl_b32 s38, s2, 9
  s_add_u32 s38, s38, 65536
  s_add_u32 s39, s38, 64
  v_mov_b32 v193, s24
  v_mov_b32 v195, s24
  s_waitcnt lgkmcnt(0)
  v_lshl_or_b32 v176, v180, 16, v176
  v_lshl_or_b32 v177, v181, 16, v177
  v_lshl_or_b32 v178, v182, 16, v178
  v_lshl_or_b32 v179, v183, 16, v179
  s_nop 1
  v_mfma_f32_16x16x32_f16 v[188:191], v[128:131], v[176:179], 0
L_noext0:
  s_waitcnt lgkmcnt(6)
  v_mfma_f32_16x16x32_f16 v[156:159], v[128:131], v[132:135], 0
  s_waitcnt lgkmcnt(4)
  v_mfma_f32_16x16x32_f16 v[160:163], v[128:131], v[136:139], 0
  s_waitcnt lgkmcnt(2)
  v_mfma_f32_16x16x32_f16 v[164:167], v[128:131], v[140:143], 0
  s_waitcnt lgkmcnt(0)
  v_mfma_f32_16x16x32_f16 v[168:171], v[128:131], v[144:147], 0
  s_cmp_lg_u32 s3, 6
  s_cbranch_scc1 L_noext
  v_cvt_pk_f16_f32 v192, v188, v189
  v_cvt_pk_f16_f32 v194, v190, v191
  s_mov_b32 exec_lo, 0xff00ff
  s_mov_b32 exec_hi, 0xff00ff
  buffer_store_dwordx2 v[192:193], v26, s[8:11], s38 offen sc1
  buffer_store_dwordx2 v[194:195], v26, s[8:11], s39 offen sc1
  s_mov_b64 exec, -1
L_noext:
  s_nop 1
  v_cvt_pk_f16_f32 v148, v156, v160
  s_nop 2
  v_cvt_pk_f16_f32 v149, v164, v168
  v_cvt_pk_f16_f32 v150, v157, v161
  v_cvt_pk_f16_f32 v151, v165, v169
  v_add_u32 v148, 0x20002, v148
  v_add_u32 v149, 0x20002, v149
  v_add_u32 v150, 0x20002, v150
  v_add_u32 v151, 0x20002, v151
  v_and_or_b32 v148, v148, v11, s25
  v_and_or_b32 v149, v149, v11, s26
  v_and_or_b32 v150, v150, v11, s27
  v_and_or_b32 v151, v151, v11, s28
  buffer_store_dwordx4 v[148:151], v22, s[8:11], s37 offen offset:0 sc1
  v_cvt_pk_f16_f32 v152, v158, v162
  v_cvt_pk_f16_f32 v153, v166, v170
  v_cvt_pk_f16_f32 v154, v159, v163
  v_cvt_pk_f16_f32 v155, v167, v171
  v_add_u32 v152, 0x20002, v152
  v_add_u32 v153, 0x20002, v153
  v_add_u32 v154, 0x20002, v154
  v_add_u32 v155, 0x20002, v155
  v_and_or_b32 v152, v152, v11, s25
  v_and_or_b32 v153, v153, v11, s26
  v_and_or_b32 v154, v154, v11, s27
  v_and_or_b32 v155, v155, v11, s28
  buffer_store_dwordx4 v[152:155], v22, s[8:11], s37 offen offset:2048 sc1
  s_barrier
  s_lshl_b32 s37, s41, 15
  s_lshl_b32 s38, s3, 12
  s_add_u32 m0, s38, 79552
  s_add_u32 s37, s37, s38
  s_add_u32 s37, s37, 20480
  buffer_load_dwordx4 v2, s[16:19], s37 offen offset:0 lds
  buffer_load_dwordx4 v2, s[16:19], s37 offen offset:1024 lds
  buffer_load_dwordx4 v2, s[16:19], s37 offen offset:2048 lds
  buffer_load_dwordx4 v2, s[16:19], s37 offen offset:3072 lds
  buffer_load_dwordx4 v[240:243], v172, s[4:7], 0 offen
  buffer_load_dwordx4 v[244:247], v173, s[4:7], 0 offen
  buffer_load_dwordx4 v[248:251], v174, s[4:7], 0 offen
  buffer_load_dwordx4 v[252:255], v175, s[4:7], 0 offen
  ds_read_b128 v[4:7], v2 offset:48640
  ds_read_b128 v[8:11], v2 offset:49664
  ds_read_b64 v[230:231], v2 offset:50696
  v_and_b32 v228, 0x1f8, v0
  v_sub_u32 v229, 57336, v228
  v_add_u32 v228, 55808, v228
  s_and_b32 s52, s3, 3
  s_lshl_b32 s36, s52, 13
  s_add_u32 s36, s36, 79552
  v_add_u32 v236, s36, v2
  s_min_u32 s36, s2, 111
  s_lshl_b32 s36, s36, 3
  s_add_u32 s36, s36, s3
  s_lshl_b32 s36, s36, 13
  v_lshl_add_u32 v237, v1, 7, s36
  s_lshl_b32 s48, s40, 11
  s_lshl_b32 s49, s42, 8
  s_add_u32 s48, s48, s49
  s_add_u32 s48, s48, 1048576
  s_lshl_b32 s36, s3, 16
  s_sub_u32 s49, s48, s36
  s_add_u32 s48, s48, s36
  s_add_u32 s54, s48, 524288
  s_add_u32 s55, s49, 999424
  s_add_u32 s49, s49, 1523712
  s_cmp_eq_u32 s41, 0
  s_mov_b32 s50, 0xbc00bc00
  s_cmov_b32 s50, 0x3c003c00
  s_lshr_b32 s51, s3, 2
  s_cmp_eq_u32 s3, 0
  s_cselect_b32 s38, 0xffff, 0
  s_mov_b32 s39, 0
  v_mov_b32 v232, s25
  v_mov_b32 v233, s26
  v_mov_b32 v234, s27
  v_mov_b32 v235, s28
  v_mov_b32 v25, 0x40000000
  s_lshl_b32 s36, s3, 10
  s_lshl_b32 s37, s51, 6
  s_waitcnt lgkmcnt(0)
  v_add_u32 v24, 0x100000, v5
  v_add_u32 v6, s36, v6
  v_cndmask_b32_e64 v24, v24, v5, s[38:39]
  v_xor_b32 v7, s37, v7
  s_mul_i32 s36, s52, 4608
  s_lshl_b32 s37, s51, 5
  v_add_u32 v11, s36, v11
  s_add_u32 s36, s36, s37
  s_mul_i32 s37, s3, 1152
  v_add_u32 v9, s36, v9
  v_add_u32 v10, s37, v10
  s_cmp_lt_u32 s3, 5
  s_cbranch_scc1 L_y0
  s_cmp_eq_u32 s3, 5
  s_cbranch_scc1 L_y01
  s_cmp_eq_u32 s3, 6
  s_cbranch_scc1 L_y00
  s_and_b32 s45, s2, 7
  s_lshl_b32 s45, s45, 11
  s_add_u32 s45, s45, 131072
  buffer_load_dwordx4 v[164:167], v2, s[8:11], s45 offen sc1
  buffer_load_dwordx4 v[168:171], v2, s[8:11], s45 offen offset:1024 sc1
  s_branch L_y0
L_y01:
  s_sub_u32 s45, 16, s43
  s_and_b32 s45, s45, 15
  s_cselect_b32 s37, 0, 16
  s_lshl_b32 s45, s45, 12
  s_lshl_b32 s44, s43, 12
  s_add_u32 s45, s45, s37
  s_add_u32 s44, s44, 196608
  s_add_u32 s45, s45, 196608
  buffer_load_dwordx3 v[112:114], v2, s[8:11], s44 offen offset:0 sc1
  buffer_load_dwordx3 v[116:118], v2, s[8:11], s44 offen offset:1024 sc1
  buffer_load_dwordx3 v[120:122], v2, s[8:11], s45 offen offset:0 sc1
  buffer_load_dwordx3 v[124:126], v2, s[8:11], s45 offen offset:1024 sc1
  s_branch L_y0
L_y00:
  s_lshl_b32 s37, s40, 6
  s_lshl_b32 s38, s42, 3
  s_add_u32 s37, s37, s38
  s_add_u32 s45, s37, 65536
  buffer_load_dwordx2 v[164:165], v230, s[8:11], s45 offen sc1
  buffer_load_dwordx2 v[166:167], v231, s[8:11], s45 offen sc1
L_y0:
  buffer_load_dwordx4 v[96:99], v4, s[8:11], s48 offen sc1
  buffer_load_dwordx4 v[100:103], v24, s[8:11], s55 offen sc1
  buffer_load_dwordx4 v[104:107], v4, s[8:11], s54 offen sc1
  buffer_load_dwordx4 v[108:111], v5, s[8:11], s49 offen sc1
  global_load_dword v238, v237, s[30:31]
  s_cmp_lg_u32 s3, 5
  s_cbranch_scc1 L_y02
  s_mov_b32 s63, 0
  s_waitcnt vmcnt(5)
  s_branch P_1_c
P_1:
  buffer_load_dwordx3 v[112:114], v2, s[8:11], s44 offen offset:0 sc1
  buffer_load_dwordx3 v[116:118], v2, s[8:11], s44 offen offset:1024 sc1
  buffer_load_dwordx3 v[120:122], v2, s[8:11], s45 offen offset:0 sc1
  buffer_load_dwordx3 v[124:126], v2, s[8:11], s45 offen offset:1024 sc1
  s_waitcnt vmcnt(0)
P_1_c:
  v_cmp_ne_u32 vcc, s24, v114
  v_cmp_ne_u32 s[38:39], s24, v118
  s_or_b64 vcc, vcc, s[38:39]
  v_cmp_ne_u32 s[38:39], s24, v122
  s_or_b64 vcc, vcc, s[38:39]
  v_cmp_ne_u32 s[38:39], s24, v126
  s_or_b64 vcc, vcc, s[38:39]
  s_cbranch_vccz P_1_x
  s_add_u32 s63, s63, 1
  s_cmp_lt_u32 s63, 65536
  s_cbranch_scc1 P_1
P_1_x:
  v_lshlrev_b32 v16, 3, v1
  v_add_f32 v112, 1.0, v112
  ds_write_b64 v16, v[112:113] offset:55808
  v_add_f32 v116, 1.0, v116
  ds_write_b64 v16, v[116:117] offset:56320
  v_add_f32 v120, 1.0, v120
  ds_write_b64 v16, v[120:121] offset:56832
  v_add_f32 v124, 1.0, v124
  ds_write_b64 v16, v[124:125] offset:57344
L_y02:
  s_cmp_ge_u32 s3, 6
  s_cbranch_scc1 L_w7
  s_waitcnt vmcnt(5)
L_w7:
  s_waitcnt vmcnt(7) lgkmcnt(0)
  s_barrier
  ds_read2_b64 v[112:115], v228 offset1:64
  ds_read2_b64 v[116:119], v229 offset1:64
  ds_read_b128 v[32:35], v236 offset:0
  ds_read_b128 v[36:39], v236 offset:1024
  ds_read_b128 v[40:43], v236 offset:2048
  ds_read_b128 v[44:47], v236 offset:3072
  ds_read_b128 v[48:51], v236 offset:4096
  ds_read_b128 v[52:55], v236 offset:5120
  ds_read_b128 v[56:59], v236 offset:6144
  ds_read_b128 v[60:63], v236 offset:7168
  v_lshlrev_b32 v64, 16, v240
  v_and_b32 v65, 0xffff0000, v240
  s_waitcnt lgkmcnt(9)
  v_pk_fma_f32 v[64:65], v[64:65], v[112:113], v[112:113] op_sel:[0,0,1] op_sel_hi:[1,0,1] neg_lo:[0,0,1] neg_hi:[0,0,1]
  v_lshlrev_b32 v66, 16, v241
  v_and_b32 v67, 0xffff0000, v241
  v_pk_fma_f32 v[66:67], v[66:67], v[112:113], v[112:113] op_sel:[0,0,1] op_sel_hi:[1,0,1] neg_lo:[0,0,1] neg_hi:[0,0,1]
  v_lshlrev_b32 v68, 16, v242
  v_and_b32 v69, 0xffff0000, v242
  v_pk_fma_f32 v[68:69], v[68:69], v[112:113], v[112:113] op_sel:[0,0,1] op_sel_hi:[1,0,1] neg_lo:[0,0,1] neg_hi:[0,0,1]
  v_lshlrev_b32 v70, 16, v243
  v_and_b32 v71, 0xffff0000, v243
  v_pk_fma_f32 v[70:71], v[70:71], v[112:113], v[112:113] op_sel:[0,0,1] op_sel_hi:[1,0,1] neg_lo:[0,0,1] neg_hi:[0,0,1]
  v_lshlrev_b32 v80, 16, v248
  v_and_b32 v81, 0xffff0000, v248
  v_pk_fma_f32 v[80:81], v[80:81], v[114:115], v[114:115] op_sel:[0,0,1] op_sel_hi:[1,0,1] neg_lo:[0,0,1] neg_hi:[0,0,1]
  v_lshlrev_b32 v82, 16, v249
  v_and_b32 v83, 0xffff0000, v249
  v_pk_fma_f32 v[82:83], v[82:83], v[114:115], v[114:115] op_sel:[0,0,1] op_sel_hi:[1,0,1] neg_lo:[0,0,1] neg_hi:[0,0,1]
  v_lshlrev_b32 v84, 16, v250
  v_and_b32 v85, 0xffff0000, v250
  v_pk_fma_f32 v[84:85], v[84:85], v[114:115], v[114:115] op_sel:[0,0,1] op_sel_hi:[1,0,1] neg_lo:[0,0,1] neg_hi:[0,0,1]
  v_lshlrev_b32 v86, 16, v251
  v_and_b32 v87, 0xffff0000, v251
  v_pk_fma_f32 v[86:87], v[86:87], v[114:115], v[114:115] op_sel:[0,0,1] op_sel_hi:[1,0,1] neg_lo:[0,0,1] neg_hi:[0,0,1]
  v_lshlrev_b32 v88, 16, v252
  v_and_b32 v89, 0xffff0000, v252
  s_waitcnt lgkmcnt(8)
  v_pk_fma_f32 v[88:89], v[88:89], v[116:117], v[116:117] op_sel:[0,0,1] op_sel_hi:[1,0,1] neg_lo:[0,0,1] neg_hi:[0,0,1]
  v_lshlrev_b32 v90, 16, v253
  v_and_b32 v91, 0xffff0000, v253
  v_pk_fma_f32 v[90:91], v[90:91], v[116:117], v[116:117] op_sel:[0,0,1] op_sel_hi:[1,0,1] neg_lo:[0,0,1] neg_hi:[0,0,1]
  v_lshlrev_b32 v92, 16, v254
  v_and_b32 v93, 0xffff0000, v254
  v_pk_fma_f32 v[92:93], v[92:93], v[116:117], v[116:117] op_sel:[0,0,1] op_sel_hi:[1,0,1] neg_lo:[0,0,1] neg_hi:[0,0,1]
  v_lshlrev_b32 v94, 16, v255
  v_and_b32 v95, 0xffff0000, v255
  v_pk_fma_f32 v[94:95], v[94:95], v[116:117], v[116:117] op_sel:[0,0,1] op_sel_hi:[1,0,1] neg_lo:[0,0,1] neg_hi:[0,0,1]
  v_lshlrev_b32 v72, 16, v244
  v_and_b32 v73, 0xffff0000, v244
  v_pk_fma_f32 v[72:73], v[72:73], v[118:119], v[118:119] op_sel:[0,0,1] op_sel_hi:[1,0,1] neg_lo:[0,0,1] neg_hi:[0,0,1]
  v_lshlrev_b32 v74, 16, v245
  v_and_b32 v75, 0xffff0000, v245
  v_pk_fma_f32 v[74:75], v[74:75], v[118:119], v[118:119] op_sel:[0,0,1] op_sel_hi:[1,0,1] neg_lo:[0,0,1] neg_hi:[0,0,1]
  v_lshlrev_b32 v76, 16, v246
  v_and_b32 v77, 0xffff0000, v246
  v_pk_fma_f32 v[76:77], v[76:77], v[118:119], v[118:119] op_sel:[0,0,1] op_sel_hi:[1,0,1] neg_lo:[0,0,1] neg_hi:[0,0,1]
  v_lshlrev_b32 v78, 16, v247
  v_and_b32 v79, 0xffff0000, v247
  v_pk_fma_f32 v[78:79], v[78:79], v[118:119], v[118:119] op_sel:[0,0,1] op_sel_hi:[1,0,1] neg_lo:[0,0,1] neg_hi:[0,0,1]
  s_cmp_lg_u32 s3, 7
  s_cbranch_scc1 L_y1
  s_mov_b32 s63, 0
  s_waitcnt vmcnt(5)
  s_branch P_2_c
P_2:
  buffer_load_dwordx4 v[164:167], v2, s[8:11], s45 offen sc1
  buffer_load_dwordx4 v[168:171], v2, s[8:11], s45 offen offset:1024 sc1
  s_waitcnt vmcnt(0)
P_2_c:
  v_cmp_ne_u32 vcc, s24, v166
  v_cmp_ne_u32 s[38:39], s24, v170
  s_or_b64 vcc, vcc, s[38:39]
  s_cbranch_vccz P_2_x
  s_add_u32 s63, s63, 1
  s_cmp_lt_u32 s63, 65536
  s_cbranch_scc1 P_2
P_2_x:
  v_max_u32 v166, v164, v168
  v_min_u32 v170, v164, v168
  v_max3_u32 v167, v170, v165, v169
  s_nop 0
  v_min_u32_dpp v170, v166, v166 row_ror:8 row_mask:0xf bank_mask:0xf
  v_max_u32_dpp v167, v167, v167 row_ror:8 row_mask:0xf bank_mask:0xf
  v_max_u32_dpp v166, v166, v166 row_ror:8 row_mask:0xf bank_mask:0xf
  v_max_u32 v167, v167, v170
  s_nop 0
  v_min_u32_dpp v170, v166, v166 row_ror:4 row_mask:0xf bank_mask:0xf
  v_max_u32_dpp v167, v167, v167 row_ror:4 row_mask:0xf bank_mask:0xf
  v_max_u32_dpp v166, v166, v166 row_ror:4 row_mask:0xf bank_mask:0xf
  v_max_u32 v167, v167, v170
  s_nop 0
  v_min_u32_dpp v170, v166, v166 row_ror:2 row_mask:0xf bank_mask:0xf
  v_max_u32_dpp v167, v167, v167 row_ror:2 row_mask:0xf bank_mask:0xf
  v_max_u32_dpp v166, v166, v166 row_ror:2 row_mask:0xf bank_mask:0xf
  v_max_u32 v167, v167, v170
  s_nop 0
  v_min_u32_dpp v170, v166, v166 row_ror:1 row_mask:0xf bank_mask:0xf
  v_max_u32_dpp v167, v167, v167 row_ror:1 row_mask:0xf bank_mask:0xf
  v_max_u32_dpp v166, v166, v166 row_ror:1 row_mask:0xf bank_mask:0xf
  v_max_u32 v167, v167, v170
  s_nop 0
  v_min_u32_dpp v170, v166, v166 row_bcast:15 row_mask:0xa bank_mask:0xf
  v_max_u32_dpp v167, v167, v167 row_bcast:15 row_mask:0xa bank_mask:0xf
  v_max_u32_dpp v166, v166, v166 row_bcast:15 row_mask:0xa bank_mask:0xf
  v_max_u32 v167, v167, v170
  s_nop 0
  v_min_u32_dpp v170, v166, v166 row_bcast:31 row_mask:0xc bank_mask:0xf
  v_max_u32_dpp v167, v167, v167 row_bcast:31 row_mask:0xc bank_mask:0xf
  v_max_u32_dpp v166, v166, v166 row_bcast:31 row_mask:0xc bank_mask:0xf
  v_max_u32 v167, v167, v170
  v_readlane_b32 s46, v166, 63
  v_readlane_b32 s47, v167, 63
  s_nop 0
  v_mov_b32 v16, s46
  v_mov_b32 v17, s47
  v_mov_b32 v18, 0
  ds_write_b64 v18, v[16:17] offset:59904
L_y1:
  s_cmp_lg_u32 s3, 6
  s_cbranch_scc1 L_y2
  s_mov_b32 s63, 0
  s_waitcnt vmcnt(5)
  s_branch P_3_c
P_3:
  buffer_load_dwordx2 v[164:165], v230, s[8:11], s45 offen sc1
  buffer_load_dwordx2 v[166:167], v231, s[8:11], s45 offen sc1
  s_waitcnt vmcnt(0)
P_3_c:
  v_cmp_ne_u32 vcc, s24, v165
  v_cmp_ne_u32 s[38:39], s24, v167
  s_or_b64 vcc, vcc, s[38:39]
  s_cbranch_vccz P_3_x
  s_add_u32 s63, s63, 1
  s_cmp_lt_u32 s63, 65536
  s_cbranch_scc1 P_3
P_3_x:
  s_cmp_eq_u32 s41, 0
  s_mov_b32 s38, 0x07060100
  s_cmov_b32 s38, 0x05040100
  v_lshrrev_b32 v17, 16, v164
  v_perm_b32 v16, v166, v164, s38
  s_mov_b64 exec, 1
  v_mov_b32 v164, v16
  v_mov_b32 v166, v17
  s_mov_b64 exec, -1
  v_lshrrev_b32 v18, 7, v230
  v_pk_fma_f16 v164, v166, s50, v164 neg_hi:[0,1,0]
  ds_write_b32 v18, v164 offset:16384
L_y2:
  s_mov_b32 s63, 0
  s_waitcnt vmcnt(1)
  s_branch P_4_c
P_4:
  buffer_load_dwordx4 v[96:99], v4, s[8:11], s48 offen sc1
  buffer_load_dwordx4 v[100:103], v24, s[8:11], s55 offen sc1
  buffer_load_dwordx4 v[104:107], v4, s[8:11], s54 offen sc1
  buffer_load_dwordx4 v[108:111], v5, s[8:11], s49 offen sc1
  s_waitcnt vmcnt(0)
P_4_c:
  v_xor_b32 v96, v232, v96
  v_xor_b32 v97, v233, v97
  v_xor_b32 v98, v234, v98
  v_xor_b32 v99, v235, v99
  v_xor_b32 v100, v232, v100
  v_xor_b32 v101, v233, v101
  v_xor_b32 v102, v234, v102
  v_xor_b32 v103, v235, v103
  v_xor_b32 v104, v232, v104
  v_xor_b32 v105, v233, v105
  v_xor_b32 v106, v234, v106
  v_xor_b32 v107, v235, v107
  v_xor_b32 v108, v232, v108
  v_xor_b32 v109, v233, v109
  v_xor_b32 v110, v234, v110
  v_xor_b32 v111, v235, v111
  v_or3_b32 v16, v96, v97, v98
  v_or3_b32 v16, v16, v99, v100
  v_or3_b32 v16, v16, v101, v102
  v_or3_b32 v16, v16, v103, v104
  v_or3_b32 v16, v16, v105, v106
  v_or3_b32 v16, v16, v107, v108
  v_or3_b32 v16, v16, v109, v110
  v_or_b32 v16, v16, v111
  v_and_b32 v16, 0x30003, v16
  v_cmp_ne_u32 vcc, 0, v16
  s_cbranch_vccz P_4_x
  s_add_u32 s63, s63, 1
  s_cmp_lt_u32 s63, 65536
  s_cbranch_scc1 P_4
P_4_x:
  s_cmp_lg_u32 s3, 0
  s_cbranch_scc1 L_y3
  s_cmp_eq_u32 s41, 0
  s_cselect_b64 s[38:39], 0, -1
  s_mov_b64 exec, 0xffff
  v_cndmask_b32_e64 v16, v100, v102, s[38:39]
  v_cndmask_b32_e64 v17, v101, v103, s[38:39]
  v_mov_b32 v100, v98
  v_mov_b32 v101, v99
  v_mov_b32 v98, v16
  v_mov_b32 v99, v17
  v_mov_b32 v102, 0
  v_mov_b32 v103, 0
  s_mov_b64 exec, -1
L_y3:
  v_pk_fma_f16 v96, v100, s50, v96
  v_pk_fma_f16 v97, v101, s50, v97
  v_pk_fma_f16 v98, v102, s50, v98 neg_lo:[0,1,0] neg_hi:[0,1,0]
  v_pk_fma_f16 v99, v103, s50, v99 neg_lo:[0,1,0] neg_hi:[0,1,0]
  ds_write_b128 v6, v[96:99] offset:0
  v_pk_fma_f16 v104, v108, s50, v104
  v_pk_fma_f16 v105, v109, s50, v105
  v_pk_fma_f16 v106, v110, s50, v106 neg_lo:[0,1,0] neg_hi:[0,1,0]
  v_pk_fma_f16 v107, v111, s50, v107 neg_lo:[0,1,0] neg_hi:[0,1,0]
  ds_write_b128 v6, v[104:107] offset:8192
  v_mov_b32 v18, 0
  s_waitcnt lgkmcnt(0)
  s_barrier
  ds_read_b64 v[16:17], v18 offset:59904
  s_cmp_lg_u32 s51, 0
  s_cbranch_scc1 L_y4
  ds_read_b64_tr_b16 v[132:133], v7 offset:0
  ds_read_b64_tr_b16 v[134:135], v7 offset:512
  ds_read_b64_tr_b16 v[136:137], v7 offset:2048
  ds_read_b64_tr_b16 v[138:139], v7 offset:2560
  ds_read_b64_tr_b16 v[140:141], v7 offset:4096
  ds_read_b64_tr_b16 v[142:143], v7 offset:4608
  ds_read_b64_tr_b16 v[144:145], v7 offset:6144
  ds_read_b64_tr_b16 v[146:147], v7 offset:6656
  ds_read_b64_tr_b16 v[148:149], v7 offset:8192
  ds_read_b64_tr_b16 v[150:151], v7 offset:8704
  ds_read_b64_tr_b16 v[152:153], v7 offset:10240
  ds_read_b64_tr_b16 v[154:155], v7 offset:10752
  ds_read_b64_tr_b16 v[156:157], v7 offset:12288
  ds_read_b64_tr_b16 v[158:159], v7 offset:12800
  s_waitcnt lgkmcnt(12)
  v_mfma_f32_32x32x16_f16 v[208:223], v[132:135], v[32:35], 0
  ds_read_b64_tr_b16 v[160:161], v7 offset:14336
  ds_read_b64_tr_b16 v[162:163], v7 offset:14848
  s_waitcnt lgkmcnt(12)
  v_mfma_f32_32x32x16_f16 v[208:223], v[136:139], v[36:39], v[208:223]
  s_waitcnt lgkmcnt(10)
  v_mfma_f32_32x32x16_f16 v[208:223], v[140:143], v[40:43], v[208:223]
  s_waitcnt lgkmcnt(8)
  v_mfma_f32_32x32x16_f16 v[208:223], v[144:147], v[44:47], v[208:223]
  v_readfirstlane_b32 s46, v16
  v_readfirstlane_b32 s47, v17
  s_and_b32 s46, s46, 0xffff
  s_and_b32 s47, s47, 0xffff
  s_sub_u32 s46, 0xffff, s46
  s_sub_u32 s47, 0xffff, s47
  v_lshrrev_b32 v16, 11, v172
  v_cmp_eq_u32 s[52:53], s46, v16
  v_cmp_eq_u32 vcc, s47, v16
  s_or_b64 s[52:53], s[52:53], vcc
  v_cndmask_b32_e64 v20, v172, v25, s[52:53]
  v_lshrrev_b32 v16, 11, v173
  v_cmp_eq_u32 s[54:55], s46, v16
  v_cmp_eq_u32 vcc, s47, v16
  s_or_b64 s[54:55], s[54:55], vcc
  v_cndmask_b32_e64 v21, v173, v25, s[54:55]
  v_lshrrev_b32 v16, 11, v174
  v_cmp_eq_u32 s[56:57], s46, v16
  v_cmp_eq_u32 vcc, s47, v16
  s_or_b64 s[56:57], s[56:57], vcc
  v_cndmask_b32_e64 v22, v174, v25, s[56:57]
  v_lshrrev_b32 v16, 11, v175
  v_cmp_eq_u32 s[58:59], s46, v16
  v_cmp_eq_u32 vcc, s47, v16
  s_or_b64 s[58:59], s[58:59], vcc
  v_cndmask_b32_e64 v23, v175, v25, s[58:59]
  s_waitcnt lgkmcnt(6)
  v_mfma_f32_32x32x16_f16 v[208:223], v[148:151], v[48:51], v[208:223]
  s_waitcnt lgkmcnt(4)
  v_mfma_f32_32x32x16_f16 v[208:223], v[152:155], v[52:55], v[208:223]
  s_waitcnt lgkmcnt(2)
  v_mfma_f32_32x32x16_f16 v[208:223], v[156:159], v[56:59], v[208:223]
  s_waitcnt lgkmcnt(0)
  v_mfma_f32_32x32x16_f16 v[208:223], v[160:163], v[60:63], v[208:223]
  s_nop 11
  v_cvt_pk_f16_f32 v112, v221, v208
  v_cvt_pk_f16_f32 v113, v212, v216
  v_cvt_pk_f16_f32 v114, v220, v209
  v_cvt_pk_f16_f32 v115, v213, v217
  ds_write_b128 v9, v[112:115] offset:16896
  v_cvt_pk_f16_f32 v116, v210, v214
  v_cvt_pk_f16_f32 v117, v218, v222
  v_cvt_pk_f16_f32 v118, v211, v215
  v_cvt_pk_f16_f32 v119, v219, v223
  ds_write_b128 v9, v[116:119] offset:16912
  s_branch L_y5
L_y4:
  ds_read_b64_tr_b16 v[132:133], v7 offset:0
  ds_read_b64_tr_b16 v[134:135], v7 offset:512
  ds_read_b128 v[176:179], v8 offset:16384
  ds_read_b64_tr_b16 v[136:137], v7 offset:2048
  ds_read_b64_tr_b16 v[138:139], v7 offset:2560
  ds_read_b128 v[180:183], v8 offset:16416
  ds_read_b64_tr_b16 v[140:141], v7 offset:4096
  ds_read_b64_tr_b16 v[142:143], v7 offset:4608
  ds_read_b128 v[184:187], v8 offset:16448
  ds_read_b64_tr_b16 v[144:145], v7 offset:6144
  ds_read_b64_tr_b16 v[146:147], v7 offset:6656
  ds_read_b128 v[188:191], v8 offset:16480
  s_waitcnt lgkmcnt(10)
  v_mfma_f32_32x32x16_f16 v[208:223], v[132:135], v[32:35], 0
  ds_read_b64_tr_b16 v[148:149], v7 offset:8192
  ds_read_b64_tr_b16 v[150:151], v7 offset:8704
  ds_read_b128 v[192:195], v8 offset:16512
  v_readfirstlane_b32 s46, v16
  v_readfirstlane_b32 s47, v17
  s_and_b32 s46, s46, 0xffff
  s_and_b32 s47, s47, 0xffff
  s_sub_u32 s46, 0xffff, s46
  s_sub_u32 s47, 0xffff, s47
  v_lshrrev_b32 v16, 11, v172
  v_cmp_eq_u32 s[52:53], s46, v16
  v_cmp_eq_u32 vcc, s47, v16
  s_or_b64 s[52:53], s[52:53], vcc
  v_cndmask_b32_e64 v20, v172, v25, s[52:53]
  v_lshrrev_b32 v16, 11, v173
  v_cmp_eq_u32 s[54:55], s46, v16
  v_cmp_eq_u32 vcc, s47, v16
  s_or_b64 s[54:55], s[54:55], vcc
  v_cndmask_b32_e64 v21, v173, v25, s[54:55]
  v_lshrrev_b32 v16, 11, v174
  v_cmp_eq_u32 s[56:57], s46, v16
  v_cmp_eq_u32 vcc, s47, v16
  s_or_b64 s[56:57], s[56:57], vcc
  v_cndmask_b32_e64 v22, v174, v25, s[56:57]
  v_lshrrev_b32 v16, 11, v175
  v_cmp_eq_u32 s[58:59], s46, v16
  v_cmp_eq_u32 vcc, s47, v16
  s_or_b64 s[58:59], s[58:59], vcc
  v_cndmask_b32_e64 v23, v175, v25, s[58:59]
  s_waitcnt lgkmcnt(10)
  v_mfma_f32_32x32x16_f16 v[208:223], v[136:139], v[36:39], v[208:223]
  ds_read_b64_tr_b16 v[152:153], v7 offset:10240
  ds_read_b64_tr_b16 v[154:155], v7 offset:10752
  ds_read_b128 v[196:199], v8 offset:16544
  v_pk_mul_f16 v224, v32, v176
  v_pk_mul_f16 v225, v33, v177
  v_pk_mul_f16 v226, v34, v178
  v_pk_mul_f16 v227, v35, v179
  s_waitcnt lgkmcnt(10)
  v_mfma_f32_32x32x16_f16 v[208:223], v[140:143], v[40:43], v[208:223]
  ds_read_b64_tr_b16 v[156:157], v7 offset:12288
  ds_read_b64_tr_b16 v[158:159], v7 offset:12800
  ds_read_b128 v[200:203], v8 offset:16576
  v_pk_fma_f16 v224, v36, v180, v224
  v_pk_fma_f16 v225, v37, v181, v225
  v_pk_fma_f16 v226, v38, v182, v226
  v_pk_fma_f16 v227, v39, v183, v227
  s_waitcnt lgkmcnt(10)
  v_mfma_f32_32x32x16_f16 v[208:223], v[144:147], v[44:47], v[208:223]
  ds_read_b64_tr_b16 v[160:161], v7 offset:14336
  ds_read_b64_tr_b16 v[162:163], v7 offset:14848
  ds_read_b128 v[204:207], v8 offset:16608
  v_pk_fma_f16 v224, v40, v184, v224
  v_pk_fma_f16 v225, v41, v185, v225
  v_pk_fma_f16 v226, v42, v186, v226
  v_pk_fma_f16 v227, v43, v187, v227
  s_waitcnt lgkmcnt(10)
  v_mfma_f32_32x32x16_f16 v[208:223], v[148:151], v[48:51], v[208:223]
  v_pk_fma_f16 v224, v44, v188, v224
  v_pk_fma_f16 v225, v45, v189, v225
  v_pk_fma_f16 v226, v46, v190, v226
  v_pk_fma_f16 v227, v47, v191, v227
  s_waitcnt lgkmcnt(7)
  v_mfma_f32_32x32x16_f16 v[208:223], v[152:155], v[52:55], v[208:223]
  v_pk_fma_f16 v224, v48, v192, v224
  v_pk_fma_f16 v225, v49, v193, v225
  v_pk_fma_f16 v226, v50, v194, v226
  v_pk_fma_f16 v227, v51, v195, v227
  s_waitcnt lgkmcnt(4)
  v_mfma_f32_32x32x16_f16 v[208:223], v[156:159], v[56:59], v[208:223]
  v_pk_fma_f16 v224, v52, v196, v224
  v_pk_fma_f16 v225, v53, v197, v225
  v_pk_fma_f16 v226, v54, v198, v226
  v_pk_fma_f16 v227, v55, v199, v227
  s_waitcnt lgkmcnt(1)
  v_mfma_f32_32x32x16_f16 v[208:223], v[160:163], v[60:63], v[208:223]
  v_pk_fma_f16 v224, v56, v200, v224
  v_pk_fma_f16 v225, v57, v201, v225
  v_pk_fma_f16 v226, v58, v202, v226
  v_pk_fma_f16 v227, v59, v203, v227
  s_waitcnt lgkmcnt(0)
  v_pk_fma_f16 v224, v60, v204, v224
  v_pk_fma_f16 v225, v61, v205, v225
  v_pk_fma_f16 v226, v62, v206, v226
  v_pk_fma_f16 v227, v63, v207, v227
  s_mov_b32 s37, 0x3c003c00
  v_pk_add_f16 v224, v224, v225
  v_pk_add_f16 v226, v226, v227
  v_dot2c_f32_f16 v18, s37, v224
  v_dot2c_f32_f16 v18, s37, v226
  s_nop 2
  v_mov_b32 v19, v18
  s_nop 1
  v_permlane32_swap_b32 v18, v19
  v_add_f32 v18, v18, v19
  v_cvt_f16_f32 v18, v18
  ds_write_b16 v11, v18 offset:16896
  v_cvt_pk_f16_f32 v112, v221, v223
  v_cvt_pk_f16_f32 v113, v219, v215
  v_cvt_pk_f16_f32 v114, v211, v222
  v_cvt_pk_f16_f32 v115, v218, v214
  ds_write_b128 v9, v[112:115] offset:16896
  v_cvt_pk_f16_f32 v116, v210, v217
  v_cvt_pk_f16_f32 v117, v213, v209
  v_cvt_pk_f16_f32 v118, v220, v216
  v_cvt_pk_f16_f32 v119, v212, v208
  ds_write_b128 v9, v[116:119] offset:16912
L_y5:
  s_mov_b32 s37, 0x42800000
  s_or_b64 s[60:61], s[52:53], s[54:55]
  s_or_b64 s[38:39], s[56:57], s[58:59]
  s_waitcnt lgkmcnt(0)
  s_barrier
  ds_read_b128 v[96:99], v10 offset:16896
  ds_read_u16 v100, v10 offset:16912
  ds_read_b128 v[104:107], v10 offset:26112
  ds_read_u16 v108, v10 offset:26128
  s_or_b64 s[60:61], s[60:61], s[38:39]
  s_cbranch_scc1 L_sel
  s_waitcnt lgkmcnt(3)
  v_fma_mix_f32 v64, v96, s37, v64 op_sel:[0,0,0] op_sel_hi:[1,0,0]
  v_fma_mix_f32 v65, v96, s37, v65 op_sel:[1,0,0] op_sel_hi:[1,0,0]
  v_fma_mix_f32 v66, v97, s37, v66 op_sel:[0,0,0] op_sel_hi:[1,0,0]
  v_fma_mix_f32 v67, v97, s37, v67 op_sel:[1,0,0] op_sel_hi:[1,0,0]
  v_fma_mix_f32 v68, v98, s37, v68 op_sel:[0,0,0] op_sel_hi:[1,0,0]
  v_fma_mix_f32 v69, v98, s37, v69 op_sel:[1,0,0] op_sel_hi:[1,0,0]
  v_fma_mix_f32 v70, v99, s37, v70 op_sel:[0,0,0] op_sel_hi:[1,0,0]
  v_fma_mix_f32 v71, v99, s37, v71 op_sel:[1,0,0] op_sel_hi:[1,0,0]
  v_cvt_pk_bf16_f32 v132, v64, v65
  v_cvt_pk_bf16_f32 v133, v66, v67
  v_cvt_pk_bf16_f32 v134, v68, v69
  v_cvt_pk_bf16_f32 v135, v70, v71
  buffer_store_dwordx4 v[132:135], v20, s[12:15], 0 offen
  s_waitcnt lgkmcnt(2)
  v_fma_mix_f32 v72, v100, s37, v72 op_sel:[0,0,0] op_sel_hi:[1,0,0]
  v_fma_mix_f32 v73, v99, s37, v73 op_sel:[1,0,0] op_sel_hi:[1,0,0]
  v_fma_mix_f32 v74, v99, s37, v74 op_sel:[0,0,0] op_sel_hi:[1,0,0]
  v_fma_mix_f32 v75, v98, s37, v75 op_sel:[1,0,0] op_sel_hi:[1,0,0]
  v_fma_mix_f32 v76, v98, s37, v76 op_sel:[0,0,0] op_sel_hi:[1,0,0]
  v_fma_mix_f32 v77, v97, s37, v77 op_sel:[1,0,0] op_sel_hi:[1,0,0]
  v_fma_mix_f32 v78, v97, s37, v78 op_sel:[0,0,0] op_sel_hi:[1,0,0]
  v_fma_mix_f32 v79, v96, s37, v79 op_sel:[1,0,0] op_sel_hi:[1,0,0]
  v_cvt_pk_bf16_f32 v136, v72, v73
  v_cvt_pk_bf16_f32 v137, v74, v75
  v_cvt_pk_bf16_f32 v138, v76, v77
  v_cvt_pk_bf16_f32 v139, v78, v79
  buffer_store_dwordx4 v[136:139], v21, s[12:15], 0 offen
  s_waitcnt lgkmcnt(1)
  v_fma_mix_f32 v80, v104, s37, v80 op_sel:[0,0,0] op_sel_hi:[1,0,0]
  v_fma_mix_f32 v81, v104, s37, v81 op_sel:[1,0,0] op_sel_hi:[1,0,0]
  v_fma_mix_f32 v82, v105, s37, v82 op_sel:[0,0,0] op_sel_hi:[1,0,0]
  v_fma_mix_f32 v83, v105, s37, v83 op_sel:[1,0,0] op_sel_hi:[1,0,0]
  v_fma_mix_f32 v84, v106, s37, v84 op_sel:[0,0,0] op_sel_hi:[1,0,0]
  v_fma_mix_f32 v85, v106, s37, v85 op_sel:[1,0,0] op_sel_hi:[1,0,0]
  v_fma_mix_f32 v86, v107, s37, v86 op_sel:[0,0,0] op_sel_hi:[1,0,0]
  v_fma_mix_f32 v87, v107, s37, v87 op_sel:[1,0,0] op_sel_hi:[1,0,0]
  v_cvt_pk_bf16_f32 v140, v80, v81
  v_cvt_pk_bf16_f32 v141, v82, v83
  v_cvt_pk_bf16_f32 v142, v84, v85
  v_cvt_pk_bf16_f32 v143, v86, v87
  buffer_store_dwordx4 v[140:143], v22, s[12:15], 0 offen
  s_waitcnt lgkmcnt(0)
  v_fma_mix_f32 v88, v108, s37, v88 op_sel:[0,0,0] op_sel_hi:[1,0,0]
  v_fma_mix_f32 v89, v107, s37, v89 op_sel:[1,0,0] op_sel_hi:[1,0,0]
  v_fma_mix_f32 v90, v107, s37, v90 op_sel:[0,0,0] op_sel_hi:[1,0,0]
  v_fma_mix_f32 v91, v106, s37, v91 op_sel:[1,0,0] op_sel_hi:[1,0,0]
  v_fma_mix_f32 v92, v106, s37, v92 op_sel:[0,0,0] op_sel_hi:[1,0,0]
  v_fma_mix_f32 v93, v105, s37, v93 op_sel:[1,0,0] op_sel_hi:[1,0,0]
  v_fma_mix_f32 v94, v105, s37, v94 op_sel:[0,0,0] op_sel_hi:[1,0,0]
  v_fma_mix_f32 v95, v104, s37, v95 op_sel:[1,0,0] op_sel_hi:[1,0,0]
  v_cvt_pk_bf16_f32 v144, v88, v89
  v_cvt_pk_bf16_f32 v145, v90, v91
  v_cvt_pk_bf16_f32 v146, v92, v93
  v_cvt_pk_bf16_f32 v147, v94, v95
  buffer_store_dwordx4 v[144:147], v23, s[12:15], 0 offen
  s_branch L_fin
L_sel:
  s_waitcnt lgkmcnt(3)
  v_fma_mix_f32 v64, v96, s37, v64 op_sel:[0,0,0] op_sel_hi:[1,0,0]
  v_fma_mix_f32 v65, v96, s37, v65 op_sel:[1,0,0] op_sel_hi:[1,0,0]
  v_fma_mix_f32 v66, v97, s37, v66 op_sel:[0,0,0] op_sel_hi:[1,0,0]
  v_fma_mix_f32 v67, v97, s37, v67 op_sel:[1,0,0] op_sel_hi:[1,0,0]
  v_fma_mix_f32 v68, v98, s37, v68 op_sel:[0,0,0] op_sel_hi:[1,0,0]
  v_fma_mix_f32 v69, v98, s37, v69 op_sel:[1,0,0] op_sel_hi:[1,0,0]
  v_fma_mix_f32 v70, v99, s37, v70 op_sel:[0,0,0] op_sel_hi:[1,0,0]
  v_fma_mix_f32 v71, v99, s37, v71 op_sel:[1,0,0] op_sel_hi:[1,0,0]
  s_cmp_eq_u64 s[52:53], 0
  s_cbranch_scc1 L_selx0
  s_mov_b64 exec, s[52:53]
  v_lshrrev_b32 v16, 11, v172
  v_and_b32 v17, 2047, v172
  v_cmp_eq_u32 vcc, s47, v16
  v_lshlrev_b32 v17, 1, v17
  v_add_u32 v16, 4096, v17
  v_mov_b32 v18, 0xffffff00
  v_cndmask_b32_e64 v16, v17, v16, vcc
  s_mov_b32 s38, 4096
  v_and_or_b32 v176, v64, v18, s29
  v_and_or_b32 v177, v65, v18, s29
  v_and_or_b32 v178, v66, v18, s29
  v_and_or_b32 v179, v67, v18, s29
  v_and_or_b32 v180, v68, v18, s29
  v_and_or_b32 v181, v69, v18, s29
  v_and_or_b32 v182, v70, v18, s29
  v_and_or_b32 v183, v71, v18, s29
  buffer_store_dwordx4 v[176:179], v16, s[8:11], s38 offen sc1
  buffer_store_dwordx4 v[180:183], v16, s[8:11], s38 offen offset:16 sc1
  s_mov_b64 exec, -1
L_selx0:
  v_cvt_pk_bf16_f32 v132, v64, v65
  v_cvt_pk_bf16_f32 v133, v66, v67
  v_cvt_pk_bf16_f32 v134, v68, v69
  v_cvt_pk_bf16_f32 v135, v70, v71
  buffer_store_dwordx4 v[132:135], v20, s[12:15], 0 offen
  s_waitcnt lgkmcnt(2)
  v_fma_mix_f32 v72, v100, s37, v72 op_sel:[0,0,0] op_sel_hi:[1,0,0]
  v_fma_mix_f32 v73, v99, s37, v73 op_sel:[1,0,0] op_sel_hi:[1,0,0]
  v_fma_mix_f32 v74, v99, s37, v74 op_sel:[0,0,0] op_sel_hi:[1,0,0]
  v_fma_mix_f32 v75, v98, s37, v75 op_sel:[1,0,0] op_sel_hi:[1,0,0]
  v_fma_mix_f32 v76, v98, s37, v76 op_sel:[0,0,0] op_sel_hi:[1,0,0]
  v_fma_mix_f32 v77, v97, s37, v77 op_sel:[1,0,0] op_sel_hi:[1,0,0]
  v_fma_mix_f32 v78, v97, s37, v78 op_sel:[0,0,0] op_sel_hi:[1,0,0]
  v_fma_mix_f32 v79, v96, s37, v79 op_sel:[1,0,0] op_sel_hi:[1,0,0]
  s_cmp_eq_u64 s[54:55], 0
  s_cbranch_scc1 L_selx1
  s_mov_b64 exec, s[54:55]
  v_lshrrev_b32 v16, 11, v173
  v_and_b32 v17, 2047, v173
  v_cmp_eq_u32 vcc, s47, v16
  v_lshlrev_b32 v17, 1, v17
  v_add_u32 v16, 4096, v17
  v_mov_b32 v18, 0xffffff00
  v_cndmask_b32_e64 v16, v17, v16, vcc
  s_mov_b32 s38, 4096
  v_and_or_b32 v176, v72, v18, s29
  v_and_or_b32 v177, v73, v18, s29
  v_and_or_b32 v178, v74, v18, s29
  v_and_or_b32 v179, v75, v18, s29
  v_and_or_b32 v180, v76, v18, s29
  v_and_or_b32 v181, v77, v18, s29
  v_and_or_b32 v182, v78, v18, s29
  v_and_or_b32 v183, v79, v18, s29
  buffer_store_dwordx4 v[176:179], v16, s[8:11], s38 offen sc1
  buffer_store_dwordx4 v[180:183], v16, s[8:11], s38 offen offset:16 sc1
  s_mov_b64 exec, -1
L_selx1:
  v_cvt_pk_bf16_f32 v136, v72, v73
  v_cvt_pk_bf16_f32 v137, v74, v75
  v_cvt_pk_bf16_f32 v138, v76, v77
  v_cvt_pk_bf16_f32 v139, v78, v79
  buffer_store_dwordx4 v[136:139], v21, s[12:15], 0 offen
  s_waitcnt lgkmcnt(1)
  v_fma_mix_f32 v80, v104, s37, v80 op_sel:[0,0,0] op_sel_hi:[1,0,0]
  v_fma_mix_f32 v81, v104, s37, v81 op_sel:[1,0,0] op_sel_hi:[1,0,0]
  v_fma_mix_f32 v82, v105, s37, v82 op_sel:[0,0,0] op_sel_hi:[1,0,0]
  v_fma_mix_f32 v83, v105, s37, v83 op_sel:[1,0,0] op_sel_hi:[1,0,0]
  v_fma_mix_f32 v84, v106, s37, v84 op_sel:[0,0,0] op_sel_hi:[1,0,0]
  v_fma_mix_f32 v85, v106, s37, v85 op_sel:[1,0,0] op_sel_hi:[1,0,0]
  v_fma_mix_f32 v86, v107, s37, v86 op_sel:[0,0,0] op_sel_hi:[1,0,0]
  v_fma_mix_f32 v87, v107, s37, v87 op_sel:[1,0,0] op_sel_hi:[1,0,0]
  s_cmp_eq_u64 s[56:57], 0
  s_cbranch_scc1 L_selx2
  s_mov_b64 exec, s[56:57]
  v_lshrrev_b32 v16, 11, v174
  v_and_b32 v17, 2047, v174
  v_cmp_eq_u32 vcc, s47, v16
  v_lshlrev_b32 v17, 1, v17
  v_add_u32 v16, 4096, v17
  v_mov_b32 v18, 0xffffff00
  v_cndmask_b32_e64 v16, v17, v16, vcc
  s_mov_b32 s38, 4096
  v_and_or_b32 v176, v80, v18, s29
  v_and_or_b32 v177, v81, v18, s29
  v_and_or_b32 v178, v82, v18, s29
  v_and_or_b32 v179, v83, v18, s29
  v_and_or_b32 v180, v84, v18, s29
  v_and_or_b32 v181, v85, v18, s29
  v_and_or_b32 v182, v86, v18, s29
  v_and_or_b32 v183, v87, v18, s29
  buffer_store_dwordx4 v[176:179], v16, s[8:11], s38 offen sc1
  buffer_store_dwordx4 v[180:183], v16, s[8:11], s38 offen offset:16 sc1
  s_mov_b64 exec, -1
L_selx2:
  v_cvt_pk_bf16_f32 v140, v80, v81
  v_cvt_pk_bf16_f32 v141, v82, v83
  v_cvt_pk_bf16_f32 v142, v84, v85
  v_cvt_pk_bf16_f32 v143, v86, v87
  buffer_store_dwordx4 v[140:143], v22, s[12:15], 0 offen
  s_waitcnt lgkmcnt(0)
  v_fma_mix_f32 v88, v108, s37, v88 op_sel:[0,0,0] op_sel_hi:[1,0,0]
  v_fma_mix_f32 v89, v107, s37, v89 op_sel:[1,0,0] op_sel_hi:[1,0,0]
  v_fma_mix_f32 v90, v107, s37, v90 op_sel:[0,0,0] op_sel_hi:[1,0,0]
  v_fma_mix_f32 v91, v106, s37, v91 op_sel:[1,0,0] op_sel_hi:[1,0,0]
  v_fma_mix_f32 v92, v106, s37, v92 op_sel:[0,0,0] op_sel_hi:[1,0,0]
  v_fma_mix_f32 v93, v105, s37, v93 op_sel:[1,0,0] op_sel_hi:[1,0,0]
  v_fma_mix_f32 v94, v105, s37, v94 op_sel:[0,0,0] op_sel_hi:[1,0,0]
  v_fma_mix_f32 v95, v104, s37, v95 op_sel:[1,0,0] op_sel_hi:[1,0,0]
  s_cmp_eq_u64 s[58:59], 0
  s_cbranch_scc1 L_selx3
  s_mov_b64 exec, s[58:59]
  v_lshrrev_b32 v16, 11, v175
  v_and_b32 v17, 2047, v175
  v_cmp_eq_u32 vcc, s47, v16
  v_lshlrev_b32 v17, 1, v17
  v_add_u32 v16, 4096, v17
  v_mov_b32 v18, 0xffffff00
  v_cndmask_b32_e64 v16, v17, v16, vcc
  s_mov_b32 s38, 4096
  v_and_or_b32 v176, v88, v18, s29
  v_and_or_b32 v177, v89, v18, s29
  v_and_or_b32 v178, v90, v18, s29
  v_and_or_b32 v179, v91, v18, s29
  v_and_or_b32 v180, v92, v18, s29
  v_and_or_b32 v181, v93, v18, s29
  v_and_or_b32 v182, v94, v18, s29
  v_and_or_b32 v183, v95, v18, s29
  buffer_store_dwordx4 v[176:179], v16, s[8:11], s38 offen sc1
  buffer_store_dwordx4 v[180:183], v16, s[8:11], s38 offen offset:16 sc1
  s_mov_b64 exec, -1
L_selx3:
  v_cvt_pk_bf16_f32 v144, v88, v89
  v_cvt_pk_bf16_f32 v145, v90, v91
  v_cvt_pk_bf16_f32 v146, v92, v93
  v_cvt_pk_bf16_f32 v147, v94, v95
  buffer_store_dwordx4 v[144:147], v23, s[12:15], 0 offen
  s_branch L_fin
L_job2:
  s_mov_b32 s62, 1
  s_mov_b32 s56, 0
  s_mov_b32 s58, 0
  s_mov_b32 s57, s60
  s_mov_b32 s59, s61
  v_subrev_u32 v12, 2176, v12
  v_subrev_u32 v13, 2176, v13
  v_subrev_u32 v14, 2176, v14
  v_subrev_u32 v15, 2176, v15
  s_branch L_job
L_cw:
  s_setprio 2
  s_waitcnt lgkmcnt(12)
  v_pk_add_f32 v[28:29], v[28:29], v[30:31]
  v_pk_add_f32 v[68:69], v[68:69], v[70:71]
  v_pk_add_f32 v[28:29], v[28:29], v[68:69]
  v_add_f32 v68, v28, v29
  v_add_f32 v31, v28, v29
  s_nop 1
  v_permlane32_swap_b32 v68, v31
  v_mov_b32 v69, v31
  v_mul_f32 v29, 0x3a800000, v68
  v_mul_f32 v31, 0x3a800000, v31
  v_fma_f32 v31, -v29, v29, v31
  v_max_f32 v31, 0, v31
  v_cvt_pk_bf16_f32 v31, v31, v31
  v_and_b32 v31, 0xffff0000, v31
  v_add_f32 v31, 0x3727c5ac, v31
  v_cvt_pk_bf16_f32 v31, v31, v31
  v_and_b32 v31, 0xffff0000, v31
  v_sqrt_f32 v31, v31
  v_mov_b32 v18, s24
  v_cvt_pk_bf16_f32 v19, v29, v31
  v_and_b32 v16, 0xffff0000, v19
  v_rcp_f32 v16, v16
  v_lshlrev_b32 v17, 16, v19
  v_mul_f32 v17, v17, v16
  v_readlane_b32 s56, v16, s34
  v_readlane_b32 s57, v16, s35
  v_readlane_b32 s58, v17, s34
  v_readlane_b32 s59, v17, s35
  v_permlane16_swap_b32 v28, v68
  v_permlane16_swap_b32 v30, v69
  v_lshlrev_b32 v29, 16, v19
  v_fma_f32 v28, -v29, v30, v28
  v_mul_f32 v28, v28, v16
  v_cvt_pk_bf16_f32 v28, v28, v28
  s_lshl_b32 s37, s2, 4
  v_ashrrev_i32 v29, 31, v28
  s_add_u32 s37, s37, 98304
  v_or_b32 v29, 0x80000000, v29
  v_xor_b32 v28, v28, v29
  v_and_b32 v28, 0xffff0000, v28
  v_or_b32 v28, v28, v9
  v_mov_b32 v30, v18
  v_lshlrev_b32 v9, 11, v1
  v_min_u32_dpp v29, v28, v28 row_ror:8 row_mask:0xf bank_mask:0xf
  v_max_u32_dpp v28, v28, v28 row_ror:8 row_mask:0xf bank_mask:0xf
  s_nop 1
  v_min_u32_dpp v31, v28, v28 row_ror:4 row_mask:0xf bank_mask:0xf
  v_max_u32_dpp v29, v29, v29 row_ror:4 row_mask:0xf bank_mask:0xf
  v_max_u32_dpp v28, v28, v28 row_ror:4 row_mask:0xf bank_mask:0xf
  v_max_u32 v29, v29, v31
  s_nop 0
  v_min_u32_dpp v31, v28, v28 row_ror:2 row_mask:0xf bank_mask:0xf
  v_max_u32_dpp v29, v29, v29 row_ror:2 row_mask:0xf bank_mask:0xf
  v_max_u32_dpp v28, v28, v28 row_ror:2 row_mask:0xf bank_mask:0xf
  v_max_u32 v29, v29, v31
  s_nop 0
  v_min_u32_dpp v31, v28, v28 row_ror:1 row_mask:0xf bank_mask:0xf
  v_max_u32_dpp v29, v29, v29 row_ror:1 row_mask:0xf bank_mask:0xf
  v_max_u32_dpp v28, v28, v28 row_ror:1 row_mask:0xf bank_mask:0xf
  v_max_u32 v29, v29, v31
  s_mov_b64 exec, 0xff0000
  buffer_store_dwordx4 v[28:31], v9, s[8:11], s37 offen sc1
  s_mov_b64 exec, s[54:55]
  s_mov_b32 s37, 196608
  buffer_store_dwordx4 v[16:19], v10, s[8:11], s37 offen sc1
  s_mov_b64 exec, -1
  s_setprio 0
  v_mfma_f32_32x32x16_bf16 v[192:207], v[132:135], v[120:123], 0
  v_mfma_f32_32x32x16_bf16 v[192:207], v[136:139], v[124:127], v[192:207]
  v_mfma_f32_32x32x16_bf16 v[208:223], v[140:143], v[112:115], 0
  v_mfma_f32_32x32x16_bf16 v[208:223], v[144:147], v[116:119], v[208:223]
  v_mfma_f32_32x32x16_bf16 v[224:239], v[140:143], v[120:123], 0
  v_mfma_f32_32x32x16_bf16 v[224:239], v[144:147], v[124:127], v[224:239]
  s_branch L_nocand
L_ffn1:
  s_mov_b32 s6, 0x400000
  s_mov_b32 s10, 8388608
  s_mov_b32 s14, 0x400000
  s_mov_b32 s15, 0x20000
  s_mov_b32 s42, 7340032
  s_mov_b32 s43, 0x20000
  s_lshl_b32 s44, s30, 16
  v_mov_b32 v9, 0xffffff00
  v_bfe_u32 v16, v1, 2, 4
  v_and_b32 v17, 3, v1
  v_mul_u32_u24 v18, 2080, v16
  s_lshl_b32 s38, s3, 8
  v_lshl_add_u32 v11, v17, 3, s38
  v_add_u32 v11, v11, v18
  v_add_u32 v3, 118784, v11
  s_mul_i32 s37, s30, 4682
  s_lshr_b32 s37, s37, 16
  s_mul_i32 s38, s37, 14
  s_sub_u32 s38, s30, s38
  s_mul_i32 s37, s37, 114688
  s_lshl_b32 s38, s38, 9
  s_add_u32 s37, s37, s38
  s_add_u32 s48, s37, 3145728
  v_lshrrev_b32 v18, 5, v0
  v_and_b32 v19, 31, v0
  v_mul_u32_u24 v18, 7168, v18
  v_lshl_add_u32 v48, v19, 4, v18
  s_mov_b32 s36, 152384
  v_lshl_add_u32 v49, v0, 3, s36
  v_lshl_add_u32 v50, v1, 3, s36
  v_lshl_add_u32 v51, v0, 1, s36
  v_and_b32 v18, 1, v1
  v_and_b32 v19, 48, v1
  v_lshl_add_u32 v20, v18, 6, v19
  s_lshl_b32 s38, s3, 7
  s_add_u32 s38, s38, s36
  v_add_u32 v52, s38, v20
  s_lshl_b32 s38, s30, 13
  s_lshl_b32 s39, s3, 10
  s_add_u32 s38, s38, s39
  s_add_u32 s49, s38, 4194304
  v_lshrrev_b32 v20, 3, v0
  v_and_b32 v21, 7, v0
  v_lshlrev_b32 v20, 13, v20
  v_lshl_add_u32 v53, v21, 4, v20
  s_and_b32 s52, s30, 63
  s_lshl_b32 s50, s52, 7
  s_add_u32 s50, s50, 4194304
  s_add_u32 s51, s50, 524288
  v_lshl_add_u32 v54, v0, 2, s36
  v_lshl_add_u32 v55, v1, 2, s36
  s_and_b32 s45, s2, 7
  s_lshl_b32 s45, s45, 11
  s_add_u32 s45, s45, 131072
  s_waitcnt lgkmcnt(0)
  s_add_u32 s24, s24, 1
  s_and_b32 s29, s24, 0xff
  v_mov_b32 v10, s29
  v_mov_b32 v8, 0x40000000
  v_mov_b32 v7, 0
  s_cmp_lg_u32 s3, 7
  s_cbranch_scc1 L_f1
  buffer_load_dwordx4 v[32:35], v2, s[8:11], s45 offen sc1
  buffer_load_dwordx4 v[36:39], v2, s[8:11], s45 offen offset:1024 sc1
  s_waitcnt vmcnt(2)
  s_barrier
  s_mov_b32 s63, 0
  s_waitcnt vmcnt(0)
  s_branch P_5_c
P_5:
  buffer_load_dwordx4 v[32:35], v2, s[8:11], s45 offen sc1
  buffer_load_dwordx4 v[36:39], v2, s[8:11], s45 offen offset:1024 sc1
  s_waitcnt vmcnt(0)
P_5_c:
  v_cmp_ne_u32 vcc, s24, v34
  v_cmp_ne_u32 s[38:39], s24, v38
  s_or_b64 vcc, vcc, s[38:39]
  s_cbranch_vccz P_5_x
  s_add_u32 s63, s63, 1
  s_cmp_lt_u32 s63, 65536
  s_cbranch_scc1 P_5
P_5_x:
  v_max_u32 v34, v32, v36
  v_min_u32 v38, v32, v36
  v_max3_u32 v35, v38, v33, v37
  s_nop 0
  v_min_u32_dpp v38, v34, v34 row_ror:8 row_mask:0xf bank_mask:0xf
  v_max_u32_dpp v35, v35, v35 row_ror:8 row_mask:0xf bank_mask:0xf
  v_max_u32_dpp v34, v34, v34 row_ror:8 row_mask:0xf bank_mask:0xf
  v_max_u32 v35, v35, v38
  s_nop 0
  v_min_u32_dpp v38, v34, v34 row_ror:4 row_mask:0xf bank_mask:0xf
  v_max_u32_dpp v35, v35, v35 row_ror:4 row_mask:0xf bank_mask:0xf
  v_max_u32_dpp v34, v34, v34 row_ror:4 row_mask:0xf bank_mask:0xf
  v_max_u32 v35, v35, v38
  s_nop 0
  v_min_u32_dpp v38, v34, v34 row_ror:2 row_mask:0xf bank_mask:0xf
  v_max_u32_dpp v35, v35, v35 row_ror:2 row_mask:0xf bank_mask:0xf
  v_max_u32_dpp v34, v34, v34 row_ror:2 row_mask:0xf bank_mask:0xf
  v_max_u32 v35, v35, v38
  s_nop 0
  v_min_u32_dpp v38, v34, v34 row_ror:1 row_mask:0xf bank_mask:0xf
  v_max_u32_dpp v35, v35, v35 row_ror:1 row_mask:0xf bank_mask:0xf
  v_max_u32_dpp v34, v34, v34 row_ror:1 row_mask:0xf bank_mask:0xf
  v_max_u32 v35, v35, v38
  s_nop 0
  v_min_u32_dpp v38, v34, v34 row_bcast:15 row_mask:0xa bank_mask:0xf
  v_max_u32_dpp v35, v35, v35 row_bcast:15 row_mask:0xa bank_mask:0xf
  v_max_u32_dpp v34, v34, v34 row_bcast:15 row_mask:0xa bank_mask:0xf
  v_max_u32 v35, v35, v38
  s_nop 0
  v_min_u32_dpp v38, v34, v34 row_bcast:31 row_mask:0xc bank_mask:0xf
  v_max_u32_dpp v35, v35, v35 row_bcast:31 row_mask:0xc bank_mask:0xf
  v_max_u32_dpp v34, v34, v34 row_bcast:31 row_mask:0xc bank_mask:0xf
  v_max_u32 v35, v35, v38
  v_readlane_b32 s46, v34, 63
  v_readlane_b32 s47, v35, 63
  s_and_b32 s36, s46, 0xffff
  s_sub_u32 s36, 0xffff, s36
  s_and_b32 s37, s47, 0xffff
  s_sub_u32 s37, 0xffff, s37
  s_lshl_b32 s38, s36, 11
  s_lshl_b32 s39, s37, 11
  s_lshl_b32 s33, s32, 7
  s_add_u32 s38, s38, s33
  s_add_u32 s39, s39, s33
  s_mov_b32 m0, 152064
  s_mov_b64 exec, 0xff
  buffer_load_dwordx4 v2, s[4:7], s38 offen lds
  s_mov_b32 m0, 152192
  s_and_b32 s33, s36, 15
  buffer_load_dwordx4 v2, s[4:7], s39 offen lds
  s_lshl_b32 s33, s33, 12
  s_and_b32 s36, s36, 0x7f0
  s_add_u32 s36, s36, s33
  s_add_u32 s36, s36, 196608
  s_and_b32 s33, s37, 15
  s_lshl_b32 s33, s33, 12
  s_and_b32 s37, s37, 0x7f0
  s_add_u32 s37, s37, s33
  s_add_u32 s37, s37, 196608
  s_mov_b64 exec, 1
  buffer_load_dwordx3 v[40:42], off, s[8:11], s36 sc1
  buffer_load_dwordx3 v[44:46], off, s[8:11], s37 sc1
  s_mov_b64 exec, -1
  s_cmp_ge_u32 s30, 112
  s_cbranch_scc1 L_f0
  s_mov_b32 m0, 118784
  s_mov_b32 s33, s44
  buffer_load_dwordx4 v2, s[40:43], s33 offen lds
  buffer_load_dwordx4 v2, s[40:43], s33 offen offset:1024 lds
  s_add_u32 m0, m0, 2080
  s_add_u32 s33, s33, 2048
  buffer_load_dwordx4 v2, s[40:43], s33 offen lds
  buffer_load_dwordx4 v2, s[40:43], s33 offen offset:1024 lds
  s_add_u32 m0, m0, 2080
  s_add_u32 s33, s33, 2048
  buffer_load_dwordx4 v2, s[40:43], s33 offen lds
  buffer_load_dwordx4 v2, s[40:43], s33 offen offset:1024 lds
  s_add_u32 m0, m0, 2080
  s_add_u32 s33, s33, 2048
  buffer_load_dwordx4 v2, s[40:43], s33 offen lds
  buffer_load_dwordx4 v2, s[40:43], s33 offen offset:1024 lds
  s_add_u32 m0, m0, 2080
  s_add_u32 s33, s33, 10240
  buffer_load_dwordx4 v2, s[40:43], s33 offen lds
  buffer_load_dwordx4 v2, s[40:43], s33 offen offset:1024 lds
  s_add_u32 m0, m0, 2080
  s_add_u32 s33, s33, 2048
  buffer_load_dwordx4 v2, s[40:43], s33 offen lds
  buffer_load_dwordx4 v2, s[40:43], s33 offen offset:1024 lds
  s_add_u32 m0, m0, 2080
  s_add_u32 s33, s33, 2048
  buffer_load_dwordx4 v2, s[40:43], s33 offen lds
  buffer_load_dwordx4 v2, s[40:43], s33 offen offset:1024 lds
  s_add_u32 m0, m0, 2080
  s_add_u32 s33, s33, 2048
  buffer_load_dwordx4 v2, s[40:43], s33 offen lds
  buffer_load_dwordx4 v2, s[40:43], s33 offen offset:1024 lds
  s_add_u32 m0, m0, 2080
  s_add_u32 s33, s33, 10240
  buffer_load_dwordx4 v2, s[40:43], s33 offen lds
  buffer_load_dwordx4 v2, s[40:43], s33 offen offset:1024 lds
  s_add_u32 m0, m0, 2080
  s_add_u32 s33, s33, 2048
  buffer_load_dwordx4 v2, s[40:43], s33 offen lds
  buffer_load_dwordx4 v2, s[40:43], s33 offen offset:1024 lds
  s_add_u32 m0, m0, 2080
  s_add_u32 s33, s33, 2048
  buffer_load_dwordx4 v2, s[40:43], s33 offen lds
  buffer_load_dwordx4 v2, s[40:43], s33 offen offset:1024 lds
  s_add_u32 m0, m0, 2080
  s_add_u32 s33, s33, 2048
  buffer_load_dwordx4 v2, s[40:43], s33 offen lds
  buffer_load_dwordx4 v2, s[40:43], s33 offen offset:1024 lds
  s_add_u32 m0, m0, 2080
  s_add_u32 s33, s33, 10240
  buffer_load_dwordx4 v2, s[40:43], s33 offen lds
  buffer_load_dwordx4 v2, s[40:43], s33 offen offset:1024 lds
  s_add_u32 m0, m0, 2080
  s_add_u32 s33, s33, 2048
  buffer_load_dwordx4 v2, s[40:43], s33 offen lds
  buffer_load_dwordx4 v2, s[40:43], s33 offen offset:1024 lds
  s_add_u32 m0, m0, 2080
  s_add_u32 s33, s33, 2048
  buffer_load_dwordx4 v2, s[40:43], s33 offen lds
  buffer_load_dwordx4 v2, s[40:43], s33 offen offset:1024 lds
  s_add_u32 m0, m0, 2080
  s_add_u32 s33, s33, 2048
  buffer_load_dwordx4 v2, s[40:43], s33 offen lds
  buffer_load_dwordx4 v2, s[40:43], s33 offen offset:1024 lds
  s_waitcnt vmcnt(32)
L_f0:
  s_mov_b64 exec, 1
  s_cmp_lt_u32 s30, 112
  s_cbranch_scc1 Q_6
  s_waitcnt vmcnt(0)
Q_6:
  s_mov_b32 s62, 0
  s_waitcnt vmcnt(63)
  s_branch P_7_c
P_7:
  buffer_load_dwordx3 v[40:42], off, s[8:11], s36 sc1
  buffer_load_dwordx3 v[44:46], off, s[8:11], s37 sc1
  s_waitcnt vmcnt(0)
P_7_c:
  v_cmp_ne_u32 vcc, s24, v42
  v_cmp_ne_u32 s[38:39], s24, v46
  s_or_b64 vcc, vcc, s[38:39]
  s_cbranch_vccz P_7_x
  s_add_u32 s62, s62, 1
  s_cmp_lt_u32 s62, 65536
  s_cbranch_scc1 P_7
P_7_x:
  v_mov_b32 v42, v41
  v_mov_b32 v41, v44
  v_mov_b32 v43, v45
  v_mov_b32 v44, 152320
  ds_write_b128 v44, v[40:43]
  s_waitcnt lgkmcnt(0)
  s_mov_b64 exec, -1
  s_barrier
  v_lshrrev_b32 v18, 5, v1
  v_mov_b32 v19, s47
  v_mov_b32 v20, s46
  s_nop 1
  v_mov_b32_dpp v19, v20 quad_perm:[0,1,2,3] row_mask:0x3 bank_mask:0xf
  s_lshr_b32 s38, s52, 1
  s_lshl_b32 s38, s38, 5
  s_and_b32 s39, s52, 1
  s_lshl_b32 s39, s39, 3
  s_add_u32 s38, s38, s39
  v_and_b32 v16, 16, v1
  v_add3_u32 v17, v21, v16, s38
  v_lshlrev_b32 v16, 12, v18
  v_lshl_add_u32 v7, v17, 2, v16
  v_ashrrev_i32 v16, 31, v19
  v_not_b32 v16, v16
  v_or_b32 v16, 0x80000000, v16
  v_xor_b32 v16, v16, v19
  v_and_b32 v16, 0xffff0000, v16
  v_mul_f32 v16, 0xbfb8aa3b, v16
  v_exp_f32 v16, v16
  v_and_b32 v19, 0xffff, v19
  v_add_f32 v16, 1.0, v16
  v_rcp_f32 v16, v16
  v_sub_u32 v19, 0xffff, v19
  v_lshlrev_b32 v19, 11, v19
  v_lshl_add_u32 v8, v17, 1, v19
  v_cvt_pk_bf16_f32 v16, v16, v16
  v_and_b32 v6, 0xffff0000, v16
  s_branch L_f2
L_f1:
  v_mul_u32_u24 v16, 928, v16
  s_lshl_b32 s36, s3, 7
  v_lshl_add_u32 v17, v17, 3, s36
  v_add_u32 v4, v16, v17
  v_add_u32 v5, 59392, v4
  v_lshl_add_u32 v6, v18, 7, v19
  v_add_u32 v6, 152064, v6
  v_mov_b32 v56, 152320
  s_mul_i32 s36, s30, 7168
  s_lshl_b32 s37, s3, 10
  s_add_u32 s36, s36, s37
  s_add_u32 s36, s36, 3145728
  v_mov_b32 v12, 0x3f803f80
  v_mov_b32 v13, 0x3f803f80
  v_mov_b32 v14, 0x3f803f80
  v_mov_b32 v15, 0x3f803f80
  s_waitcnt vmcnt(0)
  s_barrier
  ds_read_b64_tr_b16 v[64:65], v4 offset:0
  ds_read_b64_tr_b16 v[66:67], v4 offset:14848
  ds_read_b64_tr_b16 v[68:69], v4 offset:29696
  ds_read_b64_tr_b16 v[70:71], v4 offset:44544
  ds_read_b64_tr_b16 v[72:73], v5 offset:0
  ds_read_b64_tr_b16 v[74:75], v5 offset:14848
  ds_read_b64_tr_b16 v[76:77], v5 offset:29696
  ds_read_b64_tr_b16 v[78:79], v5 offset:44544
  ds_read_b64_tr_b16 v[80:81], v4 offset:32
  ds_read_b64_tr_b16 v[82:83], v4 offset:14880
  ds_read_b64_tr_b16 v[84:85], v4 offset:29728
  ds_read_b64_tr_b16 v[86:87], v4 offset:44576
  ds_read_b64_tr_b16 v[88:89], v5 offset:32
  ds_read_b64_tr_b16 v[90:91], v5 offset:14880
  ds_read_b64_tr_b16 v[92:93], v5 offset:29728
  ds_read_b64_tr_b16 v[94:95], v5 offset:44576
  ds_read_b64_tr_b16 v[96:97], v4 offset:64
  ds_read_b64_tr_b16 v[98:99], v4 offset:14912
  ds_read_b64_tr_b16 v[100:101], v4 offset:29760
  ds_read_b64_tr_b16 v[102:103], v4 offset:44608
  ds_read_b64_tr_b16 v[104:105], v5 offset:64
  ds_read_b64_tr_b16 v[106:107], v5 offset:14912
  ds_read_b64_tr_b16 v[108:109], v5 offset:29760
  ds_read_b64_tr_b16 v[110:111], v5 offset:44608
  ds_read_b64_tr_b16 v[112:113], v4 offset:96
  ds_read_b64_tr_b16 v[114:115], v4 offset:14944
  ds_read_b64_tr_b16 v[116:117], v4 offset:29792
  ds_read_b64_tr_b16 v[118:119], v4 offset:44640
  ds_read_b64_tr_b16 v[120:121], v5 offset:96
  ds_read_b64_tr_b16 v[122:123], v5 offset:14944
  ds_read_b64_tr_b16 v[124:125], v5 offset:29792
  ds_read_b64_tr_b16 v[126:127], v5 offset:44640
  s_waitcnt lgkmcnt(0)
  v_mfma_f32_16x16x32_bf16 v[128:131], v[12:15], v[64:67], 0
  v_mfma_f32_16x16x32_bf16 v[128:131], v[12:15], v[68:71], v[128:131]
  v_mfma_f32_16x16x32_bf16 v[132:135], v[12:15], v[72:75], 0
  v_mfma_f32_16x16x32_bf16 v[132:135], v[12:15], v[76:79], v[132:135]
  v_mfma_f32_16x16x32_bf16 v[136:139], v[12:15], v[80:83], 0
  v_mfma_f32_16x16x32_bf16 v[136:139], v[12:15], v[84:87], v[136:139]
  v_mfma_f32_16x16x32_bf16 v[140:143], v[12:15], v[88:91], 0
  v_mfma_f32_16x16x32_bf16 v[140:143], v[12:15], v[92:95], v[140:143]
  v_mfma_f32_16x16x32_bf16 v[144:147], v[12:15], v[96:99], 0
  v_mfma_f32_16x16x32_bf16 v[144:147], v[12:15], v[100:103], v[144:147]
  v_mfma_f32_16x16x32_bf16 v[148:151], v[12:15], v[104:107], 0
  v_mfma_f32_16x16x32_bf16 v[148:151], v[12:15], v[108:111], v[148:151]
  v_mfma_f32_16x16x32_bf16 v[152:155], v[12:15], v[112:115], 0
  v_mfma_f32_16x16x32_bf16 v[152:155], v[12:15], v[116:119], v[152:155]
  v_mfma_f32_16x16x32_bf16 v[156:159], v[12:15], v[120:123], 0
  v_mfma_f32_16x16x32_bf16 v[156:159], v[12:15], v[124:127], v[156:159]
  v_mov_b32 v16, v128
  s_nop 1
  v_mov_b32_dpp v16, v136 quad_perm:[0,1,2,3] row_mask:0x2 bank_mask:0xf
  s_nop 1
  v_mov_b32_dpp v16, v144 quad_perm:[0,1,2,3] row_mask:0x4 bank_mask:0xf
  s_nop 1
  v_mov_b32_dpp v16, v152 quad_perm:[0,1,2,3] row_mask:0x8 bank_mask:0xf
  v_mov_b32 v17, v132
  s_nop 1
  v_mov_b32_dpp v17, v140 quad_perm:[0,1,2,3] row_mask:0x2 bank_mask:0xf
  s_nop 1
  v_mov_b32_dpp v17, v148 quad_perm:[0,1,2,3] row_mask:0x4 bank_mask:0xf
  s_nop 1
  v_mov_b32_dpp v17, v156 quad_perm:[0,1,2,3] row_mask:0x8 bank_mask:0xf
  s_barrier
  ds_read_b128 v[20:23], v6
  ds_read_b128 v[24:27], v6 offset:64
  ds_read_b128 v[28:31], v56
  s_waitcnt lgkmcnt(2)
  v_mfma_f32_16x16x32_bf16 v[160:163], v[20:23], v[64:67], 0
  v_mfma_f32_16x16x32_bf16 v[164:167], v[20:23], v[72:75], 0
  v_mfma_f32_16x16x32_bf16 v[168:171], v[20:23], v[80:83], 0
  v_mfma_f32_16x16x32_bf16 v[172:175], v[20:23], v[88:91], 0
  v_mfma_f32_16x16x32_bf16 v[176:179], v[20:23], v[96:99], 0
  v_mfma_f32_16x16x32_bf16 v[180:183], v[20:23], v[104:107], 0
  v_mfma_f32_16x16x32_bf16 v[184:187], v[20:23], v[112:115], 0
  v_mfma_f32_16x16x32_bf16 v[188:191], v[20:23], v[120:123], 0
  s_waitcnt lgkmcnt(0)
  v_mfma_f32_16x16x32_bf16 v[160:163], v[24:27], v[68:71], v[160:163]
  v_pk_mul_f32 v[32:33], v[30:31], v[16:17] op_sel:[0,0] op_sel_hi:[1,0] neg_lo:[1,0] neg_hi:[1,0]
  s_nop 1
  v_mfma_f32_16x16x32_bf16 v[164:167], v[24:27], v[76:79], v[164:167]
  v_mul_f32 v34, -v30, v17
  v_mul_f32 v35, -v31, v17
  v_mfma_f32_16x16x32_bf16 v[168:171], v[24:27], v[84:87], v[168:171]
  v_mfma_f32_16x16x32_bf16 v[172:175], v[24:27], v[92:95], v[172:175]
  v_mfma_f32_16x16x32_bf16 v[176:179], v[24:27], v[100:103], v[176:179]
  v_mfma_f32_16x16x32_bf16 v[180:183], v[24:27], v[108:111], v[180:183]
  v_mfma_f32_16x16x32_bf16 v[184:187], v[24:27], v[116:119], v[184:187]
  v_mfma_f32_16x16x32_bf16 v[188:191], v[24:27], v[124:127], v[188:191]
  v_mov_b32 v40, v160
  s_nop 1
  v_mov_b32_dpp v40, v168 quad_perm:[0,1,2,3] row_mask:0x2 bank_mask:0xf
  s_nop 1
  v_mov_b32_dpp v40, v176 quad_perm:[0,1,2,3] row_mask:0x4 bank_mask:0xf
  s_nop 1
  v_mov_b32_dpp v40, v184 quad_perm:[0,1,2,3] row_mask:0x8 bank_mask:0xf
  v_mov_b32 v41, v161
  s_nop 1
  v_mov_b32_dpp v41, v169 quad_perm:[0,1,2,3] row_mask:0x2 bank_mask:0xf
  s_nop 1
  v_mov_b32_dpp v41, v177 quad_perm:[0,1,2,3] row_mask:0x4 bank_mask:0xf
  s_nop 1
  v_mov_b32_dpp v41, v185 quad_perm:[0,1,2,3] row_mask:0x8 bank_mask:0xf
  v_mov_b32 v42, v164
  s_nop 1
  v_mov_b32_dpp v42, v172 quad_perm:[0,1,2,3] row_mask:0x2 bank_mask:0xf
  s_nop 1
  v_mov_b32_dpp v42, v180 quad_perm:[0,1,2,3] row_mask:0x4 bank_mask:0xf
  s_nop 1
  v_mov_b32_dpp v42, v188 quad_perm:[0,1,2,3] row_mask:0x8 bank_mask:0xf
  v_mov_b32 v43, v165
  s_nop 1
  v_mov_b32_dpp v43, v173 quad_perm:[0,1,2,3] row_mask:0x2 bank_mask:0xf
  s_nop 1
  v_mov_b32_dpp v43, v181 quad_perm:[0,1,2,3] row_mask:0x4 bank_mask:0xf
  s_nop 1
  v_mov_b32_dpp v43, v189 quad_perm:[0,1,2,3] row_mask:0x8 bank_mask:0xf
  v_pk_fma_f32 v[40:41], v[40:41], v[28:29], v[32:33]
  v_pk_fma_f32 v[42:43], v[42:43], v[28:29], v[34:35]
  v_and_or_b32 v40, v40, v9, v10
  v_and_or_b32 v41, v41, v9, v10
  v_and_or_b32 v42, v42, v9, v10
  v_and_or_b32 v43, v43, v9, v10
  buffer_store_dwordx4 v[40:43], v2, s[8:11], s36 offen sc1
L_f2:
  s_cmp_ge_u32 s30, 112
  s_cbranch_scc1 L_red
  s_lshr_b32 s36, s3, 1
  s_lshl_b32 s36, s36, 3
  s_and_b32 s37, s3, 1
  s_lshl_b32 s37, s37, 1
  s_add_u32 s36, s36, s37
  s_add_u32 s36, s36, 4
  s_lshl_b32 s36, s36, 11
  s_add_u32 s33, s44, s36
  s_mul_i32 s36, s3, 4160
  s_add_u32 m0, s36, 0
  s_barrier
  buffer_load_dwordx4 v2, s[40:43], s33 offen lds
  buffer_load_dwordx4 v2, s[40:43], s33 offen offset:1024 lds
  s_add_u32 m0, m0, 2080
  s_add_u32 s33, s33, 2048
  buffer_load_dwordx4 v2, s[40:43], s33 offen lds
  buffer_load_dwordx4 v2, s[40:43], s33 offen offset:1024 lds
  s_mov_b32 s61, 0
P_8:
  buffer_load_dwordx4 v[24:27], v48, s[8:11], s48 offen sc1
  s_waitcnt vmcnt(0)
P_8_c:
  v_xor_b32 v24, v10, v24
  v_xor_b32 v25, v10, v25
  v_xor_b32 v26, v10, v26
  v_xor_b32 v27, v10, v27
  v_or3_b32 v16, v24, v25, v26
  v_or_b32 v16, v16, v27
  v_and_b32 v16, 0xff, v16
  v_cmp_ne_u32 vcc, 0, v16
  s_cbranch_vccz P_8_x
  s_add_u32 s61, s61, 1
  s_cmp_lt_u32 s61, 65536
  s_cbranch_scc1 P_8
P_8_x:
  v_permlane32_swap_b32 v24, v25
  v_permlane32_swap_b32 v26, v27
  v_add_f32 v24, v24, v25
  v_add_f32 v25, v26, v27
  ds_write_b64 v49, v[24:25] offset:0
  s_waitcnt lgkmcnt(0)
  s_barrier
  ds_read_b64 v[32:33], v50 offset:0
  ds_read_b64 v[34:35], v50 offset:512
  ds_read_b64 v[36:37], v50 offset:1024
  ds_read_b64 v[38:39], v50 offset:1536
  ds_read_b64 v[40:41], v50 offset:2048
  ds_read_b64 v[42:43], v50 offset:2560
  ds_read_b64 v[44:45], v50 offset:3072
  ds_read_b64 v[46:47], v50 offset:3584
  ds_read_b64_tr_b16 v[224:225], v3 offset:0
  ds_read_b64_tr_b16 v[226:227], v11 offset:0
  ds_read_b64_tr_b16 v[228:229], v3 offset:32
  ds_read_b64_tr_b16 v[230:231], v11 offset:32
  ds_read_b64_tr_b16 v[232:233], v3 offset:64
  ds_read_b64_tr_b16 v[234:235], v11 offset:64
  s_waitcnt lgkmcnt(12)
  v_pk_add_f32 v[32:33], v[32:33], v[34:35]
  s_waitcnt lgkmcnt(10)
  v_pk_add_f32 v[36:37], v[36:37], v[38:39]
  s_waitcnt lgkmcnt(8)
  v_pk_add_f32 v[40:41], v[40:41], v[42:43]
  s_waitcnt lgkmcnt(6)
  v_pk_add_f32 v[44:45], v[44:45], v[46:47]
  v_pk_add_f32 v[32:33], v[32:33], v[36:37]
  v_pk_add_f32 v[40:41], v[40:41], v[44:45]
  ds_read_b64_tr_b16 v[236:237], v3 offset:96
  ds_read_b64_tr_b16 v[238:239], v11 offset:96
  ds_read_b64_tr_b16 v[240:241], v3 offset:128
  ds_read_b64_tr_b16 v[242:243], v11 offset:128
  ds_read_b64_tr_b16 v[244:245], v3 offset:160
  ds_read_b64_tr_b16 v[246:247], v11 offset:160
  ds_read_b64_tr_b16 v[248:249], v3 offset:192
  v_pk_add_f32 v[32:33], v[32:33], v[40:41]
  v_cvt_pk_bf16_f32 v33, v32, v33
  v_lshlrev_b32 v32, 16, v33
  v_mul_f32 v34, 0xbfb8aa3b, v32
  v_exp_f32 v34, v34
  v_and_b32 v33, 0xffff0000, v33
  v_add_f32 v34, 1.0, v34
  v_rcp_f32 v34, v34
  s_waitcnt lgkmcnt(6)
  ds_read_b64_tr_b16 v[250:251], v11 offset:192
  ds_read_b64_tr_b16 v[252:253], v3 offset:224
  ds_read_b64_tr_b16 v[254:255], v11 offset:224
  v_mul_f32 v32, v32, v34
  v_cvt_pk_bf16_f32 v32, v32, v32
  v_and_b32 v32, 0xffff0000, v32
  v_mul_f32 v32, v32, v33
  v_cvt_pk_bf16_f32 v32, v32, v32
  ds_write_b16 v51, v32 offset:4096
  ds_read_b128 v[36:39], v52 offset:4096
  s_waitcnt lgkmcnt(0)
  v_mfma_f32_16x16x32_bf16 v[64:67], v[36:39], v[224:227], 0
  v_mfma_f32_16x16x32_bf16 v[68:71], v[36:39], v[228:231], 0
  v_mfma_f32_16x16x32_bf16 v[72:75], v[36:39], v[232:235], 0
  v_mfma_f32_16x16x32_bf16 v[76:79], v[36:39], v[236:239], 0
  v_mfma_f32_16x16x32_bf16 v[80:83], v[36:39], v[240:243], 0
  v_mfma_f32_16x16x32_bf16 v[84:87], v[36:39], v[244:247], 0
  v_mfma_f32_16x16x32_bf16 v[88:91], v[36:39], v[248:251], 0
  v_mfma_f32_16x16x32_bf16 v[92:95], v[36:39], v[252:255], 0
  s_nop 0
  v_mov_b32 v40, v64
  s_nop 1
  v_mov_b32_dpp v40, v72 quad_perm:[0,1,2,3] row_mask:0x2 bank_mask:0xf
  s_nop 1
  v_mov_b32_dpp v40, v80 quad_perm:[0,1,2,3] row_mask:0x4 bank_mask:0xf
  s_nop 1
  v_mov_b32_dpp v40, v88 quad_perm:[0,1,2,3] row_mask:0x8 bank_mask:0xf
  v_mov_b32 v41, v65
  s_nop 1
  v_mov_b32_dpp v41, v73 quad_perm:[0,1,2,3] row_mask:0x2 bank_mask:0xf
  s_nop 1
  v_mov_b32_dpp v41, v81 quad_perm:[0,1,2,3] row_mask:0x4 bank_mask:0xf
  s_nop 1
  v_mov_b32_dpp v41, v89 quad_perm:[0,1,2,3] row_mask:0x8 bank_mask:0xf
  v_mov_b32 v42, v68
  s_nop 1
  v_mov_b32_dpp v42, v76 quad_perm:[0,1,2,3] row_mask:0x2 bank_mask:0xf
  s_nop 1
  v_mov_b32_dpp v42, v84 quad_perm:[0,1,2,3] row_mask:0x4 bank_mask:0xf
  s_nop 1
  v_mov_b32_dpp v42, v92 quad_perm:[0,1,2,3] row_mask:0x8 bank_mask:0xf
  v_mov_b32 v43, v69
  s_nop 1
  v_mov_b32_dpp v43, v77 quad_perm:[0,1,2,3] row_mask:0x2 bank_mask:0xf
  s_nop 1
  v_mov_b32_dpp v43, v85 quad_perm:[0,1,2,3] row_mask:0x4 bank_mask:0xf
  s_nop 1
  v_mov_b32_dpp v43, v93 quad_perm:[0,1,2,3] row_mask:0x8 bank_mask:0xf
  v_and_or_b32 v40, v40, v9, v10
  v_and_or_b32 v41, v41, v9, v10
  v_and_or_b32 v42, v42, v9, v10
  v_and_or_b32 v43, v43, v9, v10
  buffer_store_dwordx4 v[40:43], v2, s[8:11], s49 offen sc1
L_red:
  s_cmp_lt_u32 s30, 64
  s_cbranch_scc1 L_fin
  s_cmp_ge_u32 s3, 6
  s_cbranch_scc1 L_r2
  s_mov_b32 s60, 0
P_9:
  buffer_load_dwordx4 v[20:23], v53, s[8:11], s50 offen sc1
  buffer_load_dwordx4 v[24:27], v53, s[8:11], s51 offen sc1
  s_waitcnt vmcnt(0)
P_9_c:
  v_xor_b32 v20, v10, v20
  v_xor_b32 v21, v10, v21
  v_xor_b32 v22, v10, v22
  v_xor_b32 v23, v10, v23
  v_xor_b32 v24, v10, v24
  v_xor_b32 v25, v10, v25
  v_xor_b32 v26, v10, v26
  v_xor_b32 v27, v10, v27
  v_or3_b32 v16, v20, v21, v22
  v_or3_b32 v16, v16, v23, v24
  v_or3_b32 v16, v16, v25, v26
  v_or_b32 v16, v16, v27
  v_and_b32 v16, 0xff, v16
  v_cmp_ne_u32 vcc, 0, v16
  s_cbranch_vccz P_9_x
  s_add_u32 s60, s60, 1
  s_cmp_lt_u32 s60, 65536
  s_cbranch_scc1 P_9
P_9_x:
  v_pk_add_f32 v[20:21], v[20:21], v[24:25]
  v_pk_add_f32 v[22:23], v[22:23], v[26:27]
  s_branch L_r3
L_r2:
  s_mov_b32 s38, 4096
  v_mov_b32 v24, v10
  s_cmp_eq_u32 s3, 7
  s_cbranch_scc1 L_r4
  s_mov_b32 s60, 0
P_10:
  buffer_load_dwordx4 v[20:23], v53, s[8:11], s50 offen sc1
  s_waitcnt vmcnt(0)
P_10_c:
  v_xor_b32 v20, v10, v20
  v_xor_b32 v21, v10, v21
  v_xor_b32 v22, v10, v22
  v_xor_b32 v23, v10, v23
  v_or3_b32 v16, v20, v21, v22
  v_or_b32 v16, v16, v23
  v_and_b32 v16, 0xff, v16
  v_cmp_ne_u32 vcc, 0, v16
  s_cbranch_vccz P_10_x
  s_add_u32 s60, s60, 1
  s_cmp_lt_u32 s60, 65536
  s_cbranch_scc1 P_10
P_10_x:
  s_branch L_r3
L_r4:
  s_mov_b32 s60, 0
P_11:
  buffer_load_dwordx4 v[20:23], v53, s[8:11], s50 offen sc1
  buffer_load_dword v24, v7, s[8:11], s38 offen sc1
  s_waitcnt vmcnt(0)
P_11_c:
  v_xor_b32 v20, v10, v20
  v_xor_b32 v21, v10, v21
  v_xor_b32 v22, v10, v22
  v_xor_b32 v23, v10, v23
  v_xor_b32 v24, v10, v24
  v_or3_b32 v16, v20, v21, v22
  v_or3_b32 v16, v16, v23, v24
  v_and_b32 v16, 0xff, v16
  v_cmp_ne_u32 vcc, 0, v16
  s_cbranch_vccz P_11_x
  s_add_u32 s60, s60, 1
  s_cmp_lt_u32 s60, 65536
  s_cbranch_scc1 P_11
P_11_x:
L_r3:
  v_permlane32_swap_b32 v20, v21
  v_permlane32_swap_b32 v22, v23
  v_add_f32 v20, v20, v21
  v_add_f32 v22, v22, v23
  s_nop 1
  v_permlane16_swap_b32 v20, v22
  v_add_f32 v20, v20, v22
  s_nop 1
  v_add_f32_dpp v20, v20, v20 row_ror:8 row_mask:0xf bank_mask:0xf
  ds_write_b32 v54, v20 offset:5120
  s_waitcnt lgkmcnt(0)
  s_barrier
  s_cmp_lg_u32 s3, 7
  s_cbranch_scc1 L_fin
  ds_read_b32 v32, v55 offset:5120
  ds_read_b32 v33, v55 offset:5376
  ds_read_b32 v34, v55 offset:5632
  ds_read_b32 v35, v55 offset:5888
  ds_read_b32 v36, v55 offset:6144
  ds_read_b32 v37, v55 offset:6400
  ds_read_b32 v38, v55 offset:6656
  ds_read_b32 v39, v55 offset:6912
  s_waitcnt lgkmcnt(4)
  v_pk_add_f32 v[32:33], v[32:33], v[34:35]
  s_waitcnt lgkmcnt(0)
  v_pk_add_f32 v[36:37], v[36:37], v[38:39]
  v_pk_add_f32 v[32:33], v[32:33], v[36:37]
  v_add_f32 v20, v32, v33
  v_cvt_pk_bf16_f32 v20, v20, v20
  v_and_b32 v20, 0xffff0000, v20
  v_mul_f32 v20, v20, v6
  v_cvt_pk_bf16_f32 v20, v20, v20
  v_and_b32 v20, 0xffff0000, v20
  v_add_f32 v20, v20, v24
  v_cvt_pk_bf16_f32 v20, v20, v20
  s_mov_b32 exec_lo, 0xff00ff
  s_mov_b32 exec_hi, 0xff00ff
  buffer_store_short v20, v8, s[12:15], 0 offen
  s_cmp_lg_u32 s52, 0
  s_cbranch_scc1 L_fin
  v_mov_b32 v16, s24
  s_mov_b64 exec, 1
  buffer_store_dword v16, off, s[8:11], 0 sc1
L_fin:
L_end:
  s_endpgm
.section .rodata,"a"
.p2align 6
.amdhsa_kernel parallel_sum__spectral_fnet__moe_arch_mod__prompt_kernel
  .amdhsa_next_free_vgpr 256
  .amdhsa_next_free_sgpr 102
  .amdhsa_accum_offset 256
  .amdhsa_group_segment_fixed_size 0
  .amdhsa_kernarg_size 104
  .amdhsa_user_sgpr_count 2
  .amdhsa_user_sgpr_kernarg_segment_ptr 1
  .amdhsa_system_sgpr_workgroup_id_x 1
.end_amdhsa_kernel
.p2align 8
L_tab:
.quad 0x3fb23fa73f973f80,0x3f973fa73fb23fb5,0x3fa73fb53fa73f80,0xbf0b25003f0b3f80,0x3f493fa73fb23f80,0xbfb2bfa7bf492500,0x25003f803fb53f80,0xa5c0bf80bfb5bf80,0xbf80bf803f803f80,0xbf80bf803f803f80,0xbe8dbfa73f493f80,0x3f49bfa7be8d3fb5,0x3f0bbfb53f0b3f80,0x3fa7a708bfa73f80,0x3f97bfa73e8d3f80,0xbe8d3fa7bf9726f0
.quad 0xbf493f0b3fb23f80,0x3fb23f0bbf49bfb5,0xbfa725003fa73f80,0x3f0b3fb53f0bbf80,0xbfb2bf0b3f973f80,0xbf973f0b3fb2a5c0,0x3f803f803f803f80,0x3f803f803f803f80,0x3fb5bf8025003f80,0xbfb53f80a708bf80,0x3f97bf0bbe8d3f80,0xbe8dbf0b3f97bfb5,0x3f0ba5c0bf0b3f80,0x3fa7bfb53fa7bf80,0xbe8d3f0bbf493f80,0x3f49bf0b3e8da708
.quad 0x3e8d3f0b3f493f80,0xbf49bf0bbe8d2500,0xbf0b25003f0b3f80,0xbfa7bfb5bfa7bf80,0xbf97bf0b3e8d3f80,0x3e8dbf0bbf97bfb5,0xbfb5bf8025003f80,0x3fb53f80a580bf80,0x3f80bf80bf803f80,0x3f80bf80bf803f80,0x3fb2bf0bbf973f80,0x3f973f0bbfb225c0,0x3fa7a580bfa73f80,0xbf0b3fb5bf0bbf80,0x3f493f0bbfb23f80,0xbfb23f0b3f49bfb5
.quad 0xbf97bfa7be8d3f80,0x3e8d3fa73f97a580,0xbf0bbfb5bf0b3f80,0xbfa725c03fa73f80,0x3e8dbfa7bf493f80,0xbf49bfa73e8d3fb5,0xbf803f80bf803f80,0xbf803f80bf803f80,0x25c03f80bfb53f80,0x25c0bf803fb5bf80,0xbf493fa7bfb23f80,0x3fb2bfa73f492660,0xbfa73fb5bfa73f80,0x3f0b25c0bf0b3f80,0xbfb23fa7bf973f80,0xbf973fa7bfb23fb5
.quad 0x3e8d3f0b3f493f80,0xbf49bf0bbe8d2500,0xbfa7bfb5bfa7bf80,0x3f0ba5c0bf0bbf80,0x3f973f0bbe8dbf80,0xbe8d3f0b3f973fb5,0x26f03f803fb53f80,0xa708bf80bfb5bf80,0xbf80bf803f803f80,0xbf80bf803f803f80,0x3fb2bf0bbf973f80,0x3f973f0bbfb22728,0xbf0b3fb5bf0bbf80,0xbfa727483fa7bf80,0xbf49bf0b3fb2bf80,0x3fb2bf0bbf493fb5
.quad 0xbf97bfa7be8d3f80,0x3e8d3fa73f97a708,0x3fa7a708bfa7bf80,0xbf0bbfb5bf0b3f80,0xbe8d3fa73f49bf80,0x3f493fa7be8dbfb5,0x3f803f803f803f80,0x3f803f803f803f80,0x3fb5bf8027283f80,0xbfb53f802718bf80,0xbf493fa7bfb23f80,0x3fb2bfa73f49a758,0xbf0b27483f0bbf80,0xbfa73fb5bfa73f80,0x3fb2bfa73f97bf80,0x3f97bfa73fb2bfb5
.quad 0xbfb2bfa7bf97bf80,0xbf97bfa7bfb2bfb5,0x3f0ba580bf0bbf80,0x3fa73fb53fa73f80,0x3f493fa73fb23f80,0xbfb2bfa7bf4925c0,0xbfb5bf8025c03f80,0x3fb53f802660bf80,0x3f80bf80bf803f80,0x3f80bf80bf803f80,0x3e8d3fa7bf49bf80,0xbf493fa73e8dbfb5,0xbfa7a5003fa7bf80,0x3f0bbfb53f0b3f80,0x3f97bfa73e8d3f80,0xbe8d3fa7bf972500
.quad 0x3f49bf0bbfb2bf80,0xbfb2bf0b3f493fb5,0x3f0b3fb53f0bbf80,0x3fa725c0bfa7bf80,0xbfb2bf0b3f973f80,0xbf973f0b3fb225c0,0xbf803f80bf803f80,0xbf803f80bf803f80,0x27bc3f80bfb53f80,0xa842bf803fb5bf80,0xbf973f0b3e8dbf80,0x3e8d3f0bbf973fb5,0x3fa7bfb53fa7bf80,0xbf0b27d43f0bbf80,0xbe8d3f0bbf493f80,0x3f49bf0b3e8da660
.quad 0xbfb2bfa7bf97bf80,0xbf97bfa7bfb2bfb5,0x3fa73fb53fa73f80,0xbf0b26f03f0b3f80,0xbf49bfa7bfb2bf80,0x3fb23fa73f49a708,0x27183f803fb53f80,0xa728bf80bfb5bf80,0xbf80bf803f803f80,0xbf80bf803f803f80,0x3e8d3fa7bf49bf80,0xbf493fa73e8dbfb5,0x3f0bbfb53f0b3f80,0x3fa7a81cbfa73f80,0xbf973fa7be8dbf80,0x3e8dbfa73f9726d0
.quad 0x3f49bf0bbfb2bf80,0xbfb2bf0b3f493fb5,0xbfa727283fa73f80,0x3f0b3fb53f0bbf80,0x3fb23f0bbf97bf80,0x3f97bf0bbfb22748,0x3f803f803f803f80,0x3f803f803f803f80,0x3fb5bf80a7ec3f80,0xbfb53f802690bf80,0xbf973f0b3e8dbf80,0x3e8d3f0bbf973fb5,0x3f0b2690bf0b3f80,0x3fa7bfb53fa7bf80,0x3e8dbf0b3f49bf80,0xbf493f0bbe8d27a4
.quad 0xbe8dbf0bbf49bf80,0x3f493f0b3e8da580,0xbf0b25c03f0b3f80,0xbfa7bfb5bfa7bf80,0x3f973f0bbe8dbf80,0xbe8d3f0b3f973fb5,0xbfb5bf80a6203f80,0x3fb53f8025c0bf80,0x3f80bf80bf803f80,0x3f80bf80bf803f80,0xbfb23f0b3f97bf80,0xbf97bf0b3fb2a660,0x3fa7a660bfa73f80,0xbf0b3fb5bf0bbf80,0xbf49bf0b3fb2bf80,0x3fb2bf0bbf493fb5
.quad 0x3f973fa73e8dbf80,0xbe8dbfa7bf97a500,0xbf0bbfb5bf0b3f80,0xbfa727bc3fa73f80,0xbe8d3fa73f49bf80,0x3f493fa7be8dbfb5,0xbf803f80bf803f80,0xbf803f80bf803f80,0x27e43f80bfb53f80,0xa6f0bf803fb5bf80,0x3f49bfa73fb2bf80,0xbfb23fa7bf4927ec,0xbfa73fb5bfa73f80,0x3f0ba85abf0b3f80,0x3fb2bfa73f97bf80,0x3f97bfa73fb2bfb5
.quad 0xbe8dbf0bbf49bf80,0x3f493f0b3e8da5c0,0xbfa7bfb5bfa7bf80,0x3f0ba708bf0bbf80,0xbf97bf0b3e8d3f80,0x3e8dbf0bbf97bfb5,0x27283f803fb53f80,0xa738bf80bfb5bf80,0xbf80bf803f803f80,0xbf80bf803f803f80,0xbfb23f0b3f97bf80,0xbf97bf0b3fb22690,0xbf0b3fb5bf0bbf80,0xbfa727a43fa7bf80,0x3f493f0bbfb23f80,0xbfb23f0b3f49bfb5
.quad 0x3f973fa73e8dbf80,0xbe8dbfa7bf972748,0x3fa72718bfa7bf80,0xbf0bbfb5bf0b3f80,0x3e8dbfa7bf493f80,0xbf49bfa73e8d3fb5,0x3f803f803f803f80,0x3f803f803f803f80,0x3fb5bf8027a43f80,0xbfb53f80a836bf80,0x3f49bfa73fb2bf80,0xbfb23fa7bf4927bc,0xbf0ba8873f0bbf80,0xbfa73fb5bfa73f80,0xbfb23fa7bf973f80,0xbf973fa7bfb23fb5
.quad 0x3fb23fa73f973f80,0x3f973fa73fb23fb5,0x3f0b2660bf0bbf80,0x3fa73fb53fa73f80,0xbf49bfa7bfb2bf80,0x3fb23fa73f4925c0,0xbfb5bf80a5003f80,0x3fb53f800000bf80,0x3f80bf80bf803f80,0x3f80bf80bf803f80,0xbe8dbfa73f493f80,0x3f49bfa7be8d3fb5,0xbfa7a7783fa7bf80,0x3f0bbfb53f0b3f80,0xbf973fa7be8dbf80,0x3e8dbfa73f97a718
.quad 0xbf493f0b3fb23f80,0x3fb23f0bbf49bfb5,0x3f0b3fb53f0bbf80,0x3fa7a842bfa7bf80,0x3fb23f0bbf97bf80,0x3f97bf0bbfb227d4,0xbf803f80bf803f80,0xbf803f80bf803f80,0x28023f80bfb53f80,0xa866bf803fb5bf80,0x3f97bf0bbe8d3f80,0xbe8dbf0b3f97bfb5,0x3fa7bfb53fa7bf80,0xbf0b28a53f0bbf80,0x3e8dbf0b3f49bf80,0xbf493f0bbe8da6f0
.quad 0x3e8d3f0b3f493f80,0xbf49bf0bbe8d2500,0xbf0b25003f0b3f80,0xbfa7bfb5bfa7bf80,0xbf97bf0b3e8d3f80,0x3e8dbf0bbf97bfb5,0xbfb5bf8025003f80,0x3fb53f80a580bf80,0x3f80bf80bf803f80,0x3f80bf80bf803f80,0x3fb2bf0bbf973f80,0x3f973f0bbfb225c0,0x3fa7a580bfa73f80,0xbf0b3fb5bf0bbf80,0x3f493f0bbfb23f80,0xbfb23f0b3f49bfb5
.quad 0xbf97bfa7be8d3f80,0x3e8d3fa73f97a580,0xbf0bbfb5bf0b3f80,0xbfa725c03fa73f80,0x3e8dbfa7bf493f80,0xbf49bfa73e8d3fb5,0x3f803f803f803f80,0x3f803f803f803f80,0x25c03f80bfb53f80,0x25c0bf803fb5bf80,0xbf493fa7bfb23f80,0x3fb2bfa73f492660,0xbfa73fb5bfa73f80,0x3f0b25c0bf0b3f80,0xbfb23fa7bf973f80,0xbf973fa7bfb23fb5
.quad 0x3fb23fa73f973f80,0x3f973fa73fb23fb5,0x3fa73fb53fa73f80,0xbf0b25003f0b3f80,0x3f493fa73fb23f80,0xbfb2bfa7bf492500,0x25003f803fb53f80,0xa5c0bf80bfb5bf80,0xbf80bf803f803f80,0xbf80bf803f803f80,0xbe8dbfa73f493f80,0x3f49bfa7be8d3fb5,0x3f0bbfb53f0b3f80,0x3fa7a708bfa73f80,0x3f97bfa73e8d3f80,0xbe8d3fa7bf9726f0
.quad 0xbf493f0b3fb23f80,0x3fb23f0bbf49bfb5,0xbfa725003fa73f80,0x3f0b3fb53f0bbf80,0xbfb2bf0b3f973f80,0xbf973f0b3fb2a5c0,0xbf803f80bf803f80,0xbf803f80bf803f80,0x3fb5bf8025003f80,0xbfb53f80a708bf80,0x3f97bf0bbe8d3f80,0xbe8dbf0b3f97bfb5,0x3f0ba5c0bf0b3f80,0x3fa7bfb53fa7bf80,0xbe8d3f0bbf493f80,0x3f49bf0b3e8da708
.quad 0xbfb2bfa7bf97bf80,0xbf97bfa7bfb2bfb5,0x3f0ba580bf0bbf80,0x3fa73fb53fa73f80,0x3f493fa73fb23f80,0xbfb2bfa7bf4925c0,0xbfb5bf8025c03f80,0x3fb53f802660bf80,0x3f80bf80bf803f80,0x3f80bf80bf803f80,0x3e8d3fa7bf49bf80,0xbf493fa73e8dbfb5,0xbfa7a5003fa7bf80,0x3f0bbfb53f0b3f80,0x3f97bfa73e8d3f80,0xbe8d3fa7bf972500
.quad 0x3f49bf0bbfb2bf80,0xbfb2bf0b3f493fb5,0x3f0b3fb53f0bbf80,0x3fa725c0bfa7bf80,0xbfb2bf0b3f973f80,0xbf973f0b3fb225c0,0x3f803f803f803f80,0x3f803f803f803f80,0x27bc3f80bfb53f80,0xa842bf803fb5bf80,0xbf973f0b3e8dbf80,0x3e8d3f0bbf973fb5,0x3fa7bfb53fa7bf80,0xbf0b27d43f0bbf80,0xbe8d3f0bbf493f80,0x3f49bf0b3e8da660
.quad 0x3e8d3f0b3f493f80,0xbf49bf0bbe8d2500,0xbfa7bfb5bfa7bf80,0x3f0ba5c0bf0bbf80,0x3f973f0bbe8dbf80,0xbe8d3f0b3f973fb5,0x26f03f803fb53f80,0xa708bf80bfb5bf80,0xbf80bf803f803f80,0xbf80bf803f803f80,0x3fb2bf0bbf973f80,0x3f973f0bbfb22728,0xbf0b3fb5bf0bbf80,0xbfa727483fa7bf80,0xbf49bf0b3fb2bf80,0x3fb2bf0bbf493fb5
.quad 0xbf97bfa7be8d3f80,0x3e8d3fa73f97a708,0x3fa7a708bfa7bf80,0xbf0bbfb5bf0b3f80,0xbe8d3fa73f49bf80,0x3f493fa7be8dbfb5,0xbf803f80bf803f80,0xbf803f80bf803f80,0x3fb5bf8027283f80,0xbfb53f802718bf80,0xbf493fa7bfb23f80,0x3fb2bfa73f49a758,0xbf0b27483f0bbf80,0xbfa73fb5bfa73f80,0x3fb2bfa73f97bf80,0x3f97bfa73fb2bfb5
.quad 0xbe8dbf0bbf49bf80,0x3f493f0b3e8da580,0xbf0b25c03f0b3f80,0xbfa7bfb5bfa7bf80,0x3f973f0bbe8dbf80,0xbe8d3f0b3f973fb5,0xbfb5bf80a6203f80,0x3fb53f8025c0bf80,0x3f80bf80bf803f80,0x3f80bf80bf803f80,0xbfb23f0b3f97bf80,0xbf97bf0b3fb2a660,0x3fa7a660bfa73f80,0xbf0b3fb5bf0bbf80,0xbf49bf0b3fb2bf80,0x3fb2bf0bbf493fb5
.quad 0x3f973fa73e8dbf80,0xbe8dbfa7bf97a500,0xbf0bbfb5bf0b3f80,0xbfa727bc3fa73f80,0xbe8d3fa73f49bf80,0x3f493fa7be8dbfb5,0x3f803f803f803f80,0x3f803f803f803f80,0x27e43f80bfb53f80,0xa6f0bf803fb5bf80,0x3f49bfa73fb2bf80,0xbfb23fa7bf4927ec,0xbfa73fb5bfa73f80,0x3f0ba85abf0b3f80,0x3fb2bfa73f97bf80,0x3f97bfa73fb2bfb5
.quad 0xbfb2bfa7bf97bf80,0xbf97bfa7bfb2bfb5,0x3fa73fb53fa73f80,0xbf0b26f03f0b3f80,0xbf49bfa7bfb2bf80,0x3fb23fa73f49a708,0x27183f803fb53f80,0xa728bf80bfb5bf80,0xbf80bf803f803f80,0xbf80bf803f803f80,0x3e8d3fa7bf49bf80,0xbf493fa73e8dbfb5,0x3f0bbfb53f0b3f80,0x3fa7a81cbfa73f80,0xbf973fa7be8dbf80,0x3e8dbfa73f9726d0
.quad 0x3f49bf0bbfb2bf80,0xbfb2bf0b3f493fb5,0xbfa727283fa73f80,0x3f0b3fb53f0bbf80,0x3fb23f0bbf97bf80,0x3f97bf0bbfb22748,0xbf803f80bf803f80,0xbf803f80bf803f80,0x3fb5bf80a7ec3f80,0xbfb53f802690bf80,0xbf973f0b3e8dbf80,0x3e8d3f0bbf973fb5,0x3f0b2690bf0b3f80,0x3fa7bfb53fa7bf80,0x3e8dbf0b3f49bf80,0xbf493f0bbe8d27a4
.quad 0x3fb23fa73f973f80,0x3f973fa73fb23fb5,0x3f0b2660bf0bbf80,0x3fa73fb53fa73f80,0xbf49bfa7bfb2bf80,0x3fb23fa73f4925c0,0xbfb5bf80a5003f80,0x3fb53f800000bf80,0x3f80bf80bf803f80,0x3f80bf80bf803f80,0xbe8dbfa73f493f80,0x3f49bfa7be8d3fb5,0xbfa7a7783fa7bf80,0x3f0bbfb53f0b3f80,0xbf973fa7be8dbf80,0x3e8dbfa73f97a718
.quad 0xbf493f0b3fb23f80,0x3fb23f0bbf49bfb5,0x3f0b3fb53f0bbf80,0x3fa7a842bfa7bf80,0x3fb23f0bbf97bf80,0x3f97bf0bbfb227d4,0x3f803f803f803f80,0x3f803f803f803f80,0x28023f80bfb53f80,0xa866bf803fb5bf80,0x3f97bf0bbe8d3f80,0xbe8dbf0b3f97bfb5,0x3fa7bfb53fa7bf80,0xbf0b28a53f0bbf80,0x3e8dbf0b3f49bf80,0xbf493f0bbe8da6f0
.quad 0xbe8dbf0bbf49bf80,0x3f493f0b3e8da5c0,0xbfa7bfb5bfa7bf80,0x3f0ba708bf0bbf80,0xbf97bf0b3e8d3f80,0x3e8dbf0bbf97bfb5,0x27283f803fb53f80,0xa738bf80bfb5bf80,0xbf80bf803f803f80,0xbf80bf803f803f80,0xbfb23f0b3f97bf80,0xbf97bf0b3fb22690,0xbf0b3fb5bf0bbf80,0xbfa727a43fa7bf80,0x3f493f0bbfb23f80,0xbfb23f0b3f49bfb5
.quad 0x3f973fa73e8dbf80,0xbe8dbfa7bf972748,0x3fa72718bfa7bf80,0xbf0bbfb5bf0b3f80,0x3e8dbfa7bf493f80,0xbf49bfa73e8d3fb5,0xbf803f80bf803f80,0xbf803f80bf803f80,0x3fb5bf8027a43f80,0xbfb53f80a836bf80,0x3f49bfa73fb2bf80,0xbfb23fa7bf4927bc,0xbf0ba8873f0bbf80,0xbfa73fb5bfa73f80,0xbfb23fa7bf973f80,0xbf973fa7bfb23fb5
.quad 0x3c003c003c003c00,0x24b622481e480000,0x3bff3bff3c003c00,0x28b6264822480000,0x3bfd3bff3c003c00,0x2b1128b624b60000,0x3bfa3bfe3bff3c00,0x2cb52a4826480000,0x3bea3bf63bfe3c00,0x30b22e462a480000,0x3be43bf43bfd3c00,0x31472f0e2b110000,0x3bdd3bf13bfc3c00,0x31db2fd62bd90000,0x3bd63bed3bfb3c00,0x326f304e2c510000
.quad 0x3bf73bfc3bff3c00,0x2de22bd927da0000,0x3bf43bfa3bff3c00,0x2f0e2cb528b60000,0x3bef3bf83bfe3c00,0x301d2d7e297f0000,0x3c003c003c003c00,0,0x3bce3bea3bfa3c00,0x330330b22cb50000,0x3bc63be63bf93c00,0x339631152d1a0000,0x3bbc3be23bf83c00,0x341431792d7e0000,0x3bb23bdd3bf73c00,0x345d31db2de20000
.quad 0x3c003c003c003c00,0xa4b6a2489e488000,0x3bff3bff3c003c00,0xa8b6a648a2488000,0x3bfd3bff3c003c00,0xab11a8b6a4b68000,0x3bfa3bfe3bff3c00,0xacb5aa48a6488000,0x3bea3bf63bfe3c00,0xb0b2ae46aa488000,0x3be43bf43bfd3c00,0xb147af0eab118000,0x3bdd3bf13bfc3c00,0xb1dbafd6abd98000,0x3bd63bed3bfb3c00,0xb26fb04eac518000
.quad 0x3bf73bfc3bff3c00,0xade2abd9a7da8000,0x3bf43bfa3bff3c00,0xaf0eacb5a8b68000,0x3bef3bf83bfe3c00,0xb01dad7ea97f8000,0x3ba83bd93bf63c00,0xb4a5b23eae468000,0x3bce3bea3bfa3c00,0xb303b0b2acb58000,0x3bc63be63bf93c00,0xb396b115ad1a8000,0x3bbc3be23bf83c00,0xb414b179ad7e8000,0x3bb23bdd3bf73c00,0xb45db1dbade28000
.quad 0x3bfe3bff3bff3bff,0x297f28b627da2648,0x3bf83bfa3bfc3bfe,0x2d7e2cb52bd92a48,0x3bef3bf43bf73bfa,0x301d2f0e2de22cb5,0x3be23bea3bf13bf6,0x317930b22fd62e46,0x3b883ba83bc33bd9,0x356434a533c6323e,0x3b693b913bb23bce,0x36083534345d3303,0x3b463b773ba03bc3,0x36aa35c234d533c6,0x3b203b5a3b8c3bb6,0x3748364e354c3444
.quad 0x3bd13bdd3be83bf1,0x32d231db30e42fd6,0x3bbc3bce3bdd3bea,0x3414330331db30b2,0x3ba43bbc3bd13be2,0x34bd341432d23179,0x3c003c003c003c00,0,0x3af63b3b3b773ba8,0x37e336d735c234a5,0x3ac93b1a3b5f3b99,0x383d375e36373505,0x3a993af63b463b88,0x388737e336aa3564,0x3a653ad03b2b3b77,0x38ce3832371b35c2
.quad 0x3bfe3bff3bff3bff,0xa97fa8b6a7daa648,0x3bf83bfa3bfc3bfe,0xad7eacb5abd9aa48,0x3bef3bf43bf73bfa,0xb01daf0eade2acb5,0x3be23bea3bf13bf6,0xb179b0b2afd6ae46,0x3b883ba83bc33bd9,0xb564b4a5b3c6b23e,0x3b693b913bb23bce,0xb608b534b45db303,0x3b463b773ba03bc3,0xb6aab5c2b4d5b3c6,0x3b203b5a3b8c3bb6,0xb748b64eb54cb444
.quad 0x3bd13bdd3be83bf1,0xb2d2b1dbb0e4afd6,0x3bbc3bce3bdd3bea,0xb414b303b1dbb0b2,0x3ba43bbc3bd13be2,0xb4bdb414b2d2b179,0x3a2f3aa73b0e3b64,0xb913b872b78bb61f,0x3af63b3b3b773ba8,0xb7e3b6d7b5c2b4a5,0x3ac93b1a3b5f3b99,0xb83db75eb637b505,0x3a993af63b463b88,0xb887b7e3b6aab564,0x3a653ad03b2b3b77,0xb8ceb832b71bb5c2
.quad 0x3bfb3bfc3bfd3bfe,0x2c512bd92b112a48,0x3bed3bf13bf43bf6,0x304e2fd62f0e2e46,0x3bd63bdd3be43bea,0x326f31db314730b2,0x3bb63bc33bce3bd9,0x344433c63303323e,0x3add3b0e3b3b3b64,0x381d378b36d7361f,0x3a923ad03b083b3b,0x3891383237a136d7,0x3a3f3a8a3ad03b0e,0x3900389b3832378b,0x39e53a3f3a923add,0x396939003891381d
.quad 0x3b8c3ba03bb23bc3,0x354c34d5345d33c6,0x3b5a3b773b913ba8,0x364e35c2353434a5,0x3b203b463b693b88,0x374836aa36083564,0x3c003c003c003c00,0,0x398439ed3a4f3aa7,0x39cb395f38ec3872,0x391d39963a073a6d,0x3a2739ba394338c4,0x38b0393a39ba3a2f,0x3a7c3a0f39963913,0x383d38d8396939ed,0x3ac93a5e39e5395f
.quad 0x3bfb3bfc3bfd3bfe,0xac51abd9ab11aa48,0x3bed3bf13bf43bf6,0xb04eafd6af0eae46,0x3bd63bdd3be43bea,0xb26fb1dbb147b0b2,0x3bb63bc33bce3bd9,0xb444b3c6b303b23e,0x3add3b0e3b3b3b64,0xb81db78bb6d7b61f,0x3a923ad03b083b3b,0xb891b832b7a1b6d7,0x3a3f3a8a3ad03b0e,0xb900b89bb832b78b,0x39e53a3f3a923add,0xb969b900b891b81d
.quad 0x3b8c3ba03bb23bc3,0xb54cb4d5b45db3c6,0x3b5a3b773b913ba8,0xb64eb5c2b534b4a5,0x3b203b463b693b88,0xb748b6aab608b564,0x378b3872391339a8,0xbb0ebaa7ba2fb9a8,0x398439ed3a4f3aa7,0xb9cbb95fb8ecb872,0x391d39963a073a6d,0xba27b9bab943b8c4,0x38b0393a39ba3a2f,0xba7cba0fb996b913,0x383d38d8396939ed,0xbac9ba5eb9e5b95f
.quad 0x3bf73bf83bf93bfa,0x2de22d7e2d1a2cb5,0x3bdd3be23be63bea,0x31db3179311530b2,0x3bb23bbc3bc63bce,0x345d341433963303,0x3b773b883b993ba8,0x35c23564350534a5,0x39ed3a2f3a6d3aa7,0x395f391338c43872,0x396939ba3a073a4f,0x39e53996394338ec,0x38d8393a399639ed,0x3a5e3a0f39ba395f,0x383d38b0391d3984,0x3ac93a7c3a2739cb
.quad 0x3b2b3b463b5f3b77,0x371b36aa363735c2,0x3ad03af63b1a3b3b,0x383237e3375e36d7,0x3a653a993ac93af6,0x38ce3887383d37e3,0x3c003c003c003c00,0,0x3732381d389b3913,0x3b253add3a8a3a2f,0x35da37053812389b,0x3b723b303ae33a8a,0x347535c23705381d,0x3baf3b773b303add,0x320d347535da3732,0x3bdb3baf3b723b25
.quad 0x3bf73bf83bf93bfa,0xade2ad7ead1aacb5,0x3bdd3be23be63bea,0xb1dbb179b115b0b2,0x3bb23bbc3bc63bce,0xb45db414b396b303,0x3b773b883b993ba8,0xb5c2b564b505b4a5,0x39ed3a2f3a6d3aa7,0xb95fb913b8c4b872,0x396939ba3a073a4f,0xb9e5b996b943b8ec,0x38d8393a399639ed,0xba5eba0fb9bab95f,0x383d38b0391d3984,0xbac9ba7cba27b9cb
.quad 0x3b2b3b463b5f3b77,0xb71bb6aab637b5c2,0x3ad03af63b1a3b3b,0xb832b7e3b75eb6d7,0x3a653a993ac93af6,0xb8ceb887b83db7e3,0x2e46323e34a5361f,0xbbf6bbd9bba8bb64,0x3732381d389b3913,0xbb25baddba8aba2f,0x35da37053812389b,0xbb72bb30bae3ba8a,0x347535c23705381d,0xbbafbb77bb30badd,0x320d347535da3732,0xbbdbbbafbb72bb25
.quad 0x3bf23bf43bf53bf6,0x2f722f0e2eaa2e46,0x3bc93bce3bd43bd9,0x3365330332a1323e,0x3b843b913b9d3ba8,0x357c353434ed34a5,0x3b253b3b3b503b64,0x373236d7367c361f,0x38c43913395f39a8,0x3a6d3a2f39ed39a8,0x37f9385d38ba3913,0x3af03ab53a743a2f,0x364e373238073872,0x3b5a3b253ae93aa7,0x348d35933693378b,0x3bab3b803b4b3b0e
.quad 0x3aae3ad03af03b0e,0x3867383237f9378b,0x3a1f3a4f3a7c3aa7,0x392738ec38b03872,0x397b39ba39f63a2f,0x39d4399639563913,0x3c003c003c003c00,0,0x317933c63505361f,0x3be23bc33b993b64,0x2b11304e32d234a5,0x3bfd3bed3bd13ba8,0xabd926482f0e323e,0x3bfc3bff3bf43bd9,0xb1aaad7e1e482e46,0x3be03bf83c003bf6
.quad 0x3bf23bf43bf53bf6,0xaf72af0eaeaaae46,0x3bc93bce3bd43bd9,0xb365b303b2a1b23e,0x3b843b913b9d3ba8,0xb57cb534b4edb4a5,0x3b253b3b3b503b64,0xb732b6d7b67cb61f,0x38c43913395f39a8,0xba6dba2fb9edb9a8,0x37f9385d38ba3913,0xbaf0bab5ba74ba2f,0x364e373238073872,0xbb5abb25bae9baa7,0x348d35933693378b,0xbbabbb80bb4bbb0e
.quad 0x3aae3ad03af03b0e,0xb867b832b7f9b78b,0x3a1f3a4f3a7c3aa7,0xb927b8ecb8b0b872,0x397b39ba39f63a2f,0xb9d4b996b956b913,0xb4a5b23eae460000,0xbba8bbd9bbf6bc00,0x317933c63505361f,0xbbe2bbc3bb99bb64,0x2b11304e32d234a5,0xbbfdbbedbbd1bba8,0xabd926482f0e323e,0xbbfcbbffbbf4bbd9,0xb1aaad7e1e482e46,0xbbe0bbf8bc00bbf6
.quad 0x3bec3bed3bef3bf1,0x3080304e301d2fd6,0x3baf3bb63bbc3bc3,0x34753444341433c6,0x3b4b3b5a3b693b77,0x3693364e360835c2,0x3ac23add3af63b0e,0x3848381d37e3378b,0x36d7378b381d3872,0x3b3b3b0e3add3aa7,0x34bd359336653732,0x3ba43b803b553b25,0x3115330334753564,0x3be63bce3baf3b88,0x24b62d7e30e43303,0x3c003bf83be83bce
.quad 0x3a173a3f3a653a8a,0x3930390038ce389b,0x394d398439ba39ed,0x39fe39cb3996395f,0x386738b038f6393a,0x3aae3a7c3a473a0f,0x3c003c003c003c00,0,0xafd6aa4826482e46,0x3bf13bfe3bff3bf6,0xb42cb1dbaeaaa648,0x3bb93bdd3bf53bff,0xb64eb505b365b0b2,0x3b5a3b993bc93bea,0xb828b705b5abb444,0x3ad63b303b7b3bb6
.quad 0x3bec3bed3bef3bf1,0xb080b04eb01dafd6,0x3baf3bb63bbc3bc3,0xb475b444b414b3c6,0x3b4b3b5a3b693b77,0xb693b64eb608b5c2,0x3ac23add3af63b0e,0xb848b81db7e3b78b,0x36d7378b381d3872,0xbb3bbb0ebaddbaa7,0x34bd359336653732,0xbba4bb80bb55bb25,0x3115330334753564,0xbbe6bbcebbafbb88,0x24b62d7e30e43303,0xbc00bbf8bbe8bbce
.quad 0x3a173a3f3a653a8a,0xb930b900b8ceb89b,0x394d398439ba39ed,0xb9feb9cbb996b95f,0x386738b038f6393a,0xbaaeba7cba47ba0f,0xb913b872b78bb61f,0xba2fbaa7bb0ebb64,0xafd6aa4826482e46,0xbbf1bbfebbffbbf6,0xb42cb1dbaeaaa648,0xbbb9bbddbbf5bbff,0xb64eb505b365b0b2,0xbb5abb99bbc9bbea,0xb828b705b5abb444,0xbad6bb30bb7bbbb6
.quad 0x3be43be63be83bea,0x3147311530e430b2,0x3b913b993ba03ba8,0x3534350534d534a5,0x3b083b1a3b2b3b3b,0x37a1375e371b36d7,0x3a4f3a6d3a8a3aa7,0x38ec38c4389b3872,0x33c634a53564361f,0x3bc33ba83b883b64,0x2d1a304e320d33c6,0x3bf93bed3bdb3bc3,0xad7ea64828b62e46,0x3bf83bff3bff3bf6,0xb3f7b1dbaf72aa48,0x3bc03bdd3bf23bfe
.quad 0x3969399639c339ed,0x39e539ba398d395f,0x385d389b38d83913,0x3ab53a8a3a5e3a2f,0x3665370537a1381d,0x3b553b303b083add,0x3c003c003c003c00,0,0xb67cb564b444b23e,0x3b503b883bb63bd9,0xb867b7b7b693b564,0x3aae3b023b4b3b88,0xb972b8ecb85db78b,0x39dc3a4f3ab53b0e,0xba56b9dcb956b8c4,0x38e2397239f63a6d
.quad 0x3be43be63be83bea,0xb147b115b0e4b0b2,0x3b913b993ba03ba8,0xb534b505b4d5b4a5,0x3b083b1a3b2b3b3b,0xb7a1b75eb71bb6d7,0x3a4f3a6d3a8a3aa7,0xb8ecb8c4b89bb872,0x33c634a53564361f,0xbbc3bba8bb88bb64,0x2d1a304e320d33c6,0xbbf9bbedbbdbbbc3,0xad7ea64828b62e46,0xbbf8bbffbbffbbf6,0xb3f7b1dbaf72aa48,0xbbc0bbddbbf2bbfe
.quad 0x3969399639c339ed,0xb9e5b9bab98db95f,0x385d389b38d83913,0xbab5ba8aba5eba2f,0x3665370537a1381d,0xbb55bb30bb08badd,0xbb0ebaa7ba2fb9a8,0xb78bb872b913b9a8,0xb67cb564b444b23e,0xbb50bb88bbb6bbd9,0xb867b7b7b693b564,0xbaaebb02bb4bbb88,0xb972b8ecb85db78b,0xb9dcba4fbab5bb0e,0xba56b9dcb956b8c4,0xb8e2b972b9f6ba6d
.quad 0x3bdb3bdd3be03be2,0x320d31db31aa3179,0x3b6e3b773b803b88,0x35f135c235933564,0x3abc3ad03ae33af6,0x38523832381237e3,0x39cb39ed3a0f3a2f,0x3984395f393a3913,0x2a482e4630b2323e,0x3bfe3bf63bea3bd9,0xb080ad7ea7da2648,0x3bec3bf83bff3bff,0xb534b444b2a1b0b2,0x3b913bb63bd43bea,0xb7f9b705b608b505,0x3af03b303b693b99
.quad 0x38a638d83909393a,0x3a833a5e3a373a0f,0x36aa373237b7381d,0x3b463b253b023add,0x33963475351d35c2,0x3bc63baf3b953b77,0x3c003c003c003c00,0,0xb93ab8c4b848b78b,0x3a0f3a6d3ac23b0e,0xba47b9dcb969b8ec,0x38f6397239e53a4f,0xbb1abac2ba5eb9ed,0x375e384838d8395f,0xbbabbb6ebb20bac2,0x348d35f137483848
.quad 0x3bdb3bdd3be03be2,0xb20db1dbb1aab179,0x3b6e3b773b803b88,0xb5f1b5c2b593b564,0x3abc3ad03ae33af6,0xb852b832b812b7e3,0x39cb39ed3a0f3a2f,0xb984b95fb93ab913,0x2a482e4630b2323e,0xbbfebbf6bbeabbd9,0xb080ad7ea7da2648,0xbbecbbf8bbffbbff,0xb534b444b2a1b0b2,0xbb91bbb6bbd4bbea,0xb7f9b705b608b505,0xbaf0bb30bb69bb99
.quad 0x38a638d83909393a,0xba83ba5eba37ba0f,0x36aa373237b7381d,0xbb46bb25bb02badd,0x33963475351d35c2,0xbbc6bbafbb95bb77,0xbbf6bbd9bba8bb64,0xae46b23eb4a5b61f,0xb93ab8c4b848b78b,0xba0fba6dbac2bb0e,0xba47b9dcb969b8ec,0xb8f6b972b9e5ba4f,0xbb1abac2ba5eb9ed,0xb75eb848b8d8b95f,0xbbabbb6ebb20bac2,0xb48db5f1b748b848
.quad 0x3c003c003c003c00,0,0x3aa73b643bd93c00,0x3872361f323e0000,0x361f39a83b643c00,0x3b6439a8361f0000,0xb23e361f3aa73c00,0x3bd93b6438720000,0xb9a8000039a83c00,0x39a83c0039a80000,0xbbd9b61f38723c00,0x323e3b643aa70000,0xbb64b9a8361f3c00,0xb61f39a83b640000,0xb872bb64323e3c00,0xbaa7361f3bd90000
.quad 0x8000bc0000003c00,0xbc0000003c000000,0x3872bb64b23e3c00,0xbaa7b61f3bd90000,0x3b64b9a8b61f3c00,0xb61fb9a83b640000,0x3bd9b61fb8723c00,0x323ebb643aa70000,0x39a88000b9a83c00,0x39a8bc0039a80000,0x323e361fbaa73c00,0x3bd9bb6438720000,0xb61f39a8bb643c00,0x3b64b9a8361f0000,0xbaa73b64bbd93c00,0x3872b61f323e0000
.quad 0xbc003c00bc003c00,0x800000000000,0xbaa73b64bbd93c00,0xb872361fb23e0000,0xb61f39a8bb643c00,0xbb6439a8b61f0000,0x323e361fbaa73c00,0xbbd93b64b8720000,0x39a80000b9a83c00,0xb9a83c00b9a80000,0x3bd9b61fb8723c00,0xb23e3b64baa70000,0x3b64b9a8b61f3c00,0x361f39a8bb640000,0x3872bb64b23e3c00,0x3aa7361fbbd90000
.quad 0xbc0080003c00,0x3c000000bc000000,0xb872bb64323e3c00,0x3aa7b61fbbd90000,0xbb64b9a8361f3c00,0x361fb9a8bb640000,0xbbd9b61f38723c00,0xb23ebb64baa70000,0xb9a8800039a83c00,0xb9a8bc00b9a80000,0xb23e361f3aa73c00,0xbbd9bb64b8720000,0x361f39a83b643c00,0xbb64b9a8b61f0000,0x3aa73b643bd93c00,0xb872b61fb23e0000
.quad 0x3c003c003c003c00,0,0x323e361f387239a8,0x3bd93b643aa739a8,0xbb64b9a8b61f0000,0x361f39a83b643c00,0xb872bb64bbd9b9a8,0xbaa7b61f323e39a8,0x39a88000b9a8bc00,0xb9a8bc00b9a80000,0x3aa73b64323eb9a8,0x3872b61fbbd9b9a8,0xb61f39a83b648000,0x3b6439a8b61fbc00,0xbbd9b61f3aa739a8,0xb23e3b643872b9a8
.quad 0x8000bc0000003c00,0xbc0000003c008000,0x3bd9b61fbaa739a8,0xb23ebb64387239a8,0x361f39a8bb640000,0x3b64b9a8b61f3c00,0xbaa73b64b23eb9a8,0x3872361fbbd939a8,0xb9a8000039a8bc00,0xb9a83c00b9a80000,0x3872bb643bd9b9a8,0xbaa7361f323eb9a8,0x3b64b9a8361f8000,0x361fb9a83b64bc00,0xb23e361fb87239a8,0x3bd9bb643aa7b9a8
.quad 0xbc003c00bc003c00,0x800000008000,0xb23e361fb87239a8,0xbbd93b64baa739a8,0x3b64b9a8361f0000,0xb61f39a8bb643c00,0x3872bb643bd9b9a8,0x3aa7b61fb23e39a8,0xb9a8800039a8bc00,0x39a8bc0039a80000,0xbaa73b64b23eb9a8,0xb872b61f3bd9b9a8,0x361f39a8bb648000,0xbb6439a8361fbc00,0x3bd9b61fbaa739a8,0x323e3b64b872b9a8
.quad 0x8000bc0080003c00,0x3c000000bc008000,0xbbd9b61f3aa739a8,0x323ebb64b87239a8,0xb61f39a83b648000,0xbb64b9a8361f3c00,0x3aa73b64323eb9a8,0xb872361f3bd939a8,0x39a88000b9a8bc00,0x39a83c0039a80000,0xb872bb64bbd9b9a8,0x3aa7361fb23eb9a8,0xbb64b9a8b61f8000,0xb61fb9a8bb64bc00,0x323e361f387239a8,0xbbd9bb64baa7b9a8
.quad 0x3c003c003c003c00,0,0xb872b61fb23e0000,0x3aa73b643bd93c00,0xb61fb9a8bb64bc00,0xbb64b9a8b61f0000,0x3bd93b6438728000,0x323eb61fbaa7bc00,0xb9a8000039a83c00,0x39a83c0039a88000,0xb23ebb64baa70000,0xbbd9b61f38723c00,0x3b6439a8b61fbc00,0x361fb9a8bb640000,0xbaa7361f3bd98000,0x38723b64b23ebc00
.quad 0x8000bc0000003c00,0xbc0000003c008000,0x3aa7361fbbd90000,0x3872bb64b23e3c00,0xbb6439a8361fbc00,0x361f39a8bb640000,0x323ebb643aa78000,0xbbd9361f3872bc00,0x39a88000b9a83c00,0x39a8bc0039a88000,0xbbd93b64b8728000,0x323e361fbaa73c00,0x361fb9a83b64bc00,0xbb6439a8b61f0000,0x3872b61f323e8000,0x3aa7bb643bd9bc00
.quad 0xbc003c00bc003c00,0x800000008000,0x3872b61f323e8000,0xbaa73b64bbd93c00,0x361fb9a83b64bc00,0x3b64b9a8361f0000,0xbbd93b64b8728000,0xb23eb61f3aa7bc00,0x39a88000b9a83c00,0xb9a83c00b9a88000,0x323ebb643aa78000,0x3bd9b61fb8723c00,0xbb6439a8361fbc00,0xb61fb9a83b640000,0x3aa7361fbbd98000,0xb8723b64323ebc00
.quad 0xbc0080003c00,0x3c000000bc008000,0xbaa7361f3bd98000,0xb872bb64323e3c00,0x3b6439a8b61fbc00,0xb61f39a83b648000,0xb23ebb64baa78000,0x3bd9361fb872bc00,0xb9a8800039a83c00,0xb9a8bc00b9a88000,0x3bd93b6438728000,0xb23e361f3aa73c00,0xb61fb9a8bb64bc00,0x3b6439a8361f0000,0xb872b61fb23e8000,0xbaa7bb64bbd9bc00
.quad 0x3c003c003c003c00,0,0xbbd9bb64baa7b9a8,0x323e361f387239a8,0x3b6439a8361f8000,0xb61fb9a8bb64bc00,0xbaa7b61f323e39a8,0x38723b643bd939a8,0x39a88000b9a8bc00,0xb9a8bc00b9a80000,0xb872361f3bd939a8,0x3aa73b64323eb9a8,0x361fb9a8bb640000,0xbb64b9a8361f3c00,0xb23e3b643872b9a8,0x3bd9361fbaa7b9a8
.quad 0x8000bc0080003c00,0xbc0000003c008000,0x323e3b64b872b9a8,0x3bd9b61fbaa739a8,0xb61fb9a83b648000,0xbb6439a8361fbc00,0x3872361fbbd939a8,0x3aa7bb64323e39a8,0xb9a8800039a8bc00,0xb9a83c00b9a80000,0x3aa7b61fb23e39a8,0x3872bb643bd9b9a8,0xbb6439a8b61f8000,0xb61f39a8bb643c00,0x3bd9bb643aa7b9a8,0x323eb61f3872b9a8
.quad 0xbc003c00bc003c00,0x800080008000,0x3bd9bb643aa7b9a8,0xb23e361fb87239a8,0xbb6439a8b61f8000,0x361fb9a83b64bc00,0x3aa7b61fb23e39a8,0xb8723b64bbd939a8,0xb9a8800039a8bc00,0x39a8bc0039a80000,0x3872361fbbd939a8,0xbaa73b64b23eb9a8,0xb61fb9a83b640000,0x3b64b9a8b61f3c00,0x323e3b64b872b9a8,0xbbd9361f3aa7b9a8
.quad 0xbc0000003c00,0x3c008000bc008000,0xb23e3b643872b9a8,0xbbd9b61f3aa739a8,0x361fb9a8bb648000,0x3b6439a8b61fbc00,0xb872361f3bd939a8,0xbaa7bb64b23e39a8,0x39a80000b9a8bc00,0x39a83c0039a88000,0xbaa7b61f323e39a8,0xb872bb64bbd9b9a8,0x3b6439a8361f0000,0x361f39a83b643c00,0xbbd9bb64baa7b9a8,0xb23eb61fb872b9a8
.quad 0x3c003c003c003c00,0,0xbaa7bb64bbd9bc00,0xb872b61fb23e0000,0x361f39a83b643c00,0x3b6439a8361f8000,0x323eb61fbaa7bc00,0xbbd9bb64b8720000,0xb9a8000039a83c00,0x39a83c0039a88000,0x3bd9361fb872bc00,0xb23ebb64baa70000,0xbb64b9a8361f3c00,0xb61f39a83b648000,0x38723b64b23ebc00,0x3aa7b61fbbd90000
.quad 0x8000bc0080003c00,0xbc0000003c008000,0xb8723b64323ebc00,0x3aa7361fbbd90000,0x3b64b9a8b61f3c00,0xb61fb9a83b648000,0xbbd9361f3872bc00,0xb23e3b64baa70000,0x39a88000b9a83c00,0x39a8bc0039a88000,0xb23eb61f3aa7bc00,0xbbd93b64b8728000,0xb61f39a8bb643c00,0x3b64b9a8361f8000,0x3aa7bb643bd9bc00,0xb872361fb23e0000
.quad 0xbc003c00bc003c00,0x800080008000,0x3aa7bb643bd9bc00,0x3872b61f323e8000,0xb61f39a8bb643c00,0xbb6439a8b61f8000,0xb23eb61f3aa7bc00,0x3bd9bb6438720000,0x39a80000b9a83c00,0xb9a83c00b9a88000,0xbbd9361f3872bc00,0x323ebb643aa78000,0x3b64b9a8b61f3c00,0x361f39a8bb648000,0xb8723b64323ebc00,0xbaa7b61f3bd90000
.quad 0xbc0000003c00,0x3c000000bc008000,0x38723b64b23ebc00,0xbaa7361f3bd98000,0xbb64b9a8361f3c00,0x361fb9a8bb640000,0x3bd9361fb872bc00,0x323e3b643aa70000,0xb9a8000039a83c00,0xb9a8bc00b9a88000,0x323eb61fbaa7bc00,0x3bd93b6438728000,0x361f39a83b643c00,0xbb64b9a8b61f8000,0xbaa7bb64bbd9bc00,0x3872361f323e0000
.quad 0x3c003c003c003c00,0,0xb23eb61fb872b9a8,0xbbd9bb64baa7b9a8,0xbb64b9a8b61f0000,0x361f39a83b643c00,0x38723b643bd939a8,0x3aa7361fb23eb9a8,0x39a88000b9a8bc00,0xb9a8bc00b9a80000,0xbaa7bb64b23e39a8,0xb872361f3bd939a8,0xb61f39a83b648000,0x3b6439a8b61fbc00,0x3bd9361fbaa7b9a8,0x323ebb64b87239a8
.quad 0x8000bc0080003c00,0xbc0000003c008000,0xbbd9361f3aa7b9a8,0x323e3b64b872b9a8,0x361f39a8bb648000,0x3b64b9a8b61f3c00,0x3aa7bb64323e39a8,0xb872b61f3bd9b9a8,0xb9a8000039a8bc00,0xb9a83c00b9a80000,0xb8723b64bbd939a8,0x3aa7b61fb23e39a8,0x3b64b9a8361f8000,0x361fb9a83b64bc00,0x323eb61f3872b9a8,0xbbd93b64baa739a8
.quad 0xbc003c00bc003c00,0x800080008000,0x323eb61f3872b9a8,0x3bd9bb643aa7b9a8,0x3b64b9a8361f0000,0xb61f39a8bb643c00,0xb8723b64bbd939a8,0xbaa7361f323eb9a8,0xb9a8800039a8bc00,0x39a8bc0039a88000,0x3aa7bb64323e39a8,0x3872361fbbd939a8,0x361f39a8bb640000,0xbb6439a8361fbc00,0xbbd9361f3aa7b9a8,0xb23ebb64387239a8
.quad 0xbc0000003c00,0x3c000000bc008000,0x3bd9361fbaa7b9a8,0xb23e3b643872b9a8,0xb61f39a83b640000,0xbb64b9a8361f3c00,0xbaa7bb64b23e39a8,0x3872b61fbbd9b9a8,0x39a80000b9a8bc00,0x39a83c0039a80000,0x38723b643bd939a8,0xbaa7b61f323e39a8,0xbb64b9a8b61f8000,0xb61fb9a8bb64bc00,0xb23eb61fb872b9a8,0x3bd93b643aa739a8
.quad 0x3c003c003c003c00,0,0x3872361f323e8000,0xbaa7bb64bbd9bc00,0xb61fb9a8bb64bc00,0xbb64b9a8b61f0000,0xbbd9bb64b8720000,0xb23e361f3aa73c00,0xb9a8800039a83c00,0x39a83c0039a88000,0x323e3b643aa78000,0x3bd9361fb872bc00,0x3b6439a8b61fbc00,0x361fb9a8bb640000,0x3aa7b61fbbd98000,0xb872bb64323e3c00
.quad 0x8000bc0080003c00,0xbc0080003c008000,0xbaa7b61f3bd98000,0xb8723b64323ebc00,0xbb6439a8361fbc00,0x361f39a8bb640000,0xb23e3b64baa70000,0x3bd9b61fb8723c00,0x39a80000b9a83c00,0x39a8bc0039a88000,0x3bd9bb6438728000,0xb23eb61f3aa7bc00,0x361fb9a83b64bc00,0xbb6439a8b61f8000,0xb872361fb23e0000,0xbaa73b64bbd93c00
.quad 0xbc003c00bc003c00,0x80008000,0xb872361fb23e8000,0x3aa7bb643bd9bc00,0x361fb9a83b64bc00,0x3b64b9a8361f0000,0x3bd9bb6438720000,0x323e361fbaa73c00,0x39a88000b9a83c00,0xb9a83c00b9a88000,0xb23e3b64baa70000,0xbbd9361f3872bc00,0xbb6439a8361fbc00,0xb61fb9a83b640000,0xbaa7b61f3bd90000,0x3872bb64b23e3c00
.quad 0xbc0080003c00,0x3c008000bc008000,0x3aa7b61fbbd98000,0x38723b64b23ebc00,0x3b6439a8b61fbc00,0xb61f39a83b640000,0x323e3b643aa70000,0xbbd9b61f38723c00,0xb9a8000039a83c00,0xb9a8bc00b9a80000,0xbbd9bb64b8728000,0x323eb61fbaa7bc00,0xb61fb9a8bb64bc00,0x3b6439a8361f0000,0x3872361f323e0000,0x3aa73b643bd93c00
.quad 0x3c003c003c003c00,0,0x3bd93b643aa739a8,0xb23eb61fb872b9a8,0x3b6439a8361f8000,0xb61fb9a8bb64bc00,0x3aa7361fb23eb9a8,0xb872bb64bbd9b9a8,0x39a88000b9a8bc00,0xb9a8bc00b9a80000,0x3872b61fbbd9b9a8,0xbaa7bb64b23e39a8,0x361fb9a8bb648000,0xbb64b9a8361f3c00,0x323ebb64b87239a8,0xbbd9b61f3aa739a8
.quad 0x8000bc0080003c00,0xbc0000003c008000,0xb23ebb64387239a8,0xbbd9361f3aa7b9a8,0xb61fb9a83b648000,0xbb6439a8361fbc00,0xb872b61f3bd9b9a8,0xbaa73b64b23eb9a8,0xb9a8000039a8bc00,0xb9a83c00b9a88000,0xbaa7361f323eb9a8,0xb8723b64bbd939a8,0xbb6439a8b61f0000,0xb61f39a8bb643c00,0xbbd93b64baa739a8,0xb23e361fb87239a8
.quad 0xbc003c00bc003c00,0x800080008000,0xbbd93b64baa739a8,0x323eb61f3872b9a8,0xbb6439a8b61f0000,0x361fb9a83b64bc00,0xbaa7361f323eb9a8,0x3872bb643bd9b9a8,0xb9a8800039a8bc00,0x39a8bc0039a80000,0xb872b61f3bd9b9a8,0x3aa7bb64323e39a8,0xb61fb9a83b640000,0x3b64b9a8b61f3c00,0xb23ebb64387239a8,0x3bd9b61fbaa739a8
.quad 0xbc0080003c00,0x3c000000bc000000,0x323ebb64b87239a8,0x3bd9361fbaa7b9a8,0x361fb9a8bb648000,0x3b6439a8b61fbc00,0x3872b61fbbd9b9a8,0x3aa73b64323eb9a8,0x39a80000b9a8bc00,0x39a83c0039a80000,0x3aa7361fb23eb9a8,0x38723b643bd939a8,0x3b6439a8361f8000,0x361f39a83b643c00,0x3bd93b643aa739a8,0x323e361f387239a8
.quad 0xf7000000f2c0,0xf92e0000f70e,0xf4e00000f2d0,0xf4ee0000f2de,0xf4f00000f2e0,0xf4fe0000f2ee,0xf5000000f2f0,0xf50e0000f2fe,0xf5100000f300,0xf51e0000f30e,0xf5200000f310,0xf52e0000f31e,0xf5300000f320,0xf53e0000f32e,0xf5400000f330,0xf54e0000f33e
.quad 0xf5500000f340,0xf55e0000f34e,0xf5600000f350,0xf56e0000f35e,0xf5700000f360,0xf57e0000f36e,0xf5800000f370,0xf58e0000f37e,0xf5900000f380,0xf59e0000f38e,0xf5a00000f390,0xf5ae0000f39e,0xf5b00000f3a0,0xf5be0000f3ae,0xf5c00000f3b0,0xf5ce0000f3be
.quad 0xf4d00000f910,0xf4de0000f6e0,0xf7f00000fa00,0xf91e0000f7fe,0xf7e00000f9f0,0xfa0e0000f7ee,0xf7d00000f9e0,0xf9fe0000f7de,0xf7c00000f9d0,0xf9ee0000f7ce,0xf7b00000f9c0,0xf9de0000f7be,0xf7a00000f9b0,0xf9ce0000f7ae,0xf7900000f9a0,0xf9be0000f79e
.quad 0xf7800000f990,0xf9ae0000f78e,0xf7700000f980,0xf99e0000f77e,0xf7600000f970,0xf98e0000f76e,0xf7500000f960,0xf97e0000f75e,0xf7400000f950,0xf96e0000f74e,0xf7300000f940,0xf95e0000f73e,0xf7200000f930,0xf94e0000f72e,0xf7100000f920,0xf93e0000f71e
.quad 0xf8000000f3c0,0xf80e0000f3ce,0xf5e00000f3d0,0xf5ee0000f3de,0xf5f00000f3e0,0xf5fe0000f3ee,0xf6000000f3f0,0xf60e0000f3fe,0xf6100000f400,0xf61e0000f40e,0xf6200000f410,0xf62e0000f41e,0xf6300000f420,0xf63e0000f42e,0xf6400000f430,0xf64e0000f43e
.quad 0xf6500000f440,0xf65e0000f44e,0xf6600000f450,0xf66e0000f45e,0xf6700000f460,0xf67e0000f46e,0xf6800000f470,0xf68e0000f47e,0xf6900000f480,0xf69e0000f48e,0xf6a00000f490,0xf6ae0000f49e,0xf6b00000f4a0,0xf6be0000f4ae,0xf6c00000f4b0,0xf6ce0000f4be
.quad 0xf5d00000fa10,0xf5de0000fa1e,0xf8f00000fb00,0xf8fe0000fb0e,0xf8e00000faf0,0xf8ee0000fafe,0xf8d00000fae0,0xf8de0000faee,0xf8c00000fad0,0xf8ce0000fade,0xf8b00000fac0,0xf8be0000face,0xf8a00000fab0,0xf8ae0000fabe,0xf8900000faa0,0xf89e0000faae
.quad 0xf8800000fa90,0xf88e0000fa9e,0xf8700000fa80,0xf87e0000fa8e,0xf8600000fa70,0xf86e0000fa7e,0xf8500000fa60,0xf85e0000fa6e,0xf8400000fa50,0xf84e0000fa5e,0xf8300000fa40,0xf83e0000fa4e,0xf8200000fa30,0xf82e0000fa3e,0xf8100000fa20,0xf81e0000fa2e
.quad 0xc00000000000,0,0xc01000000010,0x8000000010,0xc02000000020,0x1000000020,0xc03000000030,0x9000000030,0xc04000000040,0x800000040,0xc05000000050,0x8800000050,0xc06000000060,0x1800000060,0xc07000000070,0x9800000070
.quad 0xc08000000080,0x14000000080,0xc09000000090,0x1c000000090,0xc0a0000000a0,0x150000000a0,0xc0b0000000b0,0x1d0000000b0,0xc0c0000000c0,0x148000000c0,0xc0d0000000d0,0x1c8000000d0,0xc0e0000000e0,0x158000000e0,0xc0f0000000f0,0x1d8000000f0
.quad 0x800000004000,0x2000000140,0x801000004010,0xa000000150,0x802000004020,0x3000000160,0x803000004030,0xb000000170,0x804000004040,0x2800000100,0x805000004050,0xa800000110,0x806000004060,0x3800000120,0x807000004070,0xb800000130
.quad 0x808000004080,0x160000001c0,0x809000004090,0x1e0000001d0,0x80a0000040a0,0x170000001e0,0x80b0000040b0,0x1f0000001f0,0x80c0000040c0,0x16800000180,0x80d0000040d0,0x1e800000190,0x80e0000040e0,0x178000001a0,0x80f0000040f0,0x1f8000001b0
.quad 0x400000008000,0x40000000200,0x401000008010,0x48000000210,0x402000008020,0x41000000220,0x403000008030,0x49000000230,0x404000008040,0x40800000240,0x405000008050,0x48800000250,0x406000008060,0x41800000260,0x407000008070,0x49800000270
.quad 0x408000008080,0x54000000280,0x409000008090,0x5c000000290,0x40a0000080a0,0x550000002a0,0x40b0000080b0,0x5d0000002b0,0x40c0000080c0,0x548000002c0,0x40d0000080d0,0x5c8000002d0,0x40e0000080e0,0x558000002e0,0x40f0000080f0,0x5d8000002f0
.quad 0xc000,0x42000000340,0x100000c010,0x4a000000350,0x200000c020,0x43000000360,0x300000c030,0x4b000000370,0x400000c040,0x42800000300,0x500000c050,0x4a800000310,0x600000c060,0x43800000320,0x700000c070,0x4b800000330
.quad 0x800000c080,0x560000003c0,0x900000c090,0x5e0000003d0,0xa00000c0a0,0x570000003e0,0xb00000c0b0,0x5f0000003f0,0xc00000c0c0,0x56800000380,0xd00000c0d0,0x5e800000390,0xe00000c0e0,0x578000003a0,0xf00000c0f0,0x5f8000003b0
.quad 0,0x8000000000,0x9000000000,0x11000000010,0x12000000000,0x1a000000020,0x1b000000000,0x23000000030,0x24000000000,0x2c000000040,0x2d000000000,0x35000000050,0x36000000000,0x3e000000060,0x3f000000000,0x47000000070
.quad 0x48000000000,0x50000000090,0x51000000000,0x590000000a0,0x5a000000000,0x620000000b0,0x63000000000,0x6b0000000c0,0x6c000000000,0x740000000d0,0x75000000000,0x7d0000000e0,0x7e000000000,0x860000000f0,0x87000000000,0x8f000000100
.quad 0x90000000000,0x98000000120,0x99000000000,0xa1000000130,0xa2000000000,0xaa000000140,0xab000000000,0xb3000000150,0xb4000000000,0xbc000000160,0xbd000000000,0xc5000000170,0xc6000000000,0xce000000180,0xcf000000000,0xd7000000190
.quad 0xd8000000000,0xe00000001b0,0xe1000000000,0xe90000001c0,0xea000000000,0xf20000001d0,0xf3000000000,0xfb0000001e0,0xfc000000000,0x1040000001f0,0x105000000000,0x10d000000200,0x10e000000000,0x116000000210,0x117000000000,0x11f000000220
.quad 0x4000000010,0x8000000240,0xd000000010,0x11000000250,0x16000000010,0x1a000000260,0x1f000000010,0x23000000270,0x28000000010,0x2c000000280,0x31000000010,0x35000000290,0x3a000000010,0x3e0000002a0,0x43000000010,0x470000002b0
.quad 0x4c000000010,0x500000002d0,0x55000000010,0x590000002e0,0x5e000000010,0x620000002f0,0x67000000010,0x6b000000300,0x70000000010,0x74000000310,0x79000000010,0x7d000000320,0x82000000010,0x86000000330,0x8b000000010,0x8f000000340
.quad 0x94000000010,0x98000000360,0x9d000000010,0xa1000000370,0xa6000000010,0xaa000000380,0xaf000000010,0xb3000000390,0xb8000000010,0xbc0000003a0,0xc1000000010,0xc50000003b0,0xca000000010,0xce0000003c0,0xd3000000010,0xd70000003d0
.quad 0xdc000000010,0xe00000003f0,0xe5000000010,0xe9000000400,0xee000000010,0xf2000000410,0xf7000000010,0xfb000000420,0x100000000010,0x104000000430,0x109000000010,0x10d000000440,0x112000000010,0x116000000450,0x11b000000010,0x11f000000460
.quad 0x7000000000,0x800000000000,0x7000000000,0xfe0000000200,0x7000000000,0xfc0000000400,0x7000000000,0xfa0000000600,0x7000000000,0xf80000000800,0x7000000000,0xf60000000a00,0x7000000000,0xf40000000c00,0x7000000000,0xf20000000e00
.quad 0x6000000010,0xf00000001000,0x6000000010,0xee0000001200,0x6000000010,0xec0000001400,0x6000000010,0xea0000001600,0x6000000010,0xe80000001800,0x6000000010,0xe60000001a00,0x6000000010,0xe40000001c00,0x6000000010,0xe20000001e00
.quad 0x5000000020,0xe00000002000,0x5000000020,0xde0000002200,0x5000000020,0xdc0000002400,0x5000000020,0xda0000002600,0x5000000020,0xd80000002800,0x5000000020,0xd60000002a00,0x5000000020,0xd40000002c00,0x5000000020,0xd20000002e00
.quad 0x4000000030,0xd00000003000,0x4000000030,0xce0000003200,0x4000000030,0xcc0000003400,0x4000000030,0xca0000003600,0x4000000030,0xc80000003800,0x4000000030,0xc60000003a00,0x4000000030,0xc40000003c00,0x4000000030,0xc20000003e00
.quad 0x3000000040,0xc00000004000,0x3000000040,0xbe0000004200,0x3000000040,0xbc0000004400,0x3000000040,0xba0000004600,0x3000000040,0xb80000004800,0x3000000040,0xb60000004a00,0x3000000040,0xb40000004c00,0x3000000040,0xb20000004e00
.quad 0x2000000050,0xb00000005000,0x2000000050,0xae0000005200,0x2000000050,0xac0000005400,0x2000000050,0xaa0000005600,0x2000000050,0xa80000005800,0x2000000050,0xa60000005a00,0x2000000050,0xa40000005c00,0x2000000050,0xa20000005e00
.quad 0x1000000060,0xa00000006000,0x1000000060,0x9e0000006200,0x1000000060,0x9c0000006400,0x1000000060,0x9a0000006600,0x1000000060,0x980000006800,0x1000000060,0x960000006a00,0x1000000060,0x940000006c00,0x1000000060,0x920000006e00
.quad 0x70,0x900000007000,0x70,0x8e0000007200,0x70,0x8c0000007400,0x70,0x8a0000007600,0x70,0x880000007800,0x70,0x860000007a00,0x70,0x840000007c00,0x70,0x820000007e00
.quad 0xf2c0,0,0x100000f4d0,0x10,0x100000f2c0,0x20,0x200000f4d0,0x30,0xf700,0x40,0x100000f910,0x50,0x100000f700,0x60,0x200000f910,0x70
.quad 0xfb40,0x80,0x100000fd50,0x90,0x100000fb40,0xa0,0x200000fd50,0xc2000000000000b0,0xff80,0xc0,0x1000010190,0xd0,0x100000ff80,0xe0,0x2000010190,0xf0
.quad 0x114c0,0x1000,0x10000116d0,0x1010,0x10000114c0,0x1020,0x20000116d0,0x1030,0x11900,0x1040,0x1000011b10,0x1050,0x1000011900,0x1060,0x2000011b10,0x1070
.quad 0x11d40,0x1080,0x1000011f50,0x1090,0x1000011d40,0x10a0,0x2000011f50,0x10b0,0x12180,0x10c0,0x1000012390,0x10d0,0x1000012180,0x10e0,0x2000012390,0x10f0
.quad 0xf2c0,0x2000,0x100000f4d0,0x2010,0x100000f2c0,0x2020,0x200000f4d0,0x2030,0xf700,0x2040,0x100000f910,0x2050,0x100000f700,0x2060,0x200000f910,0x2070
.quad 0xfb40,0x2080,0x100000fd50,0x2090,0x100000fb40,0x20a0,0x200000fd50,0xc2000000000020b0,0xff80,0x20c0,0x1000010190,0x20d0,0x100000ff80,0x20e0,0x2000010190,0x20f0
.quad 0xf2c0,0x3000,0x100000f4d0,0x3010,0x100000f2c0,0x3020,0x200000f4d0,0x3030,0xf700,0x3040,0x100000f910,0x3050,0x100000f700,0x3060,0x200000f910,0x3070
.quad 0xfb40,0x3080,0x100000fd50,0x3090,0x100000fb40,0x30a0,0x200000fd50,0x30b0,0xff80,0x30c0,0x1000010190,0x30d0,0x100000ff80,0x30e0,0x2000010190,0x30f0
.quad 0xf72e0000f2ee,0,0xf74e0000f30e,0x8,0xf76e0000f32e,0x10,0xf78e0000f34e,0x18,0xf7ae0000f36e,0x20,0xf7ce0000f38e,0x28,0xf7ee0000f3ae,0x30,0xf6e00000f6e0,0x38
.quad 0xf72e0000f2ee,0x40,0xf74e0000f30e,0x48,0xf76e0000f32e,0x50,0xf78e0000f34e,0x58,0xf7ae0000f36e,0x60,0xf7ce0000f38e,0x68,0xf7ee0000f3ae,0x70,0xf6e00000f6e0,0x78
.quad 0x1192e000114ee,0x80,0x1194e0001150e,0x88,0x1196e0001152e,0x90,0x1198e0001154e,0x98,0x119ae0001156e,0xa0,0x119ce0001158e,0xa8,0x119ee000115ae,0xb0,0x118e0000118e0,0xb8
.quad 0x1192e000114ee,0xc0,0x1194e0001150e,0xc8,0x1196e0001152e,0xd0,0x1198e0001154e,0xd8,0x119ae0001156e,0xe0,0x119ce0001158e,0xe8,0x119ee000115ae,0xf0,0x118e0000118e0,0xf8
.quad 0xf72e0000f2ee,0x100,0xf74e0000f30e,0x108,0xf76e0000f32e,0x110,0xf78e0000f34e,0x118,0xf7ae0000f36e,0x120,0xf7ce0000f38e,0x128,0xf7ee0000f3ae,0x130,0xf6e00000f6e0,0x138
.quad 0xf72e0000f2ee,0x140,0xf74e0000f30e,0x148,0xf76e0000f32e,0x150,0xf78e0000f34e,0x158,0xf7ae0000f36e,0x160,0xf7ce0000f38e,0x168,0xf7ee0000f3ae,0x170,0xf6e00000f6e0,0x178
.quad 0xf72e0000f2ee,0x180,0xf74e0000f30e,0x188,0xf76e0000f32e,0x190,0xf78e0000f34e,0x198,0xf7ae0000f36e,0x1a0,0xf7ce0000f38e,0x1a8,0xf7ee0000f3ae,0x1b0,0xf6e00000f6e0,0x1b8
.quad 0xf72e0000f2ee,0x1c0,0xf74e0000f30e,0x1c8,0xf76e0000f32e,0x1d0,0xf78e0000f34e,0x1d8,0xf7ae0000f36e,0x1e0,0xf7ce0000f38e,0x1e8,0xf7ee0000f3ae,0x1f0,0xf6e00000f6e0,0x1f8
.quad 0xf2c0,0,0x100000f4d0,0x10,0x100000f2c0,0x20,0x200000f4d0,0x30,0xf700,0x40,0x100000f910,0x50,0x100000f700,0x60,0x200000f910,0x70
.quad 0xfb40,0x80,0x100000fd50,0x90,0x100000fb40,0xa0,0x200000fd50,0xc2000000000000b0,0xff80,0xc0,0x1000010190,0xd0,0x100000ff80,0xe0,0x2000010190,0xf0
.quad 0x114c0,0x1000,0x10000116d0,0x1010,0x10000114c0,0x1020,0x20000116d0,0x1030,0x11900,0x1040,0x1000011b10,0x1050,0x1000011900,0x1060,0x2000011b10,0x1070
.quad 0x11d40,0x1080,0x1000011f50,0x1090,0x1000011d40,0x10a0,0x2000011f50,0x10b0,0x12180,0x10c0,0x1000012390,0x10d0,0x1000012180,0x10e0,0x2000012390,0x10f0
.quad 0xea40,0x2000,0x100000ec50,0x2010,0x100000ea40,0x2020,0x200000ec50,0x2030,0xee80,0x2040,0x100000f090,0x2050,0x100000ee80,0x2060,0x200000f090,0x2070
.quad 0xf2c0,0x2080,0x100000f4d0,0x2090,0x100000f2c0,0x20a0,0x200000f4d0,0xc2000000000020b0,0xf700,0x20c0,0x100000f910,0x20d0,0x100000f700,0x20e0,0x200000f910,0x20f0
.quad 0xf2c0,0x3000,0x100000f4d0,0x3010,0x100000f2c0,0x3020,0x200000f4d0,0x3030,0xf700,0x3040,0x100000f910,0x3050,0x100000f700,0x3060,0x200000f910,0x3070
.quad 0xfb40,0x3080,0x100000fd50,0x3090,0x100000fb40,0x30a0,0x200000fd50,0x30b0,0xff80,0x30c0,0x1000010190,0x30d0,0x100000ff80,0x30e0,0x2000010190,0x30f0
.quad 0xf72e0000f2ee,0,0xf74e0000f30e,0x8,0xf76e0000f32e,0x10,0xf78e0000f34e,0x18,0xf7ae0000f36e,0x20,0xf7ce0000f38e,0x28,0xf7ee0000f3ae,0x30,0xf6e00000f6e0,0x38
.quad 0xf72e0000f2ee,0x40,0xf74e0000f30e,0x48,0xf76e0000f32e,0x50,0xf78e0000f34e,0x58,0xf7ae0000f36e,0x60,0xf7ce0000f38e,0x68,0xf7ee0000f3ae,0x70,0xf6e00000f6e0,0x78
.quad 0x1192e000114ee,0x80,0x1194e0001150e,0x88,0x1196e0001152e,0x90,0x1198e0001154e,0x98,0x119ae0001156e,0xa0,0x119ce0001158e,0xa8,0x119ee000115ae,0xb0,0x118e0000118e0,0xb8
.quad 0x1192e000114ee,0xc0,0x1194e0001150e,0xc8,0x1196e0001152e,0xd0,0x1198e0001154e,0xd8,0x119ae0001156e,0xe0,0x119ce0001158e,0xe8,0x119ee000115ae,0xf0,0x118e0000118e0,0xf8
.quad 0xeeae0000ea6e,0x100,0xeece0000ea8e,0x108,0xeeee0000eaae,0x110,0xef0e0000eace,0x118,0xef2e0000eaee,0x120,0xef4e0000eb0e,0x128,0xef6e0000eb2e,0x130,0xee600000ee60,0x138
.quad 0xeeae0000ea6e,0x140,0xeece0000ea8e,0x148,0xeeee0000eaae,0x150,0xef0e0000eace,0x158,0xef2e0000eaee,0x160,0xef4e0000eb0e,0x168,0xef6e0000eb2e,0x170,0xee600000ee60,0x178
.quad 0xf72e0000f2ee,0x180,0xf74e0000f30e,0x188,0xf76e0000f32e,0x190,0xf78e0000f34e,0x198,0xf7ae0000f36e,0x1a0,0xf7ce0000f38e,0x1a8,0xf7ee0000f3ae,0x1b0,0xf6e00000f6e0,0x1b8
.quad 0xf72e0000f2ee,0x1c0,0xf74e0000f30e,0x1c8,0xf76e0000f32e,0x1d0,0xf78e0000f34e,0x1d8,0xf7ae0000f36e,0x1e0,0xf7ce0000f38e,0x1e8,0xf7ee0000f3ae,0x1f0,0xf6e00000f6e0,0x1f8
.quad 0x8000280028002800,0x8000280080002800,0x964827fea8002800,0x9cb227ea9a4627f6,0x9a4627f628002800,0xa0a527a89e3e27d9,0x9cb227eaa8002800,0xa2d7273ba0a527a8,0x9e3e27d928002800,0xa47226a7a21f2764,0x9fc627c3a8002800,0xa55f25eda38b270e,0xa0a527a828002800,0xa62f2513a47226a7,0xa1642788a8002800,0xa6dd241da513262f
.quad 0xa21f276428002800,0xa764221fa5a825a8,0xa2d7273ba8002800,0xa7c31fc6a62f2513,0xa38b270e28002800,0xa7f61a46a6a72472,0xa41d26dda8002800,0xa7fe9648a70e238b,0xa47226a728002800,0xa7d99e3ea764221f,0xa4c4266da8002800,0xa788a164a7a820a5,0xa513262f28002800,0xa70ea38ba7d91e3e,0xa55f25eda8002800,0xa66da4c4a7f61a46
.quad 0xa5a825a828002800,0xa5a8a5a8a8000000,0xa5ed255fa8002800,0xa4c4a66da7f69a46,0xa62f251328002800,0xa38ba70ea7d99e3e,0xa66d24c4a8002800,0xa164a788a7a8a0a5,0xa6a7247228002800,0x9e3ea7d9a764a21f,0xa6dd241da8002800,0x9648a7fea70ea38b,0xa70e238b28002800,0x1a46a7f6a6a7a472,0xa73b22d7a8002800,0x1fc6a7c3a62fa513
.quad 0xa764221f28002800,0x221fa764a5a8a5a8,0xa7882164a8002800,0x241da6dda513a62f,0xa7a820a528002800,0x2513a62fa472a6a7,0xa7c31fc6a8002800,0x25eda55fa38ba70e,0xa7d91e3e28002800,0x26a7a472a21fa764,0xa7ea1cb2a8002800,0x273ba2d7a0a5a7a8,0xa7f61a4628002800,0x27a8a0a59e3ea7d9,0xa7fe1648a8002800,0x27ea9cb29a46a7f6
.quad 0x8000280080002800,0x8000280080002800,0x9fc627c39e3e27d9,0xa1642788a0a527a8,0xa38b270ea21f2764,0xa513262fa47226a7,0xa55f25eda47226a7,0xa6dd241da62f2513,0xa6a72472a5a825a8,0xa7d91e3ea764221f,0xa7882164a6a72472,0xa7ea9cb2a7f61a46,0xa7f61a46a764221f,0xa70ea38ba7d99e3e,0xa7ea9cb2a7d91e3e,0xa55fa5eda70ea38b
.quad 0xa764a21fa8000000,0xa21fa764a5a8a5a8,0xa66da4c4a7d99e3e,0x9648a7fea38ba70e,0xa513a62fa764a21f,0x20a5a7a89e3ea7d9,0xa2d7a73ba6a7a472,0x24c4a66d1a46a7f6,0x9e3ea7d9a5a8a5a8,0x26a7a472221fa764,0x1648a7fea472a6a7,0x27c39fc62513a62f,0x20a5a7a8a21fa764,0x27f61a4626a7a472,0x241da6dd9e3ea7d9,0x273b22d727a8a0a5
.quad 0x25a8a5a88000a800,0x25a825a828008000,0x26dda41d1e3ea7d9,0x22d7273b27a820a5,0x27a8a0a5221fa764,0x1a4627f626a72472,0x27fe96482472a6a7,0x9fc627c32513262f,0x27d91e3e25a8a5a8,0xa47226a7221f2764,0x273b22d726a7a472,0xa66d24c41a4627f6,0x262f25132764a21f,0xa7a820a59e3e27d9,0x24c4266d27d99e3e,0xa7fe9648a38b270e
.quad 0x221f276428008000,0xa764a21fa5a825a8,0x1cb227ea27d91e3e,0xa5eda55fa70e238b,0x9a4627f62764221f,0xa38ba70ea7d91e3e,0xa164278826a72472,0x9cb2a7eaa7f69a46,0xa47226a725a825a8,0x1e3ea7d9a764a21f,0xa5ed255f247226a7,0x241da6dda62fa513,0xa70e238b221f2764,0x262fa513a472a6a7,0xa7c31fc61e3e27d9,0x2788a164a0a5a7a8
.quad 0x8000280080002800,0x8000280080002800,0xa2d7273ba21f2764,0xa41d26dda38b270e,0xa62f2513a5a825a8,0xa70e238ba6a72472,0xa7c31fc6a764221f,0xa7fe9648a7f61a46,0xa7d99e3ea8000000,0xa6a7a472a764a21f,0xa66da4c4a764a21f,0xa2d7a73ba513a62f,0xa38ba70ea5a8a5a8,0x1a46a7f69e3ea7d9,0x9648a7fea21fa764,0x24c4a66d20a5a7a8
.quad 0x221fa7648000a800,0x2764a21f25a8a5a8,0x25eda55f221fa764,0x27ea1cb227a8a0a5,0x27a8a0a525a8a5a8,0x262f251327d91e3e,0x27ea1cb22764a21f,0x21642788262f2513,0x26a7247228008000,0x9e3e27d9221f2764,0x241d26dd2764221f,0xa55f25ed9a4627f6,0x1a4627f625a825a8,0xa7a820a5a47226a7,0xa1642788221f2764,0xa7c39fc6a70e238b
.quad 0xa5a825a800002800,0xa5a8a5a8a8000000,0xa7882164a21f2764,0x9fc6a7c3a70ea38b,0xa7f69a46a5a825a8,0x20a5a7a8a472a6a7,0xa6dda41da764221f,0x25eda55f9a46a7f6,0xa472a6a7a8000000,0x27d99e3e221fa764,0x9cb2a7eaa764a21f,0x27882164262fa513,0x20a5a7a8a5a8a5a8,0x2513262f27d99e3e,0x255fa5eda21fa764,0x1cb227ea27a820a5
.quad 0x2764a21f8000a800,0xa21f276425a825a8,0x27fe1648221fa764,0xa66d24c420a527a8,0x270e238b25a8a5a8,0xa7f61a469e3e27d9,0x24c4266d2764a21f,0xa73ba2d7a513262f,0x1e3e27d928008000,0xa472a6a7a764221f,0x9fc627c32764221f,0x9648a7fea7f69a46,0xa513262f25a825a8,0x238ba70ea6a7a472,0xa73b22d7221f2764,0x26dda41da38ba70e
.quad 0x8000280080002800,0x8000280080002800,0xa4c4266da47226a7,0xa55f25eda513262f,0xa7a820a5a764221f,0xa7f61a46a7d91e3e,0xa788a164a7d99e3e,0xa66da4c4a70ea38b,0xa472a6a7a5a8a5a8,0x9e3ea7d9a21fa764,0x1648a7fe9e3ea7d9,0x241da6dd20a5a7a8,0x2513a62f221fa764,0x27a8a0a526a7a472,0x27c39fc626a7a472,0x273b22d727f61a46
.quad 0x2764221f28008000,0x221f276425a825a8,0x241d26dd26a72472,0xa16427881a4627f6,0x9a4627f6221f2764,0xa70e238ba47226a7,0xa55f25ed9e3e27d9,0xa7c39fc6a7a820a5,0xa7d91e3ea5a825a8,0xa472a6a7a764a21f,0xa73ba2d7a7d91e3e,0x1cb2a7eaa38ba70e,0xa38ba70ea764a21f,0x262fa5131e3ea7d9,0x1cb2a7eaa472a6a7,0x27fe1648262fa513
.quad 0x25a8a5a88000a800,0x25a825a828008000,0x27ea9cb22472a6a7,0x164827fe262f2513,0x270e238b2764a21f,0xa513262f1e3e27d9,0x22d7273b27d91e3e,0xa7ea1cb2a38b270e,0x9e3e27d925a825a8,0xa6a7a472a764221f,0xa5ed255f1e3e27d9,0x9fc6a7c3a7a8a0a5,0xa7f61a46a21f2764,0x238ba70ea472a6a7,0xa6dda41da6a72472,0x2788a1641a46a7f6
.quad 0xa21fa764a8000000,0x2764221f25a8a5a8,0x1fc6a7c3a6a7a472,0x22d7273b27f69a46,0x262fa513a21fa764,0xa0a527a826a72472,0x27fe96481e3ea7d9,0xa6dd241d20a527a8,0x26a7247225a8a5a8,0xa7d99e3ea21f2764,0x2164278827d99e3e,0xa4c4a66da70e238b,0xa0a527a82764221f,0x1a46a7f6a7d99e3e,0xa66d24c4247226a7,0x25eda55fa513a62f
.quad 0x8000280080002800,0x8000280080002800,0xa5ed255fa5a825a8,0xa66d24c4a62f2513,0xa7f69a46a8000000,0xa7a8a0a5a7d99e3e,0xa4c4a66da5a8a5a8,0xa164a788a38ba70e,0x1e3ea7d98000a800,0x2472a6a7221fa764,0x26dda41d25a8a5a8,0x27fe964827a8a0a5,0x27a820a528008000,0x2513262f26a72472,0x22d7273b25a825a8,0x9fc627c31a4627f6
.quad 0xa21f276400002800,0xa764221fa5a825a8,0xa7882164a5a825a8,0xa6dda41da7f69a46,0xa70ea38ba8000000,0x9a46a7f6a472a6a7,0x9fc6a7c3a5a8a5a8,0x25eda55f20a5a7a8,0x2472a6a78000a800,0x27d91e3e2764a21f,0x27ea9cb225a8a5a8,0x22d7273b270e238b,0x262f251328008000,0xa38b270e1e3e27d9,0x164827fe25a825a8,0xa7ea1cb2a513262f
.quad 0xa5a825a800002800,0xa5a8a5a8a8000000,0xa7fe9648a5a825a8,0x1cb2a7eaa513a62f,0xa513a62fa8000000,0x270ea38b1e3ea7d9,0x1cb2a7eaa5a8a5a8,0x273b22d7270ea38b,0x26a7a4728000a800,0x1e3e27d92764221f,0x27c31fc625a8a5a8,0xa55f25ed20a527a8,0x238b270e28008000,0xa7f69a46a47226a7,0xa164278825a825a8,0xa41da6dda7f61a46
.quad 0xa764221f00002800,0x221fa764a5a8a5a8,0xa73ba2d7a5a825a8,0x27c39fc61a46a7f6,0xa0a5a7a8a8008000,0x262f251326a7a472,0x241da6dda5a8a5a8,0x964827fe27a820a5,0x27d99e3e8000a800,0xa6a72472221f2764,0x266d24c425a8a5a8,0xa788a164a38b270e,0x1a4627f628008000,0xa0a5a7a8a7d91e3e,0xa55f25ed25a825a8,0x24c4a66da62fa513
.quad 0x8000280080002800,0x8000280080002800,0xa6dd241da6a72472,0xa73b22d7a70e238b,0xa70ea38ba764a21f,0xa62fa513a6a7a472,0x9648a7fe9e3ea7d9,0x1fc6a7c31a46a7f6,0x26a7a47225a8a5a8,0x27d99e3e2764a21f,0x273b22d727d91e3e,0x24c4266d262f2513,0x1a4627f6221f2764,0xa38b270e9e3e27d9,0xa66d24c4a47226a7,0xa7fe9648a7a820a5
.quad 0xa764a21fa8000000,0xa21fa764a5a8a5a8,0x9cb2a7eaa472a6a7,0x255fa5ed20a5a7a8,0x262fa513221fa764,0x27a820a527d99e3e,0x2788216427d99e3e,0x1cb227ea2513262f,0x1e3e27d925a825a8,0xa6a72472a21f2764,0xa5ed255f9e3e27d9,0xa6dda41da7f61a46,0xa7a8a0a5a764221f,0x1a46a7f6a472a6a7,0x9fc6a7c3a6a7a472,0x2788a164238ba70e
.quad 0x25a8a5a88000a800,0x25a825a828008000,0x27c31fc626a7a472,0xa1642788238b270e,0x20a527a82764221f,0xa7f61a46a47226a7,0xa55f25ed1e3e27d9,0xa41da6dda7f69a46,0xa7d99e3ea5a825a8,0x2472a6a7a21fa764,0xa164a788a7d99e3e,0x27ea1cb22513a62f,0x2513a62fa21fa764,0x20a527a827d91e3e,0x27ea1cb22472a6a7,0xa5ed255f20a527a8
.quad 0x221f276428008000,0xa764a21fa5a825a8,0xa4c4266d247226a7,0x9648a7fea7a8a0a5,0xa7f69a46a21f2764,0x270ea38b9e3ea7d9,0xa2d7a73ba7d91e3e,0x266d24c4262fa513,0x2472a6a7a5a8a5a8,0x9e3e27d92764221f,0x27fe16481e3ea7d9,0xa7c31fc61a4627f6,0x238b270e2764a21f,0xa513a62fa6a72472,0xa41d26dd26a72472,0x22d7a73ba70ea38b
.quad 0x8000280080002800,0x8000280080002800,0xa7882164a764221f,0xa7c31fc6a7a820a5,0xa513a62fa5a8a5a8,0xa38ba70ea472a6a7,0x241da6dd221fa764,0x25eda55f2513a62f,0x27d91e3e28008000,0x26a724722764221f,0x1cb227ea221f2764,0xa16427889a4627f6,0xa70e238ba5a825a8,0xa7f69a46a7d91e3e,0xa5eda55fa764a21f,0x9cb2a7eaa38ba70e
.quad 0x221fa7648000a800,0x2764a21f25a8a5a8,0x27fe16482764a21f,0x24c4266d270e238b,0x20a527a825a825a8,0xa513262f9e3e27d9,0xa66d24c4a21f2764,0xa73ba2d7a7f61a46,0xa6a7a472a8000000,0x1e3ea7d9a21fa764,0x1fc6a7c3a21fa764,0x27fe9648262fa513,0x27f69a4625a8a5a8,0x20a527a826a72472,0x22d7273b2764221f,0xa6dd241da0a527a8
.quad 0xa5a825a800002800,0xa5a8a5a8a8008000,0xa73ba2d7a764221f,0x241da6dda0a5a7a8,0x1a46a7f6a5a8a5a8,0x27a820a526a7a472,0x27c39fc6221fa764,0x964827fe262f2513,0x247226a728008000,0xa7d91e3ea21f2764,0xa4c4266d221f2764,0xa2d7a73ba7f69a46,0xa7a8a0a5a5a825a8,0x262fa5139e3ea7d9,0x9648a7fea764a21f,0x266d24c4270ea38b
.quad 0x2764a21f8000a800,0xa21f276425a825a8,0x255f25ed2764a21f,0xa7ea9cb2a38b270e,0xa38b270e25a825a8,0x9a46a7f6a7d99e3e,0xa7ea9cb2a21f2764,0x2788a1649a46a7f6,0x9e3ea7d9a8008000,0x247226a72764a21f,0x26dda41da21fa764,0xa55f25ed2513262f,0x262f251325a8a5a8,0xa70ea38ba47226a7,0xa16427882764221f,0x1fc6a7c3a7a8a0a5
.quad 0x8000280080002800,0x8000280080002800,0xa7ea1cb2a7d91e3e,0xa7fe1648a7f61a46,0xa0a5a7a8a21fa764,0x9a46a7f69e3ea7d9,0x273ba2d726a7a472,0x27ea9cb227a8a0a5,0x247226a725a825a8,0x1e3e27d9221f2764,0xa5ed255fa47226a7,0xa7c31fc6a70e238b,0xa62fa513a764a21f,0xa0a5a7a8a472a6a7,0x241da6dd1e3ea7d9,0x2788a164262fa513
.quad 0x2764221f28008000,0x221f276425a825a8,0x9fc627c31e3e27d9,0xa73b22d7a513262f,0xa7f69a46a764221f,0xa38ba70ea6a7a472,0x9648a7fea472a6a7,0x26dda41d238ba70e,0x27d99e3e25a8a5a8,0x247226a72764221f,0x2164278826a72472,0xa66d24c4a0a527a8,0xa70e238ba21f2764,0xa513a62fa7d99e3e,0xa4c4a66da7d99e3e,0x25eda55f1a46a7f6
.quad 0x25a8a5a88000a800,0x25a825a828008000,0x266d24c427d99e3e,0xa55f25ed1a4627f6,0xa38b270e221f2764,0xa62fa513a7d91e3e,0xa788a164a6a72472,0x24c4a66da0a5a7a8,0x1e3ea7d9a5a8a5a8,0x26a724722764a21f,0x27fe16482472a6a7,0xa41d26dd238b270e,0x1a4627f62764221f,0xa70ea38ba6a72472,0xa7c31fc69e3e27d9,0x22d7a73ba513a62f
.quad 0xa21fa764a8008000,0x2764221f25a8a5a8,0x26dda41d9e3ea7d9,0xa1642788262f2513,0x2513262f2764a21f,0xa7a8a0a5a47226a7,0xa55f25ed247226a7,0x1fc6a7c3a70ea38b,0xa6a7a472a5a825a8,0x27d91e3e221fa764,0x22d7a73ba6a7a472,0x9cb227ea27a820a5,0x27a820a5221fa764,0xa7f69a469e3e27d9,0x9cb227ea27d91e3e,0x1648a7fea7f69a46
.quad 0x8000280080002800,0x8000280080002800,0xa7fe9648a8000000,0xa7ea9cb2a7f69a46,0x1a46a7f68000a800,0x20a5a7a81e3ea7d9,0x27ea1cb228008000,0x273b22d727a820a5,0x9e3e27d900002800,0xa47226a7a21f2764,0xa7c39fc6a8000000,0xa5eda55fa70ea38b,0x20a5a7a88000a800,0x262fa5132472a6a7,0x2788216428008000,0x241d26dd262f2513
.quad 0xa21f276400002800,0xa764221fa5a825a8,0xa73ba2d7a8000000,0x9fc6a7c3a513a62f,0x238ba70e8000a800,0x27f69a4626a7a472,0x26dd241d28008000,0x964827fe238b270e,0xa47226a700002800,0xa7d99e3ea764221f,0xa66da4c4a8008000,0x2164a788a0a5a7a8,0x2513a62f8000a800,0x270e238b27d99e3e,0x25ed255f28008000,0xa4c4266d1a4627f6
.quad 0xa5a825a800002800,0xa5a8a5a8a8008000,0xa55fa5eda8008000,0x266da4c41a46a7f6,0x262fa5138000a800,0x238b270e27d91e3e,0x24c4266d28008000,0xa7882164a0a527a8,0xa6a7247200002800,0x9e3ea7d9a764a21f,0xa41da6dda8008000,0x27fe9648238ba70e,0x270ea38b8000a800,0x9a4627f626a72472,0x22d7273b28008000,0xa7c39fc6a513262f
.quad 0xa764221f00002800,0x221fa764a5a8a5a8,0xa164a788a8008000,0x26dd241d262fa513,0x27a8a0a50000a800,0xa513262f247226a7,0x1fc627c328008000,0xa55fa5eda70e238b,0xa7d91e3e00002800,0x26a7a472a21fa764,0x9cb2a7eaa8008000,0x22d7273b27a8a0a5,0x27f69a468000a800,0xa7a820a51e3e27d9,0x164827fe28008000,0x9cb2a7eaa7f61a46
.quad 0x8000280080002800,0x8000280080002800,0xa7c39fc6a7d99e3e,0xa788a164a7a8a0a5,0x238ba70e221fa764,0x2513a62f2472a6a7,0x25ed255f26a72472,0x241d26dd2513262f,0xa6a72472a5a825a8,0xa7d91e3ea764221f,0xa164a788a472a6a7,0x1cb2a7ea9a46a7f6,0x27f69a462764a21f,0x270e238b27d91e3e,0x9cb227ea1e3e27d9,0xa5ed255fa38b270e
.quad 0xa764a21fa8000000,0xa21fa764a5a8a5a8,0x24c4a66d1e3ea7d9,0x27fe9648270ea38b,0x2513262f2764221f,0xa0a527a81e3e27d9,0xa73b22d7a47226a7,0xa66da4c4a7f69a46,0x9e3ea7d9a5a8a5a8,0x26a7a472221fa764,0x27fe164826a7a472,0x1fc627c3262f2513,0xa0a527a8221f2764,0xa7f69a46a6a72472,0xa6dda41da7d91e3e,0x22d7a73ba0a5a7a8
.quad 0x25a8a5a88000a800,0x25a825a828008000,0x241d26dd27d91e3e,0xa73b22d7a0a527a8,0xa7a820a5a21f2764,0x9a46a7f6a6a7a472,0x9648a7fea6a7a472,0x27c31fc6262fa513,0x27d91e3e25a8a5a8,0xa47226a7221f2764,0xa2d7273b247226a7,0xa4c4a66da7f61a46,0xa62fa513a764221f,0x27a8a0a51e3ea7d9,0x266da4c49e3ea7d9,0x964827fe270e238b
.quad 0x221f276428008000,0xa764a21fa5a825a8,0xa7ea1cb29e3e27d9,0x255fa5eda38ba70e,0x1a46a7f6a764a21f,0x238b270e27d99e3e,0x278821642472a6a7,0xa7ea1cb29a4627f6,0xa47226a725a825a8,0x1e3ea7d9a764a21f,0xa55fa5eda6a72472,0x26dd241d2513a62f,0x270ea38ba21fa764,0xa62f2513247226a7,0x1fc627c327d99e3e,0xa164a788a7a820a5
.quad 0x8000280080002800,0x8000280080002800,0xa73ba2d7a764a21f,0xa6dda41da70ea38b,0x262fa51325a8a5a8,0x270ea38b26a7a472,0x1fc627c3221f2764,0x964827fe1a4627f6,0xa7d99e3ea8000000,0xa6a7a472a764a21f,0x24c4a66d221fa764,0x273ba2d7262fa513,0x238b270e25a825a8,0x9a4627f61e3e27d9,0xa7fe1648a764221f,0xa66da4c4a7a8a0a5
.quad 0x221fa7648000a800,0x2764a21f25a8a5a8,0x255f25ed2764221f,0x9cb227ea20a527a8,0xa7a820a5a5a825a8,0xa62fa513a7d99e3e,0x1cb2a7eaa21fa764,0x2788a1642513a62f,0x26a7247228008000,0x9e3e27d9221f2764,0xa6dd241da21f2764,0xa5eda55fa7f69a46,0x9a46a7f6a5a8a5a8,0x27a8a0a52472a6a7,0x278821642764a21f,0x9fc627c3238b270e
.quad 0xa5a825a800002800,0xa5a8a5a8a8008000,0xa164a788a764a21f,0x27c39fc6238ba70e,0x27f61a4625a8a5a8,0xa0a527a8247226a7,0xa41d26dd221f2764,0xa55fa5eda7f61a46,0xa472a6a7a8008000,0x27d99e3e221fa764,0x27ea9cb2221fa764,0xa16427882513262f,0xa0a527a825a825a8,0xa513a62fa7d91e3e,0xa5eda55fa764221f,0x27ea9cb220a5a7a8
.quad 0x2764a21f8000a800,0xa21f276425a825a8,0x964827fe2764221f,0xa4c4a66da7a820a5,0xa70ea38ba5a825a8,0x27f69a461e3ea7d9,0x266da4c4a21fa764,0xa2d7273b262f2513,0x1e3e27d928008000,0xa472a6a7a764221f,0xa7c39fc6a21f2764,0x27fe96481a46a7f6,0x2513a62fa5a8a5a8,0xa38b270e26a72472,0x22d7273b2764a21f,0xa41da6dda70e238b
.quad 0x8000280080002800,0x8000280080002800,0xa66da4c4a6a7a472,0xa5eda55fa62fa513,0x27a8a0a52764a21f,0x27f69a4627d99e3e,0xa16427889e3e27d9,0xa4c4266da38b270e,0xa472a6a7a5a8a5a8,0x9e3ea7d9a21fa764,0x27fe164827d99e3e,0x26dd241d27a820a5,0xa513262fa21f2764,0xa7a820a5a6a72472,0x9fc6a7c3a472a6a7,0x22d7a73b1a46a7f6
.quad 0x2764221f28008000,0x221f276425a825a8,0xa6dd241da47226a7,0xa788a164a7f61a46,0x1a46a7f6a21fa764,0x270ea38b2472a6a7,0x25ed255f27d91e3e,0x9fc627c320a527a8,0xa7d91e3ea5a825a8,0xa472a6a7a764a21f,0x22d7a73b9e3ea7d9,0x27ea1cb2270ea38b,0x238b270e2764221f,0xa62f25139e3e27d9,0xa7ea9cb2a6a72472,0x1648a7fea513a62f
.quad 0x25a8a5a88000a800,0x25a825a828008000,0x1cb227ea26a72472,0xa7fe1648a513262f,0xa70ea38ba764221f,0x2513a62f9e3ea7d9,0x273ba2d71e3ea7d9,0x1cb227ea270e238b,0x9e3e27d925a825a8,0xa6a7a472a764221f,0xa55fa5eda7d91e3e,0x27c39fc620a5a7a8,0x27f69a46221fa764,0xa38b270e247226a7,0xa41d26dd247226a7,0xa164a788a7f69a46
.quad 0xa21fa764a8000000,0x2764221f25a8a5a8,0x27c31fc62472a6a7,0xa73b22d71a4627f6,0xa62f2513221f2764,0x20a5a7a8a6a7a472,0x9648a7fea7d99e3e,0x241d26dd27a8a0a5,0x26a7247225a8a5a8,0xa7d99e3ea21f2764,0xa78821641e3e27d9,0x266da4c4a38ba70e,0x20a5a7a8a764a21f,0x9a4627f627d91e3e,0x24c4266d26a7a472,0xa55fa5eda62f2513
.quad 0x8000280080002800,0x8000280080002800,0xa55fa5eda5a8a5a8,0xa4c4a66da513a62f,0x27f61a4628008000,0x27a820a527d91e3e,0xa66d24c4a5a825a8,0xa7882164a70e238b,0x1e3ea7d98000a800,0x2472a6a7221fa764,0x241d26dd25a825a8,0x164827fe20a527a8,0xa7a8a0a5a8000000,0xa513a62fa6a7a472,0x273ba2d725a8a5a8,0x27c31fc627f69a46
.quad 0xa21f276400002800,0xa764221fa5a825a8,0xa164a788a5a8a5a8,0x241da6dd1a46a7f6,0x270e238b28008000,0x1a4627f6247226a7,0xa7c31fc6a5a825a8,0xa55fa5eda7a8a0a5,0x2472a6a78000a800,0x27d91e3e2764a21f,0x1cb227ea25a825a8,0xa73b22d7a38b270e,0xa62fa513a8008000,0x238ba70e9e3ea7d9,0x27fe964825a8a5a8,0x1cb227ea262f2513
.quad 0xa5a825a800002800,0xa5a8a5a8a8008000,0x1648a7fea5a8a5a8,0x27ea1cb2262fa513,0x2513262f28008000,0xa70e238b9e3e27d9,0xa7ea9cb2a5a825a8,0x22d7a73ba38ba70e,0x26a7a4728000a800,0x1e3e27d92764221f,0x9fc627c325a825a8,0xa5eda55fa7a820a5,0xa38ba70ea8000000,0x27f61a462472a6a7,0x2788216425a8a5a8,0xa6dd241d1a4627f6
.quad 0xa764221f00002800,0x221fa764a5a8a5a8,0x22d7a73ba5a8a5a8,0x1fc627c327f61a46,0x20a527a828000000,0xa62fa513a6a72472,0xa6dda41da5a825a8,0x27fe164820a5a7a8,0x27d99e3e0000a800,0xa6a72472221f2764,0xa4c4266d25a825a8,0x2164a788a70ea38b,0x9a46a7f6a8000000,0x20a527a827d99e3e,0x25ed255f25a8a5a8,0xa66da4c4a513262f
.quad 0x8000280080002800,0x8000280080002800,0xa41da6dda472a6a7,0xa2d7a73ba38ba70e,0x270e238b2764221f,0x262f251326a72472,0xa7fe1648a7d91e3e,0xa7c39fc6a7f69a46,0x26a7a47225a8a5a8,0x27d99e3e2764a21f,0xa2d7273b9e3e27d9,0xa66d24c4a513262f,0x9a46a7f6a21fa764,0x238ba70e1e3ea7d9,0x24c4266d26a72472,0x964827fe20a527a8
.quad 0xa764a21fa8008000,0xa21fa764a5a8a5a8,0x27ea9cb226a7a472,0x25ed255f27a820a5,0xa62f2513a21f2764,0xa7a8a0a5a7d91e3e,0x2164a7889e3ea7d9,0x27ea9cb2262fa513,0x1e3e27d925a825a8,0xa6a72472a21f2764,0xa55fa5eda7d99e3e,0x241da6dd9a46a7f6,0x27a820a52764a21f,0x9a4627f6247226a7,0xa7c31fc6a47226a7,0xa164a788a70ea38b
.quad 0x25a8a5a80000a800,0x25a825a828008000,0x9fc627c3247226a7,0xa788a164a70e238b,0xa0a5a7a8a764a21f,0x27f69a462472a6a7,0x25ed255f27d99e3e,0xa6dd241d9a4627f6,0xa7d99e3ea5a825a8,0x2472a6a7a21fa764,0x2788a1641e3ea7d9,0x9cb227ea262f2513,0xa513262f221f2764,0xa0a5a7a8a7d99e3e,0x1cb2a7eaa6a7a472,0x255f25ed27a8a0a5
.quad 0x221f276428008000,0xa764a21fa5a825a8,0xa66da4c4a6a72472,0x27fe964820a5a7a8,0x27f61a46221fa764,0xa70e238b1e3e27d9,0xa73b22d71e3e27d9,0x24c4a66da513a62f,0x2472a6a7a5a8a5a8,0x9e3e27d92764221f,0x964827fe27d91e3e,0x9fc6a7c3a7f61a46,0xa38ba70ea764221f,0x2513262f26a7a472,0x26dd241d2472a6a7,0xa73ba2d7a38b270e
.quad 0x8000280080002800,0x8000280080002800,0xa164a788a21fa764,0x9fc6a7c3a0a5a7a8,0x2513262f25a825a8,0x238b270e247226a7,0xa6dda41da764a21f,0xa55fa5eda62fa513,0x27d91e3e28008000,0x26a724722764221f,0xa7ea1cb2a764221f,0xa788a164a7f69a46,0x270ea38b25a8a5a8,0x27f61a4627d99e3e,0xa55f25eda21f2764,0xa7ea1cb2a70e238b
.quad 0x221fa7648000a800,0x2764a21f25a8a5a8,0x964827fe221f2764,0xa66d24c4a38b270e,0xa0a5a7a8a5a8a5a8,0x2513a62f1e3ea7d9,0x24c4266d2764221f,0xa2d7273b1a4627f6,0xa6a7a472a8008000,0x1e3ea7d9a21fa764,0x27c31fc62764a21f,0x164827fe2513262f,0xa7f61a46a5a825a8,0xa0a5a7a8a6a7a472,0x273ba2d7221fa764,0x241d26dd27a820a5
.quad 0xa5a825a800002800,0xa5a8a5a8a8008000,0x22d7a73ba21fa764,0x26dd241d27a8a0a5,0x9a4627f625a825a8,0xa7a8a0a5a6a72472,0x9fc6a7c3a764a21f,0x27fe16482513a62f,0x247226a728008000,0xa7d91e3ea21f2764,0xa66da4c4a764221f,0x273ba2d71a46a7f6,0x27a820a525a8a5a8,0xa62f25131e3e27d9,0xa7fe1648a21f2764,0x24c4a66da38ba70e
.quad 0x2764a21f0000a800,0xa21f276425a825a8,0xa5ed255f221f2764,0x1cb2a7eaa70ea38b,0x238ba70ea5a8a5a8,0x1a4627f627d91e3e,0x9cb227ea2764221f,0xa164a788a7f61a46,0x9e3ea7d9a8000000,0x247226a72764a21f,0x241d26dd2764a21f,0xa5eda55fa62f2513,0xa62fa513a5a825a8,0x270e238b2472a6a7,0x27882164221fa764,0xa7c39fc6a0a527a8
.quad 0x8000280080002800,0x8000280080002800,0x9cb2a7ea9e3ea7d9,0x9648a7fe9a46a7f6,0x20a527a8221f2764,0x1a4627f61e3e27d9,0xa2d7a73ba472a6a7,0x9cb2a7eaa0a5a7a8,0x247226a725a825a8,0x1e3e27d9221f2764,0xa55fa5eda6a7a472,0x9fc6a7c3a38ba70e,0x262f25132764221f,0x20a527a8247226a7,0xa6dda41da7d99e3e,0xa164a788a513a62f
.quad 0x2764221f28008000,0x221f276425a825a8,0xa7c39fc6a7d91e3e,0xa2d7a73ba62fa513,0x27f61a462764a21f,0x238b270e26a72472,0xa7fe1648a6a72472,0xa41da6dda70ea38b,0x27d99e3e25a8a5a8,0x247226a72764221f,0xa7882164a47226a7,0xa4c4a66da7a8a0a5,0x270ea38b221fa764,0x2513262f27d91e3e,0xa66d24c49e3e27d9,0xa55fa5eda7f69a46
.quad 0x25a8a5a88000a800,0x25a825a828008000,0xa4c4266d1e3e27d9,0xa5eda55fa7f61a46,0x238ba70ea21fa764,0x262f251327d99e3e,0xa1642788247226a7,0xa66da4c4a7a820a5,0x1e3ea7d9a5a8a5a8,0x26a724722764a21f,0x964827fe26a72472,0xa6dda41da70e238b,0x9a46a7f6a764a21f,0x270e238b26a7a472,0x1fc627c327d91e3e,0xa73ba2d7a62f2513
.quad 0xa21fa764a8000000,0x2764221f25a8a5a8,0x241d26dd27d99e3e,0xa788a164a513262f,0xa513a62fa764221f,0x27a820a52472a6a7,0x25ed255f26a7a472,0xa7c39fc6a38b270e,0xa6a7a472a5a825a8,0x27d91e3e221fa764,0x273b22d72472a6a7,0xa7ea9cb2a0a527a8,0xa7a8a0a5a21f2764,0x27f61a461e3ea7d9,0x27ea1cb21e3ea7d9,0xa7fe96489a4627f6
.quad 0xa800000028002800,0x280080008000a800,0xa7fe9648a8002800,0x27ea1cb21a46a7f6,0xa7f69a4628002800,0x27a820a51e3ea7d9,0xa7ea9cb2a8002800,0x273b22d720a5a7a8,0xa7d99e3e28002800,0x26a72472221fa764,0xa7c39fc6a8002800,0x25ed255f238ba70e,0xa7a8a0a528002800,0x2513262f2472a6a7,0xa788a164a8002800,0x241d26dd2513a62f
.quad 0xa764a21f28002800,0x221f276425a8a5a8,0xa73ba2d7a8002800,0x1fc627c3262fa513,0xa70ea38b28002800,0x1a4627f626a7a472,0xa6dda41da8002800,0x964827fe270ea38b,0xa6a7a47228002800,0x9e3e27d92764a21f,0xa66da4c4a8002800,0xa164278827a8a0a5,0xa62fa51328002800,0xa38b270e27d99e3e,0xa5eda55fa8002800,0xa4c4266d27f69a46
.quad 0xa5a8a5a828002800,0xa5a825a828008000,0xa55fa5eda8002800,0xa66d24c427f61a46,0xa513a62f28002800,0xa70e238b27d91e3e,0xa4c4a66da8002800,0xa788216427a820a5,0xa472a6a728002800,0xa7d91e3e2764221f,0xa41da6dda8002800,0xa7fe1648270e238b,0xa38ba70e28002800,0xa7f69a4626a72472,0xa2d7a73ba8002800,0xa7c39fc6262f2513
.quad 0xa21fa76428002800,0xa764a21f25a825a8,0xa164a788a8002800,0xa6dda41d2513262f,0xa0a5a7a828002800,0xa62fa513247226a7,0x9fc6a7c3a8002800,0xa55fa5ed238b270e,0x9e3ea7d928002800,0xa472a6a7221f2764,0x9cb2a7eaa8002800,0xa2d7a73b20a527a8,0x9a46a7f628002800,0xa0a5a7a81e3e27d9,0x9648a7fea8002800,0x9cb2a7ea1a4627f6
.quad 0xa800000000002800,0x280080008000a800,0xa7c39fc69e3e27d9,0x2788216420a5a7a8,0xa70ea38ba21f2764,0x262f25132472a6a7,0xa5eda55fa47226a7,0x241d26dd262fa513,0xa472a6a7a5a825a8,0x1e3e27d92764a21f,0xa164a788a6a72472,0x9cb227ea27f69a46,0x9a46a7f6a764221f,0xa38b270e27d91e3e,0x1cb2a7eaa7d91e3e,0xa5ed255f270e238b
.quad 0x221fa764a8000000,0xa764221f25a825a8,0x24c4a66da7d99e3e,0xa7fe1648238b270e,0x262fa513a764a21f,0xa7a8a0a51e3e27d9,0x273ba2d7a6a7a472,0xa66da4c49a4627f6,0x27d99e3ea5a8a5a8,0xa472a6a7a21f2764,0x27fe1648a472a6a7,0x9fc6a7c3a513262f,0x27a820a5a21fa764,0x1a46a7f6a6a72472,0x26dd241d9e3ea7d9,0x22d7a73ba7a820a5
.quad 0x25a825a88000a800,0x25a8a5a8a8000000,0x241d26dd1e3ea7d9,0x273ba2d7a7a8a0a5,0x20a527a8221fa764,0x27f69a46a6a7a472,0x164827fe2472a6a7,0x27c31fc6a513a62f,0x9e3e27d925a8a5a8,0x26a72472a21fa764,0xa2d7273b26a7a472,0x24c4266d9a46a7f6,0xa513262f2764a21f,0x20a527a81e3ea7d9,0xa66d24c427d99e3e,0x964827fe238ba70e
.quad 0xa764221f28008000,0xa21f276425a8a5a8,0xa7ea1cb227d91e3e,0xa55f25ed270ea38b,0xa7f69a462764221f,0xa70e238b27d99e3e,0xa788a16426a72472,0xa7ea1cb227f61a46,0xa6a7a47225a825a8,0xa7d99e3e2764221f,0xa55fa5ed247226a7,0xa6dda41d262f2513,0xa38ba70e221f2764,0xa513a62f247226a7,0x9fc6a7c31e3e27d9,0xa164a78820a527a8
.quad 0xa800000000002800,0x280080008000a800,0xa73ba2d7a21f2764,0x26dd241d238ba70e,0xa513a62fa5a825a8,0x238b270e26a7a472,0x9fc6a7c3a764221f,0x964827fe27f69a46,0x1e3ea7d9a8000000,0xa47226a72764221f,0x24c4a66da764a21f,0xa73b22d72513262f,0x270ea38ba5a8a5a8,0xa7f69a461e3e27d9,0x27fe9648a21fa764,0xa66da4c4a0a527a8
.quad 0x2764221f8000a800,0xa21fa764a5a825a8,0x255f25ed221fa764,0x1cb2a7eaa7a820a5,0x20a527a825a8a5a8,0x2513a62fa7d99e3e,0x9cb227ea2764a21f,0x2788a164a62fa513,0xa47226a728008000,0x27d91e3ea21fa764,0xa6dd241d2764221f,0x25ed255f1a46a7f6,0xa7f61a4625a825a8,0x20a527a82472a6a7,0xa788a164221f2764,0x9fc627c3270ea38b
.quad 0xa5a8a5a800002800,0xa5a825a828008000,0xa164a788a21f2764,0xa7c31fc6270e238b,0x1a46a7f6a5a825a8,0xa7a8a0a5247226a7,0x241da6dda764221f,0xa55fa5ed1a4627f6,0x26a7a472a8008000,0x9e3ea7d9a21f2764,0x27ea9cb2a764a21f,0x2164a788a62f2513,0x27a820a5a5a8a5a8,0x262fa513a7d91e3e,0x25ed255fa21fa764,0x27ea9cb2a7a8a0a5
.quad 0x221f27648000a800,0x2764221fa5a8a5a8,0x964827fe221fa764,0x24c4266da0a5a7a8,0xa38b270e25a8a5a8,0x1a4627f61e3ea7d9,0xa66d24c42764a21f,0xa2d7273b2513a62f,0xa7d91e3e28008000,0xa6a724722764a21f,0xa7c39fc62764221f,0xa7fe164827f61a46,0xa62fa51325a825a8,0xa70ea38b26a72472,0xa2d7a73b221f2764,0xa41da6dd238b270e
.quad 0xa800800000002800,0x280080008000a800,0xa66da4c4a47226a7,0x25ed255f2513a62f,0xa0a5a7a8a764221f,0x1a4627f627d99e3e,0x2164a788a7d99e3e,0xa4c4266d270e238b,0x26a7a472a5a8a5a8,0xa7d91e3e221f2764,0x27fe16489e3ea7d9,0xa6dda41da0a527a8,0x262f2513221fa764,0xa0a5a7a8a6a72472,0x1fc627c326a7a472,0x22d7a73ba7f69a46
.quad 0xa21f276428008000,0x2764a21fa5a8a5a8,0xa6dd241d26a72472,0x278821649a46a7f6,0xa7f69a46221f2764,0x238b270e2472a6a7,0xa5eda55f9e3e27d9,0x9fc627c327a8a0a5,0x9e3ea7d9a5a825a8,0xa6a724722764221f,0x22d7a73ba7d91e3e,0xa7ea9cb2238b270e,0x270ea38ba764a21f,0xa513a62f9e3e27d9,0x27ea1cb2a472a6a7,0x1648a7fea62f2513
.quad 0x25a825a88000a800,0x25a8a5a8a8008000,0x1cb227ea2472a6a7,0x27fe9648a62fa513,0xa38b270e2764a21f,0x262f25139e3ea7d9,0xa73b22d727d91e3e,0x1cb227ea238ba70e,0xa7d99e3e25a825a8,0xa47226a72764a21f,0xa55fa5ed1e3e27d9,0xa7c31fc627a820a5,0x9a46a7f6a21f2764,0xa70ea38b247226a7,0x241da6dda6a72472,0xa164a7889a4627f6
.quad 0x2764a21fa8008000,0x221fa764a5a825a8,0x27c31fc6a6a7a472,0x273ba2d7a7f61a46,0x2513262fa21fa764,0x27a820a5a6a7a472,0x164827fe1e3ea7d9,0x241d26dda0a5a7a8,0xa47226a725a8a5a8,0x9e3e27d9221fa764,0xa788216427d99e3e,0xa66d24c4270ea38b,0xa7a8a0a52764221f,0xa7f69a4627d91e3e,0xa4c4a66d247226a7,0xa55fa5ed2513262f
.quad 0xa800800000002800,0x280080008000a800,0xa55fa5eda5a825a8,0x24c4266d262fa513,0x1a46a7f6a8008000,0xa0a527a827d91e3e,0x266da4c4a5a8a5a8,0xa7882164238b270e,0x27d91e3e8000a800,0xa6a7a472a21f2764,0x241d26dd25a8a5a8,0x9648a7fea7a820a5,0xa0a527a828008000,0x262fa513a6a7a472,0xa73b22d725a825a8,0x27c31fc69a46a7f6
.quad 0xa764a21f00002800,0x221f276425a8a5a8,0xa164a788a5a825a8,0xa41d26dd27f61a46,0x238ba70ea8008000,0xa7f61a46247226a7,0x27c39fc6a5a8a5a8,0xa55fa5eda0a527a8,0x26a724728000a800,0x1e3ea7d9a764221f,0x1cb227ea25a8a5a8,0x273ba2d7a70ea38b,0xa513262f28008000,0x270e238b9e3ea7d9,0xa7fe164825a825a8,0x1cb227ea2513a62f
.quad 0xa5a8a5a800002800,0xa5a825a828008000,0x1648a7fea5a825a8,0xa7ea9cb22513262f,0x262fa513a8008000,0xa38ba70e9e3e27d9,0x27ea1cb2a5a8a5a8,0x22d7a73ba70e238b,0x247226a70000a800,0x27d99e3ea764a21f,0x9fc627c325a8a5a8,0x25ed255fa0a5a7a8,0xa70e238b28008000,0x9a4627f62472a6a7,0xa788a16425a825a8,0xa6dd241d27f69a46
.quad 0xa21fa76400002800,0xa764a21f25a825a8,0x22d7a73ba5a825a8,0x9fc6a7c39a4627f6,0x27a8a0a5a8008000,0x2513a62fa6a72472,0x26dd241da5a8a5a8,0x27fe1648a7a8a0a5,0x1e3e27d98000a800,0x247226a7a21fa764,0xa4c4266d25a8a5a8,0xa1642788238ba70e,0xa7f61a4628008000,0xa7a820a527d99e3e,0xa5eda55f25a825a8,0xa66da4c4262f2513
.quad 0xa800800000002800,0x280080008000a800,0xa41da6dda6a72472,0x22d7273b270ea38b,0x238ba70ea764a21f,0xa513262f26a72472,0x27fe96489e3ea7d9,0xa7c39fc69a4627f6,0x247226a725a8a5a8,0x9e3ea7d9a764221f,0xa2d7273b27d91e3e,0x266da4c4a62fa513,0xa7f61a46221f2764,0x270e238b1e3ea7d9,0xa4c4a66da47226a7,0x964827fe27a8a0a5
.quad 0x221fa764a8008000,0xa764221f25a825a8,0x27ea9cb2a472a6a7,0xa5eda55fa0a527a8,0x2513262f221fa764,0x20a5a7a8a7d91e3e,0xa164278827d99e3e,0x27ea9cb2a513a62f,0xa7d91e3e25a825a8,0x247226a7221fa764,0xa55fa5ed9e3e27d9,0xa41d26dd27f69a46,0x20a5a7a8a764221f,0xa7f69a46247226a7,0x27c39fc6a6a7a472,0xa164a788a38b270e
.quad 0x25a825a88000a800,0x25a8a5a8a8000000,0x9fc627c326a7a472,0x27882164a38ba70e,0xa7a820a52764221f,0x1a4627f62472a6a7,0xa5eda55f1e3e27d9,0xa6dd241d27f61a46,0x1e3ea7d9a5a825a8,0xa6a7a472221f2764,0x2788a164a7d99e3e,0x1cb2a7eaa513262f,0x262f2513a21fa764,0x27a8a0a5a7d99e3e,0x9cb227ea2472a6a7,0x255f25eda0a5a7a8
.quad 0xa764221f28008000,0xa21f276425a8a5a8,0xa66da4c4247226a7,0xa7fe164827a820a5,0x1a46a7f6a21f2764,0xa38ba70e1e3e27d9,0x273ba2d7a7d91e3e,0x24c4a66da62f2513,0x26a72472a5a8a5a8,0x27d91e3ea764a21f,0x964827fe1e3ea7d9,0x1fc627c39a46a7f6,0xa70e238b2764a21f,0xa62f251326a7a472,0xa6dda41d26a72472,0xa73ba2d7270e238b
.quad 0xa800800000002800,0x280080000000a800,0xa164a788a764221f,0x1fc627c327a8a0a5,0x262fa513a5a8a5a8,0xa70e238b247226a7,0x26dd241d221fa764,0xa55fa5eda513262f,0x9e3e27d928008000,0x2472a6a7a764a21f,0xa7ea1cb2221f2764,0x278821641a46a7f6,0xa38ba70ea5a825a8,0x9a4627f627d99e3e,0x255fa5eda764a21f,0xa7ea1cb2238b270e
.quad 0x2764221f8000a800,0xa21fa764a5a825a8,0x964827fe2764a21f,0x266da4c4a70ea38b,0xa7a820a525a825a8,0x262f25131e3ea7d9,0xa4c4a66da21f2764,0xa2d7273b27f69a46,0x2472a6a7a8000000,0xa7d99e3e221f2764,0x27c31fc6a21fa764,0x9648a7fea62f2513,0x1a4627f625a8a5a8,0x27a8a0a5a6a7a472,0xa73b22d72764221f,0x241d26dd20a5a7a8
.quad 0xa5a8a5a800002800,0xa5a825a828008000,0x22d7a73ba764221f,0xa6dda41d20a527a8,0x27f61a46a5a8a5a8,0x20a5a7a8a6a72472,0x1fc627c3221fa764,0x27fe1648a62fa513,0xa6a7247228000000,0x1e3e27d9221fa764,0xa66da4c4221f2764,0xa73b22d727f61a46,0x20a5a7a8a5a825a8,0xa513a62f1e3e27d9,0x27fe9648a764a21f,0x24c4a66da70e238b
.quad 0x221f27640000a800,0x2764221fa5a8a5a8,0xa5ed255f2764a21f,0x9cb227ea238ba70e,0xa70ea38b25a825a8,0xa7f61a4627d91e3e,0x1cb2a7eaa21f2764,0xa164a7881a4627f6,0x27d99e3ea8000000,0x26a7a472a764221f,0x241d26dda21fa764,0x25ed255fa513a62f,0xa513262f25a8a5a8,0xa38b270e2472a6a7,0xa788a1642764221f,0xa7c39fc627a820a5
.quad 0xa800800000002800,0x280080008000a800,0x9cb2a7eaa7d91e3e,0x164827fe27f69a46,0x27a8a0a5a21fa764,0xa7f61a461e3e27d9,0x22d7273b26a7a472,0x9cb2a7eaa7a820a5,0xa6a7247225a825a8,0x27d99e3ea21fa764,0xa55fa5eda47226a7,0x1fc627c3270ea38b,0x2513a62fa764a21f,0xa7a820a5247226a7,0x26dd241d1e3ea7d9,0xa164a788a62f2513
.quad 0xa21f276428008000,0x2764a21fa5a8a5a8,0xa7c39fc61e3e27d9,0x22d7273b2513a62f,0x1a46a7f6a764221f,0xa70e238b26a72472,0x27fe9648a472a6a7,0xa41da6dda38b270e,0x1e3e27d925a8a5a8,0x26a7a472a764a21f,0xa788216426a72472,0x24c4266d20a5a7a8,0xa38ba70ea21f2764,0xa62f251327d91e3e,0x266da4c4a7d99e3e,0xa55fa5ed9a4627f6
.quad 0x25a825a80000a800,0x25a8a5a8a8000000,0xa4c4266d27d99e3e,0x25ed255f9a46a7f6,0xa70ea38b221f2764,0xa513262f27d99e3e,0x2164a788a6a72472,0xa66da4c420a527a8,0x27d91e3ea5a8a5a8,0x2472a6a7a764221f,0x964827fe2472a6a7,0x26dd241da38ba70e,0xa7f61a462764221f,0xa38b270e26a7a472,0x9fc6a7c39e3e27d9,0xa73ba2d72513262f
.quad 0x2764a21fa8000000,0x221fa764a5a825a8,0x241d26dd9e3ea7d9,0x27882164a62fa513,0xa62f25132764a21f,0xa0a527a82472a6a7,0xa5eda55f247226a7,0xa7c39fc6270e238b,0x2472a6a7a5a825a8,0x1e3ea7d9a21f2764,0x273b22d7a6a7a472,0x27ea1cb2a7a8a0a5,0xa0a527a8221fa764,0x9a4627f61e3ea7d9,0xa7ea9cb227d91e3e,0xa7fe964827f61a46
.quad 0xa800000000002800,0x280080000000a800,0x1648a7fea8000000,0x9cb227ea27f61a46,0x27f61a460000a800,0xa7a8a0a59e3e27d9,0x9cb227ea28008000,0x22d7a73ba7a8a0a5,0xa7d99e3e00002800,0x26a72472221fa764,0x1fc6a7c3a8000000,0xa55f25ed270e238b,0x27a820a58000a800,0xa513a62fa47226a7,0xa164278828008000,0x26dda41da62fa513
.quad 0xa764a21f00002800,0x221f276425a8a5a8,0x22d7a73ba8000000,0xa7c31fc62513262f,0x270e238b0000a800,0x9a46a7f6a6a72472,0xa41d26dd28008000,0x27fe1648a38ba70e,0xa6a7a47200002800,0x9e3e27d92764a21f,0x24c4a66da8000000,0xa788a16420a527a8,0x262f25138000a800,0x238ba70ea7d91e3e,0xa55f25ed28000000,0x266d24c49a46a7f6
.quad 0xa5a8a5a800002800,0xa5a825a828008000,0x25eda55fa8000000,0xa4c4a66d9a4627f6,0x2513262f0000a800,0x270ea38ba7d99e3e,0xa66d24c428008000,0x2164278820a5a7a8,0xa472a6a780002800,0xa7d91e3e2764221f,0x26dda41da8000000,0x9648a7fea38b270e,0x238b270e8000a800,0x27f61a46a6a7a472,0xa73b22d728000000,0x9fc627c32513a62f
.quad 0xa21fa76400002800,0xa764a21f25a825a8,0x2788a164a8000000,0x241da6dda62f2513,0x20a527a80000a800,0x262f2513a472a6a7,0xa7c31fc628008000,0xa5ed255f270ea38b,0x9e3ea7d900002800,0xa472a6a7221f2764,0x27ea9cb2a8000000,0x273ba2d7a7a820a5,0x1a4627f68000a800,0x20a527a89e3ea7d9,0xa7fe164828000000,0xa7ea1cb227f69a46
.quad 0xa800000000002800,0x280080008000a800,0x1fc6a7c3a7d99e3e,0xa164278827a820a5,0x270e238b221fa764,0xa62fa513a47226a7,0xa55f25ed26a72472,0x26dda41da513a62f,0xa472a6a7a5a825a8,0x1e3e27d92764a21f,0x2788a164a472a6a7,0xa7ea9cb21a4627f6,0x1a4627f62764a21f,0x238ba70ea7d99e3e,0xa7ea9cb21e3e27d9,0x255f25ed238ba70e
.quad 0x221fa764a8000000,0xa764221f25a825a8,0x266d24c41e3ea7d9,0x9648a7fea70e238b,0xa62f25132764221f,0x27a820a59e3ea7d9,0xa2d7a73ba47226a7,0xa4c4266d27f61a46,0x27d99e3ea5a8a5a8,0xa472a6a7a21f2764,0x964827fe26a7a472,0x27c39fc6a62fa513,0xa7a8a0a5221f2764,0x9a4627f626a7a472,0x241da6dda7d91e3e,0xa73ba2d720a527a8
.quad 0x25a825a88000a800,0x25a8a5a8a8000000,0xa6dd241d27d91e3e,0x22d7273b20a5a7a8,0xa0a5a7a8a21f2764,0xa7f61a4626a72472,0x27fe9648a6a7a472,0x1fc6a7c3a62f2513,0x9e3e27d925a8a5a8,0x26a72472a21fa764,0xa73ba2d7247226a7,0xa66d24c427f69a46,0x2513a62fa764221f,0xa0a5a7a89e3e27d9,0x24c4266d9e3ea7d9,0x27fe1648a70ea38b
.quad 0xa764221f28000000,0xa21f276425a8a5a8,0x9cb2a7ea9e3e27d9,0xa5eda55f238b270e,0x27f61a46a764a21f,0x270ea38ba7d91e3e,0xa16427882472a6a7,0x1cb227ea1a46a7f6,0xa6a7a47225a825a8,0xa7d99e3e2764221f,0x25eda55fa6a72472,0x241da6dda513262f,0x238b270ea21fa764,0x2513262fa472a6a7,0xa7c31fc627d99e3e,0xa788216427a8a0a5
.quad 0xa800000000002800,0x280080000000a800,0x22d7a73ba764a21f,0xa41d26dd270e238b,0x2513262f25a8a5a8,0xa38ba70ea6a72472,0xa7c31fc6221f2764,0x27fe16489a46a7f6,0x1e3ea7d9a8000000,0xa47226a72764221f,0x266d24c4221fa764,0xa2d7a73ba62f2513,0xa70e238b25a825a8,0x27f61a469e3ea7d9,0x9648a7fea764221f,0xa4c4266d27a820a5
.quad 0x2764221f0000a800,0xa21fa764a5a825a8,0xa5ed255f2764221f,0x27ea1cb2a0a5a7a8,0xa0a5a7a8a5a825a8,0xa513262f27d91e3e,0x27ea1cb2a21fa764,0xa164a788a513262f,0xa47226a728008000,0x27d91e3ea21fa764,0xa41da6dda21f2764,0xa55f25ed27f61a46,0x27f69a46a5a8a5a8,0xa0a5a7a8a47226a7,0xa16427882764a21f,0x27c31fc6a38ba70e
.quad 0xa5a8a5a800002800,0xa5a825a828000000,0x2788a164a764a21f,0x9fc6a7c3a38b270e,0x9a4627f625a8a5a8,0x27a820a5a472a6a7,0xa6dda41d221f2764,0xa5ed255f27f69a46,0x26a7a472a8008000,0x9e3ea7d9a21f2764,0x1cb227ea221fa764,0x27882164a513a62f,0xa7a8a0a525a825a8,0xa62f251327d99e3e,0x255fa5eda764221f,0x9cb2a7eaa0a527a8
.quad 0x221f27648000a800,0x2764221fa5a8a5a8,0xa7fe96482764221f,0xa66d24c427a8a0a5,0x238ba70ea5a825a8,0x9a46a7f69e3e27d9,0x24c4266da21fa764,0x273b22d7a62fa513,0xa7d91e3e28008000,0xa6a724722764a21f,0x1fc6a7c3a21f2764,0x9648a7fe9a4627f6,0x262f2513a5a8a5a8,0x270e238ba6a7a472,0xa73b22d72764a21f,0xa6dd241d270ea38b
.quad 0xa800000000002800,0x280000008000a800,0x24c4a66da6a7a472,0xa55f25ed262f2513,0x20a527a82764a21f,0x9a46a7f6a7d91e3e,0xa788a1649e3e27d9,0x266d24c4238ba70e,0x26a7a472a5a8a5a8,0xa7d91e3e221f2764,0x964827fe27d99e3e,0x241da6dda7a8a0a5,0xa62fa513a21f2764,0x20a527a826a7a472,0x27c39fc6a472a6a7,0xa73ba2d79a4627f6
.quad 0xa21f276428000000,0x2764a21fa5a8a5a8,0xa41da6dda47226a7,0xa164278827f69a46,0x27f61a46a21fa764,0xa38ba70ea47226a7,0xa55f25ed27d91e3e,0x27c31fc6a0a5a7a8,0x9e3ea7d9a5a825a8,0xa6a724722764221f,0x273b22d79e3ea7d9,0x1cb2a7eaa70e238b,0xa70e238b2764221f,0x2513262f1e3ea7d9,0x1cb2a7eaa6a72472,0xa7fe96482513262f
.quad 0x25a825a88000a800,0x25a8a5a8a8000000,0xa7ea1cb226a72472,0x164827fe2513a62f,0x238ba70ea764221f,0xa62fa5131e3e27d9,0x22d7273b1e3ea7d9,0x27ea9cb2a70ea38b,0xa7d99e3e25a825a8,0xa47226a72764a21f,0x25eda55fa7d91e3e,0x9fc6a7c3a0a527a8,0x1a4627f6221fa764,0x270e238ba472a6a7,0xa6dda41d247226a7,0xa788216427f61a46
.quad 0x2764a21fa8000000,0x221fa764a5a825a8,0x9fc627c32472a6a7,0x22d7273b9a46a7f6,0xa513a62f221f2764,0xa7a8a0a526a72472,0x27fe9648a7d99e3e,0x26dda41da7a820a5,0xa47226a725a8a5a8,0x9e3e27d9221fa764,0xa164a7881e3e27d9,0xa4c4a66d238b270e,0x27a820a5a764a21f,0x27f61a46a7d99e3e,0xa66d24c426a7a472,0xa5ed255f262fa513
.quad 0xa800000000002800,0x280080000000a800,0x25eda55fa5a8a5a8,0xa66d24c42513262f,0x9a4627f628000000,0x20a5a7a8a7d99e3e,0xa4c4a66da5a825a8,0x21642788270ea38b,0x27d91e3e8000a800,0xa6a7a472a21f2764,0xa6dd241d25a825a8,0x27fe9648a0a5a7a8,0x20a5a7a8a8000000,0xa62f251326a72472,0x22d7273b25a8a5a8,0x1fc6a7c3a7f61a46
.quad 0xa764a21f00002800,0x221f276425a8a5a8,0x2788a164a5a8a5a8,0xa6dda41d9a4627f6,0xa38b270e28000000,0x27f69a46a472a6a7,0x9fc6a7c3a5a825a8,0xa5ed255f27a820a5,0x26a724728000a800,0x1e3ea7d9a764221f,0xa7ea1cb225a825a8,0x22d7273b238ba70e,0x2513a62fa8000000,0xa70ea38b1e3e27d9,0x164827fe25a8a5a8,0x27ea9cb2a62fa513
.quad 0xa5a8a5a800002800,0xa5a825a828008000,0x27fe1648a5a8a5a8,0x1cb2a7eaa62f2513,0xa62f251328008000,0x238b270e1e3ea7d9,0x1cb2a7eaa5a825a8,0xa73ba2d7238b270e,0x247226a70000a800,0x27d99e3ea764a21f,0xa7c39fc625a825a8,0xa55f25ed27a8a0a5,0x270ea38ba8000000,0x1a46a7f6a47226a7,0xa164278825a8a5a8,0x241d26dd9a46a7f6
.quad 0xa21fa76480002800,0xa764a21f25a825a8,0x273b22d7a5a8a5a8,0x27c39fc6a7f69a46,0xa7a820a528008000,0xa513262f26a7a472,0x241da6dda5a825a8,0x1648a7fea0a527a8,0x1e3e27d98000a800,0x247226a7a21fa764,0xa66da4c425a825a8,0xa788a164270e238b,0x27f69a46a8000000,0x27a8a0a5a7d91e3e,0xa55f25ed25a8a5a8,0xa4c4266d2513a62f
.quad 0xa800000080002800,0x280000008000a800,0x26dda41da472a6a7,0xa73b22d7238b270e,0xa38b270e2764221f,0x2513a62fa6a7a472,0x9648a7fea7d91e3e,0x9fc627c327f61a46,0x247226a725a8a5a8,0x9e3ea7d9a764221f,0xa73ba2d79e3e27d9,0x24c4266d2513a62f,0x27f69a46a21fa764,0xa70ea38b9e3e27d9,0xa66d24c426a72472,0x27fe1648a0a5a7a8
.quad 0x221fa764a8000000,0xa764221f25a825a8,0x1cb227ea26a7a472,0x255fa5eda7a8a0a5,0xa513a62fa21f2764,0xa0a527a827d99e3e,0x278821649e3ea7d9,0x9cb2a7eaa62f2513,0xa7d91e3e25a825a8,0x247226a7221fa764,0x25eda55fa7d99e3e,0xa6dda41d1a4627f6,0xa0a527a82764a21f,0x27f61a46a472a6a7,0x9fc6a7c3a47226a7,0xa7882164270e238b
.quad 0x25a825a88000a800,0x25a8a5a8a8000000,0xa7c39fc6247226a7,0xa1642788270ea38b,0x27a8a0a5a764a21f,0x9a46a7f6a47226a7,0xa55f25ed27d99e3e,0x241d26dd1a46a7f6,0x1e3ea7d9a5a825a8,0xa6a7a472221f2764,0x216427881e3ea7d9,0x27ea1cb2a62fa513,0xa62fa513221f2764,0xa7a820a527d91e3e,0x27ea1cb2a6a7a472,0x25eda55fa7a820a5
.quad 0xa764221f28008000,0xa21f276425a8a5a8,0x24c4a66da6a72472,0x9648a7fea0a527a8,0x9a4627f6221fa764,0x238b270e9e3ea7d9,0xa2d7a73b1e3e27d9,0xa66da4c42513262f,0x26a72472a5a8a5a8,0x27d91e3ea764a21f,0xa7fe964827d91e3e,0xa7c31fc627f69a46,0x270ea38ba764221f,0x262fa513a6a72472,0xa41d26dd2472a6a7,0xa2d7273b238ba70e
.quad 0xa800000000002800,0x280080000000a800,0x2788a164a21fa764,0xa7c31fc620a527a8,0xa62f251325a825a8,0x270ea38ba472a6a7,0x241da6dda764a21f,0xa5ed255f262f2513,0x9e3e27d928000000,0x2472a6a7a764a21f,0x9cb2a7eaa764221f,0xa164278827f61a46,0x238b270e25a8a5a8,0x1a46a7f6a7d91e3e,0xa5eda55fa21f2764,0x1cb227ea270ea38b
.quad 0x2764221f8000a800,0xa21fa764a5a825a8,0xa7fe9648221f2764,0x24c4266d238ba70e,0x27a8a0a5a5a8a5a8,0xa62fa5139e3e27d9,0xa66d24c42764221f,0x273b22d79a46a7f6,0x2472a6a7a8000000,0xa7d99e3e221f2764,0x9fc627c32764a21f,0x27fe9648a513a62f,0x9a46a7f6a5a825a8,0xa7a820a526a72472,0x22d7273b221fa764,0x26dda41da7a8a0a5
.quad 0xa5a8a5a880002800,0xa5a825a828008000,0x273b22d7a21fa764,0x241da6dda7a820a5,0xa7f69a4625a825a8,0xa0a527a826a7a472,0x27c39fc6a764a21f,0x1648a7fea513262f,0xa6a7247228000000,0x1e3e27d9221fa764,0x24c4a66da764221f,0xa2d7a73b9a4627f6,0xa0a527a825a8a5a8,0x2513262f9e3ea7d9,0x9648a7fea21f2764,0xa66da4c4238b270e
.quad 0x221f27648000a800,0x2764221fa5a8a5a8,0xa55fa5ed221f2764,0xa7ea9cb2270e238b,0x270e238ba5a8a5a8,0x27f69a46a7d99e3e,0xa7ea9cb22764221f,0xa788216427f69a46,0x27d99e3ea8000000,0x26a7a472a764221f,0xa6dd241d2764a21f,0xa55f25ed262fa513,0x2513a62fa5a825a8,0x238ba70ea47226a7,0xa1642788221fa764,0x9fc627c320a5a7a8
.quad 0xa800000000002800,0x280000008000a800,0x27ea9cb29e3ea7d9,0xa7fe16481a4627f6,0xa7a820a5221f2764,0x27f69a469e3ea7d9,0x273ba2d7a472a6a7,0xa7ea1cb220a527a8,0xa6a7247225a825a8,0x27d99e3ea21fa764,0x25eda55fa6a7a472,0xa7c31fc6238b270e,0xa513262f2764221f,0x27a8a0a5a472a6a7,0x241da6dda7d99e3e,0xa78821642513262f
.quad 0xa21f276428008000,0x2764a21fa5a8a5a8,0x1fc6a7c3a7d91e3e,0xa73b22d7262f2513,0x9a4627f62764a21f,0x270ea38ba6a7a472,0x9648a7fea6a72472,0xa6dd241d270e238b,0x1e3e27d925a8a5a8,0x26a7a472a764a21f,0xa164a788a47226a7,0xa66d24c427a820a5,0x238b270e221fa764,0x262fa513a7d99e3e,0xa4c4a66d9e3e27d9,0xa5ed255f27f61a46
.quad 0x25a825a88000a800,0x25a8a5a8a8000000,0xa66da4c41e3e27d9,0xa55f25ed27f69a46,0x270e238ba21fa764,0x2513a62fa7d91e3e,0xa788a164247226a7,0xa4c4266d27a8a0a5,0x27d91e3ea5a8a5a8,0x2472a6a7a764221f,0xa7fe964826a72472,0xa41d26dd270ea38b,0x27f69a46a764a21f,0x238ba70ea6a72472,0xa7c31fc627d91e3e,0xa2d7273b262fa513
.quad 0x2764a21fa8008000,0x221fa764a5a825a8,0xa6dd241d27d99e3e,0xa16427882513a62f,0x262fa513a764221f,0x20a5a7a8a47226a7,0xa55f25ed26a7a472,0x9fc627c3238ba70e,0x2472a6a7a5a825a8,0x1e3ea7d9a21f2764,0xa2d7273b2472a6a7,0x9cb227ea20a5a7a8,0x20a5a7a8a21f2764,0x1a46a7f69e3e27d9,0x9cb227ea1e3ea7d9,0x964827fe1a46a7f6
.quad 0x8000a80028002800,0x8000a80000002800,0x1648a7fea8002800,0x1cb2a7ea9a4627f6,0x1a46a7f628002800,0x20a5a7a89e3e27d9,0x1cb2a7eaa8002800,0x22d7a73ba0a527a8,0x1e3ea7d928002800,0x2472a6a7a21f2764,0x1fc6a7c3a8002800,0x255fa5eda38b270e,0x20a5a7a828002800,0x262fa513a47226a7,0x2164a788a8002800,0x26dda41da513262f
.quad 0x221fa76428002800,0x2764a21fa5a825a8,0x22d7a73ba8002800,0x27c39fc6a62f2513,0x238ba70e28002800,0x27f69a46a6a72472,0x241da6dda8002800,0x27fe1648a70e238b,0x2472a6a728002800,0x27d91e3ea764221f,0x24c4a66da8002800,0x27882164a7a820a5,0x2513a62f28002800,0x270e238ba7d91e3e,0x255fa5eda8002800,0x266d24c4a7f61a46
.quad 0x25a8a5a828002800,0x25a825a8a8000000,0x25eda55fa8002800,0x24c4266da7f69a46,0x262fa51328002800,0x238b270ea7d99e3e,0x266da4c4a8002800,0x21642788a7a8a0a5,0x26a7a47228002800,0x1e3e27d9a764a21f,0x26dda41da8002800,0x164827fea70ea38b,0x270ea38b28002800,0x9a4627f6a6a7a472,0x273ba2d7a8002800,0x9fc627c3a62fa513
.quad 0x2764a21f28002800,0xa21f2764a5a8a5a8,0x2788a164a8002800,0xa41d26dda513a62f,0x27a8a0a528002800,0xa513262fa472a6a7,0x27c39fc6a8002800,0xa5ed255fa38ba70e,0x27d99e3e28002800,0xa6a72472a21fa764,0x27ea9cb2a8002800,0xa73b22d7a0a5a7a8,0x27f69a4628002800,0xa7a820a59e3ea7d9,0x27fe9648a8002800,0xa7ea1cb29a46a7f6
.quad 0x8000a80000002800,0x8000a80000002800,0x1fc6a7c39e3e27d9,0x2164a788a0a527a8,0x238ba70ea21f2764,0x2513a62fa47226a7,0x255fa5eda47226a7,0x26dda41da62f2513,0x26a7a472a5a825a8,0x27d99e3ea764221f,0x2788a164a6a72472,0x27ea1cb2a7f61a46,0x27f69a46a764221f,0x270e238ba7d99e3e,0x27ea1cb2a7d91e3e,0x255f25eda70ea38b
.quad 0x2764221fa8000000,0x221f2764a5a8a5a8,0x266d24c4a7d99e3e,0x164827fea38ba70e,0x2513262fa764a21f,0xa0a527a89e3ea7d9,0x22d7273ba6a7a472,0xa4c4266d1a46a7f6,0x1e3e27d9a5a8a5a8,0xa6a72472221fa764,0x964827fea472a6a7,0xa7c31fc62513a62f,0xa0a527a8a21fa764,0xa7f69a4626a7a472,0xa41d26dd9e3ea7d9,0xa73ba2d727a8a0a5
.quad 0xa5a825a88000a800,0xa5a8a5a828008000,0xa6dd241d1e3ea7d9,0xa2d7a73b27a820a5,0xa7a820a5221fa764,0x9a46a7f626a72472,0xa7fe16482472a6a7,0x1fc6a7c32513262f,0xa7d99e3e25a8a5a8,0x2472a6a7221f2764,0xa73ba2d726a7a472,0x266da4c41a4627f6,0xa62fa5132764a21f,0x27a8a0a59e3e27d9,0xa4c4a66d27d99e3e,0x27fe1648a38b270e
.quad 0xa21fa76428008000,0x2764221fa5a825a8,0x9cb2a7ea27d91e3e,0x25ed255fa70e238b,0x1a46a7f62764221f,0x238b270ea7d91e3e,0x2164a78826a72472,0x1cb227eaa7f69a46,0x2472a6a725a825a8,0x9e3e27d9a764a21f,0x25eda55f247226a7,0xa41d26dda62fa513,0x270ea38b221f2764,0xa62f2513a472a6a7,0x27c39fc61e3e27d9,0xa7882164a0a5a7a8
.quad 0x8000a80000002800,0x8000a80000002800,0x22d7a73ba21f2764,0x241da6dda38b270e,0x262fa513a5a825a8,0x270ea38ba6a72472,0x27c39fc6a764221f,0x27fe1648a7f61a46,0x27d91e3ea8008000,0x26a72472a764a21f,0x266d24c4a764a21f,0x22d7273ba513a62f,0x238b270ea5a8a5a8,0x9a4627f69e3ea7d9,0x164827fea21fa764,0xa4c4266d20a5a7a8
.quad 0xa21f27648000a800,0xa764221f25a8a5a8,0xa5ed255f221fa764,0xa7ea9cb227a8a0a5,0xa7a820a525a8a5a8,0xa62fa51327d91e3e,0xa7ea9cb22764a21f,0xa164a788262f2513,0xa6a7a47228008000,0x1e3ea7d9221f2764,0xa41da6dd2764221f,0x255fa5ed9a4627f6,0x9a46a7f625a825a8,0x27a8a0a5a47226a7,0x2164a788221f2764,0x27c31fc6a70e238b
.quad 0x25a8a5a800002800,0x25a825a8a8008000,0x2788a164a21f2764,0x1fc627c3a70ea38b,0x27f61a46a5a825a8,0xa0a527a8a472a6a7,0x26dd241da764221f,0xa5ed255f9a46a7f6,0x247226a7a8008000,0xa7d91e3e221fa764,0x1cb227eaa764a21f,0xa788a164262fa513,0xa0a527a8a5a8a5a8,0xa513a62f27d99e3e,0xa55f25eda21fa764,0x9cb2a7ea27a820a5
.quad 0xa764221f8000a800,0x221fa76425a825a8,0xa7fe9648221fa764,0x266da4c420a527a8,0xa70ea38b25a8a5a8,0x27f69a469e3e27d9,0xa4c4a66d2764a21f,0x273b22d7a513262f,0x9e3ea7d928008000,0x247226a7a764221f,0x1fc6a7c32764221f,0x164827fea7f69a46,0x2513a62f25a825a8,0xa38b270ea6a7a472,0x273ba2d7221f2764,0xa6dd241da38ba70e
.quad 0xa80000002800,0x8000a80000002800,0x24c4a66da47226a7,0x255fa5eda513262f,0x27a8a0a5a764221f,0x27f69a46a7d91e3e,0x27882164a7d99e3e,0x266d24c4a70ea38b,0x247226a7a5a8a5a8,0x1e3e27d9a21fa764,0x964827fe9e3ea7d9,0xa41d26dd20a5a7a8,0xa513262f221fa764,0xa7a820a526a7a472,0xa7c31fc626a7a472,0xa73ba2d727f61a46
.quad 0xa764a21f28008000,0xa21fa76425a825a8,0xa41da6dd26a72472,0x2164a7881a4627f6,0x1a46a7f6221f2764,0x270ea38ba47226a7,0x255fa5ed9e3e27d9,0x27c31fc6a7a820a5,0x27d99e3ea5a825a8,0x247226a7a764a21f,0x273b22d7a7d91e3e,0x9cb227eaa38ba70e,0x238b270ea764a21f,0xa62f25131e3ea7d9,0x9cb227eaa472a6a7,0xa7fe9648262fa513
.quad 0xa5a825a88000a800,0xa5a8a5a828008000,0xa7ea1cb22472a6a7,0x9648a7fe262f2513,0xa70ea38b2764a21f,0x2513a62f1e3e27d9,0xa2d7a73b27d91e3e,0x27ea9cb2a38b270e,0x1e3ea7d925a825a8,0x26a72472a764221f,0x25eda55f1e3e27d9,0x1fc627c3a7a8a0a5,0x27f69a46a21f2764,0xa38b270ea472a6a7,0x26dd241da6a72472,0xa78821641a46a7f6
.quad 0x221f2764a8000000,0xa764a21f25a8a5a8,0x9fc627c3a6a7a472,0xa2d7a73b27f69a46,0xa62f2513a21fa764,0x20a5a7a826a72472,0xa7fe16481e3ea7d9,0x26dda41d20a527a8,0xa6a7a47225a8a5a8,0x27d91e3ea21f2764,0xa164a78827d99e3e,0x24c4266da70e238b,0x20a5a7a82764221f,0x9a4627f6a7d99e3e,0x266da4c4247226a7,0xa5ed255fa513a62f
.quad 0xa80000002800,0x8000a80000002800,0x25eda55fa5a825a8,0x266da4c4a62f2513,0x27f61a46a8000000,0x27a820a5a7d99e3e,0x24c4266da5a8a5a8,0x21642788a38ba70e,0x9e3e27d90000a800,0xa47226a7221fa764,0xa6dd241d25a8a5a8,0xa7fe164827a8a0a5,0xa7a8a0a528008000,0xa513a62f26a72472,0xa2d7a73b25a825a8,0x1fc6a7c31a4627f6
.quad 0x221fa76400002800,0x2764a21fa5a825a8,0x2788a164a5a825a8,0x26dd241da7f69a46,0x270e238ba8000000,0x1a4627f6a472a6a7,0x1fc627c3a5a8a5a8,0xa5ed255f20a5a7a8,0xa47226a78000a800,0xa7d99e3e2764a21f,0xa7ea1cb225a8a5a8,0xa2d7a73b270e238b,0xa62fa51328008000,0x238ba70e1e3e27d9,0x9648a7fe25a825a8,0x27ea9cb2a513262f
.quad 0x25a8a5a800002800,0x25a825a8a8000000,0x27fe1648a5a825a8,0x9cb227eaa513a62f,0x2513262fa8000000,0xa70e238b1e3ea7d9,0x9cb227eaa5a8a5a8,0xa73ba2d7270ea38b,0xa6a724720000a800,0x9e3ea7d92764221f,0xa7c39fc625a8a5a8,0x255fa5ed20a527a8,0xa38ba70e28008000,0x27f61a46a47226a7,0x2164a78825a825a8,0x241d26dda7f61a46
.quad 0x2764a21f00002800,0xa21f2764a5a8a5a8,0x273b22d7a5a825a8,0xa7c31fc61a46a7f6,0x20a527a8a8000000,0xa62fa51326a7a472,0xa41d26dda5a8a5a8,0x1648a7fe27a820a5,0xa7d91e3e8000a800,0x26a7a472221f2764,0xa66da4c425a8a5a8,0x27882164a38b270e,0x9a46a7f628000000,0x20a527a8a7d91e3e,0x255fa5ed25a825a8,0xa4c4266da62fa513
.quad 0xa80000002800,0x8000a80000002800,0x26dda41da6a72472,0x273ba2d7a70e238b,0x270e238ba764a21f,0x262f2513a6a7a472,0x164827fe9e3ea7d9,0x9fc627c31a46a7f6,0xa6a7247225a8a5a8,0xa7d91e3e2764a21f,0xa73ba2d727d91e3e,0xa4c4a66d262f2513,0x9a46a7f6221f2764,0x238ba70e9e3e27d9,0x266da4c4a47226a7,0x27fe1648a7a820a5
.quad 0x2764221fa8000000,0x221f2764a5a8a5a8,0x1cb227eaa472a6a7,0xa55f25ed20a5a7a8,0xa62f2513221fa764,0xa7a8a0a527d99e3e,0xa788a16427d99e3e,0x9cb2a7ea2513262f,0x9e3ea7d925a825a8,0x26a7a472a21f2764,0x25eda55f9e3e27d9,0x26dd241da7f61a46,0x27a820a5a764221f,0x9a4627f6a472a6a7,0x1fc627c3a6a7a472,0xa7882164238ba70e
.quad 0xa5a825a80000a800,0xa5a8a5a828000000,0xa7c39fc626a7a472,0x2164a788238b270e,0xa0a5a7a82764221f,0x27f69a46a47226a7,0x255fa5ed1e3e27d9,0x241d26dda7f69a46,0x27d91e3ea5a825a8,0xa47226a7a21fa764,0x21642788a7d99e3e,0xa7ea9cb22513a62f,0xa513262fa21fa764,0xa0a5a7a827d91e3e,0xa7ea9cb22472a6a7,0x25eda55f20a527a8
.quad 0xa21fa76428008000,0x2764221fa5a825a8,0x24c4a66d247226a7,0x164827fea7a8a0a5,0x27f61a46a21f2764,0xa70e238b9e3ea7d9,0x22d7273ba7d91e3e,0xa66da4c4262fa513,0xa47226a7a5a8a5a8,0x1e3ea7d92764221f,0xa7fe96481e3ea7d9,0x27c39fc61a4627f6,0xa38ba70e2764a21f,0x2513262fa6a72472,0x241da6dd26a72472,0xa2d7273ba70ea38b
.quad 0xa80000002800,0x8000a80080002800,0x2788a164a764221f,0x27c39fc6a7a820a5,0x2513262fa5a8a5a8,0x238b270ea472a6a7,0xa41d26dd221fa764,0xa5ed255f2513a62f,0xa7d99e3e28000000,0xa6a7a4722764221f,0x9cb2a7ea221f2764,0x2164a7889a4627f6,0x270ea38ba5a825a8,0x27f61a46a7d91e3e,0x25ed255fa764a21f,0x1cb227eaa38ba70e
.quad 0xa21f27648000a800,0xa764221f25a8a5a8,0xa7fe96482764a21f,0xa4c4a66d270e238b,0xa0a5a7a825a825a8,0x2513a62f9e3e27d9,0x266da4c4a21f2764,0x273b22d7a7f61a46,0x26a72472a8000000,0x9e3e27d9a21fa764,0x9fc627c3a21fa764,0xa7fe1648262fa513,0xa7f61a4625a8a5a8,0xa0a5a7a826a72472,0xa2d7a73b2764221f,0x26dda41da0a527a8
.quad 0x25a8a5a800002800,0x25a825a8a8000000,0x273b22d7a764221f,0xa41d26dda0a5a7a8,0x9a4627f6a5a8a5a8,0xa7a8a0a526a7a472,0xa7c31fc6221fa764,0x1648a7fe262f2513,0xa472a6a728000000,0x27d99e3ea21f2764,0x24c4a66d221f2764,0x22d7273ba7f69a46,0x27a820a5a5a825a8,0xa62f25139e3ea7d9,0x164827fea764a21f,0xa66da4c4270ea38b
.quad 0xa764221f8000a800,0x221fa76425a825a8,0xa55fa5ed2764a21f,0x27ea1cb2a38b270e,0x238ba70e25a825a8,0x1a4627f6a7d99e3e,0x27ea1cb2a21f2764,0xa78821649a46a7f6,0x1e3e27d9a8000000,0xa472a6a72764a21f,0xa6dd241da21fa764,0x255fa5ed2513262f,0xa62fa51325a8a5a8,0x270e238ba47226a7,0x2164a7882764221f,0x9fc627c3a7a8a0a5
.quad 0xa80000002800,0x8000a80000002800,0x27ea9cb2a7d91e3e,0x27fe9648a7f61a46,0x20a527a8a21fa764,0x1a4627f69e3ea7d9,0xa73b22d726a7a472,0xa7ea1cb227a8a0a5,0xa472a6a725a825a8,0x9e3ea7d9221f2764,0x25eda55fa47226a7,0x27c39fc6a70e238b,0x262f2513a764a21f,0x20a527a8a472a6a7,0xa41d26dd1e3ea7d9,0xa7882164262fa513
.quad 0xa764a21f28000000,0xa21fa76425a825a8,0x1fc6a7c31e3e27d9,0x273ba2d7a513262f,0x27f61a46a764221f,0x238b270ea6a7a472,0x164827fea472a6a7,0xa6dd241d238ba70e,0xa7d91e3e25a8a5a8,0xa472a6a72764221f,0xa164a78826a72472,0x266da4c4a0a527a8,0x270ea38ba21f2764,0x2513262fa7d99e3e,0x24c4266da7d99e3e,0xa5ed255f1a46a7f6
.quad 0xa5a825a88000a800,0xa5a8a5a828008000,0xa66da4c427d99e3e,0x255fa5ed1a4627f6,0x238ba70e221f2764,0x262f2513a7d91e3e,0x27882164a6a72472,0xa4c4266da0a5a7a8,0x9e3e27d9a5a8a5a8,0xa6a7a4722764a21f,0xa7fe96482472a6a7,0x241da6dd238b270e,0x9a46a7f62764221f,0x270e238ba6a72472,0x27c39fc69e3e27d9,0xa2d7273ba513a62f
.quad 0x221f2764a8000000,0xa764a21f25a8a5a8,0xa6dd241d9e3ea7d9,0x2164a788262f2513,0xa513a62f2764a21f,0x27a820a5a47226a7,0x255fa5ed247226a7,0x9fc627c3a70ea38b,0x26a72472a5a825a8,0xa7d99e3e221fa764,0xa2d7273ba6a7a472,0x1cb2a7ea27a820a5,0xa7a8a0a5221fa764,0x27f61a469e3e27d9,0x1cb2a7ea27d91e3e,0x964827fea7f69a46
.quad 0x8000a80000002800,0x8000a80080002800,0x27fe1648a8000000,0x27ea1cb2a7f69a46,0x9a4627f68000a800,0xa0a527a81e3ea7d9,0xa7ea9cb228008000,0xa73ba2d727a820a5,0x1e3ea7d980002800,0x2472a6a7a21f2764,0x27c31fc6a8000000,0x25ed255fa70ea38b,0xa0a527a88000a800,0xa62f25132472a6a7,0xa788a16428000000,0xa41da6dd262f2513
.quad 0x221fa76400002800,0x2764a21fa5a825a8,0x273b22d7a8000000,0x1fc627c3a513a62f,0xa38b270e8000a800,0xa7f61a4626a7a472,0xa6dda41d28008000,0x1648a7fe238b270e,0x2472a6a700002800,0x27d91e3ea764221f,0x266d24c4a8000000,0xa1642788a0a5a7a8,0xa513262f8000a800,0xa70ea38b27d99e3e,0xa5eda55f28000000,0x24c4a66d1a4627f6
.quad 0x25a8a5a800002800,0x25a825a8a8000000,0x255f25eda8000000,0xa66d24c41a46a7f6,0xa62f25138000a800,0xa38ba70e27d91e3e,0xa4c4a66d28000000,0x2788a164a0a527a8,0x26a7a47280002800,0x1e3e27d9a764a21f,0x241d26dda8000000,0xa7fe1648238ba70e,0xa70e238b8000a800,0x1a46a7f626a72472,0xa2d7a73b28008000,0x27c31fc6a513262f
.quad 0x2764a21f00002800,0xa21f2764a5a8a5a8,0x21642788a8008000,0xa6dda41d262fa513,0xa7a820a58000a800,0x2513a62f247226a7,0x9fc6a7c328008000,0x255f25eda70e238b,0x27d99e3e00002800,0xa6a72472a21fa764,0x1cb227eaa8000000,0xa2d7a73b27a8a0a5,0xa7f61a460000a800,0x27a8a0a51e3e27d9,0x9648a7fe28008000,0x1cb227eaa7f61a46
.quad 0x8000a80000002800,0x8000a80000002800,0x27c31fc6a7d99e3e,0x27882164a7a8a0a5,0xa38b270e221fa764,0xa513262f2472a6a7,0xa5eda55f26a72472,0xa41da6dd2513262f,0x26a7a472a5a825a8,0x27d99e3ea764221f,0x21642788a472a6a7,0x9cb227ea9a46a7f6,0xa7f61a462764a21f,0xa70ea38b27d91e3e,0x1cb2a7ea1e3e27d9,0x25eda55fa38b270e
.quad 0x2764221fa8000000,0x221f2764a5a8a5a8,0xa4c4266d1e3ea7d9,0xa7fe1648270ea38b,0xa513a62f2764221f,0x20a5a7a81e3e27d9,0x273ba2d7a47226a7,0x266d24c4a7f69a46,0x1e3e27d9a5a8a5a8,0xa6a72472221fa764,0xa7fe964826a7a472,0x9fc6a7c3262f2513,0x20a5a7a8221f2764,0x27f61a46a6a72472,0x26dd241da7d91e3e,0xa2d7273ba0a5a7a8
.quad 0xa5a825a88000a800,0xa5a8a5a828008000,0xa41da6dd27d91e3e,0x273ba2d7a0a527a8,0x27a8a0a5a21f2764,0x1a4627f6a6a7a472,0x164827fea6a7a472,0xa7c39fc6262fa513,0xa7d99e3e25a8a5a8,0x2472a6a7221f2764,0x22d7a73b247226a7,0x24c4266da7f61a46,0x262f2513a764221f,0xa7a820a51e3ea7d9,0xa66d24c49e3ea7d9,0x1648a7fe270e238b
.quad 0xa21fa76428008000,0x2764221fa5a825a8,0x27ea9cb29e3e27d9,0xa55f25eda38ba70e,0x9a4627f6a764a21f,0xa38ba70e27d99e3e,0xa788a1642472a6a7,0x27ea9cb29a4627f6,0x2472a6a725a825a8,0x9e3e27d9a764a21f,0x255f25eda6a72472,0xa6dda41d2513a62f,0xa70e238ba21fa764,0x262fa513247226a7,0x9fc6a7c327d99e3e,0x21642788a7a820a5
.quad 0x8000a80000002800,0x8000a80080002800,0x273b22d7a764a21f,0x26dd241da70ea38b,0xa62f251325a8a5a8,0xa70e238b26a7a472,0x9fc6a7c3221f2764,0x1648a7fe1a4627f6,0x27d91e3ea8000000,0x26a72472a764a21f,0xa4c4266d221fa764,0xa73b22d7262fa513,0xa38ba70e25a825a8,0x1a46a7f61e3e27d9,0x27fe9648a764221f,0x266d24c4a7a8a0a5
.quad 0xa21f27648000a800,0xa764221f25a8a5a8,0xa55fa5ed2764221f,0x1cb2a7ea20a527a8,0x27a8a0a5a5a825a8,0x262f2513a7d99e3e,0x9cb227eaa21fa764,0xa78821642513a62f,0xa6a7a47228008000,0x1e3ea7d9221f2764,0x26dda41da21f2764,0x25ed255fa7f69a46,0x1a4627f6a5a8a5a8,0xa7a820a52472a6a7,0xa788a1642764a21f,0x1fc6a7c3238b270e
.quad 0x25a8a5a880002800,0x25a825a8a8008000,0x21642788a764a21f,0xa7c31fc6238ba70e,0xa7f69a4625a8a5a8,0x20a5a7a8247226a7,0x241da6dd221f2764,0x255f25eda7f61a46,0x247226a7a8008000,0xa7d91e3e221fa764,0xa7ea1cb2221fa764,0x2164a7882513262f,0x20a5a7a825a825a8,0x2513262fa7d91e3e,0x25ed255fa764221f,0xa7ea1cb220a5a7a8
.quad 0xa764221f8000a800,0x221fa76425a825a8,0x1648a7fe2764221f,0x24c4266da7a820a5,0x270e238ba5a825a8,0xa7f61a461e3ea7d9,0xa66d24c4a21fa764,0x22d7a73b262f2513,0x9e3ea7d928008000,0x247226a7a764221f,0x27c31fc6a21f2764,0xa7fe16481a46a7f6,0xa513262fa5a8a5a8,0x238ba70e26a72472,0xa2d7a73b2764a21f,0x241d26dda70e238b
.quad 0x8000a80000002800,0xa80000002800,0x266d24c4a6a7a472,0x25ed255fa62fa513,0xa7a820a52764a21f,0xa7f61a4627d99e3e,0x2164a7889e3e27d9,0x24c4a66da38b270e,0x247226a7a5a8a5a8,0x1e3e27d9a21fa764,0xa7fe964827d99e3e,0xa6dda41d27a820a5,0x2513a62fa21f2764,0x27a8a0a5a6a72472,0x1fc627c3a472a6a7,0xa2d7273b1a46a7f6
.quad 0xa764a21f28000000,0xa21fa76425a825a8,0x26dda41da47226a7,0x27882164a7f61a46,0x9a4627f6a21fa764,0xa70e238b2472a6a7,0xa5eda55f27d91e3e,0x1fc6a7c320a527a8,0x27d99e3ea5a825a8,0x247226a7a764a21f,0xa2d7273b9e3ea7d9,0xa7ea9cb2270ea38b,0xa38ba70e2764221f,0x262fa5139e3e27d9,0x27ea1cb2a6a72472,0x964827fea513a62f
.quad 0xa5a825a80000a800,0xa5a8a5a828000000,0x9cb2a7ea26a72472,0x27fe9648a513262f,0x270e238ba764221f,0xa513262f9e3ea7d9,0xa73b22d71e3ea7d9,0x9cb2a7ea270e238b,0x1e3ea7d925a825a8,0x26a72472a764221f,0x255f25eda7d91e3e,0xa7c31fc620a5a7a8,0xa7f61a46221fa764,0x238ba70e247226a7,0x241da6dd247226a7,0x21642788a7f69a46
.quad 0x221f2764a8000000,0xa764a21f25a8a5a8,0xa7c39fc62472a6a7,0x273ba2d71a4627f6,0x262fa513221f2764,0xa0a527a8a6a7a472,0x164827fea7d99e3e,0xa41da6dd27a8a0a5,0xa6a7a47225a8a5a8,0x27d91e3ea21f2764,0x2788a1641e3e27d9,0xa66d24c4a38ba70e,0xa0a527a8a764a21f,0x1a46a7f627d91e3e,0xa4c4a66d26a7a472,0x255f25eda62f2513
.quad 0x8000a80000002800,0x8000a80080002800,0x255f25eda5a8a5a8,0x24c4266da513a62f,0xa7f69a4628000000,0xa7a8a0a527d91e3e,0x266da4c4a5a825a8,0x2788a164a70e238b,0x9e3e27d90000a800,0xa47226a7221fa764,0xa41da6dd25a825a8,0x9648a7fe20a527a8,0x27a820a5a8008000,0x2513262fa6a7a472,0xa73b22d725a8a5a8,0xa7c39fc627f69a46
.quad 0x221fa76400002800,0x2764a21fa5a825a8,0x21642788a5a8a5a8,0xa41d26dd1a46a7f6,0xa70ea38b28008000,0x9a46a7f6247226a7,0x27c39fc6a5a825a8,0x255f25eda7a8a0a5,0xa47226a78000a800,0xa7d99e3e2764a21f,0x9cb2a7ea25a825a8,0x273ba2d7a38b270e,0x262f2513a8000000,0xa38b270e9e3ea7d9,0xa7fe164825a8a5a8,0x9cb2a7ea262f2513
.quad 0x25a8a5a800002800,0x25a825a8a8000000,0x964827fea5a8a5a8,0xa7ea9cb2262fa513,0xa513a62f28008000,0x270ea38b9e3e27d9,0x27ea1cb2a5a825a8,0xa2d7273ba38ba70e,0xa6a724720000a800,0x9e3ea7d92764221f,0x1fc6a7c325a825a8,0x25ed255fa7a820a5,0x238b270ea8000000,0xa7f69a462472a6a7,0xa788a16425a8a5a8,0x26dda41d1a4627f6
.quad 0x2764a21f00002800,0xa21f2764a5a8a5a8,0xa2d7273ba5a8a5a8,0x9fc6a7c327f61a46,0xa0a5a7a828000000,0x262f2513a6a72472,0x26dd241da5a825a8,0xa7fe964820a5a7a8,0xa7d91e3e8000a800,0x26a7a472221f2764,0x24c4a66d25a825a8,0xa1642788a70ea38b,0x1a4627f6a8008000,0xa0a5a7a827d99e3e,0xa5eda55f25a8a5a8,0x266d24c4a513262f
.quad 0x8000a80080002800,0xa80000002800,0x241d26dda472a6a7,0x22d7273ba38ba70e,0xa70ea38b2764221f,0xa62fa51326a72472,0x27fe9648a7d91e3e,0x27c31fc6a7f69a46,0xa6a7247225a8a5a8,0xa7d91e3e2764a21f,0x22d7a73b9e3e27d9,0x266da4c4a513262f,0x1a4627f6a21fa764,0xa38b270e1e3ea7d9,0xa4c4a66d26a72472,0x1648a7fe20a527a8
.quad 0x2764221fa8000000,0x221f2764a5a8a5a8,0xa7ea1cb226a7a472,0xa5eda55f27a820a5,0x262fa513a21f2764,0x27a820a5a7d91e3e,0xa16427889e3ea7d9,0xa7ea1cb2262fa513,0x9e3ea7d925a825a8,0x26a7a472a21f2764,0x255f25eda7d99e3e,0xa41d26dd9a46a7f6,0xa7a8a0a52764a21f,0x1a46a7f6247226a7,0x27c39fc6a47226a7,0x21642788a70ea38b
.quad 0xa5a825a88000a800,0xa5a8a5a828008000,0x1fc6a7c3247226a7,0x27882164a70e238b,0x20a527a8a764a21f,0xa7f61a462472a6a7,0xa5eda55f27d99e3e,0x26dda41d9a4627f6,0x27d91e3ea5a825a8,0xa47226a7a21fa764,0xa78821641e3ea7d9,0x1cb2a7ea262f2513,0x2513a62f221f2764,0x20a527a8a7d99e3e,0x9cb227eaa6a7a472,0xa55fa5ed27a8a0a5
.quad 0xa21fa76428008000,0x2764221fa5a825a8,0x266d24c4a6a72472,0xa7fe164820a5a7a8,0xa7f69a46221fa764,0x270ea38b1e3e27d9,0x273ba2d71e3e27d9,0xa4c4266da513a62f,0xa47226a7a5a8a5a8,0x1e3ea7d92764221f,0x1648a7fe27d91e3e,0x1fc627c3a7f61a46,0x238b270ea764221f,0xa513a62f26a7a472,0xa6dda41d2472a6a7,0x273b22d7a38b270e
.quad 0x8000a80000002800,0x8000a80080002800,0x21642788a21fa764,0x1fc627c3a0a5a7a8,0xa513a62f25a825a8,0xa38ba70e247226a7,0x26dd241da764a21f,0x255f25eda62fa513,0xa7d99e3e28000000,0xa6a7a4722764221f,0x27ea9cb2a764221f,0x27882164a7f69a46,0xa70e238b25a8a5a8,0xa7f69a4627d99e3e,0x255fa5eda21f2764,0x27ea9cb2a70e238b
.quad 0xa21f27640000a800,0xa764221f25a8a5a8,0x1648a7fe221f2764,0x266da4c4a38b270e,0x20a527a8a5a8a5a8,0xa513262f1e3ea7d9,0xa4c4a66d2764221f,0x22d7a73b1a4627f6,0x26a72472a8000000,0x9e3e27d9a21fa764,0xa7c39fc62764a21f,0x9648a7fe2513262f,0x27f69a46a5a825a8,0x20a527a8a6a7a472,0xa73b22d7221fa764,0xa41da6dd27a820a5
.quad 0x25a8a5a800002800,0x25a825a8a8000000,0xa2d7273ba21fa764,0xa6dda41d27a8a0a5,0x1a46a7f625a825a8,0x27a820a5a6a72472,0x1fc627c3a764a21f,0xa7fe96482513a62f,0xa472a6a728000000,0x27d99e3ea21f2764,0x266d24c4a764221f,0xa73b22d71a46a7f6,0xa7a8a0a525a8a5a8,0x262fa5131e3e27d9,0x27fe9648a21f2764,0xa4c4266da38ba70e
.quad 0xa764221f8000a800,0x221fa76425a825a8,0x25eda55f221f2764,0x9cb227eaa70ea38b,0xa38b270ea5a8a5a8,0x9a46a7f627d91e3e,0x1cb2a7ea2764221f,0x21642788a7f61a46,0x1e3e27d9a8000000,0xa472a6a72764a21f,0xa41da6dd2764a21f,0x25ed255fa62f2513,0x262f2513a5a825a8,0xa70ea38b2472a6a7,0xa788a164221fa764,0x27c31fc6a0a527a8
.quad 0x8000a80000002800,0xa80000002800,0x1cb227ea9e3ea7d9,0x164827fe9a46a7f6,0xa0a5a7a8221f2764,0x9a46a7f61e3e27d9,0x22d7273ba472a6a7,0x1cb227eaa0a5a7a8,0xa472a6a725a825a8,0x9e3ea7d9221f2764,0x255f25eda6a7a472,0x1fc627c3a38ba70e,0xa62fa5132764221f,0xa0a5a7a8247226a7,0x26dd241da7d99e3e,0x21642788a513a62f
.quad 0xa764a21f28008000,0xa21fa76425a825a8,0x27c31fc6a7d91e3e,0x22d7273ba62fa513,0xa7f69a462764a21f,0xa38ba70e26a72472,0x27fe9648a6a72472,0x241d26dda70ea38b,0xa7d91e3e25a8a5a8,0xa472a6a72764221f,0x2788a164a47226a7,0x24c4266da7a8a0a5,0xa70e238b221fa764,0xa513a62f27d91e3e,0x266da4c49e3e27d9,0x255f25eda7f69a46
.quad 0xa5a825a88000a800,0xa5a8a5a828008000,0x24c4a66d1e3e27d9,0x25ed255fa7f61a46,0xa38b270ea21fa764,0xa62fa51327d99e3e,0x2164a788247226a7,0x266d24c4a7a820a5,0x9e3e27d9a5a8a5a8,0xa6a7a4722764a21f,0x1648a7fe26a72472,0x26dd241da70e238b,0x1a4627f6a764a21f,0xa70ea38b26a7a472,0x9fc6a7c327d91e3e,0x273b22d7a62f2513
.quad 0x221f2764a8000000,0xa764a21f25a8a5a8,0xa41da6dd27d99e3e,0x27882164a513262f,0x2513262fa764221f,0xa7a8a0a52472a6a7,0xa5eda55f26a7a472,0x27c31fc6a38b270e,0x26a72472a5a825a8,0xa7d99e3e221fa764,0xa73ba2d72472a6a7,0x27ea1cb2a0a527a8,0x27a820a5a21f2764,0xa7f69a461e3ea7d9,0xa7ea9cb21e3ea7d9,0x27fe16489a4627f6
.quad 0x2800800028002800,0xa80000008000a800,0x27fe1648a8002800,0xa7ea9cb21a46a7f6,0x27f61a4628002800,0xa7a8a0a51e3ea7d9,0x27ea1cb2a8002800,0xa73ba2d720a5a7a8,0x27d91e3e28002800,0xa6a7a472221fa764,0x27c31fc6a8002800,0xa5eda55f238ba70e,0x27a820a528002800,0xa513a62f2472a6a7,0x27882164a8002800,0xa41da6dd2513a62f
.quad 0x2764221f28002800,0xa21fa76425a8a5a8,0x273b22d7a8002800,0x9fc6a7c3262fa513,0x270e238b28002800,0x9a46a7f626a7a472,0x26dd241da8002800,0x1648a7fe270ea38b,0x26a7247228002800,0x1e3ea7d92764a21f,0x266d24c4a8002800,0x2164a78827a8a0a5,0x262f251328002800,0x238ba70e27d99e3e,0x25ed255fa8002800,0x24c4a66d27f69a46
.quad 0x25a825a828002800,0x25a8a5a828008000,0x255f25eda8002800,0x266da4c427f61a46,0x2513262f28002800,0x270ea38b27d91e3e,0x24c4266da8002800,0x2788a16427a820a5,0x247226a728002800,0x27d99e3e2764221f,0x241d26dda8002800,0x27fe9648270e238b,0x238b270e28002800,0x27f61a4626a72472,0x22d7273ba8002800,0x27c31fc6262f2513
.quad 0x221f276428002800,0x2764221f25a825a8,0x21642788a8002800,0x26dd241d2513262f,0x20a527a828002800,0x262f2513247226a7,0x1fc627c3a8002800,0x255f25ed238b270e,0x1e3e27d928002800,0x247226a7221f2764,0x1cb227eaa8002800,0x22d7273b20a527a8,0x1a4627f628002800,0x20a527a81e3e27d9,0x164827fea8002800,0x1cb227ea1a4627f6
.quad 0x2800800000002800,0xa80080008000a800,0x27c31fc69e3e27d9,0xa788a16420a5a7a8,0x270e238ba21f2764,0xa62fa5132472a6a7,0x25ed255fa47226a7,0xa41da6dd262fa513,0x247226a7a5a825a8,0x9e3ea7d92764a21f,0x21642788a6a72472,0x1cb2a7ea27f69a46,0x1a4627f6a764221f,0x238ba70e27d91e3e,0x9cb227eaa7d91e3e,0x25eda55f270e238b
.quad 0xa21f2764a8008000,0x2764a21f25a825a8,0xa4c4266da7d99e3e,0x27fe9648238b270e,0xa62f2513a764a21f,0x27a820a51e3e27d9,0xa73b22d7a6a7a472,0x266d24c49a4627f6,0xa7d91e3ea5a8a5a8,0x247226a7a21f2764,0xa7fe9648a472a6a7,0x1fc627c3a513262f,0xa7a8a0a5a21fa764,0x9a4627f6a6a72472,0xa6dda41d9e3ea7d9,0xa2d7273ba7a820a5
.quad 0xa5a8a5a88000a800,0xa5a825a8a8008000,0xa41da6dd1e3ea7d9,0xa73b22d7a7a8a0a5,0xa0a5a7a8221fa764,0xa7f61a46a6a7a472,0x9648a7fe2472a6a7,0xa7c39fc6a513a62f,0x1e3ea7d925a8a5a8,0xa6a7a472a21fa764,0x22d7a73b26a7a472,0xa4c4a66d9a46a7f6,0x2513a62f2764a21f,0xa0a5a7a81e3ea7d9,0x266da4c427d99e3e,0x1648a7fe238ba70e
.quad 0x2764a21f28008000,0x221fa76425a8a5a8,0x27ea9cb227d91e3e,0x255fa5ed270ea38b,0x27f61a462764221f,0x270ea38b27d99e3e,0x2788216426a72472,0x27ea9cb227f61a46,0x26a7247225a825a8,0x27d91e3e2764221f,0x255f25ed247226a7,0x26dd241d262f2513,0x238b270e221f2764,0x2513262f247226a7,0x1fc627c31e3e27d9,0x2164278820a527a8
.quad 0x2800800000002800,0xa80000008000a800,0x273b22d7a21f2764,0xa6dda41d238ba70e,0x2513262fa5a825a8,0xa38ba70e26a7a472,0x1fc627c3a764221f,0x1648a7fe27f69a46,0x9e3e27d9a8008000,0x2472a6a72764221f,0xa4c4266da764a21f,0x273ba2d72513262f,0xa70e238ba5a8a5a8,0x27f61a461e3e27d9,0xa7fe1648a21fa764,0x266d24c4a0a527a8
.quad 0xa764a21f0000a800,0x221f2764a5a825a8,0xa55fa5ed221fa764,0x9cb227eaa7a820a5,0xa0a5a7a825a8a5a8,0xa513262fa7d99e3e,0x1cb2a7ea2764a21f,0xa7882164a62fa513,0x2472a6a728008000,0xa7d99e3ea21fa764,0x26dda41d2764221f,0xa5eda55f1a46a7f6,0x27f69a4625a825a8,0xa0a5a7a82472a6a7,0x27882164221f2764,0x1fc6a7c3270ea38b
.quad 0x25a825a800002800,0x25a8a5a828008000,0x21642788a21f2764,0x27c39fc6270e238b,0x9a4627f6a5a825a8,0x27a820a5247226a7,0xa41d26dda764221f,0x255f25ed1a4627f6,0xa6a72472a8008000,0x1e3e27d9a21f2764,0xa7ea1cb2a764a21f,0xa1642788a62f2513,0xa7a8a0a5a5a8a5a8,0xa62f2513a7d91e3e,0xa5eda55fa21fa764,0xa7ea1cb2a7a8a0a5
.quad 0xa21fa7648000a800,0xa764a21fa5a8a5a8,0x1648a7fe221fa764,0xa4c4a66da0a5a7a8,0x238ba70e25a8a5a8,0x9a46a7f61e3ea7d9,0x266da4c42764a21f,0x22d7a73b2513a62f,0x27d99e3e28008000,0x26a7a4722764a21f,0x27c31fc62764221f,0x27fe964827f61a46,0x262f251325a825a8,0x270e238b26a72472,0x22d7273b221f2764,0x241d26dd238b270e
.quad 0x2800800000002800,0xa80000000000a800,0x266d24c4a47226a7,0xa5eda55f2513a62f,0x20a527a8a764221f,0x9a46a7f627d99e3e,0xa1642788a7d99e3e,0x24c4a66d270e238b,0xa6a72472a5a8a5a8,0x27d99e3e221f2764,0xa7fe96489e3ea7d9,0x26dd241da0a527a8,0xa62fa513221fa764,0x20a527a8a6a72472,0x9fc6a7c326a7a472,0xa2d7273ba7f69a46
.quad 0x221fa76428000000,0xa764221fa5a8a5a8,0x26dda41d26a72472,0xa788a1649a46a7f6,0x27f61a46221f2764,0xa38ba70e2472a6a7,0x25ed255f9e3e27d9,0x1fc6a7c327a8a0a5,0x1e3e27d9a5a825a8,0x26a7a4722764221f,0xa2d7273ba7d91e3e,0x27ea1cb2238b270e,0xa70e238ba764a21f,0x2513262f9e3e27d9,0xa7ea9cb2a472a6a7,0x964827fea62f2513
.quad 0xa5a8a5a80000a800,0xa5a825a8a8000000,0x9cb2a7ea2472a6a7,0xa7fe1648a62fa513,0x238ba70e2764a21f,0xa62fa5139e3ea7d9,0x273ba2d727d91e3e,0x9cb2a7ea238ba70e,0x27d91e3e25a825a8,0x2472a6a72764a21f,0x255f25ed1e3e27d9,0x27c39fc627a820a5,0x1a4627f6a21f2764,0x270e238b247226a7,0xa41d26dda6a72472,0x216427889a4627f6
.quad 0xa764221fa8000000,0xa21f2764a5a825a8,0xa7c39fc6a6a7a472,0xa73b22d7a7f61a46,0xa513a62fa21fa764,0xa7a8a0a5a6a7a472,0x9648a7fe1e3ea7d9,0xa41da6dda0a5a7a8,0x2472a6a725a8a5a8,0x1e3ea7d9221fa764,0x2788a16427d99e3e,0x266da4c4270ea38b,0x27a820a52764221f,0x27f61a4627d91e3e,0x24c4266d247226a7,0x255f25ed2513262f
.quad 0x2800800000002800,0xa80000008000a800,0x255f25eda5a825a8,0xa4c4a66d262fa513,0x9a4627f6a8000000,0x20a5a7a827d91e3e,0xa66d24c4a5a8a5a8,0x2788a164238b270e,0xa7d99e3e0000a800,0x26a72472a21f2764,0xa41da6dd25a8a5a8,0x164827fea7a820a5,0x20a5a7a828008000,0xa62f2513a6a7a472,0x273ba2d725a825a8,0xa7c39fc69a46a7f6
.quad 0x2764221f80002800,0xa21fa76425a8a5a8,0x21642788a5a825a8,0x241da6dd27f61a46,0xa38b270ea8000000,0x27f69a46247226a7,0xa7c31fc6a5a8a5a8,0x255f25eda0a527a8,0xa6a7a4728000a800,0x9e3e27d9a764221f,0x9cb2a7ea25a8a5a8,0xa73b22d7a70ea38b,0x2513a62f28000000,0xa70ea38b9e3ea7d9,0x27fe964825a825a8,0x9cb2a7ea2513a62f
.quad 0x25a825a800002800,0x25a8a5a828000000,0x964827fea5a825a8,0x27ea1cb22513262f,0xa62f2513a8000000,0x238b270e9e3e27d9,0xa7ea9cb2a5a8a5a8,0xa2d7273ba70e238b,0xa472a6a70000a800,0xa7d91e3ea764a21f,0x1fc6a7c325a8a5a8,0xa5eda55fa0a5a7a8,0x270ea38b28008000,0x1a46a7f62472a6a7,0x2788216425a825a8,0x26dda41d27f69a46
.quad 0x221f276400002800,0x2764221f25a825a8,0xa2d7273ba5a825a8,0x1fc627c39a4627f6,0xa7a820a5a8000000,0xa513262fa6a72472,0xa6dda41da5a8a5a8,0xa7fe9648a7a8a0a5,0x9e3ea7d98000a800,0xa472a6a7a21fa764,0x24c4a66d25a8a5a8,0x2164a788238ba70e,0x27f69a4628000000,0x27a8a0a527d99e3e,0x25ed255f25a825a8,0x266d24c4262f2513
.quad 0x2800000000002800,0xa80000008000a800,0x241d26dda6a72472,0xa2d7a73b270ea38b,0xa38b270ea764a21f,0x2513a62f26a72472,0xa7fe16489e3ea7d9,0x27c31fc69a4627f6,0xa472a6a725a8a5a8,0x1e3e27d9a764221f,0x22d7a73b27d91e3e,0xa66d24c4a62fa513,0x27f69a46221f2764,0xa70ea38b1e3ea7d9,0x24c4266da47226a7,0x1648a7fe27a8a0a5
.quad 0xa21f2764a8008000,0x2764a21f25a825a8,0xa7ea1cb2a472a6a7,0x25ed255fa0a527a8,0xa513a62f221fa764,0xa0a527a8a7d91e3e,0x2164a78827d99e3e,0xa7ea1cb2a513a62f,0x27d99e3e25a825a8,0xa472a6a7221fa764,0x255f25ed9e3e27d9,0x241da6dd27f69a46,0xa0a527a8a764221f,0x27f61a46247226a7,0xa7c31fc6a6a7a472,0x21642788a38b270e
.quad 0xa5a8a5a88000a800,0xa5a825a8a8000000,0x1fc6a7c326a7a472,0xa788a164a38ba70e,0x27a8a0a52764221f,0x9a46a7f62472a6a7,0x25ed255f1e3e27d9,0x26dda41d27f61a46,0x9e3e27d9a5a825a8,0x26a72472221f2764,0xa7882164a7d99e3e,0x9cb227eaa513262f,0xa62fa513a21fa764,0xa7a820a5a7d99e3e,0x1cb2a7ea2472a6a7,0xa55fa5eda0a5a7a8
.quad 0x2764a21f28008000,0x221fa76425a8a5a8,0x266d24c4247226a7,0x27fe964827a820a5,0x9a4627f6a21f2764,0x238b270e1e3e27d9,0xa73b22d7a7d91e3e,0xa4c4266da62f2513,0xa6a7a472a5a8a5a8,0xa7d99e3ea764a21f,0x1648a7fe1e3ea7d9,0x9fc6a7c39a46a7f6,0x270ea38b2764a21f,0x262fa51326a7a472,0x26dd241d26a72472,0x273b22d7270e238b
.quad 0x2800800000002800,0xa80000008000a800,0x21642788a764221f,0x9fc6a7c327a8a0a5,0xa62f2513a5a8a5a8,0x270ea38b247226a7,0xa6dda41d221fa764,0x255f25eda513262f,0x1e3ea7d928008000,0xa47226a7a764a21f,0x27ea9cb2221f2764,0xa788a1641a46a7f6,0x238b270ea5a825a8,0x1a46a7f627d99e3e,0xa55f25eda764a21f,0x27ea9cb2238b270e
.quad 0xa764a21f0000a800,0x221f2764a5a825a8,0x1648a7fe2764a21f,0xa66d24c4a70ea38b,0x27a8a0a525a825a8,0xa62fa5131e3ea7d9,0x24c4266da21f2764,0x22d7a73b27f69a46,0xa47226a7a8000000,0x27d91e3e221f2764,0xa7c39fc6a21fa764,0x164827fea62f2513,0x9a46a7f625a8a5a8,0xa7a820a5a6a7a472,0x273ba2d72764221f,0xa41da6dd20a5a7a8
.quad 0x25a825a880002800,0x25a8a5a828008000,0xa2d7273ba764221f,0x26dd241d20a527a8,0xa7f69a46a5a8a5a8,0xa0a527a8a6a72472,0x9fc6a7c3221fa764,0xa7fe9648a62fa513,0x26a7a47228008000,0x9e3ea7d9221fa764,0x266d24c4221f2764,0x273ba2d727f61a46,0xa0a527a8a5a825a8,0x2513262f1e3e27d9,0xa7fe1648a764a21f,0xa4c4266da70e238b
.quad 0xa21fa7648000a800,0xa764a21fa5a8a5a8,0x25eda55f2764a21f,0x1cb2a7ea238ba70e,0x270e238b25a825a8,0x27f69a4627d91e3e,0x9cb227eaa21f2764,0x216427881a4627f6,0xa7d91e3ea8000000,0xa6a72472a764221f,0xa41da6dda21fa764,0xa5eda55fa513a62f,0x2513a62f25a8a5a8,0x238ba70e2472a6a7,0x278821642764221f,0x27c31fc627a820a5
.quad 0x2800800080002800,0xa80000008000a800,0x1cb227eaa7d91e3e,0x9648a7fe27f69a46,0xa7a820a5a21fa764,0x27f69a461e3e27d9,0xa2d7a73b26a7a472,0x1cb227eaa7a820a5,0x26a7a47225a825a8,0xa7d91e3ea21fa764,0x255f25eda47226a7,0x9fc6a7c3270ea38b,0xa513262fa764a21f,0x27a8a0a5247226a7,0xa6dda41d1e3ea7d9,0x21642788a62f2513
.quad 0x221fa76428000000,0xa764221fa5a8a5a8,0x27c31fc61e3e27d9,0xa2d7a73b2513a62f,0x9a4627f6a764221f,0x270ea38b26a72472,0xa7fe1648a472a6a7,0x241d26dda38b270e,0x9e3ea7d925a8a5a8,0xa6a72472a764a21f,0x2788a16426a72472,0xa4c4a66d20a5a7a8,0x238b270ea21f2764,0x262fa51327d91e3e,0xa66d24c4a7d99e3e,0x255f25ed9a4627f6
.quad 0xa5a8a5a88000a800,0xa5a825a8a8008000,0x24c4a66d27d99e3e,0xa5eda55f9a46a7f6,0x270e238b221f2764,0x2513a62f27d99e3e,0xa1642788a6a72472,0x266d24c420a527a8,0xa7d99e3ea5a8a5a8,0xa47226a7a764221f,0x1648a7fe2472a6a7,0xa6dda41da38ba70e,0x27f69a462764221f,0x238ba70e26a7a472,0x1fc627c39e3e27d9,0x273b22d72513262f
.quad 0xa764221fa8000000,0xa21f2764a5a825a8,0xa41da6dd9e3ea7d9,0xa788a164a62fa513,0x262fa5132764a21f,0x20a5a7a82472a6a7,0x25ed255f247226a7,0x27c31fc6270e238b,0xa47226a7a5a825a8,0x9e3e27d9a21f2764,0xa73ba2d7a6a7a472,0xa7ea9cb2a7a8a0a5,0x20a5a7a8221fa764,0x1a46a7f61e3ea7d9,0x27ea1cb227d91e3e,0x27fe164827f61a46
.quad 0x2800000000002800,0xa80080008000a800,0x964827fea8000000,0x1cb2a7ea27f61a46,0xa7f69a468000a800,0x27a820a59e3e27d9,0x1cb2a7ea28000000,0xa2d7273ba7a8a0a5,0x27d91e3e80002800,0xa6a7a472221fa764,0x9fc627c3a8000000,0x255fa5ed270e238b,0xa7a8a0a58000a800,0x2513262fa47226a7,0x2164a78828008000,0xa6dd241da62fa513
.quad 0x2764221f80002800,0xa21fa76425a8a5a8,0xa2d7273ba8008000,0x27c39fc62513262f,0xa70ea38b8000a800,0x1a4627f6a6a72472,0x241da6dd28008000,0xa7fe9648a38ba70e,0x26a7247200002800,0x1e3ea7d92764a21f,0xa4c4266da8000000,0x2788216420a527a8,0xa62fa5130000a800,0xa38b270ea7d91e3e,0x255fa5ed28008000,0xa66da4c49a46a7f6
.quad 0x25a825a800002800,0x25a8a5a828008000,0xa5ed255fa8000000,0x24c4266d9a4627f6,0xa513a62f8000a800,0xa70e238ba7d99e3e,0x266da4c428000000,0xa164a78820a5a7a8,0x247226a780002800,0x27d99e3e2764221f,0xa6dd241da8000000,0x164827fea38b270e,0xa38ba70e8000a800,0xa7f69a46a6a7a472,0x273ba2d728008000,0x1fc6a7c32513a62f
.quad 0x221f276400002800,0x2764221f25a825a8,0xa7882164a8008000,0xa41d26dda62f2513,0xa0a5a7a88000a800,0xa62fa513a472a6a7,0x27c39fc628008000,0x25eda55f270ea38b,0x1e3e27d900002800,0x247226a7221f2764,0xa7ea1cb2a8000000,0xa73b22d7a7a820a5,0x9a46a7f60000a800,0xa0a5a7a89e3ea7d9,0x27fe964828008000,0x27ea9cb227f69a46
.quad 0x2800800000002800,0xa80000008000a800,0x9fc627c3a7d99e3e,0x2164a78827a820a5,0xa70ea38b221fa764,0x262f2513a47226a7,0x255fa5ed26a72472,0xa6dd241da513a62f,0x247226a7a5a825a8,0x9e3ea7d92764a21f,0xa7882164a472a6a7,0x27ea1cb21a4627f6,0x9a46a7f62764a21f,0xa38b270ea7d99e3e,0x27ea1cb21e3e27d9,0xa55fa5ed238ba70e
.quad 0xa21f2764a8000000,0x2764a21f25a825a8,0xa66da4c41e3ea7d9,0x164827fea70e238b,0x262fa5132764221f,0xa7a8a0a59e3ea7d9,0x22d7273ba47226a7,0x24c4a66d27f61a46,0xa7d91e3ea5a8a5a8,0x247226a7a21f2764,0x1648a7fe26a7a472,0xa7c31fc6a62fa513,0x27a820a5221f2764,0x1a46a7f626a7a472,0xa41d26dda7d91e3e,0x273b22d720a527a8
.quad 0xa5a8a5a80000a800,0xa5a825a8a8000000,0x26dda41d27d91e3e,0xa2d7a73b20a5a7a8,0x20a527a8a21f2764,0x27f69a4626a72472,0xa7fe1648a6a7a472,0x9fc627c3a62f2513,0x1e3ea7d925a8a5a8,0xa6a7a472a21fa764,0x273b22d7247226a7,0x266da4c427f69a46,0xa513262fa764221f,0x20a527a89e3e27d9,0xa4c4a66d9e3ea7d9,0xa7fe9648a70ea38b
.quad 0x2764a21f28008000,0x221fa76425a8a5a8,0x1cb227ea9e3e27d9,0x25ed255f238b270e,0xa7f69a46a764a21f,0xa70e238ba7d91e3e,0x2164a7882472a6a7,0x9cb2a7ea1a46a7f6,0x26a7247225a825a8,0x27d91e3e2764221f,0xa5ed255fa6a72472,0xa41d26dda513262f,0xa38ba70ea21fa764,0xa513a62fa472a6a7,0x27c39fc627d99e3e,0x2788a16427a8a0a5
.quad 0x2800800000002800,0xa80000000000a800,0xa2d7273ba764a21f,0x241da6dd270e238b,0xa513a62f25a8a5a8,0x238b270ea6a72472,0x27c39fc6221f2764,0xa7fe96489a46a7f6,0x9e3e27d9a8008000,0x2472a6a72764221f,0xa66da4c4221fa764,0x22d7273ba62f2513,0x270ea38b25a825a8,0xa7f69a469e3ea7d9,0x164827fea764221f,0x24c4a66d27a820a5
.quad 0xa764a21f0000a800,0x221f2764a5a825a8,0x25eda55f2764221f,0xa7ea9cb2a0a5a7a8,0x20a527a8a5a825a8,0x2513a62f27d91e3e,0xa7ea9cb2a21fa764,0x21642788a513262f,0x2472a6a728008000,0xa7d99e3ea21fa764,0x241d26dda21f2764,0x255fa5ed27f61a46,0xa7f61a46a5a8a5a8,0x20a527a8a47226a7,0x2164a7882764a21f,0xa7c39fc6a38ba70e
.quad 0x25a825a800002800,0x25a8a5a828000000,0xa7882164a764a21f,0x1fc627c3a38b270e,0x1a46a7f625a8a5a8,0xa7a8a0a5a472a6a7,0x26dd241d221f2764,0x25eda55f27f69a46,0xa6a72472a8008000,0x1e3e27d9a21f2764,0x9cb2a7ea221fa764,0xa788a164a513a62f,0x27a820a525a825a8,0x262fa51327d99e3e,0xa55f25eda764221f,0x1cb227eaa0a527a8
.quad 0xa21fa7648000a800,0xa764a21fa5a8a5a8,0x27fe16482764221f,0x266da4c427a8a0a5,0xa38b270ea5a825a8,0x1a4627f69e3e27d9,0xa4c4a66da21fa764,0xa73ba2d7a62fa513,0x27d99e3e28008000,0x26a7a4722764a21f,0x9fc627c3a21f2764,0x164827fe9a4627f6,0xa62fa513a5a8a5a8,0xa70ea38ba6a7a472,0x273ba2d72764a21f,0x26dda41d270ea38b
.quad 0x2800800000002800,0xa80000008000a800,0xa4c4266da6a7a472,0x255fa5ed262f2513,0xa0a5a7a82764a21f,0x1a4627f6a7d91e3e,0x278821649e3e27d9,0xa66da4c4238ba70e,0xa6a72472a5a8a5a8,0x27d99e3e221f2764,0x1648a7fe27d99e3e,0xa41d26dda7a8a0a5,0x262f2513a21f2764,0xa0a5a7a826a7a472,0xa7c31fc6a472a6a7,0x273b22d79a4627f6
.quad 0x221fa76428000000,0xa764221fa5a8a5a8,0x241d26dda47226a7,0x2164a78827f69a46,0xa7f69a46a21fa764,0x238b270ea47226a7,0x255fa5ed27d91e3e,0xa7c39fc6a0a5a7a8,0x1e3e27d9a5a825a8,0x26a7a4722764221f,0xa73ba2d79e3ea7d9,0x9cb227eaa70e238b,0x270ea38b2764221f,0xa513a62f1e3ea7d9,0x9cb227eaa6a72472,0x27fe16482513262f
.quad 0xa5a8a5a88000a800,0xa5a825a8a8000000,0x27ea9cb226a72472,0x9648a7fe2513a62f,0xa38b270ea764221f,0x262f25131e3e27d9,0xa2d7a73b1e3ea7d9,0xa7ea1cb2a70ea38b,0x27d91e3e25a825a8,0x2472a6a72764a21f,0xa5ed255fa7d91e3e,0x1fc627c3a0a527a8,0x9a46a7f6221fa764,0xa70ea38ba472a6a7,0x26dd241d247226a7,0x2788a16427f61a46
.quad 0xa764221fa8000000,0xa21f2764a5a825a8,0x1fc6a7c32472a6a7,0xa2d7a73b9a46a7f6,0x2513262f221f2764,0x27a820a526a72472,0xa7fe1648a7d99e3e,0xa6dd241da7a820a5,0x2472a6a725a8a5a8,0x1e3ea7d9221fa764,0x216427881e3e27d9,0x24c4266d238b270e,0xa7a8a0a5a764a21f,0xa7f69a46a7d99e3e,0x266da4c426a7a472,0x25eda55f262fa513
.quad 0x2800000000002800,0xa80000008000a800,0xa5ed255fa5a8a5a8,0x266da4c42513262f,0x1a46a7f628008000,0xa0a527a8a7d99e3e,0x24c4266da5a825a8,0xa164a788270ea38b,0xa7d99e3e8000a800,0x26a72472a21f2764,0x26dda41d25a825a8,0xa7fe1648a0a5a7a8,0xa0a527a8a8000000,0x262fa51326a72472,0xa2d7a73b25a8a5a8,0x9fc627c3a7f61a46
.quad 0x2764221f80002800,0xa21fa76425a8a5a8,0xa7882164a5a8a5a8,0x26dd241d9a4627f6,0x238ba70e28008000,0xa7f61a46a472a6a7,0x1fc627c3a5a825a8,0x25eda55f27a820a5,0xa6a7a4728000a800,0x9e3e27d9a764221f,0x27ea9cb225a825a8,0xa2d7a73b238ba70e,0xa513262fa8008000,0x270e238b1e3e27d9,0x9648a7fe25a8a5a8,0xa7ea1cb2a62fa513
.quad 0x25a825a880002800,0x25a8a5a828008000,0xa7fe9648a5a8a5a8,0x9cb227eaa62f2513,0x262fa51328008000,0xa38ba70e1e3ea7d9,0x9cb227eaa5a825a8,0x273b22d7238b270e,0xa472a6a78000a800,0xa7d91e3ea764a21f,0x27c31fc625a825a8,0x255fa5ed27a8a0a5,0xa70e238ba8008000,0x9a4627f6a47226a7,0x2164a78825a8a5a8,0xa41da6dd9a46a7f6
.quad 0x221f276400002800,0x2764221f25a825a8,0xa73ba2d7a5a8a5a8,0xa7c31fc6a7f69a46,0x27a8a0a528008000,0x2513a62f26a7a472,0xa41d26dda5a825a8,0x964827fea0a527a8,0x9e3ea7d98000a800,0xa472a6a7a21fa764,0x266d24c425a825a8,0x27882164270e238b,0xa7f61a46a8008000,0xa7a820a5a7d91e3e,0x255fa5ed25a8a5a8,0x24c4a66d2513a62f
.quad 0x2800800000002800,0xa80000008000a800,0xa6dd241da472a6a7,0x273ba2d7238b270e,0x238ba70e2764221f,0xa513262fa6a7a472,0x164827fea7d91e3e,0x1fc6a7c327f61a46,0xa472a6a725a8a5a8,0x1e3e27d9a764221f,0x273b22d79e3e27d9,0xa4c4a66d2513a62f,0xa7f61a46a21fa764,0x270e238b9e3e27d9,0x266da4c426a72472,0xa7fe9648a0a5a7a8
.quad 0xa21f2764a8000000,0x2764a21f25a825a8,0x9cb2a7ea26a7a472,0xa55f25eda7a8a0a5,0x2513262fa21f2764,0x20a5a7a827d99e3e,0xa788a1649e3ea7d9,0x1cb227eaa62f2513,0x27d99e3e25a825a8,0xa472a6a7221fa764,0xa5ed255fa7d99e3e,0x26dd241d1a4627f6,0x20a5a7a82764a21f,0xa7f69a46a472a6a7,0x1fc627c3a47226a7,0x2788a164270e238b
.quad 0xa5a8a5a88000a800,0xa5a825a8a8008000,0x27c31fc6247226a7,0x2164a788270ea38b,0xa7a820a5a764a21f,0x1a4627f6a47226a7,0x255fa5ed27d99e3e,0xa41da6dd1a46a7f6,0x9e3e27d9a5a825a8,0x26a72472221f2764,0xa164a7881e3ea7d9,0xa7ea9cb2a62fa513,0x262f2513221f2764,0x27a8a0a527d91e3e,0xa7ea9cb2a6a7a472,0xa5ed255fa7a820a5
.quad 0x2764a21f28008000,0x221fa76425a8a5a8,0xa4c4266da6a72472,0x164827fea0a527a8,0x1a46a7f6221fa764,0xa38ba70e9e3ea7d9,0x22d7273b1e3e27d9,0x266d24c42513262f,0xa6a7a472a5a8a5a8,0xa7d99e3ea764a21f,0x27fe164827d91e3e,0x27c39fc627f69a46,0xa70e238ba764221f,0xa62f2513a6a72472,0x241da6dd2472a6a7,0x22d7a73b238ba70e
.quad 0x2800800080002800,0xa80080008000a800,0xa7882164a21fa764,0x27c39fc620a527a8,0x262fa51325a825a8,0xa70e238ba472a6a7,0xa41d26dda764a21f,0x25eda55f262f2513,0x1e3ea7d928000000,0xa47226a7a764a21f,0x1cb227eaa764221f,0x2164a78827f61a46,0xa38ba70e25a8a5a8,0x9a4627f6a7d91e3e,0x25ed255fa21f2764,0x9cb2a7ea270ea38b
.quad 0xa764a21f0000a800,0x221f2764a5a825a8,0x27fe1648221f2764,0xa4c4a66d238ba70e,0xa7a820a5a5a8a5a8,0x262f25139e3e27d9,0x266da4c42764221f,0xa73ba2d79a46a7f6,0xa47226a7a8000000,0x27d91e3e221f2764,0x1fc6a7c32764a21f,0xa7fe1648a513a62f,0x1a4627f6a5a825a8,0x27a8a0a526a72472,0xa2d7a73b221fa764,0xa6dd241da7a8a0a5
.quad 0x25a825a800002800,0x25a8a5a828008000,0xa73ba2d7a21fa764,0xa41d26dda7a820a5,0x27f61a4625a825a8,0x20a5a7a826a7a472,0xa7c31fc6a764a21f,0x964827fea513262f,0x26a7a47228008000,0x9e3ea7d9221fa764,0xa4c4266da764221f,0x22d7273b9a4627f6,0x20a5a7a825a8a5a8,0xa513a62f9e3ea7d9,0x164827fea21f2764,0x266d24c4238b270e
.quad 0xa21fa7648000a800,0xa764a21fa5a8a5a8,0x255f25ed221f2764,0x27ea1cb2270e238b,0xa70ea38ba5a8a5a8,0xa7f61a46a7d99e3e,0x27ea1cb22764221f,0x2788a16427f69a46,0xa7d91e3ea8000000,0xa6a72472a764221f,0x26dda41d2764a21f,0x255fa5ed262fa513,0xa513262fa5a825a8,0xa38b270ea47226a7,0x2164a788221fa764,0x1fc6a7c320a5a7a8
.quad 0x2800800000002800,0xa80080008000a800,0xa7ea1cb29e3ea7d9,0x27fe96481a4627f6,0x27a8a0a5221f2764,0xa7f61a469e3ea7d9,0xa73b22d7a472a6a7,0x27ea9cb220a527a8,0x26a7a47225a825a8,0xa7d91e3ea21fa764,0xa5ed255fa6a7a472,0x27c39fc6238b270e,0x2513a62f2764221f,0xa7a820a5a472a6a7,0xa41d26dda7d99e3e,0x2788a1642513262f
.quad 0x221fa76428000000,0xa764221fa5a8a5a8,0x9fc627c3a7d91e3e,0x273ba2d7262f2513,0x1a46a7f62764a21f,0xa70e238ba6a7a472,0x164827fea6a72472,0x26dda41d270e238b,0x9e3ea7d925a8a5a8,0xa6a72472a764a21f,0x21642788a47226a7,0x266da4c427a820a5,0xa38ba70e221fa764,0xa62f2513a7d99e3e,0x24c4266d9e3e27d9,0x25eda55f27f61a46
.quad 0xa5a8a5a80000a800,0xa5a825a8a8000000,0x266d24c41e3e27d9,0x255fa5ed27f69a46,0xa70ea38ba21fa764,0xa513262fa7d91e3e,0x27882164247226a7,0x24c4a66d27a8a0a5,0xa7d99e3ea5a8a5a8,0xa47226a7a764221f,0x27fe164826a72472,0x241da6dd270ea38b,0xa7f61a46a764a21f,0xa38b270ea6a72472,0x27c39fc627d91e3e,0x22d7a73b262fa513
.quad 0xa764221fa8000000,0xa21f2764a5a825a8,0x26dda41d27d99e3e,0x2164a7882513a62f,0xa62f2513a764221f,0xa0a527a8a47226a7,0x255fa5ed26a7a472,0x1fc6a7c3238ba70e,0xa47226a7a5a825a8,0x9e3e27d9a21f2764,0x22d7a73b2472a6a7,0x1cb2a7ea20a5a7a8,0xa0a527a8a21f2764,0x9a4627f69e3e27d9,0x1cb2a7ea1e3ea7d9,0x1648a7fe1a46a7f6
.quad 0x924827ffa8002800,0x98b527fa964827fe,0x98b527fa28002800,0x9f0327ce9cb227ea,0x9bd627f1a8002800,0xa1c227779fc627c3,0x9d7927e228002800,0xa3e326f6a1642788,0x9f0327cea8002800,0xa4ec264fa2d7273b,0xa04427b628002800,0xa5cb2584a41d26dd,0xa1052799a8002800,0xa68a249ba4c4266d,0xa1c2277728002800,0xa7252332a55f25ed
.quad 0xa27c2750a8002800,0xa7992105a5ed255f,0xa332272528002800,0xa7e21d79a66d24c4,0xa3e326f6a8002800,0xa7ff1248a6dd241d,0xa44826c228002800,0xa7f19bd6a73b22d7,0xa49b268aa8002800,0xa7b6a044a7882164,0xa4ec264f28002800,0xa750a27ca7c31fc6,0xa53a260fa8002800,0xa6c2a448a7ea1cb2,0xa58425cb28002800,0xa60fa53aa7fe1648
.quad 0xa5cb2584a8002800,0xa53aa60fa7fe9648,0xa60f253a28002800,0xa448a6c2a7ea9cb2,0xa64f24eca8002800,0xa27ca750a7c39fc6,0xa68a249b28002800,0xa044a7b6a788a164,0xa6c22448a8002800,0x9bd6a7f1a73ba2d7,0xa6f623e328002800,0x1248a7ffa6dda41d,0xa7252332a8002800,0x1d79a7e2a66da4c4,0xa750227c28002800,0x2105a799a5eda55f
.quad 0xa77721c2a8002800,0x2332a725a55fa5ed,0xa799210528002800,0x249ba68aa4c4a66d,0xa7b62044a8002800,0x2584a5cba41da6dd,0xa7ce1f0328002800,0x264fa4eca2d7a73b,0xa7e21d79a8002800,0x26f6a3e3a164a788,0xa7f11bd628002800,0x2777a1c29fc6a7c3,0xa7fa18b5a8002800,0x27ce9f039cb2a7ea,0xa7ff124828002800,0x27fa98b59648a7fe
.quad 0x9bd627f19a4627f6,0x9d7927e29cb227ea,0xa1c22777a0a527a8,0xa3e326f6a2d7273b,0xa49b268aa38b270e,0xa60f253aa55f25ed,0xa60f253aa513262f,0xa77721c2a6dd241d,0xa7252332a62f2513,0xa7ff1248a7c31fc6,0xa7ce1f03a70e238b,0xa799a105a7fe9648,0xa7ff9248a7a820a5,0xa64fa4eca788a164,0xa7b6a044a7f61a46,0xa448a6c2a66da4c4
.quad 0xa6f6a3e3a7f69a46,0x9f03a7cea4c4a66d,0xa5cba584a7a8a0a5,0x1bd6a7f1a164a788,0xa448a6c2a70ea38b,0x2332a7259648a7fe,0xa105a799a62fa513,0x25cba5841fc6a7c3,0x98b5a7faa513a62f,0x2750a27c241da6dd,0x1d79a7e2a38ba70e,0x27fa98b525eda55f,0x227ca750a0a5a7a8,0x27b62044273ba2d7,0x24eca64f9a46a7f6,0x268a249b27ea9cb2
.quad 0x264fa4ec1a46a7f6,0x249b268a27ea1cb2,0x2750a27c20a5a7a8,0x204427b6273b22d7,0x27e29d79238ba70e,0x98b527fa25ed255f,0x27fa18b52513a62f,0xa27c2750241d26dd,0x27992105262fa513,0xa58425cb1fc627c3,0x26c22448270ea38b,0xa7252332964827fe,0x258425cb27a8a0a5,0xa7f11bd6a1642788,0x23e326f627f69a46,0xa7ce9f03a4c4266d
.quad 0x204427b627f61a46,0xa6c2a448a66d24c4,0x124827ff27a820a5,0xa4eca64fa7882164,0x9f0327ce270e238b,0xa105a799a7fe1648,0xa3322725262f2513,0x1248a7ffa7c39fc6,0xa53a260f2513262f,0x21c2a777a6dda41d,0xa68a249b238b270e,0x253aa60fa55fa5ed,0xa77721c220a527a8,0x26f6a3e3a2d7a73b,0xa7f11bd61a4627f6,0x27e29d799cb2a7ea
.quad 0x9f0327ce9e3e27d9,0xa04427b69fc627c3,0xa4ec264fa47226a7,0xa5cb2584a55f25ed,0xa7252332a6a72472,0xa7ce1f03a7882164,0xa7ff1248a7d91e3e,0xa799a105a7ea9cb2,0xa750a27ca7d99e3e,0xa53aa60fa66da4c4,0xa53aa60fa6a7a472,0x9d79a7e2a2d7a73b,0xa044a7b6a472a6a7,0x21c2a7771648a7fe,0x1d79a7e29e3ea7d9,0x264fa4ec241da6dd
.quad 0x249ba68a1e3ea7d9,0x27f19bd626dda41d,0x26f6a3e32472a6a7,0x2750227c27fe9648,0x27fa98b526a7a472,0x249b268a273b22d7,0x277721c227d99e3e,0x18b527fa24c4266d,0x258425cb27d91e3e,0xa33227251cb227ea,0x2105279926a72472,0xa6c22448a1642788,0x9bd627f1247226a7,0xa7ff1248a5ed255f,0xa44826c21e3e27d9,0xa6f6a3e3a7c31fc6
.quad 0xa6c224489e3e27d9,0xa3e3a6f6a7c39fc6,0xa7f11bd6a47226a7,0x1248a7ffa5eda55f,0xa799a105a6a72472,0x2448a6c2a164a788,0xa5cba584a7d91e3e,0x2725a3321cb2a7ea,0xa1c2a777a7d99e3e,0x27fa18b524c4a66d,0x18b5a7faa6a7a472,0x268a249b273ba2d7,0x23e3a6f6a472a6a7,0x227c275027fe1648,0x268aa49b9e3ea7d9,0x9bd627f126dd241d
.quad 0x27e29d791e3ea7d9,0xa4ec264f241d26dd,0x27b620442472a6a7,0xa77721c2164827fe,0x260f253a26a7a472,0xa7e29d79a2d7273b,0x227c275027d99e3e,0xa60fa53aa66d24c4,0x924827ff27d91e3e,0xa105a799a7ea1cb2,0xa332272526a72472,0x1f03a7cea788a164,0xa64f24ec247226a7,0x2584a5cba55fa5ed,0xa7ce1f031e3e27d9,0x27b6a0449fc6a7c3
.quad 0xa1052799a0a527a8,0xa1c22777a1642788,0xa68a249ba62f2513,0xa7252332a6dd241d,0xa7ff9248a7f61a46,0xa7b6a044a7ea9cb2,0xa64fa4eca70ea38b,0xa448a6c2a55fa5ed,0xa044a7b6a38ba70e,0x1d79a7e29648a7fe,0x21c2a7771a46a7f6,0x264fa4ec24c4a66d,0x26c2a4482513a62f,0x27fa18b527c39fc6,0x27fa18b527a8a0a5,0x258425cb273b22d7
.quad 0x260f253a27a820a5,0x124827ff22d7273b,0x1f0327ce2513262f,0xa53a260f9fc627c3,0xa27c27501a4627f6,0xa7f11bd6a66d24c4,0xa6f623e3a38b270e,0xa68aa49ba7fe9648,0xa7f19bd6a70e238b,0x9f03a7cea5eda55f,0xa5cba584a7f69a46,0x23e3a6f69cb2a7ea,0x9d79a7e2a62fa513,0x2799a105241da6dd,0x2332a725a0a5a7a8,0x2750227c2788a164
.quad 0x2725a33220a5a7a8,0x227c275027882164,0x27e21d79262fa513,0xa1052799241d26dd,0x258425cb27f69a46,0xa6f623e39cb227ea,0x1bd627f1270e238b,0xa7ce9f03a5ed255f,0xa3e326f6238b270e,0xa49ba68aa7fe1648,0xa750227c9a4627f6,0x1bd6a7f1a66da4c4,0xa7ce9f03a513262f,0x260fa53a9fc6a7c3,0xa53aa60fa7a820a5,0x27ff124822d7a73b
.quad 0x98b5a7faa7a8a0a5,0x25cb2584273ba2d7,0x2448a6c2a513a62f,0x18b527fa27c31fc6,0x2777a1c29a46a7f6,0xa4ec264f24c4266d,0x27b62044238ba70e,0xa7e21d79964827fe,0x24ec264f270ea38b,0xa6c2a448a55f25ed,0x124827ff27f61a46,0xa044a7b6a7ea1cb2,0xa49b268a262f2513,0x2332a725a6dda41d,0xa799210520a527a8,0x2777a1c2a164a788
.quad 0xa27c2750a21f2764,0xa3322725a2d7273b,0xa7992105a764221f,0xa7e21d79a7c31fc6,0xa6f6a3e3a764a21f,0xa5cba584a66da4c4,0x9f03a7cea21fa764,0x1bd6a7f19648a7fe,0x249ba68a221fa764,0x26f6a3e325eda55f,0x27f19bd62764a21f,0x2750227c27ea1cb2,0x260f253a2764221f,0x1f0327ce241d26dd,0x124827ff221f2764,0xa53a260fa1642788
.quad 0xa5cb2584a21f2764,0xa7fa98b5a7882164,0xa7fa98b5a764221f,0xa448a6c2a6dda41d,0xa4eca64fa764a21f,0x21c2a7779cb2a7ea,0x1d79a7e2a21fa764,0x27b6a044255fa5ed,0x26c2a448221fa764,0x264f24ec27fe1648,0x27b620442764a21f,0x924827ff24c4266d,0x233227252764221f,0xa68a249b9fc627c3,0xa1c22777221f2764,0xa799a105a73b22d7
.quad 0xa77721c2a21f2764,0xa105a799a73ba2d7,0xa725a332a764221f,0x249ba68a9fc6a7c3,0xa044a7b6a764a21f,0x27ff924824c4a66d,0x2448a6c2a21fa764,0x24ec264f27fe9648,0x27e29d79221fa764,0xa04427b6255f25ed,0x264f24ec2764a21f,0xa77721c29cb227ea,0x18b527fa2764221f,0xa6c2a448a6dd241d,0xa58425cb221f2764,0x98b5a7faa788a164
.quad 0xa7ff9248a21f2764,0x260fa53aa164a788,0xa53aa60fa764221f,0x27ce1f03241da6dd,0x1bd6a7f1a764a21f,0x227c275027ea9cb2,0x268aa49ba21fa764,0xa3e326f625ed255f,0x27ce1f03221fa764,0xa7f11bd6964827fe,0x23e326f62764a21f,0xa584a5cba66d24c4,0xa10527992764221f,0x1d79a7e2a7c39fc6,0xa750227c221f2764,0x2725a332a2d7a73b
.quad 0xa3e326f6a38b270e,0xa44826c2a41d26dd,0xa7ff1248a7f61a46,0xa7f19bd6a7fe9648,0xa448a6c2a513a62f,0xa105a799a2d7a73b,0x2332a72520a5a7a8,0x25cba58424c4a66d,0x27fa98b527a8a0a5,0x277721c227ea1cb2,0x249b268a262f2513,0x18b527fa21642788,0xa27c27509a4627f6,0xa6f623e3a55f25ed,0xa7f11bd6a70e238b,0xa68aa49ba7c39fc6
.quad 0xa4eca64fa70ea38b,0x1d79a7e29fc6a7c3,0x21c2a7779a46a7f6,0x27b6a04425eda55f,0x27e29d79262fa513,0x253a260f27882164,0x253a260f27a820a5,0xa27c27501cb227ea,0xa105279920a527a8,0xa7ff1248a66d24c4,0xa7ce1f03a513262f,0xa332a725a73ba2d7,0xa584a5cba7f69a46,0x24eca64f9648a7fe,0x2044a7b6a38ba70e,0x27ce1f0326dda41d
.quad 0x27b6a044238ba70e,0x1f0327ce26dd241d,0x25cb258427f69a46,0xa64f24ec964827fe,0x9f0327ce2513262f,0xa725a332a73b22d7,0xa7992105a0a527a8,0x1248a7ffa66da4c4,0xa60fa53aa7a820a5,0x2750a27c1cb2a7ea,0x1d79a7e2a62fa513,0x260f253a2788a164,0x2777a1c21a46a7f6,0xa04427b625ed255f,0x264f24ec270ea38b,0xa7e21d799fc627c3
.quad 0x9bd627f1270e238b,0xa49ba68aa7c31fc6,0xa750227c1a4627f6,0x23e3a6f6a55fa5ed,0xa68aa49ba62f2513,0x27fa18b52164a788,0x18b5a7faa7a8a0a5,0x21c2277727ea9cb2,0x2725a332a0a5a7a8,0xa58425cb24c4266d,0x26c224482513a62f,0xa799a105a2d7273b,0x924827ff27f61a46,0x9bd6a7f1a7fe1648,0xa6f623e3238b270e,0x26c2a448a41da6dd
.quad 0xa49b268aa47226a7,0xa4ec264fa4c4266d,0xa7b6a044a7d99e3e,0xa750a27ca788a164,0x98b5a7fa9e3ea7d9,0x1d79a7e21648a7fe,0x2750a27c26a7a472,0x27fa98b527c39fc6,0x258425cb26a72472,0x21052799241d26dd,0xa33227259e3e27d9,0xa6c22448a55f25ed,0xa7f19bd6a7d91e3e,0xa5cba584a73ba2d7,0x9f03a7cea472a6a7,0x23e3a6f61cb2a7ea
.quad 0x26c2a4482472a6a7,0x27b6204427ea9cb2,0x264f24ec27d91e3e,0x924827ff22d7273b,0xa10527991e3e27d9,0xa7ce1f03a5ed255f,0xa7ff1248a6a72472,0xa332a725a6dda41d,0xa1c2a777a6a7a472,0x260fa53a1fc6a7c3,0x260fa53a1e3ea7d9,0x268a249b27fe9648,0x26f623e327d99e3e,0xa1c2277721642788,0x9d7927e2247226a7,0xa7f19bd6a66d24c4
.quad 0xa7e21d79a47226a7,0x9bd6a7f1a66da4c4,0xa3e3a6f6a7d99e3e,0x2777a1c22164a788,0x253aa60f9e3ea7d9,0x249b268a27fe1648,0x277721c226a7a472,0xa53a260f1fc627c3,0x924827ff26a72472,0xa725a332a6dd241d,0xa79921059e3e27d9,0x1f03a7cea5eda55f,0xa4eca64fa7d91e3e,0x27ff924822d7a73b,0x2448a6c2a472a6a7,0x204427b627ea1cb2
.quad 0x27ce1f032472a6a7,0xa6f623e31cb227ea,0x1bd627f127d91e3e,0xa584a5cba73b22d7,0xa72523321e3e27d9,0x2448a6c2a55fa5ed,0xa5cba584a6a72472,0x27992105241da6dd,0x227ca750a6a7a472,0x98b527fa27c31fc6,0x27fa18b51e3ea7d9,0xa7e21d79164827fe,0x204427b627d99e3e,0xa27ca750a7882164,0xa68a249b247226a7,0x264fa4eca4c4a66d
.quad 0xa53a260fa513262f,0xa58425cba55f25ed,0xa6c2a448a70ea38b,0xa60fa53aa66da4c4,0x227ca75020a5a7a8,0x24eca64f241da6dd,0x27b6204427f61a46,0x268a249b273b22d7,0x9bd627f11a4627f6,0xa44826c2a1642788,0xa7ff1248a7a820a5,0xa6f6a3e3a7c39fc6,0x9d79a7e2a38ba70e,0x2332a7251cb2a7ea,0x2799a105262fa513,0x2750227c27fe1648
.quad 0x23322725262f2513,0xa1c22777164827fe,0xa68a249ba38b270e,0xa799a105a7ea1cb2,0xa584a5cba7a8a0a5,0x2044a7b69fc6a7c3,0x24eca64f1a46a7f6,0x27ce1f032788a164,0x26f623e327f69a46,0x9d7927e222d7273b,0xa1c2277720a527a8,0xa7f19bd6a6dd241d,0xa7ce9f03a70e238b,0x18b5a7faa4c4a66d,0x18b5a7faa513a62f,0x27ff124825eda55f
.quad 0x27fa98b52513a62f,0x124827ff25ed255f,0x1f0327ce270e238b,0xa7fa18b5a4c4266d,0xa77721c2a0a527a8,0x9bd6a7f1a6dda41d,0xa3e3a6f6a7f69a46,0x27e29d7922d7a73b,0x264fa4ec9a46a7f6,0x1f0327ce27882164,0x25cb258427a8a0a5,0xa7b620449fc627c3,0xa49b268a238b270e,0xa105a799a7ea9cb2,0xa725a332a62f2513,0x2777a1c21648a7fe
.quad 0x2105a799a62fa513,0x227c275027fe9648,0x27e21d79238ba70e,0xa72523321cb227ea,0x924827ff27a820a5,0xa3e3a6f6a7c31fc6,0xa7f11bd69a4627f6,0x26c2a448a164a788,0xa044a7b6a7f61a46,0x249b268a273ba2d7,0x2750a27ca0a5a7a8,0xa64f24ec241d26dd,0x244826c2270ea38b,0xa53aa60fa66d24c4,0xa60f253a2513262f,0x25cba584a55fa5ed
.quad 0xa5cb2584a5a825a8,0xa60f253aa5ed255f,0xa53aa60fa5a8a5a8,0xa448a6c2a4c4a66d,0x264fa4ec25a8a5a8,0x2750a27c26dda41d,0x249b268a25a825a8,0x204427b622d7273b,0xa6c22448a5a825a8,0xa7f11bd6a7882164,0xa3e3a6f6a5a8a5a8,0x1248a7ff9fc6a7c3,0x2725a33225a8a5a8,0x27e21d7927ea9cb2,0x227c275025a825a8,0xa1052799164827fe
.quad 0xa77721c2a5a825a8,0xa725a332a7fe9648,0xa105a799a5a8a5a8,0x249ba68a1cb2a7ea,0x27b6a04425a8a5a8,0x25cb258427c31fc6,0x1f0327ce25a825a8,0xa64f24eca1642788,0xa7e21d79a5a825a8,0xa3e3a6f6a73ba2d7,0x9bd6a7f1a5a8a5a8,0x2777a1c2241da6dd,0x27fa98b525a8a5a8,0x1f0327ce266d24c4,0x124827ff25a825a8,0xa7fa18b5a55f25ed
.quad 0xa7ff9248a5a825a8,0x18b5a7faa55fa5ed,0x18b5a7faa5a8a5a8,0x27ce1f03266da4c4,0x27f11bd625a8a5a8,0xa1c22777241d26dd,0x9d7927e225a825a8,0xa6f6a3e3a73b22d7,0xa7ce9f03a5a825a8,0x24eca64fa164a788,0x2044a7b6a5a8a5a8,0x258425cb27c39fc6,0x2799210525a8a5a8,0xa68a249b1cb227ea,0xa1c2277725a825a8,0xa332a725a7fe1648
.quad 0xa750a27ca5a825a8,0x2799a1051648a7fe,0x2332a725a5a8a5a8,0x1d7927e227ea1cb2,0x26f623e325a8a5a8,0xa7ff12489fc627c3,0xa44826c225a825a8,0x1bd6a7f1a788a164,0xa68aa49ba5a825a8,0x27b6204422d7a73b,0x24eca64fa5a8a5a8,0xa27c275026dd241d,0x260f253a25a8a5a8,0xa6c2a448a4c4266d,0xa58425cb25a825a8,0x253aa60fa5eda55f
.quad 0xa64f24eca62f2513,0xa68a249ba66d24c4,0xa27ca750a38ba70e,0xa044a7b6a164a788,0x27e29d7927a8a0a5,0x27fa18b527fe9648,0x98b527fa1a4627f6,0xa27c27509fc627c3,0xa799a105a7f69a46,0xa5cba584a6dda41d,0x2448a6c220a5a7a8,0x2725a33225eda55f,0x258425cb270e238b,0x1bd627f122d7273b,0xa6f623e3a513262f,0xa7ce9f03a7ea1cb2
.quad 0xa044a7b6a513a62f,0x2448a6c21cb2a7ea,0x27ff9248270ea38b,0x24ec264f273b22d7,0x9f0327ce20a527a8,0xa7992105a55f25ed,0xa725a332a7f61a46,0x1248a7ffa41da6dd,0x253aa60f1a46a7f6,0x277721c227c39fc6,0x249b268a27a820a5,0xa53a260f964827fe,0xa77721c2a38b270e,0xa3e3a6f6a788a164,0x9bd6a7f1a62fa513,0x27e29d7924c4a66d
.quad 0x27f11bd6262fa513,0x9d7927e224c4266d,0xa1c22777238b270e,0xa6f6a3e3a7882164,0xa68aa49ba7a820a5,0x260fa53a9648a7fe,0x260fa53a9a46a7f6,0x21c2277727c31fc6,0x2332272527f61a46,0xa7ff1248a41d26dd,0xa7ce1f03a0a527a8,0x2105a799a55fa5ed,0x1248a7ffa70ea38b,0x264f24ec273ba2d7,0x27b620442513a62f,0xa6c224481cb227ea
.quad 0xa3e326f62513262f,0x9f03a7cea7ea9cb2,0xa5cba584a70e238b,0x27f11bd622d7a73b,0x26c2a448a0a5a7a8,0xa332272525ed255f,0x2105279927f69a46,0xa584a5cba6dd241d,0xa7fa18b59a4627f6,0x2750a27c9fc6a7c3,0x1d79a7e2a7a8a0a5,0x18b527fa27fe1648,0x2750227c238ba70e,0xa7b6a044a1642788,0xa4ec264f262f2513,0x249ba68aa66da4c4
.quad 0xa6c22448a6a72472,0xa6f623e3a6dd241d,0x9bd6a7f19e3ea7d9,0x1248a7ff9648a7fe,0x2799210527d91e3e,0x26c22448273b22d7,0xa58425cba47226a7,0xa7252332a66d24c4,0xa1c2a777a472a6a7,0x18b5a7fa9cb2a7ea,0x27fa18b527d99e3e,0x268a249b27882164,0xa3e326f69e3e27d9,0xa750227ca5ed255f,0xa49ba68aa6a7a472,0x1bd6a7f19fc6a7c3
.quad 0x27e29d7926a7a472,0x264f24ec27c31fc6,0xa04427b61e3e27d9,0xa77721c2a55f25ed,0xa60fa53aa7d99e3e,0x1d79a7e2a164a788,0x2750a27c2472a6a7,0x260f253a27ea1cb2,0x924827ff247226a7,0xa7992105a4c4266d,0xa725a332a7d91e3e,0x1f03a7cea2d7a73b,0x264fa4ec1e3ea7d9,0x25cb258427fe1648,0x1f0327ce26a72472,0xa7b62044a41d26dd
.quad 0xa7ce9f03a6a72472,0x2044a7b6a41da6dd,0x24eca64f9e3ea7d9,0x258425cb27fe9648,0x2332272527d91e3e,0xa7ce1f03a2d7273b,0xa7ff1248a47226a7,0x2105a799a4c4a66d,0x227ca750a472a6a7,0x253a260f27ea9cb2,0x253a260f27d99e3e,0xa7e21d79a1642788,0xa7b620449e3e27d9,0x21c2a777a55fa5ed,0x1d79a7e2a6a7a472,0x24ec264f27c39fc6
.quad 0x268a249b26a7a472,0xa7f11bd69fc627c3,0xa6f623e31e3e27d9,0x227ca750a5eda55f,0x98b5a7faa7d99e3e,0x249b268a2788a164,0x277721c22472a6a7,0xa7fa18b59cb227ea,0xa5cb2584247226a7,0x2332a725a66da4c4,0xa105a799a7d91e3e,0x244826c2273ba2d7,0x27f11bd61e3ea7d9,0xa7ff1248964827fe,0xa44826c226a72472,0x23e3a6f6a6dda41d
.quad 0xa7252332a70e238b,0xa750227ca73b22d7,0x1d79a7e21a46a7f6,0x2105a7991fc6a7c3,0x258425cb262f2513,0x23e326f624c4266d,0xa7f11bd6a7a820a5,0xa7ce9f03a7fe9648,0x23e3a6f620a5a7a8,0x268aa49b255fa5ed,0x227c27502513262f,0x9bd627f11cb227ea,0xa7ce9f03a7f61a46,0xa53aa60fa6dda41d,0x260fa53a238ba70e,0x27ff12482788a164
.quad 0x18b527fa238b270e,0xa58425cba1642788,0xa6c2a448a7f69a46,0x98b5a7faa41da6dd,0x2777a1c22513a62f,0x264f24ec27ea1cb2,0xa04427b620a527a8,0xa7e21d79a5ed255f,0xa4eca64fa7a8a0a5,0x2448a6c29648a7fe,0x27ff9248262fa513,0x204427b6266d24c4,0xa49b268a1a4627f6,0xa725a332a7c31fc6,0xa105a799a70ea38b,0x2777a1c222d7a73b
.quad 0x27992105270ea38b,0xa1c2277722d7273b,0xa68a249b9a4627f6,0xa332a725a7c39fc6,0x1248a7ffa62fa513,0x27b62044266da4c4,0x264f24ec27a8a0a5,0xa6c22448964827fe,0xa7b62044a0a527a8,0x1d79a7e2a5eda55f,0x21c2a777a513a62f,0x24ec264f27ea9cb2,0x244826c227f69a46,0xa7fa98b5a41d26dd,0xa7fa98b5a38b270e,0x25cba584a164a788
.quad 0x253aa60fa38ba70e,0x124827ff27882164,0x1f0327ce27f61a46,0xa60fa53aa6dd241d,0xa750a27ca513262f,0x27f19bd61cb2a7ea,0x26f6a3e3a0a5a7a8,0xa49b268a255f25ed,0x9bd627f127a820a5,0x9f03a7cea7fe1648,0xa5cba584a62f2513,0x26f623e324c4a66d,0x27e29d799a46a7f6,0xa79921051fc627c3,0xa3322725270e238b,0x227ca750a73ba2d7
.quad 0xa77721c2a764221f,0xa7992105a7882164,0x2332a725221fa764,0x249ba68a241da6dd,0x204427b6221f2764,0x124827ff1cb227ea,0xa6c2a448a764a21f,0xa4eca64fa5eda55f,0x27e29d792764a21f,0x27b6204427fe1648,0xa4ec264fa21f2764,0xa77721c2a66d24c4,0x98b5a7faa21fa764,0x2448a6c21fc6a7c3,0x25cb25842764221f,0x18b527fa22d7273b
.quad 0xa7ff9248a764221f,0xa53aa60fa73ba2d7,0x260fa53a221fa764,0x27ce1f0327c39fc6,0x9bd627f1221f2764,0xa750227ca4c4266d,0xa49ba68aa764a21f,0x23e3a6f69648a7fe,0x27ce1f032764a21f,0x1bd627f1255f25ed,0xa6f623e3a21f2764,0xa584a5cba7ea9cb2,0x2105a799a21fa764,0x27e21d7926dda41d,0x227c27502764221f,0xa7252332a1642788
.quad 0xa750a27ca764221f,0x2332a725a164a788,0x2799a105221fa764,0x1d7927e226dd241d,0xa3e326f6221f2764,0xa5cba584a7ea1cb2,0x9f03a7cea764a21f,0x27f11bd6255fa5ed,0x268a249b2764a21f,0xa6f623e3964827fe,0xa7f11bd6a21f2764,0x227ca750a4c4a66d,0x253aa60fa21fa764,0x1f0327ce27c31fc6,0x124827ff2764221f,0xa60fa53aa73b22d7
.quad 0xa584a5cba764221f,0x27fa18b522d7a73b,0x27fa18b5221fa764,0xa6c224481fc627c3,0xa64f24ec221f2764,0x21c2a777a66da4c4,0x1d79a7e2a764a21f,0x204427b627fe9648,0x244826c22764a21f,0xa64fa4eca5ed255f,0xa7b6a044a21f2764,0x27ff12481cb2a7ea,0x2725a332a21fa764,0xa68a249b241d26dd,0xa1c227772764221f,0x2105a799a788a164
.quad 0xa7b62044a7a820a5,0xa7ce1f03a7c31fc6,0x2584a5cb2513a62f,0x264fa4ec25eda55f,0x9f0327ce9a4627f6,0xa3322725a1642788,0xa105a799a38ba70e,0x1248a7ff9cb2a7ea,0x260f253a270e238b,0x227c275024c4266d,0xa7e29d79a7f61a46,0xa60fa53aa73ba2d7,0x2777a1c2262fa513,0x27b6204427fe9648,0xa4ec264fa0a527a8,0xa7e21d79a6dd241d
.quad 0x1bd6a7f1a0a5a7a8,0x268aa49b241da6dd,0x227c2750262f2513,0xa3e326f6964827fe,0xa68aa49ba7f69a46,0x18b5a7faa2d7a73b,0x27fa18b5270ea38b,0x21c22777266d24c4,0xa7252332a38b270e,0xa5cba584a7ea9cb2,0x2448a6c29a46a7f6,0x279921052788a164,0x924827ff2513262f,0xa7f11bd6a55f25ed,0xa3e3a6f6a7a8a0a5,0x26c2a4481fc6a7c3
.quad 0x26f623e327a8a0a5,0xa44826c21fc627c3,0xa7ff1248a513262f,0x1bd6a7f1a55fa5ed,0x26c2a4481a46a7f6,0x2105279927882164,0xa3322725238b270e,0xa584a5cba7ea1cb2,0x98b5a7faa70ea38b,0x277721c2266da4c4,0x249b268a27f69a46,0xa7fa18b5a2d7273b,0xa750a27ca62f2513,0x26f6a3e39648a7fe,0x27f19bd620a5a7a8,0xa49b268a241d26dd
.quad 0xa64f24ec20a527a8,0x1d79a7e2a6dda41d,0x21c2a777a62fa513,0x204427b627fe1648,0x1d7927e227f61a46,0xa53aa60fa73b22d7,0xa53aa60fa70e238b,0x2750227c24c4a66d,0x27992105238ba70e,0xa7ff12489cb227ea,0xa7ce1f031a4627f6,0x2725a332a164a788,0x25cba584a513a62f,0xa4ec264f25ed255f,0xa04427b627a820a5,0x1f03a7cea7c39fc6
.quad 0xa7e21d79a7d91e3e,0xa7f11bd6a7ea1cb2,0x26f6a3e326a7a472,0x2777a1c2273ba2d7,0xa53a260fa47226a7,0xa68a249ba5ed255f,0x21c2a7771e3ea7d9,0x253aa60f241da6dd,0x924827ff1e3e27d9,0xa33227259fc627c3,0xa105a799a472a6a7,0x1f03a7ce9648a7fe,0x24ec264f26a72472,0x124827ff21642788,0xa6c2a448a7d99e3e,0xa044a7b6a4c4a66d
.quad 0x27ce1f0327d99e3e,0x23e326f6266d24c4,0xa7f11bd6a6a72472,0xa584a5cba788a164,0x2725a3322472a6a7,0x26c2244827fe1648,0xa58425cb9e3e27d9,0xa799a105a7c31fc6,0x227ca7509e3ea7d9,0x27fa18b526dda41d,0x98b527fa247226a7,0xa7e21d79a55f25ed,0xa044a7b6a6a7a472,0x2750a27c22d7a73b,0x249b268a27d91e3e,0xa64f24ec9cb227ea
.quad 0xa68aa49ba7d91e3e,0x24eca64f9cb2a7ea,0x27b6204426a7a472,0xa27c275022d7273b,0xa7fa18b5a47226a7,0x1d79a7e2a55fa5ed,0x2750a27c1e3ea7d9,0x18b527fa26dd241d,0xa5cb25841e3e27d9,0xa105a799a7c39fc6,0x2332a725a472a6a7,0x244826c227fe9648,0x9bd627f126a72472,0xa5cba584a7882164,0x9f03a7cea7d99e3e,0x26f623e3266da4c4
.quad 0x244826c227d99e3e,0xa7b6a044a4c4266d,0xa64fa4eca6a72472,0x27ff12482164a788,0x279921052472a6a7,0xa7ce1f03964827fe,0xa7ff12489e3e27d9,0x2725a3329fc6a7c3,0x2777a1c29e3ea7d9,0xa60f253a241d26dd,0xa60f253a247226a7,0x249ba68aa5eda55f,0x23e3a6f6a6a7a472,0xa1c22777273b22d7,0x9d7927e227d91e3e,0x1bd6a7f1a7ea9cb2
.quad 0xa7fa18b5a7f61a46,0xa7ff1248a7fe1648,0x27ce9f0327a8a0a5,0x27fa98b527ea9cb2,0xa77721c2a70e238b,0xa7f11bd6a7c31fc6,0x26f6a3e3262fa513,0x27e29d792788a164,0xa64f24eca513262f,0xa7ce1f03a73b22d7,0x2584a5cb238ba70e,0x27b6a04426dda41d,0xa49b268aa0a527a8,0xa7992105a66d24c4,0x2332a7251a46a7f6,0x2777a1c225eda55f
.quad 0xa10527991a4627f6,0xa750227ca55f25ed,0x1d79a7e2a0a5a7a8,0x2725a33224c4a66d,0x924827ff238b270e,0xa6f623e3a41d26dd,0x9bd6a7f1a513a62f,0x26c2a44822d7a73b,0x204427b6262f2513,0xa68a249ba1642788,0xa27ca750a70ea38b,0x264fa4ec1fc6a7c3,0x244826c227a820a5,0xa60f253a9cb227ea,0xa53aa60fa7f69a46,0x25cba5841648a7fe
.quad 0x260f253a27f69a46,0xa58425cb164827fe,0xa6c2a448a7a820a5,0x253aa60f9cb2a7ea,0x2750227c270ea38b,0xa4ec264f1fc627c3,0xa7b6a044a62f2513,0x249ba68aa164a788,0x27f11bd62513a62f,0xa44826c222d7273b,0xa7ff1248a38b270e,0x23e3a6f6a41da6dd,0x27e29d7920a5a7a8,0xa332272524c4266d,0xa79921059a4627f6,0x227ca750a55fa5ed
.quad 0x2725a3329a46a7f6,0xa1c2277725ed255f,0xa68a249b20a527a8,0x2105a799a66da4c4,0x25cba584a38ba70e,0xa04427b626dd241d,0xa4ec264f2513262f,0x1f03a7cea73ba2d7,0x23e3a6f6a62fa513,0x9d7927e227882164,0xa1c22777270e238b,0x1bd6a7f1a7c39fc6,0x1f03a7cea7a8a0a5,0x98b527fa27ea1cb2,0x98b527fa27f61a46,0x1248a7ffa7fe9648
.quad 0xa7ff9248a8002800,0x27fa18b51648a7fe,0xa7fa98b528002800,0x27ce1f031cb2a7ea,0xa7f19bd6a8002800,0x277721c21fc6a7c3,0xa7e29d7928002800,0x26f623e32164a788,0xa7ce9f03a8002800,0x264f24ec22d7a73b,0xa7b6a04428002800,0x258425cb241da6dd,0xa799a105a8002800,0x249b268a24c4a66d,0xa777a1c228002800,0x23322725255fa5ed
.quad 0xa750a27ca8002800,0x2105279925eda55f,0xa725a33228002800,0x1d7927e2266da4c4,0xa6f6a3e3a8002800,0x124827ff26dda41d,0xa6c2a44828002800,0x9bd627f1273ba2d7,0xa68aa49ba8002800,0xa04427b62788a164,0xa64fa4ec28002800,0xa27c275027c39fc6,0xa60fa53aa8002800,0xa44826c227ea9cb2,0xa5cba58428002800,0xa53a260f27fe9648
.quad 0xa584a5cba8002800,0xa60f253a27fe1648,0xa53aa60f28002800,0xa6c2244827ea1cb2,0xa4eca64fa8002800,0xa750227c27c31fc6,0xa49ba68a28002800,0xa7b6204427882164,0xa448a6c2a8002800,0xa7f11bd6273b22d7,0xa3e3a6f628002800,0xa7ff924826dd241d,0xa332a725a8002800,0xa7e29d79266d24c4,0xa27ca75028002800,0xa799a10525ed255f
.quad 0xa1c2a777a8002800,0xa725a332255f25ed,0xa105a79928002800,0xa68aa49b24c4266d,0xa044a7b6a8002800,0xa5cba584241d26dd,0x9f03a7ce28002800,0xa4eca64f22d7273b,0x9d79a7e2a8002800,0xa3e3a6f621642788,0x9bd6a7f128002800,0xa1c2a7771fc627c3,0x98b5a7faa8002800,0x9f03a7ce1cb227ea,0x9248a7ff28002800,0x98b5a7fa164827fe
.quad 0xa7f19bd69a4627f6,0x27e21d791cb2a7ea,0xa777a1c2a0a527a8,0x26f623e322d7a73b,0xa68aa49ba38b270e,0x253a260f255fa5ed,0xa53aa60fa513262f,0x21c2277726dda41d,0xa332a725a62f2513,0x124827ff27c39fc6,0x9f03a7cea70e238b,0xa105279927fe1648,0x1248a7ffa7a820a5,0xa4ec264f27882164,0x2044a7b6a7f61a46,0xa6c22448266d24c4
.quad 0x23e3a6f6a7f69a46,0xa7ce1f0324c4266d,0x2584a5cba7a8a0a5,0xa7f19bd621642788,0x26c2a448a70ea38b,0xa725a332164827fe,0x2799a105a62fa513,0xa584a5cb9fc627c3,0x27fa98b5a513a62f,0xa27ca750a41d26dd,0x27e21d79a38ba70e,0x98b5a7faa5ed255f,0x2750227ca0a5a7a8,0x2044a7b6a73b22d7,0x264f24ec9a46a7f6,0x249ba68aa7ea1cb2
.quad 0x24ec264f1a46a7f6,0x268aa49ba7ea9cb2,0x227c275020a5a7a8,0x27b6a044a73ba2d7,0x1d7927e2238ba70e,0x27fa18b5a5eda55f,0x98b527fa2513a62f,0x2750227ca41da6dd,0xa1052799262fa513,0x25cb25849fc6a7c3,0xa44826c2270ea38b,0x233227251648a7fe,0xa5cb258427a8a0a5,0x1bd627f12164a788,0xa6f623e327f69a46,0x9f0327ce24c4a66d
.quad 0xa7b6204427f61a46,0xa44826c2266da4c4,0xa7ff124827a820a5,0xa64f24ec2788a164,0xa7ce9f03270e238b,0xa799210527fe9648,0xa725a332262f2513,0xa7ff924827c31fc6,0xa60fa53a2513262f,0xa777a1c226dd241d,0xa49ba68a238b270e,0xa60fa53a255f25ed,0xa1c2a77720a527a8,0xa3e3a6f622d7273b,0x9bd6a7f11a4627f6,0x9d79a7e21cb227ea
.quad 0xa7ce9f039e3e27d9,0x27b620441fc6a7c3,0xa64fa4eca47226a7,0x258425cb255fa5ed,0xa332a725a6a72472,0x1f0327ce2788a164,0x9248a7ffa7d91e3e,0xa105279927ea1cb2,0x227ca750a7d99e3e,0xa60f253a266d24c4,0x260fa53aa6a7a472,0xa7e21d7922d7273b,0x27b6a044a472a6a7,0xa777a1c2964827fe,0x27e21d799e3ea7d9,0xa4eca64fa41d26dd
.quad 0x268a249b1e3ea7d9,0x9bd6a7f1a6dd241d,0x23e326f62472a6a7,0x227ca750a7fe1648,0x18b527fa26a7a472,0x268aa49ba73ba2d7,0xa1c2277727d99e3e,0x27fa98b5a4c4a66d,0xa5cb258427d91e3e,0x272523329cb2a7ea,0xa799210526a72472,0x244826c22164a788,0xa7f19bd6247226a7,0x124827ff25eda55f,0xa6c2a4481e3e27d9,0xa3e326f627c39fc6
.quad 0xa448a6c29e3e27d9,0xa6f623e327c31fc6,0x9bd6a7f1a47226a7,0xa7ff924825ed255f,0x2105a799a6a72472,0xa6c2a44821642788,0x2584a5cba7d91e3e,0xa332a7259cb227ea,0x2777a1c2a7d99e3e,0x18b5a7faa4c4266d,0x27fa18b5a6a7a472,0x249ba68aa73b22d7,0x26f623e3a472a6a7,0x2750a27ca7fe9648,0x249b268a9e3ea7d9,0x27f11bd6a6dda41d
.quad 0x1d7927e21e3ea7d9,0x264f24eca41da6dd,0xa04427b62472a6a7,0x21c227779648a7fe,0xa53a260f26a7a472,0x9d7927e222d7a73b,0xa750227c27d99e3e,0xa53a260f266da4c4,0xa7ff924827d91e3e,0xa799210527ea9cb2,0xa725a33226a72472,0xa7ce9f0327882164,0xa4eca64f247226a7,0xa5cba584255f25ed,0x9f03a7ce1e3e27d9,0xa044a7b61fc627c3
.quad 0xa799a105a0a527a8,0x277721c22164a788,0xa49ba68aa62f2513,0x2332272526dda41d,0x1248a7ffa7f61a46,0xa04427b627ea1cb2,0x24eca64fa70ea38b,0xa6c22448255f25ed,0x27b6a044a38ba70e,0xa7e29d79164827fe,0x277721c21a46a7f6,0xa4eca64fa4c4266d,0x244826c22513a62f,0x18b5a7faa7c31fc6,0x98b527fa27a8a0a5,0x25cba584a73ba2d7
.quad 0xa53a260f27a820a5,0x27ff9248a2d7a73b,0xa7ce1f032513262f,0x260f253a1fc6a7c3,0xa750a27c1a4627f6,0x1bd627f1266da4c4,0xa3e3a6f6a38b270e,0xa49b268a27fe1648,0x1bd6a7f1a70e238b,0xa7ce1f0325ed255f,0x2584a5cba7f69a46,0xa6f6a3e31cb227ea,0x27e29d79a62fa513,0xa105a799a41d26dd,0x27252332a0a5a7a8,0x227ca750a7882164
.quad 0x2332272520a5a7a8,0x2750a27ca788a164,0x9d7927e2262fa513,0x27992105a41da6dd,0xa5cb258427f69a46,0x23e326f61cb2a7ea,0xa7f11bd6270e238b,0x9f0327ce25eda55f,0xa6f6a3e3238b270e,0xa68a249b27fe9648,0xa27ca7509a4627f6,0xa7f19bd6266d24c4,0x1f03a7cea513262f,0xa53aa60f1fc627c3,0x260fa53aa7a820a5,0x1248a7ffa2d7273b
.quad 0x27fa98b5a7a8a0a5,0x2584a5cba73b22d7,0x26c22448a513a62f,0x27fa98b5a7c39fc6,0x21c227779a46a7f6,0x264f24eca4c4a66d,0xa04427b6238ba70e,0x1d7927e21648a7fe,0xa64f24ec270ea38b,0xa44826c2255fa5ed,0xa7ff124827f61a46,0xa7b6204427ea9cb2,0xa68aa49b262f2513,0xa725a33226dd241d,0xa105a79920a527a8,0xa1c2a77721642788
.quad 0xa750a27ca21f2764,0x2725233222d7a73b,0xa105a799a764221f,0x1d7927e227c39fc6,0x23e3a6f6a764a21f,0xa58425cb266d24c4,0x27ce9f03a21fa764,0xa7f19bd6164827fe,0x268a249b221fa764,0xa3e3a6f6a5ed255f,0x1bd627f12764a21f,0x227ca750a7ea9cb2,0xa53a260f2764221f,0x27ce9f03a41da6dd,0xa7ff1248221f2764,0x260f253a2164a788
.quad 0xa584a5cba21f2764,0x98b527fa2788a164,0x18b5a7faa764221f,0xa6c2244826dd241d,0x264fa4eca764a21f,0xa777a1c21cb227ea,0x27e21d79a21fa764,0xa044a7b6a55f25ed,0x244826c2221fa764,0x24eca64fa7fe9648,0xa04427b62764a21f,0x27ff1248a4c4a66d,0xa72523322764221f,0x249b268a1fc6a7c3,0xa777a1c2221f2764,0xa1052799273ba2d7
.quad 0xa1c2a777a21f2764,0xa7992105273b22d7,0x2332a725a764221f,0xa68aa49b1fc627c3,0x27b6a044a764a21f,0x9248a7ffa4c4266d,0x26c22448a21fa764,0x264fa4eca7fe1648,0x1d7927e2221fa764,0x27b62044a55fa5ed,0xa4ec264f2764a21f,0x21c227771cb2a7ea,0xa7fa18b52764221f,0xa44826c226dda41d,0xa5cba584221f2764,0xa7fa18b527882164
.quad 0x1248a7ffa21f2764,0xa53aa60f21642788,0x260fa53aa764221f,0x1f03a7cea41d26dd,0x27f11bd6a764a21f,0x2750a27ca7ea1cb2,0x249b268aa21fa764,0x26f623e3a5eda55f,0x9f0327ce221fa764,0x1bd627f11648a7fe,0xa6f623e32764a21f,0xa5cb2584266da4c4,0xa799a1052764221f,0xa7e29d7927c31fc6,0xa27ca750221f2764,0xa332a72522d7273b
.quad 0xa6f6a3e3a38b270e,0x26c22448241da6dd,0x9248a7ffa7f61a46,0x9bd627f127fe1648,0x26c2a448a513a62f,0xa799210522d7273b,0x2725233220a5a7a8,0xa584a5cba4c4266d,0x18b527fa27a8a0a5,0x21c2a777a7ea9cb2,0xa68a249b262f2513,0x27fa98b5a164a788,0xa750a27c9a4627f6,0x23e326f6255fa5ed,0x9bd6a7f1a70e238b,0xa49b268a27c31fc6
.quad 0x264fa4eca70ea38b,0xa7e29d791fc627c3,0x277721c29a46a7f6,0xa044a7b6a5ed255f,0x1d7927e2262fa513,0x260fa53aa788a164,0xa60f253a27a820a5,0x2750227c9cb2a7ea,0xa799a10520a527a8,0x124827ff266da4c4,0x9f03a7cea513262f,0xa7252332273b22d7,0x25cba584a7f69a46,0xa64fa4ec164827fe,0x27b62044a38ba70e,0x1f03a7cea6dd241d
.quad 0x204427b6238ba70e,0x27ce9f03a6dda41d,0xa58425cb27f69a46,0x24ec264f1648a7fe,0xa7ce9f032513262f,0xa3322725273ba2d7,0xa105a799a0a527a8,0xa7ff9248266d24c4,0x253aa60fa7a820a5,0xa27ca7509cb227ea,0x27e21d79a62fa513,0x253aa60fa7882164,0x21c227771a46a7f6,0x27b62044a5eda55f,0xa4ec264f270ea38b,0x1d7927e21fc6a7c3
.quad 0xa7f19bd6270e238b,0xa68a249b27c39fc6,0xa27ca7501a4627f6,0xa6f6a3e3255f25ed,0x249ba68aa62f2513,0x18b5a7faa1642788,0x27fa18b5a7a8a0a5,0x2777a1c2a7ea1cb2,0x23322725a0a5a7a8,0x25cb2584a4c4a66d,0xa44826c22513a62f,0xa105279922d7a73b,0xa7ff924827f61a46,0xa7f11bd627fe9648,0xa3e3a6f6238b270e,0xa448a6c2241d26dd
.quad 0xa68aa49ba47226a7,0x264f24ec24c4a66d,0x2044a7b6a7d99e3e,0xa27c275027882164,0x27fa98b59e3ea7d9,0xa7e29d79964827fe,0x227c275026a7a472,0x98b5a7faa7c31fc6,0xa5cb258426a72472,0x2799a105a41da6dd,0xa725a3329e3e27d9,0x244826c2255fa5ed,0x1bd6a7f1a7d91e3e,0xa58425cb273b22d7,0x27ce9f03a472a6a7,0xa6f6a3e39cb227ea
.quad 0x244826c22472a6a7,0x2044a7b6a7ea1cb2,0xa4ec264f27d91e3e,0x27ff1248a2d7a73b,0xa799a1051e3e27d9,0x1f0327ce25eda55f,0x9248a7ffa6a72472,0xa725233226dd241d,0x2777a1c2a6a7a472,0xa53aa60f9fc627c3,0x253a260f1e3ea7d9,0x249ba68aa7fe1648,0xa3e326f627d99e3e,0x277721c2a164a788,0xa7e29d79247226a7,0x9bd627f1266da4c4
.quad 0x9d79a7e2a47226a7,0xa7f11bd6266d24c4,0x26f6a3e3a7d99e3e,0xa1c2a777a1642788,0x260f253a9e3ea7d9,0x268aa49ba7fe9648,0xa1c2277726a7a472,0x260f253a9fc6a7c3,0xa7ff924826a72472,0xa332272526dda41d,0xa105a7999e3e27d9,0xa7ce9f0325ed255f,0x264fa4eca7d91e3e,0x9248a7ffa2d7273b,0x26c22448a472a6a7,0x27b6a044a7ea9cb2
.quad 0x9f0327ce2472a6a7,0x23e326f69cb2a7ea,0xa7f11bd627d91e3e,0xa5cb2584273ba2d7,0xa332a7251e3e27d9,0xa6c2a448255f25ed,0x2584a5cba6a72472,0x2105a799a41d26dd,0x2750227ca6a7a472,0x27fa18b5a7c39fc6,0x98b527fa1e3ea7d9,0x1d7927e29648a7fe,0xa7b6204427d99e3e,0xa750227c2788a164,0xa49ba68a247226a7,0xa4eca64f24c4266d
.quad 0xa60fa53aa513262f,0x25cb2584255fa5ed,0x2448a6c2a70ea38b,0xa53a260f266d24c4,0x2750227c20a5a7a8,0xa64fa4eca41d26dd,0xa04427b627f61a46,0x249ba68aa73ba2d7,0xa7f19bd61a4627f6,0x26c224482164a788,0x9248a7ffa7a820a5,0xa3e326f627c31fc6,0x27e29d79a38ba70e,0xa725a3329cb227ea,0x21052799262fa513,0x227ca750a7fe9648
.quad 0xa7252332262f2513,0x277721c29648a7fe,0xa49ba68aa38b270e,0xa105279927ea9cb2,0x25cba584a7a8a0a5,0xa7b6a0441fc627c3,0x264f24ec1a46a7f6,0x1f03a7cea7882164,0xa3e326f627f69a46,0x27e21d79a2d7a73b,0xa777a1c220a527a8,0x9bd627f126dda41d,0x1f03a7cea70e238b,0xa7fa98b524c4266d,0x27fa18b5a513a62f,0x1248a7ffa5ed255f
.quad 0x18b527fa2513a62f,0x27ff9248a5eda55f,0xa7ce1f03270e238b,0x18b527fa24c4a66d,0xa1c2a777a0a527a8,0xa7f11bd626dd241d,0x26f6a3e3a7f69a46,0x9d79a7e2a2d7273b,0x24ec264f9a46a7f6,0x27ce9f03a788a164,0xa58425cb27a8a0a5,0x204427b61fc6a7c3,0xa68aa49b238b270e,0xa799210527ea1cb2,0x2332a725a62f2513,0xa1c2a777964827fe
.quad 0x27992105a62fa513,0x2750a27ca7fe1648,0x9d7927e2238ba70e,0x233227259cb2a7ea,0xa7ff924827a820a5,0xa6f623e327c39fc6,0x9bd6a7f19a4627f6,0xa448a6c221642788,0x27b6a044a7f61a46,0x268aa49ba73b22d7,0x227c2750a0a5a7a8,0x24ec264fa41da6dd,0xa6c22448270ea38b,0xa60f253a266da4c4,0xa53aa60f2513262f,0xa584a5cb255f25ed
.quad 0xa584a5cba5a825a8,0x253a260f25eda55f,0x260fa53aa5a8a5a8,0xa6c2244824c4266d,0x24ec264f25a8a5a8,0xa27ca750a6dd241d,0xa68a249b25a825a8,0x27b6a044a2d7a73b,0xa448a6c2a5a825a8,0x1bd627f12788a164,0x26f6a3e3a5a8a5a8,0xa7ff92481fc627c3,0x2332272525a8a5a8,0x1d79a7e2a7ea1cb2,0xa750227c25a825a8,0x279921059648a7fe
.quad 0xa1c2a777a5a825a8,0xa332272527fe1648,0x2799a105a5a8a5a8,0xa68aa49b9cb227ea,0x204427b625a8a5a8,0x2584a5cba7c39fc6,0xa7ce1f0325a825a8,0x24ec264f2164a788,0x9d79a7e2a5a825a8,0xa6f623e3273b22d7,0x27f19bd6a5a8a5a8,0xa1c2a777a41d26dd,0x18b527fa25a8a5a8,0x27ce9f03a66da4c4,0xa7ff124825a825a8,0x18b527fa255fa5ed
.quad 0x1248a7ffa5a825a8,0xa7fa98b5255f25ed,0x27fa18b5a5a8a5a8,0x1f03a7cea66d24c4,0x9bd627f125a8a5a8,0x277721c2a41da6dd,0xa7e29d7925a825a8,0xa3e326f6273ba2d7,0x1f03a7cea5a825a8,0xa64fa4ec21642788,0x27b62044a5a8a5a8,0x25cba584a7c31fc6,0xa105279925a8a5a8,0x249b268a9cb2a7ea,0xa777a1c225a825a8,0xa725233227fe9648
.quad 0x227ca750a5a825a8,0xa105a799964827fe,0x27252332a5a8a5a8,0x27e29d79a7ea9cb2,0xa3e326f625a8a5a8,0x124827ff1fc6a7c3,0xa6c2a44825a825a8,0xa7f19bd627882164,0x249ba68aa5a825a8,0x2044a7b6a2d7273b,0x264f24eca5a8a5a8,0x2750227ca6dda41d,0xa53a260f25a8a5a8,0xa44826c224c4a66d,0xa5cba58425a825a8,0xa60fa53a25ed255f
.quad 0xa4eca64fa62f2513,0x249b268a266da4c4,0x2750a27ca38ba70e,0xa7b6204421642788,0x1d7927e227a8a0a5,0x18b5a7faa7fe1648,0xa7fa98b51a4627f6,0x2750227c1fc6a7c3,0x2105a799a7f69a46,0xa58425cb26dd241d,0x26c2244820a5a7a8,0xa332a725a5ed255f,0xa5cb2584270e238b,0x27f19bd6a2d7a73b,0xa3e3a6f6a513262f,0x9f0327ce27ea9cb2
.quad 0x27b6a044a513a62f,0xa6c2a4489cb227ea,0x124827ff270ea38b,0x264fa4eca73ba2d7,0xa7ce9f0320a527a8,0x21052799255fa5ed,0x2332a725a7f61a46,0xa7ff9248241d26dd,0x260f253a1a46a7f6,0x21c2a777a7c31fc6,0xa68a249b27a820a5,0x260f253a1648a7fe,0xa1c2a777a38b270e,0xa6f623e327882164,0x27f19bd6a62fa513,0x9d79a7e2a4c4266d
.quad 0x9bd627f1262fa513,0x27e21d79a4c4a66d,0xa777a1c2238b270e,0xa3e326f62788a164,0x249ba68aa7a820a5,0xa53aa60f164827fe,0x253a260f9a46a7f6,0x2777a1c2a7c39fc6,0xa725233227f61a46,0x124827ff241da6dd,0x9f03a7cea0a527a8,0xa799a105255f25ed,0x27ff1248a70ea38b,0x24eca64fa73b22d7,0xa04427b62513a62f,0x244826c29cb2a7ea
.quad 0xa6f6a3e32513262f,0xa7ce1f0327ea1cb2,0x2584a5cba70e238b,0x1bd6a7f1a2d7273b,0x244826c2a0a5a7a8,0x27252332a5eda55f,0xa799210527f69a46,0xa5cb258426dda41d,0x98b5a7fa9a4627f6,0xa27ca7501fc627c3,0x27e21d79a7a8a0a5,0x27fa98b5a7fe9648,0xa27c2750238ba70e,0xa04427b62164a788,0xa64fa4ec262f2513,0xa68aa49b266d24c4
.quad 0xa448a6c2a6a72472,0x23e326f626dda41d,0x27f19bd69e3ea7d9,0xa7ff9248164827fe,0xa105279927d91e3e,0x2448a6c2a73ba2d7,0xa5cba584a47226a7,0x23322725266da4c4,0x2777a1c2a472a6a7,0xa7fa98b51cb227ea,0x98b527fa27d99e3e,0x249ba68aa788a164,0xa6f6a3e39e3e27d9,0x227c275025eda55f,0x268aa49ba6a7a472,0xa7f19bd61fc627c3
.quad 0x1d7927e226a7a472,0x24eca64fa7c39fc6,0xa7b6a0441e3e27d9,0x21c22777255fa5ed,0x253aa60fa7d99e3e,0xa7e29d7921642788,0x227c27502472a6a7,0x253aa60fa7ea9cb2,0xa7ff9248247226a7,0x2105279924c4a66d,0x2332a725a7d91e3e,0xa7ce9f0322d7273b,0x24ec264f1e3ea7d9,0x2584a5cba7fe9648,0xa7ce1f0326a72472,0x204427b6241da6dd
.quad 0x1f03a7cea6a72472,0xa7b6a044241d26dd,0x264f24ec9e3ea7d9,0x25cba584a7fe1648,0xa725233227d91e3e,0x1f0327ce22d7a73b,0x9248a7ffa47226a7,0xa799a10524c4266d,0x2750227ca472a6a7,0x260fa53aa7ea1cb2,0xa60f253a27d99e3e,0x1d7927e22164a788,0xa044a7b69e3e27d9,0xa777a1c2255f25ed,0x27e21d79a6a7a472,0x264fa4eca7c31fc6
.quad 0xa49b268a26a7a472,0x1bd627f11fc6a7c3,0xa3e3a6f61e3e27d9,0xa750a27c25ed255f,0x27fa98b5a7d99e3e,0x268aa49ba7882164,0xa1c227772472a6a7,0x18b527fa1cb2a7ea,0xa584a5cb247226a7,0xa725a332266d24c4,0x2799a105a7d91e3e,0x26c2a448a73b22d7,0x9bd627f11e3ea7d9,0x124827ff1648a7fe,0xa6c2a44826a72472,0xa6f6a3e326dd241d
.quad 0xa332a725a70e238b,0x227c2750273ba2d7,0x27e21d791a46a7f6,0xa799a1059fc627c3,0xa5cb2584262f2513,0x26f6a3e3a4c4a66d,0x9bd6a7f1a7a820a5,0x9f0327ce27fe1648,0x26f623e320a5a7a8,0xa49ba68aa55f25ed,0xa750227c2513262f,0x27f11bd69cb2a7ea,0x1f03a7cea7f61a46,0xa60f253a26dd241d,0x253a260f238ba70e,0x1248a7ffa7882164
.quad 0xa7fa18b5238b270e,0x25cb25842164a788,0x2448a6c2a7f69a46,0xa7fa18b5241d26dd,0x21c227772513a62f,0x24eca64fa7ea9cb2,0xa7b6a04420a527a8,0x1d7927e225eda55f,0x264fa4eca7a8a0a5,0xa6c2a448164827fe,0x124827ff262fa513,0x27b6a044a66da4c4,0xa68aa49b1a4627f6,0xa332272527c39fc6,0x2799a105a70ea38b,0xa1c2a777a2d7273b
.quad 0xa1052799270ea38b,0x277721c2a2d7a73b,0xa49ba68a9a4627f6,0xa725233227c31fc6,0x27ff1248a62fa513,0x2044a7b6a66d24c4,0xa4ec264f27a8a0a5,0x244826c21648a7fe,0xa044a7b6a0a527a8,0xa7e29d7925ed255f,0x277721c2a513a62f,0x264fa4eca7ea1cb2,0xa6c2244827f69a46,0x98b527fa241da6dd,0x18b5a7faa38b270e,0xa584a5cb21642788
.quad 0x260f253aa38ba70e,0x27ff9248a788a164,0xa7ce1f0327f61a46,0xa53a260f26dda41d,0x227ca750a513262f,0x9bd6a7f19cb227ea,0x23e326f6a0a5a7a8,0x268a249ba55fa5ed,0xa7f19bd627a820a5,0xa7ce1f0327fe9648,0x2584a5cba62f2513,0x23e3a6f6a4c4266d,0x1d7927e29a46a7f6,0x210527999fc6a7c3,0xa725a332270e238b,0xa750a27c273b22d7
.quad 0xa1c2a777a764221f,0x210527992788a164,0x27252332221fa764,0xa68aa49ba41d26dd,0xa7b62044221f2764,0x27ff92489cb2a7ea,0x2448a6c2a764a21f,0xa64f24ec25ed255f,0x1d7927e22764a21f,0x2044a7b6a7fe9648,0xa64fa4eca21f2764,0x21c22777266da4c4,0x27fa98b5a21fa764,0xa6c2a4489fc627c3,0xa58425cb2764221f,0x27fa98b5a2d7a73b
.quad 0x1248a7ffa764221f,0xa60f253a273b22d7,0x253a260f221fa764,0x1f03a7cea7c31fc6,0xa7f19bd6221f2764,0x227c275024c4a66d,0x268aa49ba764a21f,0xa6f6a3e3164827fe,0x9f0327ce2764a21f,0x27f19bd6a55fa5ed,0xa3e3a6f6a21f2764,0xa5cb258427ea1cb2,0x27992105a21fa764,0x1d79a7e2a6dd241d,0xa750227c2764221f,0x233227252164a788
.quad 0x227ca750a764221f,0xa725a33221642788,0x21052799221fa764,0x27e29d79a6dda41d,0xa6f6a3e3221f2764,0xa58425cb27ea9cb2,0x27ce9f03a764a21f,0x1bd6a7f1a55f25ed,0xa49b268a2764a21f,0x23e326f61648a7fe,0x9bd6a7f1a21f2764,0xa750a27c24c4266d,0x260f253aa21fa764,0x27ce9f03a7c39fc6,0xa7ff12482764221f,0xa53a260f273ba2d7
.quad 0x25cba584a764221f,0x18b5a7faa2d7273b,0x98b527fa221fa764,0x244826c29fc6a7c3,0xa4eca64f221f2764,0xa777a1c2266d24c4,0x27e21d79a764a21f,0x27b6a044a7fe1648,0xa6c224482764a21f,0xa4ec264f25eda55f,0x2044a7b6a21f2764,0x1248a7ff9cb227ea,0x23322725a21fa764,0x249b268aa41da6dd,0xa777a1c22764221f,0xa799a10527882164
.quad 0xa044a7b6a7a820a5,0x1f0327ce27c39fc6,0x25cb25842513a62f,0xa4eca64fa5ed255f,0xa7ce9f039a4627f6,0x272523322164a788,0x2799a105a38ba70e,0xa7ff92481cb227ea,0xa53a260f270e238b,0x2750a27ca4c4a66d,0x1d79a7e2a7f61a46,0xa53a260f273b22d7,0x21c22777262fa513,0x2044a7b6a7fe1648,0xa64fa4eca0a527a8,0x1d7927e226dda41d
.quad 0x27f11bd6a0a5a7a8,0xa49ba68aa41d26dd,0xa750227c262f2513,0x26f623e31648a7fe,0x249ba68aa7f69a46,0xa7fa98b522d7273b,0x98b527fa270ea38b,0x2777a1c2a66da4c4,0xa332a725a38b270e,0xa58425cb27ea1cb2,0x26c224489a46a7f6,0x2105a799a7882164,0xa7ff92482513262f,0x1bd627f1255fa5ed,0x26f6a3e3a7a8a0a5,0xa448a6c29fc627c3
.quad 0xa3e326f627a8a0a5,0x26c224489fc6a7c3,0x9248a7ffa513262f,0xa7f19bd6255f25ed,0x244826c21a46a7f6,0x2799a105a788a164,0xa725a332238b270e,0xa5cb258427ea9cb2,0x27fa98b5a70ea38b,0x21c2a777a66d24c4,0xa68a249b27f69a46,0x18b527fa22d7a73b,0x227ca750a62f2513,0xa3e3a6f6164827fe,0x1bd627f120a5a7a8,0x268a249ba41da6dd
.quad 0xa4eca64f20a527a8,0xa7e29d7926dd241d,0x277721c2a62fa513,0x27b6a044a7fe9648,0xa7e21d7927f61a46,0xa60f253a273ba2d7,0x260fa53aa70e238b,0x227ca750a4c4266d,0xa1052799238ba70e,0x124827ff1cb2a7ea,0x9f03a7ce1a4627f6,0xa332a72521642788,0x258425cba513a62f,0x264f24eca5eda55f,0xa7b6a04427a820a5,0xa7ce9f0327c31fc6
.quad 0x9d79a7e2a7d91e3e,0x1bd627f127ea9cb2,0x23e326f626a7a472,0xa1c2a777a73b22d7,0xa60fa53aa47226a7,0x249b268a25eda55f,0x277721c21e3ea7d9,0xa60fa53aa41d26dd,0xa7ff92481e3e27d9,0x272523321fc6a7c3,0x2799a105a472a6a7,0xa7ce9f03164827fe,0xa64f24ec26a72472,0x27ff9248a164a788,0x2448a6c2a7d99e3e,0xa7b6204424c4266d
.quad 0x9f0327ce27d99e3e,0x26f6a3e3a66da4c4,0x9bd6a7f1a6a72472,0xa5cb258427882164,0x233227252472a6a7,0x2448a6c2a7fe9648,0xa5cba5849e3e27d9,0xa105279927c39fc6,0x2750227c9e3ea7d9,0x18b5a7faa6dd241d,0xa7fa98b5247226a7,0x1d7927e2255fa5ed,0x27b6a044a6a7a472,0xa27ca750a2d7273b,0xa68a249b27d91e3e,0x24ec264f1cb2a7ea
.quad 0x249ba68aa7d91e3e,0xa64fa4ec1cb227ea,0xa04427b626a7a472,0x2750227ca2d7a73b,0x98b5a7faa47226a7,0xa7e29d79255f25ed,0x227c27501e3ea7d9,0x27fa98b5a6dda41d,0xa584a5cb1e3e27d9,0xa799210527c31fc6,0x27252332a472a6a7,0x26c2a448a7fe1648,0xa7f19bd626a72472,0xa58425cb2788a164,0x27ce9f03a7d99e3e,0x23e3a6f6a66d24c4
.quad 0xa6c2244827d99e3e,0xa04427b624c4a66d,0x24eca64fa6a72472,0x1248a7ffa1642788,0xa10527992472a6a7,0x1f0327ce1648a7fe,0x9248a7ff9e3e27d9,0xa332a7251fc627c3,0x21c227779e3ea7d9,0x253a260fa41da6dd,0xa53aa60f247226a7,0xa68aa49b25ed255f,0x26f623e3a6a7a472,0x277721c2a73ba2d7,0xa7e29d7927d91e3e,0xa7f19bd627ea1cb2
.quad 0x98b5a7faa7f61a46,0x124827ff27fe9648,0x1f0327ce27a8a0a5,0x98b5a7faa7ea1cb2,0xa1c2a777a70e238b,0x1bd627f127c39fc6,0x23e326f6262fa513,0x9d79a7e2a7882164,0xa4eca64fa513262f,0x1f0327ce273ba2d7,0x25cb2584238ba70e,0xa044a7b6a6dd241d,0xa68aa49ba0a527a8,0x21052799266da4c4,0x272523321a46a7f6,0xa1c2a777a5ed255f
.quad 0xa799a1051a4627f6,0x227c2750255fa5ed,0x27e21d79a0a5a7a8,0xa332a725a4c4266d,0xa7ff9248238b270e,0x23e326f6241da6dd,0x27f19bd6a513a62f,0xa448a6c2a2d7273b,0xa7b62044262f2513,0x249b268a2164a788,0x2750a27ca70ea38b,0xa4eca64f9fc627c3,0xa6c2244827a820a5,0x253a260f1cb2a7ea,0x260fa53aa7f69a46,0xa584a5cb964827fe
.quad 0xa53a260f27f69a46,0x25cb25849648a7fe,0x2448a6c2a7a820a5,0xa60fa53a1cb227ea,0xa27c2750270ea38b,0x264f24ec9fc6a7c3,0x2044a7b6a62f2513,0xa68aa49b21642788,0x9bd627f12513a62f,0x26c22448a2d7a73b,0x9248a7ffa38b270e,0xa6f6a3e3241d26dd,0x1d7927e220a5a7a8,0x27252332a4c4a66d,0xa105a7999a4627f6,0xa750a27c255f25ed
.quad 0x233227259a46a7f6,0x277721c2a5eda55f,0xa49ba68a20a527a8,0xa799a105266d24c4,0x258425cba38ba70e,0x27b62044a6dda41d,0xa64fa4ec2513262f,0xa7ce9f03273b22d7,0x26f623e3a62fa513,0x27e21d79a788a164,0xa777a1c2270e238b,0xa7f19bd627c31fc6,0x27ce1f03a7a8a0a5,0x27fa18b5a7ea9cb2,0xa7fa98b527f61a46,0xa7ff924827fe1648
.quad 0x1248a7ffa8002800,0x18b5a7fa964827fe,0x18b5a7fa28002800,0x1f03a7ce9cb227ea,0x1bd6a7f1a8002800,0x21c2a7779fc627c3,0x1d79a7e228002800,0x23e3a6f6a1642788,0x1f03a7cea8002800,0x24eca64fa2d7273b,0x2044a7b628002800,0x25cba584a41d26dd,0x2105a799a8002800,0x268aa49ba4c4266d,0x21c2a77728002800,0x2725a332a55f25ed
.quad 0x227ca750a8002800,0x2799a105a5ed255f,0x2332a72528002800,0x27e29d79a66d24c4,0x23e3a6f6a8002800,0x27ff9248a6dd241d,0x2448a6c228002800,0x27f11bd6a73b22d7,0x249ba68aa8002800,0x27b62044a7882164,0x24eca64f28002800,0x2750227ca7c31fc6,0x253aa60fa8002800,0x26c22448a7ea1cb2,0x2584a5cb28002800,0x260f253aa7fe1648
.quad 0x25cba584a8002800,0x253a260fa7fe9648,0x260fa53a28002800,0x244826c2a7ea9cb2,0x264fa4eca8002800,0x227c2750a7c39fc6,0x268aa49b28002800,0x204427b6a788a164,0x26c2a448a8002800,0x1bd627f1a73ba2d7,0x26f6a3e328002800,0x924827ffa6dda41d,0x2725a332a8002800,0x9d7927e2a66da4c4,0x2750a27c28002800,0xa1052799a5eda55f
.quad 0x2777a1c2a8002800,0xa3322725a55fa5ed,0x2799a10528002800,0xa49b268aa4c4a66d,0x27b6a044a8002800,0xa58425cba41da6dd,0x27ce9f0328002800,0xa64f24eca2d7a73b,0x27e29d79a8002800,0xa6f623e3a164a788,0x27f19bd628002800,0xa77721c29fc6a7c3,0x27fa98b5a8002800,0xa7ce1f039cb2a7ea,0x27ff924828002800,0xa7fa18b59648a7fe
.quad 0x1bd6a7f19a4627f6,0x1d79a7e29cb227ea,0x21c2a777a0a527a8,0x23e3a6f6a2d7273b,0x249ba68aa38b270e,0x260fa53aa55f25ed,0x260fa53aa513262f,0x2777a1c2a6dd241d,0x2725a332a62f2513,0x27ff9248a7c31fc6,0x27ce9f03a70e238b,0x27992105a7fe9648,0x27ff1248a7a820a5,0x264f24eca788a164,0x27b62044a7f61a46,0x244826c2a66da4c4
.quad 0x26f623e3a7f69a46,0x1f0327cea4c4a66d,0x25cb2584a7a8a0a5,0x9bd627f1a164a788,0x244826c2a70ea38b,0xa33227259648a7fe,0x21052799a62fa513,0xa5cb25841fc6a7c3,0x18b527faa513a62f,0xa750227c241da6dd,0x9d7927e2a38ba70e,0xa7fa18b525eda55f,0xa27c2750a0a5a7a8,0xa7b6a044273ba2d7,0xa4ec264f9a46a7f6,0xa68aa49b27ea9cb2
.quad 0xa64f24ec1a46a7f6,0xa49ba68a27ea1cb2,0xa750227c20a5a7a8,0xa044a7b6273b22d7,0xa7e21d79238ba70e,0x18b5a7fa25ed255f,0xa7fa98b52513a62f,0x227ca750241d26dd,0xa799a105262fa513,0x2584a5cb1fc627c3,0xa6c2a448270ea38b,0x2725a332964827fe,0xa584a5cb27a8a0a5,0x27f19bd6a1642788,0xa3e3a6f627f69a46,0x27ce1f03a4c4266d
.quad 0xa044a7b627f61a46,0x26c22448a66d24c4,0x9248a7ff27a820a5,0x24ec264fa7882164,0x1f03a7ce270e238b,0x21052799a7fe1648,0x2332a725262f2513,0x924827ffa7c39fc6,0x253aa60f2513262f,0xa1c22777a6dda41d,0x268aa49b238b270e,0xa53a260fa55fa5ed,0x2777a1c220a527a8,0xa6f623e3a2d7a73b,0x27f19bd61a4627f6,0xa7e21d799cb2a7ea
.quad 0x1f03a7ce9e3e27d9,0x2044a7b69fc627c3,0x24eca64fa47226a7,0x25cba584a55f25ed,0x2725a332a6a72472,0x27ce9f03a7882164,0x27ff9248a7d91e3e,0x27992105a7ea9cb2,0x2750227ca7d99e3e,0x253a260fa66da4c4,0x253a260fa6a7a472,0x1d7927e2a2d7a73b,0x204427b6a472a6a7,0xa1c227771648a7fe,0x9d7927e29e3ea7d9,0xa64f24ec241da6dd
.quad 0xa49b268a1e3ea7d9,0xa7f11bd626dda41d,0xa6f623e32472a6a7,0xa750a27c27fe9648,0xa7fa18b526a7a472,0xa49ba68a273b22d7,0xa777a1c227d99e3e,0x98b5a7fa24c4266d,0xa584a5cb27d91e3e,0x2332a7251cb227ea,0xa105a79926a72472,0x26c2a448a1642788,0x1bd6a7f1247226a7,0x27ff9248a5ed255f,0x2448a6c21e3e27d9,0x26f623e3a7c31fc6
.quad 0x26c2a4489e3e27d9,0x23e326f6a7c39fc6,0x27f19bd6a47226a7,0x924827ffa5eda55f,0x27992105a6a72472,0xa44826c2a164a788,0x25cb2584a7d91e3e,0xa72523321cb2a7ea,0x21c22777a7d99e3e,0xa7fa98b524c4a66d,0x98b527faa6a7a472,0xa68aa49b273ba2d7,0xa3e326f6a472a6a7,0xa27ca75027fe1648,0xa68a249b9e3ea7d9,0x1bd6a7f126dd241d
.quad 0xa7e21d791e3ea7d9,0x24eca64f241d26dd,0xa7b6a0442472a6a7,0x2777a1c2164827fe,0xa60fa53a26a7a472,0x27e21d79a2d7273b,0xa27ca75027d99e3e,0x260f253aa66d24c4,0x1248a7ff27d91e3e,0x21052799a7ea1cb2,0x2332a72526a72472,0x9f0327cea788a164,0x264fa4ec247226a7,0xa58425cba55fa5ed,0x27ce9f031e3e27d9,0xa7b620449fc6a7c3
.quad 0x2105a799a0a527a8,0x21c2a777a1642788,0x268aa49ba62f2513,0x2725a332a6dd241d,0x27ff1248a7f61a46,0x27b62044a7ea9cb2,0x264f24eca70ea38b,0x244826c2a55fa5ed,0x204427b6a38ba70e,0x9d7927e29648a7fe,0xa1c227771a46a7f6,0xa64f24ec24c4a66d,0xa6c224482513a62f,0xa7fa98b527c39fc6,0xa7fa98b527a8a0a5,0xa584a5cb273b22d7
.quad 0xa60fa53a27a820a5,0x9248a7ff22d7273b,0x9f03a7ce2513262f,0x253aa60f9fc627c3,0x227ca7501a4627f6,0x27f19bd6a66d24c4,0x26f6a3e3a38b270e,0x268a249ba7fe9648,0x27f11bd6a70e238b,0x1f0327cea5eda55f,0x25cb2584a7f69a46,0xa3e326f69cb2a7ea,0x1d7927e2a62fa513,0xa7992105241da6dd,0xa3322725a0a5a7a8,0xa750a27c2788a164
.quad 0xa725233220a5a7a8,0xa27ca75027882164,0xa7e29d79262fa513,0x2105a799241d26dd,0xa584a5cb27f69a46,0x26f6a3e39cb227ea,0x9bd6a7f1270e238b,0x27ce1f03a5ed255f,0x23e3a6f6238b270e,0x249b268aa7fe1648,0x2750a27c9a4627f6,0x9bd627f1a66da4c4,0x27ce1f03a513262f,0xa60f253a9fc6a7c3,0x253a260fa7a820a5,0xa7ff924822d7a73b
.quad 0x18b527faa7a8a0a5,0xa5cba584273ba2d7,0xa44826c2a513a62f,0x98b5a7fa27c31fc6,0xa77721c29a46a7f6,0x24eca64f24c4266d,0xa7b6a044238ba70e,0x27e29d79964827fe,0xa4eca64f270ea38b,0x26c22448a55f25ed,0x9248a7ff27f61a46,0x204427b6a7ea1cb2,0x249ba68a262f2513,0xa3322725a6dda41d,0x2799a10520a527a8,0xa77721c2a164a788
.quad 0x227ca750a21f2764,0x2332a725a2d7273b,0x2799a105a764221f,0x27e29d79a7c31fc6,0x26f623e3a764a21f,0x25cb2584a66da4c4,0x1f0327cea21fa764,0x9bd627f19648a7fe,0xa49b268a221fa764,0xa6f623e325eda55f,0xa7f11bd62764a21f,0xa750a27c27ea1cb2,0xa60fa53a2764221f,0x9f03a7ce241d26dd,0x9248a7ff221f2764,0x253aa60fa1642788
.quad 0x25cba584a21f2764,0x27fa18b5a7882164,0x27fa18b5a764221f,0x244826c2a6dda41d,0x24ec264fa764a21f,0xa1c227779cb2a7ea,0x9d7927e2a21fa764,0xa7b62044255fa5ed,0xa6c22448221fa764,0xa64fa4ec27fe1648,0xa7b6a0442764a21f,0x1248a7ff24c4266d,0xa332a7252764221f,0x268aa49b9fc627c3,0x21c2a777221f2764,0x27992105a73b22d7
.quad 0x2777a1c2a21f2764,0x21052799a73ba2d7,0x27252332a764221f,0xa49b268a9fc6a7c3,0x204427b6a764a21f,0xa7ff124824c4a66d,0xa44826c2a21fa764,0xa4eca64f27fe9648,0xa7e21d79221fa764,0x2044a7b6255f25ed,0xa64fa4ec2764a21f,0x2777a1c29cb227ea,0x98b5a7fa2764221f,0x26c22448a6dd241d,0x2584a5cb221f2764,0x18b527faa788a164
.quad 0x27ff1248a21f2764,0xa60f253aa164a788,0x253a260fa764221f,0xa7ce9f03241da6dd,0x9bd627f1a764a21f,0xa27ca75027ea9cb2,0xa68a249ba21fa764,0x23e3a6f625ed255f,0xa7ce9f03221fa764,0x27f19bd6964827fe,0xa3e3a6f62764a21f,0x258425cba66d24c4,0x2105a7992764221f,0x9d7927e2a7c39fc6,0x2750a27c221f2764,0xa7252332a2d7a73b
.quad 0x23e3a6f6a38b270e,0x2448a6c2a41d26dd,0x27ff9248a7f61a46,0x27f11bd6a7fe9648,0x244826c2a513a62f,0x21052799a2d7a73b,0xa332272520a5a7a8,0xa5cb258424c4a66d,0xa7fa18b527a8a0a5,0xa777a1c227ea1cb2,0xa49ba68a262f2513,0x98b5a7fa21642788,0x227ca7509a4627f6,0x26f6a3e3a55f25ed,0x27f19bd6a70e238b,0x268a249ba7c39fc6
.quad 0x24ec264fa70ea38b,0x9d7927e29fc6a7c3,0xa1c227779a46a7f6,0xa7b6204425eda55f,0xa7e21d79262fa513,0xa53aa60f27882164,0xa53aa60f27a820a5,0x227ca7501cb227ea,0x2105a79920a527a8,0x27ff9248a66d24c4,0x27ce9f03a513262f,0x23322725a73ba2d7,0x258425cba7f69a46,0xa4ec264f9648a7fe,0xa04427b6a38ba70e,0xa7ce9f0326dda41d
.quad 0xa7b62044238ba70e,0x9f03a7ce26dd241d,0xa5cba58427f69a46,0x264fa4ec964827fe,0x1f03a7ce2513262f,0x27252332a73b22d7,0x2799a105a0a527a8,0x924827ffa66da4c4,0x260f253aa7a820a5,0xa750227c1cb2a7ea,0x9d7927e2a62fa513,0xa60fa53a2788a164,0xa77721c21a46a7f6,0x2044a7b625ed255f,0xa64fa4ec270ea38b,0x27e29d799fc627c3
.quad 0x1bd6a7f1270e238b,0x249b268aa7c31fc6,0x2750a27c1a4627f6,0xa3e326f6a55fa5ed,0x268a249ba62f2513,0xa7fa98b52164a788,0x98b527faa7a8a0a5,0xa1c2a77727ea9cb2,0xa7252332a0a5a7a8,0x2584a5cb24c4266d,0xa6c2a4482513a62f,0x27992105a2d7273b,0x1248a7ff27f61a46,0x1bd627f1a7fe1648,0x26f6a3e3238b270e,0xa6c22448a41da6dd
.quad 0x249ba68aa47226a7,0x24eca64fa4c4266d,0x27b62044a7d99e3e,0x2750227ca788a164,0x18b527fa9e3ea7d9,0x9d7927e21648a7fe,0xa750227c26a7a472,0xa7fa18b527c39fc6,0xa584a5cb26a72472,0xa105a799241d26dd,0x2332a7259e3e27d9,0x26c2a448a55f25ed,0x27f11bd6a7d91e3e,0x25cb2584a73ba2d7,0x1f0327cea472a6a7,0xa3e326f61cb2a7ea
.quad 0xa6c224482472a6a7,0xa7b6a04427ea9cb2,0xa64fa4ec27d91e3e,0x1248a7ff22d7273b,0x2105a7991e3e27d9,0x27ce9f03a5ed255f,0x27ff9248a6a72472,0x23322725a6dda41d,0x21c22777a6a7a472,0xa60f253a1fc6a7c3,0xa60f253a1e3ea7d9,0xa68aa49b27fe9648,0xa6f6a3e327d99e3e,0x21c2a77721642788,0x1d79a7e2247226a7,0x27f11bd6a66d24c4
.quad 0x27e29d79a47226a7,0x1bd627f1a66da4c4,0x23e326f6a7d99e3e,0xa77721c22164a788,0xa53a260f9e3ea7d9,0xa49ba68a27fe1648,0xa777a1c226a7a472,0x253aa60f1fc627c3,0x1248a7ff26a72472,0x27252332a6dd241d,0x2799a1059e3e27d9,0x9f0327cea5eda55f,0x24ec264fa7d91e3e,0xa7ff124822d7a73b,0xa44826c2a472a6a7,0xa044a7b627ea1cb2
.quad 0xa7ce9f032472a6a7,0x26f6a3e31cb227ea,0x9bd6a7f127d91e3e,0x258425cba73b22d7,0x2725a3321e3e27d9,0xa44826c2a55fa5ed,0x25cb2584a6a72472,0xa799a105241da6dd,0xa27c2750a6a7a472,0x18b5a7fa27c31fc6,0xa7fa98b51e3ea7d9,0x27e29d79164827fe,0xa044a7b627d99e3e,0x227c2750a7882164,0x268aa49b247226a7,0xa64f24eca4c4a66d
.quad 0x253aa60fa513262f,0x2584a5cba55f25ed,0x26c22448a70ea38b,0x260f253aa66da4c4,0xa27c275020a5a7a8,0xa4ec264f241da6dd,0xa7b6a04427f61a46,0xa68aa49b273b22d7,0x1bd6a7f11a4627f6,0x2448a6c2a1642788,0x27ff9248a7a820a5,0x26f623e3a7c39fc6,0x1d7927e2a38ba70e,0xa33227251cb2a7ea,0xa7992105262fa513,0xa750a27c27fe1648
.quad 0xa332a725262f2513,0x21c2a777164827fe,0x268aa49ba38b270e,0x27992105a7ea1cb2,0x258425cba7a8a0a5,0xa04427b69fc6a7c3,0xa4ec264f1a46a7f6,0xa7ce9f032788a164,0xa6f6a3e327f69a46,0x1d79a7e222d7273b,0x21c2a77720a527a8,0x27f11bd6a6dd241d,0x27ce1f03a70e238b,0x98b527faa4c4a66d,0x98b527faa513a62f,0xa7ff924825eda55f
.quad 0xa7fa18b52513a62f,0x9248a7ff25ed255f,0x9f03a7ce270e238b,0x27fa98b5a4c4266d,0x2777a1c2a0a527a8,0x1bd627f1a6dda41d,0x23e326f6a7f69a46,0xa7e21d7922d7a73b,0xa64f24ec9a46a7f6,0x9f03a7ce27882164,0xa5cba58427a8a0a5,0x27b6a0449fc627c3,0x249ba68a238b270e,0x21052799a7ea9cb2,0x27252332a62f2513,0xa77721c21648a7fe
.quad 0xa1052799a62fa513,0xa27ca75027fe9648,0xa7e29d79238ba70e,0x2725a3321cb227ea,0x1248a7ff27a820a5,0x23e326f6a7c31fc6,0x27f19bd69a4627f6,0xa6c22448a164a788,0x204427b6a7f61a46,0xa49ba68a273ba2d7,0xa750227ca0a5a7a8,0x264fa4ec241d26dd,0xa448a6c2270ea38b,0x253a260fa66d24c4,0x260fa53a2513262f,0xa5cb2584a55fa5ed
.quad 0x25cba584a5a825a8,0x260fa53aa5ed255f,0x253a260fa5a8a5a8,0x244826c2a4c4a66d,0xa64f24ec25a8a5a8,0xa750227c26dda41d,0xa49ba68a25a825a8,0xa044a7b622d7273b,0x26c2a448a5a825a8,0x27f19bd6a7882164,0x23e326f6a5a8a5a8,0x924827ff9fc6a7c3,0xa725233225a8a5a8,0xa7e29d7927ea9cb2,0xa27ca75025a825a8,0x2105a799164827fe
.quad 0x2777a1c2a5a825a8,0x27252332a7fe9648,0x21052799a5a8a5a8,0xa49b268a1cb2a7ea,0xa7b6204425a8a5a8,0xa5cba58427c31fc6,0x9f03a7ce25a825a8,0x264fa4eca1642788,0x27e29d79a5a825a8,0x23e326f6a73ba2d7,0x1bd627f1a5a8a5a8,0xa77721c2241da6dd,0xa7fa18b525a8a5a8,0x9f03a7ce266d24c4,0x9248a7ff25a825a8,0x27fa98b5a55f25ed
.quad 0x27ff1248a5a825a8,0x98b527faa55fa5ed,0x98b527faa5a8a5a8,0xa7ce9f03266da4c4,0xa7f19bd625a8a5a8,0x21c2a777241d26dd,0x1d79a7e225a825a8,0x26f623e3a73b22d7,0x27ce1f03a5a825a8,0xa4ec264fa164a788,0xa04427b6a5a8a5a8,0xa584a5cb27c39fc6,0xa799a10525a8a5a8,0x268aa49b1cb227ea,0x21c2a77725a825a8,0x23322725a7fe1648
.quad 0x2750227ca5a825a8,0xa79921051648a7fe,0xa3322725a5a8a5a8,0x9d79a7e227ea1cb2,0xa6f6a3e325a8a5a8,0x27ff92489fc627c3,0x2448a6c225a825a8,0x9bd627f1a788a164,0x268a249ba5a825a8,0xa7b6a04422d7a73b,0xa4ec264fa5a8a5a8,0x227ca75026dd241d,0xa60fa53a25a8a5a8,0x26c22448a4c4266d,0x2584a5cb25a825a8,0xa53a260fa5eda55f
.quad 0x264fa4eca62f2513,0x268aa49ba66d24c4,0x227c2750a38ba70e,0x204427b6a164a788,0xa7e21d7927a8a0a5,0xa7fa98b527fe9648,0x18b5a7fa1a4627f6,0x227ca7509fc627c3,0x27992105a7f69a46,0x25cb2584a6dda41d,0xa44826c220a5a7a8,0xa725233225eda55f,0xa584a5cb270e238b,0x9bd6a7f122d7273b,0x26f6a3e3a513262f,0x27ce1f03a7ea1cb2
.quad 0x204427b6a513a62f,0xa44826c21cb2a7ea,0xa7ff1248270ea38b,0xa4eca64f273b22d7,0x1f03a7ce20a527a8,0x2799a105a55f25ed,0x27252332a7f61a46,0x924827ffa41da6dd,0xa53a260f1a46a7f6,0xa777a1c227c39fc6,0xa49ba68a27a820a5,0x253aa60f964827fe,0x2777a1c2a38b270e,0x23e326f6a788a164,0x1bd627f1a62fa513,0xa7e21d7924c4a66d
.quad 0xa7f19bd6262fa513,0x1d79a7e224c4266d,0x21c2a777238b270e,0x26f623e3a7882164,0x268a249ba7a820a5,0xa60f253a9648a7fe,0xa60f253a9a46a7f6,0xa1c2a77727c31fc6,0xa332a72527f61a46,0x27ff9248a41d26dd,0x27ce9f03a0a527a8,0xa1052799a55fa5ed,0x924827ffa70ea38b,0xa64fa4ec273ba2d7,0xa7b6a0442513a62f,0x26c2a4481cb227ea
.quad 0x23e3a6f62513262f,0x1f0327cea7ea9cb2,0x25cb2584a70e238b,0xa7f19bd622d7a73b,0xa6c22448a0a5a7a8,0x2332a72525ed255f,0xa105a79927f69a46,0x258425cba6dd241d,0x27fa98b59a4627f6,0xa750227c9fc6a7c3,0x9d7927e2a7a8a0a5,0x98b5a7fa27fe1648,0xa750a27c238ba70e,0x27b62044a1642788,0x24eca64f262f2513,0xa49b268aa66da4c4
.quad 0x26c2a448a6a72472,0x26f6a3e3a6dd241d,0x1bd627f19e3ea7d9,0x924827ff9648a7fe,0xa799a10527d91e3e,0xa6c2a448273b22d7,0x2584a5cba47226a7,0x2725a332a66d24c4,0x21c22777a472a6a7,0x98b527fa9cb2a7ea,0xa7fa98b527d99e3e,0xa68aa49b27882164,0x23e3a6f69e3e27d9,0x2750a27ca5ed255f,0x249b268aa6a7a472,0x9bd627f19fc6a7c3
.quad 0xa7e21d7926a7a472,0xa64fa4ec27c31fc6,0x2044a7b61e3e27d9,0x2777a1c2a55f25ed,0x260f253aa7d99e3e,0x9d7927e2a164a788,0xa750227c2472a6a7,0xa60fa53a27ea1cb2,0x1248a7ff247226a7,0x2799a105a4c4266d,0x27252332a7d91e3e,0x9f0327cea2d7a73b,0xa64f24ec1e3ea7d9,0xa5cba58427fe1648,0x9f03a7ce26a72472,0x27b6a044a41d26dd
.quad 0x27ce1f03a6a72472,0xa04427b6a41da6dd,0xa4ec264f9e3ea7d9,0xa584a5cb27fe9648,0xa332a72527d91e3e,0x27ce9f03a2d7273b,0x27ff9248a47226a7,0xa1052799a4c4a66d,0xa27c2750a472a6a7,0xa53aa60f27ea9cb2,0xa53aa60f27d99e3e,0x27e29d79a1642788,0x27b6a0449e3e27d9,0xa1c22777a55fa5ed,0x9d7927e2a6a7a472,0xa4eca64f27c39fc6
.quad 0xa68aa49b26a7a472,0x27f19bd69fc627c3,0x26f6a3e31e3e27d9,0xa27c2750a5eda55f,0x18b527faa7d99e3e,0xa49ba68a2788a164,0xa777a1c22472a6a7,0x27fa98b59cb227ea,0x25cba584247226a7,0xa3322725a66da4c4,0x21052799a7d91e3e,0xa448a6c2273ba2d7,0xa7f19bd61e3ea7d9,0x27ff9248964827fe,0x2448a6c226a72472,0xa3e326f6a6dda41d
.quad 0x2725a332a70e238b,0x2750a27ca73b22d7,0x9d7927e21a46a7f6,0xa10527991fc6a7c3,0xa584a5cb262f2513,0xa3e3a6f624c4266d,0x27f19bd6a7a820a5,0x27ce1f03a7fe9648,0xa3e326f620a5a7a8,0xa68a249b255fa5ed,0xa27ca7502513262f,0x1bd6a7f11cb227ea,0x27ce1f03a7f61a46,0x253a260fa6dda41d,0xa60f253a238ba70e,0xa7ff92482788a164
.quad 0x98b5a7fa238b270e,0x2584a5cba1642788,0x26c22448a7f69a46,0x18b527faa41da6dd,0xa77721c22513a62f,0xa64fa4ec27ea1cb2,0x2044a7b620a527a8,0x27e29d79a5ed255f,0x24ec264fa7a8a0a5,0xa44826c29648a7fe,0xa7ff1248262fa513,0xa044a7b6266d24c4,0x249ba68a1a4627f6,0x27252332a7c31fc6,0x21052799a70ea38b,0xa77721c222d7a73b
.quad 0xa799a105270ea38b,0x21c2a77722d7273b,0x268aa49b9a4627f6,0x23322725a7c39fc6,0x924827ffa62fa513,0xa7b6a044266da4c4,0xa64fa4ec27a8a0a5,0x26c2a448964827fe,0x27b6a044a0a527a8,0x9d7927e2a5eda55f,0xa1c22777a513a62f,0xa4eca64f27ea9cb2,0xa448a6c227f69a46,0x27fa18b5a41d26dd,0x27fa18b5a38b270e,0xa5cb2584a164a788
.quad 0xa53a260fa38ba70e,0x9248a7ff27882164,0x9f03a7ce27f61a46,0x260f253aa6dd241d,0x2750227ca513262f,0xa7f11bd61cb2a7ea,0xa6f623e3a0a5a7a8,0x249ba68a255f25ed,0x1bd6a7f127a820a5,0x1f0327cea7fe1648,0x25cb2584a62f2513,0xa6f6a3e324c4a66d,0xa7e21d799a46a7f6,0x2799a1051fc627c3,0x2332a725270e238b,0xa27c2750a73ba2d7
.quad 0x2777a1c2a764221f,0x2799a105a7882164,0xa3322725221fa764,0xa49b268a241da6dd,0xa044a7b6221f2764,0x9248a7ff1cb227ea,0x26c22448a764a21f,0x24ec264fa5eda55f,0xa7e21d792764a21f,0xa7b6a04427fe1648,0x24eca64fa21f2764,0x2777a1c2a66d24c4,0x18b527faa21fa764,0xa44826c21fc6a7c3,0xa5cba5842764221f,0x98b5a7fa22d7273b
.quad 0x27ff1248a764221f,0x253a260fa73ba2d7,0xa60f253a221fa764,0xa7ce9f0327c39fc6,0x1bd6a7f1221f2764,0x2750a27ca4c4266d,0x249b268aa764a21f,0xa3e326f69648a7fe,0xa7ce9f032764a21f,0x9bd6a7f1255f25ed,0x26f6a3e3a21f2764,0x258425cba7ea9cb2,0xa1052799a21fa764,0xa7e29d7926dda41d,0xa27ca7502764221f,0x2725a332a1642788
.quad 0x2750227ca764221f,0xa3322725a164a788,0xa7992105221fa764,0x9d79a7e226dd241d,0x23e3a6f6221f2764,0x25cb2584a7ea1cb2,0x1f0327cea764a21f,0xa7f19bd6255fa5ed,0xa68aa49b2764a21f,0x26f6a3e3964827fe,0x27f19bd6a21f2764,0xa27c2750a4c4a66d,0xa53a260fa21fa764,0x9f03a7ce27c31fc6,0x9248a7ff2764221f,0x260f253aa73b22d7
.quad 0x258425cba764221f,0xa7fa98b522d7a73b,0xa7fa98b5221fa764,0x26c2a4481fc627c3,0x264fa4ec221f2764,0xa1c22777a66da4c4,0x9d7927e2a764a21f,0xa044a7b627fe9648,0xa448a6c22764a21f,0x264f24eca5ed255f,0x27b62044a21f2764,0xa7ff92481cb2a7ea,0xa7252332a21fa764,0x268aa49b241d26dd,0x21c2a7772764221f,0xa1052799a788a164
.quad 0x27b6a044a7a820a5,0x27ce9f03a7c31fc6,0xa58425cb2513a62f,0xa64f24ec25eda55f,0x1f03a7ce9a4627f6,0x2332a725a1642788,0x21052799a38ba70e,0x924827ff9cb2a7ea,0xa60fa53a270e238b,0xa27ca75024c4266d,0x27e21d79a7f61a46,0x260f253aa73ba2d7,0xa77721c2262fa513,0xa7b6a04427fe9648,0x24eca64fa0a527a8,0x27e29d79a6dd241d
.quad 0x9bd627f1a0a5a7a8,0xa68a249b241da6dd,0xa27ca750262f2513,0x23e3a6f6964827fe,0x268a249ba7f69a46,0x98b527faa2d7a73b,0xa7fa98b5270ea38b,0xa1c2a777266d24c4,0x2725a332a38b270e,0x25cb2584a7ea9cb2,0xa44826c29a46a7f6,0xa799a1052788a164,0x1248a7ff2513262f,0x27f19bd6a55f25ed,0x23e326f6a7a8a0a5,0xa6c224481fc6a7c3
.quad 0xa6f6a3e327a8a0a5,0x2448a6c21fc627c3,0x27ff9248a513262f,0x9bd627f1a55fa5ed,0xa6c224481a46a7f6,0xa105a79927882164,0x2332a725238b270e,0x258425cba7ea1cb2,0x18b527faa70ea38b,0xa777a1c2266da4c4,0xa49ba68a27f69a46,0x27fa98b5a2d7273b,0x2750227ca62f2513,0xa6f623e39648a7fe,0xa7f11bd620a5a7a8,0x249ba68a241d26dd
.quad 0x264fa4ec20a527a8,0x9d7927e2a6dda41d,0xa1c22777a62fa513,0xa044a7b627fe1648,0x9d79a7e227f61a46,0x253a260fa73b22d7,0x253a260fa70e238b,0xa750a27c24c4a66d,0xa799a105238ba70e,0x27ff92489cb227ea,0x27ce9f031a4627f6,0xa7252332a164a788,0xa5cb2584a513a62f,0x24eca64f25ed255f,0x2044a7b627a820a5,0x9f0327cea7c39fc6
.quad 0x27e29d79a7d91e3e,0x27f19bd6a7ea1cb2,0xa6f623e326a7a472,0xa77721c2273ba2d7,0x253aa60fa47226a7,0x268aa49ba5ed255f,0xa1c227771e3ea7d9,0xa53a260f241da6dd,0x1248a7ff1e3e27d9,0x2332a7259fc627c3,0x21052799a472a6a7,0x9f0327ce9648a7fe,0xa4eca64f26a72472,0x9248a7ff21642788,0x26c22448a7d99e3e,0x204427b6a4c4a66d
.quad 0xa7ce9f0327d99e3e,0xa3e3a6f6266d24c4,0x27f19bd6a6a72472,0x258425cba788a164,0xa72523322472a6a7,0xa6c2a44827fe1648,0x2584a5cb9e3e27d9,0x27992105a7c31fc6,0xa27c27509e3ea7d9,0xa7fa98b526dda41d,0x18b5a7fa247226a7,0x27e29d79a55f25ed,0x204427b6a6a7a472,0xa750227c22d7a73b,0xa49ba68a27d91e3e,0x264fa4ec9cb227ea
.quad 0x268a249ba7d91e3e,0xa4ec264f9cb2a7ea,0xa7b6a04426a7a472,0x227ca75022d7273b,0x27fa98b5a47226a7,0x9d7927e2a55fa5ed,0xa750227c1e3ea7d9,0x98b5a7fa26dd241d,0x25cba5841e3e27d9,0x21052799a7c39fc6,0xa3322725a472a6a7,0xa448a6c227fe9648,0x1bd6a7f126a72472,0x25cb2584a7882164,0x1f0327cea7d99e3e,0xa6f6a3e3266da4c4
.quad 0xa448a6c227d99e3e,0x27b62044a4c4266d,0x264f24eca6a72472,0xa7ff92482164a788,0xa799a1052472a6a7,0x27ce9f03964827fe,0x27ff92489e3e27d9,0xa72523329fc6a7c3,0xa77721c29e3ea7d9,0x260fa53a241d26dd,0x260fa53a247226a7,0xa49b268aa5eda55f,0xa3e326f6a6a7a472,0x21c2a777273b22d7,0x1d79a7e227d91e3e,0x9bd627f1a7ea9cb2
.quad 0x27fa98b5a7f61a46,0x27ff9248a7fe1648,0xa7ce1f0327a8a0a5,0xa7fa18b527ea9cb2,0x2777a1c2a70e238b,0x27f19bd6a7c31fc6,0xa6f623e3262fa513,0xa7e21d792788a164,0x264fa4eca513262f,0x27ce9f03a73b22d7,0xa58425cb238ba70e,0xa7b6204426dda41d,0x249ba68aa0a527a8,0x2799a105a66d24c4,0xa33227251a46a7f6,0xa77721c225eda55f
.quad 0x2105a7991a4627f6,0x2750a27ca55f25ed,0x9d7927e2a0a5a7a8,0xa725233224c4a66d,0x1248a7ff238b270e,0x26f6a3e3a41d26dd,0x1bd627f1a513a62f,0xa6c2244822d7a73b,0xa044a7b6262f2513,0x268aa49ba1642788,0x227c2750a70ea38b,0xa64f24ec1fc6a7c3,0xa448a6c227a820a5,0x260fa53a9cb227ea,0x253a260fa7f69a46,0xa5cb25841648a7fe
.quad 0xa60fa53a27f69a46,0x2584a5cb164827fe,0x26c22448a7a820a5,0xa53a260f9cb2a7ea,0xa750a27c270ea38b,0x24eca64f1fc627c3,0x27b62044a62f2513,0xa49b268aa164a788,0xa7f19bd62513a62f,0x2448a6c222d7273b,0x27ff9248a38b270e,0xa3e326f6a41da6dd,0xa7e21d7920a5a7a8,0x2332a72524c4266d,0x2799a1059a4627f6,0xa27c2750a55fa5ed
.quad 0xa72523329a46a7f6,0x21c2a77725ed255f,0x268aa49b20a527a8,0xa1052799a66da4c4,0xa5cb2584a38ba70e,0x2044a7b626dd241d,0x24eca64f2513262f,0x9f0327cea73ba2d7,0xa3e326f6a62fa513,0x1d79a7e227882164,0x21c2a777270e238b,0x9bd627f1a7c39fc6,0x9f0327cea7a8a0a5,0x18b5a7fa27ea1cb2,0x18b5a7fa27f61a46,0x924827ffa7fe9648
.quad 0x27ff1248a8002800,0xa7fa98b51648a7fe,0x27fa18b528002800,0xa7ce9f031cb2a7ea,0x27f11bd6a8002800,0xa777a1c21fc6a7c3,0x27e21d7928002800,0xa6f6a3e32164a788,0x27ce1f03a8002800,0xa64fa4ec22d7a73b,0x27b6204428002800,0xa584a5cb241da6dd,0x27992105a8002800,0xa49ba68a24c4a66d,0x277721c228002800,0xa332a725255fa5ed
.quad 0x2750227ca8002800,0xa105a79925eda55f,0x2725233228002800,0x9d79a7e2266da4c4,0x26f623e3a8002800,0x9248a7ff26dda41d,0x26c2244828002800,0x1bd6a7f1273ba2d7,0x268a249ba8002800,0x2044a7b62788a164,0x264f24ec28002800,0x227ca75027c39fc6,0x260f253aa8002800,0x2448a6c227ea9cb2,0x25cb258428002800,0x253aa60f27fe9648
.quad 0x258425cba8002800,0x260fa53a27fe1648,0x253a260f28002800,0x26c2a44827ea1cb2,0x24ec264fa8002800,0x2750a27c27c31fc6,0x249b268a28002800,0x27b6a04427882164,0x244826c2a8002800,0x27f19bd6273b22d7,0x23e326f628002800,0x27ff124826dd241d,0x23322725a8002800,0x27e21d79266d24c4,0x227c275028002800,0x2799210525ed255f
.quad 0x21c22777a8002800,0x27252332255f25ed,0x2105279928002800,0x268a249b24c4266d,0x204427b6a8002800,0x25cb2584241d26dd,0x1f0327ce28002800,0x24ec264f22d7273b,0x1d7927e2a8002800,0x23e326f621642788,0x1bd627f128002800,0x21c227771fc627c3,0x18b527faa8002800,0x1f0327ce1cb227ea,0x124827ff28002800,0x18b527fa164827fe
.quad 0x27f11bd69a4627f6,0xa7e29d791cb2a7ea,0x277721c2a0a527a8,0xa6f6a3e322d7a73b,0x268a249ba38b270e,0xa53aa60f255fa5ed,0x253a260fa513262f,0xa1c2a77726dda41d,0x23322725a62f2513,0x9248a7ff27c39fc6,0x1f0327cea70e238b,0x2105a79927fe1648,0x924827ffa7a820a5,0x24eca64f27882164,0xa04427b6a7f61a46,0x26c2a448266d24c4
.quad 0xa3e326f6a7f69a46,0x27ce9f0324c4266d,0xa58425cba7a8a0a5,0x27f11bd621642788,0xa6c22448a70ea38b,0x27252332164827fe,0xa7992105a62fa513,0x258425cb9fc627c3,0xa7fa18b5a513a62f,0x227c2750a41d26dd,0xa7e29d79a38ba70e,0x18b527faa5ed255f,0xa750a27ca0a5a7a8,0xa04427b6a73b22d7,0xa64fa4ec9a46a7f6,0xa49b268aa7ea1cb2
.quad 0xa4eca64f1a46a7f6,0xa68a249ba7ea9cb2,0xa27ca75020a5a7a8,0xa7b62044a73ba2d7,0x9d79a7e2238ba70e,0xa7fa98b5a5eda55f,0x18b5a7fa2513a62f,0xa750a27ca41da6dd,0x2105a799262fa513,0xa5cba5849fc6a7c3,0x2448a6c2270ea38b,0xa332a7251648a7fe,0x25cba58427a8a0a5,0x9bd6a7f12164a788,0x26f6a3e327f69a46,0x1f03a7ce24c4a66d
.quad 0x27b6a04427f61a46,0x2448a6c2266da4c4,0x27ff924827a820a5,0x264fa4ec2788a164,0x27ce1f03270e238b,0x2799a10527fe9648,0x27252332262f2513,0x27ff124827c31fc6,0x260f253a2513262f,0x277721c226dd241d,0x249b268a238b270e,0x260f253a255f25ed,0x21c2277720a527a8,0x23e326f622d7273b,0x1bd627f11a4627f6,0x1d7927e21cb227ea
.quad 0x27ce1f039e3e27d9,0xa7b6a0441fc6a7c3,0x264f24eca47226a7,0xa584a5cb255fa5ed,0x23322725a6a72472,0x9f03a7ce2788a164,0x124827ffa7d91e3e,0x2105a79927ea1cb2,0xa27c2750a7d99e3e,0x260fa53a266d24c4,0xa60f253aa6a7a472,0x27e29d7922d7273b,0xa7b62044a472a6a7,0x277721c2964827fe,0xa7e29d799e3ea7d9,0x24ec264fa41d26dd
.quad 0xa68aa49b1e3ea7d9,0x1bd627f1a6dd241d,0xa3e3a6f62472a6a7,0xa27c2750a7fe1648,0x98b5a7fa26a7a472,0xa68a249ba73ba2d7,0x21c2a77727d99e3e,0xa7fa18b5a4c4a66d,0x25cba58427d91e3e,0xa725a3329cb2a7ea,0x2799a10526a72472,0xa448a6c22164a788,0x27f11bd6247226a7,0x9248a7ff25eda55f,0x26c224481e3e27d9,0x23e3a6f627c39fc6
.quad 0x244826c29e3e27d9,0x26f6a3e327c31fc6,0x1bd627f1a47226a7,0x27ff124825ed255f,0xa1052799a6a72472,0x26c2244821642788,0xa58425cba7d91e3e,0x233227259cb227ea,0xa77721c2a7d99e3e,0x98b527faa4c4266d,0xa7fa98b5a6a7a472,0xa49b268aa73b22d7,0xa6f6a3e3a472a6a7,0xa750227ca7fe9648,0xa49ba68a9e3ea7d9,0xa7f19bd6a6dda41d
.quad 0x9d79a7e21e3ea7d9,0xa64fa4eca41da6dd,0x2044a7b62472a6a7,0xa1c2a7779648a7fe,0x253aa60f26a7a472,0x1d79a7e222d7a73b,0x2750a27c27d99e3e,0x253aa60f266da4c4,0x27ff124827d91e3e,0x2799a10527ea9cb2,0x2725233226a72472,0x27ce1f0327882164,0x24ec264f247226a7,0x25cb2584255f25ed,0x1f0327ce1e3e27d9,0x204427b61fc627c3
.quad 0x27992105a0a527a8,0xa777a1c22164a788,0x249b268aa62f2513,0xa332a72526dda41d,0x924827ffa7f61a46,0x2044a7b627ea1cb2,0xa4ec264fa70ea38b,0x26c2a448255f25ed,0xa7b62044a38ba70e,0x27e21d79164827fe,0xa777a1c21a46a7f6,0x24ec264fa4c4266d,0xa448a6c22513a62f,0x98b527faa7c31fc6,0x18b5a7fa27a8a0a5,0xa5cb2584a73ba2d7
.quad 0x253aa60f27a820a5,0xa7ff1248a2d7a73b,0x27ce9f032513262f,0xa60fa53a1fc6a7c3,0x2750227c1a4627f6,0x9bd6a7f1266da4c4,0x23e326f6a38b270e,0x249ba68a27fe1648,0x9bd627f1a70e238b,0x27ce9f0325ed255f,0xa58425cba7f69a46,0x26f623e31cb227ea,0xa7e21d79a62fa513,0x21052799a41d26dd,0xa725a332a0a5a7a8,0xa27c2750a7882164
.quad 0xa332a72520a5a7a8,0xa750227ca788a164,0x1d79a7e2262fa513,0xa799a105a41da6dd,0x25cba58427f69a46,0xa3e3a6f61cb2a7ea,0x27f19bd6270e238b,0x1f03a7ce25eda55f,0x26f623e3238b270e,0x268aa49b27fe9648,0x227c27509a4627f6,0x27f11bd6266d24c4,0x9f0327cea513262f,0x253a260f1fc627c3,0xa60f253aa7a820a5,0x924827ffa2d7273b
.quad 0xa7fa18b5a7a8a0a5,0xa58425cba73b22d7,0xa6c2a448a513a62f,0xa7fa18b5a7c39fc6,0xa1c2a7779a46a7f6,0xa64fa4eca4c4a66d,0x2044a7b6238ba70e,0x9d79a7e21648a7fe,0x264fa4ec270ea38b,0x2448a6c2255fa5ed,0x27ff924827f61a46,0x27b6a04427ea9cb2,0x268a249b262f2513,0x2725233226dd241d,0x2105279920a527a8,0x21c2277721642788
.quad 0x2750227ca21f2764,0xa725a33222d7a73b,0x21052799a764221f,0x9d79a7e227c39fc6,0xa3e326f6a764a21f,0x2584a5cb266d24c4,0xa7ce1f03a21fa764,0x27f11bd6164827fe,0xa68aa49b221fa764,0x23e326f6a5ed255f,0x9bd6a7f12764a21f,0xa27c2750a7ea9cb2,0x253aa60f2764221f,0xa7ce1f03a41da6dd,0x27ff9248221f2764,0xa60fa53a2164a788
.quad 0x258425cba21f2764,0x18b5a7fa2788a164,0x98b527faa764221f,0x26c2a44826dd241d,0xa64f24eca764a21f,0x277721c21cb227ea,0xa7e29d79a21fa764,0x204427b6a55f25ed,0xa448a6c2221fa764,0xa4ec264fa7fe9648,0x2044a7b62764a21f,0xa7ff9248a4c4a66d,0x2725a3322764221f,0xa49ba68a1fc6a7c3,0x277721c2221f2764,0x2105a799273ba2d7
.quad 0x21c22777a21f2764,0x2799a105273b22d7,0xa3322725a764221f,0x268a249b1fc627c3,0xa7b62044a764a21f,0x124827ffa4c4266d,0xa6c2a448a21fa764,0xa64f24eca7fe1648,0x9d79a7e2221fa764,0xa7b6a044a55fa5ed,0x24eca64f2764a21f,0xa1c2a7771cb2a7ea,0x27fa98b52764221f,0x2448a6c226dda41d,0x25cb2584221f2764,0x27fa98b527882164
.quad 0x924827ffa21f2764,0x253a260f21642788,0xa60f253aa764221f,0x9f0327cea41d26dd,0xa7f19bd6a764a21f,0xa750227ca7ea1cb2,0xa49ba68aa21fa764,0xa6f6a3e3a5eda55f,0x1f03a7ce221fa764,0x9bd6a7f11648a7fe,0x26f6a3e32764a21f,0x25cba584266da4c4,0x279921052764221f,0x27e21d7927c31fc6,0x227c2750221f2764,0x2332272522d7273b
.quad 0x26f623e3a38b270e,0xa6c2a448241da6dd,0x124827ffa7f61a46,0x1bd6a7f127fe1648,0xa6c22448a513a62f,0x2799a10522d7273b,0xa725a33220a5a7a8,0x258425cba4c4266d,0x98b5a7fa27a8a0a5,0xa1c22777a7ea9cb2,0x268aa49b262f2513,0xa7fa18b5a164a788,0x2750227c9a4627f6,0xa3e3a6f6255fa5ed,0x1bd627f1a70e238b,0x249ba68a27c31fc6
.quad 0xa64f24eca70ea38b,0x27e21d791fc627c3,0xa777a1c29a46a7f6,0x204427b6a5ed255f,0x9d79a7e2262fa513,0xa60f253aa788a164,0x260fa53a27a820a5,0xa750a27c9cb2a7ea,0x2799210520a527a8,0x9248a7ff266da4c4,0x1f0327cea513262f,0x2725a332273b22d7,0xa5cb2584a7f69a46,0x264f24ec164827fe,0xa7b6a044a38ba70e,0x9f0327cea6dd241d
.quad 0xa044a7b6238ba70e,0xa7ce1f03a6dda41d,0x2584a5cb27f69a46,0xa4eca64f1648a7fe,0x27ce1f032513262f,0x2332a725273ba2d7,0x21052799a0a527a8,0x27ff1248266d24c4,0xa53a260fa7a820a5,0x227c27509cb227ea,0xa7e29d79a62fa513,0xa53a260fa7882164,0xa1c2a7771a46a7f6,0xa7b6a044a5eda55f,0x24eca64f270ea38b,0x9d79a7e21fc6a7c3
.quad 0x27f11bd6270e238b,0x268aa49b27c39fc6,0x227c27501a4627f6,0x26f623e3255f25ed,0xa49b268aa62f2513,0x98b527faa1642788,0xa7fa98b5a7a8a0a5,0xa77721c2a7ea1cb2,0xa332a725a0a5a7a8,0xa5cba584a4c4a66d,0x2448a6c22513a62f,0x2105a79922d7a73b,0x27ff124827f61a46,0x27f19bd627fe9648,0x23e326f6238b270e,0x244826c2241d26dd
.quad 0x268a249ba47226a7,0xa64fa4ec24c4a66d,0xa04427b6a7d99e3e,0x227ca75027882164,0xa7fa18b59e3ea7d9,0x27e21d79964827fe,0xa27ca75026a7a472,0x18b527faa7c31fc6,0x25cba58426a72472,0xa7992105a41da6dd,0x272523329e3e27d9,0xa448a6c2255fa5ed,0x9bd627f1a7d91e3e,0x2584a5cb273b22d7,0xa7ce1f03a472a6a7,0x26f623e39cb227ea
.quad 0xa448a6c22472a6a7,0xa04427b6a7ea1cb2,0x24eca64f27d91e3e,0xa7ff9248a2d7a73b,0x279921051e3e27d9,0x9f03a7ce25eda55f,0x124827ffa6a72472,0x2725a33226dd241d,0xa77721c2a6a7a472,0x253a260f9fc627c3,0xa53aa60f1e3ea7d9,0xa49b268aa7fe1648,0x23e3a6f627d99e3e,0xa777a1c2a164a788,0x27e21d79247226a7,0x1bd6a7f1266da4c4
.quad 0x1d7927e2a47226a7,0x27f19bd6266d24c4,0xa6f623e3a7d99e3e,0x21c22777a1642788,0xa60fa53a9e3ea7d9,0xa68a249ba7fe9648,0x21c2a77726a7a472,0xa60fa53a9fc6a7c3,0x27ff124826a72472,0x2332a72526dda41d,0x210527999e3e27d9,0x27ce1f0325ed255f,0xa64f24eca7d91e3e,0x124827ffa2d7273b,0xa6c2a448a472a6a7,0xa7b62044a7ea9cb2
.quad 0x1f03a7ce2472a6a7,0xa3e3a6f69cb2a7ea,0x27f19bd627d91e3e,0x25cba584273ba2d7,0x233227251e3e27d9,0x26c22448255f25ed,0xa58425cba6a72472,0xa1052799a41d26dd,0xa750a27ca6a7a472,0xa7fa98b5a7c39fc6,0x18b5a7fa1e3ea7d9,0x9d79a7e29648a7fe,0x27b6a04427d99e3e,0x2750a27c2788a164,0x249b268a247226a7,0x24ec264f24c4266d
.quad 0x260f253aa513262f,0xa5cba584255fa5ed,0xa44826c2a70ea38b,0x253aa60f266d24c4,0xa750a27c20a5a7a8,0x264f24eca41d26dd,0x2044a7b627f61a46,0xa49b268aa73ba2d7,0x27f11bd61a4627f6,0xa6c2a4482164a788,0x124827ffa7a820a5,0x23e3a6f627c31fc6,0xa7e21d79a38ba70e,0x272523329cb227ea,0xa105a799262fa513,0xa27c2750a7fe9648
.quad 0x2725a332262f2513,0xa777a1c29648a7fe,0x249b268aa38b270e,0x2105a79927ea9cb2,0xa5cb2584a7a8a0a5,0x27b620441fc627c3,0xa64fa4ec1a46a7f6,0x9f0327cea7882164,0x23e3a6f627f69a46,0xa7e29d79a2d7a73b,0x277721c220a527a8,0x1bd6a7f126dda41d,0x9f0327cea70e238b,0x27fa18b524c4266d,0xa7fa98b5a513a62f,0x924827ffa5ed255f
.quad 0x98b5a7fa2513a62f,0xa7ff1248a5eda55f,0x27ce9f03270e238b,0x98b5a7fa24c4a66d,0x21c22777a0a527a8,0x27f19bd626dd241d,0xa6f623e3a7f69a46,0x1d7927e2a2d7273b,0xa4eca64f9a46a7f6,0xa7ce1f03a788a164,0x2584a5cb27a8a0a5,0xa044a7b61fc6a7c3,0x268a249b238b270e,0x2799a10527ea1cb2,0xa3322725a62f2513,0x21c22777964827fe
.quad 0xa799a105a62fa513,0xa750227ca7fe1648,0x1d79a7e2238ba70e,0xa332a7259cb2a7ea,0x27ff124827a820a5,0x26f6a3e327c39fc6,0x1bd627f19a4627f6,0x244826c221642788,0xa7b62044a7f61a46,0xa68a249ba73b22d7,0xa27ca750a0a5a7a8,0xa4eca64fa41da6dd,0x26c2a448270ea38b,0x260fa53a266da4c4,0x253a260f2513262f,0x258425cb255f25ed
.quad 0x258425cba5a825a8,0xa53aa60f25eda55f,0xa60f253aa5a8a5a8,0x26c2a44824c4266d,0xa4eca64f25a8a5a8,0x227c2750a6dd241d,0x268aa49b25a825a8,0xa7b62044a2d7a73b,0x244826c2a5a825a8,0x9bd6a7f12788a164,0xa6f623e3a5a8a5a8,0x27ff12481fc627c3,0xa332a72525a8a5a8,0x9d7927e2a7ea1cb2,0x2750a27c25a825a8,0xa799a1059648a7fe
.quad 0x21c22777a5a825a8,0x2332a72527fe1648,0xa7992105a5a8a5a8,0x268a249b9cb227ea,0xa044a7b625a8a5a8,0xa58425cba7c39fc6,0x27ce9f0325a825a8,0xa4eca64f2164a788,0x1d7927e2a5a825a8,0x26f6a3e3273b22d7,0xa7f11bd6a5a8a5a8,0x21c22777a41d26dd,0x98b5a7fa25a8a5a8,0xa7ce1f03a66da4c4,0x27ff924825a825a8,0x98b5a7fa255fa5ed
.quad 0x924827ffa5a825a8,0x27fa18b5255f25ed,0xa7fa98b5a5a8a5a8,0x9f0327cea66d24c4,0x1bd6a7f125a8a5a8,0xa777a1c2a41da6dd,0x27e21d7925a825a8,0x23e3a6f6273ba2d7,0x9f0327cea5a825a8,0x264f24ec21642788,0xa7b6a044a5a8a5a8,0xa5cb2584a7c31fc6,0x2105a79925a8a5a8,0xa49ba68a9cb2a7ea,0x277721c225a825a8,0x2725a33227fe9648
.quad 0xa27c2750a5a825a8,0x21052799964827fe,0xa725a332a5a8a5a8,0xa7e21d79a7ea9cb2,0x23e3a6f625a8a5a8,0x9248a7ff1fc6a7c3,0x26c2244825a825a8,0x27f11bd627882164,0xa49b268aa5a825a8,0xa04427b6a2d7273b,0xa64fa4eca5a8a5a8,0xa750a27ca6dda41d,0x253aa60f25a8a5a8,0x2448a6c224c4a66d,0x25cb258425a825a8,0x260f253a25ed255f
.quad 0x24ec264fa62f2513,0xa49ba68a266da4c4,0xa750227ca38ba70e,0x27b6a04421642788,0x9d79a7e227a8a0a5,0x98b527faa7fe1648,0x27fa18b51a4627f6,0xa750a27c1fc6a7c3,0xa1052799a7f69a46,0x2584a5cb26dd241d,0xa6c2a44820a5a7a8,0x23322725a5ed255f,0x25cba584270e238b,0xa7f11bd6a2d7a73b,0x23e326f6a513262f,0x1f03a7ce27ea9cb2
.quad 0xa7b62044a513a62f,0x26c224489cb227ea,0x9248a7ff270ea38b,0xa64f24eca73ba2d7,0x27ce1f0320a527a8,0xa105a799255fa5ed,0xa3322725a7f61a46,0x27ff1248241d26dd,0xa60fa53a1a46a7f6,0xa1c22777a7c31fc6,0x268aa49b27a820a5,0xa60fa53a1648a7fe,0x21c22777a38b270e,0x26f6a3e327882164,0xa7f11bd6a62fa513,0x1d7927e2a4c4266d
.quad 0x1bd6a7f1262fa513,0xa7e29d79a4c4a66d,0x277721c2238b270e,0x23e3a6f62788a164,0xa49b268aa7a820a5,0x253a260f164827fe,0xa53aa60f9a46a7f6,0xa77721c2a7c39fc6,0x2725a33227f61a46,0x9248a7ff241da6dd,0x1f0327cea0a527a8,0x27992105255f25ed,0xa7ff9248a70ea38b,0xa4ec264fa73b22d7,0x2044a7b62513a62f,0xa448a6c29cb2a7ea
.quad 0x26f623e32513262f,0x27ce9f0327ea1cb2,0xa58425cba70e238b,0x9bd627f1a2d7273b,0xa448a6c2a0a5a7a8,0xa725a332a5eda55f,0x2799a10527f69a46,0x25cba58426dda41d,0x18b527fa9a4627f6,0x227c27501fc627c3,0xa7e29d79a7a8a0a5,0xa7fa18b5a7fe9648,0x227ca750238ba70e,0x2044a7b62164a788,0x264f24ec262f2513,0x268a249b266d24c4
.quad 0x244826c2a6a72472,0xa3e3a6f626dda41d,0xa7f11bd69e3ea7d9,0x27ff1248164827fe,0x2105a79927d91e3e,0xa44826c2a73ba2d7,0x25cb2584a47226a7,0xa332a725266da4c4,0xa77721c2a472a6a7,0x27fa18b51cb227ea,0x18b5a7fa27d99e3e,0xa49b268aa788a164,0x26f623e39e3e27d9,0xa27ca75025eda55f,0xa68a249ba6a7a472,0x27f11bd61fc627c3
.quad 0x9d79a7e226a7a472,0xa4ec264fa7c39fc6,0x27b620441e3e27d9,0xa1c2a777255fa5ed,0xa53a260fa7d99e3e,0x27e21d7921642788,0xa27ca7502472a6a7,0xa53a260fa7ea9cb2,0x27ff1248247226a7,0xa105a79924c4a66d,0xa3322725a7d91e3e,0x27ce1f0322d7273b,0xa4eca64f1e3ea7d9,0xa58425cba7fe9648,0x27ce9f0326a72472,0xa044a7b6241da6dd
.quad 0x9f0327cea6a72472,0x27b62044241d26dd,0xa64fa4ec9e3ea7d9,0xa5cb2584a7fe1648,0x2725a33227d91e3e,0x9f03a7ce22d7a73b,0x124827ffa47226a7,0x2799210524c4266d,0xa750a27ca472a6a7,0xa60f253aa7ea1cb2,0x260fa53a27d99e3e,0x9d79a7e22164a788,0x204427b69e3e27d9,0x277721c2255f25ed,0xa7e29d79a6a7a472,0xa64f24eca7c31fc6
.quad 0x249ba68a26a7a472,0x9bd6a7f11fc6a7c3,0x23e326f61e3e27d9,0x2750227c25ed255f,0xa7fa18b5a7d99e3e,0xa68a249ba7882164,0x21c2a7772472a6a7,0x98b5a7fa1cb2a7ea,0x258425cb247226a7,0x27252332266d24c4,0xa7992105a7d91e3e,0xa6c22448a73b22d7,0x1bd6a7f11e3ea7d9,0x9248a7ff1648a7fe,0x26c2244826a72472,0x26f623e326dd241d
.quad 0x23322725a70e238b,0xa27ca750273ba2d7,0xa7e29d791a46a7f6,0x279921059fc627c3,0x25cba584262f2513,0xa6f623e3a4c4a66d,0x1bd627f1a7a820a5,0x1f03a7ce27fe1648,0xa6f6a3e320a5a7a8,0x249b268aa55f25ed,0x2750a27c2513262f,0xa7f19bd69cb2a7ea,0x9f0327cea7f61a46,0x260fa53a26dd241d,0xa53aa60f238ba70e,0x924827ffa7882164
.quad 0x27fa98b5238b270e,0xa5cba5842164a788,0xa44826c2a7f69a46,0x27fa98b5241d26dd,0xa1c2a7772513a62f,0xa4ec264fa7ea9cb2,0x27b6204420a527a8,0x9d79a7e225eda55f,0xa64f24eca7a8a0a5,0x26c22448164827fe,0x9248a7ff262fa513,0xa7b62044a66da4c4,0x268a249b1a4627f6,0x2332a72527c39fc6,0xa7992105a70ea38b,0x21c22777a2d7273b
.quad 0x2105a799270ea38b,0xa777a1c2a2d7a73b,0x249b268a9a4627f6,0x2725a33227c31fc6,0xa7ff9248a62fa513,0xa04427b6a66d24c4,0x24eca64f27a8a0a5,0xa448a6c21648a7fe,0x204427b6a0a527a8,0x27e21d7925ed255f,0xa777a1c2a513a62f,0xa64f24eca7ea1cb2,0x26c2a44827f69a46,0x18b5a7fa241da6dd,0x98b527faa38b270e,0x258425cb21642788
.quad 0xa60fa53aa38ba70e,0xa7ff1248a788a164,0x27ce9f0327f61a46,0x253aa60f26dda41d,0xa27c2750a513262f,0x1bd627f19cb227ea,0xa3e3a6f6a0a5a7a8,0xa68aa49ba55fa5ed,0x27f11bd627a820a5,0x27ce9f0327fe9648,0xa58425cba62f2513,0xa3e326f6a4c4266d,0x9d79a7e29a46a7f6,0xa105a7999fc6a7c3,0x27252332270e238b,0x2750227c273b22d7
.quad 0x21c22777a764221f,0xa105a7992788a164,0xa725a332221fa764,0x268a249ba41d26dd,0x27b6a044221f2764,0xa7ff12489cb2a7ea,0xa44826c2a764a21f,0x264fa4ec25ed255f,0x9d79a7e22764a21f,0xa04427b6a7fe9648,0x264f24eca21f2764,0xa1c2a777266da4c4,0xa7fa18b5a21fa764,0x26c224489fc627c3,0x2584a5cb2764221f,0xa7fa18b5a2d7a73b
.quad 0x924827ffa764221f,0x260fa53a273b22d7,0xa53aa60f221fa764,0x9f0327cea7c31fc6,0x27f11bd6221f2764,0xa27ca75024c4a66d,0xa68a249ba764a21f,0x26f623e3164827fe,0x1f03a7ce2764a21f,0xa7f11bd6a55fa5ed,0x23e326f6a21f2764,0x25cba58427ea1cb2,0xa799a105a21fa764,0x9d7927e2a6dd241d,0x2750a27c2764221f,0xa332a7252164a788
.quad 0xa27c2750a764221f,0x2725233221642788,0xa105a799221fa764,0xa7e21d79a6dda41d,0x26f623e3221f2764,0x2584a5cb27ea9cb2,0xa7ce1f03a764a21f,0x9bd627f1a55f25ed,0x249ba68a2764a21f,0xa3e3a6f61648a7fe,0x1bd627f1a21f2764,0x2750227c24c4266d,0xa60fa53aa21fa764,0xa7ce1f03a7c39fc6,0x27ff92482764221f,0x253aa60f273ba2d7
.quad 0xa5cb2584a764221f,0x98b527faa2d7273b,0x18b5a7fa221fa764,0xa448a6c29fc6a7c3,0x24ec264f221f2764,0x277721c2266d24c4,0xa7e29d79a764a21f,0xa7b62044a7fe1648,0x26c2a4482764a21f,0x24eca64f25eda55f,0xa04427b6a21f2764,0x924827ff9cb227ea,0xa332a725a21fa764,0xa49ba68aa41da6dd,0x277721c22764221f,0x2799210527882164
.quad 0x204427b6a7a820a5,0x9f03a7ce27c39fc6,0xa5cba5842513a62f,0x24ec264fa5ed255f,0x27ce1f039a4627f6,0xa725a3322164a788,0xa7992105a38ba70e,0x27ff12481cb227ea,0x253aa60f270e238b,0xa750227ca4c4a66d,0x9d7927e2a7f61a46,0x253aa60f273b22d7,0xa1c2a777262fa513,0xa04427b6a7fe1648,0x264f24eca0a527a8,0x9d79a7e226dda41d
.quad 0xa7f19bd6a0a5a7a8,0x249b268aa41d26dd,0x2750a27c262f2513,0xa6f6a3e31648a7fe,0xa49b268aa7f69a46,0x27fa18b522d7273b,0x18b5a7fa270ea38b,0xa77721c2a66da4c4,0x23322725a38b270e,0x2584a5cb27ea1cb2,0xa6c2a4489a46a7f6,0xa1052799a7882164,0x27ff12482513262f,0x9bd6a7f1255fa5ed,0xa6f623e3a7a8a0a5,0x244826c29fc627c3
.quad 0x23e3a6f627a8a0a5,0xa6c2a4489fc6a7c3,0x124827ffa513262f,0x27f11bd6255f25ed,0xa448a6c21a46a7f6,0xa7992105a788a164,0x27252332238b270e,0x25cba58427ea9cb2,0xa7fa18b5a70ea38b,0xa1c22777a66d24c4,0x268aa49b27f69a46,0x98b5a7fa22d7a73b,0xa27c2750a62f2513,0x23e326f6164827fe,0x9bd6a7f120a5a7a8,0xa68aa49ba41da6dd
.quad 0x24ec264f20a527a8,0x27e21d7926dd241d,0xa777a1c2a62fa513,0xa7b62044a7fe9648,0x27e29d7927f61a46,0x260fa53a273ba2d7,0xa60f253aa70e238b,0xa27c2750a4c4266d,0x2105a799238ba70e,0x9248a7ff1cb2a7ea,0x1f0327ce1a4627f6,0x2332272521642788,0xa584a5cba513a62f,0xa64fa4eca5eda55f,0x27b6204427a820a5,0x27ce1f0327c31fc6
.quad 0x1d7927e2a7d91e3e,0x9bd6a7f127ea9cb2,0xa3e3a6f626a7a472,0x21c22777a73b22d7,0x260f253aa47226a7,0xa49ba68a25eda55f,0xa777a1c21e3ea7d9,0x260f253aa41d26dd,0x27ff12481e3e27d9,0xa725a3321fc6a7c3,0xa7992105a472a6a7,0x27ce1f03164827fe,0x264fa4ec26a72472,0xa7ff1248a164a788,0xa44826c2a7d99e3e,0x27b6a04424c4266d
.quad 0x1f03a7ce27d99e3e,0xa6f623e3a66da4c4,0x1bd627f1a6a72472,0x25cba58427882164,0xa332a7252472a6a7,0xa44826c2a7fe9648,0x25cb25849e3e27d9,0x2105a79927c39fc6,0xa750a27c9e3ea7d9,0x98b527faa6dd241d,0x27fa18b5247226a7,0x9d79a7e2255fa5ed,0xa7b62044a6a7a472,0x227c2750a2d7273b,0x268aa49b27d91e3e,0xa4eca64f1cb2a7ea
.quad 0xa49b268aa7d91e3e,0x264f24ec1cb227ea,0x2044a7b626a7a472,0xa750a27ca2d7a73b,0x18b527faa47226a7,0x27e21d79255f25ed,0xa27ca7501e3ea7d9,0xa7fa18b5a6dda41d,0x258425cb1e3e27d9,0x2799a10527c31fc6,0xa725a332a472a6a7,0xa6c22448a7fe1648,0x27f11bd626a72472,0x2584a5cb2788a164,0xa7ce1f03a7d99e3e,0xa3e326f6a66d24c4
.quad 0x26c2a44827d99e3e,0x2044a7b624c4a66d,0xa4ec264fa6a72472,0x924827ffa1642788,0x2105a7992472a6a7,0x9f03a7ce1648a7fe,0x124827ff9e3e27d9,0x233227251fc627c3,0xa1c2a7779e3ea7d9,0xa53aa60fa41da6dd,0x253a260f247226a7,0x268a249b25ed255f,0xa6f6a3e3a6a7a472,0xa777a1c2a73ba2d7,0x27e21d7927d91e3e,0x27f11bd627ea1cb2
.quad 0x18b527faa7f61a46,0x9248a7ff27fe9648,0x9f03a7ce27a8a0a5,0x18b527faa7ea1cb2,0x21c22777a70e238b,0x9bd6a7f127c39fc6,0xa3e3a6f6262fa513,0x1d7927e2a7882164,0x24ec264fa513262f,0x9f03a7ce273ba2d7,0xa5cba584238ba70e,0x204427b6a6dd241d,0x268a249ba0a527a8,0xa105a799266da4c4,0xa725a3321a46a7f6,0x21c22777a5ed255f
.quad 0x279921051a4627f6,0xa27ca750255fa5ed,0xa7e29d79a0a5a7a8,0x23322725a4c4266d,0x27ff1248238b270e,0xa3e3a6f6241da6dd,0xa7f11bd6a513a62f,0x244826c2a2d7273b,0x27b6a044262f2513,0xa49ba68a2164a788,0xa750227ca70ea38b,0x24ec264f9fc627c3,0x26c2a44827a820a5,0xa53aa60f1cb2a7ea,0xa60f253aa7f69a46,0x258425cb964827fe
.quad 0x253aa60f27f69a46,0xa5cba5849648a7fe,0xa44826c2a7a820a5,0x260f253a1cb227ea,0x227ca750270ea38b,0xa64fa4ec9fc6a7c3,0xa04427b6a62f2513,0x268a249b21642788,0x1bd6a7f12513a62f,0xa6c2a448a2d7a73b,0x124827ffa38b270e,0x26f623e3241d26dd,0x9d79a7e220a5a7a8,0xa725a332a4c4a66d,0x210527999a4627f6,0x2750227c255f25ed
.quad 0xa332a7259a46a7f6,0xa777a1c2a5eda55f,0x249b268a20a527a8,0x27992105266d24c4,0xa584a5cba38ba70e,0xa7b6a044a6dda41d,0x264f24ec2513262f,0x27ce1f03273b22d7,0xa6f6a3e3a62fa513,0xa7e29d79a788a164,0x277721c2270e238b,0x27f11bd627c31fc6,0xa7ce9f03a7a8a0a5,0xa7fa98b5a7ea9cb2,0x27fa18b527f61a46,0x27ff124827fe1648
.quad 0x3400340034003400,0x3400340034003400,0,0,0x35a8000034003400,0xb5a83400b400,0,0,0x3400b40034003400,0xb4003400b400b400,0,0,0xb5a834003400,0x35a80000b4003400,0,0
.quad 0xb400b40034003400,0xb400b40034003400,0,0,0xb5a8800034003400,0x800035a83400b400,0,0,0xb400340034003400,0x3400b400b400b400,0,0,0x800035a834003400,0xb5a88000b4003400,0,0
.quad 0,0,0x3400340034003400,0x3400340034003400,0,0,0x353ab054353a3054,0xb054b53a3054b53a,0,0,0xb5a835a80000,0x800035a8b5a88000,0,0,0xb53ab054353ab054,0x3054b53a3054353a
.quad 0,0,0xb40034003400b400,0xb40034003400b400,0,0,0x3054353a3054b53a,0x353ab054b53ab054,0,0,0x35a800000000b5a8,0xb5a88000800035a8,0,0,0x3054b53ab054b53a,0x353a3054353ab054
.quad 0x34003400,0,0,0,0xb400b400,0,0,0,0x34003400,0,0,0,0xb400b400,0,0,0
.quad 0x34003400,0,0,0,0xb400b400,0,0,0,0x34003400,0,0,0,0xb400b400,0,0,0
.quad 0,0,0,0,0,0,0,0,0,0,0,0,0,0,0,0
.quad 0,0,0,0,0,0,0,0,0,0,0,0,0,0,0,0
.quad 0x3400340034003400,0x3400340034003400,0xb4003400b4003400,0xb4003400b4003400,0x35a89471340333fa,0x9471b5a833fab403,0x147135a8b3fa3403,0x35a89471340333fa,0x33f3b406340633f3,0xb3f33406b406b3f3,0x340633f3b3f33406,0xb406b3f333f3b406,0x9aaab5a8340933ed,0x35a89aaab3ed3409,0x35a89aaab3ed3409,0x1aaa35a8b409b3ed
.quad 0xb40cb3e7340c33e7,0xb40cb3e7340c33e7,0x33e7b40cb3e7340c,0x33e7b40cb3e7340c,0xb5a81d8e341033e0,0x1d8e35a833e0b410,0x9d8eb5a8b3e03410,0xb5a81d8e341033e0,0xb3da3413341333da,0x33dab413b413b3da,0xb413b3dab3da3413,0x341333da33dab413,0x1fc635a8341633d4,0xb5a81fc6b3d43416,0xb5a81fc6b3d43416,0x9fc6b5a8b416b3d4
.quad 0x3400340034003400,0x3400340034003400,0xb4003400b4003400,0xb4003400b4003400,0xb5a81471b403b3fa,0x147135a8b3fa3403,0x9471b5a833fab403,0xb5a81471b403b3fa,0x33f3b406340633f3,0xb3f33406b406b3f3,0x340633f3b3f33406,0xb406b3f333f3b406,0x1aaa35a8b409b3ed,0xb5a81aaa33edb409,0xb5a81aaa33edb409,0x9aaab5a8340933ed
.quad 0xb40cb3e7340c33e7,0xb40cb3e7340c33e7,0x33e7b40cb3e7340c,0x33e7b40cb3e7340c,0x35a89d8eb410b3e0,0x9d8eb5a8b3e03410,0x1d8e35a833e0b410,0x35a89d8eb410b3e0,0xb3da3413341333da,0x33dab413b413b3da,0xb413b3dab3da3413,0x341333da33dab413,0x9fc6b5a8b416b3d4,0x35a89fc633d4b416,0x35a89fc633d4b416,0x1fc635a8341633d4
.quad 0,0,0,0,0,0,0,0,0,0,0,0,0,0,0,0
.quad 0,0,0,0,0,0,0,0,0,0,0,0,0,0,0,0
.quad 0,0,0,0,0,0,0,0,0,0,0,0,0,0,0,0
.quad 0,0,0,0,0,0,0,0,0,0,0,0,0,0,0,0
.quad 0x3400340034003400,0x3400340034003400,0xb4003400b4003400,0xb4003400b4003400,0x35a89871340633f3,0x9871b5a833f3b406,0x187135a8b3f33406,0x35a89871340633f3,0x33e7b40c340c33e7,0xb3e7340cb40cb3e7,0x340c33e7b3e7340c,0xb40cb3e733e7b40c,0x9eaab5a8341333da,0x35a89eaab3da3413,0x35a89eaab3da3413,0x1eaa35a8b413b3da
.quad 0xb419b3cd341933cd,0xb419b3cd341933cd,0x33cdb419b3cd3419,0x33cdb419b3cd3419,0xb5a7218d341f33c0,0x218d35a733c0b41f,0xa18db5a7b3c0341f,0xb5a7218d341f33c0,0xb3b33425342533b3,0x33b3b425b425b3b3,0xb425b3b3b3b33425,0x342533b333b3b425,0x23c635a7342b33a6,0xb5a723c6b3a6342b,0xb5a723c6b3a6342b,0xa3c6b5a7b42bb3a6
.quad 0x3400340034003400,0x3400340034003400,0xb4003400b4003400,0xb4003400b4003400,0xb5a81871b406b3f3,0x187135a8b3f33406,0x9871b5a833f3b406,0xb5a81871b406b3f3,0x33e7b40c340c33e7,0xb3e7340cb40cb3e7,0x340c33e7b3e7340c,0xb40cb3e733e7b40c,0x1eaa35a8b413b3da,0xb5a81eaa33dab413,0xb5a81eaa33dab413,0x9eaab5a8341333da
.quad 0xb419b3cd341933cd,0xb419b3cd341933cd,0x33cdb419b3cd3419,0x33cdb419b3cd3419,0x35a7a18db41fb3c0,0xa18db5a7b3c0341f,0x218d35a733c0b41f,0x35a7a18db41fb3c0,0xb3b33425342533b3,0x33b3b425b425b3b3,0xb425b3b3b3b33425,0x342533b333b3b425,0xa3c6b5a7b42bb3a6,0x35a7a3c633a6b42b,0x35a7a3c633a6b42b,0x23c635a7342b33a6
.quad 0,0,0,0,0,0,0,0,0,0,0,0,0,0,0,0
.quad 0,0,0,0,0,0,0,0,0,0,0,0,0,0,0,0
.quad 0,0,0,0,0,0,0,0,0,0,0,0,0,0,0,0
.quad 0,0,0,0,0,0,0,0,0,0,0,0,0,0,0,0
.quad 0x3400340034003400,0x3400340034003400,0xb4003400b4003400,0xb4003400b4003400,0x35a89aaa340933ed,0x9aaab5a833edb409,0x1aaa35a8b3ed3409,0x35a89aaa340933ed,0x33dab413341333da,0xb3da3413b413b3da,0x341333dab3da3413,0xb413b3da33dab413,0xa0ffb5a8341c33c7,0x35a8a0ffb3c7341c,0x35a8a0ffb3c7341c,0x20ff35a8b41cb3c7
.quad 0xb425b3b3342533b3,0xb425b3b3342533b3,0x33b3b425b3b33425,0x33b3b425b3b33425,0xb5a7242a342e33a0,0x242a35a733a0b42e,0xa42ab5a7b3a0342e,0xb5a7242a342e33a0,0xb38c34373437338c,0x338cb437b437b38c,0xb437b38cb38c3437,0x3437338c338cb437,0x25d435a534403378,0xb5a525d4b3783440,0xb5a525d4b3783440,0xa5d4b5a5b440b378
.quad 0x3400340034003400,0x3400340034003400,0xb4003400b4003400,0xb4003400b4003400,0xb5a81aaab409b3ed,0x1aaa35a8b3ed3409,0x9aaab5a833edb409,0xb5a81aaab409b3ed,0x33dab413341333da,0xb3da3413b413b3da,0x341333dab3da3413,0xb413b3da33dab413,0x20ff35a8b41cb3c7,0xb5a820ff33c7b41c,0xb5a820ff33c7b41c,0xa0ffb5a8341c33c7
.quad 0xb425b3b3342533b3,0xb425b3b3342533b3,0x33b3b425b3b33425,0x33b3b425b3b33425,0x35a7a42ab42eb3a0,0xa42ab5a7b3a0342e,0x242a35a733a0b42e,0x35a7a42ab42eb3a0,0xb38c34373437338c,0x338cb437b437b38c,0xb437b38cb38c3437,0x3437338c338cb437,0xa5d4b5a5b440b378,0x35a5a5d43378b440,0x35a5a5d43378b440,0x25d435a534403378
.quad 0,0,0,0,0,0,0,0,0,0,0,0,0,0,0,0
.quad 0,0,0,0,0,0,0,0,0,0,0,0,0,0,0,0
.quad 0,0,0,0,0,0,0,0,0,0,0,0,0,0,0,0
.quad 0,0,0,0,0,0,0,0,0,0,0,0,0,0,0,0
.quad 0x3400340034003400,0x3400340034003400,0xb4003400b4003400,0xb4003400b4003400,0x35a89c71340c33e7,0x9c71b5a833e7b40c,0x1c7135a8b3e7340c,0x35a89c71340c33e7,0x33cdb419341933cd,0xb3cd3419b419b3cd,0x341933cdb3cd3419,0xb419b3cd33cdb419,0xa2aab5a7342533b3,0x35a7a2aab3b33425,0x35a7a2aab3b33425,0x22aa35a7b425b3b3
.quad 0xb431b39934313399,0xb431b39934313399,0x3399b431b3993431,0x3399b431b3993431,0xb5a5258d343d337f,0x258d35a5337fb43d,0xa58db5a5b37f343d,0xb5a5258d343d337f,0xb364344934493364,0x3364b449b449b364,0xb449b364b3643449,0x344933643364b449,0x27c435a334543349,0xb5a327c4b3493454,0xb5a327c4b3493454,0xa7c4b5a3b454b349
.quad 0x3400340034003400,0x3400340034003400,0xb4003400b4003400,0xb4003400b4003400,0xb5a81c71b40cb3e7,0x1c7135a8b3e7340c,0x9c71b5a833e7b40c,0xb5a81c71b40cb3e7,0x33cdb419341933cd,0xb3cd3419b419b3cd,0x341933cdb3cd3419,0xb419b3cd33cdb419,0x22aa35a7b425b3b3,0xb5a722aa33b3b425,0xb5a722aa33b3b425,0xa2aab5a7342533b3
.quad 0xb431b39934313399,0xb431b39934313399,0x3399b431b3993431,0x3399b431b3993431,0x35a5a58db43db37f,0xa58db5a5b37f343d,0x258d35a5337fb43d,0x35a5a58db43db37f,0xb364344934493364,0x3364b449b449b364,0xb449b364b3643449,0x344933643364b449,0xa7c4b5a3b454b349,0x35a3a7c43349b454,0x35a3a7c43349b454,0x27c435a334543349
.quad 0,0,0,0,0,0,0,0,0,0,0,0,0,0,0,0
.quad 0,0,0,0,0,0,0,0,0,0,0,0,0,0,0,0
.quad 0,0,0,0,0,0,0,0,0,0,0,0,0,0,0,0
.quad 0,0,0,0,0,0,0,0,0,0,0,0,0,0,0,0
.quad 0x3400340034003400,0x3400340034003400,0xb4003400b4003400,0xb4003400b4003400,0x35a89d8e341033e0,0x9d8eb5a833e0b410,0x1d8e35a8b3e03410,0x35a89d8e341033e0,0x33c0b41f341f33c0,0xb3c0341fb41fb3c0,0x341f33c0b3c0341f,0xb41fb3c033c0b41f,0xa42ab5a7342e33a0,0x35a7a42ab3a0342e,0x35a7a42ab3a0342e,0x242a35a7b42eb3a0
.quad 0xb43db37f343d337f,0xb43db37f343d337f,0x337fb43db37f343d,0x337fb43db37f343d,0xb5a426ef344b335d,0x26ef35a4335db44b,0xa6efb5a4b35d344b,0xb5a426ef344b335d,0xb33b345a345a333b,0x333bb45ab45ab33b,0xb45ab33bb33b345a,0x345a333b333bb45a,0x28da35a034683319,0xb5a028dab3193468,0xb5a028dab3193468,0xa8dab5a0b468b319
.quad 0x3400340034003400,0x3400340034003400,0xb4003400b4003400,0xb4003400b4003400,0xb5a81d8eb410b3e0,0x1d8e35a8b3e03410,0x9d8eb5a833e0b410,0xb5a81d8eb410b3e0,0x33c0b41f341f33c0,0xb3c0341fb41fb3c0,0x341f33c0b3c0341f,0xb41fb3c033c0b41f,0x242a35a7b42eb3a0,0xb5a7242a33a0b42e,0xb5a7242a33a0b42e,0xa42ab5a7342e33a0
.quad 0xb43db37f343d337f,0xb43db37f343d337f,0x337fb43db37f343d,0x337fb43db37f343d,0x35a4a6efb44bb35d,0xa6efb5a4b35d344b,0x26ef35a4335db44b,0x35a4a6efb44bb35d,0xb33b345a345a333b,0x333bb45ab45ab33b,0xb45ab33bb33b345a,0x345a333b333bb45a,0xa8dab5a0b468b319,0x35a0a8da3319b468,0x35a0a8da3319b468,0x28da35a034683319
.quad 0,0,0,0,0,0,0,0,0,0,0,0,0,0,0,0
.quad 0,0,0,0,0,0,0,0,0,0,0,0,0,0,0,0
.quad 0,0,0,0,0,0,0,0,0,0,0,0,0,0,0,0
.quad 0,0,0,0,0,0,0,0,0,0,0,0,0,0,0,0
.quad 0x3400340034003400,0x3400340034003400,0xb4003400b4003400,0xb4003400b4003400,0x35a89eaa341333da,0x9eaab5a833dab413,0x1eaa35a8b3da3413,0x35a89eaa341333da,0x33b3b425342533b3,0xb3b33425b425b3b3,0x342533b3b3b33425,0xb425b3b333b3b425,0xa4ffb5a63437338c,0x35a6a4ffb38c3437,0x35a6a4ffb38c3437,0x24ff35a6b437b38c
.quad 0xb449b36434493364,0xb449b36434493364,0x3364b449b3643449,0x3364b449b3643449,0xb5a22829345a333b,0x282935a2333bb45a,0xa829b5a2b33b345a,0xb5a22829345a333b,0xb312346b346b3312,0x3312b46bb46bb312,0xb46bb312b312346b,0x346b33123312b46b,0x29d1359c347b32e8,0xb59c29d1b2e8347b,0xb59c29d1b2e8347b,0xa9d1b59cb47bb2e8
.quad 0x3400340034003400,0x3400340034003400,0xb4003400b4003400,0xb4003400b4003400,0xb5a81eaab413b3da,0x1eaa35a8b3da3413,0x9eaab5a833dab413,0xb5a81eaab413b3da,0x33b3b425342533b3,0xb3b33425b425b3b3,0x342533b3b3b33425,0xb425b3b333b3b425,0x24ff35a6b437b38c,0xb5a624ff338cb437,0xb5a624ff338cb437,0xa4ffb5a63437338c
.quad 0xb449b36434493364,0xb449b36434493364,0x3364b449b3643449,0x3364b449b3643449,0x35a2a829b45ab33b,0xa829b5a2b33b345a,0x282935a2333bb45a,0x35a2a829b45ab33b,0xb312346b346b3312,0x3312b46bb46bb312,0xb46bb312b312346b,0x346b33123312b46b,0xa9d1b59cb47bb2e8,0x359ca9d132e8b47b,0x359ca9d132e8b47b,0x29d1359c347b32e8
.quad 0,0,0,0,0,0,0,0,0,0,0,0,0,0,0,0
.quad 0,0,0,0,0,0,0,0,0,0,0,0,0,0,0,0
.quad 0,0,0,0,0,0,0,0,0,0,0,0,0,0,0,0
.quad 0,0,0,0,0,0,0,0,0,0,0,0,0,0,0,0
.quad 0x3400340034003400,0x3400340034003400,0xb4003400b4003400,0xb4003400b4003400,0x35a89fc6341633d4,0x9fc6b5a833d4b416,0x1fc635a8b3d43416,0x35a89fc6341633d4,0x33a6b42b342b33a6,0xb3a6342bb42bb3a6,0x342b33a6b3a6342b,0xb42bb3a633a6b42b,0xa5d4b5a534403378,0x35a5a5d4b3783440,0x35a5a5d4b3783440,0x25d435a5b440b378
.quad 0xb454b34934543349,0xb454b34934543349,0x3349b454b3493454,0x3349b454b3493454,0xb5a028da34683319,0x28da35a03319b468,0xa8dab5a0b3193468,0xb5a028da34683319,0xb2e8347b347b32e8,0x32e8b47bb47bb2e8,0xb47bb2e8b2e8347b,0x347b32e832e8b47b,0x2ac73598348e32b6,0xb5982ac7b2b6348e,0xb5982ac7b2b6348e,0xaac7b598b48eb2b6
.quad 0x3400340034003400,0x3400340034003400,0xb4003400b4003400,0xb4003400b4003400,0xb5a81fc6b416b3d4,0x1fc635a8b3d43416,0x9fc6b5a833d4b416,0xb5a81fc6b416b3d4,0x33a6b42b342b33a6,0xb3a6342bb42bb3a6,0x342b33a6b3a6342b,0xb42bb3a633a6b42b,0x25d435a5b440b378,0xb5a525d43378b440,0xb5a525d43378b440,0xa5d4b5a534403378
.quad 0xb454b34934543349,0xb454b34934543349,0x3349b454b3493454,0x3349b454b3493454,0x35a0a8dab468b319,0xa8dab5a0b3193468,0x28da35a03319b468,0x35a0a8dab468b319,0xb2e8347b347b32e8,0x32e8b47bb47bb2e8,0xb47bb2e8b2e8347b,0x347b32e832e8b47b,0xaac7b598b48eb2b6,0x3598aac732b6b48e,0x3598aac732b6b48e,0x2ac73598348e32b6
.quad 0,0,0,0,0,0,0,0,0,0,0,0,0,0,0,0
.quad 0,0,0,0,0,0,0,0,0,0,0,0,0,0,0,0
.quad 0,0,0,0,0,0,0,0,0,0,0,0,0,0,0,0
.quad 0,0,0,0,0,0,0,0,0,0,0,0,0,0,0,0
.quad 0x3400340034003400,0x3400340034003400,0xb4003400b4003400,0xb4003400b4003400,0x35a8a071341933cd,0xa071b5a833cdb419,0x207135a8b3cd3419,0x35a8a071341933cd,0x3399b43134313399,0xb3993431b431b399,0x34313399b3993431,0xb431b3993399b431,0xa6a9b5a434493364,0x35a4a6a9b3643449,0x35a4a6a9b3643449,0x26a935a4b449b364
.quad 0xb45fb32d345f332d,0xb45fb32d345f332d,0x332db45fb32d345f,0x332db45fb32d345f,0xb59d298a347632f6,0x298a359d32f6b476,0xa98ab59db2f63476,0xb59d298a347632f6,0xb2bd348b348b32bd,0x32bdb48bb48bb2bd,0xb48bb2bdb2bd348b,0x348b32bd32bdb48b,0x2bbd359334a03284,0xb5932bbdb28434a0,0xb5932bbdb28434a0,0xabbdb593b4a0b284
.quad 0x3400340034003400,0x3400340034003400,0xb4003400b4003400,0xb4003400b4003400,0xb5a82071b419b3cd,0x207135a8b3cd3419,0xa071b5a833cdb419,0xb5a82071b419b3cd,0x3399b43134313399,0xb3993431b431b399,0x34313399b3993431,0xb431b3993399b431,0x26a935a4b449b364,0xb5a426a93364b449,0xb5a426a93364b449,0xa6a9b5a434493364
.quad 0xb45fb32d345f332d,0xb45fb32d345f332d,0x332db45fb32d345f,0x332db45fb32d345f,0x359da98ab476b2f6,0xa98ab59db2f63476,0x298a359d32f6b476,0x359da98ab476b2f6,0xb2bd348b348b32bd,0x32bdb48bb48bb2bd,0xb48bb2bdb2bd348b,0x348b32bd32bdb48b,0xabbdb593b4a0b284,0x3593abbd3284b4a0,0x3593abbd3284b4a0,0x2bbd359334a03284
.quad 0,0,0,0,0,0,0,0,0,0,0,0,0,0,0,0
.quad 0,0,0,0,0,0,0,0,0,0,0,0,0,0,0,0
.quad 0,0,0,0,0,0,0,0,0,0,0,0,0,0,0,0
.quad 0,0,0,0,0,0,0,0,0,0,0,0,0,0,0,0
.quad 0x3400340034003400,0x3400340034003400,0xb4003400b4003400,0xb4003400b4003400,0x35a8a0ff341c33c7,0xa0ffb5a833c7b41c,0x20ff35a8b3c7341c,0x35a8a0ff341c33c7,0x338cb4373437338c,0xb38c3437b437b38c,0x3437338cb38c3437,0xb437b38c338cb437,0xa77db5a334513350,0x35a3a77db3503451,0x35a3a77db3503451,0x277d35a3b451b350
.quad 0xb46bb312346b3312,0xb46bb312346b3312,0x3312b46bb312346b,0x3312b46bb312346b,0xb59a2a3a348332d3,0x2a3a359a32d3b483,0xaa3ab59ab2d33483,0xb59a2a3a348332d3,0xb292349b349b3292,0x3292b49bb49bb292,0xb49bb292b292349b,0x349b32923292b49b,0x2c59358d34b23250,0xb58d2c59b25034b2,0xb58d2c59b25034b2,0xac59b58db4b2b250
.quad 0x3400340034003400,0x3400340034003400,0xb4003400b4003400,0xb4003400b4003400,0xb5a820ffb41cb3c7,0x20ff35a8b3c7341c,0xa0ffb5a833c7b41c,0xb5a820ffb41cb3c7,0x338cb4373437338c,0xb38c3437b437b38c,0x3437338cb38c3437,0xb437b38c338cb437,0x277d35a3b451b350,0xb5a3277d3350b451,0xb5a3277d3350b451,0xa77db5a334513350
.quad 0xb46bb312346b3312,0xb46bb312346b3312,0x3312b46bb312346b,0x3312b46bb312346b,0x359aaa3ab483b2d3,0xaa3ab59ab2d33483,0x2a3a359a32d3b483,0x359aaa3ab483b2d3,0xb292349b349b3292,0x3292b49bb49bb292,0xb49bb292b292349b,0x349b32923292b49b,0xac59b58db4b2b250,0x358dac593250b4b2,0x358dac593250b4b2,0x2c59358d34b23250
.quad 0,0,0,0,0,0,0,0,0,0,0,0,0,0,0,0
.quad 0,0,0,0,0,0,0,0,0,0,0,0,0,0,0,0
.quad 0,0,0,0,0,0,0,0,0,0,0,0,0,0,0,0
.quad 0,0,0,0,0,0,0,0,0,0,0,0,0,0,0,0
.quad 0x3400340034003400,0x3400340034003400,0xb4003400b4003400,0xb4003400b4003400,0x35a7a18d341f33c0,0xa18db5a733c0b41f,0x218d35a7b3c0341f,0x35a7a18d341f33c0,0x337fb43d343d337f,0xb37f343db43db37f,0x343d337fb37f343d,0xb43db37f337fb43d,0xa829b5a2345a333b,0x35a2a829b33b345a,0x35a2a829b33b345a,0x282935a2b45ab33b
.quad 0xb476b2f6347632f6,0xb476b2f6347632f6,0x32f6b476b2f63476,0x32f6b476b2f63476,0xb5972aea349032af,0x2aea359732afb490,0xaaeab597b2af3490,0xb5972aea349032af,0xb26734aa34aa3267,0x3267b4aab4aab267,0xb4aab267b26734aa,0x34aa32673267b4aa,0x2cd2358734c3321d,0xb5872cd2b21d34c3,0xb5872cd2b21d34c3,0xacd2b587b4c3b21d
.quad 0x3400340034003400,0x3400340034003400,0xb4003400b4003400,0xb4003400b4003400,0xb5a7218db41fb3c0,0x218d35a7b3c0341f,0xa18db5a733c0b41f,0xb5a7218db41fb3c0,0x337fb43d343d337f,0xb37f343db43db37f,0x343d337fb37f343d,0xb43db37f337fb43d,0x282935a2b45ab33b,0xb5a22829333bb45a,0xb5a22829333bb45a,0xa829b5a2345a333b
.quad 0xb476b2f6347632f6,0xb476b2f6347632f6,0x32f6b476b2f63476,0x32f6b476b2f63476,0x3597aaeab490b2af,0xaaeab597b2af3490,0x2aea359732afb490,0x3597aaeab490b2af,0xb26734aa34aa3267,0x3267b4aab4aab267,0xb4aab267b26734aa,0x34aa32673267b4aa,0xacd2b587b4c3b21d,0x3587acd2321db4c3,0x3587acd2321db4c3,0x2cd2358734c3321d
.quad 0,0,0,0,0,0,0,0,0,0,0,0,0,0,0,0
.quad 0,0,0,0,0,0,0,0,0,0,0,0,0,0,0,0
.quad 0,0,0,0,0,0,0,0,0,0,0,0,0,0,0,0
.quad 0,0,0,0,0,0,0,0,0,0,0,0,0,0,0,0
.quad 0x3400340034003400,0x3400340034003400,0xb4003400b4003400,0xb4003400b4003400,0x35a7a21c342233ba,0xa21cb5a733bab422,0x221c35a7b3ba3422,0x35a7a21c342233ba,0x3371b44334433371,0xb3713443b443b371,0x34433371b3713443,0xb443b3713371b443,0xa893b5a134623327,0x35a1a893b3273462,0x35a1a893b3273462,0x289335a1b462b327
.quad 0xb480b2da348032da,0xb480b2da348032da,0x32dab480b2da3480,0x32dab480b2da3480,0xb5942b9a349d328b,0x2b9a3594328bb49d,0xab9ab594b28b349d,0xb5942b9a349d328b,0xb23a34b934b9323a,0x323ab4b9b4b9b23a,0xb4b9b23ab23a34b9,0x34b9323a323ab4b9,0x2d4c358034d331e8,0xb5802d4cb1e834d3,0xb5802d4cb1e834d3,0xad4cb580b4d3b1e8
.quad 0x3400340034003400,0x3400340034003400,0xb4003400b4003400,0xb4003400b4003400,0xb5a7221cb422b3ba,0x221c35a7b3ba3422,0xa21cb5a733bab422,0xb5a7221cb422b3ba,0x3371b44334433371,0xb3713443b443b371,0x34433371b3713443,0xb443b3713371b443,0x289335a1b462b327,0xb5a128933327b462,0xb5a128933327b462,0xa893b5a134623327
.quad 0xb480b2da348032da,0xb480b2da348032da,0x32dab480b2da3480,0x32dab480b2da3480,0x3594ab9ab49db28b,0xab9ab594b28b349d,0x2b9a3594328bb49d,0x3594ab9ab49db28b,0xb23a34b934b9323a,0x323ab4b9b4b9b23a,0xb4b9b23ab23a34b9,0x34b9323a323ab4b9,0xad4cb580b4d3b1e8,0x3580ad4c31e8b4d3,0x3580ad4c31e8b4d3,0x2d4c358034d331e8
.quad 0,0,0,0,0,0,0,0,0,0,0,0,0,0,0,0
.quad 0,0,0,0,0,0,0,0,0,0,0,0,0,0,0,0
.quad 0,0,0,0,0,0,0,0,0,0,0,0,0,0,0,0
.quad 0,0,0,0,0,0,0,0,0,0,0,0,0,0,0,0
.quad 0x3400340034003400,0x3400340034003400,0xb4003400b4003400,0xb4003400b4003400,0x35a7a2aa342533b3,0xa2aab5a733b3b425,0x22aa35a7b3b33425,0x35a7a2aa342533b3,0x3364b44934493364,0xb3643449b449b364,0x34493364b3643449,0xb449b3643364b449,0xa8fdb59f346b3312,0x359fa8fdb312346b,0x359fa8fdb312346b,0x28fd359fb46bb312
.quad 0xb48bb2bd348b32bd,0xb48bb2bd348b32bd,0x32bdb48bb2bd348b,0x32bdb48bb2bd348b,0xb5902c2434aa3267,0x2c2435903267b4aa,0xac24b590b26734aa,0xb5902c2434aa3267,0xb20e34c734c7320e,0x320eb4c7b4c7b20e,0xb4c7b20eb20e34c7,0x34c7320e320eb4c7,0x2dc4357834e331b2,0xb5782dc4b1b234e3,0xb5782dc4b1b234e3,0xadc4b578b4e3b1b2
.quad 0x3400340034003400,0x3400340034003400,0xb4003400b4003400,0xb4003400b4003400,0xb5a722aab425b3b3,0x22aa35a7b3b33425,0xa2aab5a733b3b425,0xb5a722aab425b3b3,0x3364b44934493364,0xb3643449b449b364,0x34493364b3643449,0xb449b3643364b449,0x28fd359fb46bb312,0xb59f28fd3312b46b,0xb59f28fd3312b46b,0xa8fdb59f346b3312
.quad 0xb48bb2bd348b32bd,0xb48bb2bd348b32bd,0x32bdb48bb2bd348b,0x32bdb48bb2bd348b,0x3590ac24b4aab267,0xac24b590b26734aa,0x2c2435903267b4aa,0x3590ac24b4aab267,0xb20e34c734c7320e,0x320eb4c7b4c7b20e,0xb4c7b20eb20e34c7,0x34c7320e320eb4c7,0xadc4b578b4e3b1b2,0x3578adc431b2b4e3,0x3578adc431b2b4e3,0x2dc4357834e331b2
.quad 0,0,0,0,0,0,0,0,0,0,0,0,0,0,0,0
.quad 0,0,0,0,0,0,0,0,0,0,0,0,0,0,0,0
.quad 0,0,0,0,0,0,0,0,0,0,0,0,0,0,0,0
.quad 0,0,0,0,0,0,0,0,0,0,0,0,0,0,0,0
.quad 0x3400340034003400,0x3400340034003400,0xb4003400b4003400,0xb4003400b4003400,0x35a7a338342833ad,0xa338b5a733adb428,0x233835a7b3ad3428,0x35a7a338342833ad,0x3356b44e344e3356,0xb356344eb44eb356,0x344e3356b356344e,0xb44eb3563356b44e,0xa967b59e347332fd,0x359ea967b2fd3473,0x359ea967b2fd3473,0x2967359eb473b2fd
.quad 0xb496b2a1349632a1,0xb496b2a1349632a1,0x32a1b496b2a13496,0x32a1b496b2a13496,0xb58b2c7c34b73242,0x2c7c358b3242b4b7,0xac7cb58bb24234b7,0xb58b2c7c34b73242,0xb1e034d634d631e0,0x31e0b4d6b4d6b1e0,0xb4d6b1e0b1e034d6,0x34d631e031e0b4d6,0x2e3c357034f3317c,0xb5702e3cb17c34f3,0xb5702e3cb17c34f3,0xae3cb570b4f3b17c
.quad 0x3400340034003400,0x3400340034003400,0xb4003400b4003400,0xb4003400b4003400,0xb5a72338b428b3ad,0x233835a7b3ad3428,0xa338b5a733adb428,0xb5a72338b428b3ad,0x3356b44e344e3356,0xb356344eb44eb356,0x344e3356b356344e,0xb44eb3563356b44e,0x2967359eb473b2fd,0xb59e296732fdb473,0xb59e296732fdb473,0xa967b59e347332fd
.quad 0xb496b2a1349632a1,0xb496b2a1349632a1,0x32a1b496b2a13496,0x32a1b496b2a13496,0x358bac7cb4b7b242,0xac7cb58bb24234b7,0x2c7c358b3242b4b7,0x358bac7cb4b7b242,0xb1e034d634d631e0,0x31e0b4d6b4d6b1e0,0xb4d6b1e0b1e034d6,0x34d631e031e0b4d6,0xae3cb570b4f3b17c,0x3570ae3c317cb4f3,0x3570ae3c317cb4f3,0x2e3c357034f3317c
.quad 0,0,0,0,0,0,0,0,0,0,0,0,0,0,0,0
.quad 0,0,0,0,0,0,0,0,0,0,0,0,0,0,0,0
.quad 0,0,0,0,0,0,0,0,0,0,0,0,0,0,0,0
.quad 0,0,0,0,0,0,0,0,0,0,0,0,0,0,0,0
.quad 0x3400340034003400,0x3400340034003400,0xb4003400b4003400,0xb4003400b4003400,0x35a7a3c6342b33a6,0xa3c6b5a733a6b42b,0x23c635a7b3a6342b,0x35a7a3c6342b33a6,0x3349b45434543349,0xb3493454b454b349,0x34543349b3493454,0xb454b3493349b454,0xa9d1b59c347b32e8,0x359ca9d1b2e8347b,0x359ca9d1b2e8347b,0x29d1359cb47bb2e8
.quad 0xb4a0b28434a03284,0xb4a0b28434a03284,0x3284b4a0b28434a0,0x3284b4a0b28434a0,0xb5872cd234c3321d,0x2cd23587321db4c3,0xacd2b587b21d34c3,0xb5872cd234c3321d,0xb1b234e334e331b2,0x31b2b4e3b4e3b1b2,0xb4e3b1b2b1b234e3,0x34e331b231b2b4e3,0x2eb3356735013146,0xb5672eb3b1463501,0xb5672eb3b1463501,0xaeb3b567b501b146
.quad 0x3400340034003400,0x3400340034003400,0xb4003400b4003400,0xb4003400b4003400,0xb5a723c6b42bb3a6,0x23c635a7b3a6342b,0xa3c6b5a733a6b42b,0xb5a723c6b42bb3a6,0x3349b45434543349,0xb3493454b454b349,0x34543349b3493454,0xb454b3493349b454,0x29d1359cb47bb2e8,0xb59c29d132e8b47b,0xb59c29d132e8b47b,0xa9d1b59c347b32e8
.quad 0xb4a0b28434a03284,0xb4a0b28434a03284,0x3284b4a0b28434a0,0x3284b4a0b28434a0,0x3587acd2b4c3b21d,0xacd2b587b21d34c3,0x2cd23587321db4c3,0x3587acd2b4c3b21d,0xb1b234e334e331b2,0x31b2b4e3b4e3b1b2,0xb4e3b1b2b1b234e3,0x34e331b231b2b4e3,0xaeb3b567b501b146,0x3567aeb33146b501,0x3567aeb33146b501,0x2eb3356735013146
.quad 0,0,0,0,0,0,0,0,0,0,0,0,0,0,0,0
.quad 0,0,0,0,0,0,0,0,0,0,0,0,0,0,0,0
.quad 0,0,0,0,0,0,0,0,0,0,0,0,0,0,0,0
.quad 0,0,0,0,0,0,0,0,0,0,0,0,0,0,0,0
.quad 0x3400340034003400,0x3400340034003400,0xb4003400b4003400,0xb4003400b4003400,0x35a7a42a342e33a0,0xa42ab5a733a0b42e,0x242a35a7b3a0342e,0x35a7a42a342e33a0,0x333bb45a345a333b,0xb33b345ab45ab33b,0x345a333bb33b345a,0xb45ab33b333bb45a,0xaa3ab59a348332d3,0x359aaa3ab2d33483,0x359aaa3ab2d33483,0x2a3a359ab483b2d3
.quad 0xb4aab26734aa3267,0xb4aab26734aa3267,0x3267b4aab26734aa,0x3267b4aab26734aa,0xb5822d2934cf31f7,0x2d29358231f7b4cf,0xad29b582b1f734cf,0xb5822d2934cf31f7,0xb18434f034f03184,0x3184b4f0b4f0b184,0xb4f0b184b18434f0,0x34f031843184b4f0,0x2f2a355e3510310e,0xb55e2f2ab10e3510,0xb55e2f2ab10e3510,0xaf2ab55eb510b10e
.quad 0x3400340034003400,0x3400340034003400,0xb4003400b4003400,0xb4003400b4003400,0xb5a7242ab42eb3a0,0x242a35a7b3a0342e,0xa42ab5a733a0b42e,0xb5a7242ab42eb3a0,0x333bb45a345a333b,0xb33b345ab45ab33b,0x345a333bb33b345a,0xb45ab33b333bb45a,0x2a3a359ab483b2d3,0xb59a2a3a32d3b483,0xb59a2a3a32d3b483,0xaa3ab59a348332d3
.quad 0xb4aab26734aa3267,0xb4aab26734aa3267,0x3267b4aab26734aa,0x3267b4aab26734aa,0x3582ad29b4cfb1f7,0xad29b582b1f734cf,0x2d29358231f7b4cf,0x3582ad29b4cfb1f7,0xb18434f034f03184,0x3184b4f0b4f0b184,0xb4f0b184b18434f0,0x34f031843184b4f0,0xaf2ab55eb510b10e,0x355eaf2a310eb510,0x355eaf2a310eb510,0x2f2a355e3510310e
.quad 0,0,0,0,0,0,0,0,0,0,0,0,0,0,0,0
.quad 0,0,0,0,0,0,0,0,0,0,0,0,0,0,0,0
.quad 0,0,0,0,0,0,0,0,0,0,0,0,0,0,0,0
.quad 0,0,0,0,0,0,0,0,0,0,0,0,0,0,0,0
.quad 0x3400340034003400,0x3400340034003400,0xb4003400b4003400,0xb4003400b4003400,0x35a6a47134313399,0xa471b5a63399b431,0x247135a6b3993431,0x35a6a47134313399,0x332db45f345f332d,0xb32d345fb45fb32d,0x345f332db32d345f,0xb45fb32d332db45f,0xaaa4b598348b32bd,0x3598aaa4b2bd348b,0x3598aaa4b2bd348b,0x2aa43598b48bb2bd
.quad 0xb4b4b24934b43249,0xb4b4b24934b43249,0x3249b4b4b24934b4,0x3249b4b4b24934b4,0xb57d2d7f34da31d1,0x2d7f357d31d1b4da,0xad7fb57db1d134da,0xb57d2d7f34da31d1,0xb15534fd34fd3155,0x3155b4fdb4fdb155,0xb4fdb155b15534fd,0x34fd31553155b4fd,0x2f9f3554351d30d6,0xb5542f9fb0d6351d,0xb5542f9fb0d6351d,0xaf9fb554b51db0d6
.quad 0x3400340034003400,0x3400340034003400,0xb4003400b4003400,0xb4003400b4003400,0xb5a62471b431b399,0x247135a6b3993431,0xa471b5a63399b431,0xb5a62471b431b399,0x332db45f345f332d,0xb32d345fb45fb32d,0x345f332db32d345f,0xb45fb32d332db45f,0x2aa43598b48bb2bd,0xb5982aa432bdb48b,0xb5982aa432bdb48b,0xaaa4b598348b32bd
.quad 0xb4b4b24934b43249,0xb4b4b24934b43249,0x3249b4b4b24934b4,0x3249b4b4b24934b4,0x357dad7fb4dab1d1,0xad7fb57db1d134da,0x2d7f357d31d1b4da,0x357dad7fb4dab1d1,0xb15534fd34fd3155,0x3155b4fdb4fdb155,0xb4fdb155b15534fd,0x34fd31553155b4fd,0xaf9fb554b51db0d6,0x3554af9f30d6b51d,0x3554af9f30d6b51d,0x2f9f3554351d30d6
.quad 0,0,0,0,0,0,0,0,0,0,0,0,0,0,0,0
.quad 0,0,0,0,0,0,0,0,0,0,0,0,0,0,0,0
.quad 0,0,0,0,0,0,0,0,0,0,0,0,0,0,0,0
.quad 0,0,0,0,0,0,0,0,0,0,0,0,0,0,0,0
.quad 0x3400340034003400,0x3400340034003400,0xb4003400b4003400,0xb4003400b4003400,0x35a6a4b834343392,0xa4b8b5a63392b434,0x24b835a6b3923434,0x35a6a4b834343392,0x3320b46534653320,0xb3203465b465b320,0x34653320b3203465,0xb465b3203320b465,0xab0db596349332a8,0x3596ab0db2a83493,0x3596ab0db2a83493,0x2b0d3596b493b2a8
.quad 0xb4beb22b34be322b,0xb4beb22b34be322b,0x322bb4beb22b34be,0x322bb4beb22b34be,0xb5772dd634e531ab,0x2dd6357731abb4e5,0xadd6b577b1ab34e5,0xb5772dd634e531ab,0xb126350a350a3126,0x3126b50ab50ab126,0xb50ab126b126350a,0x350a31263126b50a,0x300a3549352a309e,0xb549300ab09e352a,0xb549300ab09e352a,0xb00ab549b52ab09e
.quad 0x3400340034003400,0x3400340034003400,0xb4003400b4003400,0xb4003400b4003400,0xb5a624b8b434b392,0x24b835a6b3923434,0xa4b8b5a63392b434,0xb5a624b8b434b392,0x3320b46534653320,0xb3203465b465b320,0x34653320b3203465,0xb465b3203320b465,0x2b0d3596b493b2a8,0xb5962b0d32a8b493,0xb5962b0d32a8b493,0xab0db596349332a8
.quad 0xb4beb22b34be322b,0xb4beb22b34be322b,0x322bb4beb22b34be,0x322bb4beb22b34be,0x3577add6b4e5b1ab,0xadd6b577b1ab34e5,0x2dd6357731abb4e5,0x3577add6b4e5b1ab,0xb126350a350a3126,0x3126b50ab50ab126,0xb50ab126b126350a,0x350a31263126b50a,0xb00ab549b52ab09e,0x3549b00a309eb52a,0x3549b00a309eb52a,0x300a3549352a309e
.quad 0,0,0,0,0,0,0,0,0,0,0,0,0,0,0,0
.quad 0,0,0,0,0,0,0,0,0,0,0,0,0,0,0,0
.quad 0,0,0,0,0,0,0,0,0,0,0,0,0,0,0,0
.quad 0,0,0,0,0,0,0,0,0,0,0,0,0,0,0,0
.quad 0x3400340034003400,0x3400340034003400,0xb4003400b4003400,0xb4003400b4003400,0x35a6a4ff3437338c,0xa4ffb5a6338cb437,0x24ff35a6b38c3437,0x35a6a4ff3437338c,0x3312b46b346b3312,0xb312346bb46bb312,0x346b3312b312346b,0xb46bb3123312b46b,0xab77b594349b3292,0x3594ab77b292349b,0x3594ab77b292349b,0x2b773594b49bb292
.quad 0xb4c7b20e34c7320e,0xb4c7b20e34c7320e,0x320eb4c7b20e34c7,0x320eb4c7b20e34c7,0xb5712e2b34f03184,0x2e2b35713184b4f0,0xae2bb571b18434f0,0xb5712e2b34f03184,0xb0f63515351530f6,0x30f6b515b515b0f6,0xb515b0f6b0f63515,0x351530f630f6b515,0x3044353d35363065,0xb53d3044b0653536,0xb53d3044b0653536,0xb044b53db536b065
.quad 0x3400340034003400,0x3400340034003400,0xb4003400b4003400,0xb4003400b4003400,0xb5a624ffb437b38c,0x24ff35a6b38c3437,0xa4ffb5a6338cb437,0xb5a624ffb437b38c,0x3312b46b346b3312,0xb312346bb46bb312,0x346b3312b312346b,0xb46bb3123312b46b,0x2b773594b49bb292,0xb5942b773292b49b,0xb5942b773292b49b,0xab77b594349b3292
.quad 0xb4c7b20e34c7320e,0xb4c7b20e34c7320e,0x320eb4c7b20e34c7,0x320eb4c7b20e34c7,0x3571ae2bb4f0b184,0xae2bb571b18434f0,0x2e2b35713184b4f0,0x3571ae2bb4f0b184,0xb0f63515351530f6,0x30f6b515b515b0f6,0xb515b0f6b0f63515,0x351530f630f6b515,0xb044b53db536b065,0x353db0443065b536,0x353db0443065b536,0x3044353d35363065
.quad 0,0,0,0,0,0,0,0,0,0,0,0,0,0,0,0
.quad 0,0,0,0,0,0,0,0,0,0,0,0,0,0,0,0
.quad 0,0,0,0,0,0,0,0,0,0,0,0,0,0,0,0
.quad 0,0,0,0,0,0,0,0,0,0,0,0,0,0,0,0
.quad 0x3400340034003400,0x3400340034003400,0xb4003400b4003400,0xb4003400b4003400,0x35a6a546343a3385,0xa546b5a63385b43a,0x254635a6b385343a,0x35a6a546343a3385,0x3304b47034703304,0xb3043470b470b304,0x34703304b3043470,0xb470b3043304b470,0xabe0b59234a3327c,0x3592abe0b27c34a3,0x3592abe0b27c34a3,0x2be03592b4a3b27c
.quad 0xb4d1b1ef34d131ef,0xb4d1b1ef34d131ef,0x31efb4d1b1ef34d1,0x31efb4d1b1ef34d1,0xb56b2e8034fb315d,0x2e80356b315db4fb,0xae80b56bb15d34fb,0xb56b2e8034fb315d,0xb0c63521352130c6,0x30c6b521b521b0c6,0xb521b0c6b0c63521,0x352130c630c6b521,0x307d35313542302b,0xb531307db02b3542,0xb531307db02b3542,0xb07db531b542b02b
.quad 0x3400340034003400,0x3400340034003400,0xb4003400b4003400,0xb4003400b4003400,0xb5a62546b43ab385,0x254635a6b385343a,0xa546b5a63385b43a,0xb5a62546b43ab385,0x3304b47034703304,0xb3043470b470b304,0x34703304b3043470,0xb470b3043304b470,0x2be03592b4a3b27c,0xb5922be0327cb4a3,0xb5922be0327cb4a3,0xabe0b59234a3327c
.quad 0xb4d1b1ef34d131ef,0xb4d1b1ef34d131ef,0x31efb4d1b1ef34d1,0x31efb4d1b1ef34d1,0x356bae80b4fbb15d,0xae80b56bb15d34fb,0x2e80356b315db4fb,0x356bae80b4fbb15d,0xb0c63521352130c6,0x30c6b521b521b0c6,0xb521b0c6b0c63521,0x352130c630c6b521,0xb07db531b542b02b,0x3531b07d302bb542,0x3531b07d302bb542,0x307d35313542302b
.quad 0,0,0,0,0,0,0,0,0,0,0,0,0,0,0,0
.quad 0,0,0,0,0,0,0,0,0,0,0,0,0,0,0,0
.quad 0,0,0,0,0,0,0,0,0,0,0,0,0,0,0,0
.quad 0,0,0,0,0,0,0,0,0,0,0,0,0,0,0,0
.quad 0x3400340034003400,0x3400340034003400,0xb4003400b4003400,0xb4003400b4003400,0x35a5a58d343d337f,0xa58db5a5337fb43d,0x258d35a5b37f343d,0x35a5a58d343d337f,0x32f6b476347632f6,0xb2f63476b476b2f6,0x347632f6b2f63476,0xb476b2f632f6b476,0xac24b59034aa3267,0x3590ac24b26734aa,0x3590ac24b26734aa,0x2c243590b4aab267
.quad 0xb4dab1d134da31d1,0xb4dab1d134da31d1,0x31d1b4dab1d134da,0x31d1b4dab1d134da,0xb5652ed535053136,0x2ed535653136b505,0xaed5b565b1363505,0xb5652ed535053136,0xb096352c352c3096,0x3096b52cb52cb096,0xb52cb096b096352c,0x352c30963096b52c,0x30b63525354d2fe2,0xb52530b6afe2354d,0xb52530b6afe2354d,0xb0b6b525b54dafe2
.quad 0x3400340034003400,0x3400340034003400,0xb4003400b4003400,0xb4003400b4003400,0xb5a5258db43db37f,0x258d35a5b37f343d,0xa58db5a5337fb43d,0xb5a5258db43db37f,0x32f6b476347632f6,0xb2f63476b476b2f6,0x347632f6b2f63476,0xb476b2f632f6b476,0x2c243590b4aab267,0xb5902c243267b4aa,0xb5902c243267b4aa,0xac24b59034aa3267
.quad 0xb4dab1d134da31d1,0xb4dab1d134da31d1,0x31d1b4dab1d134da,0x31d1b4dab1d134da,0x3565aed5b505b136,0xaed5b565b1363505,0x2ed535653136b505,0x3565aed5b505b136,0xb096352c352c3096,0x3096b52cb52cb096,0xb52cb096b096352c,0x352c30963096b52c,0xb0b6b525b54dafe2,0x3525b0b62fe2b54d,0x3525b0b62fe2b54d,0x30b63525354d2fe2
.quad 0,0,0,0,0,0,0,0,0,0,0,0,0,0,0,0
.quad 0,0,0,0,0,0,0,0,0,0,0,0,0,0,0,0
.quad 0,0,0,0,0,0,0,0,0,0,0,0,0,0,0,0
.quad 0,0,0,0,0,0,0,0,0,0,0,0,0,0,0,0
.quad 0x3400340034003400,0x3400340034003400,0xb4003400b4003400,0xb4003400b4003400,0x35a5a5d434403378,0xa5d4b5a53378b440,0x25d435a5b3783440,0x35a5a5d434403378,0x32e8b47b347b32e8,0xb2e8347bb47bb2e8,0x347b32e8b2e8347b,0xb47bb2e832e8b47b,0xac59b58d34b23250,0x358dac59b25034b2,0x358dac59b25034b2,0x2c59358db4b2b250
.quad 0xb4e3b1b234e331b2,0xb4e3b1b234e331b2,0x31b2b4e3b1b234e3,0x31b2b4e3b1b234e3,0xb55e2f2a3510310e,0x2f2a355e310eb510,0xaf2ab55eb10e3510,0xb55e2f2a3510310e,0xb065353635363065,0x3065b536b536b065,0xb536b065b0653536,0x353630653065b536,0x30ee351735582f6d,0xb51730eeaf6d3558,0xb51730eeaf6d3558,0xb0eeb517b558af6d
.quad 0x3400340034003400,0x3400340034003400,0xb4003400b4003400,0xb4003400b4003400,0xb5a525d4b440b378,0x25d435a5b3783440,0xa5d4b5a53378b440,0xb5a525d4b440b378,0x32e8b47b347b32e8,0xb2e8347bb47bb2e8,0x347b32e8b2e8347b,0xb47bb2e832e8b47b,0x2c59358db4b2b250,0xb58d2c593250b4b2,0xb58d2c593250b4b2,0xac59b58d34b23250
.quad 0xb4e3b1b234e331b2,0xb4e3b1b234e331b2,0x31b2b4e3b1b234e3,0x31b2b4e3b1b234e3,0x355eaf2ab510b10e,0xaf2ab55eb10e3510,0x2f2a355e310eb510,0x355eaf2ab510b10e,0xb065353635363065,0x3065b536b536b065,0xb536b065b0653536,0x353630653065b536,0xb0eeb517b558af6d,0x3517b0ee2f6db558,0x3517b0ee2f6db558,0x30ee351735582f6d
.quad 0,0,0,0,0,0,0,0,0,0,0,0,0,0,0,0
.quad 0,0,0,0,0,0,0,0,0,0,0,0,0,0,0,0
.quad 0,0,0,0,0,0,0,0,0,0,0,0,0,0,0,0
.quad 0,0,0,0,0,0,0,0,0,0,0,0,0,0,0,0
.quad 0x3400340034003400,0x3400340034003400,0xb4003400b4003400,0xb4003400b4003400,0x35a5a61b34433371,0xa61bb5a53371b443,0x261b35a5b3713443,0x35a5a61b34433371,0x32dab480348032da,0xb2da3480b480b2da,0x348032dab2da3480,0xb480b2da32dab480,0xac8db58b34b9323a,0x358bac8db23a34b9,0x358bac8db23a34b9,0x2c8d358bb4b9b23a
.quad 0xb4ecb19434ec3194,0xb4ecb19434ec3194,0x3194b4ecb19434ec,0x3194b4ecb19434ec,0xb5562f7e351930e6,0x2f7e355630e6b519,0xaf7eb556b0e63519,0xb5562f7e351930e6,0xb033354135413033,0x3033b541b541b033,0xb541b033b0333541,0x354130333033b541,0x3126350a35622ef7,0xb50a3126aef73562,0xb50a3126aef73562,0xb126b50ab562aef7
.quad 0x3400340034003400,0x3400340034003400,0xb4003400b4003400,0xb4003400b4003400,0xb5a5261bb443b371,0x261b35a5b3713443,0xa61bb5a53371b443,0xb5a5261bb443b371,0x32dab480348032da,0xb2da3480b480b2da,0x348032dab2da3480,0xb480b2da32dab480,0x2c8d358bb4b9b23a,0xb58b2c8d323ab4b9,0xb58b2c8d323ab4b9,0xac8db58b34b9323a
.quad 0xb4ecb19434ec3194,0xb4ecb19434ec3194,0x3194b4ecb19434ec,0x3194b4ecb19434ec,0x3556af7eb519b0e6,0xaf7eb556b0e63519,0x2f7e355630e6b519,0x3556af7eb519b0e6,0xb033354135413033,0x3033b541b541b033,0xb541b033b0333541,0x354130333033b541,0xb126b50ab562aef7,0x350ab1262ef7b562,0x350ab1262ef7b562,0x3126350a35622ef7
.quad 0,0,0,0,0,0,0,0,0,0,0,0,0,0,0,0
.quad 0,0,0,0,0,0,0,0,0,0,0,0,0,0,0,0
.quad 0,0,0,0,0,0,0,0,0,0,0,0,0,0,0,0
.quad 0,0,0,0,0,0,0,0,0,0,0,0,0,0,0,0
.quad 0x3400340034003400,0x3400340034003400,0xb4003400b4003400,0xb4003400b4003400,0x35a5a6623446336b,0xa662b5a5336bb446,0x266235a5b36b3446,0x35a5a6623446336b,0x32ccb486348632cc,0xb2cc3486b486b2cc,0x348632ccb2cc3486,0xb486b2cc32ccb486,0xacc1b58834c03224,0x3588acc1b22434c0,0x3588acc1b22434c0,0x2cc13588b4c0b224
.quad 0xb4f5b17534f53175,0xb4f5b17534f53175,0x3175b4f5b17534f5,0x3175b4f5b17534f5,0xb54f2fd2352330be,0x2fd2354f30beb523,0xafd2b54fb0be3523,0xb54f2fd2352330be,0xb002354a354a3002,0x3002b54ab54ab002,0xb54ab002b002354a,0x354a30023002b54a,0x315d34fb356b2e80,0xb4fb315dae80356b,0xb4fb315dae80356b,0xb15db4fbb56bae80
.quad 0x3400340034003400,0x3400340034003400,0xb4003400b4003400,0xb4003400b4003400,0xb5a52662b446b36b,0x266235a5b36b3446,0xa662b5a5336bb446,0xb5a52662b446b36b,0x32ccb486348632cc,0xb2cc3486b486b2cc,0x348632ccb2cc3486,0xb486b2cc32ccb486,0x2cc13588b4c0b224,0xb5882cc13224b4c0,0xb5882cc13224b4c0,0xacc1b58834c03224
.quad 0xb4f5b17534f53175,0xb4f5b17534f53175,0x3175b4f5b17534f5,0x3175b4f5b17534f5,0x354fafd2b523b0be,0xafd2b54fb0be3523,0x2fd2354f30beb523,0x354fafd2b523b0be,0xb002354a354a3002,0x3002b54ab54ab002,0xb54ab002b002354a,0x354a30023002b54a,0xb15db4fbb56bae80,0x34fbb15d2e80b56b,0x34fbb15d2e80b56b,0x315d34fb356b2e80
.quad 0,0,0,0,0,0,0,0,0,0,0,0,0,0,0,0
.quad 0,0,0,0,0,0,0,0,0,0,0,0,0,0,0,0
.quad 0,0,0,0,0,0,0,0,0,0,0,0,0,0,0,0
.quad 0,0,0,0,0,0,0,0,0,0,0,0,0,0,0,0
.quad 0x3400340034003400,0x3400340034003400,0xb4003400b4003400,0xb4003400b4003400,0x35a4a6a934493364,0xa6a9b5a43364b449,0x26a935a4b3643449,0x35a4a6a934493364,0x32bdb48b348b32bd,0xb2bd348bb48bb2bd,0x348b32bdb2bd348b,0xb48bb2bd32bdb48b,0xacf5b58534c7320e,0x3585acf5b20e34c7,0x3585acf5b20e34c7,0x2cf53585b4c7b20e
.quad 0xb4fdb15534fd3155,0xb4fdb15534fd3155,0x3155b4fdb15534fd,0x3155b4fdb15534fd,0xb5473012352c3096,0x301235473096b52c,0xb012b547b096352c,0xb5473012352c3096,0xaf9f355435542f9f,0x2f9fb554b554af9f,0xb554af9faf9f3554,0x35542f9f2f9fb554,0x319434ec35742e09,0xb4ec3194ae093574,0xb4ec3194ae093574,0xb194b4ecb574ae09
.quad 0x3400340034003400,0x3400340034003400,0xb4003400b4003400,0xb4003400b4003400,0xb5a426a9b449b364,0x26a935a4b3643449,0xa6a9b5a43364b449,0xb5a426a9b449b364,0x32bdb48b348b32bd,0xb2bd348bb48bb2bd,0x348b32bdb2bd348b,0xb48bb2bd32bdb48b,0x2cf53585b4c7b20e,0xb5852cf5320eb4c7,0xb5852cf5320eb4c7,0xacf5b58534c7320e
.quad 0xb4fdb15534fd3155,0xb4fdb15534fd3155,0x3155b4fdb15534fd,0x3155b4fdb15534fd,0x3547b012b52cb096,0xb012b547b096352c,0x301235473096b52c,0x3547b012b52cb096,0xaf9f355435542f9f,0x2f9fb554b554af9f,0xb554af9faf9f3554,0x35542f9f2f9fb554,0xb194b4ecb574ae09,0x34ecb1942e09b574,0x34ecb1942e09b574,0x319434ec35742e09
.quad 0,0,0,0,0,0,0,0,0,0,0,0,0,0,0,0
.quad 0,0,0,0,0,0,0,0,0,0,0,0,0,0,0,0
.quad 0,0,0,0,0,0,0,0,0,0,0,0,0,0,0,0
.quad 0,0,0,0,0,0,0,0,0,0,0,0,0,0,0,0
.quad 0x3400340034003400,0x3400340034003400,0xb4003400b4003400,0xb4003400b4003400,0x35a4a6ef344b335d,0xa6efb5a4335db44b,0x26ef35a4b35d344b,0x35a4a6ef344b335d,0x32afb490349032af,0xb2af3490b490b2af,0x349032afb2af3490,0xb490b2af32afb490,0xad29b58234cf31f7,0x3582ad29b1f734cf,0x3582ad29b1f734cf,0x2d293582b4cfb1f7
.quad 0xb505b13635053136,0xb505b13635053136,0x3136b505b1363505,0x3136b505b1363505,0xb53f303c3535306d,0x303c353f306db535,0xb03cb53fb06d3535,0xb53f303c3535306d,0xaf3b355c355c2f3b,0x2f3bb55cb55caf3b,0xb55caf3baf3b355c,0x355c2f3b2f3bb55c,0x31c934dc357c2d91,0xb4dc31c9ad91357c,0xb4dc31c9ad91357c,0xb1c9b4dcb57cad91
.quad 0x3400340034003400,0x3400340034003400,0xb4003400b4003400,0xb4003400b4003400,0xb5a426efb44bb35d,0x26ef35a4b35d344b,0xa6efb5a4335db44b,0xb5a426efb44bb35d,0x32afb490349032af,0xb2af3490b490b2af,0x349032afb2af3490,0xb490b2af32afb490,0x2d293582b4cfb1f7,0xb5822d2931f7b4cf,0xb5822d2931f7b4cf,0xad29b58234cf31f7
.quad 0xb505b13635053136,0xb505b13635053136,0x3136b505b1363505,0x3136b505b1363505,0x353fb03cb535b06d,0xb03cb53fb06d3535,0x303c353f306db535,0x353fb03cb535b06d,0xaf3b355c355c2f3b,0x2f3bb55cb55caf3b,0xb55caf3baf3b355c,0x355c2f3b2f3bb55c,0xb1c9b4dcb57cad91,0x34dcb1c92d91b57c,0x34dcb1c92d91b57c,0x31c934dc357c2d91
.quad 0,0,0,0,0,0,0,0,0,0,0,0,0,0,0,0
.quad 0,0,0,0,0,0,0,0,0,0,0,0,0,0,0,0
.quad 0,0,0,0,0,0,0,0,0,0,0,0,0,0,0,0
.quad 0,0,0,0,0,0,0,0,0,0,0,0,0,0,0,0
.quad 0x3400340034003400,0x3400340034003400,0xb4003400b4003400,0xb4003400b4003400,0x35a4a736344e3356,0xa736b5a43356b44e,0x273635a4b356344e,0x35a4a736344e3356,0x32a1b496349632a1,0xb2a13496b496b2a1,0x349632a1b2a13496,0xb496b2a132a1b496,0xad5db57f34d631e0,0x357fad5db1e034d6,0x357fad5db1e034d6,0x2d5d357fb4d6b1e0
.quad 0xb50eb116350e3116,0xb50eb116350e3116,0x3116b50eb116350e,0x3116b50eb116350e,0xb5363065353d3044,0x306535363044b53d,0xb065b536b044353d,0xb5363065353d3044,0xaed5356535652ed5,0x2ed5b565b565aed5,0xb565aed5aed53565,0x35652ed52ed5b565,0x31fe34cc35832d18,0xb4cc31fead183583,0xb4cc31fead183583,0xb1feb4ccb583ad18
.quad 0x3400340034003400,0x3400340034003400,0xb4003400b4003400,0xb4003400b4003400,0xb5a42736b44eb356,0x273635a4b356344e,0xa736b5a43356b44e,0xb5a42736b44eb356,0x32a1b496349632a1,0xb2a13496b496b2a1,0x349632a1b2a13496,0xb496b2a132a1b496,0x2d5d357fb4d6b1e0,0xb57f2d5d31e0b4d6,0xb57f2d5d31e0b4d6,0xad5db57f34d631e0
.quad 0xb50eb116350e3116,0xb50eb116350e3116,0x3116b50eb116350e,0x3116b50eb116350e,0x3536b065b53db044,0xb065b536b044353d,0x306535363044b53d,0x3536b065b53db044,0xaed5356535652ed5,0x2ed5b565b565aed5,0xb565aed5aed53565,0x35652ed52ed5b565,0xb1feb4ccb583ad18,0x34ccb1fe2d18b583,0x34ccb1fe2d18b583,0x31fe34cc35832d18
.quad 0,0,0,0,0,0,0,0,0,0,0,0,0,0,0,0
.quad 0,0,0,0,0,0,0,0,0,0,0,0,0,0,0,0
.quad 0,0,0,0,0,0,0,0,0,0,0,0,0,0,0,0
.quad 0,0,0,0,0,0,0,0,0,0,0,0,0,0,0,0
.quad 0x3400340034003400,0x3400340034003400,0xb4003400b4003400,0xb4003400b4003400,0x35a3a77d34513350,0xa77db5a33350b451,0x277d35a3b3503451,0x35a3a77d34513350,0x3292b49b349b3292,0xb292349bb49bb292,0x349b3292b292349b,0xb49bb2923292b49b,0xad91b57c34dc31c9,0x357cad91b1c934dc,0x357cad91b1c934dc,0x2d91357cb4dcb1c9
.quad 0xb515b0f6351530f6,0xb515b0f6351530f6,0x30f6b515b0f63515,0x30f6b515b0f63515,0xb52e308e3546301b,0x308e352e301bb546,0xb08eb52eb01b3546,0xb52e308e3546301b,0xae6f356c356c2e6f,0x2e6fb56cb56cae6f,0xb56cae6fae6f356c,0x356c2e6f2e6fb56c,0x323334bb358a2c9e,0xb4bb3233ac9e358a,0xb4bb3233ac9e358a,0xb233b4bbb58aac9e
.quad 0x3400340034003400,0x3400340034003400,0xb4003400b4003400,0xb4003400b4003400,0xb5a3277db451b350,0x277d35a3b3503451,0xa77db5a33350b451,0xb5a3277db451b350,0x3292b49b349b3292,0xb292349bb49bb292,0x349b3292b292349b,0xb49bb2923292b49b,0x2d91357cb4dcb1c9,0xb57c2d9131c9b4dc,0xb57c2d9131c9b4dc,0xad91b57c34dc31c9
.quad 0xb515b0f6351530f6,0xb515b0f6351530f6,0x30f6b515b0f63515,0x30f6b515b0f63515,0x352eb08eb546b01b,0xb08eb52eb01b3546,0x308e352e301bb546,0x352eb08eb546b01b,0xae6f356c356c2e6f,0x2e6fb56cb56cae6f,0xb56cae6fae6f356c,0x356c2e6f2e6fb56c,0xb233b4bbb58aac9e,0x34bbb2332c9eb58a,0x34bbb2332c9eb58a,0x323334bb358a2c9e
.quad 0,0,0,0,0,0,0,0,0,0,0,0,0,0,0,0
.quad 0,0,0,0,0,0,0,0,0,0,0,0,0,0,0,0
.quad 0,0,0,0,0,0,0,0,0,0,0,0,0,0,0,0
.quad 0,0,0,0,0,0,0,0,0,0,0,0,0,0,0,0
.quad 0x3400340034003400,0x3400340034003400,0xb4003400b4003400,0xb4003400b4003400,0x35a3a7c434543349,0xa7c4b5a33349b454,0x27c435a3b3493454,0x35a3a7c434543349,0x3284b4a034a03284,0xb28434a0b4a0b284,0x34a03284b28434a0,0xb4a0b2843284b4a0,0xadc4b57834e331b2,0x3578adc4b1b234e3,0x3578adc4b1b234e3,0x2dc43578b4e3b1b2
.quad 0xb51db0d6351d30d6,0xb51db0d6351d30d6,0x30d6b51db0d6351d,0x30d6b51db0d6351d,0xb52530b6354d2fe2,0x30b635252fe2b54d,0xb0b6b525afe2354d,0xb52530b6354d2fe2,0xae09357435742e09,0x2e09b574b574ae09,0xb574ae09ae093574,0x35742e092e09b574,0x326734aa35902c24,0xb4aa3267ac243590,0xb4aa3267ac243590,0xb267b4aab590ac24
.quad 0x3400340034003400,0x3400340034003400,0xb4003400b4003400,0xb4003400b4003400,0xb5a327c4b454b349,0x27c435a3b3493454,0xa7c4b5a33349b454,0xb5a327c4b454b349,0x3284b4a034a03284,0xb28434a0b4a0b284,0x34a03284b28434a0,0xb4a0b2843284b4a0,0x2dc43578b4e3b1b2,0xb5782dc431b2b4e3,0xb5782dc431b2b4e3,0xadc4b57834e331b2
.quad 0xb51db0d6351d30d6,0xb51db0d6351d30d6,0x30d6b51db0d6351d,0x30d6b51db0d6351d,0x3525b0b6b54dafe2,0xb0b6b525afe2354d,0x30b635252fe2b54d,0x3525b0b6b54dafe2,0xae09357435742e09,0x2e09b574b574ae09,0xb574ae09ae093574,0x35742e092e09b574,0xb267b4aab590ac24,0x34aab2672c24b590,0x34aab2672c24b590,0x326734aa35902c24
.quad 0,0,0,0,0,0,0,0,0,0,0,0,0,0,0,0
.quad 0,0,0,0,0,0,0,0,0,0,0,0,0,0,0,0
.quad 0,0,0,0,0,0,0,0,0,0,0,0,0,0,0,0
.quad 0,0,0,0,0,0,0,0,0,0,0,0,0,0,0,0
.quad 0x3400340034003400,0x3400340034003400,0xb4003400b4003400,0xb4003400b4003400,0x35a2a80534573342,0xa805b5a23342b457,0x280535a2b3423457,0x35a2a80534573342,0x3275b4a534a53275,0xb27534a5b4a5b275,0x34a53275b27534a5,0xb4a5b2753275b4a5,0xadf8b57534ea319b,0x3575adf8b19b34ea,0x3575adf8b19b34ea,0x2df83575b4eab19b
.quad 0xb525b0b6352530b6,0xb525b0b6352530b6,0x30b6b525b0b63525,0x30b6b525b0b63525,0xb51b30de35552f8f,0x30de351b2f8fb555,0xb0deb51baf8f3555,0xb51b30de35552f8f,0xada2357b357b2da2,0x2da2b57bb57bada2,0xb57bada2ada2357b,0x357b2da22da2b57b,0x3299349835952b53,0xb4983299ab533595,0xb4983299ab533595,0xb299b498b595ab53
.quad 0x3400340034003400,0x3400340034003400,0xb4003400b4003400,0xb4003400b4003400,0xb5a22805b457b342,0x280535a2b3423457,0xa805b5a23342b457,0xb5a22805b457b342,0x3275b4a534a53275,0xb27534a5b4a5b275,0x34a53275b27534a5,0xb4a5b2753275b4a5,0x2df83575b4eab19b,0xb5752df8319bb4ea,0xb5752df8319bb4ea,0xadf8b57534ea319b
.quad 0xb525b0b6352530b6,0xb525b0b6352530b6,0x30b6b525b0b63525,0x30b6b525b0b63525,0x351bb0deb555af8f,0xb0deb51baf8f3555,0x30de351b2f8fb555,0x351bb0deb555af8f,0xada2357b357b2da2,0x2da2b57bb57bada2,0xb57bada2ada2357b,0x357b2da22da2b57b,0xb299b498b595ab53,0x3498b2992b53b595,0x3498b2992b53b595,0x3299349835952b53
.quad 0,0,0,0,0,0,0,0,0,0,0,0,0,0,0,0
.quad 0,0,0,0,0,0,0,0,0,0,0,0,0,0,0,0
.quad 0,0,0,0,0,0,0,0,0,0,0,0,0,0,0,0
.quad 0,0,0,0,0,0,0,0,0,0,0,0,0,0,0,0
.quad 0x3400340034003400,0x3400340034003400,0xb4003400b4003400,0xb4003400b4003400,0x35a2a829345a333b,0xa829b5a2333bb45a,0x282935a2b33b345a,0x35a2a829345a333b,0x3267b4aa34aa3267,0xb26734aab4aab267,0x34aa3267b26734aa,0xb4aab2673267b4aa,0xae2bb57134f03184,0x3571ae2bb18434f0,0x3571ae2bb18434f0,0x2e2b3571b4f0b184
.quad 0xb52cb096352c3096,0xb52cb096352c3096,0x3096b52cb096352c,0x3096b52cb096352c,0xb5113106355c2f3b,0x310635112f3bb55c,0xb106b511af3b355c,0xb5113106355c2f3b,0xad3a358135812d3a,0x2d3ab581b581ad3a,0xb581ad3aad3a3581,0x35812d3a2d3ab581,0x32cc3486359a2a5e,0xb48632ccaa5e359a,0xb48632ccaa5e359a,0xb2ccb486b59aaa5e
.quad 0x3400340034003400,0x3400340034003400,0xb4003400b4003400,0xb4003400b4003400,0xb5a22829b45ab33b,0x282935a2b33b345a,0xa829b5a2333bb45a,0xb5a22829b45ab33b,0x3267b4aa34aa3267,0xb26734aab4aab267,0x34aa3267b26734aa,0xb4aab2673267b4aa,0x2e2b3571b4f0b184,0xb5712e2b3184b4f0,0xb5712e2b3184b4f0,0xae2bb57134f03184
.quad 0xb52cb096352c3096,0xb52cb096352c3096,0x3096b52cb096352c,0x3096b52cb096352c,0x3511b106b55caf3b,0xb106b511af3b355c,0x310635112f3bb55c,0x3511b106b55caf3b,0xad3a358135812d3a,0x2d3ab581b581ad3a,0xb581ad3aad3a3581,0x35812d3a2d3ab581,0xb2ccb486b59aaa5e,0x3486b2cc2a5eb59a,0x3486b2cc2a5eb59a,0x32cc3486359a2a5e
.quad 0,0,0,0,0,0,0,0,0,0,0,0,0,0,0,0
.quad 0,0,0,0,0,0,0,0,0,0,0,0,0,0,0,0
.quad 0,0,0,0,0,0,0,0,0,0,0,0,0,0,0,0
.quad 0,0,0,0,0,0,0,0,0,0,0,0,0,0,0,0
.quad 0x3400340034003400,0x3400340034003400,0xb4003400b4003400,0xb4003400b4003400,0x35a2a84c345d3334,0xa84cb5a23334b45d,0x284c35a2b334345d,0x35a2a84c345d3334,0x3258b4af34af3258,0xb25834afb4afb258,0x34af3258b25834af,0xb4afb2583258b4af,0xae5eb56e34f7316d,0x356eae5eb16d34f7,0x356eae5eb16d34f7,0x2e5e356eb4f7b16d
.quad 0xb533b07535333075,0xb533b07535333075,0x3075b533b0753533,0x3075b533b0753533,0xb507312e35632ee6,0x312e35072ee6b563,0xb12eb507aee63563,0xb507312e35632ee6,0xacd2358735872cd2,0x2cd2b587b587acd2,0xb587acd2acd23587,0x35872cd22cd2b587,0x32fd3473359e2967,0xb47332fda967359e,0xb47332fda967359e,0xb2fdb473b59ea967
.quad 0x3400340034003400,0x3400340034003400,0xb4003400b4003400,0xb4003400b4003400,0xb5a2284cb45db334,0x284c35a2b334345d,0xa84cb5a23334b45d,0xb5a2284cb45db334,0x3258b4af34af3258,0xb25834afb4afb258,0x34af3258b25834af,0xb4afb2583258b4af,0x2e5e356eb4f7b16d,0xb56e2e5e316db4f7,0xb56e2e5e316db4f7,0xae5eb56e34f7316d
.quad 0xb533b07535333075,0xb533b07535333075,0x3075b533b0753533,0x3075b533b0753533,0x3507b12eb563aee6,0xb12eb507aee63563,0x312e35072ee6b563,0x3507b12eb563aee6,0xacd2358735872cd2,0x2cd2b587b587acd2,0xb587acd2acd23587,0x35872cd22cd2b587,0xb2fdb473b59ea967,0x3473b2fd2967b59e,0x3473b2fd2967b59e,0x32fd3473359e2967
.quad 0,0,0,0,0,0,0,0,0,0,0,0,0,0,0,0
.quad 0,0,0,0,0,0,0,0,0,0,0,0,0,0,0,0
.quad 0,0,0,0,0,0,0,0,0,0,0,0,0,0,0,0
.quad 0,0,0,0,0,0,0,0,0,0,0,0,0,0,0,0
.quad 0x3400340034003400,0x3400340034003400,0xb4003400b4003400,0xb4003400b4003400,0x35a1a870345f332d,0xa870b5a1332db45f,0x287035a1b32d345f,0x35a1a870345f332d,0x3249b4b434b43249,0xb24934b4b4b4b249,0x34b43249b24934b4,0xb4b4b2493249b4b4,0xae92b56a34fd3155,0x356aae92b15534fd,0x356aae92b15534fd,0x2e92356ab4fdb155
.quad 0xb53ab054353a3054,0xb53ab054353a3054,0x3054b53ab054353a,0x3054b53ab054353a,0xb4fd3155356a2e92,0x315534fd2e92b56a,0xb155b4fdae92356a,0xb4fd3155356a2e92,0xac6a358c358c2c6a,0x2c6ab58cb58cac6a,0xb58cac6aac6a358c,0x358c2c6a2c6ab58c,0x332d345f35a12870,0xb45f332da87035a1,0xb45f332da87035a1,0xb32db45fb5a1a870
.quad 0x3400340034003400,0x3400340034003400,0xb4003400b4003400,0xb4003400b4003400,0xb5a12870b45fb32d,0x287035a1b32d345f,0xa870b5a1332db45f,0xb5a12870b45fb32d,0x3249b4b434b43249,0xb24934b4b4b4b249,0x34b43249b24934b4,0xb4b4b2493249b4b4,0x2e92356ab4fdb155,0xb56a2e923155b4fd,0xb56a2e923155b4fd,0xae92b56a34fd3155
.quad 0xb53ab054353a3054,0xb53ab054353a3054,0x3054b53ab054353a,0x3054b53ab054353a,0x34fdb155b56aae92,0xb155b4fdae92356a,0x315534fd2e92b56a,0x34fdb155b56aae92,0xac6a358c358c2c6a,0x2c6ab58cb58cac6a,0xb58cac6aac6a358c,0x358c2c6a2c6ab58c,0xb32db45fb5a1a870,0x345fb32d2870b5a1,0x345fb32d2870b5a1,0x332d345f35a12870
.quad 0,0,0,0,0,0,0,0,0,0,0,0,0,0,0,0
.quad 0,0,0,0,0,0,0,0,0,0,0,0,0,0,0,0
.quad 0,0,0,0,0,0,0,0,0,0,0,0,0,0,0,0
.quad 0,0,0,0,0,0,0,0,0,0,0,0,0,0,0,0
.quad 0x3400340034003400,0x3400340034003400,0xb4003400b4003400,0xb4003400b4003400,0x35a1a89334623327,0xa893b5a13327b462,0x289335a1b3273462,0x35a1a89334623327,0x323ab4b934b9323a,0xb23a34b9b4b9b23a,0x34b9323ab23a34b9,0xb4b9b23a323ab4b9,0xaec4b5663503313e,0x3566aec4b13e3503,0x3566aec4b13e3503,0x2ec43566b503b13e
.quad 0xb541b03335413033,0xb541b03335413033,0x3033b541b0333541,0x3033b541b0333541,0xb4f3317c35702e3c,0x317c34f32e3cb570,0xb17cb4f3ae3c3570,0xb4f3317c35702e3c,0xac01359135912c01,0x2c01b591b591ac01,0xb591ac01ac013591,0x35912c012c01b591,0x335d344b35a426ef,0xb44b335da6ef35a4,0xb44b335da6ef35a4,0xb35db44bb5a4a6ef
.quad 0x3400340034003400,0x3400340034003400,0xb4003400b4003400,0xb4003400b4003400,0xb5a12893b462b327,0x289335a1b3273462,0xa893b5a13327b462,0xb5a12893b462b327,0x323ab4b934b9323a,0xb23a34b9b4b9b23a,0x34b9323ab23a34b9,0xb4b9b23a323ab4b9,0x2ec43566b503b13e,0xb5662ec4313eb503,0xb5662ec4313eb503,0xaec4b5663503313e
.quad 0xb541b03335413033,0xb541b03335413033,0x3033b541b0333541,0x3033b541b0333541,0x34f3b17cb570ae3c,0xb17cb4f3ae3c3570,0x317c34f32e3cb570,0x34f3b17cb570ae3c,0xac01359135912c01,0x2c01b591b591ac01,0xb591ac01ac013591,0x35912c012c01b591,0xb35db44bb5a4a6ef,0x344bb35d26efb5a4,0x344bb35d26efb5a4,0x335d344b35a426ef
.quad 0,0,0,0,0,0,0,0,0,0,0,0,0,0,0,0
.quad 0,0,0,0,0,0,0,0,0,0,0,0,0,0,0,0
.quad 0,0,0,0,0,0,0,0,0,0,0,0,0,0,0,0
.quad 0,0,0,0,0,0,0,0,0,0,0,0,0,0,0,0
.quad 0x3400340034003400,0x3400340034003400,0xb4003400b4003400,0xb4003400b4003400,0x35a0a8b634653320,0xa8b6b5a03320b465,0x28b635a0b3203465,0x35a0a8b634653320,0x322bb4be34be322b,0xb22b34beb4beb22b,0x34be322bb22b34be,0xb4beb22b322bb4be,0xaef7b562350a3126,0x3562aef7b126350a,0x3562aef7b126350a,0x2ef73562b50ab126
.quad 0xb547b01235473012,0xb547b01235473012,0x3012b547b0123547,0x3012b547b0123547,0xb4e831a335762de7,0x31a334e82de7b576,0xb1a3b4e8ade73576,0xb4e831a335762de7,0xab30359635962b30,0x2b30b596b596ab30,0xb596ab30ab303596,0x35962b302b30b596,0x338c343735a624ff,0xb437338ca4ff35a6,0xb437338ca4ff35a6,0xb38cb437b5a6a4ff
.quad 0x3400340034003400,0x3400340034003400,0xb4003400b4003400,0xb4003400b4003400,0xb5a028b6b465b320,0x28b635a0b3203465,0xa8b6b5a03320b465,0xb5a028b6b465b320,0x322bb4be34be322b,0xb22b34beb4beb22b,0x34be322bb22b34be,0xb4beb22b322bb4be,0x2ef73562b50ab126,0xb5622ef73126b50a,0xb5622ef73126b50a,0xaef7b562350a3126
.quad 0xb547b01235473012,0xb547b01235473012,0x3012b547b0123547,0x3012b547b0123547,0x34e8b1a3b576ade7,0xb1a3b4e8ade73576,0x31a334e82de7b576,0x34e8b1a3b576ade7,0xab30359635962b30,0x2b30b596b596ab30,0xb596ab30ab303596,0x35962b302b30b596,0xb38cb437b5a6a4ff,0x3437b38c24ffb5a6,0x3437b38c24ffb5a6,0x338c343735a624ff
.quad 0,0,0,0,0,0,0,0,0,0,0,0,0,0,0,0
.quad 0,0,0,0,0,0,0,0,0,0,0,0,0,0,0,0
.quad 0,0,0,0,0,0,0,0,0,0,0,0,0,0,0,0
.quad 0,0,0,0,0,0,0,0,0,0,0,0,0,0,0,0
.quad 0x3400340034003400,0x3400340034003400,0xb4003400b4003400,0xb4003400b4003400,0x35a0a8da34683319,0xa8dab5a03319b468,0x28da35a0b3193468,0x35a0a8da34683319,0x321db4c334c3321d,0xb21d34c3b4c3b21d,0x34c3321db21d34c3,0xb4c3b21d321db4c3,0xaf2ab55e3510310e,0x355eaf2ab10e3510,0x355eaf2ab10e3510,0x2f2a355eb510b10e
.quad 0xb54dafe2354d2fe2,0xb54dafe2354d2fe2,0x2fe2b54dafe2354d,0x2fe2b54dafe2354d,0xb4dc31c9357c2d91,0x31c934dc2d91b57c,0xb1c9b4dcad91357c,0xb4dc31c9357c2d91,0xaa5e359a359a2a5e,0x2a5eb59ab59aaa5e,0xb59aaa5eaa5e359a,0x359a2a5e2a5eb59a,0x33ba342235a7221c,0xb42233baa21c35a7,0xb42233baa21c35a7,0xb3bab422b5a7a21c
.quad 0x3400340034003400,0x3400340034003400,0xb4003400b4003400,0xb4003400b4003400,0xb5a028dab468b319,0x28da35a0b3193468,0xa8dab5a03319b468,0xb5a028dab468b319,0x321db4c334c3321d,0xb21d34c3b4c3b21d,0x34c3321db21d34c3,0xb4c3b21d321db4c3,0x2f2a355eb510b10e,0xb55e2f2a310eb510,0xb55e2f2a310eb510,0xaf2ab55e3510310e
.quad 0xb54dafe2354d2fe2,0xb54dafe2354d2fe2,0x2fe2b54dafe2354d,0x2fe2b54dafe2354d,0x34dcb1c9b57cad91,0xb1c9b4dcad91357c,0x31c934dc2d91b57c,0x34dcb1c9b57cad91,0xaa5e359a359a2a5e,0x2a5eb59ab59aaa5e,0xb59aaa5eaa5e359a,0x359a2a5e2a5eb59a,0xb3bab422b5a7a21c,0x3422b3ba221cb5a7,0x3422b3ba221cb5a7,0x33ba342235a7221c
.quad 0,0,0,0,0,0,0,0,0,0,0,0,0,0,0,0
.quad 0,0,0,0,0,0,0,0,0,0,0,0,0,0,0,0
.quad 0,0,0,0,0,0,0,0,0,0,0,0,0,0,0,0
.quad 0,0,0,0,0,0,0,0,0,0,0,0,0,0,0,0
.quad 0x3400340034003400,0x3400340034003400,0xb4003400b4003400,0xb4003400b4003400,0x359fa8fd346b3312,0xa8fdb59f3312b46b,0x28fd359fb312346b,0x359fa8fd346b3312,0x320eb4c734c7320e,0xb20e34c7b4c7b20e,0x34c7320eb20e34c7,0xb4c7b20e320eb4c7,0xaf5cb559351530f6,0x3559af5cb0f63515,0x3559af5cb0f63515,0x2f5c3559b515b0f6
.quad 0xb554af9f35542f9f,0xb554af9f35542f9f,0x2f9fb554af9f3554,0x2f9fb554af9f3554,0xb4d131ef35812d3a,0x31ef34d12d3ab581,0xb1efb4d1ad3a3581,0xb4d131ef35812d3a,0xa98a359d359d298a,0x298ab59db59da98a,0xb59da98aa98a359d,0x359d298a298ab59d,0x33e7340c35a81c71,0xb40c33e79c7135a8,0xb40c33e79c7135a8,0xb3e7b40cb5a89c71
.quad 0x3400340034003400,0x3400340034003400,0xb4003400b4003400,0xb4003400b4003400,0xb59f28fdb46bb312,0x28fd359fb312346b,0xa8fdb59f3312b46b,0xb59f28fdb46bb312,0x320eb4c734c7320e,0xb20e34c7b4c7b20e,0x34c7320eb20e34c7,0xb4c7b20e320eb4c7,0x2f5c3559b515b0f6,0xb5592f5c30f6b515,0xb5592f5c30f6b515,0xaf5cb559351530f6
.quad 0xb554af9f35542f9f,0xb554af9f35542f9f,0x2f9fb554af9f3554,0x2f9fb554af9f3554,0x34d1b1efb581ad3a,0xb1efb4d1ad3a3581,0x31ef34d12d3ab581,0x34d1b1efb581ad3a,0xa98a359d359d298a,0x298ab59db59da98a,0xb59da98aa98a359d,0x359d298a298ab59d,0xb3e7b40cb5a89c71,0x340cb3e71c71b5a8,0x340cb3e71c71b5a8,0x33e7340c35a81c71
.quad 0,0,0,0,0,0,0,0,0,0,0,0,0,0,0,0
.quad 0,0,0,0,0,0,0,0,0,0,0,0,0,0,0,0
.quad 0,0,0,0,0,0,0,0,0,0,0,0,0,0,0,0
.quad 0,0,0,0,0,0,0,0,0,0,0,0,0,0,0,0
.quad 0x3400340034003400,0x3400340034003400,0xb4003400b4003400,0xb4003400b4003400,0x359fa920346d330b,0xa920b59f330bb46d,0x2920359fb30b346d,0x359fa920346d330b,0x31feb4cc34cc31fe,0xb1fe34ccb4ccb1fe,0x34cc31feb1fe34cc,0xb4ccb1fe31feb4cc,0xaf8fb555351b30de,0x3555af8fb0de351b,0x3555af8fb0de351b,0x2f8f3555b51bb0de
.quad 0xb559af5c35592f5c,0xb559af5c35592f5c,0x2f5cb559af5c3559,0x2f5cb559af5c3559,0xb4c5321535862ce4,0x321534c52ce4b586,0xb215b4c5ace43586,0xb4c5321535862ce4,0xa8b635a035a028b6,0x28b6b5a0b5a0a8b6,0xb5a0a8b6a8b635a0,0x35a028b628b6b5a0,0x340933ed35a89aaa,0xb3ed34091aaa35a8,0xb3ed34091aaa35a8,0xb409b3edb5a81aaa
.quad 0x3400340034003400,0x3400340034003400,0xb4003400b4003400,0xb4003400b4003400,0xb59f2920b46db30b,0x2920359fb30b346d,0xa920b59f330bb46d,0xb59f2920b46db30b,0x31feb4cc34cc31fe,0xb1fe34ccb4ccb1fe,0x34cc31feb1fe34cc,0xb4ccb1fe31feb4cc,0x2f8f3555b51bb0de,0xb5552f8f30deb51b,0xb5552f8f30deb51b,0xaf8fb555351b30de
.quad 0xb559af5c35592f5c,0xb559af5c35592f5c,0x2f5cb559af5c3559,0x2f5cb559af5c3559,0x34c5b215b586ace4,0xb215b4c5ace43586,0x321534c52ce4b586,0x34c5b215b586ace4,0xa8b635a035a028b6,0x28b6b5a0b5a0a8b6,0xb5a0a8b6a8b635a0,0x35a028b628b6b5a0,0xb409b3edb5a81aaa,0x33edb4099aaab5a8,0x33edb4099aaab5a8,0x340933ed35a89aaa
.quad 0,0,0,0,0,0,0,0,0,0,0,0,0,0,0,0
.quad 0,0,0,0,0,0,0,0,0,0,0,0,0,0,0,0
.quad 0,0,0,0,0,0,0,0,0,0,0,0,0,0,0,0
.quad 0,0,0,0,0,0,0,0,0,0,0,0,0,0,0,0
.quad 0x3400340034003400,0x3400340034003400,0xb4003400b4003400,0xb4003400b4003400,0x359ea94434703304,0xa944b59e3304b470,0x2944359eb3043470,0x359ea94434703304,0x31efb4d134d131ef,0xb1ef34d1b4d1b1ef,0x34d131efb1ef34d1,0xb4d1b1ef31efb4d1,0xafc1b550352130c6,0x3550afc1b0c63521,0x3550afc1b0c63521,0x2fc13550b521b0c6
.quad 0xb55faf19355f2f19,0xb55faf19355f2f19,0x2f19b55faf19355f,0x2f19b55faf19355f,0xb4b9323a358b2c8d,0x323a34b92c8db58b,0xb23ab4b9ac8d358b,0xb4b9323a358b2c8d,0xa7c435a335a327c4,0x27c4b5a3b5a3a7c4,0xb5a3a7c4a7c435a3,0x35a327c427c4b5a3,0x341f33c035a7a18d,0xb3c0341f218d35a7,0xb3c0341f218d35a7,0xb41fb3c0b5a7218d
.quad 0x3400340034003400,0x3400340034003400,0xb4003400b4003400,0xb4003400b4003400,0xb59e2944b470b304,0x2944359eb3043470,0xa944b59e3304b470,0xb59e2944b470b304,0x31efb4d134d131ef,0xb1ef34d1b4d1b1ef,0x34d131efb1ef34d1,0xb4d1b1ef31efb4d1,0x2fc13550b521b0c6,0xb5502fc130c6b521,0xb5502fc130c6b521,0xafc1b550352130c6
.quad 0xb55faf19355f2f19,0xb55faf19355f2f19,0x2f19b55faf19355f,0x2f19b55faf19355f,0x34b9b23ab58bac8d,0xb23ab4b9ac8d358b,0x323a34b92c8db58b,0x34b9b23ab58bac8d,0xa7c435a335a327c4,0x27c4b5a3b5a3a7c4,0xb5a3a7c4a7c435a3,0x35a327c427c4b5a3,0xb41fb3c0b5a7218d,0x33c0b41fa18db5a7,0x33c0b41fa18db5a7,0x341f33c035a7a18d
.quad 0,0,0,0,0,0,0,0,0,0,0,0,0,0,0,0
.quad 0,0,0,0,0,0,0,0,0,0,0,0,0,0,0,0
.quad 0,0,0,0,0,0,0,0,0,0,0,0,0,0,0,0
.quad 0,0,0,0,0,0,0,0,0,0,0,0,0,0,0,0
.quad 0x3400340034003400,0x3400340034003400,0xb4003400b4003400,0xb4003400b4003400,0x359ea967347332fd,0xa967b59e32fdb473,0x2967359eb2fd3473,0x359ea967347332fd,0x31e0b4d634d631e0,0xb1e034d6b4d6b1e0,0x34d631e0b1e034d6,0xb4d6b1e031e0b4d6,0xaff3b54c352630ae,0x354caff3b0ae3526,0x354caff3b0ae3526,0x2ff3354cb526b0ae
.quad 0xb565aed535652ed5,0xb565aed535652ed5,0x2ed5b565aed53565,0x2ed5b565aed53565,0xb4ad325f358f2c36,0x325f34ad2c36b58f,0xb25fb4adac36358f,0xb4ad325f358f2c36,0xa61b35a535a5261b,0x261bb5a5b5a5a61b,0xb5a5a61ba61b35a5,0x35a5261b261bb5a5,0x3434339235a6a4b8,0xb392343424b835a6,0xb392343424b835a6,0xb434b392b5a624b8
.quad 0x3400340034003400,0x3400340034003400,0xb4003400b4003400,0xb4003400b4003400,0xb59e2967b473b2fd,0x2967359eb2fd3473,0xa967b59e32fdb473,0xb59e2967b473b2fd,0x31e0b4d634d631e0,0xb1e034d6b4d6b1e0,0x34d631e0b1e034d6,0xb4d6b1e031e0b4d6,0x2ff3354cb526b0ae,0xb54c2ff330aeb526,0xb54c2ff330aeb526,0xaff3b54c352630ae
.quad 0xb565aed535652ed5,0xb565aed535652ed5,0x2ed5b565aed53565,0x2ed5b565aed53565,0x34adb25fb58fac36,0xb25fb4adac36358f,0x325f34ad2c36b58f,0x34adb25fb58fac36,0xa61b35a535a5261b,0x261bb5a5b5a5a61b,0xb5a5a61ba61b35a5,0x35a5261b261bb5a5,0xb434b392b5a624b8,0x3392b434a4b8b5a6,0x3392b434a4b8b5a6,0x3434339235a6a4b8
.quad 0,0,0,0,0,0,0,0,0,0,0,0,0,0,0,0
.quad 0,0,0,0,0,0,0,0,0,0,0,0,0,0,0,0
.quad 0,0,0,0,0,0,0,0,0,0,0,0,0,0,0,0
.quad 0,0,0,0,0,0,0,0,0,0,0,0,0,0,0,0
.quad 0x3400340034003400,0x3400340034003400,0xb4003400b4003400,0xb4003400b4003400,0x359da98a347632f6,0xa98ab59d32f6b476,0x298a359db2f63476,0x359da98a347632f6,0x31d1b4da34da31d1,0xb1d134dab4dab1d1,0x34da31d1b1d134da,0xb4dab1d131d1b4da,0xb012b547352c3096,0x3547b012b096352c,0x3547b012b096352c,0x30123547b52cb096
.quad 0xb56aae92356a2e92,0xb56aae92356a2e92,0x2e92b56aae92356a,0x2e92b56aae92356a,0xb4a0328435932bbd,0x328434a02bbdb593,0xb284b4a0abbd3593,0xb4a0328435932bbd,0xa47135a635a62471,0x2471b5a6b5a6a471,0xb5a6a471a47135a6,0x35a624712471b5a6,0x3449336435a4a6a9,0xb364344926a935a4,0xb364344926a935a4,0xb449b364b5a426a9
.quad 0x3400340034003400,0x3400340034003400,0xb4003400b4003400,0xb4003400b4003400,0xb59d298ab476b2f6,0x298a359db2f63476,0xa98ab59d32f6b476,0xb59d298ab476b2f6,0x31d1b4da34da31d1,0xb1d134dab4dab1d1,0x34da31d1b1d134da,0xb4dab1d131d1b4da,0x30123547b52cb096,0xb54730123096b52c,0xb54730123096b52c,0xb012b547352c3096
.quad 0xb56aae92356a2e92,0xb56aae92356a2e92,0x2e92b56aae92356a,0x2e92b56aae92356a,0x34a0b284b593abbd,0xb284b4a0abbd3593,0x328434a02bbdb593,0x34a0b284b593abbd,0xa47135a635a62471,0x2471b5a6b5a6a471,0xb5a6a471a47135a6,0x35a624712471b5a6,0xb449b364b5a426a9,0x3364b449a6a9b5a4,0x3364b449a6a9b5a4,0x3449336435a4a6a9
.quad 0,0,0,0,0,0,0,0,0,0,0,0,0,0,0,0
.quad 0,0,0,0,0,0,0,0,0,0,0,0,0,0,0,0
.quad 0,0,0,0,0,0,0,0,0,0,0,0,0,0,0,0
.quad 0,0,0,0,0,0,0,0,0,0,0,0,0,0,0,0
.quad 0x3400340034003400,0x3400340034003400,0xb4003400b4003400,0xb4003400b4003400,0x359da9ad347832ef,0xa9adb59d32efb478,0x29ad359db2ef3478,0x359da9ad347832ef,0x31c2b4df34df31c2,0xb1c234dfb4dfb1c2,0x34df31c2b1c234df,0xb4dfb1c231c2b4df,0xb02bb5423531307d,0x3542b02bb07d3531,0x3542b02bb07d3531,0x302b3542b531b07d
.quad 0xb56fae4d356f2e4d,0xb56fae4d356f2e4d,0x2e4db56fae4d356f,0x2e4db56fae4d356f,0xb49332a835962b0d,0x32a834932b0db596,0xb2a8b493ab0d3596,0xb49332a835962b0d,0xa18d35a735a7218d,0x218db5a7b5a7a18d,0xb5a7a18da18d35a7,0x35a7218d218db5a7,0x345d333435a2a84c,0xb334345d284c35a2,0xb334345d284c35a2,0xb45db334b5a2284c
.quad 0x3400340034003400,0x3400340034003400,0xb4003400b4003400,0xb4003400b4003400,0xb59d29adb478b2ef,0x29ad359db2ef3478,0xa9adb59d32efb478,0xb59d29adb478b2ef,0x31c2b4df34df31c2,0xb1c234dfb4dfb1c2,0x34df31c2b1c234df,0xb4dfb1c231c2b4df,0x302b3542b531b07d,0xb542302b307db531,0xb542302b307db531,0xb02bb5423531307d
.quad 0xb56fae4d356f2e4d,0xb56fae4d356f2e4d,0x2e4db56fae4d356f,0x2e4db56fae4d356f,0x3493b2a8b596ab0d,0xb2a8b493ab0d3596,0x32a834932b0db596,0x3493b2a8b596ab0d,0xa18d35a735a7218d,0x218db5a7b5a7a18d,0xb5a7a18da18d35a7,0x35a7218d218db5a7,0xb45db334b5a2284c,0x3334b45da84cb5a2,0x3334b45da84cb5a2,0x345d333435a2a84c
.quad 0,0,0,0,0,0,0,0,0,0,0,0,0,0,0,0
.quad 0,0,0,0,0,0,0,0,0,0,0,0,0,0,0,0
.quad 0,0,0,0,0,0,0,0,0,0,0,0,0,0,0,0
.quad 0,0,0,0,0,0,0,0,0,0,0,0,0,0,0,0
.quad 0x3400340034003400,0x3400340034003400,0xb4003400b4003400,0xb4003400b4003400,0x359ca9d1347b32e8,0xa9d1b59c32e8b47b,0x29d1359cb2e8347b,0x359ca9d1347b32e8,0x31b2b4e334e331b2,0xb1b234e3b4e3b1b2,0x34e331b2b1b234e3,0xb4e3b1b231b2b4e3,0xb044b53d35363065,0x353db044b0653536,0x353db044b0653536,0x3044353db536b065
.quad 0xb574ae0935742e09,0xb574ae0935742e09,0x2e09b574ae093574,0x2e09b574ae093574,0xb48632cc359a2a5e,0x32cc34862a5eb59a,0xb2ccb486aa5e359a,0xb48632cc359a2a5e,0x9c7135a835a81c71,0x1c71b5a8b5a89c71,0xb5a89c719c7135a8,0x35a81c711c71b5a8,0x34703304359ea944,0xb30434702944359e,0xb30434702944359e,0xb470b304b59e2944
.quad 0x3400340034003400,0x3400340034003400,0xb4003400b4003400,0xb4003400b4003400,0xb59c29d1b47bb2e8,0x29d1359cb2e8347b,0xa9d1b59c32e8b47b,0xb59c29d1b47bb2e8,0x31b2b4e334e331b2,0xb1b234e3b4e3b1b2,0x34e331b2b1b234e3,0xb4e3b1b231b2b4e3,0x3044353db536b065,0xb53d30443065b536,0xb53d30443065b536,0xb044b53d35363065
.quad 0xb574ae0935742e09,0xb574ae0935742e09,0x2e09b574ae093574,0x2e09b574ae093574,0x3486b2ccb59aaa5e,0xb2ccb486aa5e359a,0x32cc34862a5eb59a,0x3486b2ccb59aaa5e,0x9c7135a835a81c71,0x1c71b5a8b5a89c71,0xb5a89c719c7135a8,0x35a81c711c71b5a8,0xb470b304b59e2944,0x3304b470a944b59e,0x3304b470a944b59e,0x34703304359ea944
.quad 0,0,0,0,0,0,0,0,0,0,0,0,0,0,0,0
.quad 0,0,0,0,0,0,0,0,0,0,0,0,0,0,0,0
.quad 0,0,0,0,0,0,0,0,0,0,0,0,0,0,0,0
.quad 0,0,0,0,0,0,0,0,0,0,0,0,0,0,0,0
.quad 0x3400340034003400,0x3400340034003400,0xb4003400b4003400,0xb4003400b4003400,0x359ca9f4347e32e1,0xa9f4b59c32e1b47e,0x29f4359cb2e1347e,0x359ca9f4347e32e1,0x31a3b4e834e831a3,0xb1a334e8b4e8b1a3,0x34e831a3b1a334e8,0xb4e8b1a331a3b4e8,0xb05db538353c304c,0x3538b05db04c353c,0x3538b05db04c353c,0x305d3538b53cb04c
.quad 0xb578adc435782dc4,0xb578adc435782dc4,0x2dc4b578adc43578,0x2dc4b578adc43578,0xb47832ef359d29ad,0x32ef347829adb59d,0xb2efb478a9ad359d,0xb47832ef359d29ad,0x187135a835a89871,0x9871b5a8b5a81871,0xb5a81871187135a8,0x35a898719871b5a8,0x348332d3359aaa3a,0xb2d334832a3a359a,0xb2d334832a3a359a,0xb483b2d3b59a2a3a
.quad 0x3400340034003400,0x3400340034003400,0xb4003400b4003400,0xb4003400b4003400,0xb59c29f4b47eb2e1,0x29f4359cb2e1347e,0xa9f4b59c32e1b47e,0xb59c29f4b47eb2e1,0x31a3b4e834e831a3,0xb1a334e8b4e8b1a3,0x34e831a3b1a334e8,0xb4e8b1a331a3b4e8,0x305d3538b53cb04c,0xb538305d304cb53c,0xb538305d304cb53c,0xb05db538353c304c
.quad 0xb578adc435782dc4,0xb578adc435782dc4,0x2dc4b578adc43578,0x2dc4b578adc43578,0x3478b2efb59da9ad,0xb2efb478a9ad359d,0x32ef347829adb59d,0x3478b2efb59da9ad,0x187135a835a89871,0x9871b5a8b5a81871,0xb5a81871187135a8,0x35a898719871b5a8,0xb483b2d3b59a2a3a,0x32d3b483aa3ab59a,0x32d3b483aa3ab59a,0x348332d3359aaa3a
.quad 0,0,0,0,0,0,0,0,0,0,0,0,0,0,0,0
.quad 0,0,0,0,0,0,0,0,0,0,0,0,0,0,0,0
.quad 0,0,0,0,0,0,0,0,0,0,0,0,0,0,0,0
.quad 0,0,0,0,0,0,0,0,0,0,0,0,0,0,0,0
.quad 0x3400340034003400,0x3400340034003400,0xb4003400b4003400,0xb4003400b4003400,0x359baa17348032da,0xaa17b59b32dab480,0x2a17359bb2da3480,0x359baa17348032da,0x3194b4ec34ec3194,0xb19434ecb4ecb194,0x34ec3194b19434ec,0xb4ecb1943194b4ec,0xb075b53335413033,0x3533b075b0333541,0x3533b075b0333541,0x30753533b541b033
.quad 0xb57dad7f357d2d7f,0xb57dad7f357d2d7f,0x2d7fb57dad7f357d,0x2d7fb57dad7f357d,0xb46b3312359f28fd,0x3312346b28fdb59f,0xb312b46ba8fd359f,0xb46b3312359f28fd,0x207135a835a8a071,0xa071b5a8b5a82071,0xb5a82071207135a8,0x35a8a071a071b5a8,0x349632a13596ab30,0xb2a134962b303596,0xb2a134962b303596,0xb496b2a1b5962b30
.quad 0x3400340034003400,0x3400340034003400,0xb4003400b4003400,0xb4003400b4003400,0xb59b2a17b480b2da,0x2a17359bb2da3480,0xaa17b59b32dab480,0xb59b2a17b480b2da,0x3194b4ec34ec3194,0xb19434ecb4ecb194,0x34ec3194b19434ec,0xb4ecb1943194b4ec,0x30753533b541b033,0xb53330753033b541,0xb53330753033b541,0xb075b53335413033
.quad 0xb57dad7f357d2d7f,0xb57dad7f357d2d7f,0x2d7fb57dad7f357d,0x2d7fb57dad7f357d,0x346bb312b59fa8fd,0xb312b46ba8fd359f,0x3312346b28fdb59f,0x346bb312b59fa8fd,0x207135a835a8a071,0xa071b5a8b5a82071,0xb5a82071207135a8,0x35a8a071a071b5a8,0xb496b2a1b5962b30,0x32a1b496ab30b596,0x32a1b496ab30b596,0x349632a13596ab30
.quad 0,0,0,0,0,0,0,0,0,0,0,0,0,0,0,0
.quad 0,0,0,0,0,0,0,0,0,0,0,0,0,0,0,0
.quad 0,0,0,0,0,0,0,0,0,0,0,0,0,0,0,0
.quad 0,0,0,0,0,0,0,0,0,0,0,0,0,0,0,0
.quad 0x3400340034003400,0x3400340034003400,0xb4003400b4003400,0xb4003400b4003400,0x359aaa3a348332d3,0xaa3ab59a32d3b483,0x2a3a359ab2d33483,0x359aaa3a348332d3,0x3184b4f034f03184,0xb18434f0b4f0b184,0x34f03184b18434f0,0xb4f0b1843184b4f0,0xb08eb52e3546301b,0x352eb08eb01b3546,0x352eb08eb01b3546,0x308e352eb546b01b
.quad 0xb581ad3a35812d3a,0xb581ad3a35812d3a,0x2d3ab581ad3a3581,0x2d3ab581ad3a3581,0xb45d333435a2284c,0x3334345d284cb5a2,0xb334b45da84c35a2,0xb45d333435a2284c,0x23c635a735a7a3c6,0xa3c6b5a7b5a723c6,0xb5a723c623c635a7,0x35a7a3c6a3c6b5a7,0x34a8326e3590ac13,0xb26e34a82c133590,0xb26e34a82c133590,0xb4a8b26eb5902c13
.quad 0x3400340034003400,0x3400340034003400,0xb4003400b4003400,0xb4003400b4003400,0xb59a2a3ab483b2d3,0x2a3a359ab2d33483,0xaa3ab59a32d3b483,0xb59a2a3ab483b2d3,0x3184b4f034f03184,0xb18434f0b4f0b184,0x34f03184b18434f0,0xb4f0b1843184b4f0,0x308e352eb546b01b,0xb52e308e301bb546,0xb52e308e301bb546,0xb08eb52e3546301b
.quad 0xb581ad3a35812d3a,0xb581ad3a35812d3a,0x2d3ab581ad3a3581,0x2d3ab581ad3a3581,0x345db334b5a2a84c,0xb334b45da84c35a2,0x3334345d284cb5a2,0x345db334b5a2a84c,0x23c635a735a7a3c6,0xa3c6b5a7b5a723c6,0xb5a723c623c635a7,0x35a7a3c6a3c6b5a7,0xb4a8b26eb5902c13,0x326eb4a8ac13b590,0x326eb4a8ac13b590,0x34a8326e3590ac13
.quad 0,0,0,0,0,0,0,0,0,0,0,0,0,0,0,0
.quad 0,0,0,0,0,0,0,0,0,0,0,0,0,0,0,0
.quad 0,0,0,0,0,0,0,0,0,0,0,0,0,0,0,0
.quad 0,0,0,0,0,0,0,0,0,0,0,0,0,0,0,0
.quad 0x3400340034003400,0x3400340034003400,0xb4003400b4003400,0xb4003400b4003400,0x359aaa5e348632cc,0xaa5eb59a32ccb486,0x2a5e359ab2cc3486,0x359aaa5e348632cc,0x3175b4f534f53175,0xb17534f5b4f5b175,0x34f53175b17534f5,0xb4f5b1753175b4f5,0xb0a6b528354a3002,0x3528b0a6b002354a,0x3528b0a6b002354a,0x30a63528b54ab002
.quad 0xb585acf535852cf5,0xb585acf535852cf5,0x2cf5b585acf53585,0x2cf5b585acf53585,0xb44e335635a42736,0x3356344e2736b5a4,0xb356b44ea73635a4,0xb44e335635a42736,0x258d35a535a5a58d,0xa58db5a5b5a5258d,0xb5a5258d258d35a5,0x35a5a58da58db5a5,0x34b9323a358bac8d,0xb23a34b92c8d358b,0xb23a34b92c8d358b,0xb4b9b23ab58b2c8d
.quad 0x3400340034003400,0x3400340034003400,0xb4003400b4003400,0xb4003400b4003400,0xb59a2a5eb486b2cc,0x2a5e359ab2cc3486,0xaa5eb59a32ccb486,0xb59a2a5eb486b2cc,0x3175b4f534f53175,0xb17534f5b4f5b175,0x34f53175b17534f5,0xb4f5b1753175b4f5,0x30a63528b54ab002,0xb52830a63002b54a,0xb52830a63002b54a,0xb0a6b528354a3002
.quad 0xb585acf535852cf5,0xb585acf535852cf5,0x2cf5b585acf53585,0x2cf5b585acf53585,0x344eb356b5a4a736,0xb356b44ea73635a4,0x3356344e2736b5a4,0x344eb356b5a4a736,0x258d35a535a5a58d,0xa58db5a5b5a5258d,0xb5a5258d258d35a5,0x35a5a58da58db5a5,0xb4b9b23ab58b2c8d,0x323ab4b9ac8db58b,0x323ab4b9ac8db58b,0x34b9323a358bac8d
.quad 0,0,0,0,0,0,0,0,0,0,0,0,0,0,0,0
.quad 0,0,0,0,0,0,0,0,0,0,0,0,0,0,0,0
.quad 0,0,0,0,0,0,0,0,0,0,0,0,0,0,0,0
.quad 0,0,0,0,0,0,0,0,0,0,0,0,0,0,0,0
.quad 0x3400340034003400,0x3400340034003400,0xb4003400b4003400,0xb4003400b4003400,0x3599aa81348932c4,0xaa81b59932c4b489,0x2a813599b2c43489,0x3599aa81348932c4,0x3165b4f934f93165,0xb16534f9b4f9b165,0x34f93165b16534f9,0xb4f9b1653165b4f9,0xb0beb523354f2fd2,0x3523b0beafd2354f,0x3523b0beafd2354f,0x30be3523b54fafd2
.quad 0xb589acb035892cb0,0xb589acb035892cb0,0x2cb0b589acb03589,0x2cb0b589acb03589,0xb440337835a525d4,0x3378344025d4b5a5,0xb378b440a5d435a5,0xb440337835a525d4,0x273635a435a4a736,0xa736b5a4b5a42736,0xb5a42736273635a4,0x35a4a736a736b5a4,0x34ca32063584ad07,0xb20634ca2d073584,0xb20634ca2d073584,0xb4cab206b5842d07
.quad 0x3400340034003400,0x3400340034003400,0xb4003400b4003400,0xb4003400b4003400,0xb5992a81b489b2c4,0x2a813599b2c43489,0xaa81b59932c4b489,0xb5992a81b489b2c4,0x3165b4f934f93165,0xb16534f9b4f9b165,0x34f93165b16534f9,0xb4f9b1653165b4f9,0x30be3523b54fafd2,0xb52330be2fd2b54f,0xb52330be2fd2b54f,0xb0beb523354f2fd2
.quad 0xb589acb035892cb0,0xb589acb035892cb0,0x2cb0b589acb03589,0x2cb0b589acb03589,0x3440b378b5a5a5d4,0xb378b440a5d435a5,0x3378344025d4b5a5,0x3440b378b5a5a5d4,0x273635a435a4a736,0xa736b5a4b5a42736,0xb5a42736273635a4,0x35a4a736a736b5a4,0xb4cab206b5842d07,0x3206b4caad07b584,0x3206b4caad07b584,0x34ca32063584ad07
.quad 0,0,0,0,0,0,0,0,0,0,0,0,0,0,0,0
.quad 0,0,0,0,0,0,0,0,0,0,0,0,0,0,0,0
.quad 0,0,0,0,0,0,0,0,0,0,0,0,0,0,0,0
.quad 0,0,0,0,0,0,0,0,0,0,0,0,0,0,0,0
.quad 0x3400340034003400,0x3400340034003400,0xb4003400b4003400,0xb4003400b4003400,0x3598aaa4348b32bd,0xaaa4b59832bdb48b,0x2aa43598b2bd348b,0x3598aaa4348b32bd,0x3155b4fd34fd3155,0xb15534fdb4fdb155,0x34fd3155b15534fd,0xb4fdb1553155b4fd,0xb0d6b51d35542f9f,0x351db0d6af9f3554,0x351db0d6af9f3554,0x30d6351db554af9f
.quad 0xb58cac6a358c2c6a,0xb58cac6a358c2c6a,0x2c6ab58cac6a358c,0x2c6ab58cac6a358c,0xb431339935a62471,0x339934312471b5a6,0xb399b431a47135a6,0xb431339935a62471,0x287035a135a1a870,0xa870b5a1b5a12870,0xb5a12870287035a1,0x35a1a870a870b5a1,0x34da31d1357dad7f,0xb1d134da2d7f357d,0xb1d134da2d7f357d,0xb4dab1d1b57d2d7f
.quad 0x3400340034003400,0x3400340034003400,0xb4003400b4003400,0xb4003400b4003400,0xb5982aa4b48bb2bd,0x2aa43598b2bd348b,0xaaa4b59832bdb48b,0xb5982aa4b48bb2bd,0x3155b4fd34fd3155,0xb15534fdb4fdb155,0x34fd3155b15534fd,0xb4fdb1553155b4fd,0x30d6351db554af9f,0xb51d30d62f9fb554,0xb51d30d62f9fb554,0xb0d6b51d35542f9f
.quad 0xb58cac6a358c2c6a,0xb58cac6a358c2c6a,0x2c6ab58cac6a358c,0x2c6ab58cac6a358c,0x3431b399b5a6a471,0xb399b431a47135a6,0x339934312471b5a6,0x3431b399b5a6a471,0x287035a135a1a870,0xa870b5a1b5a12870,0xb5a12870287035a1,0x35a1a870a870b5a1,0xb4dab1d1b57d2d7f,0x31d1b4daad7fb57d,0x31d1b4daad7fb57d,0x34da31d1357dad7f
.quad 0,0,0,0,0,0,0,0,0,0,0,0,0,0,0,0
.quad 0,0,0,0,0,0,0,0,0,0,0,0,0,0,0,0
.quad 0,0,0,0,0,0,0,0,0,0,0,0,0,0,0,0
.quad 0,0,0,0,0,0,0,0,0,0,0,0,0,0,0,0
.quad 0x3400340034003400,0x3400340034003400,0xb4003400b4003400,0xb4003400b4003400,0x3598aac7348e32b6,0xaac7b59832b6b48e,0x2ac73598b2b6348e,0x3598aac7348e32b6,0x3146b50135013146,0xb1463501b501b146,0x35013146b1463501,0xb501b1463146b501,0xb0eeb51735582f6d,0x3517b0eeaf6d3558,0x3517b0eeaf6d3558,0x30ee3517b558af6d
.quad 0xb590ac2435902c24,0xb590ac2435902c24,0x2c24b590ac243590,0x2c24b590ac243590,0xb42233ba35a7221c,0x33ba3422221cb5a7,0xb3bab422a21c35a7,0xb42233ba35a7221c,0x2944359e359ea944,0xa944b59eb59e2944,0xb59e29442944359e,0x359ea944a944b59e,0x34ea319b3575adf8,0xb19b34ea2df83575,0xb19b34ea2df83575,0xb4eab19bb5752df8
.quad 0x3400340034003400,0x3400340034003400,0xb4003400b4003400,0xb4003400b4003400,0xb5982ac7b48eb2b6,0x2ac73598b2b6348e,0xaac7b59832b6b48e,0xb5982ac7b48eb2b6,0x3146b50135013146,0xb1463501b501b146,0x35013146b1463501,0xb501b1463146b501,0x30ee3517b558af6d,0xb51730ee2f6db558,0xb51730ee2f6db558,0xb0eeb51735582f6d
.quad 0xb590ac2435902c24,0xb590ac2435902c24,0x2c24b590ac243590,0x2c24b590ac243590,0x3422b3bab5a7a21c,0xb3bab422a21c35a7,0x33ba3422221cb5a7,0x3422b3bab5a7a21c,0x2944359e359ea944,0xa944b59eb59e2944,0xb59e29442944359e,0x359ea944a944b59e,0xb4eab19bb5752df8,0x319bb4eaadf8b575,0x319bb4eaadf8b575,0x34ea319b3575adf8
.quad 0,0,0,0,0,0,0,0,0,0,0,0,0,0,0,0
.quad 0,0,0,0,0,0,0,0,0,0,0,0,0,0,0,0
.quad 0,0,0,0,0,0,0,0,0,0,0,0,0,0,0,0
.quad 0,0,0,0,0,0,0,0,0,0,0,0,0,0,0,0
.quad 0x3400340034003400,0x3400340034003400,0xb4003400b4003400,0xb4003400b4003400,0x3597aaea349032af,0xaaeab59732afb490,0x2aea3597b2af3490,0x3597aaea349032af,0x3136b50535053136,0xb1363505b505b136,0x35053136b1363505,0xb505b1363136b505,0xb106b511355c2f3b,0x3511b106af3b355c,0x3511b106af3b355c,0x31063511b55caf3b
.quad 0xb593abbd35932bbd,0xb593abbd35932bbd,0x2bbdb593abbd3593,0x2bbdb593abbd3593,0xb41333da35a81eaa,0x33da34131eaab5a8,0xb3dab4139eaa35a8,0xb41333da35a81eaa,0x2a17359b359baa17,0xaa17b59bb59b2a17,0xb59b2a172a17359b,0x359baa17aa17b59b,0x34f93165356cae6f,0xb16534f92e6f356c,0xb16534f92e6f356c,0xb4f9b165b56c2e6f
.quad 0x3400340034003400,0x3400340034003400,0xb4003400b4003400,0xb4003400b4003400,0xb5972aeab490b2af,0x2aea3597b2af3490,0xaaeab59732afb490,0xb5972aeab490b2af,0x3136b50535053136,0xb1363505b505b136,0x35053136b1363505,0xb505b1363136b505,0x31063511b55caf3b,0xb51131062f3bb55c,0xb51131062f3bb55c,0xb106b511355c2f3b
.quad 0xb593abbd35932bbd,0xb593abbd35932bbd,0x2bbdb593abbd3593,0x2bbdb593abbd3593,0x3413b3dab5a89eaa,0xb3dab4139eaa35a8,0x33da34131eaab5a8,0x3413b3dab5a89eaa,0x2a17359b359baa17,0xaa17b59bb59b2a17,0xb59b2a172a17359b,0x359baa17aa17b59b,0xb4f9b165b56c2e6f,0x3165b4f9ae6fb56c,0x3165b4f9ae6fb56c,0x34f93165356cae6f
.quad 0,0,0,0,0,0,0,0,0,0,0,0,0,0,0,0
.quad 0,0,0,0,0,0,0,0,0,0,0,0,0,0,0,0
.quad 0,0,0,0,0,0,0,0,0,0,0,0,0,0,0,0
.quad 0,0,0,0,0,0,0,0,0,0,0,0,0,0,0,0
.quad 0x3400340034003400,0x3400340034003400,0xb4003400b4003400,0xb4003400b4003400,0x3596ab0d349332a8,0xab0db59632a8b493,0x2b0d3596b2a83493,0x3596ab0d349332a8,0x3126b50a350a3126,0xb126350ab50ab126,0x350a3126b126350a,0xb50ab1263126b50a,0xb11eb50c35602f08,0x350cb11eaf083560,0x350cb11eaf083560,0x311e350cb560af08
.quad 0xb596ab3035962b30,0xb596ab3035962b30,0x2b30b596ab303596,0x2b30b596ab303596,0xb40333fa35a81471,0x33fa34031471b5a8,0xb3fab403947135a8,0xb40333fa35a81471,0x2aea35973597aaea,0xaaeab597b5972aea,0xb5972aea2aea3597,0x3597aaeaaaeab597,0x3507312e3563aee6,0xb12e35072ee63563,0xb12e35072ee63563,0xb507b12eb5632ee6
.quad 0x3400340034003400,0x3400340034003400,0xb4003400b4003400,0xb4003400b4003400,0xb5962b0db493b2a8,0x2b0d3596b2a83493,0xab0db59632a8b493,0xb5962b0db493b2a8,0x3126b50a350a3126,0xb126350ab50ab126,0x350a3126b126350a,0xb50ab1263126b50a,0x311e350cb560af08,0xb50c311e2f08b560,0xb50c311e2f08b560,0xb11eb50c35602f08
.quad 0xb596ab3035962b30,0xb596ab3035962b30,0x2b30b596ab303596,0x2b30b596ab303596,0x3403b3fab5a89471,0xb3fab403947135a8,0x33fa34031471b5a8,0x3403b3fab5a89471,0x2aea35973597aaea,0xaaeab597b5972aea,0xb5972aea2aea3597,0x3597aaeaaaeab597,0xb507b12eb5632ee6,0x312eb507aee6b563,0x312eb507aee6b563,0x3507312e3563aee6
.quad 0,0,0,0,0,0,0,0,0,0,0,0,0,0,0,0
.quad 0,0,0,0,0,0,0,0,0,0,0,0,0,0,0,0
.quad 0,0,0,0,0,0,0,0,0,0,0,0,0,0,0,0
.quad 0,0,0,0,0,0,0,0,0,0,0,0,0,0,0,0
.quad 0x3400340034003400,0x3400340034003400,0xb4003400b4003400,0xb4003400b4003400,0x3596ab30349632a1,0xab30b59632a1b496,0x2b303596b2a13496,0x3596ab30349632a1,0x3116b50e350e3116,0xb116350eb50eb116,0x350e3116b116350e,0xb50eb1163116b50e,0xb136b50535652ed5,0x3505b136aed53565,0x3505b136aed53565,0x31363505b565aed5
.quad 0xb598aaa435982aa4,0xb598aaa435982aa4,0x2aa4b598aaa43598,0x2aa4b598aaa43598,0xb3e7340c35a89c71,0x340c33e79c71b5a8,0xb40cb3e71c7135a8,0xb3e7340c35a89c71,0x2bbd35933593abbd,0xabbdb593b5932bbd,0xb5932bbd2bbd3593,0x3593abbdabbdb593,0x351530f63559af5c,0xb0f635152f5c3559,0xb0f635152f5c3559,0xb515b0f6b5592f5c
.quad 0x3400340034003400,0x3400340034003400,0xb4003400b4003400,0xb4003400b4003400,0xb5962b30b496b2a1,0x2b303596b2a13496,0xab30b59632a1b496,0xb5962b30b496b2a1,0x3116b50e350e3116,0xb116350eb50eb116,0x350e3116b116350e,0xb50eb1163116b50e,0x31363505b565aed5,0xb50531362ed5b565,0xb50531362ed5b565,0xb136b50535652ed5
.quad 0xb598aaa435982aa4,0xb598aaa435982aa4,0x2aa4b598aaa43598,0x2aa4b598aaa43598,0x33e7b40cb5a81c71,0xb40cb3e71c7135a8,0x340c33e79c71b5a8,0x33e7b40cb5a81c71,0x2bbd35933593abbd,0xabbdb593b5932bbd,0xb5932bbd2bbd3593,0x3593abbdabbdb593,0xb515b0f6b5592f5c,0x30f6b515af5cb559,0x30f6b515af5cb559,0x351530f63559af5c
.quad 0,0,0,0,0,0,0,0,0,0,0,0,0,0,0,0
.quad 0,0,0,0,0,0,0,0,0,0,0,0,0,0,0,0
.quad 0,0,0,0,0,0,0,0,0,0,0,0,0,0,0,0
.quad 0,0,0,0,0,0,0,0,0,0,0,0,0,0,0,0
.quad 0x3400340034003400,0x3400340034003400,0xb4003400b4003400,0xb4003400b4003400,0x3595ab5334983299,0xab53b5953299b498,0x2b533595b2993498,0x3595ab5334983299,0x3106b51135113106,0xb1063511b511b106,0x35113106b1063511,0xb511b1063106b511,0xb14db4ff35692ea3,0x34ffb14daea33569,0x34ffb14daea33569,0x314d34ffb569aea3
.quad 0xb59baa17359b2a17,0xb59baa17359b2a17,0x2a17b59baa17359b,0x2a17b59baa17359b,0xb3c7341c35a8a0ff,0x341c33c7a0ffb5a8,0xb41cb3c720ff35a8,0xb3c7341c35a8a0ff,0x2c47358e358eac47,0xac47b58eb58e2c47,0xb58e2c472c47358e,0x358eac47ac47b58e,0x352330be354fafd2,0xb0be35232fd2354f,0xb0be35232fd2354f,0xb523b0beb54f2fd2
.quad 0x3400340034003400,0x3400340034003400,0xb4003400b4003400,0xb4003400b4003400,0xb5952b53b498b299,0x2b533595b2993498,0xab53b5953299b498,0xb5952b53b498b299,0x3106b51135113106,0xb1063511b511b106,0x35113106b1063511,0xb511b1063106b511,0x314d34ffb569aea3,0xb4ff314d2ea3b569,0xb4ff314d2ea3b569,0xb14db4ff35692ea3
.quad 0xb59baa17359b2a17,0xb59baa17359b2a17,0x2a17b59baa17359b,0x2a17b59baa17359b,0x33c7b41cb5a820ff,0xb41cb3c720ff35a8,0x341c33c7a0ffb5a8,0x33c7b41cb5a820ff,0x2c47358e358eac47,0xac47b58eb58e2c47,0xb58e2c472c47358e,0x358eac47ac47b58e,0xb523b0beb54f2fd2,0x30beb523afd2b54f,0x30beb523afd2b54f,0x352330be354fafd2
.quad 0,0,0,0,0,0,0,0,0,0,0,0,0,0,0,0
.quad 0,0,0,0,0,0,0,0,0,0,0,0,0,0,0,0
.quad 0,0,0,0,0,0,0,0,0,0,0,0,0,0,0,0
.quad 0,0,0,0,0,0,0,0,0,0,0,0,0,0,0,0
.quad 0x3400340034003400,0x3400340034003400,0xb4003400b4003400,0xb4003400b4003400,0x3594ab77349b3292,0xab77b5943292b49b,0x2b773594b292349b,0x3594ab77349b3292,0x30f6b515351530f6,0xb0f63515b515b0f6,0x351530f6b0f63515,0xb515b0f630f6b515,0xb165b4f9356c2e6f,0x34f9b165ae6f356c,0x34f9b165ae6f356c,0x316534f9b56cae6f
.quad 0xb59da98a359d298a,0xb59da98a359d298a,0x298ab59da98a359d,0x298ab59da98a359d,0xb3a6342b35a7a3c6,0x342b33a6a3c6b5a7,0xb42bb3a623c635a7,0xb3a6342b35a7a3c6,0x2cb035893589acb0,0xacb0b589b5892cb0,0xb5892cb02cb03589,0x3589acb0acb0b589,0x352f30853544b023,0xb085352f30233544,0xb085352f30233544,0xb52fb085b5443023
.quad 0x3400340034003400,0x3400340034003400,0xb4003400b4003400,0xb4003400b4003400,0xb5942b77b49bb292,0x2b773594b292349b,0xab77b5943292b49b,0xb5942b77b49bb292,0x30f6b515351530f6,0xb0f63515b515b0f6,0x351530f6b0f63515,0xb515b0f630f6b515,0x316534f9b56cae6f,0xb4f931652e6fb56c,0xb4f931652e6fb56c,0xb165b4f9356c2e6f
.quad 0xb59da98a359d298a,0xb59da98a359d298a,0x298ab59da98a359d,0x298ab59da98a359d,0x33a6b42bb5a723c6,0xb42bb3a623c635a7,0x342b33a6a3c6b5a7,0x33a6b42bb5a723c6,0x2cb035893589acb0,0xacb0b589b5892cb0,0xb5892cb02cb03589,0x3589acb0acb0b589,0xb52fb085b5443023,0x3085b52fb023b544,0x3085b52fb023b544,0x352f30853544b023
.quad 0,0,0,0,0,0,0,0,0,0,0,0,0,0,0,0
.quad 0,0,0,0,0,0,0,0,0,0,0,0,0,0,0,0
.quad 0,0,0,0,0,0,0,0,0,0,0,0,0,0,0,0
.quad 0,0,0,0,0,0,0,0,0,0,0,0,0,0,0,0
.quad 0x3400340034003400,0x3400340034003400,0xb4003400b4003400,0xb4003400b4003400,0x3594ab9a349d328b,0xab9ab594328bb49d,0x2b9a3594b28b349d,0x3594ab9a349d328b,0x30e6b519351930e6,0xb0e63519b519b0e6,0x351930e6b0e63519,0xb519b0e630e6b519,0xb17cb4f335702e3c,0x34f3b17cae3c3570,0x34f3b17cae3c3570,0x317c34f3b570ae3c
.quad 0xb59fa8fd359f28fd,0xb59fa8fd359f28fd,0x28fdb59fa8fd359f,0x28fdb59fa8fd359f,0xb385343a35a6a546,0x343a3385a546b5a6,0xb43ab385254635a6,0xb385343a35a6a546,0x2d1835833583ad18,0xad18b583b5832d18,0xb5832d182d183583,0x3583ad18ad18b583,0x353c304c3538b05d,0xb04c353c305d3538,0xb04c353c305d3538,0xb53cb04cb538305d
.quad 0x3400340034003400,0x3400340034003400,0xb4003400b4003400,0xb4003400b4003400,0xb5942b9ab49db28b,0x2b9a3594b28b349d,0xab9ab594328bb49d,0xb5942b9ab49db28b,0x30e6b519351930e6,0xb0e63519b519b0e6,0x351930e6b0e63519,0xb519b0e630e6b519,0x317c34f3b570ae3c,0xb4f3317c2e3cb570,0xb4f3317c2e3cb570,0xb17cb4f335702e3c
.quad 0xb59fa8fd359f28fd,0xb59fa8fd359f28fd,0x28fdb59fa8fd359f,0x28fdb59fa8fd359f,0x3385b43ab5a62546,0xb43ab385254635a6,0x343a3385a546b5a6,0x3385b43ab5a62546,0x2d1835833583ad18,0xad18b583b5832d18,0xb5832d182d183583,0x3583ad18ad18b583,0xb53cb04cb538305d,0x304cb53cb05db538,0x304cb53cb05db538,0x353c304c3538b05d
.quad 0,0,0,0,0,0,0,0,0,0,0,0,0,0,0,0
.quad 0,0,0,0,0,0,0,0,0,0,0,0,0,0,0,0
.quad 0,0,0,0,0,0,0,0,0,0,0,0,0,0,0,0
.quad 0,0,0,0,0,0,0,0,0,0,0,0,0,0,0,0
.quad 0x3400340034003400,0x3400340034003400,0xb4003400b4003400,0xb4003400b4003400,0x3593abbd34a03284,0xabbdb5933284b4a0,0x2bbd3593b28434a0,0x3593abbd34a03284,0x30d6b51d351d30d6,0xb0d6351db51db0d6,0x351d30d6b0d6351d,0xb51db0d630d6b51d,0xb194b4ec35742e09,0x34ecb194ae093574,0x34ecb194ae093574,0x319434ecb574ae09
.quad 0xb5a1a87035a12870,0xb5a1a87035a12870,0x2870b5a1a87035a1,0x2870b5a1a87035a1,0xb364344935a4a6a9,0x34493364a6a9b5a4,0xb449b36426a935a4,0xb364344935a4a6a9,0x2d7f357d357dad7f,0xad7fb57db57d2d7f,0xb57d2d7f2d7f357d,0x357dad7fad7fb57d,0x35473012352cb096,0xb01235473096352c,0xb01235473096352c,0xb547b012b52c3096
.quad 0x3400340034003400,0x3400340034003400,0xb4003400b4003400,0xb4003400b4003400,0xb5932bbdb4a0b284,0x2bbd3593b28434a0,0xabbdb5933284b4a0,0xb5932bbdb4a0b284,0x30d6b51d351d30d6,0xb0d6351db51db0d6,0x351d30d6b0d6351d,0xb51db0d630d6b51d,0x319434ecb574ae09,0xb4ec31942e09b574,0xb4ec31942e09b574,0xb194b4ec35742e09
.quad 0xb5a1a87035a12870,0xb5a1a87035a12870,0x2870b5a1a87035a1,0x2870b5a1a87035a1,0x3364b449b5a426a9,0xb449b36426a935a4,0x34493364a6a9b5a4,0x3364b449b5a426a9,0x2d7f357d357dad7f,0xad7fb57db57d2d7f,0xb57d2d7f2d7f357d,0x357dad7fad7fb57d,0xb547b012b52c3096,0x3012b547b096b52c,0x3012b547b096b52c,0x35473012352cb096
.quad 0,0,0,0,0,0,0,0,0,0,0,0,0,0,0,0
.quad 0,0,0,0,0,0,0,0,0,0,0,0,0,0,0,0
.quad 0,0,0,0,0,0,0,0,0,0,0,0,0,0,0,0
.quad 0,0,0,0,0,0,0,0,0,0,0,0,0,0,0,0
.quad 0x3400340034003400,0x3400340034003400,0xb4003400b4003400,0xb4003400b4003400,0x3592abe034a3327c,0xabe0b592327cb4a3,0x2be03592b27c34a3,0x3592abe034a3327c,0x30c6b521352130c6,0xb0c63521b521b0c6,0x352130c6b0c63521,0xb521b0c630c6b521,0xb1abb4e535772dd6,0x34e5b1abadd63577,0x34e5b1abadd63577,0x31ab34e5b577add6
.quad 0xb5a3a7c435a327c4,0xb5a3a7c435a327c4,0x27c4b5a3a7c435a3,0x27c4b5a3a7c435a3,0xb342345735a2a805,0x34573342a805b5a2,0xb457b342280535a2,0xb342345735a2a805,0x2de735763576ade7,0xade7b576b5762de7,0xb5762de72de73576,0x3576ade7ade7b576,0x35522fb0351fb0ce,0xafb0355230ce351f,0xafb0355230ce351f,0xb552afb0b51f30ce
.quad 0x3400340034003400,0x3400340034003400,0xb4003400b4003400,0xb4003400b4003400,0xb5922be0b4a3b27c,0x2be03592b27c34a3,0xabe0b592327cb4a3,0xb5922be0b4a3b27c,0x30c6b521352130c6,0xb0c63521b521b0c6,0x352130c6b0c63521,0xb521b0c630c6b521,0x31ab34e5b577add6,0xb4e531ab2dd6b577,0xb4e531ab2dd6b577,0xb1abb4e535772dd6
.quad 0xb5a3a7c435a327c4,0xb5a3a7c435a327c4,0x27c4b5a3a7c435a3,0x27c4b5a3a7c435a3,0x3342b457b5a22805,0xb457b342280535a2,0x34573342a805b5a2,0x3342b457b5a22805,0x2de735763576ade7,0xade7b576b5762de7,0xb5762de72de73576,0x3576ade7ade7b576,0xb552afb0b51f30ce,0x2fb0b552b0ceb51f,0x2fb0b552b0ceb51f,0x35522fb0351fb0ce
.quad 0,0,0,0,0,0,0,0,0,0,0,0,0,0,0,0
.quad 0,0,0,0,0,0,0,0,0,0,0,0,0,0,0,0
.quad 0,0,0,0,0,0,0,0,0,0,0,0,0,0,0,0
.quad 0,0,0,0,0,0,0,0,0,0,0,0,0,0,0,0
.quad 0x3400340034003400,0x3400340034003400,0xb4003400b4003400,0xb4003400b4003400,0x3591ac0134a53275,0xac01b5913275b4a5,0x2c013591b27534a5,0x3591ac0134a53275,0x30b6b525352530b6,0xb0b63525b525b0b6,0x352530b6b0b63525,0xb525b0b630b6b525,0xb1c2b4df357b2da2,0x34dfb1c2ada2357b,0x34dfb1c2ada2357b,0x31c234dfb57bada2
.quad 0xb5a4a6a935a426a9,0xb5a4a6a935a426a9,0x26a9b5a4a6a935a4,0x26a9b5a4a6a935a4,0xb320346535a0a8b6,0x34653320a8b6b5a0,0xb465b32028b635a0,0xb320346535a0a8b6,0x2e4d356f356fae4d,0xae4db56fb56f2e4d,0xb56f2e4d2e4d356f,0x356fae4dae4db56f,0x355c2f3b3511b106,0xaf3b355c31063511,0xaf3b355c31063511,0xb55caf3bb5113106
.quad 0x3400340034003400,0x3400340034003400,0xb4003400b4003400,0xb4003400b4003400,0xb5912c01b4a5b275,0x2c013591b27534a5,0xac01b5913275b4a5,0xb5912c01b4a5b275,0x30b6b525352530b6,0xb0b63525b525b0b6,0x352530b6b0b63525,0xb525b0b630b6b525,0x31c234dfb57bada2,0xb4df31c22da2b57b,0xb4df31c22da2b57b,0xb1c2b4df357b2da2
.quad 0xb5a4a6a935a426a9,0xb5a4a6a935a426a9,0x26a9b5a4a6a935a4,0x26a9b5a4a6a935a4,0x3320b465b5a028b6,0xb465b32028b635a0,0x34653320a8b6b5a0,0x3320b465b5a028b6,0x2e4d356f356fae4d,0xae4db56fb56f2e4d,0xb56f2e4d2e4d356f,0x356fae4dae4db56f,0xb55caf3bb5113106,0x2f3bb55cb106b511,0x2f3bb55cb106b511,0x355c2f3b3511b106
.quad 0,0,0,0,0,0,0,0,0,0,0,0,0,0,0,0
.quad 0,0,0,0,0,0,0,0,0,0,0,0,0,0,0,0
.quad 0,0,0,0,0,0,0,0,0,0,0,0,0,0,0,0
.quad 0,0,0,0,0,0,0,0,0,0,0,0,0,0,0,0
.quad 0x3400340034003400,0x3400340034003400,0xb4003400b4003400,0xb4003400b4003400,0x3590ac1334a8326e,0xac13b590326eb4a8,0x2c133590b26e34a8,0x3590ac1334a8326e,0x30a6b528352830a6,0xb0a63528b528b0a6,0x352830a6b0a63528,0xb528b0a630a6b528,0xb1d9b4d8357e2d6e,0x34d8b1d9ad6e357e,0x34d8b1d9ad6e357e,0x31d934d8b57ead6e
.quad 0xb5a5a58d35a5258d,0xb5a5a58d35a5258d,0x258db5a5a58d35a5,0x258db5a5a58d35a5,0xb2fd3473359ea967,0x347332fda967b59e,0xb473b2fd2967359e,0xb2fd3473359ea967,0x2eb335673567aeb3,0xaeb3b567b5672eb3,0xb5672eb32eb33567,0x3567aeb3aeb3b567,0x35662ec43503b13e,0xaec43566313e3503,0xaec43566313e3503,0xb566aec4b503313e
.quad 0x3400340034003400,0x3400340034003400,0xb4003400b4003400,0xb4003400b4003400,0xb5902c13b4a8b26e,0x2c133590b26e34a8,0xac13b590326eb4a8,0xb5902c13b4a8b26e,0x30a6b528352830a6,0xb0a63528b528b0a6,0x352830a6b0a63528,0xb528b0a630a6b528,0x31d934d8b57ead6e,0xb4d831d92d6eb57e,0xb4d831d92d6eb57e,0xb1d9b4d8357e2d6e
.quad 0xb5a5a58d35a5258d,0xb5a5a58d35a5258d,0x258db5a5a58d35a5,0x258db5a5a58d35a5,0x32fdb473b59e2967,0xb473b2fd2967359e,0x347332fda967b59e,0x32fdb473b59e2967,0x2eb335673567aeb3,0xaeb3b567b5672eb3,0xb5672eb32eb33567,0x3567aeb3aeb3b567,0xb566aec4b503313e,0x2ec4b566b13eb503,0x2ec4b566b13eb503,0x35662ec43503b13e
.quad 0,0,0,0,0,0,0,0,0,0,0,0,0,0,0,0
.quad 0,0,0,0,0,0,0,0,0,0,0,0,0,0,0,0
.quad 0,0,0,0,0,0,0,0,0,0,0,0,0,0,0,0
.quad 0,0,0,0,0,0,0,0,0,0,0,0,0,0,0,0
.quad 0x3400340034003400,0x3400340034003400,0xb4003400b4003400,0xb4003400b4003400,0x3590ac2434aa3267,0xac24b5903267b4aa,0x2c243590b26734aa,0x3590ac2434aa3267,0x3096b52c352c3096,0xb096352cb52cb096,0x352c3096b096352c,0xb52cb0963096b52c,0xb1efb4d135812d3a,0x34d1b1efad3a3581,0x34d1b1efad3a3581,0x31ef34d1b581ad3a
.quad 0xb5a6a47135a62471,0xb5a6a47135a62471,0x2471b5a6a47135a6,0x2471b5a6a47135a6,0xb2da3480359baa17,0x348032daaa17b59b,0xb480b2da2a17359b,0xb2da3480359baa17,0x2f19355f355faf19,0xaf19b55fb55f2f19,0xb55f2f192f19355f,0x355faf19af19b55f,0x356f2e4d34f5b175,0xae4d356f317534f5,0xae4d356f317534f5,0xb56fae4db4f53175
.quad 0x3400340034003400,0x3400340034003400,0xb4003400b4003400,0xb4003400b4003400,0xb5902c24b4aab267,0x2c243590b26734aa,0xac24b5903267b4aa,0xb5902c24b4aab267,0x3096b52c352c3096,0xb096352cb52cb096,0x352c3096b096352c,0xb52cb0963096b52c,0x31ef34d1b581ad3a,0xb4d131ef2d3ab581,0xb4d131ef2d3ab581,0xb1efb4d135812d3a
.quad 0xb5a6a47135a62471,0xb5a6a47135a62471,0x2471b5a6a47135a6,0x2471b5a6a47135a6,0x32dab480b59b2a17,0xb480b2da2a17359b,0x348032daaa17b59b,0x32dab480b59b2a17,0x2f19355f355faf19,0xaf19b55fb55f2f19,0xb55f2f192f19355f,0x355faf19af19b55f,0xb56fae4db4f53175,0x2e4db56fb175b4f5,0x2e4db56fb175b4f5,0x356f2e4d34f5b175
.quad 0,0,0,0,0,0,0,0,0,0,0,0,0,0,0,0
.quad 0,0,0,0,0,0,0,0,0,0,0,0,0,0,0,0
.quad 0,0,0,0,0,0,0,0,0,0,0,0,0,0,0,0
.quad 0,0,0,0,0,0,0,0,0,0,0,0,0,0,0,0
.quad 0x3400340034003400,0x3400340034003400,0xb4003400b4003400,0xb4003400b4003400,0x358fac3634ad325f,0xac36b58f325fb4ad,0x2c36358fb25f34ad,0x358fac3634ad325f,0x3085b52f352f3085,0xb085352fb52fb085,0x352f3085b085352f,0xb52fb0853085b52f,0xb206b4ca35842d07,0x34cab206ad073584,0x34cab206ad073584,0x320634cab584ad07
.quad 0xb5a7a2aa35a722aa,0xb5a7a2aa35a722aa,0x22aab5a7a2aa35a7,0x22aab5a7a2aa35a7,0xb2b6348e3598aac7,0x348e32b6aac7b598,0xb48eb2b62ac73598,0xb2b6348e3598aac7,0x2f7e35563556af7e,0xaf7eb556b5562f7e,0xb5562f7e2f7e3556,0x3556af7eaf7eb556,0x35772dd634e5b1ab,0xadd6357731ab34e5,0xadd6357731ab34e5,0xb577add6b4e531ab
.quad 0x3400340034003400,0x3400340034003400,0xb4003400b4003400,0xb4003400b4003400,0xb58f2c36b4adb25f,0x2c36358fb25f34ad,0xac36b58f325fb4ad,0xb58f2c36b4adb25f,0x3085b52f352f3085,0xb085352fb52fb085,0x352f3085b085352f,0xb52fb0853085b52f,0x320634cab584ad07,0xb4ca32062d07b584,0xb4ca32062d07b584,0xb206b4ca35842d07
.quad 0xb5a7a2aa35a722aa,0xb5a7a2aa35a722aa,0x22aab5a7a2aa35a7,0x22aab5a7a2aa35a7,0x32b6b48eb5982ac7,0xb48eb2b62ac73598,0x348e32b6aac7b598,0x32b6b48eb5982ac7,0x2f7e35563556af7e,0xaf7eb556b5562f7e,0xb5562f7e2f7e3556,0x3556af7eaf7eb556,0xb577add6b4e531ab,0x2dd6b577b1abb4e5,0x2dd6b577b1abb4e5,0x35772dd634e5b1ab
.quad 0,0,0,0,0,0,0,0,0,0,0,0,0,0,0,0
.quad 0,0,0,0,0,0,0,0,0,0,0,0,0,0,0,0
.quad 0,0,0,0,0,0,0,0,0,0,0,0,0,0,0,0
.quad 0,0,0,0,0,0,0,0,0,0,0,0,0,0,0,0
.quad 0x3400340034003400,0x3400340034003400,0xb4003400b4003400,0xb4003400b4003400,0x358eac4734af3258,0xac47b58e3258b4af,0x2c47358eb25834af,0x358eac4734af3258,0x3075b53335333075,0xb0753533b533b075,0x35333075b0753533,0xb533b0753075b533,0xb21db4c335872cd2,0x34c3b21dacd23587,0x34c3b21dacd23587,0x321d34c3b587acd2
.quad 0xb5a8a07135a82071,0xb5a8a07135a82071,0x2071b5a8a07135a8,0x2071b5a8a07135a8,0xb292349b3594ab77,0x349b3292ab77b594,0xb49bb2922b773594,0xb292349b3594ab77,0x2fe2354d354dafe2,0xafe2b54db54d2fe2,0xb54d2fe22fe2354d,0x354dafe2afe2b54d,0x357f2d5d34d6b1e0,0xad5d357f31e034d6,0xad5d357f31e034d6,0xb57fad5db4d631e0
.quad 0x3400340034003400,0x3400340034003400,0xb4003400b4003400,0xb4003400b4003400,0xb58e2c47b4afb258,0x2c47358eb25834af,0xac47b58e3258b4af,0xb58e2c47b4afb258,0x3075b53335333075,0xb0753533b533b075,0x35333075b0753533,0xb533b0753075b533,0x321d34c3b587acd2,0xb4c3321d2cd2b587,0xb4c3321d2cd2b587,0xb21db4c335872cd2
.quad 0xb5a8a07135a82071,0xb5a8a07135a82071,0x2071b5a8a07135a8,0x2071b5a8a07135a8,0x3292b49bb5942b77,0xb49bb2922b773594,0x349b3292ab77b594,0x3292b49bb5942b77,0x2fe2354d354dafe2,0xafe2b54db54d2fe2,0xb54d2fe22fe2354d,0x354dafe2afe2b54d,0xb57fad5db4d631e0,0x2d5db57fb1e0b4d6,0x2d5db57fb1e0b4d6,0x357f2d5d34d6b1e0
.quad 0,0,0,0,0,0,0,0,0,0,0,0,0,0,0,0
.quad 0,0,0,0,0,0,0,0,0,0,0,0,0,0,0,0
.quad 0,0,0,0,0,0,0,0,0,0,0,0,0,0,0,0
.quad 0,0,0,0,0,0,0,0,0,0,0,0,0,0,0,0
.quad 0x3400340034003400,0x3400340034003400,0xb4003400b4003400,0xb4003400b4003400,0x358dac5934b23250,0xac59b58d3250b4b2,0x2c59358db25034b2,0x358dac5934b23250,0x3065b53635363065,0xb0653536b536b065,0x35363065b0653536,0xb536b0653065b536,0xb233b4bb358a2c9e,0x34bbb233ac9e358a,0x34bbb233ac9e358a,0x323334bbb58aac9e
.quad 0xb5a89c7135a81c71,0xb5a89c7135a81c71,0x1c71b5a89c7135a8,0x1c71b5a89c7135a8,0xb26e34a83590ac13,0x34a8326eac13b590,0xb4a8b26e2c133590,0xb26e34a83590ac13,0x302335443544b023,0xb023b544b5443023,0xb544302330233544,0x3544b023b023b544,0x35862ce434c5b215,0xace43586321534c5,0xace43586321534c5,0xb586ace4b4c53215
.quad 0x3400340034003400,0x3400340034003400,0xb4003400b4003400,0xb4003400b4003400,0xb58d2c59b4b2b250,0x2c59358db25034b2,0xac59b58d3250b4b2,0xb58d2c59b4b2b250,0x3065b53635363065,0xb0653536b536b065,0x35363065b0653536,0xb536b0653065b536,0x323334bbb58aac9e,0xb4bb32332c9eb58a,0xb4bb32332c9eb58a,0xb233b4bb358a2c9e
.quad 0xb5a89c7135a81c71,0xb5a89c7135a81c71,0x1c71b5a89c7135a8,0x1c71b5a89c7135a8,0x326eb4a8b5902c13,0xb4a8b26e2c133590,0x34a8326eac13b590,0x326eb4a8b5902c13,0x302335443544b023,0xb023b544b5443023,0xb544302330233544,0x3544b023b023b544,0xb586ace4b4c53215,0x2ce4b586b215b4c5,0x2ce4b586b215b4c5,0x35862ce434c5b215
.quad 0,0,0,0,0,0,0,0,0,0,0,0,0,0,0,0
.quad 0,0,0,0,0,0,0,0,0,0,0,0,0,0,0,0
.quad 0,0,0,0,0,0,0,0,0,0,0,0,0,0,0,0
.quad 0,0,0,0,0,0,0,0,0,0,0,0,0,0,0,0
.quad 0x3400340034003400,0x3400340034003400,0xb4003400b4003400,0xb4003400b4003400,0x358cac6a34b43249,0xac6ab58c3249b4b4,0x2c6a358cb24934b4,0x358cac6a34b43249,0x3054b53a353a3054,0xb054353ab53ab054,0x353a3054b054353a,0xb53ab0543054b53a,0xb249b4b4358c2c6a,0x34b4b249ac6a358c,0x34b4b249ac6a358c,0x324934b4b58cac6a
.quad 0xb5a8800035a80000,0xb5a8800035a80000,0xb5a8000035a8,0xb5a8800035a8,0xb24934b4358cac6a,0x34b43249ac6ab58c,0xb4b4b2492c6a358c,0xb24934b4358cac6a,0x3054353a353ab054,0xb054b53ab53a3054,0xb53a30543054353a,0x353ab054b054b53a,0x358c2c6a34b4b249,0xac6a358c324934b4,0xac6a358c324934b4,0xb58cac6ab4b43249
.quad 0x3400340034003400,0x3400340034003400,0xb4003400b4003400,0xb4003400b4003400,0xb58c2c6ab4b4b249,0x2c6a358cb24934b4,0xac6ab58c3249b4b4,0xb58c2c6ab4b4b249,0x3054b53a353a3054,0xb054353ab53ab054,0x353a3054b054353a,0xb53ab0543054b53a,0x324934b4b58cac6a,0xb4b432492c6ab58c,0xb4b432492c6ab58c,0xb249b4b4358c2c6a
.quad 0xb5a8800035a80000,0xb5a8800035a88000,0xb5a8800035a8,0xb5a8800035a8,0x3249b4b4b58c2c6a,0xb4b4b2492c6a358c,0x34b43249ac6ab58c,0x3249b4b4b58c2c6a,0x3054353a353ab054,0xb054b53ab53a3054,0xb53a30543054353a,0x353ab054b054b53a,0xb58cac6ab4b43249,0x2c6ab58cb249b4b4,0x2c6ab58cb249b4b4,0x358c2c6a34b4b249
.quad 0,0,0,0,0,0,0,0,0,0,0,0,0,0,0,0
.quad 0,0,0,0,0,0,0,0,0,0,0,0,0,0,0,0
.quad 0,0,0,0,0,0,0,0,0,0,0,0,0,0,0,0
.quad 0,0,0,0,0,0,0,0,0,0,0,0,0,0,0,0
.quad 0x3400340034003400,0x3400340034003400,0xb4003400b4003400,0xb4003400b4003400,0x358bac7c34b73242,0xac7cb58b3242b4b7,0x2c7c358bb24234b7,0x358bac7c34b73242,0x3044b53d353d3044,0xb044353db53db044,0x353d3044b044353d,0xb53db0443044b53d,0xb25fb4ad358f2c36,0x34adb25fac36358f,0x34adb25fac36358f,0x325f34adb58fac36
.quad 0xb5a81c7135a89c71,0xb5a81c7135a89c71,0x9c71b5a81c7135a8,0x9c71b5a81c7135a8,0xb22434c03588acc1,0x34c03224acc1b588,0xb4c0b2242cc13588,0xb22434c03588acc1,0x3085352f352fb085,0xb085b52fb52f3085,0xb52f30853085352f,0x352fb085b085b52f,0x35922be034a3b27c,0xabe03592327c34a3,0xabe03592327c34a3,0xb592abe0b4a3327c
.quad 0x3400340034003400,0x3400340034003400,0xb4003400b4003400,0xb4003400b4003400,0xb58b2c7cb4b7b242,0x2c7c358bb24234b7,0xac7cb58b3242b4b7,0xb58b2c7cb4b7b242,0x3044b53d353d3044,0xb044353db53db044,0x353d3044b044353d,0xb53db0443044b53d,0x325f34adb58fac36,0xb4ad325f2c36b58f,0xb4ad325f2c36b58f,0xb25fb4ad358f2c36
.quad 0xb5a81c7135a89c71,0xb5a81c7135a89c71,0x9c71b5a81c7135a8,0x9c71b5a81c7135a8,0x3224b4c0b5882cc1,0xb4c0b2242cc13588,0x34c03224acc1b588,0x3224b4c0b5882cc1,0x3085352f352fb085,0xb085b52fb52f3085,0xb52f30853085352f,0x352fb085b085b52f,0xb592abe0b4a3327c,0x2be0b592b27cb4a3,0x2be0b592b27cb4a3,0x35922be034a3b27c
.quad 0,0,0,0,0,0,0,0,0,0,0,0,0,0,0,0
.quad 0,0,0,0,0,0,0,0,0,0,0,0,0,0,0,0
.quad 0,0,0,0,0,0,0,0,0,0,0,0,0,0,0,0
.quad 0,0,0,0,0,0,0,0,0,0,0,0,0,0,0,0
.quad 0x3400340034003400,0x3400340034003400,0xb4003400b4003400,0xb4003400b4003400,0x358bac8d34b9323a,0xac8db58b323ab4b9,0x2c8d358bb23a34b9,0x358bac8d34b9323a,0x3033b54135413033,0xb0333541b541b033,0x35413033b0333541,0xb541b0333033b541,0xb275b4a535912c01,0x34a5b275ac013591,0x34a5b275ac013591,0x327534a5b591ac01
.quad 0xb5a8207135a8a071,0xb5a8207135a8a071,0xa071b5a8207135a8,0xa071b5a8207135a8,0xb1fe34cc3583ad18,0x34cc31fead18b583,0xb4ccb1fe2d183583,0xb1fe34cc3583ad18,0x30b635253525b0b6,0xb0b6b525b52530b6,0xb52530b630b63525,0x3525b0b6b0b6b525,0x35972aea3490b2af,0xaaea359732af3490,0xaaea359732af3490,0xb597aaeab49032af
.quad 0x3400340034003400,0x3400340034003400,0xb4003400b4003400,0xb4003400b4003400,0xb58b2c8db4b9b23a,0x2c8d358bb23a34b9,0xac8db58b323ab4b9,0xb58b2c8db4b9b23a,0x3033b54135413033,0xb0333541b541b033,0x35413033b0333541,0xb541b0333033b541,0x327534a5b591ac01,0xb4a532752c01b591,0xb4a532752c01b591,0xb275b4a535912c01
.quad 0xb5a8207135a8a071,0xb5a8207135a8a071,0xa071b5a8207135a8,0xa071b5a8207135a8,0x31feb4ccb5832d18,0xb4ccb1fe2d183583,0x34cc31fead18b583,0x31feb4ccb5832d18,0x30b635253525b0b6,0xb0b6b525b52530b6,0xb52530b630b63525,0x3525b0b6b0b6b525,0xb597aaeab49032af,0x2aeab597b2afb490,0x2aeab597b2afb490,0x35972aea3490b2af
.quad 0,0,0,0,0,0,0,0,0,0,0,0,0,0,0,0
.quad 0,0,0,0,0,0,0,0,0,0,0,0,0,0,0,0
.quad 0,0,0,0,0,0,0,0,0,0,0,0,0,0,0,0
.quad 0,0,0,0,0,0,0,0,0,0,0,0,0,0,0,0
.quad 0x3400340034003400,0x3400340034003400,0xb4003400b4003400,0xb4003400b4003400,0x358aac9e34bb3233,0xac9eb58a3233b4bb,0x2c9e358ab23334bb,0x358aac9e34bb3233,0x3023b54435443023,0xb0233544b544b023,0x35443023b0233544,0xb544b0233023b544,0xb28bb49d35942b9a,0x349db28bab9a3594,0x349db28bab9a3594,0x328b349db594ab9a
.quad 0xb5a722aa35a7a2aa,0xb5a722aa35a7a2aa,0xa2aab5a722aa35a7,0xa2aab5a722aa35a7,0xb1d934d8357ead6e,0x34d831d9ad6eb57e,0xb4d8b1d92d6e357e,0xb1d934d8357ead6e,0x30e635193519b0e6,0xb0e6b519b51930e6,0xb51930e630e63519,0x3519b0e6b0e6b519,0x359c29f4347eb2e1,0xa9f4359c32e1347e,0xa9f4359c32e1347e,0xb59ca9f4b47e32e1
.quad 0x3400340034003400,0x3400340034003400,0xb4003400b4003400,0xb4003400b4003400,0xb58a2c9eb4bbb233,0x2c9e358ab23334bb,0xac9eb58a3233b4bb,0xb58a2c9eb4bbb233,0x3023b54435443023,0xb0233544b544b023,0x35443023b0233544,0xb544b0233023b544,0x328b349db594ab9a,0xb49d328b2b9ab594,0xb49d328b2b9ab594,0xb28bb49d35942b9a
.quad 0xb5a722aa35a7a2aa,0xb5a722aa35a7a2aa,0xa2aab5a722aa35a7,0xa2aab5a722aa35a7,0x31d9b4d8b57e2d6e,0xb4d8b1d92d6e357e,0x34d831d9ad6eb57e,0x31d9b4d8b57e2d6e,0x30e635193519b0e6,0xb0e6b519b51930e6,0xb51930e630e63519,0x3519b0e6b0e6b519,0xb59ca9f4b47e32e1,0x29f4b59cb2e1b47e,0x29f4b59cb2e1b47e,0x359c29f4347eb2e1
.quad 0,0,0,0,0,0,0,0,0,0,0,0,0,0,0,0
.quad 0,0,0,0,0,0,0,0,0,0,0,0,0,0,0,0
.quad 0,0,0,0,0,0,0,0,0,0,0,0,0,0,0,0
.quad 0,0,0,0,0,0,0,0,0,0,0,0,0,0,0,0
.quad 0x3400340034003400,0x3400340034003400,0xb4003400b4003400,0xb4003400b4003400,0x3589acb034be322b,0xacb0b589322bb4be,0x2cb03589b22b34be,0x3589acb034be322b,0x3012b54735473012,0xb0123547b547b012,0x35473012b0123547,0xb547b0123012b547,0xb2a1b49635962b30,0x3496b2a1ab303596,0x3496b2a1ab303596,0x32a13496b596ab30
.quad 0xb5a6247135a6a471,0xb5a6247135a6a471,0xa471b5a6247135a6,0xa471b5a6247135a6,0xb1b234e33578adc4,0x34e331b2adc4b578,0xb4e3b1b22dc43578,0xb1b234e33578adc4,0x3116350e350eb116,0xb116b50eb50e3116,0xb50e31163116350e,0x350eb116b116b50e,0x359f28fd346bb312,0xa8fd359f3312346b,0xa8fd359f3312346b,0xb59fa8fdb46b3312
.quad 0x3400340034003400,0x3400340034003400,0xb4003400b4003400,0xb4003400b4003400,0xb5892cb0b4beb22b,0x2cb03589b22b34be,0xacb0b589322bb4be,0xb5892cb0b4beb22b,0x3012b54735473012,0xb0123547b547b012,0x35473012b0123547,0xb547b0123012b547,0x32a13496b596ab30,0xb49632a12b30b596,0xb49632a12b30b596,0xb2a1b49635962b30
.quad 0xb5a6247135a6a471,0xb5a6247135a6a471,0xa471b5a6247135a6,0xa471b5a6247135a6,0x31b2b4e3b5782dc4,0xb4e3b1b22dc43578,0x34e331b2adc4b578,0x31b2b4e3b5782dc4,0x3116350e350eb116,0xb116b50eb50e3116,0xb50e31163116350e,0x350eb116b116b50e,0xb59fa8fdb46b3312,0x28fdb59fb312b46b,0x28fdb59fb312b46b,0x359f28fd346bb312
.quad 0,0,0,0,0,0,0,0,0,0,0,0,0,0,0,0
.quad 0,0,0,0,0,0,0,0,0,0,0,0,0,0,0,0
.quad 0,0,0,0,0,0,0,0,0,0,0,0,0,0,0,0
.quad 0,0,0,0,0,0,0,0,0,0,0,0,0,0,0,0
.quad 0x3400340034003400,0x3400340034003400,0xb4003400b4003400,0xb4003400b4003400,0x3588acc134c03224,0xacc1b5883224b4c0,0x2cc13588b22434c0,0x3588acc134c03224,0x3002b54a354a3002,0xb002354ab54ab002,0x354a3002b002354a,0xb54ab0023002b54a,0xb2b6b48e35982ac7,0x348eb2b6aac73598,0x348eb2b6aac73598,0x32b6348eb598aac7
.quad 0xb5a5258d35a5a58d,0xb5a5258d35a5a58d,0xa58db5a5258d35a5,0xa58db5a5258d35a5,0xb18c34ee3573ae1a,0x34ee318cae1ab573,0xb4eeb18c2e1a3573,0xb18c34ee3573ae1a,0x314635013501b146,0xb146b501b5013146,0xb501314631463501,0x3501b146b146b501,0x35a228053457b342,0xa80535a233423457,0xa80535a233423457,0xb5a2a805b4573342
.quad 0x3400340034003400,0x3400340034003400,0xb4003400b4003400,0xb4003400b4003400,0xb5882cc1b4c0b224,0x2cc13588b22434c0,0xacc1b5883224b4c0,0xb5882cc1b4c0b224,0x3002b54a354a3002,0xb002354ab54ab002,0x354a3002b002354a,0xb54ab0023002b54a,0x32b6348eb598aac7,0xb48e32b62ac7b598,0xb48e32b62ac7b598,0xb2b6b48e35982ac7
.quad 0xb5a5258d35a5a58d,0xb5a5258d35a5a58d,0xa58db5a5258d35a5,0xa58db5a5258d35a5,0x318cb4eeb5732e1a,0xb4eeb18c2e1a3573,0x34ee318cae1ab573,0x318cb4eeb5732e1a,0x314635013501b146,0xb146b501b5013146,0xb501314631463501,0x3501b146b146b501,0xb5a2a805b4573342,0x2805b5a2b342b457,0x2805b5a2b342b457,0x35a228053457b342
.quad 0,0,0,0,0,0,0,0,0,0,0,0,0,0,0,0
.quad 0,0,0,0,0,0,0,0,0,0,0,0,0,0,0,0
.quad 0,0,0,0,0,0,0,0,0,0,0,0,0,0,0,0
.quad 0,0,0,0,0,0,0,0,0,0,0,0,0,0,0,0
.quad 0x3400340034003400,0x3400340034003400,0xb4003400b4003400,0xb4003400b4003400,0x3587acd234c3321d,0xacd2b587321db4c3,0x2cd23587b21d34c3,0x3587acd234c3321d,0x2fe2b54d354d2fe2,0xafe2354db54dafe2,0x354d2fe2afe2354d,0xb54dafe22fe2b54d,0xb2ccb486359a2a5e,0x3486b2ccaa5e359a,0x3486b2ccaa5e359a,0x32cc3486b59aaa5e
.quad 0xb5a426a935a4a6a9,0xb5a426a935a4a6a9,0xa6a9b5a426a935a4,0xa6a9b5a426a935a4,0xb16534f9356cae6f,0x34f93165ae6fb56c,0xb4f9b1652e6f356c,0xb16534f9356cae6f,0x317534f534f5b175,0xb175b4f5b4f53175,0xb4f53175317534f5,0x34f5b175b175b4f5,0x35a5261b3443b371,0xa61b35a533713443,0xa61b35a533713443,0xb5a5a61bb4433371
.quad 0x3400340034003400,0x3400340034003400,0xb4003400b4003400,0xb4003400b4003400,0xb5872cd2b4c3b21d,0x2cd23587b21d34c3,0xacd2b587321db4c3,0xb5872cd2b4c3b21d,0x2fe2b54d354d2fe2,0xafe2354db54dafe2,0x354d2fe2afe2354d,0xb54dafe22fe2b54d,0x32cc3486b59aaa5e,0xb48632cc2a5eb59a,0xb48632cc2a5eb59a,0xb2ccb486359a2a5e
.quad 0xb5a426a935a4a6a9,0xb5a426a935a4a6a9,0xa6a9b5a426a935a4,0xa6a9b5a426a935a4,0x3165b4f9b56c2e6f,0xb4f9b1652e6f356c,0x34f93165ae6fb56c,0x3165b4f9b56c2e6f,0x317534f534f5b175,0xb175b4f5b4f53175,0xb4f53175317534f5,0x34f5b175b175b4f5,0xb5a5a61bb4433371,0x261bb5a5b371b443,0x261bb5a5b371b443,0x35a5261b3443b371
.quad 0,0,0,0,0,0,0,0,0,0,0,0,0,0,0,0
.quad 0,0,0,0,0,0,0,0,0,0,0,0,0,0,0,0
.quad 0,0,0,0,0,0,0,0,0,0,0,0,0,0,0,0
.quad 0,0,0,0,0,0,0,0,0,0,0,0,0,0,0,0
.quad 0x3400340034003400,0x3400340034003400,0xb4003400b4003400,0xb4003400b4003400,0x3586ace434c53215,0xace4b5863215b4c5,0x2ce43586b21534c5,0x3586ace434c53215,0x2fc1b55035502fc1,0xafc13550b550afc1,0x35502fc1afc13550,0xb550afc12fc1b550,0xb2e1b47e359c29f4,0x347eb2e1a9f4359c,0x347eb2e1a9f4359c,0x32e1347eb59ca9f4
.quad 0xb5a327c435a3a7c4,0xb5a327c435a3a7c4,0xa7c4b5a327c435a3,0xa7c4b5a327c435a3,0xb13e35033566aec4,0x3503313eaec4b566,0xb503b13e2ec43566,0xb13e35033566aec4,0x31a334e834e8b1a3,0xb1a3b4e8b4e831a3,0xb4e831a331a334e8,0x34e8b1a3b1a3b4e8,0x35a7242a342eb3a0,0xa42a35a733a0342e,0xa42a35a733a0342e,0xb5a7a42ab42e33a0
.quad 0x3400340034003400,0x3400340034003400,0xb4003400b4003400,0xb4003400b4003400,0xb5862ce4b4c5b215,0x2ce43586b21534c5,0xace4b5863215b4c5,0xb5862ce4b4c5b215,0x2fc1b55035502fc1,0xafc13550b550afc1,0x35502fc1afc13550,0xb550afc12fc1b550,0x32e1347eb59ca9f4,0xb47e32e129f4b59c,0xb47e32e129f4b59c,0xb2e1b47e359c29f4
.quad 0xb5a327c435a3a7c4,0xb5a327c435a3a7c4,0xa7c4b5a327c435a3,0xa7c4b5a327c435a3,0x313eb503b5662ec4,0xb503b13e2ec43566,0x3503313eaec4b566,0x313eb503b5662ec4,0x31a334e834e8b1a3,0xb1a3b4e8b4e831a3,0xb4e831a331a334e8,0x34e8b1a3b1a3b4e8,0xb5a7a42ab42e33a0,0x242ab5a7b3a0b42e,0x242ab5a7b3a0b42e,0x35a7242a342eb3a0
.quad 0,0,0,0,0,0,0,0,0,0,0,0,0,0,0,0
.quad 0,0,0,0,0,0,0,0,0,0,0,0,0,0,0,0
.quad 0,0,0,0,0,0,0,0,0,0,0,0,0,0,0,0
.quad 0,0,0,0,0,0,0,0,0,0,0,0,0,0,0,0
.quad 0x3400340034003400,0x3400340034003400,0xb4003400b4003400,0xb4003400b4003400,0x3585acf534c7320e,0xacf5b585320eb4c7,0x2cf53585b20e34c7,0x3585acf534c7320e,0x2f9fb55435542f9f,0xaf9f3554b554af9f,0x35542f9faf9f3554,0xb554af9f2f9fb554,0xb2f6b476359d298a,0x3476b2f6a98a359d,0x3476b2f6a98a359d,0x32f63476b59da98a
.quad 0xb5a1287035a1a870,0xb5a1287035a1a870,0xa870b5a1287035a1,0xa870b5a1287035a1,0xb116350e355faf19,0x350e3116af19b55f,0xb50eb1162f19355f,0xb116350e355faf19,0x31d134da34dab1d1,0xb1d1b4dab4da31d1,0xb4da31d131d134da,0x34dab1d1b1d1b4da,0x35a820713419b3cd,0xa07135a833cd3419,0xa07135a833cd3419,0xb5a8a071b41933cd
.quad 0x3400340034003400,0x3400340034003400,0xb4003400b4003400,0xb4003400b4003400,0xb5852cf5b4c7b20e,0x2cf53585b20e34c7,0xacf5b585320eb4c7,0xb5852cf5b4c7b20e,0x2f9fb55435542f9f,0xaf9f3554b554af9f,0x35542f9faf9f3554,0xb554af9f2f9fb554,0x32f63476b59da98a,0xb47632f6298ab59d,0xb47632f6298ab59d,0xb2f6b476359d298a
.quad 0xb5a1287035a1a870,0xb5a1287035a1a870,0xa870b5a1287035a1,0xa870b5a1287035a1,0x3116b50eb55f2f19,0xb50eb1162f19355f,0x350e3116af19b55f,0x3116b50eb55f2f19,0x31d134da34dab1d1,0xb1d1b4dab4da31d1,0xb4da31d131d134da,0x34dab1d1b1d1b4da,0xb5a8a071b41933cd,0x2071b5a8b3cdb419,0x2071b5a8b3cdb419,0x35a820713419b3cd
.quad 0,0,0,0,0,0,0,0,0,0,0,0,0,0,0,0
.quad 0,0,0,0,0,0,0,0,0,0,0,0,0,0,0,0
.quad 0,0,0,0,0,0,0,0,0,0,0,0,0,0,0,0
.quad 0,0,0,0,0,0,0,0,0,0,0,0,0,0,0,0
.quad 0x3400340034003400,0x3400340034003400,0xb4003400b4003400,0xb4003400b4003400,0x3584ad0734ca3206,0xad07b5843206b4ca,0x2d073584b20634ca,0x3584ad0734ca3206,0x2f7eb55635562f7e,0xaf7e3556b556af7e,0x35562f7eaf7e3556,0xb556af7e2f7eb556,0xb30bb46d359f2920,0x346db30ba920359f,0x346db30ba920359f,0x330b346db59fa920
.quad 0xb59f28fd359fa8fd,0xb59f28fd359fa8fd,0xa8fdb59f28fd359f,0xa8fdb59f28fd359f,0xb0ee35173558af6d,0x351730eeaf6db558,0xb517b0ee2f6d3558,0xb0ee35173558af6d,0x31fe34cc34ccb1fe,0xb1feb4ccb4cc31fe,0xb4cc31fe31fe34cc,0x34ccb1feb1feb4cc,0x35a814713403b3fa,0x947135a833fa3403,0x947135a833fa3403,0xb5a89471b40333fa
.quad 0x3400340034003400,0x3400340034003400,0xb4003400b4003400,0xb4003400b4003400,0xb5842d07b4cab206,0x2d073584b20634ca,0xad07b5843206b4ca,0xb5842d07b4cab206,0x2f7eb55635562f7e,0xaf7e3556b556af7e,0x35562f7eaf7e3556,0xb556af7e2f7eb556,0x330b346db59fa920,0xb46d330b2920b59f,0xb46d330b2920b59f,0xb30bb46d359f2920
.quad 0xb59f28fd359fa8fd,0xb59f28fd359fa8fd,0xa8fdb59f28fd359f,0xa8fdb59f28fd359f,0x30eeb517b5582f6d,0xb517b0ee2f6d3558,0x351730eeaf6db558,0x30eeb517b5582f6d,0x31fe34cc34ccb1fe,0xb1feb4ccb4cc31fe,0xb4cc31fe31fe34cc,0x34ccb1feb1feb4cc,0xb5a89471b40333fa,0x1471b5a8b3fab403,0x1471b5a8b3fab403,0x35a814713403b3fa
.quad 0,0,0,0,0,0,0,0,0,0,0,0,0,0,0,0
.quad 0,0,0,0,0,0,0,0,0,0,0,0,0,0,0,0
.quad 0,0,0,0,0,0,0,0,0,0,0,0,0,0,0,0
.quad 0,0,0,0,0,0,0,0,0,0,0,0,0,0,0,0
.quad 0x3400340034003400,0x3400340034003400,0xb4003400b4003400,0xb4003400b4003400,0x3583ad1834cc31fe,0xad18b58331feb4cc,0x2d183583b1fe34cc,0x3583ad1834cc31fe,0x2f5cb55935592f5c,0xaf5c3559b559af5c,0x35592f5caf5c3559,0xb559af5c2f5cb559,0xb320b46535a028b6,0x3465b320a8b635a0,0x3465b320a8b635a0,0x33203465b5a0a8b6
.quad 0xb59d298a359da98a,0xb59d298a359da98a,0xa98ab59d298a359d,0xa98ab59d298a359d,0xb0c635213550afc1,0x352130c6afc1b550,0xb521b0c62fc13550,0xb0c635213550afc1,0x322b34be34beb22b,0xb22bb4beb4be322b,0xb4be322b322b34be,0x34beb22bb22bb4be,0x35a89eaa33dab413,0x1eaa35a8341333da,0x1eaa35a8341333da,0xb5a81eaab3da3413
.quad 0x3400340034003400,0x3400340034003400,0xb4003400b4003400,0xb4003400b4003400,0xb5832d18b4ccb1fe,0x2d183583b1fe34cc,0xad18b58331feb4cc,0xb5832d18b4ccb1fe,0x2f5cb55935592f5c,0xaf5c3559b559af5c,0x35592f5caf5c3559,0xb559af5c2f5cb559,0x33203465b5a0a8b6,0xb465332028b6b5a0,0xb465332028b6b5a0,0xb320b46535a028b6
.quad 0xb59d298a359da98a,0xb59d298a359da98a,0xa98ab59d298a359d,0xa98ab59d298a359d,0x30c6b521b5502fc1,0xb521b0c62fc13550,0x352130c6afc1b550,0x30c6b521b5502fc1,0x322b34be34beb22b,0xb22bb4beb4be322b,0xb4be322b322b34be,0x34beb22bb22bb4be,0xb5a81eaab3da3413,0x9eaab5a8b413b3da,0x9eaab5a8b413b3da,0x35a89eaa33dab413
.quad 0,0,0,0,0,0,0,0,0,0,0,0,0,0,0,0
.quad 0,0,0,0,0,0,0,0,0,0,0,0,0,0,0,0
.quad 0,0,0,0,0,0,0,0,0,0,0,0,0,0,0,0
.quad 0,0,0,0,0,0,0,0,0,0,0,0,0,0,0,0
.quad 0x3400340034003400,0x3400340034003400,0xb4003400b4003400,0xb4003400b4003400,0x3582ad2934cf31f7,0xad29b58231f7b4cf,0x2d293582b1f734cf,0x3582ad2934cf31f7,0x2f3bb55c355c2f3b,0xaf3b355cb55caf3b,0x355c2f3baf3b355c,0xb55caf3b2f3bb55c,0xb334b45d35a2284c,0x345db334a84c35a2,0x345db334a84c35a2,0x3334345db5a2a84c
.quad 0xb59b2a17359baa17,0xb59b2a17359baa17,0xaa17b59b2a17359b,0xaa17b59b2a17359b,0xb09e352a3549b00a,0x352a309eb00ab549,0xb52ab09e300a3549,0xb09e352a3549b00a,0x325834af34afb258,0xb258b4afb4af3258,0xb4af3258325834af,0x34afb258b258b4af,0x35a7a33833adb428,0x233835a7342833ad,0x233835a7342833ad,0xb5a72338b3ad3428
.quad 0x3400340034003400,0x3400340034003400,0xb4003400b4003400,0xb4003400b4003400,0xb5822d29b4cfb1f7,0x2d293582b1f734cf,0xad29b58231f7b4cf,0xb5822d29b4cfb1f7,0x2f3bb55c355c2f3b,0xaf3b355cb55caf3b,0x355c2f3baf3b355c,0xb55caf3b2f3bb55c,0x3334345db5a2a84c,0xb45d3334284cb5a2,0xb45d3334284cb5a2,0xb334b45d35a2284c
.quad 0xb59b2a17359baa17,0xb59b2a17359baa17,0xaa17b59b2a17359b,0xaa17b59b2a17359b,0x309eb52ab549300a,0xb52ab09e300a3549,0x352a309eb00ab549,0x309eb52ab549300a,0x325834af34afb258,0xb258b4afb4af3258,0xb4af3258325834af,0x34afb258b258b4af,0xb5a72338b3ad3428,0xa338b5a7b428b3ad,0xa338b5a7b428b3ad,0x35a7a33833adb428
.quad 0,0,0,0,0,0,0,0,0,0,0,0,0,0,0,0
.quad 0,0,0,0,0,0,0,0,0,0,0,0,0,0,0,0
.quad 0,0,0,0,0,0,0,0,0,0,0,0,0,0,0,0
.quad 0,0,0,0,0,0,0,0,0,0,0,0,0,0,0,0
.quad 0x3400340034003400,0x3400340034003400,0xb4003400b4003400,0xb4003400b4003400,0x3581ad3a34d131ef,0xad3ab58131efb4d1,0x2d3a3581b1ef34d1,0x3581ad3a34d131ef,0x2f19b55f355f2f19,0xaf19355fb55faf19,0x355f2f19af19355f,0xb55faf192f19b55f,0xb349b45435a327c4,0x3454b349a7c435a3,0x3454b349a7c435a3,0x33493454b5a3a7c4
.quad 0xb5982aa43598aaa4,0xb5982aa43598aaa4,0xaaa4b5982aa43598,0xaaa4b5982aa43598,0xb07535333541b033,0x35333075b033b541,0xb533b07530333541,0xb07535333541b033,0x328434a034a0b284,0xb284b4a0b4a03284,0xb4a03284328434a0,0x34a0b284b284b4a0,0x35a5a58d337fb43d,0x258d35a5343d337f,0x258d35a5343d337f,0xb5a5258db37f343d
.quad 0x3400340034003400,0x3400340034003400,0xb4003400b4003400,0xb4003400b4003400,0xb5812d3ab4d1b1ef,0x2d3a3581b1ef34d1,0xad3ab58131efb4d1,0xb5812d3ab4d1b1ef,0x2f19b55f355f2f19,0xaf19355fb55faf19,0x355f2f19af19355f,0xb55faf192f19b55f,0x33493454b5a3a7c4,0xb454334927c4b5a3,0xb454334927c4b5a3,0xb349b45435a327c4
.quad 0xb5982aa43598aaa4,0xb5982aa43598aaa4,0xaaa4b5982aa43598,0xaaa4b5982aa43598,0x3075b533b5413033,0xb533b07530333541,0x35333075b033b541,0x3075b533b5413033,0x328434a034a0b284,0xb284b4a0b4a03284,0xb4a03284328434a0,0x34a0b284b284b4a0,0xb5a5258db37f343d,0xa58db5a5b43db37f,0xa58db5a5b43db37f,0x35a5a58d337fb43d
.quad 0,0,0,0,0,0,0,0,0,0,0,0,0,0,0,0
.quad 0,0,0,0,0,0,0,0,0,0,0,0,0,0,0,0
.quad 0,0,0,0,0,0,0,0,0,0,0,0,0,0,0,0
.quad 0,0,0,0,0,0,0,0,0,0,0,0,0,0,0,0
.quad 0x3400340034003400,0x3400340034003400,0xb4003400b4003400,0xb4003400b4003400,0x3580ad4c34d331e8,0xad4cb58031e8b4d3,0x2d4c3580b1e834d3,0x3580ad4c34d331e8,0x2ef7b56235622ef7,0xaef73562b562aef7,0x35622ef7aef73562,0xb562aef72ef7b562,0xb35db44b35a426ef,0x344bb35da6ef35a4,0x344bb35da6ef35a4,0x335d344bb5a4a6ef
.quad 0xb5962b303596ab30,0xb5962b303596ab30,0xab30b5962b303596,0xab30b5962b303596,0xb04c353c3538b05d,0x353c304cb05db538,0xb53cb04c305d3538,0xb04c353c3538b05d,0x32af34903490b2af,0xb2afb490b49032af,0xb49032af32af3490,0x3490b2afb2afb490,0x35a3a77d3350b451,0x277d35a334513350,0x277d35a334513350,0xb5a3277db3503451
.quad 0x3400340034003400,0x3400340034003400,0xb4003400b4003400,0xb4003400b4003400,0xb5802d4cb4d3b1e8,0x2d4c3580b1e834d3,0xad4cb58031e8b4d3,0xb5802d4cb4d3b1e8,0x2ef7b56235622ef7,0xaef73562b562aef7,0x35622ef7aef73562,0xb562aef72ef7b562,0x335d344bb5a4a6ef,0xb44b335d26efb5a4,0xb44b335d26efb5a4,0xb35db44b35a426ef
.quad 0xb5962b303596ab30,0xb5962b303596ab30,0xab30b5962b303596,0xab30b5962b303596,0x304cb53cb538305d,0xb53cb04c305d3538,0x353c304cb05db538,0x304cb53cb538305d,0x32af34903490b2af,0xb2afb490b49032af,0xb49032af32af3490,0x3490b2afb2afb490,0xb5a3277db3503451,0xa77db5a3b451b350,0xa77db5a3b451b350,0x35a3a77d3350b451
.quad 0,0,0,0,0,0,0,0,0,0,0,0,0,0,0,0
.quad 0,0,0,0,0,0,0,0,0,0,0,0,0,0,0,0
.quad 0,0,0,0,0,0,0,0,0,0,0,0,0,0,0,0
.quad 0,0,0,0,0,0,0,0,0,0,0,0,0,0,0,0
.quad 0x3400340034003400,0x3400340034003400,0xb4003400b4003400,0xb4003400b4003400,0x357fad5d34d631e0,0xad5db57f31e0b4d6,0x2d5d357fb1e034d6,0x357fad5d34d631e0,0x2ed5b56535652ed5,0xaed53565b565aed5,0x35652ed5aed53565,0xb565aed52ed5b565,0xb371b44335a5261b,0x3443b371a61b35a5,0x3443b371a61b35a5,0x33713443b5a5a61b
.quad 0xb5932bbd3593abbd,0xb5932bbd3593abbd,0xabbdb5932bbd3593,0xabbdb5932bbd3593,0xb0233544352fb085,0x35443023b085b52f,0xb544b0233085352f,0xb0233544352fb085,0x32da34803480b2da,0xb2dab480b48032da,0xb48032da32da3480,0x3480b2dab2dab480,0x35a0a8b63320b465,0x28b635a034653320,0x28b635a034653320,0xb5a028b6b3203465
.quad 0x3400340034003400,0x3400340034003400,0xb4003400b4003400,0xb4003400b4003400,0xb57f2d5db4d6b1e0,0x2d5d357fb1e034d6,0xad5db57f31e0b4d6,0xb57f2d5db4d6b1e0,0x2ed5b56535652ed5,0xaed53565b565aed5,0x35652ed5aed53565,0xb565aed52ed5b565,0x33713443b5a5a61b,0xb4433371261bb5a5,0xb4433371261bb5a5,0xb371b44335a5261b
.quad 0xb5932bbd3593abbd,0xb5932bbd3593abbd,0xabbdb5932bbd3593,0xabbdb5932bbd3593,0x3023b544b52f3085,0xb544b0233085352f,0x35443023b085b52f,0x3023b544b52f3085,0x32da34803480b2da,0xb2dab480b48032da,0xb48032da32da3480,0x3480b2dab2dab480,0xb5a028b6b3203465,0xa8b6b5a0b465b320,0xa8b6b5a0b465b320,0x35a0a8b63320b465
.quad 0,0,0,0,0,0,0,0,0,0,0,0,0,0,0,0
.quad 0,0,0,0,0,0,0,0,0,0,0,0,0,0,0,0
.quad 0,0,0,0,0,0,0,0,0,0,0,0,0,0,0,0
.quad 0,0,0,0,0,0,0,0,0,0,0,0,0,0,0,0
.quad 0x3400340034003400,0x3400340034003400,0xb4003400b4003400,0xb4003400b4003400,0x357ead6e34d831d9,0xad6eb57e31d9b4d8,0x2d6e357eb1d934d8,0x357ead6e34d831d9,0x2eb3b56735672eb3,0xaeb33567b567aeb3,0x35672eb3aeb33567,0xb567aeb32eb3b567,0xb385b43a35a62546,0x343ab385a54635a6,0x343ab385a54635a6,0x3385343ab5a6a546
.quad 0xb5902c243590ac24,0xb5902c243590ac24,0xac24b5902c243590,0xac24b5902c243590,0xaff3354c3526b0ae,0x354c2ff3b0aeb526,0xb54caff330ae3526,0xaff3354c3526b0ae,0x330434703470b304,0xb304b470b4703304,0xb470330433043470,0x3470b304b304b470,0x359da9ad32efb478,0x29ad359d347832ef,0x29ad359d347832ef,0xb59d29adb2ef3478
.quad 0x3400340034003400,0x3400340034003400,0xb4003400b4003400,0xb4003400b4003400,0xb57e2d6eb4d8b1d9,0x2d6e357eb1d934d8,0xad6eb57e31d9b4d8,0xb57e2d6eb4d8b1d9,0x2eb3b56735672eb3,0xaeb33567b567aeb3,0x35672eb3aeb33567,0xb567aeb32eb3b567,0x3385343ab5a6a546,0xb43a33852546b5a6,0xb43a33852546b5a6,0xb385b43a35a62546
.quad 0xb5902c243590ac24,0xb5902c243590ac24,0xac24b5902c243590,0xac24b5902c243590,0x2ff3b54cb52630ae,0xb54caff330ae3526,0x354c2ff3b0aeb526,0x2ff3b54cb52630ae,0x330434703470b304,0xb304b470b4703304,0xb470330433043470,0x3470b304b304b470,0xb59d29adb2ef3478,0xa9adb59db478b2ef,0xa9adb59db478b2ef,0x359da9ad32efb478
.quad 0,0,0,0,0,0,0,0,0,0,0,0,0,0,0,0
.quad 0,0,0,0,0,0,0,0,0,0,0,0,0,0,0,0
.quad 0,0,0,0,0,0,0,0,0,0,0,0,0,0,0,0
.quad 0,0,0,0,0,0,0,0,0,0,0,0,0,0,0,0
.quad 0x3400340034003400,0x3400340034003400,0xb4003400b4003400,0xb4003400b4003400,0x357dad7f34da31d1,0xad7fb57d31d1b4da,0x2d7f357db1d134da,0x357dad7f34da31d1,0x2e92b56a356a2e92,0xae92356ab56aae92,0x356a2e92ae92356a,0xb56aae922e92b56a,0xb399b43135a62471,0x3431b399a47135a6,0x3431b399a47135a6,0x33993431b5a6a471
.quad 0xb58c2c6a358cac6a,0xb58c2c6a358cac6a,0xac6ab58c2c6a358c,0xac6ab58c2c6a358c,0xaf9f3554351db0d6,0x35542f9fb0d6b51d,0xb554af9f30d6351d,0xaf9f3554351db0d6,0x332d345f345fb32d,0xb32db45fb45f332d,0xb45f332d332d345f,0x345fb32db32db45f,0x3598aaa432bdb48b,0x2aa43598348b32bd,0x2aa43598348b32bd,0xb5982aa4b2bd348b
.quad 0x3400340034003400,0x3400340034003400,0xb4003400b4003400,0xb4003400b4003400,0xb57d2d7fb4dab1d1,0x2d7f357db1d134da,0xad7fb57d31d1b4da,0xb57d2d7fb4dab1d1,0x2e92b56a356a2e92,0xae92356ab56aae92,0x356a2e92ae92356a,0xb56aae922e92b56a,0x33993431b5a6a471,0xb43133992471b5a6,0xb43133992471b5a6,0xb399b43135a62471
.quad 0xb58c2c6a358cac6a,0xb58c2c6a358cac6a,0xac6ab58c2c6a358c,0xac6ab58c2c6a358c,0x2f9fb554b51d30d6,0xb554af9f30d6351d,0x35542f9fb0d6b51d,0x2f9fb554b51d30d6,0x332d345f345fb32d,0xb32db45fb45f332d,0xb45f332d332d345f,0x345fb32db32db45f,0xb5982aa4b2bd348b,0xaaa4b598b48bb2bd,0xaaa4b598b48bb2bd,0x3598aaa432bdb48b
.quad 0,0,0,0,0,0,0,0,0,0,0,0,0,0,0,0
.quad 0,0,0,0,0,0,0,0,0,0,0,0,0,0,0,0
.quad 0,0,0,0,0,0,0,0,0,0,0,0,0,0,0,0
.quad 0,0,0,0,0,0,0,0,0,0,0,0,0,0,0,0
.quad 0x3400340034003400,0x3400340034003400,0xb4003400b4003400,0xb4003400b4003400,0x357cad9134dc31c9,0xad91b57c31c9b4dc,0x2d91357cb1c934dc,0x357cad9134dc31c9,0x2e6fb56c356c2e6f,0xae6f356cb56cae6f,0x356c2e6fae6f356c,0xb56cae6f2e6fb56c,0xb3adb42835a72338,0x3428b3ada33835a7,0x3428b3ada33835a7,0x33ad3428b5a7a338
.quad 0xb5892cb03589acb0,0xb5892cb03589acb0,0xacb0b5892cb03589,0xacb0b5892cb03589,0xaf4c355b3513b0fe,0x355b2f4cb0feb513,0xb55baf4c30fe3513,0xaf4c355b3513b0fe,0x3356344e344eb356,0xb356b44eb44e3356,0xb44e33563356344e,0x344eb356b356b44e,0x3594ab9a328bb49d,0x2b9a3594349d328b,0x2b9a3594349d328b,0xb5942b9ab28b349d
.quad 0x3400340034003400,0x3400340034003400,0xb4003400b4003400,0xb4003400b4003400,0xb57c2d91b4dcb1c9,0x2d91357cb1c934dc,0xad91b57c31c9b4dc,0xb57c2d91b4dcb1c9,0x2e6fb56c356c2e6f,0xae6f356cb56cae6f,0x356c2e6fae6f356c,0xb56cae6f2e6fb56c,0x33ad3428b5a7a338,0xb42833ad2338b5a7,0xb42833ad2338b5a7,0xb3adb42835a72338
.quad 0xb5892cb03589acb0,0xb5892cb03589acb0,0xacb0b5892cb03589,0xacb0b5892cb03589,0x2f4cb55bb51330fe,0xb55baf4c30fe3513,0x355b2f4cb0feb513,0x2f4cb55bb51330fe,0x3356344e344eb356,0xb356b44eb44e3356,0xb44e33563356344e,0x344eb356b356b44e,0xb5942b9ab28b349d,0xab9ab594b49db28b,0xab9ab594b49db28b,0x3594ab9a328bb49d
.quad 0,0,0,0,0,0,0,0,0,0,0,0,0,0,0,0
.quad 0,0,0,0,0,0,0,0,0,0,0,0,0,0,0,0
.quad 0,0,0,0,0,0,0,0,0,0,0,0,0,0,0,0
.quad 0,0,0,0,0,0,0,0,0,0,0,0,0,0,0,0
.quad 0x3400340034003400,0x3400340034003400,0xb4003400b4003400,0xb4003400b4003400,0x357bada234df31c2,0xada2b57b31c2b4df,0x2da2357bb1c234df,0x357bada234df31c2,0x2e4db56f356f2e4d,0xae4d356fb56fae4d,0x356f2e4dae4d356f,0xb56fae4d2e4db56f,0xb3c0b41f35a7218d,0x341fb3c0a18d35a7,0x341fb3c0a18d35a7,0x33c0341fb5a7a18d
.quad 0xb5852cf53585acf5,0xb5852cf53585acf5,0xacf5b5852cf53585,0xacf5b5852cf53585,0xaef73562350ab126,0x35622ef7b126b50a,0xb562aef73126350a,0xaef73562350ab126,0x337f343d343db37f,0xb37fb43db43d337f,0xb43d337f337f343d,0x343db37fb37fb43d,0x358eac473258b4af,0x2c47358e34af3258,0x2c47358e34af3258,0xb58e2c47b25834af
.quad 0x3400340034003400,0x3400340034003400,0xb4003400b4003400,0xb4003400b4003400,0xb57b2da2b4dfb1c2,0x2da2357bb1c234df,0xada2b57b31c2b4df,0xb57b2da2b4dfb1c2,0x2e4db56f356f2e4d,0xae4d356fb56fae4d,0x356f2e4dae4d356f,0xb56fae4d2e4db56f,0x33c0341fb5a7a18d,0xb41f33c0218db5a7,0xb41f33c0218db5a7,0xb3c0b41f35a7218d
.quad 0xb5852cf53585acf5,0xb5852cf53585acf5,0xacf5b5852cf53585,0xacf5b5852cf53585,0x2ef7b562b50a3126,0xb562aef73126350a,0x35622ef7b126b50a,0x2ef7b562b50a3126,0x337f343d343db37f,0xb37fb43db43d337f,0xb43d337f337f343d,0x343db37fb37fb43d,0xb58e2c47b25834af,0xac47b58eb4afb258,0xac47b58eb4afb258,0x358eac473258b4af
.quad 0,0,0,0,0,0,0,0,0,0,0,0,0,0,0,0
.quad 0,0,0,0,0,0,0,0,0,0,0,0,0,0,0,0
.quad 0,0,0,0,0,0,0,0,0,0,0,0,0,0,0,0
.quad 0,0,0,0,0,0,0,0,0,0,0,0,0,0,0,0
.quad 0x3400340034003400,0x3400340034003400,0xb4003400b4003400,0xb4003400b4003400,0x3579adb334e131ba,0xadb3b57931bab4e1,0x2db33579b1ba34e1,0x3579adb334e131ba,0x2e2bb57135712e2b,0xae2b3571b571ae2b,0x35712e2bae2b3571,0xb571ae2b2e2bb571,0xb3d4b41635a81fc6,0x3416b3d49fc635a8,0x3416b3d49fc635a8,0x33d43416b5a89fc6
.quad 0xb5812d3a3581ad3a,0xb5812d3a3581ad3a,0xad3ab5812d3a3581,0xad3ab5812d3a3581,0xaea3356934ffb14d,0x35692ea3b14db4ff,0xb569aea3314d34ff,0xaea3356934ffb14d,0x33a6342b342bb3a6,0xb3a6b42bb42b33a6,0xb42b33a633a6342b,0x342bb3a6b3a6b42b,0x3588acc13224b4c0,0x2cc1358834c03224,0x2cc1358834c03224,0xb5882cc1b22434c0
.quad 0x3400340034003400,0x3400340034003400,0xb4003400b4003400,0xb4003400b4003400,0xb5792db3b4e1b1ba,0x2db33579b1ba34e1,0xadb3b57931bab4e1,0xb5792db3b4e1b1ba,0x2e2bb57135712e2b,0xae2b3571b571ae2b,0x35712e2bae2b3571,0xb571ae2b2e2bb571,0x33d43416b5a89fc6,0xb41633d41fc6b5a8,0xb41633d41fc6b5a8,0xb3d4b41635a81fc6
.quad 0xb5812d3a3581ad3a,0xb5812d3a3581ad3a,0xad3ab5812d3a3581,0xad3ab5812d3a3581,0x2ea3b569b4ff314d,0xb569aea3314d34ff,0x35692ea3b14db4ff,0x2ea3b569b4ff314d,0x33a6342b342bb3a6,0xb3a6b42bb42b33a6,0xb42b33a633a6342b,0x342bb3a6b3a6b42b,0xb5882cc1b22434c0,0xacc1b588b4c0b224,0xacc1b588b4c0b224,0x3588acc13224b4c0
.quad 0,0,0,0,0,0,0,0,0,0,0,0,0,0,0,0
.quad 0,0,0,0,0,0,0,0,0,0,0,0,0,0,0,0
.quad 0,0,0,0,0,0,0,0,0,0,0,0,0,0,0,0
.quad 0,0,0,0,0,0,0,0,0,0,0,0,0,0,0,0
.quad 0x3400340034003400,0x3400340034003400,0xb4003400b4003400,0xb4003400b4003400,0x3578adc434e331b2,0xadc4b57831b2b4e3,0x2dc43578b1b234e3,0x3578adc434e331b2,0x2e09b57435742e09,0xae093574b574ae09,0x35742e09ae093574,0xb574ae092e09b574,0xb3e7b40c35a81c71,0x340cb3e79c7135a8,0x340cb3e79c7135a8,0x33e7340cb5a89c71
.quad 0xb57d2d7f357dad7f,0xb57d2d7f357dad7f,0xad7fb57d2d7f357d,0xad7fb57d2d7f357d,0xae4d356f34f5b175,0x356f2e4db175b4f5,0xb56fae4d317534f5,0xae4d356f34f5b175,0x33cd34193419b3cd,0xb3cdb419b41933cd,0xb41933cd33cd3419,0x3419b3cdb3cdb419,0x3581ad3a31efb4d1,0x2d3a358134d131ef,0x2d3a358134d131ef,0xb5812d3ab1ef34d1
.quad 0x3400340034003400,0x3400340034003400,0xb4003400b4003400,0xb4003400b4003400,0xb5782dc4b4e3b1b2,0x2dc43578b1b234e3,0xadc4b57831b2b4e3,0xb5782dc4b4e3b1b2,0x2e09b57435742e09,0xae093574b574ae09,0x35742e09ae093574,0xb574ae092e09b574,0x33e7340cb5a89c71,0xb40c33e71c71b5a8,0xb40c33e71c71b5a8,0xb3e7b40c35a81c71
.quad 0xb57d2d7f357dad7f,0xb57d2d7f357dad7f,0xad7fb57d2d7f357d,0xad7fb57d2d7f357d,0x2e4db56fb4f53175,0xb56fae4d317534f5,0x356f2e4db175b4f5,0x2e4db56fb4f53175,0x33cd34193419b3cd,0xb3cdb419b41933cd,0xb41933cd33cd3419,0x3419b3cdb3cdb419,0xb5812d3ab1ef34d1,0xad3ab581b4d1b1ef,0xad3ab581b4d1b1ef,0x3581ad3a31efb4d1
.quad 0,0,0,0,0,0,0,0,0,0,0,0,0,0,0,0
.quad 0,0,0,0,0,0,0,0,0,0,0,0,0,0,0,0
.quad 0,0,0,0,0,0,0,0,0,0,0,0,0,0,0,0
.quad 0,0,0,0,0,0,0,0,0,0,0,0,0,0,0,0
.quad 0x3400340034003400,0x3400340034003400,0xb4003400b4003400,0xb4003400b4003400,0x3577add634e531ab,0xadd6b57731abb4e5,0x2dd63577b1ab34e5,0x3577add634e531ab,0x2de7b57635762de7,0xade73576b576ade7,0x35762de7ade73576,0xb576ade72de7b576,0xb3fab40335a81471,0x3403b3fa947135a8,0x3403b3fa947135a8,0x33fa3403b5a89471
.quad 0xb5782dc43578adc4,0xb5782dc43578adc4,0xadc4b5782dc43578,0xadc4b5782dc43578,0xadf8357534eab19b,0x35752df8b19bb4ea,0xb575adf8319b34ea,0xadf8357534eab19b,0x33f334063406b3f3,0xb3f3b406b40633f3,0xb40633f333f33406,0x3406b3f3b3f3b406,0x3579adb331bab4e1,0x2db3357934e131ba,0x2db3357934e131ba,0xb5792db3b1ba34e1
.quad 0x3400340034003400,0x3400340034003400,0xb4003400b4003400,0xb4003400b4003400,0xb5772dd6b4e5b1ab,0x2dd63577b1ab34e5,0xadd6b57731abb4e5,0xb5772dd6b4e5b1ab,0x2de7b57635762de7,0xade73576b576ade7,0x35762de7ade73576,0xb576ade72de7b576,0x33fa3403b5a89471,0xb40333fa1471b5a8,0xb40333fa1471b5a8,0xb3fab40335a81471
.quad 0xb5782dc43578adc4,0xb5782dc43578adc4,0xadc4b5782dc43578,0xadc4b5782dc43578,0x2df8b575b4ea319b,0xb575adf8319b34ea,0x35752df8b19bb4ea,0x2df8b575b4ea319b,0x33f334063406b3f3,0xb3f3b406b40633f3,0xb40633f333f33406,0x3406b3f3b3f3b406,0xb5792db3b1ba34e1,0xadb3b579b4e1b1ba,0xadb3b579b4e1b1ba,0x3579adb331bab4e1
.quad 0,0,0,0,0,0,0,0,0,0,0,0,0,0,0,0
.quad 0,0,0,0,0,0,0,0,0,0,0,0,0,0,0,0
.quad 0,0,0,0,0,0,0,0,0,0,0,0,0,0,0,0
.quad 0,0,0,0,0,0,0,0,0,0,0,0,0,0,0,0
.quad 0x3400340034003400,0x3400340034003400,0xb4003400b4003400,0xb4003400b4003400,0x3576ade734e831a3,0xade7b57631a3b4e8,0x2de73576b1a334e8,0x3576ade734e831a3,0x2dc4b57835782dc4,0xadc43578b578adc4,0x35782dc4adc43578,0xb578adc42dc4b578,0xb406b3f335a89871,0x33f3b406187135a8,0x33f3b406187135a8,0x340633f3b5a81871
.quad 0xb5742e093574ae09,0xb5742e093574ae09,0xae09b5742e093574,0xae09b5742e093574,0xada2357b34dfb1c2,0x357b2da2b1c2b4df,0xb57bada231c234df,0xada2357b34dfb1c2,0x340c33e733e7b40c,0xb40cb3e7b3e7340c,0xb3e7340c340c33e7,0x33e7b40cb40cb3e7,0x3571ae2b3184b4f0,0x2e2b357134f03184,0x2e2b357134f03184,0xb5712e2bb18434f0
.quad 0x3400340034003400,0x3400340034003400,0xb4003400b4003400,0xb4003400b4003400,0xb5762de7b4e8b1a3,0x2de73576b1a334e8,0xade7b57631a3b4e8,0xb5762de7b4e8b1a3,0x2dc4b57835782dc4,0xadc43578b578adc4,0x35782dc4adc43578,0xb578adc42dc4b578,0x340633f3b5a81871,0xb3f334069871b5a8,0xb3f334069871b5a8,0xb406b3f335a89871
.quad 0xb5742e093574ae09,0xb5742e093574ae09,0xae09b5742e093574,0xae09b5742e093574,0x2da2b57bb4df31c2,0xb57bada231c234df,0x357b2da2b1c2b4df,0x2da2b57bb4df31c2,0x340c33e733e7b40c,0xb40cb3e7b3e7340c,0xb3e7340c340c33e7,0x33e7b40cb40cb3e7,0xb5712e2bb18434f0,0xae2bb571b4f0b184,0xae2bb571b4f0b184,0x3571ae2b3184b4f0
.quad 0,0,0,0,0,0,0,0,0,0,0,0,0,0,0,0
.quad 0,0,0,0,0,0,0,0,0,0,0,0,0,0,0,0
.quad 0,0,0,0,0,0,0,0,0,0,0,0,0,0,0,0
.quad 0,0,0,0,0,0,0,0,0,0,0,0,0,0,0,0
.quad 0x3400340034003400,0x3400340034003400,0xb4003400b4003400,0xb4003400b4003400,0x3575adf834ea319b,0xadf8b575319bb4ea,0x2df83575b19b34ea,0x3575adf834ea319b,0x2da2b57b357b2da2,0xada2357bb57bada2,0x357b2da2ada2357b,0xb57bada22da2b57b,0xb410b3e035a89d8e,0x33e0b4101d8e35a8,0x33e0b4101d8e35a8,0x341033e0b5a81d8e
.quad 0xb56f2e4d356fae4d,0xb56f2e4d356fae4d,0xae4db56f2e4d356f,0xae4db56f2e4d356f,0xad4c358034d3b1e8,0x35802d4cb1e8b4d3,0xb580ad4c31e834d3,0xad4c358034d3b1e8,0x341f33c033c0b41f,0xb41fb3c0b3c0341f,0xb3c0341f341f33c0,0x33c0b41fb41fb3c0,0x3569aea3314db4ff,0x2ea3356934ff314d,0x2ea3356934ff314d,0xb5692ea3b14d34ff
.quad 0x3400340034003400,0x3400340034003400,0xb4003400b4003400,0xb4003400b4003400,0xb5752df8b4eab19b,0x2df83575b19b34ea,0xadf8b575319bb4ea,0xb5752df8b4eab19b,0x2da2b57b357b2da2,0xada2357bb57bada2,0x357b2da2ada2357b,0xb57bada22da2b57b,0x341033e0b5a81d8e,0xb3e034109d8eb5a8,0xb3e034109d8eb5a8,0xb410b3e035a89d8e
.quad 0xb56f2e4d356fae4d,0xb56f2e4d356fae4d,0xae4db56f2e4d356f,0xae4db56f2e4d356f,0x2d4cb580b4d331e8,0xb580ad4c31e834d3,0x35802d4cb1e8b4d3,0x2d4cb580b4d331e8,0x341f33c033c0b41f,0xb41fb3c0b3c0341f,0xb3c0341f341f33c0,0x33c0b41fb41fb3c0,0xb5692ea3b14d34ff,0xaea3b569b4ffb14d,0xaea3b569b4ffb14d,0x3569aea3314db4ff
.quad 0,0,0,0,0,0,0,0,0,0,0,0,0,0,0,0
.quad 0,0,0,0,0,0,0,0,0,0,0,0,0,0,0,0
.quad 0,0,0,0,0,0,0,0,0,0,0,0,0,0,0,0
.quad 0,0,0,0,0,0,0,0,0,0,0,0,0,0,0,0
.quad 0x3400340034003400,0x3400340034003400,0xb4003400b4003400,0xb4003400b4003400,0x3574ae0934ec3194,0xae09b5743194b4ec,0x2e093574b19434ec,0x3574ae0934ec3194,0x2d7fb57d357d2d7f,0xad7f357db57dad7f,0x357d2d7fad7f357d,0xb57dad7f2d7fb57d,0xb419b3cd35a8a071,0x33cdb419207135a8,0x33cdb419207135a8,0x341933cdb5a82071
.quad 0xb56a2e92356aae92,0xb56a2e92356aae92,0xae92b56a2e92356a,0xae92b56a2e92356a,0xacf5358534c7b20e,0x35852cf5b20eb4c7,0xb585acf5320e34c7,0xacf5358534c7b20e,0x343133993399b431,0xb431b399b3993431,0xb399343134313399,0x3399b431b431b399,0x355faf193116b50e,0x2f19355f350e3116,0x2f19355f350e3116,0xb55f2f19b116350e
.quad 0x3400340034003400,0x3400340034003400,0xb4003400b4003400,0xb4003400b4003400,0xb5742e09b4ecb194,0x2e093574b19434ec,0xae09b5743194b4ec,0xb5742e09b4ecb194,0x2d7fb57d357d2d7f,0xad7f357db57dad7f,0x357d2d7fad7f357d,0xb57dad7f2d7fb57d,0x341933cdb5a82071,0xb3cd3419a071b5a8,0xb3cd3419a071b5a8,0xb419b3cd35a8a071
.quad 0xb56a2e92356aae92,0xb56a2e92356aae92,0xae92b56a2e92356a,0xae92b56a2e92356a,0x2cf5b585b4c7320e,0xb585acf5320e34c7,0x35852cf5b20eb4c7,0x2cf5b585b4c7320e,0x343133993399b431,0xb431b399b3993431,0xb399343134313399,0x3399b431b431b399,0xb55f2f19b116350e,0xaf19b55fb50eb116,0xaf19b55fb50eb116,0x355faf193116b50e
.quad 0,0,0,0,0,0,0,0,0,0,0,0,0,0,0,0
.quad 0,0,0,0,0,0,0,0,0,0,0,0,0,0,0,0
.quad 0,0,0,0,0,0,0,0,0,0,0,0,0,0,0,0
.quad 0,0,0,0,0,0,0,0,0,0,0,0,0,0,0,0
.quad 0x3400340034003400,0x3400340034003400,0xb4003400b4003400,0xb4003400b4003400,0x3573ae1a34ee318c,0xae1ab573318cb4ee,0x2e1a3573b18c34ee,0x3573ae1a34ee318c,0x2d5db57f357f2d5d,0xad5d357fb57fad5d,0x357f2d5dad5d357f,0xb57fad5d2d5db57f,0xb422b3ba35a7a21c,0x33bab422221c35a7,0x33bab422221c35a7,0x342233bab5a7221c
.quad 0xb5652ed53565aed5,0xb5652ed53565aed5,0xaed5b5652ed53565,0xaed5b5652ed53565,0xac9e358a34bbb233,0x358a2c9eb233b4bb,0xb58aac9e323334bb,0xac9e358a34bbb233,0x344333713371b443,0xb443b371b3713443,0xb371344334433371,0x3371b443b443b371,0x3555af8f30deb51b,0x2f8f3555351b30de,0x2f8f3555351b30de,0xb5552f8fb0de351b
.quad 0x3400340034003400,0x3400340034003400,0xb4003400b4003400,0xb4003400b4003400,0xb5732e1ab4eeb18c,0x2e1a3573b18c34ee,0xae1ab573318cb4ee,0xb5732e1ab4eeb18c,0x2d5db57f357f2d5d,0xad5d357fb57fad5d,0x357f2d5dad5d357f,0xb57fad5d2d5db57f,0x342233bab5a7221c,0xb3ba3422a21cb5a7,0xb3ba3422a21cb5a7,0xb422b3ba35a7a21c
.quad 0xb5652ed53565aed5,0xb5652ed53565aed5,0xaed5b5652ed53565,0xaed5b5652ed53565,0x2c9eb58ab4bb3233,0xb58aac9e323334bb,0x358a2c9eb233b4bb,0x2c9eb58ab4bb3233,0x344333713371b443,0xb443b371b3713443,0xb371344334433371,0x3371b443b443b371,0xb5552f8fb0de351b,0xaf8fb555b51bb0de,0xaf8fb555b51bb0de,0x3555af8f30deb51b
.quad 0,0,0,0,0,0,0,0,0,0,0,0,0,0,0,0
.quad 0,0,0,0,0,0,0,0,0,0,0,0,0,0,0,0
.quad 0,0,0,0,0,0,0,0,0,0,0,0,0,0,0,0
.quad 0,0,0,0,0,0,0,0,0,0,0,0,0,0,0,0
.quad 0x3400340034003400,0x3400340034003400,0xb4003400b4003400,0xb4003400b4003400,0x3571ae2b34f03184,0xae2bb5713184b4f0,0x2e2b3571b18434f0,0x3571ae2b34f03184,0x2d3ab58135812d3a,0xad3a3581b581ad3a,0x35812d3aad3a3581,0xb581ad3a2d3ab581,0xb42bb3a635a7a3c6,0x33a6b42b23c635a7,0x33a6b42b23c635a7,0x342b33a6b5a723c6
.quad 0xb55f2f19355faf19,0xb55f2f19355faf19,0xaf19b55f2f19355f,0xaf19b55f2f19355f,0xac47358e34afb258,0x358e2c47b258b4af,0xb58eac47325834af,0xac47358e34afb258,0x345433493349b454,0xb454b349b3493454,0xb349345434543349,0x3349b454b454b349,0x354ab00230a6b528,0x3002354a352830a6,0x3002354a352830a6,0xb54a3002b0a63528
.quad 0x3400340034003400,0x3400340034003400,0xb4003400b4003400,0xb4003400b4003400,0xb5712e2bb4f0b184,0x2e2b3571b18434f0,0xae2bb5713184b4f0,0xb5712e2bb4f0b184,0x2d3ab58135812d3a,0xad3a3581b581ad3a,0x35812d3aad3a3581,0xb581ad3a2d3ab581,0x342b33a6b5a723c6,0xb3a6342ba3c6b5a7,0xb3a6342ba3c6b5a7,0xb42bb3a635a7a3c6
.quad 0xb55f2f19355faf19,0xb55f2f19355faf19,0xaf19b55f2f19355f,0xaf19b55f2f19355f,0x2c47b58eb4af3258,0xb58eac47325834af,0x358e2c47b258b4af,0x2c47b58eb4af3258,0x345433493349b454,0xb454b349b3493454,0xb349345434543349,0x3349b454b454b349,0xb54a3002b0a63528,0xb002b54ab528b0a6,0xb002b54ab528b0a6,0x354ab00230a6b528
.quad 0,0,0,0,0,0,0,0,0,0,0,0,0,0,0,0
.quad 0,0,0,0,0,0,0,0,0,0,0,0,0,0,0,0
.quad 0,0,0,0,0,0,0,0,0,0,0,0,0,0,0,0
.quad 0,0,0,0,0,0,0,0,0,0,0,0,0,0,0,0
.quad 0x3400340034003400,0x3400340034003400,0xb4003400b4003400,0xb4003400b4003400,0x3570ae3c34f3317c,0xae3cb570317cb4f3,0x2e3c3570b17c34f3,0x3570ae3c34f3317c,0x2d18b58335832d18,0xad183583b583ad18,0x35832d18ad183583,0xb583ad182d18b583,0xb434b39235a6a4b8,0x3392b43424b835a6,0x3392b43424b835a6,0x34343392b5a624b8
.quad 0xb5592f5c3559af5c,0xb5592f5c3559af5c,0xaf5cb5592f5c3559,0xaf5cb5592f5c3559,0xabe0359234a3b27c,0x35922be0b27cb4a3,0xb592abe0327c34a3,0xabe0359234a3b27c,0x346533203320b465,0xb465b320b3203465,0xb320346534653320,0x3320b465b465b320,0x353fb03c306db535,0x303c353f3535306d,0x303c353f3535306d,0xb53f303cb06d3535
.quad 0x3400340034003400,0x3400340034003400,0xb4003400b4003400,0xb4003400b4003400,0xb5702e3cb4f3b17c,0x2e3c3570b17c34f3,0xae3cb570317cb4f3,0xb5702e3cb4f3b17c,0x2d18b58335832d18,0xad183583b583ad18,0x35832d18ad183583,0xb583ad182d18b583,0x34343392b5a624b8,0xb3923434a4b8b5a6,0xb3923434a4b8b5a6,0xb434b39235a6a4b8
.quad 0xb5592f5c3559af5c,0xb5592f5c3559af5c,0xaf5cb5592f5c3559,0xaf5cb5592f5c3559,0x2be0b592b4a3327c,0xb592abe0327c34a3,0x35922be0b27cb4a3,0x2be0b592b4a3327c,0x346533203320b465,0xb465b320b3203465,0xb320346534653320,0x3320b465b465b320,0xb53f303cb06d3535,0xb03cb53fb535b06d,0xb03cb53fb535b06d,0x353fb03c306db535
.quad 0,0,0,0,0,0,0,0,0,0,0,0,0,0,0,0
.quad 0,0,0,0,0,0,0,0,0,0,0,0,0,0,0,0
.quad 0,0,0,0,0,0,0,0,0,0,0,0,0,0,0,0
.quad 0,0,0,0,0,0,0,0,0,0,0,0,0,0,0,0
.quad 0x3400340034003400,0x3400340034003400,0xb4003400b4003400,0xb4003400b4003400,0x356fae4d34f53175,0xae4db56f3175b4f5,0x2e4d356fb17534f5,0x356fae4d34f53175,0x2cf5b58535852cf5,0xacf53585b585acf5,0x35852cf5acf53585,0xb585acf52cf5b585,0xb43db37f35a5a58d,0x337fb43d258d35a5,0x337fb43d258d35a5,0x343d337fb5a5258d
.quad 0xb5542f9f3554af9f,0xb5542f9f3554af9f,0xaf9fb5542f9f3554,0xaf9fb5542f9f3554,0xab3035963496b2a1,0x35962b30b2a1b496,0xb596ab3032a13496,0xab3035963496b2a1,0x347632f632f6b476,0xb476b2f6b2f63476,0xb2f63476347632f6,0x32f6b476b476b2f6,0x3533b0753033b541,0x3075353335413033,0x3075353335413033,0xb5333075b0333541
.quad 0x3400340034003400,0x3400340034003400,0xb4003400b4003400,0xb4003400b4003400,0xb56f2e4db4f5b175,0x2e4d356fb17534f5,0xae4db56f3175b4f5,0xb56f2e4db4f5b175,0x2cf5b58535852cf5,0xacf53585b585acf5,0x35852cf5acf53585,0xb585acf52cf5b585,0x343d337fb5a5258d,0xb37f343da58db5a5,0xb37f343da58db5a5,0xb43db37f35a5a58d
.quad 0xb5542f9f3554af9f,0xb5542f9f3554af9f,0xaf9fb5542f9f3554,0xaf9fb5542f9f3554,0x2b30b596b49632a1,0xb596ab3032a13496,0x35962b30b2a1b496,0x2b30b596b49632a1,0x347632f632f6b476,0xb476b2f6b2f63476,0xb2f63476347632f6,0x32f6b476b476b2f6,0xb5333075b0333541,0xb075b533b541b033,0xb075b533b541b033,0x3533b0753033b541
.quad 0,0,0,0,0,0,0,0,0,0,0,0,0,0,0,0
.quad 0,0,0,0,0,0,0,0,0,0,0,0,0,0,0,0
.quad 0,0,0,0,0,0,0,0,0,0,0,0,0,0,0,0
.quad 0,0,0,0,0,0,0,0,0,0,0,0,0,0,0,0
.quad 0x3400340034003400,0x3400340034003400,0xb4003400b4003400,0xb4003400b4003400,0x356eae5e34f7316d,0xae5eb56e316db4f7,0x2e5e356eb16d34f7,0x356eae5e34f7316d,0x2cd2b58735872cd2,0xacd23587b587acd2,0x35872cd2acd23587,0xb587acd22cd2b587,0xb446b36b35a5a662,0x336bb446266235a5,0x336bb446266235a5,0x3446336bb5a52662
.quad 0xb54d2fe2354dafe2,0xb54d2fe2354dafe2,0xafe2b54d2fe2354d,0xafe2b54d2fe2354d,0xaa8135993489b2c4,0x35992a81b2c4b489,0xb599aa8132c43489,0xaa8135993489b2c4,0x348632cc32ccb486,0xb486b2ccb2cc3486,0xb2cc3486348632cc,0x32ccb486b486b2cc,0x3526b0ae2ff3b54c,0x30ae3526354c2ff3,0x30ae3526354c2ff3,0xb52630aeaff3354c
.quad 0x3400340034003400,0x3400340034003400,0xb4003400b4003400,0xb4003400b4003400,0xb56e2e5eb4f7b16d,0x2e5e356eb16d34f7,0xae5eb56e316db4f7,0xb56e2e5eb4f7b16d,0x2cd2b58735872cd2,0xacd23587b587acd2,0x35872cd2acd23587,0xb587acd22cd2b587,0x3446336bb5a52662,0xb36b3446a662b5a5,0xb36b3446a662b5a5,0xb446b36b35a5a662
.quad 0xb54d2fe2354dafe2,0xb54d2fe2354dafe2,0xafe2b54d2fe2354d,0xafe2b54d2fe2354d,0x2a81b599b48932c4,0xb599aa8132c43489,0x35992a81b2c4b489,0x2a81b599b48932c4,0x348632cc32ccb486,0xb486b2ccb2cc3486,0xb2cc3486348632cc,0x32ccb486b486b2cc,0xb52630aeaff3354c,0xb0aeb526b54caff3,0xb0aeb526b54caff3,0x3526b0ae2ff3b54c
.quad 0,0,0,0,0,0,0,0,0,0,0,0,0,0,0,0
.quad 0,0,0,0,0,0,0,0,0,0,0,0,0,0,0,0
.quad 0,0,0,0,0,0,0,0,0,0,0,0,0,0,0,0
.quad 0,0,0,0,0,0,0,0,0,0,0,0,0,0,0,0
.quad 0x3400340034003400,0x3400340034003400,0xb4003400b4003400,0xb4003400b4003400,0x356cae6f34f93165,0xae6fb56c3165b4f9,0x2e6f356cb16534f9,0x356cae6f34f93165,0x2cb0b58935892cb0,0xacb03589b589acb0,0x35892cb0acb03589,0xb589acb02cb0b589,0xb44eb35635a4a736,0x3356b44e273635a4,0x3356b44e273635a4,0x344e3356b5a42736
.quad 0xb54730123547b012,0xb54730123547b012,0xb012b54730123547,0xb012b54730123547,0xa9d1359c347bb2e8,0x359c29d1b2e8b47b,0xb59ca9d132e8347b,0xa9d1359c347bb2e8,0x349632a132a1b496,0xb496b2a1b2a13496,0xb2a13496349632a1,0x32a1b496b496b2a1,0x3519b0e62f7eb556,0x30e6351935562f7e,0x30e6351935562f7e,0xb51930e6af7e3556
.quad 0x3400340034003400,0x3400340034003400,0xb4003400b4003400,0xb4003400b4003400,0xb56c2e6fb4f9b165,0x2e6f356cb16534f9,0xae6fb56c3165b4f9,0xb56c2e6fb4f9b165,0x2cb0b58935892cb0,0xacb03589b589acb0,0x35892cb0acb03589,0xb589acb02cb0b589,0x344e3356b5a42736,0xb356344ea736b5a4,0xb356344ea736b5a4,0xb44eb35635a4a736
.quad 0xb54730123547b012,0xb54730123547b012,0xb012b54730123547,0xb012b54730123547,0x29d1b59cb47b32e8,0xb59ca9d132e8347b,0x359c29d1b2e8b47b,0x29d1b59cb47b32e8,0x349632a132a1b496,0xb496b2a1b2a13496,0xb2a13496349632a1,0x32a1b496b496b2a1,0xb51930e6af7e3556,0xb0e6b519b556af7e,0xb0e6b519b556af7e,0x3519b0e62f7eb556
.quad 0,0,0,0,0,0,0,0,0,0,0,0,0,0,0,0
.quad 0,0,0,0,0,0,0,0,0,0,0,0,0,0,0,0
.quad 0,0,0,0,0,0,0,0,0,0,0,0,0,0,0,0
.quad 0,0,0,0,0,0,0,0,0,0,0,0,0,0,0,0
.quad 0x3400340034003400,0x3400340034003400,0xb4003400b4003400,0xb4003400b4003400,0x356bae8034fb315d,0xae80b56b315db4fb,0x2e80356bb15d34fb,0x356bae8034fb315d,0x2c8db58b358b2c8d,0xac8d358bb58bac8d,0x358b2c8dac8d358b,0xb58bac8d2c8db58b,0xb457b34235a2a805,0x3342b457280535a2,0x3342b457280535a2,0x34573342b5a22805
.quad 0xb54130333541b033,0xb54130333541b033,0xb033b54130333541,0xb033b54130333541,0xa920359f346db30b,0x359f2920b30bb46d,0xb59fa920330b346d,0xa920359f346db30b,0x34a532753275b4a5,0xb4a5b275b27534a5,0xb27534a534a53275,0x3275b4a5b4a5b275,0x350cb11e2f08b560,0x311e350c35602f08,0x311e350c35602f08,0xb50c311eaf083560
.quad 0x3400340034003400,0x3400340034003400,0xb4003400b4003400,0xb4003400b4003400,0xb56b2e80b4fbb15d,0x2e80356bb15d34fb,0xae80b56b315db4fb,0xb56b2e80b4fbb15d,0x2c8db58b358b2c8d,0xac8d358bb58bac8d,0x358b2c8dac8d358b,0xb58bac8d2c8db58b,0x34573342b5a22805,0xb3423457a805b5a2,0xb3423457a805b5a2,0xb457b34235a2a805
.quad 0xb54130333541b033,0xb54130333541b033,0xb033b54130333541,0xb033b54130333541,0x2920b59fb46d330b,0xb59fa920330b346d,0x359f2920b30bb46d,0x2920b59fb46d330b,0x34a532753275b4a5,0xb4a5b275b27534a5,0xb27534a534a53275,0x3275b4a5b4a5b275,0xb50c311eaf083560,0xb11eb50cb560af08,0xb11eb50cb560af08,0x350cb11e2f08b560
.quad 0,0,0,0,0,0,0,0,0,0,0,0,0,0,0,0
.quad 0,0,0,0,0,0,0,0,0,0,0,0,0,0,0,0
.quad 0,0,0,0,0,0,0,0,0,0,0,0,0,0,0,0
.quad 0,0,0,0,0,0,0,0,0,0,0,0,0,0,0,0
.quad 0x3400340034003400,0x3400340034003400,0xb4003400b4003400,0xb4003400b4003400,0x356aae9234fd3155,0xae92b56a3155b4fd,0x2e92356ab15534fd,0x356aae9234fd3155,0x2c6ab58c358c2c6a,0xac6a358cb58cac6a,0x358c2c6aac6a358c,0xb58cac6a2c6ab58c,0xb45fb32d35a1a870,0x332db45f287035a1,0x332db45f287035a1,0x345f332db5a12870
.quad 0xb53a3054353ab054,0xb53a3054353ab054,0xb054b53a3054353a,0xb054b53a3054353a,0xa87035a1345fb32d,0x35a12870b32db45f,0xb5a1a870332d345f,0xa87035a1345fb32d,0x34b432493249b4b4,0xb4b4b249b24934b4,0xb24934b434b43249,0x3249b4b4b4b4b249,0x34fdb1552e92b56a,0x315534fd356a2e92,0x315534fd356a2e92,0xb4fd3155ae92356a
.quad 0x3400340034003400,0x3400340034003400,0xb4003400b4003400,0xb4003400b4003400,0xb56a2e92b4fdb155,0x2e92356ab15534fd,0xae92b56a3155b4fd,0xb56a2e92b4fdb155,0x2c6ab58c358c2c6a,0xac6a358cb58cac6a,0x358c2c6aac6a358c,0xb58cac6a2c6ab58c,0x345f332db5a12870,0xb32d345fa870b5a1,0xb32d345fa870b5a1,0xb45fb32d35a1a870
.quad 0xb53a3054353ab054,0xb53a3054353ab054,0xb054b53a3054353a,0xb054b53a3054353a,0x2870b5a1b45f332d,0xb5a1a870332d345f,0x35a12870b32db45f,0x2870b5a1b45f332d,0x34b432493249b4b4,0xb4b4b249b24934b4,0xb24934b434b43249,0x3249b4b4b4b4b249,0xb4fd3155ae92356a,0xb155b4fdb56aae92,0xb155b4fdb56aae92,0x34fdb1552e92b56a
.quad 0,0,0,0,0,0,0,0,0,0,0,0,0,0,0,0
.quad 0,0,0,0,0,0,0,0,0,0,0,0,0,0,0,0
.quad 0,0,0,0,0,0,0,0,0,0,0,0,0,0,0,0
.quad 0,0,0,0,0,0,0,0,0,0,0,0,0,0,0,0
.quad 0x3400340034003400,0x3400340034003400,0xb4003400b4003400,0xb4003400b4003400,0x3569aea334ff314d,0xaea3b569314db4ff,0x2ea33569b14d34ff,0x3569aea334ff314d,0x2c47b58e358e2c47,0xac47358eb58eac47,0x358e2c47ac47358e,0xb58eac472c47b58e,0xb468b31935a0a8da,0x3319b46828da35a0,0x3319b46828da35a0,0x34683319b5a028da
.quad 0xb53330753533b075,0xb53330753533b075,0xb075b53330753533,0xb075b53330753533,0xa77d35a33451b350,0x35a3277db350b451,0xb5a3a77d33503451,0xa77d35a33451b350,0x34c3321d321db4c3,0xb4c3b21db21d34c3,0xb21d34c334c3321d,0x321db4c3b4c3b21d,0x34eeb18c2e1ab573,0x318c34ee35732e1a,0x318c34ee35732e1a,0xb4ee318cae1a3573
.quad 0x3400340034003400,0x3400340034003400,0xb4003400b4003400,0xb4003400b4003400,0xb5692ea3b4ffb14d,0x2ea33569b14d34ff,0xaea3b569314db4ff,0xb5692ea3b4ffb14d,0x2c47b58e358e2c47,0xac47358eb58eac47,0x358e2c47ac47358e,0xb58eac472c47b58e,0x34683319b5a028da,0xb3193468a8dab5a0,0xb3193468a8dab5a0,0xb468b31935a0a8da
.quad 0xb53330753533b075,0xb53330753533b075,0xb075b53330753533,0xb075b53330753533,0x277db5a3b4513350,0xb5a3a77d33503451,0x35a3277db350b451,0x277db5a3b4513350,0x34c3321d321db4c3,0xb4c3b21db21d34c3,0xb21d34c334c3321d,0x321db4c3b4c3b21d,0xb4ee318cae1a3573,0xb18cb4eeb573ae1a,0xb18cb4eeb573ae1a,0x34eeb18c2e1ab573
.quad 0,0,0,0,0,0,0,0,0,0,0,0,0,0,0,0
.quad 0,0,0,0,0,0,0,0,0,0,0,0,0,0,0,0
.quad 0,0,0,0,0,0,0,0,0,0,0,0,0,0,0,0
.quad 0,0,0,0,0,0,0,0,0,0,0,0,0,0,0,0
.quad 0x3400340034003400,0x3400340034003400,0xb4003400b4003400,0xb4003400b4003400,0x3567aeb335013146,0xaeb3b5673146b501,0x2eb33567b1463501,0x3567aeb335013146,0x2c24b59035902c24,0xac243590b590ac24,0x35902c24ac243590,0xb590ac242c24b590,0xb470b304359ea944,0x3304b4702944359e,0x3304b4702944359e,0x34703304b59e2944
.quad 0xb52c3096352cb096,0xb52c3096352cb096,0xb096b52c3096352c,0xb096b52c3096352c,0xa61b35a53443b371,0x35a5261bb371b443,0xb5a5a61b33713443,0xa61b35a53443b371,0x34d131ef31efb4d1,0xb4d1b1efb1ef34d1,0xb1ef34d134d131ef,0x31efb4d1b4d1b1ef,0x34dfb1c22da2b57b,0x31c234df357b2da2,0x31c234df357b2da2,0xb4df31c2ada2357b
.quad 0x3400340034003400,0x3400340034003400,0xb4003400b4003400,0xb4003400b4003400,0xb5672eb3b501b146,0x2eb33567b1463501,0xaeb3b5673146b501,0xb5672eb3b501b146,0x2c24b59035902c24,0xac243590b590ac24,0x35902c24ac243590,0xb590ac242c24b590,0x34703304b59e2944,0xb3043470a944b59e,0xb3043470a944b59e,0xb470b304359ea944
.quad 0xb52c3096352cb096,0xb52c3096352cb096,0xb096b52c3096352c,0xb096b52c3096352c,0x261bb5a5b4433371,0xb5a5a61b33713443,0x35a5261bb371b443,0x261bb5a5b4433371,0x34d131ef31efb4d1,0xb4d1b1efb1ef34d1,0xb1ef34d134d131ef,0x31efb4d1b4d1b1ef,0xb4df31c2ada2357b,0xb1c2b4dfb57bada2,0xb1c2b4dfb57bada2,0x34dfb1c22da2b57b
.quad 0,0,0,0,0,0,0,0,0,0,0,0,0,0,0,0
.quad 0,0,0,0,0,0,0,0,0,0,0,0,0,0,0,0
.quad 0,0,0,0,0,0,0,0,0,0,0,0,0,0,0,0
.quad 0,0,0,0,0,0,0,0,0,0,0,0,0,0,0,0
.quad 0x3400340034003400,0x3400340034003400,0xb4003400b4003400,0xb4003400b4003400,0x3566aec43503313e,0xaec4b566313eb503,0x2ec43566b13e3503,0x3566aec43503313e,0x2c01b59135912c01,0xac013591b591ac01,0x35912c01ac013591,0xb591ac012c01b591,0xb478b2ef359da9ad,0x32efb47829ad359d,0x32efb47829ad359d,0x347832efb59d29ad
.quad 0xb52530b63525b0b6,0xb52530b63525b0b6,0xb0b6b52530b63525,0xb0b6b52530b63525,0xa4b835a63434b392,0x35a624b8b392b434,0xb5a6a4b833923434,0xa4b835a63434b392,0x34df31c231c2b4df,0xb4dfb1c2b1c234df,0xb1c234df34df31c2,0x31c2b4dfb4dfb1c2,0x34cfb1f72d29b582,0x31f734cf35822d29,0x31f734cf35822d29,0xb4cf31f7ad293582
.quad 0x3400340034003400,0x3400340034003400,0xb4003400b4003400,0xb4003400b4003400,0xb5662ec4b503b13e,0x2ec43566b13e3503,0xaec4b566313eb503,0xb5662ec4b503b13e,0x2c01b59135912c01,0xac013591b591ac01,0x35912c01ac013591,0xb591ac012c01b591,0x347832efb59d29ad,0xb2ef3478a9adb59d,0xb2ef3478a9adb59d,0xb478b2ef359da9ad
.quad 0xb52530b63525b0b6,0xb52530b63525b0b6,0xb0b6b52530b63525,0xb0b6b52530b63525,0x24b8b5a6b4343392,0xb5a6a4b833923434,0x35a624b8b392b434,0x24b8b5a6b4343392,0x34df31c231c2b4df,0xb4dfb1c2b1c234df,0xb1c234df34df31c2,0x31c2b4dfb4dfb1c2,0xb4cf31f7ad293582,0xb1f7b4cfb582ad29,0xb1f7b4cfb582ad29,0x34cfb1f72d29b582
.quad 0,0,0,0,0,0,0,0,0,0,0,0,0,0,0,0
.quad 0,0,0,0,0,0,0,0,0,0,0,0,0,0,0,0
.quad 0,0,0,0,0,0,0,0,0,0,0,0,0,0,0,0
.quad 0,0,0,0,0,0,0,0,0,0,0,0,0,0,0,0
.quad 0x3400340034003400,0x3400340034003400,0xb4003400b4003400,0xb4003400b4003400,0x3565aed535053136,0xaed5b5653136b505,0x2ed53565b1363505,0x3565aed535053136,0x2bbdb59335932bbd,0xabbd3593b593abbd,0x35932bbdabbd3593,0xb593abbd2bbdb593,0xb480b2da359baa17,0x32dab4802a17359b,0x32dab4802a17359b,0x348032dab59b2a17
.quad 0xb51d30d6351db0d6,0xb51d30d6351db0d6,0xb0d6b51d30d6351d,0xb0d6b51d30d6351d,0xa2aa35a73425b3b3,0x35a722aab3b3b425,0xb5a7a2aa33b33425,0xa2aa35a73425b3b3,0x34ec31943194b4ec,0xb4ecb194b19434ec,0xb19434ec34ec3194,0x3194b4ecb4ecb194,0x34beb22b2cb0b589,0x322b34be35892cb0,0x322b34be35892cb0,0xb4be322bacb03589
.quad 0x3400340034003400,0x3400340034003400,0xb4003400b4003400,0xb4003400b4003400,0xb5652ed5b505b136,0x2ed53565b1363505,0xaed5b5653136b505,0xb5652ed5b505b136,0x2bbdb59335932bbd,0xabbd3593b593abbd,0x35932bbdabbd3593,0xb593abbd2bbdb593,0x348032dab59b2a17,0xb2da3480aa17b59b,0xb2da3480aa17b59b,0xb480b2da359baa17
.quad 0xb51d30d6351db0d6,0xb51d30d6351db0d6,0xb0d6b51d30d6351d,0xb0d6b51d30d6351d,0x22aab5a7b42533b3,0xb5a7a2aa33b33425,0x35a722aab3b3b425,0x22aab5a7b42533b3,0x34ec31943194b4ec,0xb4ecb194b19434ec,0xb19434ec34ec3194,0x3194b4ecb4ecb194,0xb4be322bacb03589,0xb22bb4beb589acb0,0xb22bb4beb589acb0,0x34beb22b2cb0b589
.quad 0,0,0,0,0,0,0,0,0,0,0,0,0,0,0,0
.quad 0,0,0,0,0,0,0,0,0,0,0,0,0,0,0,0
.quad 0,0,0,0,0,0,0,0,0,0,0,0,0,0,0,0
.quad 0,0,0,0,0,0,0,0,0,0,0,0,0,0,0,0
.quad 0x3400340034003400,0x3400340034003400,0xb4003400b4003400,0xb4003400b4003400,0x3563aee63507312e,0xaee6b563312eb507,0x2ee63563b12e3507,0x3563aee63507312e,0x2b77b59435942b77,0xab773594b594ab77,0x35942b77ab773594,0xb594ab772b77b594,0xb489b2c43599aa81,0x32c4b4892a813599,0x32c4b4892a813599,0x348932c4b5992a81
.quad 0xb51530f63515b0f6,0xb51530f63515b0f6,0xb0f6b51530f63515,0xb0f6b51530f63515,0x9fc635a83416b3d4,0x35a81fc6b3d4b416,0xb5a89fc633d43416,0x9fc635a83416b3d4,0x34f931653165b4f9,0xb4f9b165b16534f9,0xb16534f934f93165,0x3165b4f9b4f9b165,0x34adb25f2c36b58f,0x325f34ad358f2c36,0x325f34ad358f2c36,0xb4ad325fac36358f
.quad 0x3400340034003400,0x3400340034003400,0xb4003400b4003400,0xb4003400b4003400,0xb5632ee6b507b12e,0x2ee63563b12e3507,0xaee6b563312eb507,0xb5632ee6b507b12e,0x2b77b59435942b77,0xab773594b594ab77,0x35942b77ab773594,0xb594ab772b77b594,0x348932c4b5992a81,0xb2c43489aa81b599,0xb2c43489aa81b599,0xb489b2c43599aa81
.quad 0xb51530f63515b0f6,0xb51530f63515b0f6,0xb0f6b51530f63515,0xb0f6b51530f63515,0x1fc6b5a8b41633d4,0xb5a89fc633d43416,0x35a81fc6b3d4b416,0x1fc6b5a8b41633d4,0x34f931653165b4f9,0xb4f9b165b16534f9,0xb16534f934f93165,0x3165b4f9b4f9b165,0xb4ad325fac36358f,0xb25fb4adb58fac36,0xb25fb4adb58fac36,0x34adb25f2c36b58f
.quad 0,0,0,0,0,0,0,0,0,0,0,0,0,0,0,0
.quad 0,0,0,0,0,0,0,0,0,0,0,0,0,0,0,0
.quad 0,0,0,0,0,0,0,0,0,0,0,0,0,0,0,0
.quad 0,0,0,0,0,0,0,0,0,0,0,0,0,0,0,0
.quad 0x3400340034003400,0x3400340034003400,0xb4003400b4003400,0xb4003400b4003400,0x3562aef7350a3126,0xaef7b5623126b50a,0x2ef73562b126350a,0x3562aef7350a3126,0x2b30b59635962b30,0xab303596b596ab30,0x35962b30ab303596,0xb596ab302b30b596,0xb490b2af3597aaea,0x32afb4902aea3597,0x32afb4902aea3597,0x349032afb5972aea
.quad 0xb50e3116350eb116,0xb50e3116350eb116,0xb116b50e3116350e,0xb116b50e3116350e,0x987135a83406b3f3,0x35a81871b3f3b406,0xb5a8987133f33406,0x987135a83406b3f3,0x350531363136b505,0xb505b136b1363505,0xb136350535053136,0x3136b505b505b136,0x349bb2922b77b594,0x3292349b35942b77,0x3292349b35942b77,0xb49b3292ab773594
.quad 0x3400340034003400,0x3400340034003400,0xb4003400b4003400,0xb4003400b4003400,0xb5622ef7b50ab126,0x2ef73562b126350a,0xaef7b5623126b50a,0xb5622ef7b50ab126,0x2b30b59635962b30,0xab303596b596ab30,0x35962b30ab303596,0xb596ab302b30b596,0x349032afb5972aea,0xb2af3490aaeab597,0xb2af3490aaeab597,0xb490b2af3597aaea
.quad 0xb50e3116350eb116,0xb50e3116350eb116,0xb116b50e3116350e,0xb116b50e3116350e,0x1871b5a8b40633f3,0xb5a8987133f33406,0x35a81871b3f3b406,0x1871b5a8b40633f3,0x350531363136b505,0xb505b136b1363505,0xb136350535053136,0x3136b505b505b136,0xb49b3292ab773594,0xb292b49bb594ab77,0xb292b49bb594ab77,0x349bb2922b77b594
.quad 0,0,0,0,0,0,0,0,0,0,0,0,0,0,0,0
.quad 0,0,0,0,0,0,0,0,0,0,0,0,0,0,0,0
.quad 0,0,0,0,0,0,0,0,0,0,0,0,0,0,0,0
.quad 0,0,0,0,0,0,0,0,0,0,0,0,0,0,0,0
.quad 0x3400340034003400,0x3400340034003400,0xb4003400b4003400,0xb4003400b4003400,0x3560af08350c311e,0xaf08b560311eb50c,0x2f083560b11e350c,0x3560af08350c311e,0x2aeab59735972aea,0xaaea3597b597aaea,0x35972aeaaaea3597,0xb597aaea2aeab597,0xb498b2993595ab53,0x3299b4982b533595,0x3299b4982b533595,0x34983299b5952b53
.quad 0xb50531363505b136,0xb50531363505b136,0xb136b50531363505,0xb136b50531363505,0x1aaa35a833edb409,0x35a89aaab409b3ed,0xb5a81aaa340933ed,0x1aaa35a833edb409,0x351131063106b511,0xb511b106b1063511,0xb106351135113106,0x3106b511b511b106,0x3489b2c42a81b599,0x32c4348935992a81,0x32c4348935992a81,0xb48932c4aa813599
.quad 0x3400340034003400,0x3400340034003400,0xb4003400b4003400,0xb4003400b4003400,0xb5602f08b50cb11e,0x2f083560b11e350c,0xaf08b560311eb50c,0xb5602f08b50cb11e,0x2aeab59735972aea,0xaaea3597b597aaea,0x35972aeaaaea3597,0xb597aaea2aeab597,0x34983299b5952b53,0xb2993498ab53b595,0xb2993498ab53b595,0xb498b2993595ab53
.quad 0xb50531363505b136,0xb50531363505b136,0xb136b50531363505,0xb136b50531363505,0x9aaab5a8b3ed3409,0xb5a81aaa340933ed,0x35a89aaab409b3ed,0x9aaab5a8b3ed3409,0x351131063106b511,0xb511b106b1063511,0xb106351135113106,0x3106b511b511b106,0xb48932c4aa813599,0xb2c4b489b599aa81,0xb2c4b489b599aa81,0x3489b2c42a81b599
.quad 0,0,0,0,0,0,0,0,0,0,0,0,0,0,0,0
.quad 0,0,0,0,0,0,0,0,0,0,0,0,0,0,0,0
.quad 0,0,0,0,0,0,0,0,0,0,0,0,0,0,0,0
.quad 0,0,0,0,0,0,0,0,0,0,0,0,0,0,0,0
.quad 0x3400340034003400,0x3400340034003400,0xb4003400b4003400,0xb4003400b4003400,0x355faf19350e3116,0xaf19b55f3116b50e,0x2f19355fb116350e,0x355faf19350e3116,0x2aa4b59835982aa4,0xaaa43598b598aaa4,0x35982aa4aaa43598,0xb598aaa42aa4b598,0xb4a0b2843593abbd,0x3284b4a02bbd3593,0x3284b4a02bbd3593,0x34a03284b5932bbd
.quad 0xb4fd315534fdb155,0xb4fd315534fdb155,0xb155b4fd315534fd,0xb155b4fd315534fd,0x207135a833cdb419,0x35a8a071b419b3cd,0xb5a82071341933cd,0x207135a833cdb419,0x351d30d630d6b51d,0xb51db0d6b0d6351d,0xb0d6351d351d30d6,0x30d6b51db51db0d6,0x3476b2f6298ab59d,0x32f63476359d298a,0x32f63476359d298a,0xb47632f6a98a359d
.quad 0x3400340034003400,0x3400340034003400,0xb4003400b4003400,0xb4003400b4003400,0xb55f2f19b50eb116,0x2f19355fb116350e,0xaf19b55f3116b50e,0xb55f2f19b50eb116,0x2aa4b59835982aa4,0xaaa43598b598aaa4,0x35982aa4aaa43598,0xb598aaa42aa4b598,0x34a03284b5932bbd,0xb28434a0abbdb593,0xb28434a0abbdb593,0xb4a0b2843593abbd
.quad 0xb4fd315534fdb155,0xb4fd315534fdb155,0xb155b4fd315534fd,0xb155b4fd315534fd,0xa071b5a8b3cd3419,0xb5a82071341933cd,0x35a8a071b419b3cd,0xa071b5a8b3cd3419,0x351d30d630d6b51d,0xb51db0d6b0d6351d,0xb0d6351d351d30d6,0x30d6b51db51db0d6,0xb47632f6a98a359d,0xb2f6b476b59da98a,0xb2f6b476b59da98a,0x3476b2f6298ab59d
.quad 0,0,0,0,0,0,0,0,0,0,0,0,0,0,0,0
.quad 0,0,0,0,0,0,0,0,0,0,0,0,0,0,0,0
.quad 0,0,0,0,0,0,0,0,0,0,0,0,0,0,0,0
.quad 0,0,0,0,0,0,0,0,0,0,0,0,0,0,0,0
.quad 0x3400340034003400,0x3400340034003400,0xb4003400b4003400,0xb4003400b4003400,0x355eaf2a3510310e,0xaf2ab55e310eb510,0x2f2a355eb10e3510,0x355eaf2a3510310e,0x2a5eb59a359a2a5e,0xaa5e359ab59aaa5e,0x359a2a5eaa5e359a,0xb59aaa5e2a5eb59a,0xb4a8b26e3590ac13,0x326eb4a82c133590,0x326eb4a82c133590,0x34a8326eb5902c13
.quad 0xb4f5317534f5b175,0xb4f5317534f5b175,0xb175b4f5317534f5,0xb175b4f5317534f5,0x233835a733adb428,0x35a7a338b428b3ad,0xb5a72338342833ad,0x233835a733adb428,0x352830a630a6b528,0xb528b0a6b0a63528,0xb0a63528352830a6,0x30a6b528b528b0a6,0x3462b3272893b5a1,0x3327346235a12893,0x3327346235a12893,0xb4623327a89335a1
.quad 0x3400340034003400,0x3400340034003400,0xb4003400b4003400,0xb4003400b4003400,0xb55e2f2ab510b10e,0x2f2a355eb10e3510,0xaf2ab55e310eb510,0xb55e2f2ab510b10e,0x2a5eb59a359a2a5e,0xaa5e359ab59aaa5e,0x359a2a5eaa5e359a,0xb59aaa5e2a5eb59a,0x34a8326eb5902c13,0xb26e34a8ac13b590,0xb26e34a8ac13b590,0xb4a8b26e3590ac13
.quad 0xb4f5317534f5b175,0xb4f5317534f5b175,0xb175b4f5317534f5,0xb175b4f5317534f5,0xa338b5a7b3ad3428,0xb5a72338342833ad,0x35a7a338b428b3ad,0xa338b5a7b3ad3428,0x352830a630a6b528,0xb528b0a6b0a63528,0xb0a63528352830a6,0x30a6b528b528b0a6,0xb4623327a89335a1,0xb327b462b5a1a893,0xb327b462b5a1a893,0x3462b3272893b5a1
.quad 0,0,0,0,0,0,0,0,0,0,0,0,0,0,0,0
.quad 0,0,0,0,0,0,0,0,0,0,0,0,0,0,0,0
.quad 0,0,0,0,0,0,0,0,0,0,0,0,0,0,0,0
.quad 0,0,0,0,0,0,0,0,0,0,0,0,0,0,0,0
.quad 0x3400340034003400,0x3400340034003400,0xb4003400b4003400,0xb4003400b4003400,0x355caf3b35113106,0xaf3bb55c3106b511,0x2f3b355cb1063511,0x355caf3b35113106,0x2a17b59b359b2a17,0xaa17359bb59baa17,0x359b2a17aa17359b,0xb59baa172a17b59b,0xb4afb258358eac47,0x3258b4af2c47358e,0x3258b4af2c47358e,0x34af3258b58e2c47
.quad 0xb4ec319434ecb194,0xb4ec319434ecb194,0xb194b4ec319434ec,0xb194b4ec319434ec,0x24ff35a6338cb437,0x35a6a4ffb437b38c,0xb5a624ff3437338c,0x24ff35a6338cb437,0x353330753075b533,0xb533b075b0753533,0xb075353335333075,0x3075b533b533b075,0x344eb3562736b5a4,0x3356344e35a42736,0x3356344e35a42736,0xb44e3356a73635a4
.quad 0x3400340034003400,0x3400340034003400,0xb4003400b4003400,0xb4003400b4003400,0xb55c2f3bb511b106,0x2f3b355cb1063511,0xaf3bb55c3106b511,0xb55c2f3bb511b106,0x2a17b59b359b2a17,0xaa17359bb59baa17,0x359b2a17aa17359b,0xb59baa172a17b59b,0x34af3258b58e2c47,0xb25834afac47b58e,0xb25834afac47b58e,0xb4afb258358eac47
.quad 0xb4ec319434ecb194,0xb4ec319434ecb194,0xb194b4ec319434ec,0xb194b4ec319434ec,0xa4ffb5a6b38c3437,0xb5a624ff3437338c,0x35a6a4ffb437b38c,0xa4ffb5a6b38c3437,0x353330753075b533,0xb533b075b0753533,0xb075353335333075,0x3075b533b533b075,0xb44e3356a73635a4,0xb356b44eb5a4a736,0xb356b44eb5a4a736,0x344eb3562736b5a4
.quad 0,0,0,0,0,0,0,0,0,0,0,0,0,0,0,0
.quad 0,0,0,0,0,0,0,0,0,0,0,0,0,0,0,0
.quad 0,0,0,0,0,0,0,0,0,0,0,0,0,0,0,0
.quad 0,0,0,0,0,0,0,0,0,0,0,0,0,0,0,0
.quad 0x3400340034003400,0x3400340034003400,0xb4003400b4003400,0xb4003400b4003400,0x355baf4c351330fe,0xaf4cb55b30feb513,0x2f4c355bb0fe3513,0x355baf4c351330fe,0x29d1b59c359c29d1,0xa9d1359cb59ca9d1,0x359c29d1a9d1359c,0xb59ca9d129d1b59c,0xb4b7b242358bac7c,0x3242b4b72c7c358b,0x3242b4b72c7c358b,0x34b73242b58b2c7c
.quad 0xb4e331b234e3b1b2,0xb4e331b234e3b1b2,0xb1b2b4e331b234e3,0xb1b2b4e331b234e3,0x266235a5336bb446,0x35a5a662b446b36b,0xb5a526623446336b,0x266235a5336bb446,0x353d30443044b53d,0xb53db044b044353d,0xb044353d353d3044,0x3044b53db53db044,0x343ab3852546b5a6,0x3385343a35a62546,0x3385343a35a62546,0xb43a3385a54635a6
.quad 0x3400340034003400,0x3400340034003400,0xb4003400b4003400,0xb4003400b4003400,0xb55b2f4cb513b0fe,0x2f4c355bb0fe3513,0xaf4cb55b30feb513,0xb55b2f4cb513b0fe,0x29d1b59c359c29d1,0xa9d1359cb59ca9d1,0x359c29d1a9d1359c,0xb59ca9d129d1b59c,0x34b73242b58b2c7c,0xb24234b7ac7cb58b,0xb24234b7ac7cb58b,0xb4b7b242358bac7c
.quad 0xb4e331b234e3b1b2,0xb4e331b234e3b1b2,0xb1b2b4e331b234e3,0xb1b2b4e331b234e3,0xa662b5a5b36b3446,0xb5a526623446336b,0x35a5a662b446b36b,0xa662b5a5b36b3446,0x353d30443044b53d,0xb53db044b044353d,0xb044353d353d3044,0x3044b53db53db044,0xb43a3385a54635a6,0xb385b43ab5a6a546,0xb385b43ab5a6a546,0x343ab3852546b5a6
.quad 0,0,0,0,0,0,0,0,0,0,0,0,0,0,0,0
.quad 0,0,0,0,0,0,0,0,0,0,0,0,0,0,0,0
.quad 0,0,0,0,0,0,0,0,0,0,0,0,0,0,0,0
.quad 0,0,0,0,0,0,0,0,0,0,0,0,0,0,0,0
.quad 0x3400340034003400,0x3400340034003400,0xb4003400b4003400,0xb4003400b4003400,0x3559af5c351530f6,0xaf5cb55930f6b515,0x2f5c3559b0f63515,0x3559af5c351530f6,0x298ab59d359d298a,0xa98a359db59da98a,0x359d298aa98a359d,0xb59da98a298ab59d,0xb4beb22b3589acb0,0x322bb4be2cb03589,0x322bb4be2cb03589,0x34be322bb5892cb0
.quad 0xb4da31d134dab1d1,0xb4da31d134dab1d1,0xb1d1b4da31d134da,0xb1d1b4da31d134da,0x27c435a33349b454,0x35a3a7c4b454b349,0xb5a327c434543349,0x27c435a33349b454,0x354730123012b547,0xb547b012b0123547,0xb012354735473012,0x3012b547b547b012,0x3425b3b322aab5a7,0x33b3342535a722aa,0x33b3342535a722aa,0xb42533b3a2aa35a7
.quad 0x3400340034003400,0x3400340034003400,0xb4003400b4003400,0xb4003400b4003400,0xb5592f5cb515b0f6,0x2f5c3559b0f63515,0xaf5cb55930f6b515,0xb5592f5cb515b0f6,0x298ab59d359d298a,0xa98a359db59da98a,0x359d298aa98a359d,0xb59da98a298ab59d,0x34be322bb5892cb0,0xb22b34beacb0b589,0xb22b34beacb0b589,0xb4beb22b3589acb0
.quad 0xb4da31d134dab1d1,0xb4da31d134dab1d1,0xb1d1b4da31d134da,0xb1d1b4da31d134da,0xa7c4b5a3b3493454,0xb5a327c434543349,0x35a3a7c4b454b349,0xa7c4b5a3b3493454,0x354730123012b547,0xb547b012b0123547,0xb012354735473012,0x3012b547b547b012,0xb42533b3a2aa35a7,0xb3b3b425b5a7a2aa,0xb3b3b425b5a7a2aa,0x3425b3b322aab5a7
.quad 0,0,0,0,0,0,0,0,0,0,0,0,0,0,0,0
.quad 0,0,0,0,0,0,0,0,0,0,0,0,0,0,0,0
.quad 0,0,0,0,0,0,0,0,0,0,0,0,0,0,0,0
.quad 0,0,0,0,0,0,0,0,0,0,0,0,0,0,0,0
.quad 0x3400340034003400,0x3400340034003400,0xb4003400b4003400,0xb4003400b4003400,0x3558af6d351730ee,0xaf6db55830eeb517,0x2f6d3558b0ee3517,0x3558af6d351730ee,0x2944b59e359e2944,0xa944359eb59ea944,0x359e2944a944359e,0xb59ea9442944b59e,0xb4c5b2153586ace4,0x3215b4c52ce43586,0x3215b4c52ce43586,0x34c53215b5862ce4
.quad 0xb4d131ef34d1b1ef,0xb4d131ef34d1b1ef,0xb1efb4d131ef34d1,0xb1efb4d131ef34d1,0x289335a13327b462,0x35a1a893b462b327,0xb5a1289334623327,0x289335a13327b462,0x35502fc12fc1b550,0xb550afc1afc13550,0xafc1355035502fc1,0x2fc1b550b550afc1,0x3410b3e01d8eb5a8,0x33e0341035a81d8e,0x33e0341035a81d8e,0xb41033e09d8e35a8
.quad 0x3400340034003400,0x3400340034003400,0xb4003400b4003400,0xb4003400b4003400,0xb5582f6db517b0ee,0x2f6d3558b0ee3517,0xaf6db55830eeb517,0xb5582f6db517b0ee,0x2944b59e359e2944,0xa944359eb59ea944,0x359e2944a944359e,0xb59ea9442944b59e,0x34c53215b5862ce4,0xb21534c5ace4b586,0xb21534c5ace4b586,0xb4c5b2153586ace4
.quad 0xb4d131ef34d1b1ef,0xb4d131ef34d1b1ef,0xb1efb4d131ef34d1,0xb1efb4d131ef34d1,0xa893b5a1b3273462,0xb5a1289334623327,0x35a1a893b462b327,0xa893b5a1b3273462,0x35502fc12fc1b550,0xb550afc1afc13550,0xafc1355035502fc1,0x2fc1b550b550afc1,0xb41033e09d8e35a8,0xb3e0b410b5a89d8e,0xb3e0b410b5a89d8e,0x3410b3e01d8eb5a8
.quad 0,0,0,0,0,0,0,0,0,0,0,0,0,0,0,0
.quad 0,0,0,0,0,0,0,0,0,0,0,0,0,0,0,0
.quad 0,0,0,0,0,0,0,0,0,0,0,0,0,0,0,0
.quad 0,0,0,0,0,0,0,0,0,0,0,0,0,0,0,0
.quad 0x3400340034003400,0x3400340034003400,0xb4003400b4003400,0xb4003400b4003400,0x3556af7e351930e6,0xaf7eb55630e6b519,0x2f7e3556b0e63519,0x3556af7e351930e6,0x28fdb59f359f28fd,0xa8fd359fb59fa8fd,0x359f28fda8fd359f,0xb59fa8fd28fdb59f,0xb4ccb1fe3583ad18,0x31feb4cc2d183583,0x31feb4cc2d183583,0x34cc31feb5832d18
.quad 0xb4c7320e34c7b20e,0xb4c7320e34c7b20e,0xb20eb4c7320e34c7,0xb20eb4c7320e34c7,0x2944359e3304b470,0x359ea944b470b304,0xb59e294434703304,0x2944359e3304b470,0x35592f5c2f5cb559,0xb559af5caf5c3559,0xaf5c355935592f5c,0x2f5cb559b559af5c,0x33f3b4069871b5a8,0x340633f335a89871,0x340633f335a89871,0xb3f33406187135a8
.quad 0x3400340034003400,0x3400340034003400,0xb4003400b4003400,0xb4003400b4003400,0xb5562f7eb519b0e6,0x2f7e3556b0e63519,0xaf7eb55630e6b519,0xb5562f7eb519b0e6,0x28fdb59f359f28fd,0xa8fd359fb59fa8fd,0x359f28fda8fd359f,0xb59fa8fd28fdb59f,0x34cc31feb5832d18,0xb1fe34ccad18b583,0xb1fe34ccad18b583,0xb4ccb1fe3583ad18
.quad 0xb4c7320e34c7b20e,0xb4c7320e34c7b20e,0xb20eb4c7320e34c7,0xb20eb4c7320e34c7,0xa944b59eb3043470,0xb59e294434703304,0x359ea944b470b304,0xa944b59eb3043470,0x35592f5c2f5cb559,0xb559af5caf5c3559,0xaf5c355935592f5c,0x2f5cb559b559af5c,0xb3f33406187135a8,0xb406b3f3b5a81871,0xb406b3f3b5a81871,0x33f3b4069871b5a8
.quad 0,0,0,0,0,0,0,0,0,0,0,0,0,0,0,0
.quad 0,0,0,0,0,0,0,0,0,0,0,0,0,0,0,0
.quad 0,0,0,0,0,0,0,0,0,0,0,0,0,0,0,0
.quad 0,0,0,0,0,0,0,0,0,0,0,0,0,0,0,0
.quad 0x3400340034003400,0x3400340034003400,0xb4003400b4003400,0xb4003400b4003400,0x3555af8f351b30de,0xaf8fb55530deb51b,0x2f8f3555b0de351b,0x3555af8f351b30de,0x28b6b5a035a028b6,0xa8b635a0b5a0a8b6,0x35a028b6a8b635a0,0xb5a0a8b628b6b5a0,0xb4d3b1e83580ad4c,0x31e8b4d32d4c3580,0x31e8b4d32d4c3580,0x34d331e8b5802d4c
.quad 0xb4be322b34beb22b,0xb4be322b34beb22b,0xb22bb4be322b34be,0xb22bb4be322b34be,0x29f4359c32e1b47e,0x359ca9f4b47eb2e1,0xb59c29f4347e32e1,0x29f4359c32e1b47e,0x35622ef72ef7b562,0xb562aef7aef73562,0xaef7356235622ef7,0x2ef7b562b562aef7,0x33c7b41ca0ffb5a8,0x341c33c735a8a0ff,0x341c33c735a8a0ff,0xb3c7341c20ff35a8
.quad 0x3400340034003400,0x3400340034003400,0xb4003400b4003400,0xb4003400b4003400,0xb5552f8fb51bb0de,0x2f8f3555b0de351b,0xaf8fb55530deb51b,0xb5552f8fb51bb0de,0x28b6b5a035a028b6,0xa8b635a0b5a0a8b6,0x35a028b6a8b635a0,0xb5a0a8b628b6b5a0,0x34d331e8b5802d4c,0xb1e834d3ad4cb580,0xb1e834d3ad4cb580,0xb4d3b1e83580ad4c
.quad 0xb4be322b34beb22b,0xb4be322b34beb22b,0xb22bb4be322b34be,0xb22bb4be322b34be,0xa9f4b59cb2e1347e,0xb59c29f4347e32e1,0x359ca9f4b47eb2e1,0xa9f4b59cb2e1347e,0x35622ef72ef7b562,0xb562aef7aef73562,0xaef7356235622ef7,0x2ef7b562b562aef7,0xb3c7341c20ff35a8,0xb41cb3c7b5a820ff,0xb41cb3c7b5a820ff,0x33c7b41ca0ffb5a8
.quad 0,0,0,0,0,0,0,0,0,0,0,0,0,0,0,0
.quad 0,0,0,0,0,0,0,0,0,0,0,0,0,0,0,0
.quad 0,0,0,0,0,0,0,0,0,0,0,0,0,0,0,0
.quad 0,0,0,0,0,0,0,0,0,0,0,0,0,0,0,0
.quad 0x3400340034003400,0x3400340034003400,0xb4003400b4003400,0xb4003400b4003400,0x3554af9f351d30d6,0xaf9fb55430d6b51d,0x2f9f3554b0d6351d,0x3554af9f351d30d6,0x2870b5a135a12870,0xa87035a1b5a1a870,0x35a12870a87035a1,0xb5a1a8702870b5a1,0xb4dab1d1357dad7f,0x31d1b4da2d7f357d,0x31d1b4da2d7f357d,0x34da31d1b57d2d7f
.quad 0xb4b4324934b4b249,0xb4b4324934b4b249,0xb249b4b4324934b4,0xb249b4b4324934b4,0x2aa4359832bdb48b,0x3598aaa4b48bb2bd,0xb5982aa4348b32bd,0x2aa4359832bdb48b,0x356a2e922e92b56a,0xb56aae92ae92356a,0xae92356a356a2e92,0x2e92b56ab56aae92,0x3399b431a471b5a6,0x3431339935a6a471,0x3431339935a6a471,0xb3993431247135a6
.quad 0x3400340034003400,0x3400340034003400,0xb4003400b4003400,0xb4003400b4003400,0xb5542f9fb51db0d6,0x2f9f3554b0d6351d,0xaf9fb55430d6b51d,0xb5542f9fb51db0d6,0x2870b5a135a12870,0xa87035a1b5a1a870,0x35a12870a87035a1,0xb5a1a8702870b5a1,0x34da31d1b57d2d7f,0xb1d134daad7fb57d,0xb1d134daad7fb57d,0xb4dab1d1357dad7f
.quad 0xb4b4324934b4b249,0xb4b4324934b4b249,0xb249b4b4324934b4,0xb249b4b4324934b4,0xaaa4b598b2bd348b,0xb5982aa4348b32bd,0x3598aaa4b48bb2bd,0xaaa4b598b2bd348b,0x356a2e922e92b56a,0xb56aae92ae92356a,0xae92356a356a2e92,0x2e92b56ab56aae92,0xb3993431247135a6,0xb431b399b5a62471,0xb431b399b5a62471,0x3399b431a471b5a6
.quad 0,0,0,0,0,0,0,0,0,0,0,0,0,0,0,0
.quad 0,0,0,0,0,0,0,0,0,0,0,0,0,0,0,0
.quad 0,0,0,0,0,0,0,0,0,0,0,0,0,0,0,0
.quad 0,0,0,0,0,0,0,0,0,0,0,0,0,0,0,0
.quad 0x3400340034003400,0x3400340034003400,0xb4003400b4003400,0xb4003400b4003400,0x3552afb0351f30ce,0xafb0b55230ceb51f,0x2fb03552b0ce351f,0x3552afb0351f30ce,0x2829b5a235a22829,0xa82935a2b5a2a829,0x35a22829a82935a2,0xb5a2a8292829b5a2,0xb4e1b1ba3579adb3,0x31bab4e12db33579,0x31bab4e12db33579,0x34e131bab5792db3
.quad 0xb4aa326734aab267,0xb4aa326734aab267,0xb267b4aa326734aa,0xb267b4aa326734aa,0x2b5335953299b498,0x3595ab53b498b299,0xb5952b5334983299,0x2b5335953299b498,0x35712e2b2e2bb571,0xb571ae2bae2b3571,0xae2b357135712e2b,0x2e2bb571b571ae2b,0x336bb446a662b5a5,0x3446336b35a5a662,0x3446336b35a5a662,0xb36b3446266235a5
.quad 0x3400340034003400,0x3400340034003400,0xb4003400b4003400,0xb4003400b4003400,0xb5522fb0b51fb0ce,0x2fb03552b0ce351f,0xafb0b55230ceb51f,0xb5522fb0b51fb0ce,0x2829b5a235a22829,0xa82935a2b5a2a829,0x35a22829a82935a2,0xb5a2a8292829b5a2,0x34e131bab5792db3,0xb1ba34e1adb3b579,0xb1ba34e1adb3b579,0xb4e1b1ba3579adb3
.quad 0xb4aa326734aab267,0xb4aa326734aab267,0xb267b4aa326734aa,0xb267b4aa326734aa,0xab53b595b2993498,0xb5952b5334983299,0x3595ab53b498b299,0xab53b595b2993498,0x35712e2b2e2bb571,0xb571ae2bae2b3571,0xae2b357135712e2b,0x2e2bb571b571ae2b,0xb36b3446266235a5,0xb446b36bb5a52662,0xb446b36bb5a52662,0x336bb446a662b5a5
.quad 0,0,0,0,0,0,0,0,0,0,0,0,0,0,0,0
.quad 0,0,0,0,0,0,0,0,0,0,0,0,0,0,0,0
.quad 0,0,0,0,0,0,0,0,0,0,0,0,0,0,0,0
.quad 0,0,0,0,0,0,0,0,0,0,0,0,0,0,0,0
.quad 0x3400340034003400,0x3400340034003400,0xb4003400b4003400,0xb4003400b4003400,0x3550afc1352130c6,0xafc1b55030c6b521,0x2fc13550b0c63521,0x3550afc1352130c6,0x27c4b5a335a327c4,0xa7c435a3b5a3a7c4,0x35a327c4a7c435a3,0xb5a3a7c427c4b5a3,0xb4e8b1a33576ade7,0x31a3b4e82de73576,0x31a3b4e82de73576,0x34e831a3b5762de7
.quad 0xb4a0328434a0b284,0xb4a0328434a0b284,0xb284b4a0328434a0,0xb284b4a0328434a0,0x2c0135913275b4a5,0x3591ac01b4a5b275,0xb5912c0134a53275,0x2c0135913275b4a5,0x35782dc42dc4b578,0xb578adc4adc43578,0xadc4357835782dc4,0x2dc4b578b578adc4,0x333bb45aa829b5a2,0x345a333b35a2a829,0x345a333b35a2a829,0xb33b345a282935a2
.quad 0x3400340034003400,0x3400340034003400,0xb4003400b4003400,0xb4003400b4003400,0xb5502fc1b521b0c6,0x2fc13550b0c63521,0xafc1b55030c6b521,0xb5502fc1b521b0c6,0x27c4b5a335a327c4,0xa7c435a3b5a3a7c4,0x35a327c4a7c435a3,0xb5a3a7c427c4b5a3,0x34e831a3b5762de7,0xb1a334e8ade7b576,0xb1a334e8ade7b576,0xb4e8b1a33576ade7
.quad 0xb4a0328434a0b284,0xb4a0328434a0b284,0xb284b4a0328434a0,0xb284b4a0328434a0,0xac01b591b27534a5,0xb5912c0134a53275,0x3591ac01b4a5b275,0xac01b591b27534a5,0x35782dc42dc4b578,0xb578adc4adc43578,0xadc4357835782dc4,0x2dc4b578b578adc4,0xb33b345a282935a2,0xb45ab33bb5a22829,0xb45ab33bb5a22829,0x333bb45aa829b5a2
.quad 0,0,0,0,0,0,0,0,0,0,0,0,0,0,0,0
.quad 0,0,0,0,0,0,0,0,0,0,0,0,0,0,0,0
.quad 0,0,0,0,0,0,0,0,0,0,0,0,0,0,0,0
.quad 0,0,0,0,0,0,0,0,0,0,0,0,0,0,0,0
.quad 0x3400340034003400,0x3400340034003400,0xb4003400b4003400,0xb4003400b4003400,0x354fafd2352330be,0xafd2b54f30beb523,0x2fd2354fb0be3523,0x354fafd2352330be,0x2736b5a435a42736,0xa73635a4b5a4a736,0x35a42736a73635a4,0xb5a4a7362736b5a4,0xb4eeb18c3573ae1a,0x318cb4ee2e1a3573,0x318cb4ee2e1a3573,0x34ee318cb5732e1a
.quad 0xb49632a13496b2a1,0xb49632a13496b2a1,0xb2a1b49632a13496,0xb2a1b49632a13496,0x2c59358d3250b4b2,0x358dac59b4b2b250,0xb58d2c5934b23250,0x2c59358d3250b4b2,0x357f2d5d2d5db57f,0xb57fad5dad5d357f,0xad5d357f357f2d5d,0x2d5db57fb57fad5d,0x330bb46da920b59f,0x346d330b359fa920,0x346d330b359fa920,0xb30b346d2920359f
.quad 0x3400340034003400,0x3400340034003400,0xb4003400b4003400,0xb4003400b4003400,0xb54f2fd2b523b0be,0x2fd2354fb0be3523,0xafd2b54f30beb523,0xb54f2fd2b523b0be,0x2736b5a435a42736,0xa73635a4b5a4a736,0x35a42736a73635a4,0xb5a4a7362736b5a4,0x34ee318cb5732e1a,0xb18c34eeae1ab573,0xb18c34eeae1ab573,0xb4eeb18c3573ae1a
.quad 0xb49632a13496b2a1,0xb49632a13496b2a1,0xb2a1b49632a13496,0xb2a1b49632a13496,0xac59b58db25034b2,0xb58d2c5934b23250,0x358dac59b4b2b250,0xac59b58db25034b2,0x357f2d5d2d5db57f,0xb57fad5dad5d357f,0xad5d357f357f2d5d,0x2d5db57fb57fad5d,0xb30b346d2920359f,0xb46db30bb59f2920,0xb46db30bb59f2920,0x330bb46da920b59f
.quad 0,0,0,0,0,0,0,0,0,0,0,0,0,0,0,0
.quad 0,0,0,0,0,0,0,0,0,0,0,0,0,0,0,0
.quad 0,0,0,0,0,0,0,0,0,0,0,0,0,0,0,0
.quad 0,0,0,0,0,0,0,0,0,0,0,0,0,0,0,0
.quad 0x3400340034003400,0x3400340034003400,0xb4003400b4003400,0xb4003400b4003400,0x354dafe2352530b6,0xafe2b54d30b6b525,0x2fe2354db0b63525,0x354dafe2352530b6,0x26a9b5a435a426a9,0xa6a935a4b5a4a6a9,0x35a426a9a6a935a4,0xb5a4a6a926a9b5a4,0xb4f5b175356fae4d,0x3175b4f52e4d356f,0x3175b4f52e4d356f,0x34f53175b56f2e4d
.quad 0xb48b32bd348bb2bd,0xb48b32bd348bb2bd,0xb2bdb48b32bd348b,0xb2bdb48b32bd348b,0x2cb03589322bb4be,0x3589acb0b4beb22b,0xb5892cb034be322b,0x2cb03589322bb4be,0x35852cf52cf5b585,0xb585acf5acf53585,0xacf5358535852cf5,0x2cf5b585b585acf5,0x32dab480aa17b59b,0x348032da359baa17,0x348032da359baa17,0xb2da34802a17359b
.quad 0x3400340034003400,0x3400340034003400,0xb4003400b4003400,0xb4003400b4003400,0xb54d2fe2b525b0b6,0x2fe2354db0b63525,0xafe2b54d30b6b525,0xb54d2fe2b525b0b6,0x26a9b5a435a426a9,0xa6a935a4b5a4a6a9,0x35a426a9a6a935a4,0xb5a4a6a926a9b5a4,0x34f53175b56f2e4d,0xb17534f5ae4db56f,0xb17534f5ae4db56f,0xb4f5b175356fae4d
.quad 0xb48b32bd348bb2bd,0xb48b32bd348bb2bd,0xb2bdb48b32bd348b,0xb2bdb48b32bd348b,0xacb0b589b22b34be,0xb5892cb034be322b,0x3589acb0b4beb22b,0xacb0b589b22b34be,0x35852cf52cf5b585,0xb585acf5acf53585,0xacf5358535852cf5,0x2cf5b585b585acf5,0xb2da34802a17359b,0xb480b2dab59b2a17,0xb480b2dab59b2a17,0x32dab480aa17b59b
.quad 0,0,0,0,0,0,0,0,0,0,0,0,0,0,0,0
.quad 0,0,0,0,0,0,0,0,0,0,0,0,0,0,0,0
.quad 0,0,0,0,0,0,0,0,0,0,0,0,0,0,0,0
.quad 0,0,0,0,0,0,0,0,0,0,0,0,0,0,0,0
.quad 0x3400340034003400,0x3400340034003400,0xb4003400b4003400,0xb4003400b4003400,0x354caff3352630ae,0xaff3b54c30aeb526,0x2ff3354cb0ae3526,0x354caff3352630ae,0x261bb5a535a5261b,0xa61b35a5b5a5a61b,0x35a5261ba61b35a5,0xb5a5a61b261bb5a5,0xb4fbb15d356bae80,0x315db4fb2e80356b,0x315db4fb2e80356b,0x34fb315db56b2e80
.quad 0xb48032da3480b2da,0xb48032da3480b2da,0xb2dab48032da3480,0xb2dab48032da3480,0x2d0735843206b4ca,0x3584ad07b4cab206,0xb5842d0734ca3206,0x2d0735843206b4ca,0x358b2c8d2c8db58b,0xb58bac8dac8d358b,0xac8d358b358b2c8d,0x2c8db58bb58bac8d,0x32a8b493ab0db596,0x349332a83596ab0d,0x349332a83596ab0d,0xb2a834932b0d3596
.quad 0x3400340034003400,0x3400340034003400,0xb4003400b4003400,0xb4003400b4003400,0xb54c2ff3b526b0ae,0x2ff3354cb0ae3526,0xaff3b54c30aeb526,0xb54c2ff3b526b0ae,0x261bb5a535a5261b,0xa61b35a5b5a5a61b,0x35a5261ba61b35a5,0xb5a5a61b261bb5a5,0x34fb315db56b2e80,0xb15d34fbae80b56b,0xb15d34fbae80b56b,0xb4fbb15d356bae80
.quad 0xb48032da3480b2da,0xb48032da3480b2da,0xb2dab48032da3480,0xb2dab48032da3480,0xad07b584b20634ca,0xb5842d0734ca3206,0x3584ad07b4cab206,0xad07b584b20634ca,0x358b2c8d2c8db58b,0xb58bac8dac8d358b,0xac8d358b358b2c8d,0x2c8db58bb58bac8d,0xb2a834932b0d3596,0xb493b2a8b5962b0d,0xb493b2a8b5962b0d,0x32a8b493ab0db596
.quad 0,0,0,0,0,0,0,0,0,0,0,0,0,0,0,0
.quad 0,0,0,0,0,0,0,0,0,0,0,0,0,0,0,0
.quad 0,0,0,0,0,0,0,0,0,0,0,0,0,0,0,0
.quad 0,0,0,0,0,0,0,0,0,0,0,0,0,0,0,0
.quad 0x3400340034003400,0x3400340034003400,0xb4003400b4003400,0xb4003400b4003400,0x354ab002352830a6,0xb002b54a30a6b528,0x3002354ab0a63528,0x354ab002352830a6,0x258db5a535a5258d,0xa58d35a5b5a5a58d,0x35a5258da58d35a5,0xb5a5a58d258db5a5,0xb501b1463567aeb3,0x3146b5012eb33567,0x3146b5012eb33567,0x35013146b5672eb3
.quad 0xb47632f63476b2f6,0xb47632f63476b2f6,0xb2f6b47632f63476,0xb2f6b47632f63476,0x2d5d357f31e0b4d6,0x357fad5db4d6b1e0,0xb57f2d5d34d631e0,0x2d5d357f31e0b4d6,0x35902c242c24b590,0xb590ac24ac243590,0xac24359035902c24,0x2c24b590b590ac24,0x3275b4a5ac01b591,0x34a532753591ac01,0x34a532753591ac01,0xb27534a52c013591
.quad 0x3400340034003400,0x3400340034003400,0xb4003400b4003400,0xb4003400b4003400,0xb54a3002b528b0a6,0x3002354ab0a63528,0xb002b54a30a6b528,0xb54a3002b528b0a6,0x258db5a535a5258d,0xa58d35a5b5a5a58d,0x35a5258da58d35a5,0xb5a5a58d258db5a5,0x35013146b5672eb3,0xb1463501aeb3b567,0xb1463501aeb3b567,0xb501b1463567aeb3
.quad 0xb47632f63476b2f6,0xb47632f63476b2f6,0xb2f6b47632f63476,0xb2f6b47632f63476,0xad5db57fb1e034d6,0xb57f2d5d34d631e0,0x357fad5db4d6b1e0,0xad5db57fb1e034d6,0x35902c242c24b590,0xb590ac24ac243590,0xac24359035902c24,0x2c24b590b590ac24,0xb27534a52c013591,0xb4a5b275b5912c01,0xb4a5b275b5912c01,0x3275b4a5ac01b591
.quad 0,0,0,0,0,0,0,0,0,0,0,0,0,0,0,0
.quad 0,0,0,0,0,0,0,0,0,0,0,0,0,0,0,0
.quad 0,0,0,0,0,0,0,0,0,0,0,0,0,0,0,0
.quad 0,0,0,0,0,0,0,0,0,0,0,0,0,0,0,0
.quad 0x3400340034003400,0x3400340034003400,0xb4003400b4003400,0xb4003400b4003400,0x3549b00a352a309e,0xb00ab549309eb52a,0x300a3549b09e352a,0x3549b00a352a309e,0x24ffb5a635a624ff,0xa4ff35a6b5a6a4ff,0x35a624ffa4ff35a6,0xb5a6a4ff24ffb5a6,0xb507b12e3563aee6,0x312eb5072ee63563,0x312eb5072ee63563,0x3507312eb5632ee6
.quad 0xb46b3312346bb312,0xb46b3312346bb312,0xb312b46b3312346b,0xb312b46b3312346b,0x2db3357931bab4e1,0x3579adb3b4e1b1ba,0xb5792db334e131ba,0x2db3357931bab4e1,0x35942b772b77b594,0xb594ab77ab773594,0xab77359435942b77,0x2b77b594b594ab77,0x3242b4b7ac7cb58b,0x34b73242358bac7c,0x34b73242358bac7c,0xb24234b72c7c358b
.quad 0x3400340034003400,0x3400340034003400,0xb4003400b4003400,0xb4003400b4003400,0xb549300ab52ab09e,0x300a3549b09e352a,0xb00ab549309eb52a,0xb549300ab52ab09e,0x24ffb5a635a624ff,0xa4ff35a6b5a6a4ff,0x35a624ffa4ff35a6,0xb5a6a4ff24ffb5a6,0x3507312eb5632ee6,0xb12e3507aee6b563,0xb12e3507aee6b563,0xb507b12e3563aee6
.quad 0xb46b3312346bb312,0xb46b3312346bb312,0xb312b46b3312346b,0xb312b46b3312346b,0xadb3b579b1ba34e1,0xb5792db334e131ba,0x3579adb3b4e1b1ba,0xadb3b579b1ba34e1,0x35942b772b77b594,0xb594ab77ab773594,0xab77359435942b77,0x2b77b594b594ab77,0xb24234b72c7c358b,0xb4b7b242b58b2c7c,0xb4b7b242b58b2c7c,0x3242b4b7ac7cb58b
.quad 0,0,0,0,0,0,0,0,0,0,0,0,0,0,0,0
.quad 0,0,0,0,0,0,0,0,0,0,0,0,0,0,0,0
.quad 0,0,0,0,0,0,0,0,0,0,0,0,0,0,0,0
.quad 0,0,0,0,0,0,0,0,0,0,0,0,0,0,0,0
.quad 0x3400340034003400,0x3400340034003400,0xb4003400b4003400,0xb4003400b4003400,0x3547b012352c3096,0xb012b5473096b52c,0x30123547b096352c,0x3547b012352c3096,0x2471b5a635a62471,0xa47135a6b5a6a471,0x35a62471a47135a6,0xb5a6a4712471b5a6,0xb50eb116355faf19,0x3116b50e2f19355f,0x3116b50e2f19355f,0x350e3116b55f2f19
.quad 0xb45f332d345fb32d,0xb45f332d345fb32d,0xb32db45f332d345f,0xb32db45f332d345f,0x2e0935743194b4ec,0x3574ae09b4ecb194,0xb5742e0934ec3194,0x2e0935743194b4ec,0x35982aa42aa4b598,0xb598aaa4aaa43598,0xaaa4359835982aa4,0x2aa4b598b598aaa4,0x320eb4c7acf5b585,0x34c7320e3585acf5,0x34c7320e3585acf5,0xb20e34c72cf53585
.quad 0x3400340034003400,0x3400340034003400,0xb4003400b4003400,0xb4003400b4003400,0xb5473012b52cb096,0x30123547b096352c,0xb012b5473096b52c,0xb5473012b52cb096,0x2471b5a635a62471,0xa47135a6b5a6a471,0x35a62471a47135a6,0xb5a6a4712471b5a6,0x350e3116b55f2f19,0xb116350eaf19b55f,0xb116350eaf19b55f,0xb50eb116355faf19
.quad 0xb45f332d345fb32d,0xb45f332d345fb32d,0xb32db45f332d345f,0xb32db45f332d345f,0xae09b574b19434ec,0xb5742e0934ec3194,0x3574ae09b4ecb194,0xae09b574b19434ec,0x35982aa42aa4b598,0xb598aaa4aaa43598,0xaaa4359835982aa4,0x2aa4b598b598aaa4,0xb20e34c72cf53585,0xb4c7b20eb5852cf5,0xb4c7b20eb5852cf5,0x320eb4c7acf5b585
.quad 0,0,0,0,0,0,0,0,0,0,0,0,0,0,0,0
.quad 0,0,0,0,0,0,0,0,0,0,0,0,0,0,0,0
.quad 0,0,0,0,0,0,0,0,0,0,0,0,0,0,0,0
.quad 0,0,0,0,0,0,0,0,0,0,0,0,0,0,0,0
.quad 0x3400340034003400,0x3400340034003400,0xb4003400b4003400,0xb4003400b4003400,0x3546b01b352e308e,0xb01bb546308eb52e,0x301b3546b08e352e,0x3546b01b352e308e,0x23c6b5a735a723c6,0xa3c635a7b5a7a3c6,0x35a723c6a3c635a7,0xb5a7a3c623c6b5a7,0xb513b0fe355baf4c,0x30feb5132f4c355b,0x30feb5132f4c355b,0x351330feb55b2f4c
.quad 0xb45433493454b349,0xb45433493454b349,0xb349b45433493454,0xb349b45433493454,0x2e5e356e316db4f7,0x356eae5eb4f7b16d,0xb56e2e5e34f7316d,0x2e5e356e316db4f7,0x359c29d129d1b59c,0xb59ca9d1a9d1359c,0xa9d1359c359c29d1,0x29d1b59cb59ca9d1,0x31d9b4d8ad6eb57e,0x34d831d9357ead6e,0x34d831d9357ead6e,0xb1d934d82d6e357e
.quad 0x3400340034003400,0x3400340034003400,0xb4003400b4003400,0xb4003400b4003400,0xb546301bb52eb08e,0x301b3546b08e352e,0xb01bb546308eb52e,0xb546301bb52eb08e,0x23c6b5a735a723c6,0xa3c635a7b5a7a3c6,0x35a723c6a3c635a7,0xb5a7a3c623c6b5a7,0x351330feb55b2f4c,0xb0fe3513af4cb55b,0xb0fe3513af4cb55b,0xb513b0fe355baf4c
.quad 0xb45433493454b349,0xb45433493454b349,0xb349b45433493454,0xb349b45433493454,0xae5eb56eb16d34f7,0xb56e2e5e34f7316d,0x356eae5eb4f7b16d,0xae5eb56eb16d34f7,0x359c29d129d1b59c,0xb59ca9d1a9d1359c,0xa9d1359c359c29d1,0x29d1b59cb59ca9d1,0xb1d934d82d6e357e,0xb4d8b1d9b57e2d6e,0xb4d8b1d9b57e2d6e,0x31d9b4d8ad6eb57e
.quad 0,0,0,0,0,0,0,0,0,0,0,0,0,0,0,0
.quad 0,0,0,0,0,0,0,0,0,0,0,0,0,0,0,0
.quad 0,0,0,0,0,0,0,0,0,0,0,0,0,0,0,0
.quad 0,0,0,0,0,0,0,0,0,0,0,0,0,0,0,0
.quad 0x3400340034003400,0x3400340034003400,0xb4003400b4003400,0xb4003400b4003400,0x3544b023352f3085,0xb023b5443085b52f,0x30233544b085352f,0x3544b023352f3085,0x22aab5a735a722aa,0xa2aa35a7b5a7a2aa,0x35a722aaa2aa35a7,0xb5a7a2aa22aab5a7,0xb519b0e63556af7e,0x30e6b5192f7e3556,0x30e6b5192f7e3556,0x351930e6b5562f7e
.quad 0xb44933643449b364,0xb44933643449b364,0xb364b44933643449,0xb364b44933643449,0x2eb335673146b501,0x3567aeb3b501b146,0xb5672eb335013146,0x2eb335673146b501,0x359f28fd28fdb59f,0xb59fa8fda8fd359f,0xa8fd359f359f28fd,0x28fdb59fb59fa8fd,0x31a3b4e8ade7b576,0x34e831a33576ade7,0x34e831a33576ade7,0xb1a334e82de73576
.quad 0x3400340034003400,0x3400340034003400,0xb4003400b4003400,0xb4003400b4003400,0xb5443023b52fb085,0x30233544b085352f,0xb023b5443085b52f,0xb5443023b52fb085,0x22aab5a735a722aa,0xa2aa35a7b5a7a2aa,0x35a722aaa2aa35a7,0xb5a7a2aa22aab5a7,0x351930e6b5562f7e,0xb0e63519af7eb556,0xb0e63519af7eb556,0xb519b0e63556af7e
.quad 0xb44933643449b364,0xb44933643449b364,0xb364b44933643449,0xb364b44933643449,0xaeb3b567b1463501,0xb5672eb335013146,0x3567aeb3b501b146,0xaeb3b567b1463501,0x359f28fd28fdb59f,0xb59fa8fda8fd359f,0xa8fd359f359f28fd,0x28fdb59fb59fa8fd,0xb1a334e82de73576,0xb4e8b1a3b5762de7,0xb4e8b1a3b5762de7,0x31a3b4e8ade7b576
.quad 0,0,0,0,0,0,0,0,0,0,0,0,0,0,0,0
.quad 0,0,0,0,0,0,0,0,0,0,0,0,0,0,0,0
.quad 0,0,0,0,0,0,0,0,0,0,0,0,0,0,0,0
.quad 0,0,0,0,0,0,0,0,0,0,0,0,0,0,0,0
.quad 0x3400340034003400,0x3400340034003400,0xb4003400b4003400,0xb4003400b4003400,0x3542b02b3531307d,0xb02bb542307db531,0x302b3542b07d3531,0x3542b02b3531307d,0x218db5a735a7218d,0xa18d35a7b5a7a18d,0x35a7218da18d35a7,0xb5a7a18d218db5a7,0xb51fb0ce3552afb0,0x30ceb51f2fb03552,0x30ceb51f2fb03552,0x351f30ceb5522fb0
.quad 0xb43d337f343db37f,0xb43d337f343db37f,0xb37fb43d337f343d,0xb37fb43d337f343d,0x2f083560311eb50c,0x3560af08b50cb11e,0xb5602f08350c311e,0x2f083560311eb50c,0x35a228292829b5a2,0xb5a2a829a82935a2,0xa82935a235a22829,0x2829b5a2b5a2a829,0x316db4f7ae5eb56e,0x34f7316d356eae5e,0x34f7316d356eae5e,0xb16d34f72e5e356e
.quad 0x3400340034003400,0x3400340034003400,0xb4003400b4003400,0xb4003400b4003400,0xb542302bb531b07d,0x302b3542b07d3531,0xb02bb542307db531,0xb542302bb531b07d,0x218db5a735a7218d,0xa18d35a7b5a7a18d,0x35a7218da18d35a7,0xb5a7a18d218db5a7,0x351f30ceb5522fb0,0xb0ce351fafb0b552,0xb0ce351fafb0b552,0xb51fb0ce3552afb0
.quad 0xb43d337f343db37f,0xb43d337f343db37f,0xb37fb43d337f343d,0xb37fb43d337f343d,0xaf08b560b11e350c,0xb5602f08350c311e,0x3560af08b50cb11e,0xaf08b560b11e350c,0x35a228292829b5a2,0xb5a2a829a82935a2,0xa82935a235a22829,0x2829b5a2b5a2a829,0xb16d34f72e5e356e,0xb4f7b16db56e2e5e,0xb4f7b16db56e2e5e,0x316db4f7ae5eb56e
.quad 0,0,0,0,0,0,0,0,0,0,0,0,0,0,0,0
.quad 0,0,0,0,0,0,0,0,0,0,0,0,0,0,0,0
.quad 0,0,0,0,0,0,0,0,0,0,0,0,0,0,0,0
.quad 0,0,0,0,0,0,0,0,0,0,0,0,0,0,0,0
.quad 0x3400340034003400,0x3400340034003400,0xb4003400b4003400,0xb4003400b4003400,0x3541b03335333075,0xb033b5413075b533,0x30333541b0753533,0x3541b03335333075,0x2071b5a835a82071,0xa07135a8b5a8a071,0x35a82071a07135a8,0xb5a8a0712071b5a8,0xb525b0b6354dafe2,0x30b6b5252fe2354d,0x30b6b5252fe2354d,0x352530b6b54d2fe2
.quad 0xb43133993431b399,0xb43133993431b399,0xb399b43133993431,0xb399b43133993431,0x2f5c355930f6b515,0x3559af5cb515b0f6,0xb5592f5c351530f6,0x2f5c355930f6b515,0x35a426a926a9b5a4,0xb5a4a6a9a6a935a4,0xa6a935a435a426a9,0x26a9b5a4b5a4a6a9,0x3136b505aed5b565,0x350531363565aed5,0x350531363565aed5,0xb13635052ed53565
.quad 0x3400340034003400,0x3400340034003400,0xb4003400b4003400,0xb4003400b4003400,0xb5413033b533b075,0x30333541b0753533,0xb033b5413075b533,0xb5413033b533b075,0x2071b5a835a82071,0xa07135a8b5a8a071,0x35a82071a07135a8,0xb5a8a0712071b5a8,0x352530b6b54d2fe2,0xb0b63525afe2b54d,0xb0b63525afe2b54d,0xb525b0b6354dafe2
.quad 0xb43133993431b399,0xb43133993431b399,0xb399b43133993431,0xb399b43133993431,0xaf5cb559b0f63515,0xb5592f5c351530f6,0x3559af5cb515b0f6,0xaf5cb559b0f63515,0x35a426a926a9b5a4,0xb5a4a6a9a6a935a4,0xa6a935a435a426a9,0x26a9b5a4b5a4a6a9,0xb13635052ed53565,0xb505b136b5652ed5,0xb505b136b5652ed5,0x3136b505aed5b565
.quad 0,0,0,0,0,0,0,0,0,0,0,0,0,0,0,0
.quad 0,0,0,0,0,0,0,0,0,0,0,0,0,0,0,0
.quad 0,0,0,0,0,0,0,0,0,0,0,0,0,0,0,0
.quad 0,0,0,0,0,0,0,0,0,0,0,0,0,0,0,0
.quad 0x3400340034003400,0x3400340034003400,0xb4003400b4003400,0xb4003400b4003400,0x353fb03c3535306d,0xb03cb53f306db535,0x303c353fb06d3535,0x353fb03c3535306d,0x1eaab5a835a81eaa,0x9eaa35a8b5a89eaa,0x35a81eaa9eaa35a8,0xb5a89eaa1eaab5a8,0xb52ab09e3549b00a,0x309eb52a300a3549,0x309eb52a300a3549,0x352a309eb549300a
.quad 0xb42533b33425b3b3,0xb42533b33425b3b3,0xb3b3b42533b33425,0xb3b3b42533b33425,0x2fb0355230ceb51f,0x3552afb0b51fb0ce,0xb5522fb0351f30ce,0x2fb0355230ceb51f,0x35a624ff24ffb5a6,0xb5a6a4ffa4ff35a6,0xa4ff35a635a624ff,0x24ffb5a6b5a6a4ff,0x30feb513af4cb55b,0x351330fe355baf4c,0x351330fe355baf4c,0xb0fe35132f4c355b
.quad 0x3400340034003400,0x3400340034003400,0xb4003400b4003400,0xb4003400b4003400,0xb53f303cb535b06d,0x303c353fb06d3535,0xb03cb53f306db535,0xb53f303cb535b06d,0x1eaab5a835a81eaa,0x9eaa35a8b5a89eaa,0x35a81eaa9eaa35a8,0xb5a89eaa1eaab5a8,0x352a309eb549300a,0xb09e352ab00ab549,0xb09e352ab00ab549,0xb52ab09e3549b00a
.quad 0xb42533b33425b3b3,0xb42533b33425b3b3,0xb3b3b42533b33425,0xb3b3b42533b33425,0xafb0b552b0ce351f,0xb5522fb0351f30ce,0x3552afb0b51fb0ce,0xafb0b552b0ce351f,0x35a624ff24ffb5a6,0xb5a6a4ffa4ff35a6,0xa4ff35a635a624ff,0x24ffb5a6b5a6a4ff,0xb0fe35132f4c355b,0xb513b0feb55b2f4c,0xb513b0feb55b2f4c,0x30feb513af4cb55b
.quad 0,0,0,0,0,0,0,0,0,0,0,0,0,0,0,0
.quad 0,0,0,0,0,0,0,0,0,0,0,0,0,0,0,0
.quad 0,0,0,0,0,0,0,0,0,0,0,0,0,0,0,0
.quad 0,0,0,0,0,0,0,0,0,0,0,0,0,0,0,0
.quad 0x3400340034003400,0x3400340034003400,0xb4003400b4003400,0xb4003400b4003400,0x353db04435363065,0xb044b53d3065b536,0x3044353db0653536,0x353db04435363065,0x1c71b5a835a81c71,0x9c7135a8b5a89c71,0x35a81c719c7135a8,0xb5a89c711c71b5a8,0xb52fb0853544b023,0x3085b52f30233544,0x3085b52f30233544,0x352f3085b5443023
.quad 0xb41933cd3419b3cd,0xb41933cd3419b3cd,0xb3cdb41933cd3419,0xb3cdb41933cd3419,0x3002354a30a6b528,0x354ab002b528b0a6,0xb54a3002352830a6,0x3002354a30a6b528,0x35a722aa22aab5a7,0xb5a7a2aaa2aa35a7,0xa2aa35a735a722aa,0x22aab5a7b5a7a2aa,0x30c6b521afc1b550,0x352130c63550afc1,0x352130c63550afc1,0xb0c635212fc13550
.quad 0x3400340034003400,0x3400340034003400,0xb4003400b4003400,0xb4003400b4003400,0xb53d3044b536b065,0x3044353db0653536,0xb044b53d3065b536,0xb53d3044b536b065,0x1c71b5a835a81c71,0x9c7135a8b5a89c71,0x35a81c719c7135a8,0xb5a89c711c71b5a8,0x352f3085b5443023,0xb085352fb023b544,0xb085352fb023b544,0xb52fb0853544b023
.quad 0xb41933cd3419b3cd,0xb41933cd3419b3cd,0xb3cdb41933cd3419,0xb3cdb41933cd3419,0xb002b54ab0a63528,0xb54a3002352830a6,0x354ab002b528b0a6,0xb002b54ab0a63528,0x35a722aa22aab5a7,0xb5a7a2aaa2aa35a7,0xa2aa35a735a722aa,0x22aab5a7b5a7a2aa,0xb0c635212fc13550,0xb521b0c6b5502fc1,0xb521b0c6b5502fc1,0x30c6b521afc1b550
.quad 0,0,0,0,0,0,0,0,0,0,0,0,0,0,0,0
.quad 0,0,0,0,0,0,0,0,0,0,0,0,0,0,0,0
.quad 0,0,0,0,0,0,0,0,0,0,0,0,0,0,0,0
.quad 0,0,0,0,0,0,0,0,0,0,0,0,0,0,0,0
.quad 0x3400340034003400,0x3400340034003400,0xb4003400b4003400,0xb4003400b4003400,0x353cb04c3538305d,0xb04cb53c305db538,0x304c353cb05d3538,0x353cb04c3538305d,0x1871b5a835a81871,0x987135a8b5a89871,0x35a81871987135a8,0xb5a898711871b5a8,0xb535b06d353fb03c,0x306db535303c353f,0x306db535303c353f,0x3535306db53f303c
.quad 0xb40c33e7340cb3e7,0xb40c33e7340cb3e7,0xb3e7b40c33e7340c,0xb3e7b40c33e7340c,0x302b3542307db531,0x3542b02bb531b07d,0xb542302b3531307d,0x302b3542307db531,0x35a81eaa1eaab5a8,0xb5a89eaa9eaa35a8,0x9eaa35a835a81eaa,0x1eaab5a8b5a89eaa,0x308eb52eb01bb546,0x352e308e3546b01b,0x352e308e3546b01b,0xb08e352e301b3546
.quad 0x3400340034003400,0x3400340034003400,0xb4003400b4003400,0xb4003400b4003400,0xb53c304cb538b05d,0x304c353cb05d3538,0xb04cb53c305db538,0xb53c304cb538b05d,0x1871b5a835a81871,0x987135a8b5a89871,0x35a81871987135a8,0xb5a898711871b5a8,0x3535306db53f303c,0xb06d3535b03cb53f,0xb06d3535b03cb53f,0xb535b06d353fb03c
.quad 0xb40c33e7340cb3e7,0xb40c33e7340cb3e7,0xb3e7b40c33e7340c,0xb3e7b40c33e7340c,0xb02bb542b07d3531,0xb542302b3531307d,0x3542b02bb531b07d,0xb02bb542b07d3531,0x35a81eaa1eaab5a8,0xb5a89eaa9eaa35a8,0x9eaa35a835a81eaa,0x1eaab5a8b5a89eaa,0xb08e352e301b3546,0xb52eb08eb546301b,0xb52eb08eb546301b,0x308eb52eb01bb546
.quad 0,0,0,0,0,0,0,0,0,0,0,0,0,0,0,0
.quad 0,0,0,0,0,0,0,0,0,0,0,0,0,0,0,0
.quad 0,0,0,0,0,0,0,0,0,0,0,0,0,0,0,0
.quad 0,0,0,0,0,0,0,0,0,0,0,0,0,0,0,0
```

```asm
; @launch grid=(256,1,1) block=(512,1,1) lds=159552
.amdgcn_target "amdgcn-amd-amdhsa--gfx950"
.text
.globl parallel_sum__spectral_fnet__moe_arch_mod__prompt_kernel
.p2align 8
.type parallel_sum__spectral_fnet__moe_arch_mod__prompt_kernel,@function
parallel_sum__spectral_fnet__moe_arch_mod__prompt_kernel:
  s_load_dwordx2 s[4:5], s[0:1], 0
  s_load_dwordx2 s[8:9], s[0:1], 96
  s_load_dwordx2 s[12:13], s[0:1], 80
  s_getpc_b64 s[26:27]
L_pc:
  s_add_u32 s16, s26, L_tab@rel32@lo+4
  s_addc_u32 s17, s27, L_tab@rel32@hi+12
  v_lshrrev_b32 v3, 6, v0
  v_and_b32 v1, 63, v0
  s_mov_b32 s7, 0x20000
  v_readfirstlane_b32 s3, v3
  s_mov_b32 s11, 0x20000
  s_mov_b32 s19, 0x20000
  s_mov_b32 s23, 0x20000
  v_lshlrev_b32 v2, 4, v1
  s_mov_b32 s18, 85888
  s_cmp_ge_u32 s2, 128
  s_cbranch_scc1 L_ffn0
  s_load_dwordx2 s[20:21], s[0:1], 48
  s_mov_b32 s47, s2
  s_and_b32 s30, s2, 7
  s_sub_u32 s31, 16, s30
  s_cmp_eq_u32 s30, 0
  s_cselect_b32 s31, 8, s31
  s_bitcmp1_b32 s2, 3
  s_cselect_b32 s30, s31, s30
  s_and_b32 s2, s2, 0x70
  s_or_b32 s2, s2, s30
  s_mov_b32 s18, 217088
  s_lshl_b32 s30, s3, 8
  v_and_b32 v16, 15, v1
  v_lshrrev_b32 v17, 4, v1
  v_cmp_eq_u32 vcc, 4, v16
  v_mov_b32 v64, 0x3f803f80
  v_lshl_add_u32 v18, v17, 4, s30
  s_add_u32 s30, s30, s2
  s_cmp_eq_u32 s2, 0
  s_cselect_b32 s32, 896, 0
  v_cndmask_b32_e64 v32, 0, v64, vcc
  s_cmp_ge_u32 s3, 4
  s_cselect_b32 s32, s32, 0
  s_sub_u32 s30, s30, s32
  s_sub_u32 s31, 2048, s30
  s_cmp_eq_u32 s30, 0
  s_cselect_b32 s31, 1024, s31
  s_lshl_b32 s32, s30, 11
  s_lshl_b32 s33, s31, 11
  s_mul_i32 s34, s3, 4128
  s_mov_b32 s6, 0x400000
  s_mov_b32 s22, 2048
  s_lshl_b32 s38, s3, 9
  s_add_u32 m0, s38, 35328
  s_mov_b32 exec_hi, 0
  buffer_load_dwordx4 v2, s[16:19], s38 offen lds
  s_mov_b32 exec_hi, -1
  s_lshl_b32 s46, s3, 11
  s_add_u32 s39, s46, 39424
  s_add_u32 s46, s46, 4096
  s_cmp_eq_u32 s2, 0
  s_cselect_b32 s37, 2048, 0
  s_add_u32 s37, s37, s46
  s_cmp_eq_u32 s3, 6
  s_cselect_b32 s46, s37, s46
  s_lshl_b32 s37, s2, 10
  s_add_u32 s37, s37, 86016
  s_cmp_eq_u32 s3, 7
  s_cselect_b32 s46, s37, s46
  s_mov_b32 m0, s39
  s_nop 0
  buffer_load_dwordx4 v2, s[16:19], s46 offen lds
  buffer_load_dwordx4 v2, s[16:19], s46 offen offset:1024 lds
  v_mov_b32 v33, v32
  v_mov_b32 v34, v32
  v_mov_b32 v35, v32
  v_mov_b32 v36, v32
  v_mov_b32 v37, v32
  v_mov_b32 v38, v32
  v_mov_b32 v39, v32
  v_mov_b32 v40, v32
  v_mov_b32 v41, v32
  v_mov_b32 v42, v32
  v_mov_b32 v43, v32
  v_mov_b32 v44, v32
  v_mov_b32 v45, v32
  v_mov_b32 v46, v32
  v_mov_b32 v47, v32
  s_mov_b32 m0, s34
  s_waitcnt lgkmcnt(0)
  s_mov_b32 exec_lo, 0x01010101
  s_mov_b32 exec_hi, 0x01010101
  buffer_load_dwordx4 v[32:35], v18, s[20:23], 0 offen offset:0
  buffer_load_dwordx4 v[36:39], v18, s[20:23], 0 offen offset:64
  buffer_load_dwordx4 v[40:43], v18, s[20:23], 0 offen offset:128
  buffer_load_dwordx4 v[44:47], v18, s[20:23], 0 offen offset:192
  s_mov_b64 exec, -1
  buffer_load_dwordx4 v2, s[4:7], s32 offen lds
  buffer_load_dwordx4 v2, s[4:7], s32 offen offset:1024 lds
  s_add_u32 m0, m0, 2064
  s_load_dword s24, s[8:9], 0
  buffer_load_dwordx4 v2, s[4:7], s33 offen lds
  buffer_load_dwordx4 v2, s[4:7], s33 offen offset:1024 lds
  s_branch L_fft1
L_ffn0:
  s_cmp_ge_u32 s2, 256
  s_cbranch_scc1 L_end
  s_sub_u32 s30, s2, 128
  s_lshr_b32 s31, s30, 3
  s_lshl_b32 s31, s31, 13
  s_sub_u32 s32, s31, 16384
  s_cselect_b32 s31, s31, s32
  s_cselect_b64 s[16:17], s[26:27], s[16:17]
  s_cselect_b32 s32, L_end-L_pc, s18
  v_and_b32 v4, 0x1f8, v0
  v_lshl_add_u32 v4, v4, 4, s31
  v_min_u32 v4, s32, v4
  global_load_dword v57, v4, s[16:17]
  s_load_dwordx2 s[38:39], s[0:1], 48
  v_and_b32 v58, 0x7f0, v0
  v_lshlrev_b32 v58, 2, v58
  s_load_dwordx4 s[16:19], s[0:1], 56
  s_load_dwordx2 s[40:41], s[0:1], 72
  s_lshr_b32 s31, s30, 4
  s_and_b32 s32, s30, 15
  s_lshl_b32 s33, s32, 3
  s_add_u32 s33, s33, s3
  s_mul_i32 s33, s33, 57344
  s_mul_i32 s34, s31, 896
  s_add_u32 s33, s33, s34
  s_and_b32 s34, s3, 3
  s_mul_i32 s34, s34, 3712
  s_lshr_b32 s35, s3, 2
  s_mul_i32 s35, s35, 29696
  s_add_u32 m0, s34, s35
  s_mov_b32 s22, 7340032
  s_mov_b32 exec_hi, 0x00ffffff
  s_waitcnt lgkmcnt(0)
  s_mov_b64 s[20:21], s[18:19]
  s_mov_b32 s18, 7340032
  s_mov_b32 s19, 0x20000
  s_load_dword s24, s[8:9], 0
  s_cmp_lt_u32 s30, 8
  s_cbranch_scc0 L_npr
  global_load_dword v59, v58, s[38:39]
L_npr:
  s_waitcnt vmcnt(0)
  buffer_load_dwordx4 v2, s[16:19], s33 offen nt lds
  s_add_u32 m0, m0, 59392
  s_nop 0
  buffer_load_dwordx4 v2, s[20:23], s33 offen nt lds
  s_sub_u32 m0, m0, 58464
  s_add_u32 s33, s33, 7168
  buffer_load_dwordx4 v2, s[16:19], s33 offen nt lds
  s_add_u32 m0, m0, 59392
  s_nop 0
  buffer_load_dwordx4 v2, s[20:23], s33 offen nt lds
  s_sub_u32 m0, m0, 58464
  s_add_u32 s33, s33, 7168
  buffer_load_dwordx4 v2, s[16:19], s33 offen nt lds
  s_add_u32 m0, m0, 59392
  s_nop 0
  buffer_load_dwordx4 v2, s[20:23], s33 offen nt lds
  s_sub_u32 m0, m0, 58464
  s_add_u32 s33, s33, 7168
  buffer_load_dwordx4 v2, s[16:19], s33 offen nt lds
  s_add_u32 m0, m0, 59392
  s_nop 0
  buffer_load_dwordx4 v2, s[20:23], s33 offen nt lds
  s_sub_u32 m0, m0, 47328
  s_add_u32 s33, s33, 7168
  buffer_load_dwordx4 v2, s[16:19], s33 offen nt lds
  s_add_u32 m0, m0, 59392
  s_nop 0
  buffer_load_dwordx4 v2, s[20:23], s33 offen nt lds
  s_sub_u32 m0, m0, 58464
  s_add_u32 s33, s33, 7168
  buffer_load_dwordx4 v2, s[16:19], s33 offen nt lds
  s_add_u32 m0, m0, 59392
  s_nop 0
  buffer_load_dwordx4 v2, s[20:23], s33 offen nt lds
  s_sub_u32 m0, m0, 58464
  s_add_u32 s33, s33, 7168
  buffer_load_dwordx4 v2, s[16:19], s33 offen nt lds
  s_add_u32 m0, m0, 59392
  s_nop 0
  buffer_load_dwordx4 v2, s[20:23], s33 offen nt lds
  s_sub_u32 m0, m0, 58464
  s_add_u32 s33, s33, 7168
  buffer_load_dwordx4 v2, s[16:19], s33 offen nt lds
  s_add_u32 m0, m0, 59392
  s_nop 0
  buffer_load_dwordx4 v2, s[20:23], s33 offen nt lds
  s_mov_b32 exec_hi, -1
  s_branch L_ffn1
L_fft1:
  s_bfe_u32 s41, s2, 0x10003
  s_load_dwordx2 s[30:31], s[0:1], 72
  s_min_u32 s36, s47, 111
  s_lshl_b32 s36, s36, 16
  s_lshr_b32 s37, s3, 1
  s_lshl_b32 s37, s37, 14
  s_add_u32 s36, s36, s37
  s_and_b32 s37, s3, 1
  s_lshl_b32 s37, s37, 12
  s_add_u32 s36, s36, s37
  v_and_b32 v19, 1, v17
  v_and_b32 v20, 2, v17
  v_lshl_add_u32 v3, v16, 7, s36
  v_lshl_add_u32 v3, v19, 11, v3
  v_lshl_add_u32 v3, v20, 12, v3
  s_and_b32 s40, s2, 7
  s_lshr_b32 s42, s2, 4
  s_and_b32 s43, s2, 15
  v_lshrrev_b32 v19, 3, v0
  v_and_b32 v20, 7, v0
  v_lshl_add_u32 v19, v19, 4, s43
  s_lshl_b32 s44, s42, 7
  v_lshl_add_u32 v20, v20, 4, s44
  v_lshl_add_u32 v172, v19, 11, v20
  v_sub_u32 v19, 1024, v19
  v_sub_u32 v20, 2032, v20
  v_add_u32 v174, 0x200000, v172
  v_lshl_add_u32 v175, v19, 11, v20
  v_add_u32 v173, 0x200000, v175
  v_and_b32 v173, 0x3fffff, v173
  v_mul_u32_u24 v5, 2064, v16
  v_add_u32 v5, v5, v18
  s_mov_b32 s36, 55808
  v_lshl_add_u32 v8, v1, 5, s36
  v_lshrrev_b32 v19, 3, v1
  v_add_u32 v19, s3, v19
  v_and_b32 v20, 7, v19
  v_lshl_add_u32 v6, v20, 2, v8
  v_lshlrev_b32 v21, 1, v17
  v_sub_u32 v19, v19, v21
  v_add_u32 v19, 6, v19
  v_and_b32 v19, 7, v19
  v_lshlrev_b32 v19, 2, v19
  v_lshl_add_u32 v20, v16, 5, v19
  v_add_u32 v20, 57344, v20
  v_add_u32 v21, 2048, v6
  s_mov_b32 s36, 0x00f0000f
  s_mov_b32 s37, 0xf0000f00
  v_cndmask_b32_e64 v7, v21, v20, s[36:37]
  v_bfe_u32 v20, v1, 2, 2
  v_and_b32 v21, 3, v1
  v_lshrrev_b32 v22, 5, v1
  v_lshl_add_u32 v22, v22, 3, v20
  v_and_b32 v23, 1, v17
  v_lshlrev_b32 v22, 6, v22
  v_lshl_add_u32 v22, v23, 5, v22
  v_lshl_add_u32 v22, v21, 3, v22
  v_add_u32 v4, s34, v22
  v_mov_b32 v65, v64
  v_mov_b32 v66, v64
  v_mov_b32 v67, v64
  v_mov_b32 v11, 0xfffcfffc
  s_mov_b32 s10, 8388608
  s_mov_b32 s14, 0x400000
  s_mov_b32 s15, 0x20000
  s_lshl_b32 s34, s3, 1
  s_add_u32 s35, s34, 17
  s_add_u32 s34, s34, 16
  s_mov_b32 s48, 0x22222222
  s_mov_b32 s49, 0x22222222
  s_mov_b32 s50, 0x44444444
  s_mov_b32 s51, 0x44444444
  s_mov_b32 s52, 0x88888888
  s_mov_b32 s53, 0x88888888
  v_lshrrev_b32 v20, 1, v16
  v_lshlrev_b32 v20, 8, v20
  s_cmp_eq_u32 s2, 0
  s_cselect_b32 s36, 896, 0
  s_cselect_b32 s55, 0x10000, 0
  s_mov_b32 s54, 0xffff0000
  v_bfe_u32 v21, v1, 3, 1
  v_mul_u32_u24 v21, s36, v21
  v_add_u32 v20, s2, v20
  v_sub_u32 v20, v20, v21
  v_sub_u32 v21, 0x800, v20
  v_cmp_eq_u32 vcc, 0, v20
  v_mov_b32 v22, 0x400
  s_mov_b32 s36, 0xaaaaaaaa
  s_mov_b32 s37, s36
  v_cndmask_b32_e64 v21, v21, v22, vcc
  v_cndmask_b32_e64 v20, v20, v21, s[36:37]
  v_sub_u32 v9, 0xffff, v20
  v_and_b32 v21, 15, v20
  v_and_b32 v20, 0x7f0, v20
  v_lshl_add_u32 v10, v21, 12, v20
  v_mov_b32 v21, 0x800
  s_nop 1
  v_mov_b32_dpp v10, v21 quad_perm:[0,1,2,3] row_mask:0xd bank_mask:0xf
  s_waitcnt vmcnt(0)
  v_mfma_f32_16x16x32_bf16 v[76:79], v[32:35], v[64:67], 0
  v_mfma_f32_16x16x32_bf16 v[76:79], v[36:39], v[64:67], v[76:79]
  v_mfma_f32_16x16x32_bf16 v[76:79], v[40:43], v[64:67], v[76:79]
  v_mfma_f32_16x16x32_bf16 v[76:79], v[44:47], v[64:67], v[76:79]
  s_waitcnt lgkmcnt(0)
  s_barrier
  ds_read_b128 v[48:51], v5 offset:0
  ds_read_b128 v[52:55], v5 offset:64
  ds_read_b128 v[56:59], v5 offset:128
  ds_read_b128 v[60:63], v5 offset:192
  ds_read_b64_tr_b16 v[132:133], v4 offset:0
  ds_read_b64_tr_b16 v[134:135], v4 offset:256
  ds_read_b64_tr_b16 v[136:137], v4 offset:1024
  ds_read_b64_tr_b16 v[138:139], v4 offset:1280
  ds_read_b128 v[112:115], v2 offset:35328
  ds_read_b128 v[116:119], v2 offset:36352
  s_add_u32 s24, s24, 1
  s_and_b32 s29, s24, 0xff
  s_waitcnt lgkmcnt(9)
  v_mfma_f32_16x16x32_bf16 v[72:75], v[48:51], v[48:51], 0
  v_mfma_f32_16x16x32_bf16 v[68:71], v[32:35], v[48:51], 0
  s_waitcnt lgkmcnt(8)
  v_mfma_f32_16x16x32_bf16 v[72:75], v[52:55], v[52:55], v[72:75]
  v_mfma_f32_16x16x32_bf16 v[68:71], v[36:39], v[52:55], v[68:71]
  s_waitcnt lgkmcnt(7)
  v_mfma_f32_16x16x32_bf16 v[72:75], v[56:59], v[56:59], v[72:75]
  v_mfma_f32_16x16x32_bf16 v[68:71], v[40:43], v[56:59], v[68:71]
  s_waitcnt lgkmcnt(6)
  v_mfma_f32_16x16x32_bf16 v[72:75], v[60:63], v[60:63], v[72:75]
  v_mfma_f32_16x16x32_bf16 v[68:71], v[44:47], v[60:63], v[68:71]
  ds_read_b128 v[120:123], v2 offset:37376
  ds_read_b128 v[124:127], v2 offset:38400
  ds_read_b64_tr_b16 v[140:141], v4 offset:2064
  ds_read_b64_tr_b16 v[142:143], v4 offset:2320
  ds_read_b64_tr_b16 v[144:145], v4 offset:3088
  ds_read_b64_tr_b16 v[146:147], v4 offset:3344
  s_nop 0
  v_cndmask_b32_e64 v72, v72, v73, s[48:49]
  v_cndmask_b32_e64 v74, v74, v75, s[52:53]
  v_mov_b32_dpp v68, v76 quad_perm:[0,1,2,3] row_mask:0x4 bank_mask:0xf
  s_or_b64 s[50:51], s[50:51], s[52:53]
  ds_write_b32 v6, v68
  v_cndmask_b32_e64 v72, v72, v74, s[50:51]
  ds_write_b32 v7, v72
  s_waitcnt lgkmcnt(8)
  v_mfma_f32_32x32x16_bf16 v[176:191], v[132:135], v[112:115], 0
  v_mfma_f32_32x32x16_bf16 v[176:191], v[136:139], v[116:119], v[176:191]
  s_waitcnt lgkmcnt(0)
  s_barrier
  ds_read_b128 v[28:31], v8
  ds_read_b128 v[68:71], v8 offset:16
  ds_read_b128 v[20:23], v2 offset:51712
  ds_read_b128 v[12:15], v2 offset:47616
  ds_read_b128 v[80:83], v2 offset:39424
  ds_read_b128 v[84:87], v2 offset:40448
  ds_read_b128 v[88:91], v2 offset:41472
  ds_read_b128 v[92:95], v2 offset:42496
  ds_read_b128 v[96:99], v2 offset:43520
  ds_read_b128 v[100:103], v2 offset:44544
  ds_read_b128 v[104:107], v2 offset:45568
  ds_read_b128 v[108:111], v2 offset:46592
  ds_read_b128 v[128:131], v2 offset:53760
  ds_read_b128 v[24:27], v2 offset:52736
  s_cmp_eq_u32 s3, 7
  s_cbranch_scc1 L_cw
  v_mfma_f32_32x32x16_bf16 v[192:207], v[132:135], v[120:123], 0
  s_waitcnt lgkmcnt(12)
  v_pk_add_f32 v[28:29], v[28:29], v[30:31]
  v_pk_add_f32 v[68:69], v[68:69], v[70:71]
  v_pk_add_f32 v[28:29], v[28:29], v[68:69]
  v_add_f32 v68, v28, v29
  v_add_f32 v31, v28, v29
  s_nop 1
  v_permlane32_swap_b32 v68, v31
  v_mfma_f32_32x32x16_bf16 v[192:207], v[136:139], v[124:127], v[192:207]
  v_mov_b32 v69, v31
  v_mul_f32 v29, 0x3a800000, v68
  v_mul_f32 v31, 0x3a800000, v31
  v_fma_f32 v31, -v29, v29, v31
  v_max_f32 v31, 0, v31
  v_mfma_f32_32x32x16_bf16 v[208:223], v[140:143], v[112:115], 0
  v_cvt_pk_bf16_f32 v31, v31, v31
  v_and_b32 v31, 0xffff0000, v31
  v_add_f32 v31, 0x3727c5ac, v31
  v_cvt_pk_bf16_f32 v31, v31, v31
  v_and_b32 v31, 0xffff0000, v31
  v_sqrt_f32 v31, v31
  v_mfma_f32_32x32x16_bf16 v[208:223], v[144:147], v[116:119], v[208:223]
  v_mov_b32 v18, s24
  v_cvt_pk_bf16_f32 v19, v29, v31
  v_and_b32 v16, 0xffff0000, v19
  v_rcp_f32 v16, v16
  v_lshlrev_b32 v17, 16, v19
  v_mfma_f32_32x32x16_bf16 v[224:239], v[140:143], v[120:123], 0
  v_mul_f32 v17, v17, v16
  v_readlane_b32 s56, v16, s34
  v_readlane_b32 s57, v16, s35
  v_readlane_b32 s58, v17, s34
  v_readlane_b32 s59, v17, s35
  v_mfma_f32_32x32x16_bf16 v[224:239], v[144:147], v[124:127], v[224:239]
L_nocand:
  s_lshl_b32 s63, s41, 15
  s_lshl_b32 s38, s3, 13
  s_add_u32 m0, s38, 79552
  s_add_u32 s63, s63, s38
  s_add_u32 s63, s63, 20480
  s_mov_b32 s60, s57
  s_mov_b32 s61, s59
  s_or_b32 s62, s2, s3
  s_cselect_b32 s57, s57, 0
  s_cselect_b32 s59, s59, 0
  s_mul_i32 s36, s3, 2176
  s_lshl_b32 s37, s3, 5
  s_waitcnt lgkmcnt(10)
  v_add_u32 v21, s37, v21
  v_add_u32 v12, s36, v12
  v_add_u32 v13, s36, v13
  v_add_u32 v14, s36, v14
  v_add_u32 v15, s36, v15
  v_and_b32 v21, 0xff, v21
  v_add_u32 v20, v20, v21
L_job:
  v_mul_f32 v18, s58, v23
  v_mul_f32 v19, s59, v23
  v_add_f32 v16, v18, v19
  v_sub_f32 v17, v18, v19
  v_pk_fma_f32 v[156:157], v[176:177], s[56:57], v[16:17] op_sel:[0,0,0] op_sel_hi:[1,0,0]
  v_pk_fma_f32 v[158:159], v[192:193], s[56:57], v[16:17] op_sel:[0,0,1] op_sel_hi:[1,0,1]
  v_pk_fma_f32 v[156:157], v[224:225], s[56:57], v[156:157] op_sel:[0,1,0] op_sel_hi:[1,1,1]
  v_pk_fma_f32 v[158:159], v[208:209], s[56:57], v[158:159] op_sel:[0,1,0] op_sel_hi:[1,1,1] neg_lo:[1,0,0] neg_hi:[1,0,0]
  s_waitcnt lgkmcnt(2)
  v_cvt_pk_f16_f32 v160, v156, v157
  v_cvt_pk_f16_f32 v161, v158, v159
  v_pk_mul_f16 v162, v160, v80
  v_pk_mul_f16 v163, v161, v80
  v_pk_fma_f16 v132, v161, v82, v162
  v_pk_fma_f16 v134, v160, v82, v163 neg_lo:[1,0,0] neg_hi:[1,0,0]
  v_pk_fma_f32 v[164:165], v[178:179], s[56:57], v[16:17] op_sel:[0,0,0] op_sel_hi:[1,0,0]
  v_pk_fma_f32 v[166:167], v[194:195], s[56:57], v[16:17] op_sel:[0,0,1] op_sel_hi:[1,0,1]
  v_pk_fma_f32 v[164:165], v[226:227], s[56:57], v[164:165] op_sel:[0,1,0] op_sel_hi:[1,1,1]
  v_pk_fma_f32 v[166:167], v[210:211], s[56:57], v[166:167] op_sel:[0,1,0] op_sel_hi:[1,1,1] neg_lo:[1,0,0] neg_hi:[1,0,0]
  v_cvt_pk_f16_f32 v168, v164, v165
  v_cvt_pk_f16_f32 v169, v166, v167
  v_pk_mul_f16 v170, v168, v81
  v_pk_mul_f16 v171, v169, v81
  v_pk_fma_f16 v133, v169, v83, v170
  v_pk_fma_f16 v135, v168, v83, v171 neg_lo:[1,0,0] neg_hi:[1,0,0]
  v_pk_fma_f32 v[156:157], v[180:181], s[56:57], v[16:17] op_sel:[0,0,0] op_sel_hi:[1,0,0]
  v_pk_fma_f32 v[158:159], v[196:197], s[56:57], v[16:17] op_sel:[0,0,1] op_sel_hi:[1,0,1]
  v_pk_fma_f32 v[156:157], v[228:229], s[56:57], v[156:157] op_sel:[0,1,0] op_sel_hi:[1,1,1]
  v_pk_fma_f32 v[158:159], v[212:213], s[56:57], v[158:159] op_sel:[0,1,0] op_sel_hi:[1,1,1] neg_lo:[1,0,0] neg_hi:[1,0,0]
  s_nop 1
  v_mfma_f32_32x32x16_f16 v[112:127], v[132:135], v[96:99], 0
  v_cvt_pk_f16_f32 v160, v156, v157
  v_cvt_pk_f16_f32 v161, v158, v159
  v_pk_mul_f16 v162, v160, v84
  v_pk_mul_f16 v163, v161, v84
  v_pk_fma_f16 v136, v161, v86, v162
  v_pk_fma_f16 v138, v160, v86, v163 neg_lo:[1,0,0] neg_hi:[1,0,0]
  v_pk_fma_f32 v[164:165], v[182:183], s[56:57], v[16:17] op_sel:[0,0,0] op_sel_hi:[1,0,0]
  v_pk_fma_f32 v[166:167], v[198:199], s[56:57], v[16:17] op_sel:[0,0,1] op_sel_hi:[1,0,1]
  v_pk_fma_f32 v[164:165], v[230:231], s[56:57], v[164:165] op_sel:[0,1,0] op_sel_hi:[1,1,1]
  v_pk_fma_f32 v[166:167], v[214:215], s[56:57], v[166:167] op_sel:[0,1,0] op_sel_hi:[1,1,1] neg_lo:[1,0,0] neg_hi:[1,0,0]
  v_cvt_pk_f16_f32 v168, v164, v165
  v_cvt_pk_f16_f32 v169, v166, v167
  v_pk_mul_f16 v170, v168, v85
  v_pk_mul_f16 v171, v169, v85
  v_pk_fma_f16 v137, v169, v87, v170
  v_pk_fma_f16 v139, v168, v87, v171 neg_lo:[1,0,0] neg_hi:[1,0,0]
  v_pk_fma_f32 v[156:157], v[184:185], s[56:57], v[16:17] op_sel:[0,0,0] op_sel_hi:[1,0,0]
  v_pk_fma_f32 v[158:159], v[200:201], s[56:57], v[16:17] op_sel:[0,0,1] op_sel_hi:[1,0,1]
  v_pk_fma_f32 v[156:157], v[232:233], s[56:57], v[156:157] op_sel:[0,1,0] op_sel_hi:[1,1,1]
  v_pk_fma_f32 v[158:159], v[216:217], s[56:57], v[158:159] op_sel:[0,1,0] op_sel_hi:[1,1,1] neg_lo:[1,0,0] neg_hi:[1,0,0]
  s_nop 1
  v_mfma_f32_32x32x16_f16 v[112:127], v[136:139], v[100:103], v[112:127]
  s_cmp_ge_u32 s3, 4
  s_cbranch_scc1 L_yb0
  buffer_load_dwordx4 v2, s[16:19], s63 offen offset:0 lds
  buffer_load_dwordx4 v2, s[16:19], s63 offen offset:1024 lds
L_yb0:
  v_cvt_pk_f16_f32 v160, v156, v157
  v_cvt_pk_f16_f32 v161, v158, v159
  v_pk_mul_f16 v162, v160, v88
  v_pk_mul_f16 v163, v161, v88
  v_pk_fma_f16 v140, v161, v90, v162
  v_pk_fma_f16 v142, v160, v90, v163 neg_lo:[1,0,0] neg_hi:[1,0,0]
  v_pk_fma_f32 v[164:165], v[186:187], s[56:57], v[16:17] op_sel:[0,0,0] op_sel_hi:[1,0,0]
  v_pk_fma_f32 v[166:167], v[202:203], s[56:57], v[16:17] op_sel:[0,0,1] op_sel_hi:[1,0,1]
  v_pk_fma_f32 v[164:165], v[234:235], s[56:57], v[164:165] op_sel:[0,1,0] op_sel_hi:[1,1,1]
  v_pk_fma_f32 v[166:167], v[218:219], s[56:57], v[166:167] op_sel:[0,1,0] op_sel_hi:[1,1,1] neg_lo:[1,0,0] neg_hi:[1,0,0]
  s_cmp_ge_u32 s3, 4
  s_cbranch_scc1 L_yb1
  buffer_load_dwordx4 v2, s[16:19], s63 offen offset:2048 lds
  buffer_load_dwordx4 v2, s[16:19], s63 offen offset:3072 lds
L_yb1:
  v_cvt_pk_f16_f32 v168, v164, v165
  v_cvt_pk_f16_f32 v169, v166, v167
  v_pk_mul_f16 v170, v168, v89
  v_pk_mul_f16 v171, v169, v89
  v_pk_fma_f16 v141, v169, v91, v170
  v_pk_fma_f16 v143, v168, v91, v171 neg_lo:[1,0,0] neg_hi:[1,0,0]
  v_pk_fma_f32 v[156:157], v[188:189], s[56:57], v[16:17] op_sel:[0,0,0] op_sel_hi:[1,0,0]
  v_pk_fma_f32 v[158:159], v[204:205], s[56:57], v[16:17] op_sel:[0,0,1] op_sel_hi:[1,0,1]
  v_pk_fma_f32 v[156:157], v[236:237], s[56:57], v[156:157] op_sel:[0,1,0] op_sel_hi:[1,1,1]
  v_pk_fma_f32 v[158:159], v[220:221], s[56:57], v[158:159] op_sel:[0,1,0] op_sel_hi:[1,1,1] neg_lo:[1,0,0] neg_hi:[1,0,0]
  s_nop 1
  v_mfma_f32_32x32x16_f16 v[112:127], v[140:143], v[104:107], v[112:127]
  s_cmp_ge_u32 s3, 4
  s_cbranch_scc1 L_yb2
  s_add_u32 m0, m0, 4096
  s_add_u32 s63, s63, 4096
  buffer_load_dwordx4 v2, s[16:19], s63 offen offset:0 lds
  buffer_load_dwordx4 v2, s[16:19], s63 offen offset:1024 lds
L_yb2:
  v_cvt_pk_f16_f32 v160, v156, v157
  v_cvt_pk_f16_f32 v161, v158, v159
  v_pk_mul_f16 v162, v160, v92
  v_pk_mul_f16 v163, v161, v92
  v_pk_fma_f16 v144, v161, v94, v162
  v_pk_fma_f16 v146, v160, v94, v163 neg_lo:[1,0,0] neg_hi:[1,0,0]
  v_pk_fma_f32 v[164:165], v[190:191], s[56:57], v[16:17] op_sel:[0,0,0] op_sel_hi:[1,0,0]
  v_pk_fma_f32 v[166:167], v[206:207], s[56:57], v[16:17] op_sel:[0,0,1] op_sel_hi:[1,0,1]
  v_pk_fma_f32 v[164:165], v[238:239], s[56:57], v[164:165] op_sel:[0,1,0] op_sel_hi:[1,1,1]
  v_pk_fma_f32 v[166:167], v[222:223], s[56:57], v[166:167] op_sel:[0,1,0] op_sel_hi:[1,1,1] neg_lo:[1,0,0] neg_hi:[1,0,0]
  s_cmp_ge_u32 s3, 4
  s_cbranch_scc1 L_yb3
  buffer_load_dwordx4 v2, s[16:19], s63 offen offset:2048 lds
  buffer_load_dwordx4 v2, s[16:19], s63 offen offset:3072 lds
  s_sub_u32 m0, m0, 4096
  s_sub_u32 s63, s63, 4096
L_yb3:
  v_cvt_pk_f16_f32 v168, v164, v165
  v_cvt_pk_f16_f32 v169, v166, v167
  v_pk_mul_f16 v170, v168, v93
  v_pk_mul_f16 v171, v169, v93
  v_pk_fma_f16 v145, v169, v95, v170
  v_pk_fma_f16 v147, v168, v95, v171 neg_lo:[1,0,0] neg_hi:[1,0,0]
  s_nop 1
  v_mfma_f32_32x32x16_f16 v[112:127], v[144:147], v[108:111], v[112:127]
  s_and_b32 s37, s24, 0x3333
  s_and_b32 s38, s24, 0xcccc
  s_lshl_b32 s38, s38, 14
  s_or_b32 s37, s37, s38
  s_and_b32 s25, s37, 0x30003
  s_lshr_b32 s38, s37, 4
  s_and_b32 s26, s38, 0x30003
  s_lshr_b32 s38, s37, 8
  s_and_b32 s27, s38, 0x30003
  s_lshr_b32 s38, s37, 12
  s_and_b32 s28, s38, 0x30003
  s_nop 0
  v_cvt_pk_f16_f32 v148, v112, v113
  v_cvt_pk_f16_f32 v149, v114, v115
  v_cvt_pk_f16_f32 v150, v116, v117
  v_cvt_pk_f16_f32 v151, v118, v119
  ds_write_b128 v12, v[148:151]
  v_cvt_pk_f16_f32 v152, v120, v121
  v_cvt_pk_f16_f32 v153, v122, v123
  v_cvt_pk_f16_f32 v154, v124, v125
  v_cvt_pk_f16_f32 v155, v126, v127
  ds_write_b128 v13, v[152:155]
  ds_write_b16_d16_hi v14, v151
  ds_write_b16_d16_hi v15, v155
  s_cmp_lg_u32 s62, 0
  s_cbranch_scc0 L_job2
L_jobx:
  s_lshl_b32 s37, s2, 14
  s_lshl_b32 s38, s3, 8
  s_add_u32 s37, s37, s38
  s_add_u32 s37, s37, 1048576
  s_waitcnt lgkmcnt(0)
  s_barrier
  ds_read_b64_tr_b16 v[132:133], v20 offset:0
  ds_read_b64_tr_b16 v[134:135], v20 offset:4352
  ds_read_b64_tr_b16 v[136:137], v20 offset:8
  ds_read_b64_tr_b16 v[138:139], v20 offset:4360
  ds_read_b64_tr_b16 v[140:141], v20 offset:256
  ds_read_b64_tr_b16 v[142:143], v20 offset:4608
  ds_read_b64_tr_b16 v[144:145], v20 offset:264
  ds_read_b64_tr_b16 v[146:147], v20 offset:4616
  s_cmp_lg_u32 s3, 6
  s_cbranch_scc1 L_noext0
  ds_read_u16 v176, v24 offset:0
  ds_read_u16 v180, v25 offset:0
  ds_read_u16 v177, v24 offset:2176
  ds_read_u16 v181, v25 offset:2176
  ds_read_u16 v178, v24 offset:4352
  ds_read_u16 v182, v25 offset:4352
  ds_read_u16 v179, v24 offset:6528
  ds_read_u16 v183, v25 offset:6528
  s_lshl_b32 s38, s2, 9
  s_add_u32 s38, s38, 65536
  s_add_u32 s39, s38, 64
  v_mov_b32 v193, s24
  v_mov_b32 v195, s24
  s_waitcnt lgkmcnt(0)
  v_lshl_or_b32 v176, v180, 16, v176
  v_lshl_or_b32 v177, v181, 16, v177
  v_lshl_or_b32 v178, v182, 16, v178
  v_lshl_or_b32 v179, v183, 16, v179
  s_nop 1
  v_mfma_f32_16x16x32_f16 v[188:191], v[128:131], v[176:179], 0
L_noext0:
  s_waitcnt lgkmcnt(6)
  v_mfma_f32_16x16x32_f16 v[156:159], v[128:131], v[132:135], 0
  s_waitcnt lgkmcnt(4)
  v_mfma_f32_16x16x32_f16 v[160:163], v[128:131], v[136:139], 0
  s_waitcnt lgkmcnt(2)
  v_mfma_f32_16x16x32_f16 v[164:167], v[128:131], v[140:143], 0
  s_waitcnt lgkmcnt(0)
  v_mfma_f32_16x16x32_f16 v[168:171], v[128:131], v[144:147], 0
  s_cmp_lg_u32 s3, 6
  s_cbranch_scc1 L_noext
  v_cvt_pk_f16_f32 v192, v188, v189
  v_cvt_pk_f16_f32 v194, v190, v191
  s_mov_b32 exec_lo, 0xff00ff
  s_mov_b32 exec_hi, 0xff00ff
  buffer_store_dwordx2 v[192:193], v26, s[8:11], s38 offen sc1
  buffer_store_dwordx2 v[194:195], v26, s[8:11], s39 offen sc1
  s_mov_b64 exec, -1
L_noext:
  s_nop 1
  v_cvt_pk_f16_f32 v148, v156, v160
  s_nop 2
  v_cvt_pk_f16_f32 v149, v164, v168
  v_cvt_pk_f16_f32 v150, v157, v161
  v_cvt_pk_f16_f32 v151, v165, v169
  v_add_u32 v148, 0x20002, v148
  v_add_u32 v149, 0x20002, v149
  v_add_u32 v150, 0x20002, v150
  v_add_u32 v151, 0x20002, v151
  v_and_or_b32 v148, v148, v11, s25
  v_and_or_b32 v149, v149, v11, s26
  v_and_or_b32 v150, v150, v11, s27
  v_and_or_b32 v151, v151, v11, s28
  buffer_store_dwordx4 v[148:151], v22, s[8:11], s37 offen offset:0 sc1
  v_cvt_pk_f16_f32 v152, v158, v162
  v_cvt_pk_f16_f32 v153, v166, v170
  v_cvt_pk_f16_f32 v154, v159, v163
  v_cvt_pk_f16_f32 v155, v167, v171
  v_add_u32 v152, 0x20002, v152
  v_add_u32 v153, 0x20002, v153
  v_add_u32 v154, 0x20002, v154
  v_add_u32 v155, 0x20002, v155
  v_and_or_b32 v152, v152, v11, s25
  v_and_or_b32 v153, v153, v11, s26
  v_and_or_b32 v154, v154, v11, s27
  v_and_or_b32 v155, v155, v11, s28
  buffer_store_dwordx4 v[152:155], v22, s[8:11], s37 offen offset:2048 sc1
  s_barrier
  buffer_load_dwordx4 v[240:243], v172, s[4:7], 0 offen
  buffer_load_dwordx4 v[244:247], v173, s[4:7], 0 offen
  buffer_load_dwordx4 v[248:251], v174, s[4:7], 0 offen
  buffer_load_dwordx4 v[252:255], v175, s[4:7], 0 offen
  ds_read_b128 v[4:7], v2 offset:48640
  ds_read_b128 v[8:11], v2 offset:49664
  ds_read_b64 v[230:231], v2 offset:50696
  v_and_b32 v228, 0x1f8, v0
  v_sub_u32 v229, 57336, v228
  v_add_u32 v228, 55808, v228
  s_and_b32 s52, s3, 3
  s_lshl_b32 s36, s52, 13
  s_add_u32 s36, s36, 79552
  v_add_u32 v236, s36, v2
  s_lshl_b32 s48, s40, 11
  s_lshl_b32 s49, s42, 8
  s_add_u32 s48, s48, s49
  s_add_u32 s48, s48, 1048576
  s_lshl_b32 s36, s3, 16
  s_sub_u32 s49, s48, s36
  s_add_u32 s48, s48, s36
  s_add_u32 s54, s48, 524288
  s_add_u32 s55, s49, 999424
  s_add_u32 s49, s49, 1523712
  s_cmp_eq_u32 s41, 0
  s_mov_b32 s50, 0xbc00bc00
  s_cmov_b32 s50, 0x3c003c00
  s_lshr_b32 s51, s3, 2
  s_cmp_eq_u32 s3, 0
  s_cselect_b32 s38, 0xffff, 0
  s_mov_b32 s39, 0
  v_mov_b32 v232, s25
  v_mov_b32 v233, s26
  v_mov_b32 v234, s27
  v_mov_b32 v235, s28
  v_mov_b32 v25, 0x40000000
  s_lshl_b32 s36, s3, 10
  s_lshl_b32 s37, s51, 6
  s_waitcnt lgkmcnt(0)
  v_add_u32 v24, 0x100000, v5
  v_add_u32 v6, s36, v6
  v_cndmask_b32_e64 v24, v24, v5, s[38:39]
  v_xor_b32 v7, s37, v7
  s_mul_i32 s36, s52, 4608
  s_lshl_b32 s37, s51, 5
  v_add_u32 v11, s36, v11
  s_add_u32 s36, s36, s37
  s_mul_i32 s37, s3, 1152
  v_add_u32 v9, s36, v9
  v_add_u32 v10, s37, v10
  s_cmp_lt_u32 s3, 5
  s_cbranch_scc1 L_y0
  s_cmp_eq_u32 s3, 5
  s_cbranch_scc1 L_y01
  s_cmp_eq_u32 s3, 6
  s_cbranch_scc1 L_y00
  s_and_b32 s45, s2, 7
  s_lshl_b32 s45, s45, 11
  s_add_u32 s45, s45, 131072
  buffer_load_dwordx4 v[164:167], v2, s[8:11], s45 offen sc1
  buffer_load_dwordx4 v[168:171], v2, s[8:11], s45 offen offset:1024 sc1
  s_branch L_y0
L_y01:
  s_sub_u32 s45, 16, s43
  s_and_b32 s45, s45, 15
  s_cselect_b32 s37, 0, 16
  s_lshl_b32 s45, s45, 12
  s_lshl_b32 s44, s43, 12
  s_add_u32 s45, s45, s37
  s_add_u32 s44, s44, 196608
  s_add_u32 s45, s45, 196608
  buffer_load_dwordx3 v[112:114], v2, s[8:11], s44 offen offset:0 sc1
  buffer_load_dwordx3 v[116:118], v2, s[8:11], s44 offen offset:1024 sc1
  buffer_load_dwordx3 v[120:122], v2, s[8:11], s45 offen offset:0 sc1
  buffer_load_dwordx3 v[124:126], v2, s[8:11], s45 offen offset:1024 sc1
  s_branch L_y0
L_y00:
  s_lshl_b32 s37, s40, 6
  s_lshl_b32 s38, s42, 3
  s_add_u32 s37, s37, s38
  s_add_u32 s45, s37, 65536
  buffer_load_dwordx2 v[164:165], v230, s[8:11], s45 offen sc1
  buffer_load_dwordx2 v[166:167], v231, s[8:11], s45 offen sc1
L_y0:
  buffer_load_dwordx4 v[96:99], v4, s[8:11], s48 offen sc1
  buffer_load_dwordx4 v[100:103], v24, s[8:11], s55 offen sc1
  buffer_load_dwordx4 v[104:107], v4, s[8:11], s54 offen sc1
  buffer_load_dwordx4 v[108:111], v5, s[8:11], s49 offen sc1
  s_cmp_lg_u32 s3, 5
  s_cbranch_scc1 L_y02
  s_mov_b32 s63, 0
  s_waitcnt vmcnt(4)
  s_branch P_1_c
P_1:
  buffer_load_dwordx3 v[112:114], v2, s[8:11], s44 offen offset:0 sc1
  buffer_load_dwordx3 v[116:118], v2, s[8:11], s44 offen offset:1024 sc1
  buffer_load_dwordx3 v[120:122], v2, s[8:11], s45 offen offset:0 sc1
  buffer_load_dwordx3 v[124:126], v2, s[8:11], s45 offen offset:1024 sc1
  s_waitcnt vmcnt(0)
P_1_c:
  v_cmp_ne_u32 vcc, s24, v114
  v_cmp_ne_u32 s[38:39], s24, v118
  s_or_b64 vcc, vcc, s[38:39]
  v_cmp_ne_u32 s[38:39], s24, v122
  s_or_b64 vcc, vcc, s[38:39]
  v_cmp_ne_u32 s[38:39], s24, v126
  s_or_b64 vcc, vcc, s[38:39]
  s_cbranch_vccz P_1_x
  s_add_u32 s63, s63, 1
  s_cmp_lt_u32 s63, 65536
  s_cbranch_scc1 P_1
P_1_x:
  v_lshlrev_b32 v16, 3, v1
  v_add_f32 v112, 1.0, v112
  ds_write_b64 v16, v[112:113] offset:55808
  v_add_f32 v116, 1.0, v116
  ds_write_b64 v16, v[116:117] offset:56320
  v_add_f32 v120, 1.0, v120
  ds_write_b64 v16, v[120:121] offset:56832
  v_add_f32 v124, 1.0, v124
  ds_write_b64 v16, v[124:125] offset:57344
L_y02:
  s_cmp_ge_u32 s3, 6
  s_cbranch_scc1 L_w7
  s_waitcnt vmcnt(4)
L_w7:
  s_waitcnt vmcnt(6) lgkmcnt(0)
  s_barrier
  s_mov_b32 exec_lo, 0
  global_load_dword v27, v3, s[30:31]
  s_mov_b64 exec, -1
  ds_read2_b64 v[112:115], v228 offset1:64
  ds_read2_b64 v[116:119], v229 offset1:64
  ds_read_b128 v[32:35], v236 offset:0
  ds_read_b128 v[36:39], v236 offset:1024
  ds_read_b128 v[40:43], v236 offset:2048
  ds_read_b128 v[44:47], v236 offset:3072
  ds_read_b128 v[48:51], v236 offset:4096
  ds_read_b128 v[52:55], v236 offset:5120
  ds_read_b128 v[56:59], v236 offset:6144
  ds_read_b128 v[60:63], v236 offset:7168
  v_lshlrev_b32 v64, 16, v240
  v_and_b32 v65, 0xffff0000, v240
  s_waitcnt lgkmcnt(9)
  v_pk_fma_f32 v[64:65], v[64:65], v[112:113], v[112:113] op_sel:[0,0,1] op_sel_hi:[1,0,1] neg_lo:[0,0,1] neg_hi:[0,0,1]
  v_lshlrev_b32 v66, 16, v241
  v_and_b32 v67, 0xffff0000, v241
  v_pk_fma_f32 v[66:67], v[66:67], v[112:113], v[112:113] op_sel:[0,0,1] op_sel_hi:[1,0,1] neg_lo:[0,0,1] neg_hi:[0,0,1]
  v_lshlrev_b32 v68, 16, v242
  v_and_b32 v69, 0xffff0000, v242
  v_pk_fma_f32 v[68:69], v[68:69], v[112:113], v[112:113] op_sel:[0,0,1] op_sel_hi:[1,0,1] neg_lo:[0,0,1] neg_hi:[0,0,1]
  v_lshlrev_b32 v70, 16, v243
  v_and_b32 v71, 0xffff0000, v243
  v_pk_fma_f32 v[70:71], v[70:71], v[112:113], v[112:113] op_sel:[0,0,1] op_sel_hi:[1,0,1] neg_lo:[0,0,1] neg_hi:[0,0,1]
  v_lshlrev_b32 v80, 16, v248
  v_and_b32 v81, 0xffff0000, v248
  v_pk_fma_f32 v[80:81], v[80:81], v[114:115], v[114:115] op_sel:[0,0,1] op_sel_hi:[1,0,1] neg_lo:[0,0,1] neg_hi:[0,0,1]
  v_lshlrev_b32 v82, 16, v249
  v_and_b32 v83, 0xffff0000, v249
  v_pk_fma_f32 v[82:83], v[82:83], v[114:115], v[114:115] op_sel:[0,0,1] op_sel_hi:[1,0,1] neg_lo:[0,0,1] neg_hi:[0,0,1]
  v_lshlrev_b32 v84, 16, v250
  v_and_b32 v85, 0xffff0000, v250
  v_pk_fma_f32 v[84:85], v[84:85], v[114:115], v[114:115] op_sel:[0,0,1] op_sel_hi:[1,0,1] neg_lo:[0,0,1] neg_hi:[0,0,1]
  v_lshlrev_b32 v86, 16, v251
  v_and_b32 v87, 0xffff0000, v251
  v_pk_fma_f32 v[86:87], v[86:87], v[114:115], v[114:115] op_sel:[0,0,1] op_sel_hi:[1,0,1] neg_lo:[0,0,1] neg_hi:[0,0,1]
  v_lshlrev_b32 v88, 16, v252
  v_and_b32 v89, 0xffff0000, v252
  s_waitcnt lgkmcnt(8)
  v_pk_fma_f32 v[88:89], v[88:89], v[116:117], v[116:117] op_sel:[0,0,1] op_sel_hi:[1,0,1] neg_lo:[0,0,1] neg_hi:[0,0,1]
  v_lshlrev_b32 v90, 16, v253
  v_and_b32 v91, 0xffff0000, v253
  v_pk_fma_f32 v[90:91], v[90:91], v[116:117], v[116:117] op_sel:[0,0,1] op_sel_hi:[1,0,1] neg_lo:[0,0,1] neg_hi:[0,0,1]
  v_lshlrev_b32 v92, 16, v254
  v_and_b32 v93, 0xffff0000, v254
  v_pk_fma_f32 v[92:93], v[92:93], v[116:117], v[116:117] op_sel:[0,0,1] op_sel_hi:[1,0,1] neg_lo:[0,0,1] neg_hi:[0,0,1]
  v_lshlrev_b32 v94, 16, v255
  v_and_b32 v95, 0xffff0000, v255
  v_pk_fma_f32 v[94:95], v[94:95], v[116:117], v[116:117] op_sel:[0,0,1] op_sel_hi:[1,0,1] neg_lo:[0,0,1] neg_hi:[0,0,1]
  v_lshlrev_b32 v72, 16, v244
  v_and_b32 v73, 0xffff0000, v244
  v_pk_fma_f32 v[72:73], v[72:73], v[118:119], v[118:119] op_sel:[0,0,1] op_sel_hi:[1,0,1] neg_lo:[0,0,1] neg_hi:[0,0,1]
  v_lshlrev_b32 v74, 16, v245
  v_and_b32 v75, 0xffff0000, v245
  v_pk_fma_f32 v[74:75], v[74:75], v[118:119], v[118:119] op_sel:[0,0,1] op_sel_hi:[1,0,1] neg_lo:[0,0,1] neg_hi:[0,0,1]
  v_lshlrev_b32 v76, 16, v246
  v_and_b32 v77, 0xffff0000, v246
  v_pk_fma_f32 v[76:77], v[76:77], v[118:119], v[118:119] op_sel:[0,0,1] op_sel_hi:[1,0,1] neg_lo:[0,0,1] neg_hi:[0,0,1]
  v_lshlrev_b32 v78, 16, v247
  v_and_b32 v79, 0xffff0000, v247
  v_pk_fma_f32 v[78:79], v[78:79], v[118:119], v[118:119] op_sel:[0,0,1] op_sel_hi:[1,0,1] neg_lo:[0,0,1] neg_hi:[0,0,1]
  s_cmp_lg_u32 s3, 7
  s_cbranch_scc1 L_y1
  s_mov_b32 s63, 0
  s_waitcnt vmcnt(5)
  s_branch P_2_c
P_2:
  buffer_load_dwordx4 v[164:167], v2, s[8:11], s45 offen sc1
  buffer_load_dwordx4 v[168:171], v2, s[8:11], s45 offen offset:1024 sc1
  s_waitcnt vmcnt(0)
P_2_c:
  v_cmp_ne_u32 vcc, s24, v166
  v_cmp_ne_u32 s[38:39], s24, v170
  s_or_b64 vcc, vcc, s[38:39]
  s_cbranch_vccz P_2_x
  s_add_u32 s63, s63, 1
  s_cmp_lt_u32 s63, 65536
  s_cbranch_scc1 P_2
P_2_x:
  v_max_u32 v166, v164, v168
  v_min_u32 v170, v164, v168
  v_max3_u32 v167, v170, v165, v169
  s_nop 0
  v_min_u32_dpp v170, v166, v166 row_ror:8 row_mask:0xf bank_mask:0xf
  v_max_u32_dpp v167, v167, v167 row_ror:8 row_mask:0xf bank_mask:0xf
  v_max_u32_dpp v166, v166, v166 row_ror:8 row_mask:0xf bank_mask:0xf
  v_max_u32 v167, v167, v170
  s_nop 0
  v_min_u32_dpp v170, v166, v166 row_ror:4 row_mask:0xf bank_mask:0xf
  v_max_u32_dpp v167, v167, v167 row_ror:4 row_mask:0xf bank_mask:0xf
  v_max_u32_dpp v166, v166, v166 row_ror:4 row_mask:0xf bank_mask:0xf
  v_max_u32 v167, v167, v170
  s_nop 0
  v_min_u32_dpp v170, v166, v166 row_ror:2 row_mask:0xf bank_mask:0xf
  v_max_u32_dpp v167, v167, v167 row_ror:2 row_mask:0xf bank_mask:0xf
  v_max_u32_dpp v166, v166, v166 row_ror:2 row_mask:0xf bank_mask:0xf
  v_max_u32 v167, v167, v170
  s_nop 0
  v_min_u32_dpp v170, v166, v166 row_ror:1 row_mask:0xf bank_mask:0xf
  v_max_u32_dpp v167, v167, v167 row_ror:1 row_mask:0xf bank_mask:0xf
  v_max_u32_dpp v166, v166, v166 row_ror:1 row_mask:0xf bank_mask:0xf
  v_max_u32 v167, v167, v170
  s_nop 0
  v_min_u32_dpp v170, v166, v166 row_bcast:15 row_mask:0xa bank_mask:0xf
  v_max_u32_dpp v167, v167, v167 row_bcast:15 row_mask:0xa bank_mask:0xf
  v_max_u32_dpp v166, v166, v166 row_bcast:15 row_mask:0xa bank_mask:0xf
  v_max_u32 v167, v167, v170
  s_nop 0
  v_min_u32_dpp v170, v166, v166 row_bcast:31 row_mask:0xc bank_mask:0xf
  v_max_u32_dpp v167, v167, v167 row_bcast:31 row_mask:0xc bank_mask:0xf
  v_max_u32_dpp v166, v166, v166 row_bcast:31 row_mask:0xc bank_mask:0xf
  v_max_u32 v167, v167, v170
  v_readlane_b32 s46, v166, 63
  v_readlane_b32 s47, v167, 63
  s_nop 0
  v_mov_b32 v16, s46
  v_mov_b32 v17, s47
  v_mov_b32 v18, 0
  ds_write_b64 v18, v[16:17] offset:59904
L_y1:
  s_cmp_lg_u32 s3, 6
  s_cbranch_scc1 L_y2
  s_mov_b32 s63, 0
  s_waitcnt vmcnt(5)
  s_branch P_3_c
P_3:
  buffer_load_dwordx2 v[164:165], v230, s[8:11], s45 offen sc1
  buffer_load_dwordx2 v[166:167], v231, s[8:11], s45 offen sc1
  s_waitcnt vmcnt(0)
P_3_c:
  v_cmp_ne_u32 vcc, s24, v165
  v_cmp_ne_u32 s[38:39], s24, v167
  s_or_b64 vcc, vcc, s[38:39]
  s_cbranch_vccz P_3_x
  s_add_u32 s63, s63, 1
  s_cmp_lt_u32 s63, 65536
  s_cbranch_scc1 P_3
P_3_x:
  s_cmp_eq_u32 s41, 0
  s_mov_b32 s38, 0x07060100
  s_cmov_b32 s38, 0x05040100
  v_lshrrev_b32 v17, 16, v164
  v_perm_b32 v16, v166, v164, s38
  s_mov_b64 exec, 1
  v_mov_b32 v164, v16
  v_mov_b32 v166, v17
  s_mov_b64 exec, -1
  v_lshrrev_b32 v18, 7, v230
  v_pk_fma_f16 v164, v166, s50, v164 neg_hi:[0,1,0]
  ds_write_b32 v18, v164 offset:16384
L_y2:
  s_mov_b32 s63, 0
  s_waitcnt vmcnt(1)
  s_branch P_4_c
P_4:
  buffer_load_dwordx4 v[96:99], v4, s[8:11], s48 offen sc1
  buffer_load_dwordx4 v[100:103], v24, s[8:11], s55 offen sc1
  buffer_load_dwordx4 v[104:107], v4, s[8:11], s54 offen sc1
  buffer_load_dwordx4 v[108:111], v5, s[8:11], s49 offen sc1
  s_waitcnt vmcnt(0)
P_4_c:
  v_xor_b32 v96, v232, v96
  v_xor_b32 v97, v233, v97
  v_xor_b32 v98, v234, v98
  v_xor_b32 v99, v235, v99
  v_xor_b32 v100, v232, v100
  v_xor_b32 v101, v233, v101
  v_xor_b32 v102, v234, v102
  v_xor_b32 v103, v235, v103
  v_xor_b32 v104, v232, v104
  v_xor_b32 v105, v233, v105
  v_xor_b32 v106, v234, v106
  v_xor_b32 v107, v235, v107
  v_xor_b32 v108, v232, v108
  v_xor_b32 v109, v233, v109
  v_xor_b32 v110, v234, v110
  v_xor_b32 v111, v235, v111
  v_or3_b32 v16, v96, v97, v98
  v_or3_b32 v16, v16, v99, v100
  v_or3_b32 v16, v16, v101, v102
  v_or3_b32 v16, v16, v103, v104
  v_or3_b32 v16, v16, v105, v106
  v_or3_b32 v16, v16, v107, v108
  v_or3_b32 v16, v16, v109, v110
  v_or_b32 v16, v16, v111
  v_and_b32 v16, 0x30003, v16
  v_cmp_ne_u32 vcc, 0, v16
  s_cbranch_vccz P_4_x
  s_add_u32 s63, s63, 1
  s_cmp_lt_u32 s63, 65536
  s_cbranch_scc1 P_4
P_4_x:
  s_cmp_lg_u32 s3, 0
  s_cbranch_scc1 L_y3
  s_cmp_eq_u32 s41, 0
  s_cselect_b64 s[38:39], 0, -1
  s_mov_b64 exec, 0xffff
  v_cndmask_b32_e64 v16, v100, v102, s[38:39]
  v_cndmask_b32_e64 v17, v101, v103, s[38:39]
  v_mov_b32 v100, v98
  v_mov_b32 v101, v99
  v_mov_b32 v98, v16
  v_mov_b32 v99, v17
  v_mov_b32 v102, 0
  v_mov_b32 v103, 0
  s_mov_b64 exec, -1
L_y3:
  v_pk_fma_f16 v96, v100, s50, v96
  v_pk_fma_f16 v97, v101, s50, v97
  v_pk_fma_f16 v98, v102, s50, v98 neg_lo:[0,1,0] neg_hi:[0,1,0]
  v_pk_fma_f16 v99, v103, s50, v99 neg_lo:[0,1,0] neg_hi:[0,1,0]
  ds_write_b128 v6, v[96:99] offset:0
  v_pk_fma_f16 v104, v108, s50, v104
  v_pk_fma_f16 v105, v109, s50, v105
  v_pk_fma_f16 v106, v110, s50, v106 neg_lo:[0,1,0] neg_hi:[0,1,0]
  v_pk_fma_f16 v107, v111, s50, v107 neg_lo:[0,1,0] neg_hi:[0,1,0]
  ds_write_b128 v6, v[104:107] offset:8192
  v_mov_b32 v18, 0
  s_waitcnt lgkmcnt(0)
  s_barrier
  ds_read_b64 v[16:17], v18 offset:59904
  s_cmp_lg_u32 s51, 0
  s_cbranch_scc1 L_y4
  ds_read_b64_tr_b16 v[132:133], v7 offset:0
  ds_read_b64_tr_b16 v[134:135], v7 offset:512
  ds_read_b64_tr_b16 v[136:137], v7 offset:2048
  ds_read_b64_tr_b16 v[138:139], v7 offset:2560
  ds_read_b64_tr_b16 v[140:141], v7 offset:4096
  ds_read_b64_tr_b16 v[142:143], v7 offset:4608
  ds_read_b64_tr_b16 v[144:145], v7 offset:6144
  ds_read_b64_tr_b16 v[146:147], v7 offset:6656
  ds_read_b64_tr_b16 v[148:149], v7 offset:8192
  ds_read_b64_tr_b16 v[150:151], v7 offset:8704
  ds_read_b64_tr_b16 v[152:153], v7 offset:10240
  ds_read_b64_tr_b16 v[154:155], v7 offset:10752
  ds_read_b64_tr_b16 v[156:157], v7 offset:12288
  ds_read_b64_tr_b16 v[158:159], v7 offset:12800
  s_waitcnt lgkmcnt(12)
  v_mfma_f32_32x32x16_f16 v[208:223], v[132:135], v[32:35], 0
  ds_read_b64_tr_b16 v[160:161], v7 offset:14336
  ds_read_b64_tr_b16 v[162:163], v7 offset:14848
  s_waitcnt lgkmcnt(12)
  v_mfma_f32_32x32x16_f16 v[208:223], v[136:139], v[36:39], v[208:223]
  s_waitcnt lgkmcnt(10)
  v_mfma_f32_32x32x16_f16 v[208:223], v[140:143], v[40:43], v[208:223]
  s_waitcnt lgkmcnt(8)
  v_mfma_f32_32x32x16_f16 v[208:223], v[144:147], v[44:47], v[208:223]
  v_readfirstlane_b32 s46, v16
  v_readfirstlane_b32 s47, v17
  s_and_b32 s46, s46, 0xffff
  s_and_b32 s47, s47, 0xffff
  s_sub_u32 s46, 0xffff, s46
  s_sub_u32 s47, 0xffff, s47
  v_lshrrev_b32 v16, 11, v172
  v_cmp_eq_u32 s[52:53], s46, v16
  v_cmp_eq_u32 vcc, s47, v16
  s_or_b64 s[52:53], s[52:53], vcc
  v_cndmask_b32_e64 v20, v172, v25, s[52:53]
  v_lshrrev_b32 v16, 11, v173
  v_cmp_eq_u32 s[54:55], s46, v16
  v_cmp_eq_u32 vcc, s47, v16
  s_or_b64 s[54:55], s[54:55], vcc
  v_cndmask_b32_e64 v21, v173, v25, s[54:55]
  v_lshrrev_b32 v16, 11, v174
  v_cmp_eq_u32 s[56:57], s46, v16
  v_cmp_eq_u32 vcc, s47, v16
  s_or_b64 s[56:57], s[56:57], vcc
  v_cndmask_b32_e64 v22, v174, v25, s[56:57]
  v_lshrrev_b32 v16, 11, v175
  v_cmp_eq_u32 s[58:59], s46, v16
  v_cmp_eq_u32 vcc, s47, v16
  s_or_b64 s[58:59], s[58:59], vcc
  v_cndmask_b32_e64 v23, v175, v25, s[58:59]
  s_waitcnt lgkmcnt(6)
  v_mfma_f32_32x32x16_f16 v[208:223], v[148:151], v[48:51], v[208:223]
  s_waitcnt lgkmcnt(4)
  v_mfma_f32_32x32x16_f16 v[208:223], v[152:155], v[52:55], v[208:223]
  s_waitcnt lgkmcnt(2)
  v_mfma_f32_32x32x16_f16 v[208:223], v[156:159], v[56:59], v[208:223]
  s_waitcnt lgkmcnt(0)
  v_mfma_f32_32x32x16_f16 v[208:223], v[160:163], v[60:63], v[208:223]
  s_nop 11
  v_cvt_pk_f16_f32 v112, v221, v208
  v_cvt_pk_f16_f32 v113, v212, v216
  v_cvt_pk_f16_f32 v114, v220, v209
  v_cvt_pk_f16_f32 v115, v213, v217
  ds_write_b128 v9, v[112:115] offset:16896
  v_cvt_pk_f16_f32 v116, v210, v214
  v_cvt_pk_f16_f32 v117, v218, v222
  v_cvt_pk_f16_f32 v118, v211, v215
  v_cvt_pk_f16_f32 v119, v219, v223
  ds_write_b128 v9, v[116:119] offset:16912
  s_branch L_y5
L_y4:
  ds_read_b64_tr_b16 v[132:133], v7 offset:0
  ds_read_b64_tr_b16 v[134:135], v7 offset:512
  ds_read_b128 v[176:179], v8 offset:16384
  ds_read_b64_tr_b16 v[136:137], v7 offset:2048
  ds_read_b64_tr_b16 v[138:139], v7 offset:2560
  ds_read_b128 v[180:183], v8 offset:16416
  ds_read_b64_tr_b16 v[140:141], v7 offset:4096
  ds_read_b64_tr_b16 v[142:143], v7 offset:4608
  ds_read_b128 v[184:187], v8 offset:16448
  ds_read_b64_tr_b16 v[144:145], v7 offset:6144
  ds_read_b64_tr_b16 v[146:147], v7 offset:6656
  ds_read_b128 v[188:191], v8 offset:16480
  s_waitcnt lgkmcnt(10)
  v_mfma_f32_32x32x16_f16 v[208:223], v[132:135], v[32:35], 0
  ds_read_b64_tr_b16 v[148:149], v7 offset:8192
  ds_read_b64_tr_b16 v[150:151], v7 offset:8704
  ds_read_b128 v[192:195], v8 offset:16512
  v_readfirstlane_b32 s46, v16
  v_readfirstlane_b32 s47, v17
  s_and_b32 s46, s46, 0xffff
  s_and_b32 s47, s47, 0xffff
  s_sub_u32 s46, 0xffff, s46
  s_sub_u32 s47, 0xffff, s47
  v_lshrrev_b32 v16, 11, v172
  v_cmp_eq_u32 s[52:53], s46, v16
  v_cmp_eq_u32 vcc, s47, v16
  s_or_b64 s[52:53], s[52:53], vcc
  v_cndmask_b32_e64 v20, v172, v25, s[52:53]
  v_lshrrev_b32 v16, 11, v173
  v_cmp_eq_u32 s[54:55], s46, v16
  v_cmp_eq_u32 vcc, s47, v16
  s_or_b64 s[54:55], s[54:55], vcc
  v_cndmask_b32_e64 v21, v173, v25, s[54:55]
  v_lshrrev_b32 v16, 11, v174
  v_cmp_eq_u32 s[56:57], s46, v16
  v_cmp_eq_u32 vcc, s47, v16
  s_or_b64 s[56:57], s[56:57], vcc
  v_cndmask_b32_e64 v22, v174, v25, s[56:57]
  v_lshrrev_b32 v16, 11, v175
  v_cmp_eq_u32 s[58:59], s46, v16
  v_cmp_eq_u32 vcc, s47, v16
  s_or_b64 s[58:59], s[58:59], vcc
  v_cndmask_b32_e64 v23, v175, v25, s[58:59]
  s_waitcnt lgkmcnt(10)
  v_mfma_f32_32x32x16_f16 v[208:223], v[136:139], v[36:39], v[208:223]
  ds_read_b64_tr_b16 v[152:153], v7 offset:10240
  ds_read_b64_tr_b16 v[154:155], v7 offset:10752
  ds_read_b128 v[196:199], v8 offset:16544
  v_pk_mul_f16 v224, v32, v176
  v_pk_mul_f16 v225, v33, v177
  v_pk_mul_f16 v226, v34, v178
  v_pk_mul_f16 v227, v35, v179
  s_waitcnt lgkmcnt(10)
  v_mfma_f32_32x32x16_f16 v[208:223], v[140:143], v[40:43], v[208:223]
  ds_read_b64_tr_b16 v[156:157], v7 offset:12288
  ds_read_b64_tr_b16 v[158:159], v7 offset:12800
  ds_read_b128 v[200:203], v8 offset:16576
  v_pk_fma_f16 v224, v36, v180, v224
  v_pk_fma_f16 v225, v37, v181, v225
  v_pk_fma_f16 v226, v38, v182, v226
  v_pk_fma_f16 v227, v39, v183, v227
  s_waitcnt lgkmcnt(10)
  v_mfma_f32_32x32x16_f16 v[208:223], v[144:147], v[44:47], v[208:223]
  ds_read_b64_tr_b16 v[160:161], v7 offset:14336
  ds_read_b64_tr_b16 v[162:163], v7 offset:14848
  ds_read_b128 v[204:207], v8 offset:16608
  v_pk_fma_f16 v224, v40, v184, v224
  v_pk_fma_f16 v225, v41, v185, v225
  v_pk_fma_f16 v226, v42, v186, v226
  v_pk_fma_f16 v227, v43, v187, v227
  s_waitcnt lgkmcnt(10)
  v_mfma_f32_32x32x16_f16 v[208:223], v[148:151], v[48:51], v[208:223]
  v_pk_fma_f16 v224, v44, v188, v224
  v_pk_fma_f16 v225, v45, v189, v225
  v_pk_fma_f16 v226, v46, v190, v226
  v_pk_fma_f16 v227, v47, v191, v227
  s_waitcnt lgkmcnt(7)
  v_mfma_f32_32x32x16_f16 v[208:223], v[152:155], v[52:55], v[208:223]
  v_pk_fma_f16 v224, v48, v192, v224
  v_pk_fma_f16 v225, v49, v193, v225
  v_pk_fma_f16 v226, v50, v194, v226
  v_pk_fma_f16 v227, v51, v195, v227
  s_waitcnt lgkmcnt(4)
  v_mfma_f32_32x32x16_f16 v[208:223], v[156:159], v[56:59], v[208:223]
  v_pk_fma_f16 v224, v52, v196, v224
  v_pk_fma_f16 v225, v53, v197, v225
  v_pk_fma_f16 v226, v54, v198, v226
  v_pk_fma_f16 v227, v55, v199, v227
  s_waitcnt lgkmcnt(1)
  v_mfma_f32_32x32x16_f16 v[208:223], v[160:163], v[60:63], v[208:223]
  v_pk_fma_f16 v224, v56, v200, v224
  v_pk_fma_f16 v225, v57, v201, v225
  v_pk_fma_f16 v226, v58, v202, v226
  v_pk_fma_f16 v227, v59, v203, v227
  s_waitcnt lgkmcnt(0)
  v_pk_fma_f16 v224, v60, v204, v224
  v_pk_fma_f16 v225, v61, v205, v225
  v_pk_fma_f16 v226, v62, v206, v226
  v_pk_fma_f16 v227, v63, v207, v227
  s_mov_b32 s37, 0x3c003c00
  v_pk_add_f16 v224, v224, v225
  v_pk_add_f16 v226, v226, v227
  v_dot2c_f32_f16 v18, s37, v224
  v_dot2c_f32_f16 v18, s37, v226
  s_nop 2
  v_mov_b32 v19, v18
  s_nop 1
  v_permlane32_swap_b32 v18, v19
  v_add_f32 v18, v18, v19
  v_cvt_f16_f32 v18, v18
  ds_write_b16 v11, v18 offset:16896
  v_cvt_pk_f16_f32 v112, v221, v223
  v_cvt_pk_f16_f32 v113, v219, v215
  v_cvt_pk_f16_f32 v114, v211, v222
  v_cvt_pk_f16_f32 v115, v218, v214
  ds_write_b128 v9, v[112:115] offset:16896
  v_cvt_pk_f16_f32 v116, v210, v217
  v_cvt_pk_f16_f32 v117, v213, v209
  v_cvt_pk_f16_f32 v118, v220, v216
  v_cvt_pk_f16_f32 v119, v212, v208
  ds_write_b128 v9, v[116:119] offset:16912
L_y5:
  s_mov_b32 s37, 0x42800000
  s_or_b64 s[60:61], s[52:53], s[54:55]
  s_or_b64 s[38:39], s[56:57], s[58:59]
  s_waitcnt lgkmcnt(0)
  s_barrier
  ds_read_b128 v[96:99], v10 offset:16896
  ds_read_u16 v100, v10 offset:16912
  ds_read_b128 v[104:107], v10 offset:26112
  ds_read_u16 v108, v10 offset:26128
  s_or_b64 s[60:61], s[60:61], s[38:39]
  s_cbranch_scc1 L_sel
  s_waitcnt lgkmcnt(3)
  v_fma_mix_f32 v64, v96, s37, v64 op_sel:[0,0,0] op_sel_hi:[1,0,0]
  v_fma_mix_f32 v65, v96, s37, v65 op_sel:[1,0,0] op_sel_hi:[1,0,0]
  v_fma_mix_f32 v66, v97, s37, v66 op_sel:[0,0,0] op_sel_hi:[1,0,0]
  v_fma_mix_f32 v67, v97, s37, v67 op_sel:[1,0,0] op_sel_hi:[1,0,0]
  v_fma_mix_f32 v68, v98, s37, v68 op_sel:[0,0,0] op_sel_hi:[1,0,0]
  v_fma_mix_f32 v69, v98, s37, v69 op_sel:[1,0,0] op_sel_hi:[1,0,0]
  v_fma_mix_f32 v70, v99, s37, v70 op_sel:[0,0,0] op_sel_hi:[1,0,0]
  v_fma_mix_f32 v71, v99, s37, v71 op_sel:[1,0,0] op_sel_hi:[1,0,0]
  v_cvt_pk_bf16_f32 v132, v64, v65
  v_cvt_pk_bf16_f32 v133, v66, v67
  v_cvt_pk_bf16_f32 v134, v68, v69
  v_cvt_pk_bf16_f32 v135, v70, v71
  buffer_store_dwordx4 v[132:135], v20, s[12:15], 0 offen
  s_waitcnt lgkmcnt(2)
  v_fma_mix_f32 v72, v100, s37, v72 op_sel:[0,0,0] op_sel_hi:[1,0,0]
  v_fma_mix_f32 v73, v99, s37, v73 op_sel:[1,0,0] op_sel_hi:[1,0,0]
  v_fma_mix_f32 v74, v99, s37, v74 op_sel:[0,0,0] op_sel_hi:[1,0,0]
  v_fma_mix_f32 v75, v98, s37, v75 op_sel:[1,0,0] op_sel_hi:[1,0,0]
  v_fma_mix_f32 v76, v98, s37, v76 op_sel:[0,0,0] op_sel_hi:[1,0,0]
  v_fma_mix_f32 v77, v97, s37, v77 op_sel:[1,0,0] op_sel_hi:[1,0,0]
  v_fma_mix_f32 v78, v97, s37, v78 op_sel:[0,0,0] op_sel_hi:[1,0,0]
  v_fma_mix_f32 v79, v96, s37, v79 op_sel:[1,0,0] op_sel_hi:[1,0,0]
  v_cvt_pk_bf16_f32 v136, v72, v73
  v_cvt_pk_bf16_f32 v137, v74, v75
  v_cvt_pk_bf16_f32 v138, v76, v77
  v_cvt_pk_bf16_f32 v139, v78, v79
  buffer_store_dwordx4 v[136:139], v21, s[12:15], 0 offen
  s_waitcnt lgkmcnt(1)
  v_fma_mix_f32 v80, v104, s37, v80 op_sel:[0,0,0] op_sel_hi:[1,0,0]
  v_fma_mix_f32 v81, v104, s37, v81 op_sel:[1,0,0] op_sel_hi:[1,0,0]
  v_fma_mix_f32 v82, v105, s37, v82 op_sel:[0,0,0] op_sel_hi:[1,0,0]
  v_fma_mix_f32 v83, v105, s37, v83 op_sel:[1,0,0] op_sel_hi:[1,0,0]
  v_fma_mix_f32 v84, v106, s37, v84 op_sel:[0,0,0] op_sel_hi:[1,0,0]
  v_fma_mix_f32 v85, v106, s37, v85 op_sel:[1,0,0] op_sel_hi:[1,0,0]
  v_fma_mix_f32 v86, v107, s37, v86 op_sel:[0,0,0] op_sel_hi:[1,0,0]
  v_fma_mix_f32 v87, v107, s37, v87 op_sel:[1,0,0] op_sel_hi:[1,0,0]
  v_cvt_pk_bf16_f32 v140, v80, v81
  v_cvt_pk_bf16_f32 v141, v82, v83
  v_cvt_pk_bf16_f32 v142, v84, v85
  v_cvt_pk_bf16_f32 v143, v86, v87
  buffer_store_dwordx4 v[140:143], v22, s[12:15], 0 offen
  s_waitcnt lgkmcnt(0)
  v_fma_mix_f32 v88, v108, s37, v88 op_sel:[0,0,0] op_sel_hi:[1,0,0]
  v_fma_mix_f32 v89, v107, s37, v89 op_sel:[1,0,0] op_sel_hi:[1,0,0]
  v_fma_mix_f32 v90, v107, s37, v90 op_sel:[0,0,0] op_sel_hi:[1,0,0]
  v_fma_mix_f32 v91, v106, s37, v91 op_sel:[1,0,0] op_sel_hi:[1,0,0]
  v_fma_mix_f32 v92, v106, s37, v92 op_sel:[0,0,0] op_sel_hi:[1,0,0]
  v_fma_mix_f32 v93, v105, s37, v93 op_sel:[1,0,0] op_sel_hi:[1,0,0]
  v_fma_mix_f32 v94, v105, s37, v94 op_sel:[0,0,0] op_sel_hi:[1,0,0]
  v_fma_mix_f32 v95, v104, s37, v95 op_sel:[1,0,0] op_sel_hi:[1,0,0]
  v_cvt_pk_bf16_f32 v144, v88, v89
  v_cvt_pk_bf16_f32 v145, v90, v91
  v_cvt_pk_bf16_f32 v146, v92, v93
  v_cvt_pk_bf16_f32 v147, v94, v95
  buffer_store_dwordx4 v[144:147], v23, s[12:15], 0 offen
  s_branch L_fin
L_sel:
  s_waitcnt lgkmcnt(3)
  v_fma_mix_f32 v64, v96, s37, v64 op_sel:[0,0,0] op_sel_hi:[1,0,0]
  v_fma_mix_f32 v65, v96, s37, v65 op_sel:[1,0,0] op_sel_hi:[1,0,0]
  v_fma_mix_f32 v66, v97, s37, v66 op_sel:[0,0,0] op_sel_hi:[1,0,0]
  v_fma_mix_f32 v67, v97, s37, v67 op_sel:[1,0,0] op_sel_hi:[1,0,0]
  v_fma_mix_f32 v68, v98, s37, v68 op_sel:[0,0,0] op_sel_hi:[1,0,0]
  v_fma_mix_f32 v69, v98, s37, v69 op_sel:[1,0,0] op_sel_hi:[1,0,0]
  v_fma_mix_f32 v70, v99, s37, v70 op_sel:[0,0,0] op_sel_hi:[1,0,0]
  v_fma_mix_f32 v71, v99, s37, v71 op_sel:[1,0,0] op_sel_hi:[1,0,0]
  s_cmp_eq_u64 s[52:53], 0
  s_cbranch_scc1 L_selx0
  s_mov_b64 exec, s[52:53]
  v_lshrrev_b32 v16, 11, v172
  v_and_b32 v17, 2047, v172
  v_cmp_eq_u32 vcc, s47, v16
  v_lshlrev_b32 v17, 1, v17
  v_add_u32 v16, 4096, v17
  v_mov_b32 v18, 0xffffff00
  v_cndmask_b32_e64 v16, v17, v16, vcc
  s_mov_b32 s38, 4096
  v_and_or_b32 v176, v64, v18, s29
  v_and_or_b32 v177, v65, v18, s29
  v_and_or_b32 v178, v66, v18, s29
  v_and_or_b32 v179, v67, v18, s29
  v_and_or_b32 v180, v68, v18, s29
  v_and_or_b32 v181, v69, v18, s29
  v_and_or_b32 v182, v70, v18, s29
  v_and_or_b32 v183, v71, v18, s29
  buffer_store_dwordx4 v[176:179], v16, s[8:11], s38 offen sc1
  buffer_store_dwordx4 v[180:183], v16, s[8:11], s38 offen offset:16 sc1
  s_mov_b64 exec, -1
L_selx0:
  v_cvt_pk_bf16_f32 v132, v64, v65
  v_cvt_pk_bf16_f32 v133, v66, v67
  v_cvt_pk_bf16_f32 v134, v68, v69
  v_cvt_pk_bf16_f32 v135, v70, v71
  buffer_store_dwordx4 v[132:135], v20, s[12:15], 0 offen
  s_waitcnt lgkmcnt(2)
  v_fma_mix_f32 v72, v100, s37, v72 op_sel:[0,0,0] op_sel_hi:[1,0,0]
  v_fma_mix_f32 v73, v99, s37, v73 op_sel:[1,0,0] op_sel_hi:[1,0,0]
  v_fma_mix_f32 v74, v99, s37, v74 op_sel:[0,0,0] op_sel_hi:[1,0,0]
  v_fma_mix_f32 v75, v98, s37, v75 op_sel:[1,0,0] op_sel_hi:[1,0,0]
  v_fma_mix_f32 v76, v98, s37, v76 op_sel:[0,0,0] op_sel_hi:[1,0,0]
  v_fma_mix_f32 v77, v97, s37, v77 op_sel:[1,0,0] op_sel_hi:[1,0,0]
  v_fma_mix_f32 v78, v97, s37, v78 op_sel:[0,0,0] op_sel_hi:[1,0,0]
  v_fma_mix_f32 v79, v96, s37, v79 op_sel:[1,0,0] op_sel_hi:[1,0,0]
  s_cmp_eq_u64 s[54:55], 0
  s_cbranch_scc1 L_selx1
  s_mov_b64 exec, s[54:55]
  v_lshrrev_b32 v16, 11, v173
  v_and_b32 v17, 2047, v173
  v_cmp_eq_u32 vcc, s47, v16
  v_lshlrev_b32 v17, 1, v17
  v_add_u32 v16, 4096, v17
  v_mov_b32 v18, 0xffffff00
  v_cndmask_b32_e64 v16, v17, v16, vcc
  s_mov_b32 s38, 4096
  v_and_or_b32 v176, v72, v18, s29
  v_and_or_b32 v177, v73, v18, s29
  v_and_or_b32 v178, v74, v18, s29
  v_and_or_b32 v179, v75, v18, s29
  v_and_or_b32 v180, v76, v18, s29
  v_and_or_b32 v181, v77, v18, s29
  v_and_or_b32 v182, v78, v18, s29
  v_and_or_b32 v183, v79, v18, s29
  buffer_store_dwordx4 v[176:179], v16, s[8:11], s38 offen sc1
  buffer_store_dwordx4 v[180:183], v16, s[8:11], s38 offen offset:16 sc1
  s_mov_b64 exec, -1
L_selx1:
  v_cvt_pk_bf16_f32 v136, v72, v73
  v_cvt_pk_bf16_f32 v137, v74, v75
  v_cvt_pk_bf16_f32 v138, v76, v77
  v_cvt_pk_bf16_f32 v139, v78, v79
  buffer_store_dwordx4 v[136:139], v21, s[12:15], 0 offen
  s_waitcnt lgkmcnt(1)
  v_fma_mix_f32 v80, v104, s37, v80 op_sel:[0,0,0] op_sel_hi:[1,0,0]
  v_fma_mix_f32 v81, v104, s37, v81 op_sel:[1,0,0] op_sel_hi:[1,0,0]
  v_fma_mix_f32 v82, v105, s37, v82 op_sel:[0,0,0] op_sel_hi:[1,0,0]
  v_fma_mix_f32 v83, v105, s37, v83 op_sel:[1,0,0] op_sel_hi:[1,0,0]
  v_fma_mix_f32 v84, v106, s37, v84 op_sel:[0,0,0] op_sel_hi:[1,0,0]
  v_fma_mix_f32 v85, v106, s37, v85 op_sel:[1,0,0] op_sel_hi:[1,0,0]
  v_fma_mix_f32 v86, v107, s37, v86 op_sel:[0,0,0] op_sel_hi:[1,0,0]
  v_fma_mix_f32 v87, v107, s37, v87 op_sel:[1,0,0] op_sel_hi:[1,0,0]
  s_cmp_eq_u64 s[56:57], 0
  s_cbranch_scc1 L_selx2
  s_mov_b64 exec, s[56:57]
  v_lshrrev_b32 v16, 11, v174
  v_and_b32 v17, 2047, v174
  v_cmp_eq_u32 vcc, s47, v16
  v_lshlrev_b32 v17, 1, v17
  v_add_u32 v16, 4096, v17
  v_mov_b32 v18, 0xffffff00
  v_cndmask_b32_e64 v16, v17, v16, vcc
  s_mov_b32 s38, 4096
  v_and_or_b32 v176, v80, v18, s29
  v_and_or_b32 v177, v81, v18, s29
  v_and_or_b32 v178, v82, v18, s29
  v_and_or_b32 v179, v83, v18, s29
  v_and_or_b32 v180, v84, v18, s29
  v_and_or_b32 v181, v85, v18, s29
  v_and_or_b32 v182, v86, v18, s29
  v_and_or_b32 v183, v87, v18, s29
  buffer_store_dwordx4 v[176:179], v16, s[8:11], s38 offen sc1
  buffer_store_dwordx4 v[180:183], v16, s[8:11], s38 offen offset:16 sc1
  s_mov_b64 exec, -1
L_selx2:
  v_cvt_pk_bf16_f32 v140, v80, v81
  v_cvt_pk_bf16_f32 v141, v82, v83
  v_cvt_pk_bf16_f32 v142, v84, v85
  v_cvt_pk_bf16_f32 v143, v86, v87
  buffer_store_dwordx4 v[140:143], v22, s[12:15], 0 offen
  s_waitcnt lgkmcnt(0)
  v_fma_mix_f32 v88, v108, s37, v88 op_sel:[0,0,0] op_sel_hi:[1,0,0]
  v_fma_mix_f32 v89, v107, s37, v89 op_sel:[1,0,0] op_sel_hi:[1,0,0]
  v_fma_mix_f32 v90, v107, s37, v90 op_sel:[0,0,0] op_sel_hi:[1,0,0]
  v_fma_mix_f32 v91, v106, s37, v91 op_sel:[1,0,0] op_sel_hi:[1,0,0]
  v_fma_mix_f32 v92, v106, s37, v92 op_sel:[0,0,0] op_sel_hi:[1,0,0]
  v_fma_mix_f32 v93, v105, s37, v93 op_sel:[1,0,0] op_sel_hi:[1,0,0]
  v_fma_mix_f32 v94, v105, s37, v94 op_sel:[0,0,0] op_sel_hi:[1,0,0]
  v_fma_mix_f32 v95, v104, s37, v95 op_sel:[1,0,0] op_sel_hi:[1,0,0]
  s_cmp_eq_u64 s[58:59], 0
  s_cbranch_scc1 L_selx3
  s_mov_b64 exec, s[58:59]
  v_lshrrev_b32 v16, 11, v175
  v_and_b32 v17, 2047, v175
  v_cmp_eq_u32 vcc, s47, v16
  v_lshlrev_b32 v17, 1, v17
  v_add_u32 v16, 4096, v17
  v_mov_b32 v18, 0xffffff00
  v_cndmask_b32_e64 v16, v17, v16, vcc
  s_mov_b32 s38, 4096
  v_and_or_b32 v176, v88, v18, s29
  v_and_or_b32 v177, v89, v18, s29
  v_and_or_b32 v178, v90, v18, s29
  v_and_or_b32 v179, v91, v18, s29
  v_and_or_b32 v180, v92, v18, s29
  v_and_or_b32 v181, v93, v18, s29
  v_and_or_b32 v182, v94, v18, s29
  v_and_or_b32 v183, v95, v18, s29
  buffer_store_dwordx4 v[176:179], v16, s[8:11], s38 offen sc1
  buffer_store_dwordx4 v[180:183], v16, s[8:11], s38 offen offset:16 sc1
  s_mov_b64 exec, -1
L_selx3:
  v_cvt_pk_bf16_f32 v144, v88, v89
  v_cvt_pk_bf16_f32 v145, v90, v91
  v_cvt_pk_bf16_f32 v146, v92, v93
  v_cvt_pk_bf16_f32 v147, v94, v95
  buffer_store_dwordx4 v[144:147], v23, s[12:15], 0 offen
  s_branch L_fin
L_job2:
  s_mov_b32 s62, 1
  s_mov_b32 s56, 0
  s_mov_b32 s58, 0
  s_mov_b32 s57, s60
  s_mov_b32 s59, s61
  v_subrev_u32 v12, 2176, v12
  v_subrev_u32 v13, 2176, v13
  v_subrev_u32 v14, 2176, v14
  v_subrev_u32 v15, 2176, v15
  s_branch L_job
L_cw:
  s_setprio 2
  s_waitcnt lgkmcnt(12)
  v_pk_add_f32 v[28:29], v[28:29], v[30:31]
  v_pk_add_f32 v[68:69], v[68:69], v[70:71]
  v_pk_add_f32 v[28:29], v[28:29], v[68:69]
  v_add_f32 v68, v28, v29
  v_add_f32 v31, v28, v29
  s_nop 1
  v_permlane32_swap_b32 v68, v31
  v_mov_b32 v69, v31
  v_mul_f32 v29, 0x3a800000, v68
  v_mul_f32 v31, 0x3a800000, v31
  v_fma_f32 v31, -v29, v29, v31
  v_max_f32 v31, 0, v31
  v_cvt_pk_bf16_f32 v31, v31, v31
  v_and_b32 v31, 0xffff0000, v31
  v_add_f32 v31, 0x3727c5ac, v31
  v_cvt_pk_bf16_f32 v31, v31, v31
  v_and_b32 v31, 0xffff0000, v31
  v_sqrt_f32 v31, v31
  v_mov_b32 v18, s24
  v_cvt_pk_bf16_f32 v19, v29, v31
  v_and_b32 v16, 0xffff0000, v19
  v_rcp_f32 v16, v16
  v_lshlrev_b32 v17, 16, v19
  v_mul_f32 v17, v17, v16
  v_readlane_b32 s56, v16, s34
  v_readlane_b32 s57, v16, s35
  v_readlane_b32 s58, v17, s34
  v_readlane_b32 s59, v17, s35
  v_permlane16_swap_b32 v28, v68
  v_permlane16_swap_b32 v30, v69
  v_lshlrev_b32 v29, 16, v19
  v_fma_f32 v28, -v29, v30, v28
  v_mul_f32 v28, v28, v16
  v_cvt_pk_bf16_f32 v28, v28, v28
  s_lshl_b32 s37, s2, 4
  v_ashrrev_i32 v29, 31, v28
  s_add_u32 s37, s37, 98304
  v_or_b32 v29, 0x80000000, v29
  v_xor_b32 v28, v28, v29
  v_and_b32 v28, 0xffff0000, v28
  v_or_b32 v28, v28, v9
  v_mov_b32 v30, v18
  v_lshlrev_b32 v9, 11, v1
  v_min_u32_dpp v29, v28, v28 row_ror:8 row_mask:0xf bank_mask:0xf
  v_max_u32_dpp v28, v28, v28 row_ror:8 row_mask:0xf bank_mask:0xf
  s_nop 1
  v_min_u32_dpp v31, v28, v28 row_ror:4 row_mask:0xf bank_mask:0xf
  v_max_u32_dpp v29, v29, v29 row_ror:4 row_mask:0xf bank_mask:0xf
  v_max_u32_dpp v28, v28, v28 row_ror:4 row_mask:0xf bank_mask:0xf
  v_max_u32 v29, v29, v31
  s_nop 0
  v_min_u32_dpp v31, v28, v28 row_ror:2 row_mask:0xf bank_mask:0xf
  v_max_u32_dpp v29, v29, v29 row_ror:2 row_mask:0xf bank_mask:0xf
  v_max_u32_dpp v28, v28, v28 row_ror:2 row_mask:0xf bank_mask:0xf
  v_max_u32 v29, v29, v31
  s_nop 0
  v_min_u32_dpp v31, v28, v28 row_ror:1 row_mask:0xf bank_mask:0xf
  v_max_u32_dpp v29, v29, v29 row_ror:1 row_mask:0xf bank_mask:0xf
  v_max_u32_dpp v28, v28, v28 row_ror:1 row_mask:0xf bank_mask:0xf
  v_max_u32 v29, v29, v31
  s_mov_b64 exec, 0xff0000
  buffer_store_dwordx4 v[28:31], v9, s[8:11], s37 offen sc1
  s_mov_b64 exec, s[54:55]
  s_mov_b32 s37, 196608
  buffer_store_dwordx4 v[16:19], v10, s[8:11], s37 offen sc1
  s_mov_b64 exec, -1
  s_setprio 0
  v_mfma_f32_32x32x16_bf16 v[192:207], v[132:135], v[120:123], 0
  v_mfma_f32_32x32x16_bf16 v[192:207], v[136:139], v[124:127], v[192:207]
  v_mfma_f32_32x32x16_bf16 v[208:223], v[140:143], v[112:115], 0
  v_mfma_f32_32x32x16_bf16 v[208:223], v[144:147], v[116:119], v[208:223]
  v_mfma_f32_32x32x16_bf16 v[224:239], v[140:143], v[120:123], 0
  v_mfma_f32_32x32x16_bf16 v[224:239], v[144:147], v[124:127], v[224:239]
  s_branch L_nocand
L_ffn1:
  s_mov_b32 s6, 0x400000
  s_mov_b32 s10, 8388608
  s_mov_b32 s14, 0x400000
  s_mov_b32 s15, 0x20000
  s_mov_b32 s42, 7340032
  s_mov_b32 s43, 0x20000
  s_lshl_b32 s44, s30, 16
  v_mov_b32 v9, 0xffffff00
  v_bfe_u32 v16, v1, 2, 4
  v_and_b32 v17, 3, v1
  v_mul_u32_u24 v18, 2080, v16
  s_lshl_b32 s38, s3, 8
  v_lshl_add_u32 v11, v17, 3, s38
  v_add_u32 v11, v11, v18
  v_add_u32 v3, 118784, v11
  s_mul_i32 s37, s30, 4682
  s_lshr_b32 s37, s37, 16
  s_mul_i32 s38, s37, 14
  s_sub_u32 s38, s30, s38
  s_mul_i32 s37, s37, 114688
  s_lshl_b32 s38, s38, 9
  s_add_u32 s37, s37, s38
  s_add_u32 s48, s37, 3145728
  v_lshrrev_b32 v18, 5, v0
  v_and_b32 v19, 31, v0
  v_mul_u32_u24 v18, 7168, v18
  v_lshl_add_u32 v48, v19, 4, v18
  s_mov_b32 s36, 152384
  v_lshl_add_u32 v49, v0, 3, s36
  v_lshl_add_u32 v50, v1, 3, s36
  v_lshl_add_u32 v51, v0, 1, s36
  v_and_b32 v18, 1, v1
  v_and_b32 v19, 48, v1
  v_lshl_add_u32 v20, v18, 6, v19
  s_lshl_b32 s38, s3, 7
  s_add_u32 s38, s38, s36
  v_add_u32 v52, s38, v20
  s_lshl_b32 s38, s30, 13
  s_lshl_b32 s39, s3, 10
  s_add_u32 s38, s38, s39
  s_add_u32 s49, s38, 4194304
  v_lshrrev_b32 v20, 3, v0
  v_and_b32 v21, 7, v0
  v_lshlrev_b32 v20, 13, v20
  v_lshl_add_u32 v53, v21, 4, v20
  s_and_b32 s52, s30, 63
  s_lshl_b32 s50, s52, 7
  s_add_u32 s50, s50, 4194304
  s_add_u32 s51, s50, 524288
  s_mov_b32 s53, 4096
  v_lshl_add_u32 v54, v0, 2, s36
  v_lshl_add_u32 v55, v1, 2, s36
  s_and_b32 s45, s2, 7
  s_lshl_b32 s45, s45, 11
  s_add_u32 s45, s45, 131072
  s_waitcnt lgkmcnt(0)
  s_add_u32 s24, s24, 1
  s_and_b32 s29, s24, 0xff
  v_mov_b32 v10, s29
  v_mov_b32 v8, 0x40000000
  v_mov_b32 v7, 0
  s_not_b32 s36, s24
  v_mov_b32 v60, s36
  v_mov_b32 v61, s36
  v_mov_b32 v62, s36
  v_mov_b32 v63, s36
  s_cmp_lg_u32 s3, 7
  s_cbranch_scc1 L_f1
  s_waitcnt vmcnt(2)
  buffer_load_dwordx4 v[32:35], v2, s[8:11], s45 offen sc1
  buffer_load_dwordx4 v[36:39], v2, s[8:11], s45 offen offset:1024 sc1
  buffer_store_dwordx4 v[60:63], v2, s[8:11], s49 offen sc1
  s_and_b32 s36, s52, 62
  s_lshl_b32 s36, s36, 6
  s_add_u32 s36, s36, s53
  buffer_load_dword v59, off, s[8:11], s36 sc1
  s_add_u32 s36, s36, 4096
  buffer_load_dword v59, off, s[8:11], s36 sc1
  s_waitcnt vmcnt(5)
  s_barrier
  s_mov_b32 s63, 0
  s_waitcnt vmcnt(3)
  s_branch P_5_c
P_5:
  buffer_load_dwordx4 v[32:35], v2, s[8:11], s45 offen sc1
  buffer_load_dwordx4 v[36:39], v2, s[8:11], s45 offen offset:1024 sc1
  s_waitcnt vmcnt(0)
P_5_c:
  v_cmp_ne_u32 vcc, s24, v34
  v_cmp_ne_u32 s[38:39], s24, v38
  s_or_b64 vcc, vcc, s[38:39]
  s_cbranch_vccz P_5_x
  s_add_u32 s63, s63, 1
  s_cmp_lt_u32 s63, 65536
  s_cbranch_scc1 P_5
P_5_x:
  v_max_u32 v34, v32, v36
  v_min_u32 v38, v32, v36
  v_max3_u32 v35, v38, v33, v37
  s_nop 0
  v_min_u32_dpp v38, v34, v34 row_ror:8 row_mask:0xf bank_mask:0xf
  v_max_u32_dpp v35, v35, v35 row_ror:8 row_mask:0xf bank_mask:0xf
  v_max_u32_dpp v34, v34, v34 row_ror:8 row_mask:0xf bank_mask:0xf
  v_max_u32 v35, v35, v38
  s_nop 0
  v_min_u32_dpp v38, v34, v34 row_ror:4 row_mask:0xf bank_mask:0xf
  v_max_u32_dpp v35, v35, v35 row_ror:4 row_mask:0xf bank_mask:0xf
  v_max_u32_dpp v34, v34, v34 row_ror:4 row_mask:0xf bank_mask:0xf
  v_max_u32 v35, v35, v38
  s_nop 0
  v_min_u32_dpp v38, v34, v34 row_ror:2 row_mask:0xf bank_mask:0xf
  v_max_u32_dpp v35, v35, v35 row_ror:2 row_mask:0xf bank_mask:0xf
  v_max_u32_dpp v34, v34, v34 row_ror:2 row_mask:0xf bank_mask:0xf
  v_max_u32 v35, v35, v38
  s_nop 0
  v_min_u32_dpp v38, v34, v34 row_ror:1 row_mask:0xf bank_mask:0xf
  v_max_u32_dpp v35, v35, v35 row_ror:1 row_mask:0xf bank_mask:0xf
  v_max_u32_dpp v34, v34, v34 row_ror:1 row_mask:0xf bank_mask:0xf
  v_max_u32 v35, v35, v38
  s_nop 0
  v_min_u32_dpp v38, v34, v34 row_bcast:15 row_mask:0xa bank_mask:0xf
  v_max_u32_dpp v35, v35, v35 row_bcast:15 row_mask:0xa bank_mask:0xf
  v_max_u32_dpp v34, v34, v34 row_bcast:15 row_mask:0xa bank_mask:0xf
  v_max_u32 v35, v35, v38
  s_nop 0
  v_min_u32_dpp v38, v34, v34 row_bcast:31 row_mask:0xc bank_mask:0xf
  v_max_u32_dpp v35, v35, v35 row_bcast:31 row_mask:0xc bank_mask:0xf
  v_max_u32_dpp v34, v34, v34 row_bcast:31 row_mask:0xc bank_mask:0xf
  v_max_u32 v35, v35, v38
  v_readlane_b32 s46, v34, 63
  v_readlane_b32 s47, v35, 63
  s_and_b32 s36, s46, 0xffff
  s_sub_u32 s36, 0xffff, s36
  s_and_b32 s37, s47, 0xffff
  s_sub_u32 s37, 0xffff, s37
  s_lshl_b32 s38, s36, 11
  s_lshl_b32 s39, s37, 11
  s_lshl_b32 s33, s32, 7
  s_add_u32 s38, s38, s33
  s_add_u32 s39, s39, s33
  s_mov_b32 m0, 152064
  s_mov_b64 exec, 0xff
  buffer_load_dwordx4 v2, s[4:7], s38 offen lds
  s_mov_b32 m0, 152192
  s_and_b32 s33, s36, 15
  buffer_load_dwordx4 v2, s[4:7], s39 offen lds
  s_lshl_b32 s33, s33, 12
  s_and_b32 s36, s36, 0x7f0
  s_add_u32 s36, s36, s33
  s_add_u32 s36, s36, 196608
  s_and_b32 s33, s37, 15
  s_lshl_b32 s33, s33, 12
  s_and_b32 s37, s37, 0x7f0
  s_add_u32 s37, s37, s33
  s_add_u32 s37, s37, 196608
  s_mov_b64 exec, 1
  buffer_load_dwordx3 v[40:42], off, s[8:11], s36 sc1
  buffer_load_dwordx3 v[44:46], off, s[8:11], s37 sc1
  s_mov_b64 exec, -1
  s_cmp_ge_u32 s30, 112
  s_cbranch_scc1 L_f0
  s_mov_b32 m0, 118784
  s_mov_b32 s33, s44
  buffer_load_dwordx4 v2, s[40:43], s33 offen lds
  buffer_load_dwordx4 v2, s[40:43], s33 offen offset:1024 lds
  s_add_u32 m0, m0, 2080
  s_add_u32 s33, s33, 2048
  buffer_load_dwordx4 v2, s[40:43], s33 offen lds
  buffer_load_dwordx4 v2, s[40:43], s33 offen offset:1024 lds
  s_add_u32 m0, m0, 2080
  s_add_u32 s33, s33, 2048
  buffer_load_dwordx4 v2, s[40:43], s33 offen lds
  buffer_load_dwordx4 v2, s[40:43], s33 offen offset:1024 lds
  s_add_u32 m0, m0, 2080
  s_add_u32 s33, s33, 2048
  buffer_load_dwordx4 v2, s[40:43], s33 offen lds
  buffer_load_dwordx4 v2, s[40:43], s33 offen offset:1024 lds
  s_add_u32 m0, m0, 2080
  s_add_u32 s33, s33, 10240
  buffer_load_dwordx4 v2, s[40:43], s33 offen lds
  buffer_load_dwordx4 v2, s[40:43], s33 offen offset:1024 lds
  s_add_u32 m0, m0, 2080
  s_add_u32 s33, s33, 2048
  buffer_load_dwordx4 v2, s[40:43], s33 offen lds
  buffer_load_dwordx4 v2, s[40:43], s33 offen offset:1024 lds
  s_add_u32 m0, m0, 2080
  s_add_u32 s33, s33, 2048
  buffer_load_dwordx4 v2, s[40:43], s33 offen lds
  buffer_load_dwordx4 v2, s[40:43], s33 offen offset:1024 lds
  s_add_u32 m0, m0, 2080
  s_add_u32 s33, s33, 2048
  buffer_load_dwordx4 v2, s[40:43], s33 offen lds
  buffer_load_dwordx4 v2, s[40:43], s33 offen offset:1024 lds
  s_add_u32 m0, m0, 2080
  s_add_u32 s33, s33, 10240
  buffer_load_dwordx4 v2, s[40:43], s33 offen lds
  buffer_load_dwordx4 v2, s[40:43], s33 offen offset:1024 lds
  s_add_u32 m0, m0, 2080
  s_add_u32 s33, s33, 2048
  buffer_load_dwordx4 v2, s[40:43], s33 offen lds
  buffer_load_dwordx4 v2, s[40:43], s33 offen offset:1024 lds
  s_add_u32 m0, m0, 2080
  s_add_u32 s33, s33, 2048
  buffer_load_dwordx4 v2, s[40:43], s33 offen lds
  buffer_load_dwordx4 v2, s[40:43], s33 offen offset:1024 lds
  s_add_u32 m0, m0, 2080
  s_add_u32 s33, s33, 2048
  buffer_load_dwordx4 v2, s[40:43], s33 offen lds
  buffer_load_dwordx4 v2, s[40:43], s33 offen offset:1024 lds
  s_add_u32 m0, m0, 2080
  s_add_u32 s33, s33, 10240
  buffer_load_dwordx4 v2, s[40:43], s33 offen lds
  buffer_load_dwordx4 v2, s[40:43], s33 offen offset:1024 lds
  s_add_u32 m0, m0, 2080
  s_add_u32 s33, s33, 2048
  buffer_load_dwordx4 v2, s[40:43], s33 offen lds
  buffer_load_dwordx4 v2, s[40:43], s33 offen offset:1024 lds
  s_add_u32 m0, m0, 2080
  s_add_u32 s33, s33, 2048
  buffer_load_dwordx4 v2, s[40:43], s33 offen lds
  buffer_load_dwordx4 v2, s[40:43], s33 offen offset:1024 lds
  s_add_u32 m0, m0, 2080
  s_add_u32 s33, s33, 2048
  buffer_load_dwordx4 v2, s[40:43], s33 offen lds
  buffer_load_dwordx4 v2, s[40:43], s33 offen offset:1024 lds
  s_waitcnt vmcnt(32)
L_f0:
  s_mov_b64 exec, 1
  s_cmp_lt_u32 s30, 112
  s_cbranch_scc1 Q_6
  s_waitcnt vmcnt(0)
Q_6:
  s_mov_b32 s62, 0
  s_waitcnt vmcnt(63)
  s_branch P_7_c
P_7:
  buffer_load_dwordx3 v[40:42], off, s[8:11], s36 sc1
  buffer_load_dwordx3 v[44:46], off, s[8:11], s37 sc1
  s_waitcnt vmcnt(0)
P_7_c:
  v_cmp_ne_u32 vcc, s24, v42
  v_cmp_ne_u32 s[38:39], s24, v46
  s_or_b64 vcc, vcc, s[38:39]
  s_cbranch_vccz P_7_x
  s_add_u32 s62, s62, 1
  s_cmp_lt_u32 s62, 65536
  s_cbranch_scc1 P_7
P_7_x:
  v_mov_b32 v42, v41
  v_mov_b32 v41, v44
  v_mov_b32 v43, v45
  v_mov_b32 v44, 152320
  ds_write_b128 v44, v[40:43]
  s_waitcnt lgkmcnt(0)
  s_mov_b64 exec, -1
  s_barrier
  v_lshrrev_b32 v18, 5, v1
  v_mov_b32 v19, s47
  v_mov_b32 v20, s46
  s_nop 1
  v_mov_b32_dpp v19, v20 quad_perm:[0,1,2,3] row_mask:0x3 bank_mask:0xf
  s_lshr_b32 s38, s52, 1
  s_lshl_b32 s38, s38, 5
  s_and_b32 s39, s52, 1
  s_lshl_b32 s39, s39, 3
  s_add_u32 s38, s38, s39
  v_and_b32 v16, 16, v1
  v_add3_u32 v17, v21, v16, s38
  v_lshlrev_b32 v16, 12, v18
  v_lshl_add_u32 v7, v17, 2, v16
  v_ashrrev_i32 v16, 31, v19
  v_not_b32 v16, v16
  v_or_b32 v16, 0x80000000, v16
  v_xor_b32 v16, v16, v19
  v_and_b32 v16, 0xffff0000, v16
  v_mul_f32 v16, 0xbfb8aa3b, v16
  v_exp_f32 v16, v16
  v_and_b32 v19, 0xffff, v19
  v_add_f32 v16, 1.0, v16
  v_rcp_f32 v16, v16
  v_sub_u32 v19, 0xffff, v19
  v_lshlrev_b32 v19, 11, v19
  v_lshl_add_u32 v8, v17, 1, v19
  v_cvt_pk_bf16_f32 v16, v16, v16
  v_and_b32 v6, 0xffff0000, v16
  s_branch L_f2
L_f1:
  v_mul_u32_u24 v16, 928, v16
  s_lshl_b32 s36, s3, 7
  v_lshl_add_u32 v17, v17, 3, s36
  v_add_u32 v4, v16, v17
  v_add_u32 v5, 59392, v4
  v_lshl_add_u32 v6, v18, 7, v19
  v_add_u32 v6, 152064, v6
  v_mov_b32 v56, 152320
  s_mul_i32 s36, s30, 7168
  s_lshl_b32 s37, s3, 10
  s_add_u32 s36, s36, s37
  s_add_u32 s36, s36, 3145728
  buffer_store_dwordx4 v[60:63], v2, s[8:11], s36 offen sc1
  buffer_store_dwordx4 v[60:63], v2, s[8:11], s49 offen sc1
  v_mov_b32 v12, 0x3f803f80
  v_mov_b32 v13, 0x3f803f80
  v_mov_b32 v14, 0x3f803f80
  v_mov_b32 v15, 0x3f803f80
  s_waitcnt vmcnt(2)
  s_barrier
  ds_read_b64_tr_b16 v[64:65], v4 offset:0
  ds_read_b64_tr_b16 v[66:67], v4 offset:14848
  ds_read_b64_tr_b16 v[68:69], v4 offset:29696
  ds_read_b64_tr_b16 v[70:71], v4 offset:44544
  ds_read_b64_tr_b16 v[72:73], v5 offset:0
  ds_read_b64_tr_b16 v[74:75], v5 offset:14848
  ds_read_b64_tr_b16 v[76:77], v5 offset:29696
  ds_read_b64_tr_b16 v[78:79], v5 offset:44544
  ds_read_b64_tr_b16 v[80:81], v4 offset:32
  ds_read_b64_tr_b16 v[82:83], v4 offset:14880
  ds_read_b64_tr_b16 v[84:85], v4 offset:29728
  ds_read_b64_tr_b16 v[86:87], v4 offset:44576
  ds_read_b64_tr_b16 v[88:89], v5 offset:32
  ds_read_b64_tr_b16 v[90:91], v5 offset:14880
  ds_read_b64_tr_b16 v[92:93], v5 offset:29728
  ds_read_b64_tr_b16 v[94:95], v5 offset:44576
  ds_read_b64_tr_b16 v[96:97], v4 offset:64
  ds_read_b64_tr_b16 v[98:99], v4 offset:14912
  ds_read_b64_tr_b16 v[100:101], v4 offset:29760
  ds_read_b64_tr_b16 v[102:103], v4 offset:44608
  ds_read_b64_tr_b16 v[104:105], v5 offset:64
  ds_read_b64_tr_b16 v[106:107], v5 offset:14912
  ds_read_b64_tr_b16 v[108:109], v5 offset:29760
  ds_read_b64_tr_b16 v[110:111], v5 offset:44608
  ds_read_b64_tr_b16 v[112:113], v4 offset:96
  ds_read_b64_tr_b16 v[114:115], v4 offset:14944
  ds_read_b64_tr_b16 v[116:117], v4 offset:29792
  ds_read_b64_tr_b16 v[118:119], v4 offset:44640
  ds_read_b64_tr_b16 v[120:121], v5 offset:96
  ds_read_b64_tr_b16 v[122:123], v5 offset:14944
  ds_read_b64_tr_b16 v[124:125], v5 offset:29792
  ds_read_b64_tr_b16 v[126:127], v5 offset:44640
  s_waitcnt lgkmcnt(0)
  v_mfma_f32_16x16x32_bf16 v[128:131], v[12:15], v[64:67], 0
  v_mfma_f32_16x16x32_bf16 v[128:131], v[12:15], v[68:71], v[128:131]
  v_mfma_f32_16x16x32_bf16 v[132:135], v[12:15], v[72:75], 0
  v_mfma_f32_16x16x32_bf16 v[132:135], v[12:15], v[76:79], v[132:135]
  v_mfma_f32_16x16x32_bf16 v[136:139], v[12:15], v[80:83], 0
  v_mfma_f32_16x16x32_bf16 v[136:139], v[12:15], v[84:87], v[136:139]
  v_mfma_f32_16x16x32_bf16 v[140:143], v[12:15], v[88:91], 0
  v_mfma_f32_16x16x32_bf16 v[140:143], v[12:15], v[92:95], v[140:143]
  v_mfma_f32_16x16x32_bf16 v[144:147], v[12:15], v[96:99], 0
  v_mfma_f32_16x16x32_bf16 v[144:147], v[12:15], v[100:103], v[144:147]
  v_mfma_f32_16x16x32_bf16 v[148:151], v[12:15], v[104:107], 0
  v_mfma_f32_16x16x32_bf16 v[148:151], v[12:15], v[108:111], v[148:151]
  v_mfma_f32_16x16x32_bf16 v[152:155], v[12:15], v[112:115], 0
  v_mfma_f32_16x16x32_bf16 v[152:155], v[12:15], v[116:119], v[152:155]
  v_mfma_f32_16x16x32_bf16 v[156:159], v[12:15], v[120:123], 0
  v_mfma_f32_16x16x32_bf16 v[156:159], v[12:15], v[124:127], v[156:159]
  v_mov_b32 v16, v128
  s_nop 1
  v_mov_b32_dpp v16, v136 quad_perm:[0,1,2,3] row_mask:0x2 bank_mask:0xf
  s_nop 1
  v_mov_b32_dpp v16, v144 quad_perm:[0,1,2,3] row_mask:0x4 bank_mask:0xf
  s_nop 1
  v_mov_b32_dpp v16, v152 quad_perm:[0,1,2,3] row_mask:0x8 bank_mask:0xf
  v_mov_b32 v17, v132
  s_nop 1
  v_mov_b32_dpp v17, v140 quad_perm:[0,1,2,3] row_mask:0x2 bank_mask:0xf
  s_nop 1
  v_mov_b32_dpp v17, v148 quad_perm:[0,1,2,3] row_mask:0x4 bank_mask:0xf
  s_nop 1
  v_mov_b32_dpp v17, v156 quad_perm:[0,1,2,3] row_mask:0x8 bank_mask:0xf
  s_barrier
  ds_read_b128 v[20:23], v6
  ds_read_b128 v[24:27], v6 offset:64
  ds_read_b128 v[28:31], v56
  s_waitcnt lgkmcnt(2)
  v_mfma_f32_16x16x32_bf16 v[160:163], v[20:23], v[64:67], 0
  v_mfma_f32_16x16x32_bf16 v[164:167], v[20:23], v[72:75], 0
  v_mfma_f32_16x16x32_bf16 v[168:171], v[20:23], v[80:83], 0
  v_mfma_f32_16x16x32_bf16 v[172:175], v[20:23], v[88:91], 0
  v_mfma_f32_16x16x32_bf16 v[176:179], v[20:23], v[96:99], 0
  v_mfma_f32_16x16x32_bf16 v[180:183], v[20:23], v[104:107], 0
  v_mfma_f32_16x16x32_bf16 v[184:187], v[20:23], v[112:115], 0
  v_mfma_f32_16x16x32_bf16 v[188:191], v[20:23], v[120:123], 0
  s_waitcnt lgkmcnt(0)
  v_mfma_f32_16x16x32_bf16 v[160:163], v[24:27], v[68:71], v[160:163]
  v_pk_mul_f32 v[32:33], v[30:31], v[16:17] op_sel:[0,0] op_sel_hi:[1,0] neg_lo:[1,0] neg_hi:[1,0]
  s_nop 1
  v_mfma_f32_16x16x32_bf16 v[164:167], v[24:27], v[76:79], v[164:167]
  v_mul_f32 v34, -v30, v17
  v_mul_f32 v35, -v31, v17
  v_mfma_f32_16x16x32_bf16 v[168:171], v[24:27], v[84:87], v[168:171]
  v_mfma_f32_16x16x32_bf16 v[172:175], v[24:27], v[92:95], v[172:175]
  v_mfma_f32_16x16x32_bf16 v[176:179], v[24:27], v[100:103], v[176:179]
  v_mfma_f32_16x16x32_bf16 v[180:183], v[24:27], v[108:111], v[180:183]
  v_mfma_f32_16x16x32_bf16 v[184:187], v[24:27], v[116:119], v[184:187]
  v_mfma_f32_16x16x32_bf16 v[188:191], v[24:27], v[124:127], v[188:191]
  v_mov_b32 v40, v160
  s_nop 1
  v_mov_b32_dpp v40, v168 quad_perm:[0,1,2,3] row_mask:0x2 bank_mask:0xf
  s_nop 1
  v_mov_b32_dpp v40, v176 quad_perm:[0,1,2,3] row_mask:0x4 bank_mask:0xf
  s_nop 1
  v_mov_b32_dpp v40, v184 quad_perm:[0,1,2,3] row_mask:0x8 bank_mask:0xf
  v_mov_b32 v41, v161
  s_nop 1
  v_mov_b32_dpp v41, v169 quad_perm:[0,1,2,3] row_mask:0x2 bank_mask:0xf
  s_nop 1
  v_mov_b32_dpp v41, v177 quad_perm:[0,1,2,3] row_mask:0x4 bank_mask:0xf
  s_nop 1
  v_mov_b32_dpp v41, v185 quad_perm:[0,1,2,3] row_mask:0x8 bank_mask:0xf
  v_mov_b32 v42, v164
  s_nop 1
  v_mov_b32_dpp v42, v172 quad_perm:[0,1,2,3] row_mask:0x2 bank_mask:0xf
  s_nop 1
  v_mov_b32_dpp v42, v180 quad_perm:[0,1,2,3] row_mask:0x4 bank_mask:0xf
  s_nop 1
  v_mov_b32_dpp v42, v188 quad_perm:[0,1,2,3] row_mask:0x8 bank_mask:0xf
  v_mov_b32 v43, v165
  s_nop 1
  v_mov_b32_dpp v43, v173 quad_perm:[0,1,2,3] row_mask:0x2 bank_mask:0xf
  s_nop 1
  v_mov_b32_dpp v43, v181 quad_perm:[0,1,2,3] row_mask:0x4 bank_mask:0xf
  s_nop 1
  v_mov_b32_dpp v43, v189 quad_perm:[0,1,2,3] row_mask:0x8 bank_mask:0xf
  v_pk_fma_f32 v[40:41], v[40:41], v[28:29], v[32:33]
  v_pk_fma_f32 v[42:43], v[42:43], v[28:29], v[34:35]
  v_and_or_b32 v40, v40, v9, v10
  v_and_or_b32 v41, v41, v9, v10
  v_and_or_b32 v42, v42, v9, v10
  v_and_or_b32 v43, v43, v9, v10
  buffer_store_dwordx4 v[40:43], v2, s[8:11], s36 offen sc1
L_f2:
  s_cmp_ge_u32 s30, 112
  s_cbranch_scc1 L_red
  s_lshr_b32 s36, s3, 1
  s_lshl_b32 s36, s36, 3
  s_and_b32 s37, s3, 1
  s_lshl_b32 s37, s37, 1
  s_add_u32 s36, s36, s37
  s_add_u32 s36, s36, 4
  s_lshl_b32 s36, s36, 11
  s_add_u32 s33, s44, s36
  s_mul_i32 s36, s3, 4160
  s_add_u32 m0, s36, 0
  s_barrier
  buffer_load_dwordx4 v2, s[40:43], s33 offen lds
  buffer_load_dwordx4 v2, s[40:43], s33 offen offset:1024 lds
  s_add_u32 m0, m0, 2080
  s_add_u32 s33, s33, 2048
  buffer_load_dwordx4 v2, s[40:43], s33 offen lds
  buffer_load_dwordx4 v2, s[40:43], s33 offen offset:1024 lds
  s_mov_b32 s61, 0
P_8:
  buffer_load_dwordx4 v[24:27], v48, s[8:11], s48 offen sc1
  s_waitcnt vmcnt(0)
P_8_c:
  v_xor_b32 v24, v10, v24
  v_xor_b32 v25, v10, v25
  v_xor_b32 v26, v10, v26
  v_xor_b32 v27, v10, v27
  v_or3_b32 v16, v24, v25, v26
  v_or_b32 v16, v16, v27
  v_and_b32 v16, 0xff, v16
  v_cmp_ne_u32 vcc, 0, v16
  s_cbranch_vccz P_8_x
  s_add_u32 s61, s61, 1
  s_cmp_lt_u32 s61, 65536
  s_cbranch_scc1 P_8
P_8_x:
  v_permlane32_swap_b32 v24, v25
  v_permlane32_swap_b32 v26, v27
  v_add_f32 v24, v24, v25
  v_add_f32 v25, v26, v27
  ds_write_b64 v49, v[24:25] offset:0
  s_waitcnt vmcnt(0) lgkmcnt(0)
  s_barrier
  ds_read_b64 v[32:33], v50 offset:0
  ds_read_b64 v[34:35], v50 offset:512
  ds_read_b64 v[36:37], v50 offset:1024
  ds_read_b64 v[38:39], v50 offset:1536
  ds_read_b64 v[40:41], v50 offset:2048
  ds_read_b64 v[42:43], v50 offset:2560
  ds_read_b64 v[44:45], v50 offset:3072
  ds_read_b64 v[46:47], v50 offset:3584
  ds_read_b64_tr_b16 v[224:225], v3 offset:0
  ds_read_b64_tr_b16 v[226:227], v11 offset:0
  ds_read_b64_tr_b16 v[228:229], v3 offset:32
  ds_read_b64_tr_b16 v[230:231], v11 offset:32
  ds_read_b64_tr_b16 v[232:233], v3 offset:64
  ds_read_b64_tr_b16 v[234:235], v11 offset:64
  s_waitcnt lgkmcnt(12)
  v_pk_add_f32 v[32:33], v[32:33], v[34:35]
  s_waitcnt lgkmcnt(10)
  v_pk_add_f32 v[36:37], v[36:37], v[38:39]
  s_waitcnt lgkmcnt(8)
  v_pk_add_f32 v[40:41], v[40:41], v[42:43]
  s_waitcnt lgkmcnt(6)
  v_pk_add_f32 v[44:45], v[44:45], v[46:47]
  v_pk_add_f32 v[32:33], v[32:33], v[36:37]
  v_pk_add_f32 v[40:41], v[40:41], v[44:45]
  ds_read_b64_tr_b16 v[236:237], v3 offset:96
  ds_read_b64_tr_b16 v[238:239], v11 offset:96
  ds_read_b64_tr_b16 v[240:241], v3 offset:128
  ds_read_b64_tr_b16 v[242:243], v11 offset:128
  ds_read_b64_tr_b16 v[244:245], v3 offset:160
  ds_read_b64_tr_b16 v[246:247], v11 offset:160
  ds_read_b64_tr_b16 v[248:249], v3 offset:192
  v_pk_add_f32 v[32:33], v[32:33], v[40:41]
  v_cvt_pk_bf16_f32 v33, v32, v33
  v_lshlrev_b32 v32, 16, v33
  v_mul_f32 v34, 0xbfb8aa3b, v32
  v_exp_f32 v34, v34
  v_and_b32 v33, 0xffff0000, v33
  v_add_f32 v34, 1.0, v34
  v_rcp_f32 v34, v34
  s_waitcnt lgkmcnt(6)
  ds_read_b64_tr_b16 v[250:251], v11 offset:192
  ds_read_b64_tr_b16 v[252:253], v3 offset:224
  ds_read_b64_tr_b16 v[254:255], v11 offset:224
  v_mul_f32 v32, v32, v34
  v_cvt_pk_bf16_f32 v32, v32, v32
  v_and_b32 v32, 0xffff0000, v32
  v_mul_f32 v32, v32, v33
  v_cvt_pk_bf16_f32 v32, v32, v32
  ds_write_b16 v51, v32 offset:4096
  ds_read_b128 v[36:39], v52 offset:4096
  s_waitcnt lgkmcnt(0)
  v_mfma_f32_16x16x32_bf16 v[64:67], v[36:39], v[224:227], 0
  v_mfma_f32_16x16x32_bf16 v[68:71], v[36:39], v[228:231], 0
  v_mfma_f32_16x16x32_bf16 v[72:75], v[36:39], v[232:235], 0
  v_mfma_f32_16x16x32_bf16 v[76:79], v[36:39], v[236:239], 0
  v_mfma_f32_16x16x32_bf16 v[80:83], v[36:39], v[240:243], 0
  v_mfma_f32_16x16x32_bf16 v[84:87], v[36:39], v[244:247], 0
  v_mfma_f32_16x16x32_bf16 v[88:91], v[36:39], v[248:251], 0
  v_mfma_f32_16x16x32_bf16 v[92:95], v[36:39], v[252:255], 0
  s_nop 0
  v_mov_b32 v40, v64
  s_nop 1
  v_mov_b32_dpp v40, v72 quad_perm:[0,1,2,3] row_mask:0x2 bank_mask:0xf
  s_nop 1
  v_mov_b32_dpp v40, v80 quad_perm:[0,1,2,3] row_mask:0x4 bank_mask:0xf
  s_nop 1
  v_mov_b32_dpp v40, v88 quad_perm:[0,1,2,3] row_mask:0x8 bank_mask:0xf
  v_mov_b32 v41, v65
  s_nop 1
  v_mov_b32_dpp v41, v73 quad_perm:[0,1,2,3] row_mask:0x2 bank_mask:0xf
  s_nop 1
  v_mov_b32_dpp v41, v81 quad_perm:[0,1,2,3] row_mask:0x4 bank_mask:0xf
  s_nop 1
  v_mov_b32_dpp v41, v89 quad_perm:[0,1,2,3] row_mask:0x8 bank_mask:0xf
  v_mov_b32 v42, v68
  s_nop 1
  v_mov_b32_dpp v42, v76 quad_perm:[0,1,2,3] row_mask:0x2 bank_mask:0xf
  s_nop 1
  v_mov_b32_dpp v42, v84 quad_perm:[0,1,2,3] row_mask:0x4 bank_mask:0xf
  s_nop 1
  v_mov_b32_dpp v42, v92 quad_perm:[0,1,2,3] row_mask:0x8 bank_mask:0xf
  v_mov_b32 v43, v69
  s_nop 1
  v_mov_b32_dpp v43, v77 quad_perm:[0,1,2,3] row_mask:0x2 bank_mask:0xf
  s_nop 1
  v_mov_b32_dpp v43, v85 quad_perm:[0,1,2,3] row_mask:0x4 bank_mask:0xf
  s_nop 1
  v_mov_b32_dpp v43, v93 quad_perm:[0,1,2,3] row_mask:0x8 bank_mask:0xf
  v_and_or_b32 v40, v40, v9, v10
  v_and_or_b32 v41, v41, v9, v10
  v_and_or_b32 v42, v42, v9, v10
  v_and_or_b32 v43, v43, v9, v10
  buffer_store_dwordx4 v[40:43], v2, s[8:11], s49 offen sc1
L_red:
  s_sub_u32 s36, s30, 64
  s_cmp_ge_u32 s36, 64
  s_cbranch_scc1 L_fin
  s_cmp_ge_u32 s3, 6
  s_cbranch_scc1 L_r2
  s_mov_b32 s60, 0
P_9:
  buffer_load_dwordx4 v[20:23], v53, s[8:11], s50 offen sc1
  buffer_load_dwordx4 v[24:27], v53, s[8:11], s51 offen sc1
  s_waitcnt vmcnt(0)
P_9_c:
  v_xor_b32 v20, v10, v20
  v_xor_b32 v21, v10, v21
  v_xor_b32 v22, v10, v22
  v_xor_b32 v23, v10, v23
  v_xor_b32 v24, v10, v24
  v_xor_b32 v25, v10, v25
  v_xor_b32 v26, v10, v26
  v_xor_b32 v27, v10, v27
  v_or3_b32 v16, v20, v21, v22
  v_or3_b32 v16, v16, v23, v24
  v_or3_b32 v16, v16, v25, v26
  v_or_b32 v16, v16, v27
  v_and_b32 v16, 0xff, v16
  v_cmp_ne_u32 vcc, 0, v16
  s_cbranch_vccz P_9_x
  s_add_u32 s60, s60, 1
  s_cmp_lt_u32 s60, 65536
  s_cbranch_scc1 P_9
P_9_x:
  v_pk_add_f32 v[20:21], v[20:21], v[24:25]
  v_pk_add_f32 v[22:23], v[22:23], v[26:27]
  s_branch L_r3
L_r2:
  s_cmp_eq_u32 s3, 7
  s_cbranch_scc1 L_r4
  s_mov_b32 s60, 0
P_10:
  buffer_load_dwordx4 v[20:23], v53, s[8:11], s50 offen sc1
  s_waitcnt vmcnt(0)
P_10_c:
  v_xor_b32 v20, v10, v20
  v_xor_b32 v21, v10, v21
  v_xor_b32 v22, v10, v22
  v_xor_b32 v23, v10, v23
  v_or3_b32 v16, v20, v21, v22
  v_or_b32 v16, v16, v23
  v_and_b32 v16, 0xff, v16
  v_cmp_ne_u32 vcc, 0, v16
  s_cbranch_vccz P_10_x
  s_add_u32 s60, s60, 1
  s_cmp_lt_u32 s60, 65536
  s_cbranch_scc1 P_10
P_10_x:
  s_branch L_r3
L_r4:
  s_mov_b32 s60, 0
P_11:
  buffer_load_dwordx4 v[20:23], v53, s[8:11], s50 offen sc1
  buffer_load_dword v24, v7, s[8:11], s53 offen sc1
  s_waitcnt vmcnt(0)
P_11_c:
  v_xor_b32 v20, v10, v20
  v_xor_b32 v21, v10, v21
  v_xor_b32 v22, v10, v22
  v_xor_b32 v23, v10, v23
  v_xor_b32 v24, v10, v24
  v_or3_b32 v16, v20, v21, v22
  v_or3_b32 v16, v16, v23, v24
  v_and_b32 v16, 0xff, v16
  v_cmp_ne_u32 vcc, 0, v16
  s_cbranch_vccz P_11_x
  s_add_u32 s60, s60, 1
  s_cmp_lt_u32 s60, 65536
  s_cbranch_scc1 P_11
P_11_x:
L_r3:
  v_permlane32_swap_b32 v20, v21
  v_permlane32_swap_b32 v22, v23
  v_add_f32 v20, v20, v21
  v_add_f32 v22, v22, v23
  s_nop 1
  v_permlane16_swap_b32 v20, v22
  v_add_f32 v20, v20, v22
  s_nop 1
  v_add_f32_dpp v20, v20, v20 row_ror:8 row_mask:0xf bank_mask:0xf
  ds_write_b32 v54, v20 offset:5120
  s_waitcnt lgkmcnt(0)
  s_barrier
  s_cmp_lg_u32 s3, 7
  s_cbranch_scc1 L_fin
  ds_read_b32 v32, v55 offset:5120
  ds_read_b32 v33, v55 offset:5376
  ds_read_b32 v34, v55 offset:5632
  ds_read_b32 v35, v55 offset:5888
  ds_read_b32 v36, v55 offset:6144
  ds_read_b32 v37, v55 offset:6400
  ds_read_b32 v38, v55 offset:6656
  ds_read_b32 v39, v55 offset:6912
  s_waitcnt lgkmcnt(4)
  v_pk_add_f32 v[32:33], v[32:33], v[34:35]
  s_waitcnt lgkmcnt(0)
  v_pk_add_f32 v[36:37], v[36:37], v[38:39]
  v_pk_add_f32 v[32:33], v[32:33], v[36:37]
  v_add_f32 v20, v32, v33
  v_cvt_pk_bf16_f32 v20, v20, v20
  v_and_b32 v20, 0xffff0000, v20
  v_mul_f32 v20, v20, v6
  v_cvt_pk_bf16_f32 v20, v20, v20
  v_and_b32 v20, 0xffff0000, v20
  v_add_f32 v20, v20, v24
  v_cvt_pk_bf16_f32 v20, v20, v20
  s_mov_b32 exec_lo, 0xff00ff
  s_mov_b32 exec_hi, 0xff00ff
  buffer_store_short v20, v8, s[12:15], 0 offen
  s_cmp_lg_u32 s52, 0
  s_cbranch_scc1 L_fin
  v_mov_b32 v16, s24
  s_mov_b64 exec, 1
  buffer_store_dword v16, off, s[8:11], 0 sc1
L_fin:
L_end:
  s_endpgm
.section .rodata,"a"
.p2align 6
.amdhsa_kernel parallel_sum__spectral_fnet__moe_arch_mod__prompt_kernel
  .amdhsa_next_free_vgpr 256
  .amdhsa_next_free_sgpr 102
  .amdhsa_accum_offset 256
  .amdhsa_group_segment_fixed_size 0
  .amdhsa_kernarg_size 104
  .amdhsa_user_sgpr_count 2
  .amdhsa_user_sgpr_kernarg_segment_ptr 1
  .amdhsa_system_sgpr_workgroup_id_x 1
.end_amdhsa_kernel
.p2align 8
L_tab:
.quad 0x3fb23fa73f973f80,0x3f973fa73fb23fb5,0x3fa73fb53fa73f80,0xbf0b25003f0b3f80,0x3f493fa73fb23f80,0xbfb2bfa7bf492500,0x25003f803fb53f80,0xa5c0bf80bfb5bf80,0xbf80bf803f803f80,0xbf80bf803f803f80,0xbe8dbfa73f493f80,0x3f49bfa7be8d3fb5,0x3f0bbfb53f0b3f80,0x3fa7a708bfa73f80,0x3f97bfa73e8d3f80,0xbe8d3fa7bf9726f0
.quad 0xbf493f0b3fb23f80,0x3fb23f0bbf49bfb5,0xbfa725003fa73f80,0x3f0b3fb53f0bbf80,0xbfb2bf0b3f973f80,0xbf973f0b3fb2a5c0,0x3f803f803f803f80,0x3f803f803f803f80,0x3fb5bf8025003f80,0xbfb53f80a708bf80,0x3f97bf0bbe8d3f80,0xbe8dbf0b3f97bfb5,0x3f0ba5c0bf0b3f80,0x3fa7bfb53fa7bf80,0xbe8d3f0bbf493f80,0x3f49bf0b3e8da708
.quad 0x3e8d3f0b3f493f80,0xbf49bf0bbe8d2500,0xbf0b25003f0b3f80,0xbfa7bfb5bfa7bf80,0xbf97bf0b3e8d3f80,0x3e8dbf0bbf97bfb5,0xbfb5bf8025003f80,0x3fb53f80a580bf80,0x3f80bf80bf803f80,0x3f80bf80bf803f80,0x3fb2bf0bbf973f80,0x3f973f0bbfb225c0,0x3fa7a580bfa73f80,0xbf0b3fb5bf0bbf80,0x3f493f0bbfb23f80,0xbfb23f0b3f49bfb5
.quad 0xbf97bfa7be8d3f80,0x3e8d3fa73f97a580,0xbf0bbfb5bf0b3f80,0xbfa725c03fa73f80,0x3e8dbfa7bf493f80,0xbf49bfa73e8d3fb5,0xbf803f80bf803f80,0xbf803f80bf803f80,0x25c03f80bfb53f80,0x25c0bf803fb5bf80,0xbf493fa7bfb23f80,0x3fb2bfa73f492660,0xbfa73fb5bfa73f80,0x3f0b25c0bf0b3f80,0xbfb23fa7bf973f80,0xbf973fa7bfb23fb5
.quad 0x3e8d3f0b3f493f80,0xbf49bf0bbe8d2500,0xbfa7bfb5bfa7bf80,0x3f0ba5c0bf0bbf80,0x3f973f0bbe8dbf80,0xbe8d3f0b3f973fb5,0x26f03f803fb53f80,0xa708bf80bfb5bf80,0xbf80bf803f803f80,0xbf80bf803f803f80,0x3fb2bf0bbf973f80,0x3f973f0bbfb22728,0xbf0b3fb5bf0bbf80,0xbfa727483fa7bf80,0xbf49bf0b3fb2bf80,0x3fb2bf0bbf493fb5
.quad 0xbf97bfa7be8d3f80,0x3e8d3fa73f97a708,0x3fa7a708bfa7bf80,0xbf0bbfb5bf0b3f80,0xbe8d3fa73f49bf80,0x3f493fa7be8dbfb5,0x3f803f803f803f80,0x3f803f803f803f80,0x3fb5bf8027283f80,0xbfb53f802718bf80,0xbf493fa7bfb23f80,0x3fb2bfa73f49a758,0xbf0b27483f0bbf80,0xbfa73fb5bfa73f80,0x3fb2bfa73f97bf80,0x3f97bfa73fb2bfb5
.quad 0xbfb2bfa7bf97bf80,0xbf97bfa7bfb2bfb5,0x3f0ba580bf0bbf80,0x3fa73fb53fa73f80,0x3f493fa73fb23f80,0xbfb2bfa7bf4925c0,0xbfb5bf8025c03f80,0x3fb53f802660bf80,0x3f80bf80bf803f80,0x3f80bf80bf803f80,0x3e8d3fa7bf49bf80,0xbf493fa73e8dbfb5,0xbfa7a5003fa7bf80,0x3f0bbfb53f0b3f80,0x3f97bfa73e8d3f80,0xbe8d3fa7bf972500
.quad 0x3f49bf0bbfb2bf80,0xbfb2bf0b3f493fb5,0x3f0b3fb53f0bbf80,0x3fa725c0bfa7bf80,0xbfb2bf0b3f973f80,0xbf973f0b3fb225c0,0xbf803f80bf803f80,0xbf803f80bf803f80,0x27bc3f80bfb53f80,0xa842bf803fb5bf80,0xbf973f0b3e8dbf80,0x3e8d3f0bbf973fb5,0x3fa7bfb53fa7bf80,0xbf0b27d43f0bbf80,0xbe8d3f0bbf493f80,0x3f49bf0b3e8da660
.quad 0xbfb2bfa7bf97bf80,0xbf97bfa7bfb2bfb5,0x3fa73fb53fa73f80,0xbf0b26f03f0b3f80,0xbf49bfa7bfb2bf80,0x3fb23fa73f49a708,0x27183f803fb53f80,0xa728bf80bfb5bf80,0xbf80bf803f803f80,0xbf80bf803f803f80,0x3e8d3fa7bf49bf80,0xbf493fa73e8dbfb5,0x3f0bbfb53f0b3f80,0x3fa7a81cbfa73f80,0xbf973fa7be8dbf80,0x3e8dbfa73f9726d0
.quad 0x3f49bf0bbfb2bf80,0xbfb2bf0b3f493fb5,0xbfa727283fa73f80,0x3f0b3fb53f0bbf80,0x3fb23f0bbf97bf80,0x3f97bf0bbfb22748,0x3f803f803f803f80,0x3f803f803f803f80,0x3fb5bf80a7ec3f80,0xbfb53f802690bf80,0xbf973f0b3e8dbf80,0x3e8d3f0bbf973fb5,0x3f0b2690bf0b3f80,0x3fa7bfb53fa7bf80,0x3e8dbf0b3f49bf80,0xbf493f0bbe8d27a4
.quad 0xbe8dbf0bbf49bf80,0x3f493f0b3e8da580,0xbf0b25c03f0b3f80,0xbfa7bfb5bfa7bf80,0x3f973f0bbe8dbf80,0xbe8d3f0b3f973fb5,0xbfb5bf80a6203f80,0x3fb53f8025c0bf80,0x3f80bf80bf803f80,0x3f80bf80bf803f80,0xbfb23f0b3f97bf80,0xbf97bf0b3fb2a660,0x3fa7a660bfa73f80,0xbf0b3fb5bf0bbf80,0xbf49bf0b3fb2bf80,0x3fb2bf0bbf493fb5
.quad 0x3f973fa73e8dbf80,0xbe8dbfa7bf97a500,0xbf0bbfb5bf0b3f80,0xbfa727bc3fa73f80,0xbe8d3fa73f49bf80,0x3f493fa7be8dbfb5,0xbf803f80bf803f80,0xbf803f80bf803f80,0x27e43f80bfb53f80,0xa6f0bf803fb5bf80,0x3f49bfa73fb2bf80,0xbfb23fa7bf4927ec,0xbfa73fb5bfa73f80,0x3f0ba85abf0b3f80,0x3fb2bfa73f97bf80,0x3f97bfa73fb2bfb5
.quad 0xbe8dbf0bbf49bf80,0x3f493f0b3e8da5c0,0xbfa7bfb5bfa7bf80,0x3f0ba708bf0bbf80,0xbf97bf0b3e8d3f80,0x3e8dbf0bbf97bfb5,0x27283f803fb53f80,0xa738bf80bfb5bf80,0xbf80bf803f803f80,0xbf80bf803f803f80,0xbfb23f0b3f97bf80,0xbf97bf0b3fb22690,0xbf0b3fb5bf0bbf80,0xbfa727a43fa7bf80,0x3f493f0bbfb23f80,0xbfb23f0b3f49bfb5
.quad 0x3f973fa73e8dbf80,0xbe8dbfa7bf972748,0x3fa72718bfa7bf80,0xbf0bbfb5bf0b3f80,0x3e8dbfa7bf493f80,0xbf49bfa73e8d3fb5,0x3f803f803f803f80,0x3f803f803f803f80,0x3fb5bf8027a43f80,0xbfb53f80a836bf80,0x3f49bfa73fb2bf80,0xbfb23fa7bf4927bc,0xbf0ba8873f0bbf80,0xbfa73fb5bfa73f80,0xbfb23fa7bf973f80,0xbf973fa7bfb23fb5
.quad 0x3fb23fa73f973f80,0x3f973fa73fb23fb5,0x3f0b2660bf0bbf80,0x3fa73fb53fa73f80,0xbf49bfa7bfb2bf80,0x3fb23fa73f4925c0,0xbfb5bf80a5003f80,0x3fb53f800000bf80,0x3f80bf80bf803f80,0x3f80bf80bf803f80,0xbe8dbfa73f493f80,0x3f49bfa7be8d3fb5,0xbfa7a7783fa7bf80,0x3f0bbfb53f0b3f80,0xbf973fa7be8dbf80,0x3e8dbfa73f97a718
.quad 0xbf493f0b3fb23f80,0x3fb23f0bbf49bfb5,0x3f0b3fb53f0bbf80,0x3fa7a842bfa7bf80,0x3fb23f0bbf97bf80,0x3f97bf0bbfb227d4,0xbf803f80bf803f80,0xbf803f80bf803f80,0x28023f80bfb53f80,0xa866bf803fb5bf80,0x3f97bf0bbe8d3f80,0xbe8dbf0b3f97bfb5,0x3fa7bfb53fa7bf80,0xbf0b28a53f0bbf80,0x3e8dbf0b3f49bf80,0xbf493f0bbe8da6f0
.quad 0x3e8d3f0b3f493f80,0xbf49bf0bbe8d2500,0xbf0b25003f0b3f80,0xbfa7bfb5bfa7bf80,0xbf97bf0b3e8d3f80,0x3e8dbf0bbf97bfb5,0xbfb5bf8025003f80,0x3fb53f80a580bf80,0x3f80bf80bf803f80,0x3f80bf80bf803f80,0x3fb2bf0bbf973f80,0x3f973f0bbfb225c0,0x3fa7a580bfa73f80,0xbf0b3fb5bf0bbf80,0x3f493f0bbfb23f80,0xbfb23f0b3f49bfb5
.quad 0xbf97bfa7be8d3f80,0x3e8d3fa73f97a580,0xbf0bbfb5bf0b3f80,0xbfa725c03fa73f80,0x3e8dbfa7bf493f80,0xbf49bfa73e8d3fb5,0x3f803f803f803f80,0x3f803f803f803f80,0x25c03f80bfb53f80,0x25c0bf803fb5bf80,0xbf493fa7bfb23f80,0x3fb2bfa73f492660,0xbfa73fb5bfa73f80,0x3f0b25c0bf0b3f80,0xbfb23fa7bf973f80,0xbf973fa7bfb23fb5
.quad 0x3fb23fa73f973f80,0x3f973fa73fb23fb5,0x3fa73fb53fa73f80,0xbf0b25003f0b3f80,0x3f493fa73fb23f80,0xbfb2bfa7bf492500,0x25003f803fb53f80,0xa5c0bf80bfb5bf80,0xbf80bf803f803f80,0xbf80bf803f803f80,0xbe8dbfa73f493f80,0x3f49bfa7be8d3fb5,0x3f0bbfb53f0b3f80,0x3fa7a708bfa73f80,0x3f97bfa73e8d3f80,0xbe8d3fa7bf9726f0
.quad 0xbf493f0b3fb23f80,0x3fb23f0bbf49bfb5,0xbfa725003fa73f80,0x3f0b3fb53f0bbf80,0xbfb2bf0b3f973f80,0xbf973f0b3fb2a5c0,0xbf803f80bf803f80,0xbf803f80bf803f80,0x3fb5bf8025003f80,0xbfb53f80a708bf80,0x3f97bf0bbe8d3f80,0xbe8dbf0b3f97bfb5,0x3f0ba5c0bf0b3f80,0x3fa7bfb53fa7bf80,0xbe8d3f0bbf493f80,0x3f49bf0b3e8da708
.quad 0xbfb2bfa7bf97bf80,0xbf97bfa7bfb2bfb5,0x3f0ba580bf0bbf80,0x3fa73fb53fa73f80,0x3f493fa73fb23f80,0xbfb2bfa7bf4925c0,0xbfb5bf8025c03f80,0x3fb53f802660bf80,0x3f80bf80bf803f80,0x3f80bf80bf803f80,0x3e8d3fa7bf49bf80,0xbf493fa73e8dbfb5,0xbfa7a5003fa7bf80,0x3f0bbfb53f0b3f80,0x3f97bfa73e8d3f80,0xbe8d3fa7bf972500
.quad 0x3f49bf0bbfb2bf80,0xbfb2bf0b3f493fb5,0x3f0b3fb53f0bbf80,0x3fa725c0bfa7bf80,0xbfb2bf0b3f973f80,0xbf973f0b3fb225c0,0x3f803f803f803f80,0x3f803f803f803f80,0x27bc3f80bfb53f80,0xa842bf803fb5bf80,0xbf973f0b3e8dbf80,0x3e8d3f0bbf973fb5,0x3fa7bfb53fa7bf80,0xbf0b27d43f0bbf80,0xbe8d3f0bbf493f80,0x3f49bf0b3e8da660
.quad 0x3e8d3f0b3f493f80,0xbf49bf0bbe8d2500,0xbfa7bfb5bfa7bf80,0x3f0ba5c0bf0bbf80,0x3f973f0bbe8dbf80,0xbe8d3f0b3f973fb5,0x26f03f803fb53f80,0xa708bf80bfb5bf80,0xbf80bf803f803f80,0xbf80bf803f803f80,0x3fb2bf0bbf973f80,0x3f973f0bbfb22728,0xbf0b3fb5bf0bbf80,0xbfa727483fa7bf80,0xbf49bf0b3fb2bf80,0x3fb2bf0bbf493fb5
.quad 0xbf97bfa7be8d3f80,0x3e8d3fa73f97a708,0x3fa7a708bfa7bf80,0xbf0bbfb5bf0b3f80,0xbe8d3fa73f49bf80,0x3f493fa7be8dbfb5,0xbf803f80bf803f80,0xbf803f80bf803f80,0x3fb5bf8027283f80,0xbfb53f802718bf80,0xbf493fa7bfb23f80,0x3fb2bfa73f49a758,0xbf0b27483f0bbf80,0xbfa73fb5bfa73f80,0x3fb2bfa73f97bf80,0x3f97bfa73fb2bfb5
.quad 0xbe8dbf0bbf49bf80,0x3f493f0b3e8da580,0xbf0b25c03f0b3f80,0xbfa7bfb5bfa7bf80,0x3f973f0bbe8dbf80,0xbe8d3f0b3f973fb5,0xbfb5bf80a6203f80,0x3fb53f8025c0bf80,0x3f80bf80bf803f80,0x3f80bf80bf803f80,0xbfb23f0b3f97bf80,0xbf97bf0b3fb2a660,0x3fa7a660bfa73f80,0xbf0b3fb5bf0bbf80,0xbf49bf0b3fb2bf80,0x3fb2bf0bbf493fb5
.quad 0x3f973fa73e8dbf80,0xbe8dbfa7bf97a500,0xbf0bbfb5bf0b3f80,0xbfa727bc3fa73f80,0xbe8d3fa73f49bf80,0x3f493fa7be8dbfb5,0x3f803f803f803f80,0x3f803f803f803f80,0x27e43f80bfb53f80,0xa6f0bf803fb5bf80,0x3f49bfa73fb2bf80,0xbfb23fa7bf4927ec,0xbfa73fb5bfa73f80,0x3f0ba85abf0b3f80,0x3fb2bfa73f97bf80,0x3f97bfa73fb2bfb5
.quad 0xbfb2bfa7bf97bf80,0xbf97bfa7bfb2bfb5,0x3fa73fb53fa73f80,0xbf0b26f03f0b3f80,0xbf49bfa7bfb2bf80,0x3fb23fa73f49a708,0x27183f803fb53f80,0xa728bf80bfb5bf80,0xbf80bf803f803f80,0xbf80bf803f803f80,0x3e8d3fa7bf49bf80,0xbf493fa73e8dbfb5,0x3f0bbfb53f0b3f80,0x3fa7a81cbfa73f80,0xbf973fa7be8dbf80,0x3e8dbfa73f9726d0
.quad 0x3f49bf0bbfb2bf80,0xbfb2bf0b3f493fb5,0xbfa727283fa73f80,0x3f0b3fb53f0bbf80,0x3fb23f0bbf97bf80,0x3f97bf0bbfb22748,0xbf803f80bf803f80,0xbf803f80bf803f80,0x3fb5bf80a7ec3f80,0xbfb53f802690bf80,0xbf973f0b3e8dbf80,0x3e8d3f0bbf973fb5,0x3f0b2690bf0b3f80,0x3fa7bfb53fa7bf80,0x3e8dbf0b3f49bf80,0xbf493f0bbe8d27a4
.quad 0x3fb23fa73f973f80,0x3f973fa73fb23fb5,0x3f0b2660bf0bbf80,0x3fa73fb53fa73f80,0xbf49bfa7bfb2bf80,0x3fb23fa73f4925c0,0xbfb5bf80a5003f80,0x3fb53f800000bf80,0x3f80bf80bf803f80,0x3f80bf80bf803f80,0xbe8dbfa73f493f80,0x3f49bfa7be8d3fb5,0xbfa7a7783fa7bf80,0x3f0bbfb53f0b3f80,0xbf973fa7be8dbf80,0x3e8dbfa73f97a718
.quad 0xbf493f0b3fb23f80,0x3fb23f0bbf49bfb5,0x3f0b3fb53f0bbf80,0x3fa7a842bfa7bf80,0x3fb23f0bbf97bf80,0x3f97bf0bbfb227d4,0x3f803f803f803f80,0x3f803f803f803f80,0x28023f80bfb53f80,0xa866bf803fb5bf80,0x3f97bf0bbe8d3f80,0xbe8dbf0b3f97bfb5,0x3fa7bfb53fa7bf80,0xbf0b28a53f0bbf80,0x3e8dbf0b3f49bf80,0xbf493f0bbe8da6f0
.quad 0xbe8dbf0bbf49bf80,0x3f493f0b3e8da5c0,0xbfa7bfb5bfa7bf80,0x3f0ba708bf0bbf80,0xbf97bf0b3e8d3f80,0x3e8dbf0bbf97bfb5,0x27283f803fb53f80,0xa738bf80bfb5bf80,0xbf80bf803f803f80,0xbf80bf803f803f80,0xbfb23f0b3f97bf80,0xbf97bf0b3fb22690,0xbf0b3fb5bf0bbf80,0xbfa727a43fa7bf80,0x3f493f0bbfb23f80,0xbfb23f0b3f49bfb5
.quad 0x3f973fa73e8dbf80,0xbe8dbfa7bf972748,0x3fa72718bfa7bf80,0xbf0bbfb5bf0b3f80,0x3e8dbfa7bf493f80,0xbf49bfa73e8d3fb5,0xbf803f80bf803f80,0xbf803f80bf803f80,0x3fb5bf8027a43f80,0xbfb53f80a836bf80,0x3f49bfa73fb2bf80,0xbfb23fa7bf4927bc,0xbf0ba8873f0bbf80,0xbfa73fb5bfa73f80,0xbfb23fa7bf973f80,0xbf973fa7bfb23fb5
.quad 0x3c003c003c003c00,0x24b622481e480000,0x3bff3bff3c003c00,0x28b6264822480000,0x3bfd3bff3c003c00,0x2b1128b624b60000,0x3bfa3bfe3bff3c00,0x2cb52a4826480000,0x3bea3bf63bfe3c00,0x30b22e462a480000,0x3be43bf43bfd3c00,0x31472f0e2b110000,0x3bdd3bf13bfc3c00,0x31db2fd62bd90000,0x3bd63bed3bfb3c00,0x326f304e2c510000
.quad 0x3bf73bfc3bff3c00,0x2de22bd927da0000,0x3bf43bfa3bff3c00,0x2f0e2cb528b60000,0x3bef3bf83bfe3c00,0x301d2d7e297f0000,0x3c003c003c003c00,0,0x3bce3bea3bfa3c00,0x330330b22cb50000,0x3bc63be63bf93c00,0x339631152d1a0000,0x3bbc3be23bf83c00,0x341431792d7e0000,0x3bb23bdd3bf73c00,0x345d31db2de20000
.quad 0x3c003c003c003c00,0xa4b6a2489e488000,0x3bff3bff3c003c00,0xa8b6a648a2488000,0x3bfd3bff3c003c00,0xab11a8b6a4b68000,0x3bfa3bfe3bff3c00,0xacb5aa48a6488000,0x3bea3bf63bfe3c00,0xb0b2ae46aa488000,0x3be43bf43bfd3c00,0xb147af0eab118000,0x3bdd3bf13bfc3c00,0xb1dbafd6abd98000,0x3bd63bed3bfb3c00,0xb26fb04eac518000
.quad 0x3bf73bfc3bff3c00,0xade2abd9a7da8000,0x3bf43bfa3bff3c00,0xaf0eacb5a8b68000,0x3bef3bf83bfe3c00,0xb01dad7ea97f8000,0x3ba83bd93bf63c00,0xb4a5b23eae468000,0x3bce3bea3bfa3c00,0xb303b0b2acb58000,0x3bc63be63bf93c00,0xb396b115ad1a8000,0x3bbc3be23bf83c00,0xb414b179ad7e8000,0x3bb23bdd3bf73c00,0xb45db1dbade28000
.quad 0x3bfe3bff3bff3bff,0x297f28b627da2648,0x3bf83bfa3bfc3bfe,0x2d7e2cb52bd92a48,0x3bef3bf43bf73bfa,0x301d2f0e2de22cb5,0x3be23bea3bf13bf6,0x317930b22fd62e46,0x3b883ba83bc33bd9,0x356434a533c6323e,0x3b693b913bb23bce,0x36083534345d3303,0x3b463b773ba03bc3,0x36aa35c234d533c6,0x3b203b5a3b8c3bb6,0x3748364e354c3444
.quad 0x3bd13bdd3be83bf1,0x32d231db30e42fd6,0x3bbc3bce3bdd3bea,0x3414330331db30b2,0x3ba43bbc3bd13be2,0x34bd341432d23179,0x3c003c003c003c00,0,0x3af63b3b3b773ba8,0x37e336d735c234a5,0x3ac93b1a3b5f3b99,0x383d375e36373505,0x3a993af63b463b88,0x388737e336aa3564,0x3a653ad03b2b3b77,0x38ce3832371b35c2
.quad 0x3bfe3bff3bff3bff,0xa97fa8b6a7daa648,0x3bf83bfa3bfc3bfe,0xad7eacb5abd9aa48,0x3bef3bf43bf73bfa,0xb01daf0eade2acb5,0x3be23bea3bf13bf6,0xb179b0b2afd6ae46,0x3b883ba83bc33bd9,0xb564b4a5b3c6b23e,0x3b693b913bb23bce,0xb608b534b45db303,0x3b463b773ba03bc3,0xb6aab5c2b4d5b3c6,0x3b203b5a3b8c3bb6,0xb748b64eb54cb444
.quad 0x3bd13bdd3be83bf1,0xb2d2b1dbb0e4afd6,0x3bbc3bce3bdd3bea,0xb414b303b1dbb0b2,0x3ba43bbc3bd13be2,0xb4bdb414b2d2b179,0x3a2f3aa73b0e3b64,0xb913b872b78bb61f,0x3af63b3b3b773ba8,0xb7e3b6d7b5c2b4a5,0x3ac93b1a3b5f3b99,0xb83db75eb637b505,0x3a993af63b463b88,0xb887b7e3b6aab564,0x3a653ad03b2b3b77,0xb8ceb832b71bb5c2
.quad 0x3bfb3bfc3bfd3bfe,0x2c512bd92b112a48,0x3bed3bf13bf43bf6,0x304e2fd62f0e2e46,0x3bd63bdd3be43bea,0x326f31db314730b2,0x3bb63bc33bce3bd9,0x344433c63303323e,0x3add3b0e3b3b3b64,0x381d378b36d7361f,0x3a923ad03b083b3b,0x3891383237a136d7,0x3a3f3a8a3ad03b0e,0x3900389b3832378b,0x39e53a3f3a923add,0x396939003891381d
.quad 0x3b8c3ba03bb23bc3,0x354c34d5345d33c6,0x3b5a3b773b913ba8,0x364e35c2353434a5,0x3b203b463b693b88,0x374836aa36083564,0x3c003c003c003c00,0,0x398439ed3a4f3aa7,0x39cb395f38ec3872,0x391d39963a073a6d,0x3a2739ba394338c4,0x38b0393a39ba3a2f,0x3a7c3a0f39963913,0x383d38d8396939ed,0x3ac93a5e39e5395f
.quad 0x3bfb3bfc3bfd3bfe,0xac51abd9ab11aa48,0x3bed3bf13bf43bf6,0xb04eafd6af0eae46,0x3bd63bdd3be43bea,0xb26fb1dbb147b0b2,0x3bb63bc33bce3bd9,0xb444b3c6b303b23e,0x3add3b0e3b3b3b64,0xb81db78bb6d7b61f,0x3a923ad03b083b3b,0xb891b832b7a1b6d7,0x3a3f3a8a3ad03b0e,0xb900b89bb832b78b,0x39e53a3f3a923add,0xb969b900b891b81d
.quad 0x3b8c3ba03bb23bc3,0xb54cb4d5b45db3c6,0x3b5a3b773b913ba8,0xb64eb5c2b534b4a5,0x3b203b463b693b88,0xb748b6aab608b564,0x378b3872391339a8,0xbb0ebaa7ba2fb9a8,0x398439ed3a4f3aa7,0xb9cbb95fb8ecb872,0x391d39963a073a6d,0xba27b9bab943b8c4,0x38b0393a39ba3a2f,0xba7cba0fb996b913,0x383d38d8396939ed,0xbac9ba5eb9e5b95f
.quad 0x3bf73bf83bf93bfa,0x2de22d7e2d1a2cb5,0x3bdd3be23be63bea,0x31db3179311530b2,0x3bb23bbc3bc63bce,0x345d341433963303,0x3b773b883b993ba8,0x35c23564350534a5,0x39ed3a2f3a6d3aa7,0x395f391338c43872,0x396939ba3a073a4f,0x39e53996394338ec,0x38d8393a399639ed,0x3a5e3a0f39ba395f,0x383d38b0391d3984,0x3ac93a7c3a2739cb
.quad 0x3b2b3b463b5f3b77,0x371b36aa363735c2,0x3ad03af63b1a3b3b,0x383237e3375e36d7,0x3a653a993ac93af6,0x38ce3887383d37e3,0x3c003c003c003c00,0,0x3732381d389b3913,0x3b253add3a8a3a2f,0x35da37053812389b,0x3b723b303ae33a8a,0x347535c23705381d,0x3baf3b773b303add,0x320d347535da3732,0x3bdb3baf3b723b25
.quad 0x3bf73bf83bf93bfa,0xade2ad7ead1aacb5,0x3bdd3be23be63bea,0xb1dbb179b115b0b2,0x3bb23bbc3bc63bce,0xb45db414b396b303,0x3b773b883b993ba8,0xb5c2b564b505b4a5,0x39ed3a2f3a6d3aa7,0xb95fb913b8c4b872,0x396939ba3a073a4f,0xb9e5b996b943b8ec,0x38d8393a399639ed,0xba5eba0fb9bab95f,0x383d38b0391d3984,0xbac9ba7cba27b9cb
.quad 0x3b2b3b463b5f3b77,0xb71bb6aab637b5c2,0x3ad03af63b1a3b3b,0xb832b7e3b75eb6d7,0x3a653a993ac93af6,0xb8ceb887b83db7e3,0x2e46323e34a5361f,0xbbf6bbd9bba8bb64,0x3732381d389b3913,0xbb25baddba8aba2f,0x35da37053812389b,0xbb72bb30bae3ba8a,0x347535c23705381d,0xbbafbb77bb30badd,0x320d347535da3732,0xbbdbbbafbb72bb25
.quad 0x3bf23bf43bf53bf6,0x2f722f0e2eaa2e46,0x3bc93bce3bd43bd9,0x3365330332a1323e,0x3b843b913b9d3ba8,0x357c353434ed34a5,0x3b253b3b3b503b64,0x373236d7367c361f,0x38c43913395f39a8,0x3a6d3a2f39ed39a8,0x37f9385d38ba3913,0x3af03ab53a743a2f,0x364e373238073872,0x3b5a3b253ae93aa7,0x348d35933693378b,0x3bab3b803b4b3b0e
.quad 0x3aae3ad03af03b0e,0x3867383237f9378b,0x3a1f3a4f3a7c3aa7,0x392738ec38b03872,0x397b39ba39f63a2f,0x39d4399639563913,0x3c003c003c003c00,0,0x317933c63505361f,0x3be23bc33b993b64,0x2b11304e32d234a5,0x3bfd3bed3bd13ba8,0xabd926482f0e323e,0x3bfc3bff3bf43bd9,0xb1aaad7e1e482e46,0x3be03bf83c003bf6
.quad 0x3bf23bf43bf53bf6,0xaf72af0eaeaaae46,0x3bc93bce3bd43bd9,0xb365b303b2a1b23e,0x3b843b913b9d3ba8,0xb57cb534b4edb4a5,0x3b253b3b3b503b64,0xb732b6d7b67cb61f,0x38c43913395f39a8,0xba6dba2fb9edb9a8,0x37f9385d38ba3913,0xbaf0bab5ba74ba2f,0x364e373238073872,0xbb5abb25bae9baa7,0x348d35933693378b,0xbbabbb80bb4bbb0e
.quad 0x3aae3ad03af03b0e,0xb867b832b7f9b78b,0x3a1f3a4f3a7c3aa7,0xb927b8ecb8b0b872,0x397b39ba39f63a2f,0xb9d4b996b956b913,0xb4a5b23eae460000,0xbba8bbd9bbf6bc00,0x317933c63505361f,0xbbe2bbc3bb99bb64,0x2b11304e32d234a5,0xbbfdbbedbbd1bba8,0xabd926482f0e323e,0xbbfcbbffbbf4bbd9,0xb1aaad7e1e482e46,0xbbe0bbf8bc00bbf6
.quad 0x3bec3bed3bef3bf1,0x3080304e301d2fd6,0x3baf3bb63bbc3bc3,0x34753444341433c6,0x3b4b3b5a3b693b77,0x3693364e360835c2,0x3ac23add3af63b0e,0x3848381d37e3378b,0x36d7378b381d3872,0x3b3b3b0e3add3aa7,0x34bd359336653732,0x3ba43b803b553b25,0x3115330334753564,0x3be63bce3baf3b88,0x24b62d7e30e43303,0x3c003bf83be83bce
.quad 0x3a173a3f3a653a8a,0x3930390038ce389b,0x394d398439ba39ed,0x39fe39cb3996395f,0x386738b038f6393a,0x3aae3a7c3a473a0f,0x3c003c003c003c00,0,0xafd6aa4826482e46,0x3bf13bfe3bff3bf6,0xb42cb1dbaeaaa648,0x3bb93bdd3bf53bff,0xb64eb505b365b0b2,0x3b5a3b993bc93bea,0xb828b705b5abb444,0x3ad63b303b7b3bb6
.quad 0x3bec3bed3bef3bf1,0xb080b04eb01dafd6,0x3baf3bb63bbc3bc3,0xb475b444b414b3c6,0x3b4b3b5a3b693b77,0xb693b64eb608b5c2,0x3ac23add3af63b0e,0xb848b81db7e3b78b,0x36d7378b381d3872,0xbb3bbb0ebaddbaa7,0x34bd359336653732,0xbba4bb80bb55bb25,0x3115330334753564,0xbbe6bbcebbafbb88,0x24b62d7e30e43303,0xbc00bbf8bbe8bbce
.quad 0x3a173a3f3a653a8a,0xb930b900b8ceb89b,0x394d398439ba39ed,0xb9feb9cbb996b95f,0x386738b038f6393a,0xbaaeba7cba47ba0f,0xb913b872b78bb61f,0xba2fbaa7bb0ebb64,0xafd6aa4826482e46,0xbbf1bbfebbffbbf6,0xb42cb1dbaeaaa648,0xbbb9bbddbbf5bbff,0xb64eb505b365b0b2,0xbb5abb99bbc9bbea,0xb828b705b5abb444,0xbad6bb30bb7bbbb6
.quad 0x3be43be63be83bea,0x3147311530e430b2,0x3b913b993ba03ba8,0x3534350534d534a5,0x3b083b1a3b2b3b3b,0x37a1375e371b36d7,0x3a4f3a6d3a8a3aa7,0x38ec38c4389b3872,0x33c634a53564361f,0x3bc33ba83b883b64,0x2d1a304e320d33c6,0x3bf93bed3bdb3bc3,0xad7ea64828b62e46,0x3bf83bff3bff3bf6,0xb3f7b1dbaf72aa48,0x3bc03bdd3bf23bfe
.quad 0x3969399639c339ed,0x39e539ba398d395f,0x385d389b38d83913,0x3ab53a8a3a5e3a2f,0x3665370537a1381d,0x3b553b303b083add,0x3c003c003c003c00,0,0xb67cb564b444b23e,0x3b503b883bb63bd9,0xb867b7b7b693b564,0x3aae3b023b4b3b88,0xb972b8ecb85db78b,0x39dc3a4f3ab53b0e,0xba56b9dcb956b8c4,0x38e2397239f63a6d
.quad 0x3be43be63be83bea,0xb147b115b0e4b0b2,0x3b913b993ba03ba8,0xb534b505b4d5b4a5,0x3b083b1a3b2b3b3b,0xb7a1b75eb71bb6d7,0x3a4f3a6d3a8a3aa7,0xb8ecb8c4b89bb872,0x33c634a53564361f,0xbbc3bba8bb88bb64,0x2d1a304e320d33c6,0xbbf9bbedbbdbbbc3,0xad7ea64828b62e46,0xbbf8bbffbbffbbf6,0xb3f7b1dbaf72aa48,0xbbc0bbddbbf2bbfe
.quad 0x3969399639c339ed,0xb9e5b9bab98db95f,0x385d389b38d83913,0xbab5ba8aba5eba2f,0x3665370537a1381d,0xbb55bb30bb08badd,0xbb0ebaa7ba2fb9a8,0xb78bb872b913b9a8,0xb67cb564b444b23e,0xbb50bb88bbb6bbd9,0xb867b7b7b693b564,0xbaaebb02bb4bbb88,0xb972b8ecb85db78b,0xb9dcba4fbab5bb0e,0xba56b9dcb956b8c4,0xb8e2b972b9f6ba6d
.quad 0x3bdb3bdd3be03be2,0x320d31db31aa3179,0x3b6e3b773b803b88,0x35f135c235933564,0x3abc3ad03ae33af6,0x38523832381237e3,0x39cb39ed3a0f3a2f,0x3984395f393a3913,0x2a482e4630b2323e,0x3bfe3bf63bea3bd9,0xb080ad7ea7da2648,0x3bec3bf83bff3bff,0xb534b444b2a1b0b2,0x3b913bb63bd43bea,0xb7f9b705b608b505,0x3af03b303b693b99
.quad 0x38a638d83909393a,0x3a833a5e3a373a0f,0x36aa373237b7381d,0x3b463b253b023add,0x33963475351d35c2,0x3bc63baf3b953b77,0x3c003c003c003c00,0,0xb93ab8c4b848b78b,0x3a0f3a6d3ac23b0e,0xba47b9dcb969b8ec,0x38f6397239e53a4f,0xbb1abac2ba5eb9ed,0x375e384838d8395f,0xbbabbb6ebb20bac2,0x348d35f137483848
.quad 0x3bdb3bdd3be03be2,0xb20db1dbb1aab179,0x3b6e3b773b803b88,0xb5f1b5c2b593b564,0x3abc3ad03ae33af6,0xb852b832b812b7e3,0x39cb39ed3a0f3a2f,0xb984b95fb93ab913,0x2a482e4630b2323e,0xbbfebbf6bbeabbd9,0xb080ad7ea7da2648,0xbbecbbf8bbffbbff,0xb534b444b2a1b0b2,0xbb91bbb6bbd4bbea,0xb7f9b705b608b505,0xbaf0bb30bb69bb99
.quad 0x38a638d83909393a,0xba83ba5eba37ba0f,0x36aa373237b7381d,0xbb46bb25bb02badd,0x33963475351d35c2,0xbbc6bbafbb95bb77,0xbbf6bbd9bba8bb64,0xae46b23eb4a5b61f,0xb93ab8c4b848b78b,0xba0fba6dbac2bb0e,0xba47b9dcb969b8ec,0xb8f6b972b9e5ba4f,0xbb1abac2ba5eb9ed,0xb75eb848b8d8b95f,0xbbabbb6ebb20bac2,0xb48db5f1b748b848
.quad 0x3c003c003c003c00,0,0x3aa73b643bd93c00,0x3872361f323e0000,0x361f39a83b643c00,0x3b6439a8361f0000,0xb23e361f3aa73c00,0x3bd93b6438720000,0xb9a8000039a83c00,0x39a83c0039a80000,0xbbd9b61f38723c00,0x323e3b643aa70000,0xbb64b9a8361f3c00,0xb61f39a83b640000,0xb872bb64323e3c00,0xbaa7361f3bd90000
.quad 0x8000bc0000003c00,0xbc0000003c000000,0x3872bb64b23e3c00,0xbaa7b61f3bd90000,0x3b64b9a8b61f3c00,0xb61fb9a83b640000,0x3bd9b61fb8723c00,0x323ebb643aa70000,0x39a88000b9a83c00,0x39a8bc0039a80000,0x323e361fbaa73c00,0x3bd9bb6438720000,0xb61f39a8bb643c00,0x3b64b9a8361f0000,0xbaa73b64bbd93c00,0x3872b61f323e0000
.quad 0xbc003c00bc003c00,0x800000000000,0xbaa73b64bbd93c00,0xb872361fb23e0000,0xb61f39a8bb643c00,0xbb6439a8b61f0000,0x323e361fbaa73c00,0xbbd93b64b8720000,0x39a80000b9a83c00,0xb9a83c00b9a80000,0x3bd9b61fb8723c00,0xb23e3b64baa70000,0x3b64b9a8b61f3c00,0x361f39a8bb640000,0x3872bb64b23e3c00,0x3aa7361fbbd90000
.quad 0xbc0080003c00,0x3c000000bc000000,0xb872bb64323e3c00,0x3aa7b61fbbd90000,0xbb64b9a8361f3c00,0x361fb9a8bb640000,0xbbd9b61f38723c00,0xb23ebb64baa70000,0xb9a8800039a83c00,0xb9a8bc00b9a80000,0xb23e361f3aa73c00,0xbbd9bb64b8720000,0x361f39a83b643c00,0xbb64b9a8b61f0000,0x3aa73b643bd93c00,0xb872b61fb23e0000
.quad 0x3c003c003c003c00,0,0x323e361f387239a8,0x3bd93b643aa739a8,0xbb64b9a8b61f0000,0x361f39a83b643c00,0xb872bb64bbd9b9a8,0xbaa7b61f323e39a8,0x39a88000b9a8bc00,0xb9a8bc00b9a80000,0x3aa73b64323eb9a8,0x3872b61fbbd9b9a8,0xb61f39a83b648000,0x3b6439a8b61fbc00,0xbbd9b61f3aa739a8,0xb23e3b643872b9a8
.quad 0x8000bc0000003c00,0xbc0000003c008000,0x3bd9b61fbaa739a8,0xb23ebb64387239a8,0x361f39a8bb640000,0x3b64b9a8b61f3c00,0xbaa73b64b23eb9a8,0x3872361fbbd939a8,0xb9a8000039a8bc00,0xb9a83c00b9a80000,0x3872bb643bd9b9a8,0xbaa7361f323eb9a8,0x3b64b9a8361f8000,0x361fb9a83b64bc00,0xb23e361fb87239a8,0x3bd9bb643aa7b9a8
.quad 0xbc003c00bc003c00,0x800000008000,0xb23e361fb87239a8,0xbbd93b64baa739a8,0x3b64b9a8361f0000,0xb61f39a8bb643c00,0x3872bb643bd9b9a8,0x3aa7b61fb23e39a8,0xb9a8800039a8bc00,0x39a8bc0039a80000,0xbaa73b64b23eb9a8,0xb872b61f3bd9b9a8,0x361f39a8bb648000,0xbb6439a8361fbc00,0x3bd9b61fbaa739a8,0x323e3b64b872b9a8
.quad 0x8000bc0080003c00,0x3c000000bc008000,0xbbd9b61f3aa739a8,0x323ebb64b87239a8,0xb61f39a83b648000,0xbb64b9a8361f3c00,0x3aa73b64323eb9a8,0xb872361f3bd939a8,0x39a88000b9a8bc00,0x39a83c0039a80000,0xb872bb64bbd9b9a8,0x3aa7361fb23eb9a8,0xbb64b9a8b61f8000,0xb61fb9a8bb64bc00,0x323e361f387239a8,0xbbd9bb64baa7b9a8
.quad 0x3c003c003c003c00,0,0xb872b61fb23e0000,0x3aa73b643bd93c00,0xb61fb9a8bb64bc00,0xbb64b9a8b61f0000,0x3bd93b6438728000,0x323eb61fbaa7bc00,0xb9a8000039a83c00,0x39a83c0039a88000,0xb23ebb64baa70000,0xbbd9b61f38723c00,0x3b6439a8b61fbc00,0x361fb9a8bb640000,0xbaa7361f3bd98000,0x38723b64b23ebc00
.quad 0x8000bc0000003c00,0xbc0000003c008000,0x3aa7361fbbd90000,0x3872bb64b23e3c00,0xbb6439a8361fbc00,0x361f39a8bb640000,0x323ebb643aa78000,0xbbd9361f3872bc00,0x39a88000b9a83c00,0x39a8bc0039a88000,0xbbd93b64b8728000,0x323e361fbaa73c00,0x361fb9a83b64bc00,0xbb6439a8b61f0000,0x3872b61f323e8000,0x3aa7bb643bd9bc00
.quad 0xbc003c00bc003c00,0x800000008000,0x3872b61f323e8000,0xbaa73b64bbd93c00,0x361fb9a83b64bc00,0x3b64b9a8361f0000,0xbbd93b64b8728000,0xb23eb61f3aa7bc00,0x39a88000b9a83c00,0xb9a83c00b9a88000,0x323ebb643aa78000,0x3bd9b61fb8723c00,0xbb6439a8361fbc00,0xb61fb9a83b640000,0x3aa7361fbbd98000,0xb8723b64323ebc00
.quad 0xbc0080003c00,0x3c000000bc008000,0xbaa7361f3bd98000,0xb872bb64323e3c00,0x3b6439a8b61fbc00,0xb61f39a83b648000,0xb23ebb64baa78000,0x3bd9361fb872bc00,0xb9a8800039a83c00,0xb9a8bc00b9a88000,0x3bd93b6438728000,0xb23e361f3aa73c00,0xb61fb9a8bb64bc00,0x3b6439a8361f0000,0xb872b61fb23e8000,0xbaa7bb64bbd9bc00
.quad 0x3c003c003c003c00,0,0xbbd9bb64baa7b9a8,0x323e361f387239a8,0x3b6439a8361f8000,0xb61fb9a8bb64bc00,0xbaa7b61f323e39a8,0x38723b643bd939a8,0x39a88000b9a8bc00,0xb9a8bc00b9a80000,0xb872361f3bd939a8,0x3aa73b64323eb9a8,0x361fb9a8bb640000,0xbb64b9a8361f3c00,0xb23e3b643872b9a8,0x3bd9361fbaa7b9a8
.quad 0x8000bc0080003c00,0xbc0000003c008000,0x323e3b64b872b9a8,0x3bd9b61fbaa739a8,0xb61fb9a83b648000,0xbb6439a8361fbc00,0x3872361fbbd939a8,0x3aa7bb64323e39a8,0xb9a8800039a8bc00,0xb9a83c00b9a80000,0x3aa7b61fb23e39a8,0x3872bb643bd9b9a8,0xbb6439a8b61f8000,0xb61f39a8bb643c00,0x3bd9bb643aa7b9a8,0x323eb61f3872b9a8
.quad 0xbc003c00bc003c00,0x800080008000,0x3bd9bb643aa7b9a8,0xb23e361fb87239a8,0xbb6439a8b61f8000,0x361fb9a83b64bc00,0x3aa7b61fb23e39a8,0xb8723b64bbd939a8,0xb9a8800039a8bc00,0x39a8bc0039a80000,0x3872361fbbd939a8,0xbaa73b64b23eb9a8,0xb61fb9a83b640000,0x3b64b9a8b61f3c00,0x323e3b64b872b9a8,0xbbd9361f3aa7b9a8
.quad 0xbc0000003c00,0x3c008000bc008000,0xb23e3b643872b9a8,0xbbd9b61f3aa739a8,0x361fb9a8bb648000,0x3b6439a8b61fbc00,0xb872361f3bd939a8,0xbaa7bb64b23e39a8,0x39a80000b9a8bc00,0x39a83c0039a88000,0xbaa7b61f323e39a8,0xb872bb64bbd9b9a8,0x3b6439a8361f0000,0x361f39a83b643c00,0xbbd9bb64baa7b9a8,0xb23eb61fb872b9a8
.quad 0x3c003c003c003c00,0,0xbaa7bb64bbd9bc00,0xb872b61fb23e0000,0x361f39a83b643c00,0x3b6439a8361f8000,0x323eb61fbaa7bc00,0xbbd9bb64b8720000,0xb9a8000039a83c00,0x39a83c0039a88000,0x3bd9361fb872bc00,0xb23ebb64baa70000,0xbb64b9a8361f3c00,0xb61f39a83b648000,0x38723b64b23ebc00,0x3aa7b61fbbd90000
.quad 0x8000bc0080003c00,0xbc0000003c008000,0xb8723b64323ebc00,0x3aa7361fbbd90000,0x3b64b9a8b61f3c00,0xb61fb9a83b648000,0xbbd9361f3872bc00,0xb23e3b64baa70000,0x39a88000b9a83c00,0x39a8bc0039a88000,0xb23eb61f3aa7bc00,0xbbd93b64b8728000,0xb61f39a8bb643c00,0x3b64b9a8361f8000,0x3aa7bb643bd9bc00,0xb872361fb23e0000
.quad 0xbc003c00bc003c00,0x800080008000,0x3aa7bb643bd9bc00,0x3872b61f323e8000,0xb61f39a8bb643c00,0xbb6439a8b61f8000,0xb23eb61f3aa7bc00,0x3bd9bb6438720000,0x39a80000b9a83c00,0xb9a83c00b9a88000,0xbbd9361f3872bc00,0x323ebb643aa78000,0x3b64b9a8b61f3c00,0x361f39a8bb648000,0xb8723b64323ebc00,0xbaa7b61f3bd90000
.quad 0xbc0000003c00,0x3c000000bc008000,0x38723b64b23ebc00,0xbaa7361f3bd98000,0xbb64b9a8361f3c00,0x361fb9a8bb640000,0x3bd9361fb872bc00,0x323e3b643aa70000,0xb9a8000039a83c00,0xb9a8bc00b9a88000,0x323eb61fbaa7bc00,0x3bd93b6438728000,0x361f39a83b643c00,0xbb64b9a8b61f8000,0xbaa7bb64bbd9bc00,0x3872361f323e0000
.quad 0x3c003c003c003c00,0,0xb23eb61fb872b9a8,0xbbd9bb64baa7b9a8,0xbb64b9a8b61f0000,0x361f39a83b643c00,0x38723b643bd939a8,0x3aa7361fb23eb9a8,0x39a88000b9a8bc00,0xb9a8bc00b9a80000,0xbaa7bb64b23e39a8,0xb872361f3bd939a8,0xb61f39a83b648000,0x3b6439a8b61fbc00,0x3bd9361fbaa7b9a8,0x323ebb64b87239a8
.quad 0x8000bc0080003c00,0xbc0000003c008000,0xbbd9361f3aa7b9a8,0x323e3b64b872b9a8,0x361f39a8bb648000,0x3b64b9a8b61f3c00,0x3aa7bb64323e39a8,0xb872b61f3bd9b9a8,0xb9a8000039a8bc00,0xb9a83c00b9a80000,0xb8723b64bbd939a8,0x3aa7b61fb23e39a8,0x3b64b9a8361f8000,0x361fb9a83b64bc00,0x323eb61f3872b9a8,0xbbd93b64baa739a8
.quad 0xbc003c00bc003c00,0x800080008000,0x323eb61f3872b9a8,0x3bd9bb643aa7b9a8,0x3b64b9a8361f0000,0xb61f39a8bb643c00,0xb8723b64bbd939a8,0xbaa7361f323eb9a8,0xb9a8800039a8bc00,0x39a8bc0039a88000,0x3aa7bb64323e39a8,0x3872361fbbd939a8,0x361f39a8bb640000,0xbb6439a8361fbc00,0xbbd9361f3aa7b9a8,0xb23ebb64387239a8
.quad 0xbc0000003c00,0x3c000000bc008000,0x3bd9361fbaa7b9a8,0xb23e3b643872b9a8,0xb61f39a83b640000,0xbb64b9a8361f3c00,0xbaa7bb64b23e39a8,0x3872b61fbbd9b9a8,0x39a80000b9a8bc00,0x39a83c0039a80000,0x38723b643bd939a8,0xbaa7b61f323e39a8,0xbb64b9a8b61f8000,0xb61fb9a8bb64bc00,0xb23eb61fb872b9a8,0x3bd93b643aa739a8
.quad 0x3c003c003c003c00,0,0x3872361f323e8000,0xbaa7bb64bbd9bc00,0xb61fb9a8bb64bc00,0xbb64b9a8b61f0000,0xbbd9bb64b8720000,0xb23e361f3aa73c00,0xb9a8800039a83c00,0x39a83c0039a88000,0x323e3b643aa78000,0x3bd9361fb872bc00,0x3b6439a8b61fbc00,0x361fb9a8bb640000,0x3aa7b61fbbd98000,0xb872bb64323e3c00
.quad 0x8000bc0080003c00,0xbc0080003c008000,0xbaa7b61f3bd98000,0xb8723b64323ebc00,0xbb6439a8361fbc00,0x361f39a8bb640000,0xb23e3b64baa70000,0x3bd9b61fb8723c00,0x39a80000b9a83c00,0x39a8bc0039a88000,0x3bd9bb6438728000,0xb23eb61f3aa7bc00,0x361fb9a83b64bc00,0xbb6439a8b61f8000,0xb872361fb23e0000,0xbaa73b64bbd93c00
.quad 0xbc003c00bc003c00,0x80008000,0xb872361fb23e8000,0x3aa7bb643bd9bc00,0x361fb9a83b64bc00,0x3b64b9a8361f0000,0x3bd9bb6438720000,0x323e361fbaa73c00,0x39a88000b9a83c00,0xb9a83c00b9a88000,0xb23e3b64baa70000,0xbbd9361f3872bc00,0xbb6439a8361fbc00,0xb61fb9a83b640000,0xbaa7b61f3bd90000,0x3872bb64b23e3c00
.quad 0xbc0080003c00,0x3c008000bc008000,0x3aa7b61fbbd98000,0x38723b64b23ebc00,0x3b6439a8b61fbc00,0xb61f39a83b640000,0x323e3b643aa70000,0xbbd9b61f38723c00,0xb9a8000039a83c00,0xb9a8bc00b9a80000,0xbbd9bb64b8728000,0x323eb61fbaa7bc00,0xb61fb9a8bb64bc00,0x3b6439a8361f0000,0x3872361f323e0000,0x3aa73b643bd93c00
.quad 0x3c003c003c003c00,0,0x3bd93b643aa739a8,0xb23eb61fb872b9a8,0x3b6439a8361f8000,0xb61fb9a8bb64bc00,0x3aa7361fb23eb9a8,0xb872bb64bbd9b9a8,0x39a88000b9a8bc00,0xb9a8bc00b9a80000,0x3872b61fbbd9b9a8,0xbaa7bb64b23e39a8,0x361fb9a8bb648000,0xbb64b9a8361f3c00,0x323ebb64b87239a8,0xbbd9b61f3aa739a8
.quad 0x8000bc0080003c00,0xbc0000003c008000,0xb23ebb64387239a8,0xbbd9361f3aa7b9a8,0xb61fb9a83b648000,0xbb6439a8361fbc00,0xb872b61f3bd9b9a8,0xbaa73b64b23eb9a8,0xb9a8000039a8bc00,0xb9a83c00b9a88000,0xbaa7361f323eb9a8,0xb8723b64bbd939a8,0xbb6439a8b61f0000,0xb61f39a8bb643c00,0xbbd93b64baa739a8,0xb23e361fb87239a8
.quad 0xbc003c00bc003c00,0x800080008000,0xbbd93b64baa739a8,0x323eb61f3872b9a8,0xbb6439a8b61f0000,0x361fb9a83b64bc00,0xbaa7361f323eb9a8,0x3872bb643bd9b9a8,0xb9a8800039a8bc00,0x39a8bc0039a80000,0xb872b61f3bd9b9a8,0x3aa7bb64323e39a8,0xb61fb9a83b640000,0x3b64b9a8b61f3c00,0xb23ebb64387239a8,0x3bd9b61fbaa739a8
.quad 0xbc0080003c00,0x3c000000bc000000,0x323ebb64b87239a8,0x3bd9361fbaa7b9a8,0x361fb9a8bb648000,0x3b6439a8b61fbc00,0x3872b61fbbd9b9a8,0x3aa73b64323eb9a8,0x39a80000b9a8bc00,0x39a83c0039a80000,0x3aa7361fb23eb9a8,0x38723b643bd939a8,0x3b6439a8361f8000,0x361f39a83b643c00,0x3bd93b643aa739a8,0x323e361f387239a8
.quad 0xf7000000f2c0,0xf92e0000f70e,0xf4e00000f2d0,0xf4ee0000f2de,0xf4f00000f2e0,0xf4fe0000f2ee,0xf5000000f2f0,0xf50e0000f2fe,0xf5100000f300,0xf51e0000f30e,0xf5200000f310,0xf52e0000f31e,0xf5300000f320,0xf53e0000f32e,0xf5400000f330,0xf54e0000f33e
.quad 0xf5500000f340,0xf55e0000f34e,0xf5600000f350,0xf56e0000f35e,0xf5700000f360,0xf57e0000f36e,0xf5800000f370,0xf58e0000f37e,0xf5900000f380,0xf59e0000f38e,0xf5a00000f390,0xf5ae0000f39e,0xf5b00000f3a0,0xf5be0000f3ae,0xf5c00000f3b0,0xf5ce0000f3be
.quad 0xf4d00000f910,0xf4de0000f6e0,0xf7f00000fa00,0xf91e0000f7fe,0xf7e00000f9f0,0xfa0e0000f7ee,0xf7d00000f9e0,0xf9fe0000f7de,0xf7c00000f9d0,0xf9ee0000f7ce,0xf7b00000f9c0,0xf9de0000f7be,0xf7a00000f9b0,0xf9ce0000f7ae,0xf7900000f9a0,0xf9be0000f79e
.quad 0xf7800000f990,0xf9ae0000f78e,0xf7700000f980,0xf99e0000f77e,0xf7600000f970,0xf98e0000f76e,0xf7500000f960,0xf97e0000f75e,0xf7400000f950,0xf96e0000f74e,0xf7300000f940,0xf95e0000f73e,0xf7200000f930,0xf94e0000f72e,0xf7100000f920,0xf93e0000f71e
.quad 0xf8000000f3c0,0xf80e0000f3ce,0xf5e00000f3d0,0xf5ee0000f3de,0xf5f00000f3e0,0xf5fe0000f3ee,0xf6000000f3f0,0xf60e0000f3fe,0xf6100000f400,0xf61e0000f40e,0xf6200000f410,0xf62e0000f41e,0xf6300000f420,0xf63e0000f42e,0xf6400000f430,0xf64e0000f43e
.quad 0xf6500000f440,0xf65e0000f44e,0xf6600000f450,0xf66e0000f45e,0xf6700000f460,0xf67e0000f46e,0xf6800000f470,0xf68e0000f47e,0xf6900000f480,0xf69e0000f48e,0xf6a00000f490,0xf6ae0000f49e,0xf6b00000f4a0,0xf6be0000f4ae,0xf6c00000f4b0,0xf6ce0000f4be
.quad 0xf5d00000fa10,0xf5de0000fa1e,0xf8f00000fb00,0xf8fe0000fb0e,0xf8e00000faf0,0xf8ee0000fafe,0xf8d00000fae0,0xf8de0000faee,0xf8c00000fad0,0xf8ce0000fade,0xf8b00000fac0,0xf8be0000face,0xf8a00000fab0,0xf8ae0000fabe,0xf8900000faa0,0xf89e0000faae
.quad 0xf8800000fa90,0xf88e0000fa9e,0xf8700000fa80,0xf87e0000fa8e,0xf8600000fa70,0xf86e0000fa7e,0xf8500000fa60,0xf85e0000fa6e,0xf8400000fa50,0xf84e0000fa5e,0xf8300000fa40,0xf83e0000fa4e,0xf8200000fa30,0xf82e0000fa3e,0xf8100000fa20,0xf81e0000fa2e
.quad 0xc00000000000,0,0xc01000000010,0x8000000010,0xc02000000020,0x1000000020,0xc03000000030,0x9000000030,0xc04000000040,0x800000040,0xc05000000050,0x8800000050,0xc06000000060,0x1800000060,0xc07000000070,0x9800000070
.quad 0xc08000000080,0x14000000080,0xc09000000090,0x1c000000090,0xc0a0000000a0,0x150000000a0,0xc0b0000000b0,0x1d0000000b0,0xc0c0000000c0,0x148000000c0,0xc0d0000000d0,0x1c8000000d0,0xc0e0000000e0,0x158000000e0,0xc0f0000000f0,0x1d8000000f0
.quad 0x800000004000,0x2000000140,0x801000004010,0xa000000150,0x802000004020,0x3000000160,0x803000004030,0xb000000170,0x804000004040,0x2800000100,0x805000004050,0xa800000110,0x806000004060,0x3800000120,0x807000004070,0xb800000130
.quad 0x808000004080,0x160000001c0,0x809000004090,0x1e0000001d0,0x80a0000040a0,0x170000001e0,0x80b0000040b0,0x1f0000001f0,0x80c0000040c0,0x16800000180,0x80d0000040d0,0x1e800000190,0x80e0000040e0,0x178000001a0,0x80f0000040f0,0x1f8000001b0
.quad 0x400000008000,0x40000000200,0x401000008010,0x48000000210,0x402000008020,0x41000000220,0x403000008030,0x49000000230,0x404000008040,0x40800000240,0x405000008050,0x48800000250,0x406000008060,0x41800000260,0x407000008070,0x49800000270
.quad 0x408000008080,0x54000000280,0x409000008090,0x5c000000290,0x40a0000080a0,0x550000002a0,0x40b0000080b0,0x5d0000002b0,0x40c0000080c0,0x548000002c0,0x40d0000080d0,0x5c8000002d0,0x40e0000080e0,0x558000002e0,0x40f0000080f0,0x5d8000002f0
.quad 0xc000,0x42000000340,0x100000c010,0x4a000000350,0x200000c020,0x43000000360,0x300000c030,0x4b000000370,0x400000c040,0x42800000300,0x500000c050,0x4a800000310,0x600000c060,0x43800000320,0x700000c070,0x4b800000330
.quad 0x800000c080,0x560000003c0,0x900000c090,0x5e0000003d0,0xa00000c0a0,0x570000003e0,0xb00000c0b0,0x5f0000003f0,0xc00000c0c0,0x56800000380,0xd00000c0d0,0x5e800000390,0xe00000c0e0,0x578000003a0,0xf00000c0f0,0x5f8000003b0
.quad 0,0x8000000000,0x9000000000,0x11000000010,0x12000000000,0x1a000000020,0x1b000000000,0x23000000030,0x24000000000,0x2c000000040,0x2d000000000,0x35000000050,0x36000000000,0x3e000000060,0x3f000000000,0x47000000070
.quad 0x48000000000,0x50000000090,0x51000000000,0x590000000a0,0x5a000000000,0x620000000b0,0x63000000000,0x6b0000000c0,0x6c000000000,0x740000000d0,0x75000000000,0x7d0000000e0,0x7e000000000,0x860000000f0,0x87000000000,0x8f000000100
.quad 0x90000000000,0x98000000120,0x99000000000,0xa1000000130,0xa2000000000,0xaa000000140,0xab000000000,0xb3000000150,0xb4000000000,0xbc000000160,0xbd000000000,0xc5000000170,0xc6000000000,0xce000000180,0xcf000000000,0xd7000000190
.quad 0xd8000000000,0xe00000001b0,0xe1000000000,0xe90000001c0,0xea000000000,0xf20000001d0,0xf3000000000,0xfb0000001e0,0xfc000000000,0x1040000001f0,0x105000000000,0x10d000000200,0x10e000000000,0x116000000210,0x117000000000,0x11f000000220
.quad 0x4000000010,0x8000000240,0xd000000010,0x11000000250,0x16000000010,0x1a000000260,0x1f000000010,0x23000000270,0x28000000010,0x2c000000280,0x31000000010,0x35000000290,0x3a000000010,0x3e0000002a0,0x43000000010,0x470000002b0
.quad 0x4c000000010,0x500000002d0,0x55000000010,0x590000002e0,0x5e000000010,0x620000002f0,0x67000000010,0x6b000000300,0x70000000010,0x74000000310,0x79000000010,0x7d000000320,0x82000000010,0x86000000330,0x8b000000010,0x8f000000340
.quad 0x94000000010,0x98000000360,0x9d000000010,0xa1000000370,0xa6000000010,0xaa000000380,0xaf000000010,0xb3000000390,0xb8000000010,0xbc0000003a0,0xc1000000010,0xc50000003b0,0xca000000010,0xce0000003c0,0xd3000000010,0xd70000003d0
.quad 0xdc000000010,0xe00000003f0,0xe5000000010,0xe9000000400,0xee000000010,0xf2000000410,0xf7000000010,0xfb000000420,0x100000000010,0x104000000430,0x109000000010,0x10d000000440,0x112000000010,0x116000000450,0x11b000000010,0x11f000000460
.quad 0x7000000000,0x800000000000,0x7000000000,0xfe0000000200,0x7000000000,0xfc0000000400,0x7000000000,0xfa0000000600,0x7000000000,0xf80000000800,0x7000000000,0xf60000000a00,0x7000000000,0xf40000000c00,0x7000000000,0xf20000000e00
.quad 0x6000000010,0xf00000001000,0x6000000010,0xee0000001200,0x6000000010,0xec0000001400,0x6000000010,0xea0000001600,0x6000000010,0xe80000001800,0x6000000010,0xe60000001a00,0x6000000010,0xe40000001c00,0x6000000010,0xe20000001e00
.quad 0x5000000020,0xe00000002000,0x5000000020,0xde0000002200,0x5000000020,0xdc0000002400,0x5000000020,0xda0000002600,0x5000000020,0xd80000002800,0x5000000020,0xd60000002a00,0x5000000020,0xd40000002c00,0x5000000020,0xd20000002e00
.quad 0x4000000030,0xd00000003000,0x4000000030,0xce0000003200,0x4000000030,0xcc0000003400,0x4000000030,0xca0000003600,0x4000000030,0xc80000003800,0x4000000030,0xc60000003a00,0x4000000030,0xc40000003c00,0x4000000030,0xc20000003e00
.quad 0x3000000040,0xc00000004000,0x3000000040,0xbe0000004200,0x3000000040,0xbc0000004400,0x3000000040,0xba0000004600,0x3000000040,0xb80000004800,0x3000000040,0xb60000004a00,0x3000000040,0xb40000004c00,0x3000000040,0xb20000004e00
.quad 0x2000000050,0xb00000005000,0x2000000050,0xae0000005200,0x2000000050,0xac0000005400,0x2000000050,0xaa0000005600,0x2000000050,0xa80000005800,0x2000000050,0xa60000005a00,0x2000000050,0xa40000005c00,0x2000000050,0xa20000005e00
.quad 0x1000000060,0xa00000006000,0x1000000060,0x9e0000006200,0x1000000060,0x9c0000006400,0x1000000060,0x9a0000006600,0x1000000060,0x980000006800,0x1000000060,0x960000006a00,0x1000000060,0x940000006c00,0x1000000060,0x920000006e00
.quad 0x70,0x900000007000,0x70,0x8e0000007200,0x70,0x8c0000007400,0x70,0x8a0000007600,0x70,0x880000007800,0x70,0x860000007a00,0x70,0x840000007c00,0x70,0x820000007e00
.quad 0xf2c0,0,0x100000f4d0,0x10,0x100000f2c0,0x20,0x200000f4d0,0x30,0xf700,0x40,0x100000f910,0x50,0x100000f700,0x60,0x200000f910,0x70
.quad 0xfb40,0x80,0x100000fd50,0x90,0x100000fb40,0xa0,0x200000fd50,0xc2000000000000b0,0xff80,0xc0,0x1000010190,0xd0,0x100000ff80,0xe0,0x2000010190,0xf0
.quad 0x114c0,0x1000,0x10000116d0,0x1010,0x10000114c0,0x1020,0x20000116d0,0x1030,0x11900,0x1040,0x1000011b10,0x1050,0x1000011900,0x1060,0x2000011b10,0x1070
.quad 0x11d40,0x1080,0x1000011f50,0x1090,0x1000011d40,0x10a0,0x2000011f50,0x10b0,0x12180,0x10c0,0x1000012390,0x10d0,0x1000012180,0x10e0,0x2000012390,0x10f0
.quad 0xf2c0,0x2000,0x100000f4d0,0x2010,0x100000f2c0,0x2020,0x200000f4d0,0x2030,0xf700,0x2040,0x100000f910,0x2050,0x100000f700,0x2060,0x200000f910,0x2070
.quad 0xfb40,0x2080,0x100000fd50,0x2090,0x100000fb40,0x20a0,0x200000fd50,0xc2000000000020b0,0xff80,0x20c0,0x1000010190,0x20d0,0x100000ff80,0x20e0,0x2000010190,0x20f0
.quad 0xf2c0,0x3000,0x100000f4d0,0x3010,0x100000f2c0,0x3020,0x200000f4d0,0x3030,0xf700,0x3040,0x100000f910,0x3050,0x100000f700,0x3060,0x200000f910,0x3070
.quad 0xfb40,0x3080,0x100000fd50,0x3090,0x100000fb40,0x30a0,0x200000fd50,0x30b0,0xff80,0x30c0,0x1000010190,0x30d0,0x100000ff80,0x30e0,0x2000010190,0x30f0
.quad 0xf72e0000f2ee,0,0xf74e0000f30e,0x8,0xf76e0000f32e,0x10,0xf78e0000f34e,0x18,0xf7ae0000f36e,0x20,0xf7ce0000f38e,0x28,0xf7ee0000f3ae,0x30,0xf6e00000f6e0,0x38
.quad 0xf72e0000f2ee,0x40,0xf74e0000f30e,0x48,0xf76e0000f32e,0x50,0xf78e0000f34e,0x58,0xf7ae0000f36e,0x60,0xf7ce0000f38e,0x68,0xf7ee0000f3ae,0x70,0xf6e00000f6e0,0x78
.quad 0x1192e000114ee,0x80,0x1194e0001150e,0x88,0x1196e0001152e,0x90,0x1198e0001154e,0x98,0x119ae0001156e,0xa0,0x119ce0001158e,0xa8,0x119ee000115ae,0xb0,0x118e0000118e0,0xb8
.quad 0x1192e000114ee,0xc0,0x1194e0001150e,0xc8,0x1196e0001152e,0xd0,0x1198e0001154e,0xd8,0x119ae0001156e,0xe0,0x119ce0001158e,0xe8,0x119ee000115ae,0xf0,0x118e0000118e0,0xf8
.quad 0xf72e0000f2ee,0x100,0xf74e0000f30e,0x108,0xf76e0000f32e,0x110,0xf78e0000f34e,0x118,0xf7ae0000f36e,0x120,0xf7ce0000f38e,0x128,0xf7ee0000f3ae,0x130,0xf6e00000f6e0,0x138
.quad 0xf72e0000f2ee,0x140,0xf74e0000f30e,0x148,0xf76e0000f32e,0x150,0xf78e0000f34e,0x158,0xf7ae0000f36e,0x160,0xf7ce0000f38e,0x168,0xf7ee0000f3ae,0x170,0xf6e00000f6e0,0x178
.quad 0xf72e0000f2ee,0x180,0xf74e0000f30e,0x188,0xf76e0000f32e,0x190,0xf78e0000f34e,0x198,0xf7ae0000f36e,0x1a0,0xf7ce0000f38e,0x1a8,0xf7ee0000f3ae,0x1b0,0xf6e00000f6e0,0x1b8
.quad 0xf72e0000f2ee,0x1c0,0xf74e0000f30e,0x1c8,0xf76e0000f32e,0x1d0,0xf78e0000f34e,0x1d8,0xf7ae0000f36e,0x1e0,0xf7ce0000f38e,0x1e8,0xf7ee0000f3ae,0x1f0,0xf6e00000f6e0,0x1f8
.quad 0xf2c0,0,0x100000f4d0,0x10,0x100000f2c0,0x20,0x200000f4d0,0x30,0xf700,0x40,0x100000f910,0x50,0x100000f700,0x60,0x200000f910,0x70
.quad 0xfb40,0x80,0x100000fd50,0x90,0x100000fb40,0xa0,0x200000fd50,0xc2000000000000b0,0xff80,0xc0,0x1000010190,0xd0,0x100000ff80,0xe0,0x2000010190,0xf0
.quad 0x114c0,0x1000,0x10000116d0,0x1010,0x10000114c0,0x1020,0x20000116d0,0x1030,0x11900,0x1040,0x1000011b10,0x1050,0x1000011900,0x1060,0x2000011b10,0x1070
.quad 0x11d40,0x1080,0x1000011f50,0x1090,0x1000011d40,0x10a0,0x2000011f50,0x10b0,0x12180,0x10c0,0x1000012390,0x10d0,0x1000012180,0x10e0,0x2000012390,0x10f0
.quad 0xea40,0x2000,0x100000ec50,0x2010,0x100000ea40,0x2020,0x200000ec50,0x2030,0xee80,0x2040,0x100000f090,0x2050,0x100000ee80,0x2060,0x200000f090,0x2070
.quad 0xf2c0,0x2080,0x100000f4d0,0x2090,0x100000f2c0,0x20a0,0x200000f4d0,0xc2000000000020b0,0xf700,0x20c0,0x100000f910,0x20d0,0x100000f700,0x20e0,0x200000f910,0x20f0
.quad 0xf2c0,0x3000,0x100000f4d0,0x3010,0x100000f2c0,0x3020,0x200000f4d0,0x3030,0xf700,0x3040,0x100000f910,0x3050,0x100000f700,0x3060,0x200000f910,0x3070
.quad 0xfb40,0x3080,0x100000fd50,0x3090,0x100000fb40,0x30a0,0x200000fd50,0x30b0,0xff80,0x30c0,0x1000010190,0x30d0,0x100000ff80,0x30e0,0x2000010190,0x30f0
.quad 0xf72e0000f2ee,0,0xf74e0000f30e,0x8,0xf76e0000f32e,0x10,0xf78e0000f34e,0x18,0xf7ae0000f36e,0x20,0xf7ce0000f38e,0x28,0xf7ee0000f3ae,0x30,0xf6e00000f6e0,0x38
.quad 0xf72e0000f2ee,0x40,0xf74e0000f30e,0x48,0xf76e0000f32e,0x50,0xf78e0000f34e,0x58,0xf7ae0000f36e,0x60,0xf7ce0000f38e,0x68,0xf7ee0000f3ae,0x70,0xf6e00000f6e0,0x78
.quad 0x1192e000114ee,0x80,0x1194e0001150e,0x88,0x1196e0001152e,0x90,0x1198e0001154e,0x98,0x119ae0001156e,0xa0,0x119ce0001158e,0xa8,0x119ee000115ae,0xb0,0x118e0000118e0,0xb8
.quad 0x1192e000114ee,0xc0,0x1194e0001150e,0xc8,0x1196e0001152e,0xd0,0x1198e0001154e,0xd8,0x119ae0001156e,0xe0,0x119ce0001158e,0xe8,0x119ee000115ae,0xf0,0x118e0000118e0,0xf8
.quad 0xeeae0000ea6e,0x100,0xeece0000ea8e,0x108,0xeeee0000eaae,0x110,0xef0e0000eace,0x118,0xef2e0000eaee,0x120,0xef4e0000eb0e,0x128,0xef6e0000eb2e,0x130,0xee600000ee60,0x138
.quad 0xeeae0000ea6e,0x140,0xeece0000ea8e,0x148,0xeeee0000eaae,0x150,0xef0e0000eace,0x158,0xef2e0000eaee,0x160,0xef4e0000eb0e,0x168,0xef6e0000eb2e,0x170,0xee600000ee60,0x178
.quad 0xf72e0000f2ee,0x180,0xf74e0000f30e,0x188,0xf76e0000f32e,0x190,0xf78e0000f34e,0x198,0xf7ae0000f36e,0x1a0,0xf7ce0000f38e,0x1a8,0xf7ee0000f3ae,0x1b0,0xf6e00000f6e0,0x1b8
.quad 0xf72e0000f2ee,0x1c0,0xf74e0000f30e,0x1c8,0xf76e0000f32e,0x1d0,0xf78e0000f34e,0x1d8,0xf7ae0000f36e,0x1e0,0xf7ce0000f38e,0x1e8,0xf7ee0000f3ae,0x1f0,0xf6e00000f6e0,0x1f8
.quad 0x8000280028002800,0x8000280080002800,0x964827fea8002800,0x9cb227ea9a4627f6,0x9a4627f628002800,0xa0a527a89e3e27d9,0x9cb227eaa8002800,0xa2d7273ba0a527a8,0x9e3e27d928002800,0xa47226a7a21f2764,0x9fc627c3a8002800,0xa55f25eda38b270e,0xa0a527a828002800,0xa62f2513a47226a7,0xa1642788a8002800,0xa6dd241da513262f
.quad 0xa21f276428002800,0xa764221fa5a825a8,0xa2d7273ba8002800,0xa7c31fc6a62f2513,0xa38b270e28002800,0xa7f61a46a6a72472,0xa41d26dda8002800,0xa7fe9648a70e238b,0xa47226a728002800,0xa7d99e3ea764221f,0xa4c4266da8002800,0xa788a164a7a820a5,0xa513262f28002800,0xa70ea38ba7d91e3e,0xa55f25eda8002800,0xa66da4c4a7f61a46
.quad 0xa5a825a828002800,0xa5a8a5a8a8000000,0xa5ed255fa8002800,0xa4c4a66da7f69a46,0xa62f251328002800,0xa38ba70ea7d99e3e,0xa66d24c4a8002800,0xa164a788a7a8a0a5,0xa6a7247228002800,0x9e3ea7d9a764a21f,0xa6dd241da8002800,0x9648a7fea70ea38b,0xa70e238b28002800,0x1a46a7f6a6a7a472,0xa73b22d7a8002800,0x1fc6a7c3a62fa513
.quad 0xa764221f28002800,0x221fa764a5a8a5a8,0xa7882164a8002800,0x241da6dda513a62f,0xa7a820a528002800,0x2513a62fa472a6a7,0xa7c31fc6a8002800,0x25eda55fa38ba70e,0xa7d91e3e28002800,0x26a7a472a21fa764,0xa7ea1cb2a8002800,0x273ba2d7a0a5a7a8,0xa7f61a4628002800,0x27a8a0a59e3ea7d9,0xa7fe1648a8002800,0x27ea9cb29a46a7f6
.quad 0x8000280080002800,0x8000280080002800,0x9fc627c39e3e27d9,0xa1642788a0a527a8,0xa38b270ea21f2764,0xa513262fa47226a7,0xa55f25eda47226a7,0xa6dd241da62f2513,0xa6a72472a5a825a8,0xa7d91e3ea764221f,0xa7882164a6a72472,0xa7ea9cb2a7f61a46,0xa7f61a46a764221f,0xa70ea38ba7d99e3e,0xa7ea9cb2a7d91e3e,0xa55fa5eda70ea38b
.quad 0xa764a21fa8000000,0xa21fa764a5a8a5a8,0xa66da4c4a7d99e3e,0x9648a7fea38ba70e,0xa513a62fa764a21f,0x20a5a7a89e3ea7d9,0xa2d7a73ba6a7a472,0x24c4a66d1a46a7f6,0x9e3ea7d9a5a8a5a8,0x26a7a472221fa764,0x1648a7fea472a6a7,0x27c39fc62513a62f,0x20a5a7a8a21fa764,0x27f61a4626a7a472,0x241da6dd9e3ea7d9,0x273b22d727a8a0a5
.quad 0x25a8a5a88000a800,0x25a825a828008000,0x26dda41d1e3ea7d9,0x22d7273b27a820a5,0x27a8a0a5221fa764,0x1a4627f626a72472,0x27fe96482472a6a7,0x9fc627c32513262f,0x27d91e3e25a8a5a8,0xa47226a7221f2764,0x273b22d726a7a472,0xa66d24c41a4627f6,0x262f25132764a21f,0xa7a820a59e3e27d9,0x24c4266d27d99e3e,0xa7fe9648a38b270e
.quad 0x221f276428008000,0xa764a21fa5a825a8,0x1cb227ea27d91e3e,0xa5eda55fa70e238b,0x9a4627f62764221f,0xa38ba70ea7d91e3e,0xa164278826a72472,0x9cb2a7eaa7f69a46,0xa47226a725a825a8,0x1e3ea7d9a764a21f,0xa5ed255f247226a7,0x241da6dda62fa513,0xa70e238b221f2764,0x262fa513a472a6a7,0xa7c31fc61e3e27d9,0x2788a164a0a5a7a8
.quad 0x8000280080002800,0x8000280080002800,0xa2d7273ba21f2764,0xa41d26dda38b270e,0xa62f2513a5a825a8,0xa70e238ba6a72472,0xa7c31fc6a764221f,0xa7fe9648a7f61a46,0xa7d99e3ea8000000,0xa6a7a472a764a21f,0xa66da4c4a764a21f,0xa2d7a73ba513a62f,0xa38ba70ea5a8a5a8,0x1a46a7f69e3ea7d9,0x9648a7fea21fa764,0x24c4a66d20a5a7a8
.quad 0x221fa7648000a800,0x2764a21f25a8a5a8,0x25eda55f221fa764,0x27ea1cb227a8a0a5,0x27a8a0a525a8a5a8,0x262f251327d91e3e,0x27ea1cb22764a21f,0x21642788262f2513,0x26a7247228008000,0x9e3e27d9221f2764,0x241d26dd2764221f,0xa55f25ed9a4627f6,0x1a4627f625a825a8,0xa7a820a5a47226a7,0xa1642788221f2764,0xa7c39fc6a70e238b
.quad 0xa5a825a800002800,0xa5a8a5a8a8000000,0xa7882164a21f2764,0x9fc6a7c3a70ea38b,0xa7f69a46a5a825a8,0x20a5a7a8a472a6a7,0xa6dda41da764221f,0x25eda55f9a46a7f6,0xa472a6a7a8000000,0x27d99e3e221fa764,0x9cb2a7eaa764a21f,0x27882164262fa513,0x20a5a7a8a5a8a5a8,0x2513262f27d99e3e,0x255fa5eda21fa764,0x1cb227ea27a820a5
.quad 0x2764a21f8000a800,0xa21f276425a825a8,0x27fe1648221fa764,0xa66d24c420a527a8,0x270e238b25a8a5a8,0xa7f61a469e3e27d9,0x24c4266d2764a21f,0xa73ba2d7a513262f,0x1e3e27d928008000,0xa472a6a7a764221f,0x9fc627c32764221f,0x9648a7fea7f69a46,0xa513262f25a825a8,0x238ba70ea6a7a472,0xa73b22d7221f2764,0x26dda41da38ba70e
.quad 0x8000280080002800,0x8000280080002800,0xa4c4266da47226a7,0xa55f25eda513262f,0xa7a820a5a764221f,0xa7f61a46a7d91e3e,0xa788a164a7d99e3e,0xa66da4c4a70ea38b,0xa472a6a7a5a8a5a8,0x9e3ea7d9a21fa764,0x1648a7fe9e3ea7d9,0x241da6dd20a5a7a8,0x2513a62f221fa764,0x27a8a0a526a7a472,0x27c39fc626a7a472,0x273b22d727f61a46
.quad 0x2764221f28008000,0x221f276425a825a8,0x241d26dd26a72472,0xa16427881a4627f6,0x9a4627f6221f2764,0xa70e238ba47226a7,0xa55f25ed9e3e27d9,0xa7c39fc6a7a820a5,0xa7d91e3ea5a825a8,0xa472a6a7a764a21f,0xa73ba2d7a7d91e3e,0x1cb2a7eaa38ba70e,0xa38ba70ea764a21f,0x262fa5131e3ea7d9,0x1cb2a7eaa472a6a7,0x27fe1648262fa513
.quad 0x25a8a5a88000a800,0x25a825a828008000,0x27ea9cb22472a6a7,0x164827fe262f2513,0x270e238b2764a21f,0xa513262f1e3e27d9,0x22d7273b27d91e3e,0xa7ea1cb2a38b270e,0x9e3e27d925a825a8,0xa6a7a472a764221f,0xa5ed255f1e3e27d9,0x9fc6a7c3a7a8a0a5,0xa7f61a46a21f2764,0x238ba70ea472a6a7,0xa6dda41da6a72472,0x2788a1641a46a7f6
.quad 0xa21fa764a8000000,0x2764221f25a8a5a8,0x1fc6a7c3a6a7a472,0x22d7273b27f69a46,0x262fa513a21fa764,0xa0a527a826a72472,0x27fe96481e3ea7d9,0xa6dd241d20a527a8,0x26a7247225a8a5a8,0xa7d99e3ea21f2764,0x2164278827d99e3e,0xa4c4a66da70e238b,0xa0a527a82764221f,0x1a46a7f6a7d99e3e,0xa66d24c4247226a7,0x25eda55fa513a62f
.quad 0x8000280080002800,0x8000280080002800,0xa5ed255fa5a825a8,0xa66d24c4a62f2513,0xa7f69a46a8000000,0xa7a8a0a5a7d99e3e,0xa4c4a66da5a8a5a8,0xa164a788a38ba70e,0x1e3ea7d98000a800,0x2472a6a7221fa764,0x26dda41d25a8a5a8,0x27fe964827a8a0a5,0x27a820a528008000,0x2513262f26a72472,0x22d7273b25a825a8,0x9fc627c31a4627f6
.quad 0xa21f276400002800,0xa764221fa5a825a8,0xa7882164a5a825a8,0xa6dda41da7f69a46,0xa70ea38ba8000000,0x9a46a7f6a472a6a7,0x9fc6a7c3a5a8a5a8,0x25eda55f20a5a7a8,0x2472a6a78000a800,0x27d91e3e2764a21f,0x27ea9cb225a8a5a8,0x22d7273b270e238b,0x262f251328008000,0xa38b270e1e3e27d9,0x164827fe25a825a8,0xa7ea1cb2a513262f
.quad 0xa5a825a800002800,0xa5a8a5a8a8000000,0xa7fe9648a5a825a8,0x1cb2a7eaa513a62f,0xa513a62fa8000000,0x270ea38b1e3ea7d9,0x1cb2a7eaa5a8a5a8,0x273b22d7270ea38b,0x26a7a4728000a800,0x1e3e27d92764221f,0x27c31fc625a8a5a8,0xa55f25ed20a527a8,0x238b270e28008000,0xa7f69a46a47226a7,0xa164278825a825a8,0xa41da6dda7f61a46
.quad 0xa764221f00002800,0x221fa764a5a8a5a8,0xa73ba2d7a5a825a8,0x27c39fc61a46a7f6,0xa0a5a7a8a8008000,0x262f251326a7a472,0x241da6dda5a8a5a8,0x964827fe27a820a5,0x27d99e3e8000a800,0xa6a72472221f2764,0x266d24c425a8a5a8,0xa788a164a38b270e,0x1a4627f628008000,0xa0a5a7a8a7d91e3e,0xa55f25ed25a825a8,0x24c4a66da62fa513
.quad 0x8000280080002800,0x8000280080002800,0xa6dd241da6a72472,0xa73b22d7a70e238b,0xa70ea38ba764a21f,0xa62fa513a6a7a472,0x9648a7fe9e3ea7d9,0x1fc6a7c31a46a7f6,0x26a7a47225a8a5a8,0x27d99e3e2764a21f,0x273b22d727d91e3e,0x24c4266d262f2513,0x1a4627f6221f2764,0xa38b270e9e3e27d9,0xa66d24c4a47226a7,0xa7fe9648a7a820a5
.quad 0xa764a21fa8000000,0xa21fa764a5a8a5a8,0x9cb2a7eaa472a6a7,0x255fa5ed20a5a7a8,0x262fa513221fa764,0x27a820a527d99e3e,0x2788216427d99e3e,0x1cb227ea2513262f,0x1e3e27d925a825a8,0xa6a72472a21f2764,0xa5ed255f9e3e27d9,0xa6dda41da7f61a46,0xa7a8a0a5a764221f,0x1a46a7f6a472a6a7,0x9fc6a7c3a6a7a472,0x2788a164238ba70e
.quad 0x25a8a5a88000a800,0x25a825a828008000,0x27c31fc626a7a472,0xa1642788238b270e,0x20a527a82764221f,0xa7f61a46a47226a7,0xa55f25ed1e3e27d9,0xa41da6dda7f69a46,0xa7d99e3ea5a825a8,0x2472a6a7a21fa764,0xa164a788a7d99e3e,0x27ea1cb22513a62f,0x2513a62fa21fa764,0x20a527a827d91e3e,0x27ea1cb22472a6a7,0xa5ed255f20a527a8
.quad 0x221f276428008000,0xa764a21fa5a825a8,0xa4c4266d247226a7,0x9648a7fea7a8a0a5,0xa7f69a46a21f2764,0x270ea38b9e3ea7d9,0xa2d7a73ba7d91e3e,0x266d24c4262fa513,0x2472a6a7a5a8a5a8,0x9e3e27d92764221f,0x27fe16481e3ea7d9,0xa7c31fc61a4627f6,0x238b270e2764a21f,0xa513a62fa6a72472,0xa41d26dd26a72472,0x22d7a73ba70ea38b
.quad 0x8000280080002800,0x8000280080002800,0xa7882164a764221f,0xa7c31fc6a7a820a5,0xa513a62fa5a8a5a8,0xa38ba70ea472a6a7,0x241da6dd221fa764,0x25eda55f2513a62f,0x27d91e3e28008000,0x26a724722764221f,0x1cb227ea221f2764,0xa16427889a4627f6,0xa70e238ba5a825a8,0xa7f69a46a7d91e3e,0xa5eda55fa764a21f,0x9cb2a7eaa38ba70e
.quad 0x221fa7648000a800,0x2764a21f25a8a5a8,0x27fe16482764a21f,0x24c4266d270e238b,0x20a527a825a825a8,0xa513262f9e3e27d9,0xa66d24c4a21f2764,0xa73ba2d7a7f61a46,0xa6a7a472a8000000,0x1e3ea7d9a21fa764,0x1fc6a7c3a21fa764,0x27fe9648262fa513,0x27f69a4625a8a5a8,0x20a527a826a72472,0x22d7273b2764221f,0xa6dd241da0a527a8
.quad 0xa5a825a800002800,0xa5a8a5a8a8008000,0xa73ba2d7a764221f,0x241da6dda0a5a7a8,0x1a46a7f6a5a8a5a8,0x27a820a526a7a472,0x27c39fc6221fa764,0x964827fe262f2513,0x247226a728008000,0xa7d91e3ea21f2764,0xa4c4266d221f2764,0xa2d7a73ba7f69a46,0xa7a8a0a5a5a825a8,0x262fa5139e3ea7d9,0x9648a7fea764a21f,0x266d24c4270ea38b
.quad 0x2764a21f8000a800,0xa21f276425a825a8,0x255f25ed2764a21f,0xa7ea9cb2a38b270e,0xa38b270e25a825a8,0x9a46a7f6a7d99e3e,0xa7ea9cb2a21f2764,0x2788a1649a46a7f6,0x9e3ea7d9a8008000,0x247226a72764a21f,0x26dda41da21fa764,0xa55f25ed2513262f,0x262f251325a8a5a8,0xa70ea38ba47226a7,0xa16427882764221f,0x1fc6a7c3a7a8a0a5
.quad 0x8000280080002800,0x8000280080002800,0xa7ea1cb2a7d91e3e,0xa7fe1648a7f61a46,0xa0a5a7a8a21fa764,0x9a46a7f69e3ea7d9,0x273ba2d726a7a472,0x27ea9cb227a8a0a5,0x247226a725a825a8,0x1e3e27d9221f2764,0xa5ed255fa47226a7,0xa7c31fc6a70e238b,0xa62fa513a764a21f,0xa0a5a7a8a472a6a7,0x241da6dd1e3ea7d9,0x2788a164262fa513
.quad 0x2764221f28008000,0x221f276425a825a8,0x9fc627c31e3e27d9,0xa73b22d7a513262f,0xa7f69a46a764221f,0xa38ba70ea6a7a472,0x9648a7fea472a6a7,0x26dda41d238ba70e,0x27d99e3e25a8a5a8,0x247226a72764221f,0x2164278826a72472,0xa66d24c4a0a527a8,0xa70e238ba21f2764,0xa513a62fa7d99e3e,0xa4c4a66da7d99e3e,0x25eda55f1a46a7f6
.quad 0x25a8a5a88000a800,0x25a825a828008000,0x266d24c427d99e3e,0xa55f25ed1a4627f6,0xa38b270e221f2764,0xa62fa513a7d91e3e,0xa788a164a6a72472,0x24c4a66da0a5a7a8,0x1e3ea7d9a5a8a5a8,0x26a724722764a21f,0x27fe16482472a6a7,0xa41d26dd238b270e,0x1a4627f62764221f,0xa70ea38ba6a72472,0xa7c31fc69e3e27d9,0x22d7a73ba513a62f
.quad 0xa21fa764a8008000,0x2764221f25a8a5a8,0x26dda41d9e3ea7d9,0xa1642788262f2513,0x2513262f2764a21f,0xa7a8a0a5a47226a7,0xa55f25ed247226a7,0x1fc6a7c3a70ea38b,0xa6a7a472a5a825a8,0x27d91e3e221fa764,0x22d7a73ba6a7a472,0x9cb227ea27a820a5,0x27a820a5221fa764,0xa7f69a469e3e27d9,0x9cb227ea27d91e3e,0x1648a7fea7f69a46
.quad 0x8000280080002800,0x8000280080002800,0xa7fe9648a8000000,0xa7ea9cb2a7f69a46,0x1a46a7f68000a800,0x20a5a7a81e3ea7d9,0x27ea1cb228008000,0x273b22d727a820a5,0x9e3e27d900002800,0xa47226a7a21f2764,0xa7c39fc6a8000000,0xa5eda55fa70ea38b,0x20a5a7a88000a800,0x262fa5132472a6a7,0x2788216428008000,0x241d26dd262f2513
.quad 0xa21f276400002800,0xa764221fa5a825a8,0xa73ba2d7a8000000,0x9fc6a7c3a513a62f,0x238ba70e8000a800,0x27f69a4626a7a472,0x26dd241d28008000,0x964827fe238b270e,0xa47226a700002800,0xa7d99e3ea764221f,0xa66da4c4a8008000,0x2164a788a0a5a7a8,0x2513a62f8000a800,0x270e238b27d99e3e,0x25ed255f28008000,0xa4c4266d1a4627f6
.quad 0xa5a825a800002800,0xa5a8a5a8a8008000,0xa55fa5eda8008000,0x266da4c41a46a7f6,0x262fa5138000a800,0x238b270e27d91e3e,0x24c4266d28008000,0xa7882164a0a527a8,0xa6a7247200002800,0x9e3ea7d9a764a21f,0xa41da6dda8008000,0x27fe9648238ba70e,0x270ea38b8000a800,0x9a4627f626a72472,0x22d7273b28008000,0xa7c39fc6a513262f
.quad 0xa764221f00002800,0x221fa764a5a8a5a8,0xa164a788a8008000,0x26dd241d262fa513,0x27a8a0a50000a800,0xa513262f247226a7,0x1fc627c328008000,0xa55fa5eda70e238b,0xa7d91e3e00002800,0x26a7a472a21fa764,0x9cb2a7eaa8008000,0x22d7273b27a8a0a5,0x27f69a468000a800,0xa7a820a51e3e27d9,0x164827fe28008000,0x9cb2a7eaa7f61a46
.quad 0x8000280080002800,0x8000280080002800,0xa7c39fc6a7d99e3e,0xa788a164a7a8a0a5,0x238ba70e221fa764,0x2513a62f2472a6a7,0x25ed255f26a72472,0x241d26dd2513262f,0xa6a72472a5a825a8,0xa7d91e3ea764221f,0xa164a788a472a6a7,0x1cb2a7ea9a46a7f6,0x27f69a462764a21f,0x270e238b27d91e3e,0x9cb227ea1e3e27d9,0xa5ed255fa38b270e
.quad 0xa764a21fa8000000,0xa21fa764a5a8a5a8,0x24c4a66d1e3ea7d9,0x27fe9648270ea38b,0x2513262f2764221f,0xa0a527a81e3e27d9,0xa73b22d7a47226a7,0xa66da4c4a7f69a46,0x9e3ea7d9a5a8a5a8,0x26a7a472221fa764,0x27fe164826a7a472,0x1fc627c3262f2513,0xa0a527a8221f2764,0xa7f69a46a6a72472,0xa6dda41da7d91e3e,0x22d7a73ba0a5a7a8
.quad 0x25a8a5a88000a800,0x25a825a828008000,0x241d26dd27d91e3e,0xa73b22d7a0a527a8,0xa7a820a5a21f2764,0x9a46a7f6a6a7a472,0x9648a7fea6a7a472,0x27c31fc6262fa513,0x27d91e3e25a8a5a8,0xa47226a7221f2764,0xa2d7273b247226a7,0xa4c4a66da7f61a46,0xa62fa513a764221f,0x27a8a0a51e3ea7d9,0x266da4c49e3ea7d9,0x964827fe270e238b
.quad 0x221f276428008000,0xa764a21fa5a825a8,0xa7ea1cb29e3e27d9,0x255fa5eda38ba70e,0x1a46a7f6a764a21f,0x238b270e27d99e3e,0x278821642472a6a7,0xa7ea1cb29a4627f6,0xa47226a725a825a8,0x1e3ea7d9a764a21f,0xa55fa5eda6a72472,0x26dd241d2513a62f,0x270ea38ba21fa764,0xa62f2513247226a7,0x1fc627c327d99e3e,0xa164a788a7a820a5
.quad 0x8000280080002800,0x8000280080002800,0xa73ba2d7a764a21f,0xa6dda41da70ea38b,0x262fa51325a8a5a8,0x270ea38b26a7a472,0x1fc627c3221f2764,0x964827fe1a4627f6,0xa7d99e3ea8000000,0xa6a7a472a764a21f,0x24c4a66d221fa764,0x273ba2d7262fa513,0x238b270e25a825a8,0x9a4627f61e3e27d9,0xa7fe1648a764221f,0xa66da4c4a7a8a0a5
.quad 0x221fa7648000a800,0x2764a21f25a8a5a8,0x255f25ed2764221f,0x9cb227ea20a527a8,0xa7a820a5a5a825a8,0xa62fa513a7d99e3e,0x1cb2a7eaa21fa764,0x2788a1642513a62f,0x26a7247228008000,0x9e3e27d9221f2764,0xa6dd241da21f2764,0xa5eda55fa7f69a46,0x9a46a7f6a5a8a5a8,0x27a8a0a52472a6a7,0x278821642764a21f,0x9fc627c3238b270e
.quad 0xa5a825a800002800,0xa5a8a5a8a8008000,0xa164a788a764a21f,0x27c39fc6238ba70e,0x27f61a4625a8a5a8,0xa0a527a8247226a7,0xa41d26dd221f2764,0xa55fa5eda7f61a46,0xa472a6a7a8008000,0x27d99e3e221fa764,0x27ea9cb2221fa764,0xa16427882513262f,0xa0a527a825a825a8,0xa513a62fa7d91e3e,0xa5eda55fa764221f,0x27ea9cb220a5a7a8
.quad 0x2764a21f8000a800,0xa21f276425a825a8,0x964827fe2764221f,0xa4c4a66da7a820a5,0xa70ea38ba5a825a8,0x27f69a461e3ea7d9,0x266da4c4a21fa764,0xa2d7273b262f2513,0x1e3e27d928008000,0xa472a6a7a764221f,0xa7c39fc6a21f2764,0x27fe96481a46a7f6,0x2513a62fa5a8a5a8,0xa38b270e26a72472,0x22d7273b2764a21f,0xa41da6dda70e238b
.quad 0x8000280080002800,0x8000280080002800,0xa66da4c4a6a7a472,0xa5eda55fa62fa513,0x27a8a0a52764a21f,0x27f69a4627d99e3e,0xa16427889e3e27d9,0xa4c4266da38b270e,0xa472a6a7a5a8a5a8,0x9e3ea7d9a21fa764,0x27fe164827d99e3e,0x26dd241d27a820a5,0xa513262fa21f2764,0xa7a820a5a6a72472,0x9fc6a7c3a472a6a7,0x22d7a73b1a46a7f6
.quad 0x2764221f28008000,0x221f276425a825a8,0xa6dd241da47226a7,0xa788a164a7f61a46,0x1a46a7f6a21fa764,0x270ea38b2472a6a7,0x25ed255f27d91e3e,0x9fc627c320a527a8,0xa7d91e3ea5a825a8,0xa472a6a7a764a21f,0x22d7a73b9e3ea7d9,0x27ea1cb2270ea38b,0x238b270e2764221f,0xa62f25139e3e27d9,0xa7ea9cb2a6a72472,0x1648a7fea513a62f
.quad 0x25a8a5a88000a800,0x25a825a828008000,0x1cb227ea26a72472,0xa7fe1648a513262f,0xa70ea38ba764221f,0x2513a62f9e3ea7d9,0x273ba2d71e3ea7d9,0x1cb227ea270e238b,0x9e3e27d925a825a8,0xa6a7a472a764221f,0xa55fa5eda7d91e3e,0x27c39fc620a5a7a8,0x27f69a46221fa764,0xa38b270e247226a7,0xa41d26dd247226a7,0xa164a788a7f69a46
.quad 0xa21fa764a8000000,0x2764221f25a8a5a8,0x27c31fc62472a6a7,0xa73b22d71a4627f6,0xa62f2513221f2764,0x20a5a7a8a6a7a472,0x9648a7fea7d99e3e,0x241d26dd27a8a0a5,0x26a7247225a8a5a8,0xa7d99e3ea21f2764,0xa78821641e3e27d9,0x266da4c4a38ba70e,0x20a5a7a8a764a21f,0x9a4627f627d91e3e,0x24c4266d26a7a472,0xa55fa5eda62f2513
.quad 0x8000280080002800,0x8000280080002800,0xa55fa5eda5a8a5a8,0xa4c4a66da513a62f,0x27f61a4628008000,0x27a820a527d91e3e,0xa66d24c4a5a825a8,0xa7882164a70e238b,0x1e3ea7d98000a800,0x2472a6a7221fa764,0x241d26dd25a825a8,0x164827fe20a527a8,0xa7a8a0a5a8000000,0xa513a62fa6a7a472,0x273ba2d725a8a5a8,0x27c31fc627f69a46
.quad 0xa21f276400002800,0xa764221fa5a825a8,0xa164a788a5a8a5a8,0x241da6dd1a46a7f6,0x270e238b28008000,0x1a4627f6247226a7,0xa7c31fc6a5a825a8,0xa55fa5eda7a8a0a5,0x2472a6a78000a800,0x27d91e3e2764a21f,0x1cb227ea25a825a8,0xa73b22d7a38b270e,0xa62fa513a8008000,0x238ba70e9e3ea7d9,0x27fe964825a8a5a8,0x1cb227ea262f2513
.quad 0xa5a825a800002800,0xa5a8a5a8a8008000,0x1648a7fea5a8a5a8,0x27ea1cb2262fa513,0x2513262f28008000,0xa70e238b9e3e27d9,0xa7ea9cb2a5a825a8,0x22d7a73ba38ba70e,0x26a7a4728000a800,0x1e3e27d92764221f,0x9fc627c325a825a8,0xa5eda55fa7a820a5,0xa38ba70ea8000000,0x27f61a462472a6a7,0x2788216425a8a5a8,0xa6dd241d1a4627f6
.quad 0xa764221f00002800,0x221fa764a5a8a5a8,0x22d7a73ba5a8a5a8,0x1fc627c327f61a46,0x20a527a828000000,0xa62fa513a6a72472,0xa6dda41da5a825a8,0x27fe164820a5a7a8,0x27d99e3e0000a800,0xa6a72472221f2764,0xa4c4266d25a825a8,0x2164a788a70ea38b,0x9a46a7f6a8000000,0x20a527a827d99e3e,0x25ed255f25a8a5a8,0xa66da4c4a513262f
.quad 0x8000280080002800,0x8000280080002800,0xa41da6dda472a6a7,0xa2d7a73ba38ba70e,0x270e238b2764221f,0x262f251326a72472,0xa7fe1648a7d91e3e,0xa7c39fc6a7f69a46,0x26a7a47225a8a5a8,0x27d99e3e2764a21f,0xa2d7273b9e3e27d9,0xa66d24c4a513262f,0x9a46a7f6a21fa764,0x238ba70e1e3ea7d9,0x24c4266d26a72472,0x964827fe20a527a8
.quad 0xa764a21fa8008000,0xa21fa764a5a8a5a8,0x27ea9cb226a7a472,0x25ed255f27a820a5,0xa62f2513a21f2764,0xa7a8a0a5a7d91e3e,0x2164a7889e3ea7d9,0x27ea9cb2262fa513,0x1e3e27d925a825a8,0xa6a72472a21f2764,0xa55fa5eda7d99e3e,0x241da6dd9a46a7f6,0x27a820a52764a21f,0x9a4627f6247226a7,0xa7c31fc6a47226a7,0xa164a788a70ea38b
.quad 0x25a8a5a80000a800,0x25a825a828008000,0x9fc627c3247226a7,0xa788a164a70e238b,0xa0a5a7a8a764a21f,0x27f69a462472a6a7,0x25ed255f27d99e3e,0xa6dd241d9a4627f6,0xa7d99e3ea5a825a8,0x2472a6a7a21fa764,0x2788a1641e3ea7d9,0x9cb227ea262f2513,0xa513262f221f2764,0xa0a5a7a8a7d99e3e,0x1cb2a7eaa6a7a472,0x255f25ed27a8a0a5
.quad 0x221f276428008000,0xa764a21fa5a825a8,0xa66da4c4a6a72472,0x27fe964820a5a7a8,0x27f61a46221fa764,0xa70e238b1e3e27d9,0xa73b22d71e3e27d9,0x24c4a66da513a62f,0x2472a6a7a5a8a5a8,0x9e3e27d92764221f,0x964827fe27d91e3e,0x9fc6a7c3a7f61a46,0xa38ba70ea764221f,0x2513262f26a7a472,0x26dd241d2472a6a7,0xa73ba2d7a38b270e
.quad 0x8000280080002800,0x8000280080002800,0xa164a788a21fa764,0x9fc6a7c3a0a5a7a8,0x2513262f25a825a8,0x238b270e247226a7,0xa6dda41da764a21f,0xa55fa5eda62fa513,0x27d91e3e28008000,0x26a724722764221f,0xa7ea1cb2a764221f,0xa788a164a7f69a46,0x270ea38b25a8a5a8,0x27f61a4627d99e3e,0xa55f25eda21f2764,0xa7ea1cb2a70e238b
.quad 0x221fa7648000a800,0x2764a21f25a8a5a8,0x964827fe221f2764,0xa66d24c4a38b270e,0xa0a5a7a8a5a8a5a8,0x2513a62f1e3ea7d9,0x24c4266d2764221f,0xa2d7273b1a4627f6,0xa6a7a472a8008000,0x1e3ea7d9a21fa764,0x27c31fc62764a21f,0x164827fe2513262f,0xa7f61a46a5a825a8,0xa0a5a7a8a6a7a472,0x273ba2d7221fa764,0x241d26dd27a820a5
.quad 0xa5a825a800002800,0xa5a8a5a8a8008000,0x22d7a73ba21fa764,0x26dd241d27a8a0a5,0x9a4627f625a825a8,0xa7a8a0a5a6a72472,0x9fc6a7c3a764a21f,0x27fe16482513a62f,0x247226a728008000,0xa7d91e3ea21f2764,0xa66da4c4a764221f,0x273ba2d71a46a7f6,0x27a820a525a8a5a8,0xa62f25131e3e27d9,0xa7fe1648a21f2764,0x24c4a66da38ba70e
.quad 0x2764a21f0000a800,0xa21f276425a825a8,0xa5ed255f221f2764,0x1cb2a7eaa70ea38b,0x238ba70ea5a8a5a8,0x1a4627f627d91e3e,0x9cb227ea2764221f,0xa164a788a7f61a46,0x9e3ea7d9a8000000,0x247226a72764a21f,0x241d26dd2764a21f,0xa5eda55fa62f2513,0xa62fa513a5a825a8,0x270e238b2472a6a7,0x27882164221fa764,0xa7c39fc6a0a527a8
.quad 0x8000280080002800,0x8000280080002800,0x9cb2a7ea9e3ea7d9,0x9648a7fe9a46a7f6,0x20a527a8221f2764,0x1a4627f61e3e27d9,0xa2d7a73ba472a6a7,0x9cb2a7eaa0a5a7a8,0x247226a725a825a8,0x1e3e27d9221f2764,0xa55fa5eda6a7a472,0x9fc6a7c3a38ba70e,0x262f25132764221f,0x20a527a8247226a7,0xa6dda41da7d99e3e,0xa164a788a513a62f
.quad 0x2764221f28008000,0x221f276425a825a8,0xa7c39fc6a7d91e3e,0xa2d7a73ba62fa513,0x27f61a462764a21f,0x238b270e26a72472,0xa7fe1648a6a72472,0xa41da6dda70ea38b,0x27d99e3e25a8a5a8,0x247226a72764221f,0xa7882164a47226a7,0xa4c4a66da7a8a0a5,0x270ea38b221fa764,0x2513262f27d91e3e,0xa66d24c49e3e27d9,0xa55fa5eda7f69a46
.quad 0x25a8a5a88000a800,0x25a825a828008000,0xa4c4266d1e3e27d9,0xa5eda55fa7f61a46,0x238ba70ea21fa764,0x262f251327d99e3e,0xa1642788247226a7,0xa66da4c4a7a820a5,0x1e3ea7d9a5a8a5a8,0x26a724722764a21f,0x964827fe26a72472,0xa6dda41da70e238b,0x9a46a7f6a764a21f,0x270e238b26a7a472,0x1fc627c327d91e3e,0xa73ba2d7a62f2513
.quad 0xa21fa764a8000000,0x2764221f25a8a5a8,0x241d26dd27d99e3e,0xa788a164a513262f,0xa513a62fa764221f,0x27a820a52472a6a7,0x25ed255f26a7a472,0xa7c39fc6a38b270e,0xa6a7a472a5a825a8,0x27d91e3e221fa764,0x273b22d72472a6a7,0xa7ea9cb2a0a527a8,0xa7a8a0a5a21f2764,0x27f61a461e3ea7d9,0x27ea1cb21e3ea7d9,0xa7fe96489a4627f6
.quad 0xa800000028002800,0x280080008000a800,0xa7fe9648a8002800,0x27ea1cb21a46a7f6,0xa7f69a4628002800,0x27a820a51e3ea7d9,0xa7ea9cb2a8002800,0x273b22d720a5a7a8,0xa7d99e3e28002800,0x26a72472221fa764,0xa7c39fc6a8002800,0x25ed255f238ba70e,0xa7a8a0a528002800,0x2513262f2472a6a7,0xa788a164a8002800,0x241d26dd2513a62f
.quad 0xa764a21f28002800,0x221f276425a8a5a8,0xa73ba2d7a8002800,0x1fc627c3262fa513,0xa70ea38b28002800,0x1a4627f626a7a472,0xa6dda41da8002800,0x964827fe270ea38b,0xa6a7a47228002800,0x9e3e27d92764a21f,0xa66da4c4a8002800,0xa164278827a8a0a5,0xa62fa51328002800,0xa38b270e27d99e3e,0xa5eda55fa8002800,0xa4c4266d27f69a46
.quad 0xa5a8a5a828002800,0xa5a825a828008000,0xa55fa5eda8002800,0xa66d24c427f61a46,0xa513a62f28002800,0xa70e238b27d91e3e,0xa4c4a66da8002800,0xa788216427a820a5,0xa472a6a728002800,0xa7d91e3e2764221f,0xa41da6dda8002800,0xa7fe1648270e238b,0xa38ba70e28002800,0xa7f69a4626a72472,0xa2d7a73ba8002800,0xa7c39fc6262f2513
.quad 0xa21fa76428002800,0xa764a21f25a825a8,0xa164a788a8002800,0xa6dda41d2513262f,0xa0a5a7a828002800,0xa62fa513247226a7,0x9fc6a7c3a8002800,0xa55fa5ed238b270e,0x9e3ea7d928002800,0xa472a6a7221f2764,0x9cb2a7eaa8002800,0xa2d7a73b20a527a8,0x9a46a7f628002800,0xa0a5a7a81e3e27d9,0x9648a7fea8002800,0x9cb2a7ea1a4627f6
.quad 0xa800000000002800,0x280080008000a800,0xa7c39fc69e3e27d9,0x2788216420a5a7a8,0xa70ea38ba21f2764,0x262f25132472a6a7,0xa5eda55fa47226a7,0x241d26dd262fa513,0xa472a6a7a5a825a8,0x1e3e27d92764a21f,0xa164a788a6a72472,0x9cb227ea27f69a46,0x9a46a7f6a764221f,0xa38b270e27d91e3e,0x1cb2a7eaa7d91e3e,0xa5ed255f270e238b
.quad 0x221fa764a8000000,0xa764221f25a825a8,0x24c4a66da7d99e3e,0xa7fe1648238b270e,0x262fa513a764a21f,0xa7a8a0a51e3e27d9,0x273ba2d7a6a7a472,0xa66da4c49a4627f6,0x27d99e3ea5a8a5a8,0xa472a6a7a21f2764,0x27fe1648a472a6a7,0x9fc6a7c3a513262f,0x27a820a5a21fa764,0x1a46a7f6a6a72472,0x26dd241d9e3ea7d9,0x22d7a73ba7a820a5
.quad 0x25a825a88000a800,0x25a8a5a8a8000000,0x241d26dd1e3ea7d9,0x273ba2d7a7a8a0a5,0x20a527a8221fa764,0x27f69a46a6a7a472,0x164827fe2472a6a7,0x27c31fc6a513a62f,0x9e3e27d925a8a5a8,0x26a72472a21fa764,0xa2d7273b26a7a472,0x24c4266d9a46a7f6,0xa513262f2764a21f,0x20a527a81e3ea7d9,0xa66d24c427d99e3e,0x964827fe238ba70e
.quad 0xa764221f28008000,0xa21f276425a8a5a8,0xa7ea1cb227d91e3e,0xa55f25ed270ea38b,0xa7f69a462764221f,0xa70e238b27d99e3e,0xa788a16426a72472,0xa7ea1cb227f61a46,0xa6a7a47225a825a8,0xa7d99e3e2764221f,0xa55fa5ed247226a7,0xa6dda41d262f2513,0xa38ba70e221f2764,0xa513a62f247226a7,0x9fc6a7c31e3e27d9,0xa164a78820a527a8
.quad 0xa800000000002800,0x280080008000a800,0xa73ba2d7a21f2764,0x26dd241d238ba70e,0xa513a62fa5a825a8,0x238b270e26a7a472,0x9fc6a7c3a764221f,0x964827fe27f69a46,0x1e3ea7d9a8000000,0xa47226a72764221f,0x24c4a66da764a21f,0xa73b22d72513262f,0x270ea38ba5a8a5a8,0xa7f69a461e3e27d9,0x27fe9648a21fa764,0xa66da4c4a0a527a8
.quad 0x2764221f8000a800,0xa21fa764a5a825a8,0x255f25ed221fa764,0x1cb2a7eaa7a820a5,0x20a527a825a8a5a8,0x2513a62fa7d99e3e,0x9cb227ea2764a21f,0x2788a164a62fa513,0xa47226a728008000,0x27d91e3ea21fa764,0xa6dd241d2764221f,0x25ed255f1a46a7f6,0xa7f61a4625a825a8,0x20a527a82472a6a7,0xa788a164221f2764,0x9fc627c3270ea38b
.quad 0xa5a8a5a800002800,0xa5a825a828008000,0xa164a788a21f2764,0xa7c31fc6270e238b,0x1a46a7f6a5a825a8,0xa7a8a0a5247226a7,0x241da6dda764221f,0xa55fa5ed1a4627f6,0x26a7a472a8008000,0x9e3ea7d9a21f2764,0x27ea9cb2a764a21f,0x2164a788a62f2513,0x27a820a5a5a8a5a8,0x262fa513a7d91e3e,0x25ed255fa21fa764,0x27ea9cb2a7a8a0a5
.quad 0x221f27648000a800,0x2764221fa5a8a5a8,0x964827fe221fa764,0x24c4266da0a5a7a8,0xa38b270e25a8a5a8,0x1a4627f61e3ea7d9,0xa66d24c42764a21f,0xa2d7273b2513a62f,0xa7d91e3e28008000,0xa6a724722764a21f,0xa7c39fc62764221f,0xa7fe164827f61a46,0xa62fa51325a825a8,0xa70ea38b26a72472,0xa2d7a73b221f2764,0xa41da6dd238b270e
.quad 0xa800800000002800,0x280080008000a800,0xa66da4c4a47226a7,0x25ed255f2513a62f,0xa0a5a7a8a764221f,0x1a4627f627d99e3e,0x2164a788a7d99e3e,0xa4c4266d270e238b,0x26a7a472a5a8a5a8,0xa7d91e3e221f2764,0x27fe16489e3ea7d9,0xa6dda41da0a527a8,0x262f2513221fa764,0xa0a5a7a8a6a72472,0x1fc627c326a7a472,0x22d7a73ba7f69a46
.quad 0xa21f276428008000,0x2764a21fa5a8a5a8,0xa6dd241d26a72472,0x278821649a46a7f6,0xa7f69a46221f2764,0x238b270e2472a6a7,0xa5eda55f9e3e27d9,0x9fc627c327a8a0a5,0x9e3ea7d9a5a825a8,0xa6a724722764221f,0x22d7a73ba7d91e3e,0xa7ea9cb2238b270e,0x270ea38ba764a21f,0xa513a62f9e3e27d9,0x27ea1cb2a472a6a7,0x1648a7fea62f2513
.quad 0x25a825a88000a800,0x25a8a5a8a8008000,0x1cb227ea2472a6a7,0x27fe9648a62fa513,0xa38b270e2764a21f,0x262f25139e3ea7d9,0xa73b22d727d91e3e,0x1cb227ea238ba70e,0xa7d99e3e25a825a8,0xa47226a72764a21f,0xa55fa5ed1e3e27d9,0xa7c31fc627a820a5,0x9a46a7f6a21f2764,0xa70ea38b247226a7,0x241da6dda6a72472,0xa164a7889a4627f6
.quad 0x2764a21fa8008000,0x221fa764a5a825a8,0x27c31fc6a6a7a472,0x273ba2d7a7f61a46,0x2513262fa21fa764,0x27a820a5a6a7a472,0x164827fe1e3ea7d9,0x241d26dda0a5a7a8,0xa47226a725a8a5a8,0x9e3e27d9221fa764,0xa788216427d99e3e,0xa66d24c4270ea38b,0xa7a8a0a52764221f,0xa7f69a4627d91e3e,0xa4c4a66d247226a7,0xa55fa5ed2513262f
.quad 0xa800800000002800,0x280080008000a800,0xa55fa5eda5a825a8,0x24c4266d262fa513,0x1a46a7f6a8008000,0xa0a527a827d91e3e,0x266da4c4a5a8a5a8,0xa7882164238b270e,0x27d91e3e8000a800,0xa6a7a472a21f2764,0x241d26dd25a8a5a8,0x9648a7fea7a820a5,0xa0a527a828008000,0x262fa513a6a7a472,0xa73b22d725a825a8,0x27c31fc69a46a7f6
.quad 0xa764a21f00002800,0x221f276425a8a5a8,0xa164a788a5a825a8,0xa41d26dd27f61a46,0x238ba70ea8008000,0xa7f61a46247226a7,0x27c39fc6a5a8a5a8,0xa55fa5eda0a527a8,0x26a724728000a800,0x1e3ea7d9a764221f,0x1cb227ea25a8a5a8,0x273ba2d7a70ea38b,0xa513262f28008000,0x270e238b9e3ea7d9,0xa7fe164825a825a8,0x1cb227ea2513a62f
.quad 0xa5a8a5a800002800,0xa5a825a828008000,0x1648a7fea5a825a8,0xa7ea9cb22513262f,0x262fa513a8008000,0xa38ba70e9e3e27d9,0x27ea1cb2a5a8a5a8,0x22d7a73ba70e238b,0x247226a70000a800,0x27d99e3ea764a21f,0x9fc627c325a8a5a8,0x25ed255fa0a5a7a8,0xa70e238b28008000,0x9a4627f62472a6a7,0xa788a16425a825a8,0xa6dd241d27f69a46
.quad 0xa21fa76400002800,0xa764a21f25a825a8,0x22d7a73ba5a825a8,0x9fc6a7c39a4627f6,0x27a8a0a5a8008000,0x2513a62fa6a72472,0x26dd241da5a8a5a8,0x27fe1648a7a8a0a5,0x1e3e27d98000a800,0x247226a7a21fa764,0xa4c4266d25a8a5a8,0xa1642788238ba70e,0xa7f61a4628008000,0xa7a820a527d99e3e,0xa5eda55f25a825a8,0xa66da4c4262f2513
.quad 0xa800800000002800,0x280080008000a800,0xa41da6dda6a72472,0x22d7273b270ea38b,0x238ba70ea764a21f,0xa513262f26a72472,0x27fe96489e3ea7d9,0xa7c39fc69a4627f6,0x247226a725a8a5a8,0x9e3ea7d9a764221f,0xa2d7273b27d91e3e,0x266da4c4a62fa513,0xa7f61a46221f2764,0x270e238b1e3ea7d9,0xa4c4a66da47226a7,0x964827fe27a8a0a5
.quad 0x221fa764a8008000,0xa764221f25a825a8,0x27ea9cb2a472a6a7,0xa5eda55fa0a527a8,0x2513262f221fa764,0x20a5a7a8a7d91e3e,0xa164278827d99e3e,0x27ea9cb2a513a62f,0xa7d91e3e25a825a8,0x247226a7221fa764,0xa55fa5ed9e3e27d9,0xa41d26dd27f69a46,0x20a5a7a8a764221f,0xa7f69a46247226a7,0x27c39fc6a6a7a472,0xa164a788a38b270e
.quad 0x25a825a88000a800,0x25a8a5a8a8000000,0x9fc627c326a7a472,0x27882164a38ba70e,0xa7a820a52764221f,0x1a4627f62472a6a7,0xa5eda55f1e3e27d9,0xa6dd241d27f61a46,0x1e3ea7d9a5a825a8,0xa6a7a472221f2764,0x2788a164a7d99e3e,0x1cb2a7eaa513262f,0x262f2513a21fa764,0x27a8a0a5a7d99e3e,0x9cb227ea2472a6a7,0x255f25eda0a5a7a8
.quad 0xa764221f28008000,0xa21f276425a8a5a8,0xa66da4c4247226a7,0xa7fe164827a820a5,0x1a46a7f6a21f2764,0xa38ba70e1e3e27d9,0x273ba2d7a7d91e3e,0x24c4a66da62f2513,0x26a72472a5a8a5a8,0x27d91e3ea764a21f,0x964827fe1e3ea7d9,0x1fc627c39a46a7f6,0xa70e238b2764a21f,0xa62f251326a7a472,0xa6dda41d26a72472,0xa73ba2d7270e238b
.quad 0xa800800000002800,0x280080000000a800,0xa164a788a764221f,0x1fc627c327a8a0a5,0x262fa513a5a8a5a8,0xa70e238b247226a7,0x26dd241d221fa764,0xa55fa5eda513262f,0x9e3e27d928008000,0x2472a6a7a764a21f,0xa7ea1cb2221f2764,0x278821641a46a7f6,0xa38ba70ea5a825a8,0x9a4627f627d99e3e,0x255fa5eda764a21f,0xa7ea1cb2238b270e
.quad 0x2764221f8000a800,0xa21fa764a5a825a8,0x964827fe2764a21f,0x266da4c4a70ea38b,0xa7a820a525a825a8,0x262f25131e3ea7d9,0xa4c4a66da21f2764,0xa2d7273b27f69a46,0x2472a6a7a8000000,0xa7d99e3e221f2764,0x27c31fc6a21fa764,0x9648a7fea62f2513,0x1a4627f625a8a5a8,0x27a8a0a5a6a7a472,0xa73b22d72764221f,0x241d26dd20a5a7a8
.quad 0xa5a8a5a800002800,0xa5a825a828008000,0x22d7a73ba764221f,0xa6dda41d20a527a8,0x27f61a46a5a8a5a8,0x20a5a7a8a6a72472,0x1fc627c3221fa764,0x27fe1648a62fa513,0xa6a7247228000000,0x1e3e27d9221fa764,0xa66da4c4221f2764,0xa73b22d727f61a46,0x20a5a7a8a5a825a8,0xa513a62f1e3e27d9,0x27fe9648a764a21f,0x24c4a66da70e238b
.quad 0x221f27640000a800,0x2764221fa5a8a5a8,0xa5ed255f2764a21f,0x9cb227ea238ba70e,0xa70ea38b25a825a8,0xa7f61a4627d91e3e,0x1cb2a7eaa21f2764,0xa164a7881a4627f6,0x27d99e3ea8000000,0x26a7a472a764221f,0x241d26dda21fa764,0x25ed255fa513a62f,0xa513262f25a8a5a8,0xa38b270e2472a6a7,0xa788a1642764221f,0xa7c39fc627a820a5
.quad 0xa800800000002800,0x280080008000a800,0x9cb2a7eaa7d91e3e,0x164827fe27f69a46,0x27a8a0a5a21fa764,0xa7f61a461e3e27d9,0x22d7273b26a7a472,0x9cb2a7eaa7a820a5,0xa6a7247225a825a8,0x27d99e3ea21fa764,0xa55fa5eda47226a7,0x1fc627c3270ea38b,0x2513a62fa764a21f,0xa7a820a5247226a7,0x26dd241d1e3ea7d9,0xa164a788a62f2513
.quad 0xa21f276428008000,0x2764a21fa5a8a5a8,0xa7c39fc61e3e27d9,0x22d7273b2513a62f,0x1a46a7f6a764221f,0xa70e238b26a72472,0x27fe9648a472a6a7,0xa41da6dda38b270e,0x1e3e27d925a8a5a8,0x26a7a472a764a21f,0xa788216426a72472,0x24c4266d20a5a7a8,0xa38ba70ea21f2764,0xa62f251327d91e3e,0x266da4c4a7d99e3e,0xa55fa5ed9a4627f6
.quad 0x25a825a80000a800,0x25a8a5a8a8000000,0xa4c4266d27d99e3e,0x25ed255f9a46a7f6,0xa70ea38b221f2764,0xa513262f27d99e3e,0x2164a788a6a72472,0xa66da4c420a527a8,0x27d91e3ea5a8a5a8,0x2472a6a7a764221f,0x964827fe2472a6a7,0x26dd241da38ba70e,0xa7f61a462764221f,0xa38b270e26a7a472,0x9fc6a7c39e3e27d9,0xa73ba2d72513262f
.quad 0x2764a21fa8000000,0x221fa764a5a825a8,0x241d26dd9e3ea7d9,0x27882164a62fa513,0xa62f25132764a21f,0xa0a527a82472a6a7,0xa5eda55f247226a7,0xa7c39fc6270e238b,0x2472a6a7a5a825a8,0x1e3ea7d9a21f2764,0x273b22d7a6a7a472,0x27ea1cb2a7a8a0a5,0xa0a527a8221fa764,0x9a4627f61e3ea7d9,0xa7ea9cb227d91e3e,0xa7fe964827f61a46
.quad 0xa800000000002800,0x280080000000a800,0x1648a7fea8000000,0x9cb227ea27f61a46,0x27f61a460000a800,0xa7a8a0a59e3e27d9,0x9cb227ea28008000,0x22d7a73ba7a8a0a5,0xa7d99e3e00002800,0x26a72472221fa764,0x1fc6a7c3a8000000,0xa55f25ed270e238b,0x27a820a58000a800,0xa513a62fa47226a7,0xa164278828008000,0x26dda41da62fa513
.quad 0xa764a21f00002800,0x221f276425a8a5a8,0x22d7a73ba8000000,0xa7c31fc62513262f,0x270e238b0000a800,0x9a46a7f6a6a72472,0xa41d26dd28008000,0x27fe1648a38ba70e,0xa6a7a47200002800,0x9e3e27d92764a21f,0x24c4a66da8000000,0xa788a16420a527a8,0x262f25138000a800,0x238ba70ea7d91e3e,0xa55f25ed28000000,0x266d24c49a46a7f6
.quad 0xa5a8a5a800002800,0xa5a825a828008000,0x25eda55fa8000000,0xa4c4a66d9a4627f6,0x2513262f0000a800,0x270ea38ba7d99e3e,0xa66d24c428008000,0x2164278820a5a7a8,0xa472a6a780002800,0xa7d91e3e2764221f,0x26dda41da8000000,0x9648a7fea38b270e,0x238b270e8000a800,0x27f61a46a6a7a472,0xa73b22d728000000,0x9fc627c32513a62f
.quad 0xa21fa76400002800,0xa764a21f25a825a8,0x2788a164a8000000,0x241da6dda62f2513,0x20a527a80000a800,0x262f2513a472a6a7,0xa7c31fc628008000,0xa5ed255f270ea38b,0x9e3ea7d900002800,0xa472a6a7221f2764,0x27ea9cb2a8000000,0x273ba2d7a7a820a5,0x1a4627f68000a800,0x20a527a89e3ea7d9,0xa7fe164828000000,0xa7ea1cb227f69a46
.quad 0xa800000000002800,0x280080008000a800,0x1fc6a7c3a7d99e3e,0xa164278827a820a5,0x270e238b221fa764,0xa62fa513a47226a7,0xa55f25ed26a72472,0x26dda41da513a62f,0xa472a6a7a5a825a8,0x1e3e27d92764a21f,0x2788a164a472a6a7,0xa7ea9cb21a4627f6,0x1a4627f62764a21f,0x238ba70ea7d99e3e,0xa7ea9cb21e3e27d9,0x255f25ed238ba70e
.quad 0x221fa764a8000000,0xa764221f25a825a8,0x266d24c41e3ea7d9,0x9648a7fea70e238b,0xa62f25132764221f,0x27a820a59e3ea7d9,0xa2d7a73ba47226a7,0xa4c4266d27f61a46,0x27d99e3ea5a8a5a8,0xa472a6a7a21f2764,0x964827fe26a7a472,0x27c39fc6a62fa513,0xa7a8a0a5221f2764,0x9a4627f626a7a472,0x241da6dda7d91e3e,0xa73ba2d720a527a8
.quad 0x25a825a88000a800,0x25a8a5a8a8000000,0xa6dd241d27d91e3e,0x22d7273b20a5a7a8,0xa0a5a7a8a21f2764,0xa7f61a4626a72472,0x27fe9648a6a7a472,0x1fc6a7c3a62f2513,0x9e3e27d925a8a5a8,0x26a72472a21fa764,0xa73ba2d7247226a7,0xa66d24c427f69a46,0x2513a62fa764221f,0xa0a5a7a89e3e27d9,0x24c4266d9e3ea7d9,0x27fe1648a70ea38b
.quad 0xa764221f28000000,0xa21f276425a8a5a8,0x9cb2a7ea9e3e27d9,0xa5eda55f238b270e,0x27f61a46a764a21f,0x270ea38ba7d91e3e,0xa16427882472a6a7,0x1cb227ea1a46a7f6,0xa6a7a47225a825a8,0xa7d99e3e2764221f,0x25eda55fa6a72472,0x241da6dda513262f,0x238b270ea21fa764,0x2513262fa472a6a7,0xa7c31fc627d99e3e,0xa788216427a8a0a5
.quad 0xa800000000002800,0x280080000000a800,0x22d7a73ba764a21f,0xa41d26dd270e238b,0x2513262f25a8a5a8,0xa38ba70ea6a72472,0xa7c31fc6221f2764,0x27fe16489a46a7f6,0x1e3ea7d9a8000000,0xa47226a72764221f,0x266d24c4221fa764,0xa2d7a73ba62f2513,0xa70e238b25a825a8,0x27f61a469e3ea7d9,0x9648a7fea764221f,0xa4c4266d27a820a5
.quad 0x2764221f0000a800,0xa21fa764a5a825a8,0xa5ed255f2764221f,0x27ea1cb2a0a5a7a8,0xa0a5a7a8a5a825a8,0xa513262f27d91e3e,0x27ea1cb2a21fa764,0xa164a788a513262f,0xa47226a728008000,0x27d91e3ea21fa764,0xa41da6dda21f2764,0xa55f25ed27f61a46,0x27f69a46a5a8a5a8,0xa0a5a7a8a47226a7,0xa16427882764a21f,0x27c31fc6a38ba70e
.quad 0xa5a8a5a800002800,0xa5a825a828000000,0x2788a164a764a21f,0x9fc6a7c3a38b270e,0x9a4627f625a8a5a8,0x27a820a5a472a6a7,0xa6dda41d221f2764,0xa5ed255f27f69a46,0x26a7a472a8008000,0x9e3ea7d9a21f2764,0x1cb227ea221fa764,0x27882164a513a62f,0xa7a8a0a525a825a8,0xa62f251327d99e3e,0x255fa5eda764221f,0x9cb2a7eaa0a527a8
.quad 0x221f27648000a800,0x2764221fa5a8a5a8,0xa7fe96482764221f,0xa66d24c427a8a0a5,0x238ba70ea5a825a8,0x9a46a7f69e3e27d9,0x24c4266da21fa764,0x273b22d7a62fa513,0xa7d91e3e28008000,0xa6a724722764a21f,0x1fc6a7c3a21f2764,0x9648a7fe9a4627f6,0x262f2513a5a8a5a8,0x270e238ba6a7a472,0xa73b22d72764a21f,0xa6dd241d270ea38b
.quad 0xa800000000002800,0x280000008000a800,0x24c4a66da6a7a472,0xa55f25ed262f2513,0x20a527a82764a21f,0x9a46a7f6a7d91e3e,0xa788a1649e3e27d9,0x266d24c4238ba70e,0x26a7a472a5a8a5a8,0xa7d91e3e221f2764,0x964827fe27d99e3e,0x241da6dda7a8a0a5,0xa62fa513a21f2764,0x20a527a826a7a472,0x27c39fc6a472a6a7,0xa73ba2d79a4627f6
.quad 0xa21f276428000000,0x2764a21fa5a8a5a8,0xa41da6dda47226a7,0xa164278827f69a46,0x27f61a46a21fa764,0xa38ba70ea47226a7,0xa55f25ed27d91e3e,0x27c31fc6a0a5a7a8,0x9e3ea7d9a5a825a8,0xa6a724722764221f,0x273b22d79e3ea7d9,0x1cb2a7eaa70e238b,0xa70e238b2764221f,0x2513262f1e3ea7d9,0x1cb2a7eaa6a72472,0xa7fe96482513262f
.quad 0x25a825a88000a800,0x25a8a5a8a8000000,0xa7ea1cb226a72472,0x164827fe2513a62f,0x238ba70ea764221f,0xa62fa5131e3e27d9,0x22d7273b1e3ea7d9,0x27ea9cb2a70ea38b,0xa7d99e3e25a825a8,0xa47226a72764a21f,0x25eda55fa7d91e3e,0x9fc6a7c3a0a527a8,0x1a4627f6221fa764,0x270e238ba472a6a7,0xa6dda41d247226a7,0xa788216427f61a46
.quad 0x2764a21fa8000000,0x221fa764a5a825a8,0x9fc627c32472a6a7,0x22d7273b9a46a7f6,0xa513a62f221f2764,0xa7a8a0a526a72472,0x27fe9648a7d99e3e,0x26dda41da7a820a5,0xa47226a725a8a5a8,0x9e3e27d9221fa764,0xa164a7881e3e27d9,0xa4c4a66d238b270e,0x27a820a5a764a21f,0x27f61a46a7d99e3e,0xa66d24c426a7a472,0xa5ed255f262fa513
.quad 0xa800000000002800,0x280080000000a800,0x25eda55fa5a8a5a8,0xa66d24c42513262f,0x9a4627f628000000,0x20a5a7a8a7d99e3e,0xa4c4a66da5a825a8,0x21642788270ea38b,0x27d91e3e8000a800,0xa6a7a472a21f2764,0xa6dd241d25a825a8,0x27fe9648a0a5a7a8,0x20a5a7a8a8000000,0xa62f251326a72472,0x22d7273b25a8a5a8,0x1fc6a7c3a7f61a46
.quad 0xa764a21f00002800,0x221f276425a8a5a8,0x2788a164a5a8a5a8,0xa6dda41d9a4627f6,0xa38b270e28000000,0x27f69a46a472a6a7,0x9fc6a7c3a5a825a8,0xa5ed255f27a820a5,0x26a724728000a800,0x1e3ea7d9a764221f,0xa7ea1cb225a825a8,0x22d7273b238ba70e,0x2513a62fa8000000,0xa70ea38b1e3e27d9,0x164827fe25a8a5a8,0x27ea9cb2a62fa513
.quad 0xa5a8a5a800002800,0xa5a825a828008000,0x27fe1648a5a8a5a8,0x1cb2a7eaa62f2513,0xa62f251328008000,0x238b270e1e3ea7d9,0x1cb2a7eaa5a825a8,0xa73ba2d7238b270e,0x247226a70000a800,0x27d99e3ea764a21f,0xa7c39fc625a825a8,0xa55f25ed27a8a0a5,0x270ea38ba8000000,0x1a46a7f6a47226a7,0xa164278825a8a5a8,0x241d26dd9a46a7f6
.quad 0xa21fa76480002800,0xa764a21f25a825a8,0x273b22d7a5a8a5a8,0x27c39fc6a7f69a46,0xa7a820a528008000,0xa513262f26a7a472,0x241da6dda5a825a8,0x1648a7fea0a527a8,0x1e3e27d98000a800,0x247226a7a21fa764,0xa66da4c425a825a8,0xa788a164270e238b,0x27f69a46a8000000,0x27a8a0a5a7d91e3e,0xa55f25ed25a8a5a8,0xa4c4266d2513a62f
.quad 0xa800000080002800,0x280000008000a800,0x26dda41da472a6a7,0xa73b22d7238b270e,0xa38b270e2764221f,0x2513a62fa6a7a472,0x9648a7fea7d91e3e,0x9fc627c327f61a46,0x247226a725a8a5a8,0x9e3ea7d9a764221f,0xa73ba2d79e3e27d9,0x24c4266d2513a62f,0x27f69a46a21fa764,0xa70ea38b9e3e27d9,0xa66d24c426a72472,0x27fe1648a0a5a7a8
.quad 0x221fa764a8000000,0xa764221f25a825a8,0x1cb227ea26a7a472,0x255fa5eda7a8a0a5,0xa513a62fa21f2764,0xa0a527a827d99e3e,0x278821649e3ea7d9,0x9cb2a7eaa62f2513,0xa7d91e3e25a825a8,0x247226a7221fa764,0x25eda55fa7d99e3e,0xa6dda41d1a4627f6,0xa0a527a82764a21f,0x27f61a46a472a6a7,0x9fc6a7c3a47226a7,0xa7882164270e238b
.quad 0x25a825a88000a800,0x25a8a5a8a8000000,0xa7c39fc6247226a7,0xa1642788270ea38b,0x27a8a0a5a764a21f,0x9a46a7f6a47226a7,0xa55f25ed27d99e3e,0x241d26dd1a46a7f6,0x1e3ea7d9a5a825a8,0xa6a7a472221f2764,0x216427881e3ea7d9,0x27ea1cb2a62fa513,0xa62fa513221f2764,0xa7a820a527d91e3e,0x27ea1cb2a6a7a472,0x25eda55fa7a820a5
.quad 0xa764221f28008000,0xa21f276425a8a5a8,0x24c4a66da6a72472,0x9648a7fea0a527a8,0x9a4627f6221fa764,0x238b270e9e3ea7d9,0xa2d7a73b1e3e27d9,0xa66da4c42513262f,0x26a72472a5a8a5a8,0x27d91e3ea764a21f,0xa7fe964827d91e3e,0xa7c31fc627f69a46,0x270ea38ba764221f,0x262fa513a6a72472,0xa41d26dd2472a6a7,0xa2d7273b238ba70e
.quad 0xa800000000002800,0x280080000000a800,0x2788a164a21fa764,0xa7c31fc620a527a8,0xa62f251325a825a8,0x270ea38ba472a6a7,0x241da6dda764a21f,0xa5ed255f262f2513,0x9e3e27d928000000,0x2472a6a7a764a21f,0x9cb2a7eaa764221f,0xa164278827f61a46,0x238b270e25a8a5a8,0x1a46a7f6a7d91e3e,0xa5eda55fa21f2764,0x1cb227ea270ea38b
.quad 0x2764221f8000a800,0xa21fa764a5a825a8,0xa7fe9648221f2764,0x24c4266d238ba70e,0x27a8a0a5a5a8a5a8,0xa62fa5139e3e27d9,0xa66d24c42764221f,0x273b22d79a46a7f6,0x2472a6a7a8000000,0xa7d99e3e221f2764,0x9fc627c32764a21f,0x27fe9648a513a62f,0x9a46a7f6a5a825a8,0xa7a820a526a72472,0x22d7273b221fa764,0x26dda41da7a8a0a5
.quad 0xa5a8a5a880002800,0xa5a825a828008000,0x273b22d7a21fa764,0x241da6dda7a820a5,0xa7f69a4625a825a8,0xa0a527a826a7a472,0x27c39fc6a764a21f,0x1648a7fea513262f,0xa6a7247228000000,0x1e3e27d9221fa764,0x24c4a66da764221f,0xa2d7a73b9a4627f6,0xa0a527a825a8a5a8,0x2513262f9e3ea7d9,0x9648a7fea21f2764,0xa66da4c4238b270e
.quad 0x221f27648000a800,0x2764221fa5a8a5a8,0xa55fa5ed221f2764,0xa7ea9cb2270e238b,0x270e238ba5a8a5a8,0x27f69a46a7d99e3e,0xa7ea9cb22764221f,0xa788216427f69a46,0x27d99e3ea8000000,0x26a7a472a764221f,0xa6dd241d2764a21f,0xa55f25ed262fa513,0x2513a62fa5a825a8,0x238ba70ea47226a7,0xa1642788221fa764,0x9fc627c320a5a7a8
.quad 0xa800000000002800,0x280000008000a800,0x27ea9cb29e3ea7d9,0xa7fe16481a4627f6,0xa7a820a5221f2764,0x27f69a469e3ea7d9,0x273ba2d7a472a6a7,0xa7ea1cb220a527a8,0xa6a7247225a825a8,0x27d99e3ea21fa764,0x25eda55fa6a7a472,0xa7c31fc6238b270e,0xa513262f2764221f,0x27a8a0a5a472a6a7,0x241da6dda7d99e3e,0xa78821642513262f
.quad 0xa21f276428008000,0x2764a21fa5a8a5a8,0x1fc6a7c3a7d91e3e,0xa73b22d7262f2513,0x9a4627f62764a21f,0x270ea38ba6a7a472,0x9648a7fea6a72472,0xa6dd241d270e238b,0x1e3e27d925a8a5a8,0x26a7a472a764a21f,0xa164a788a47226a7,0xa66d24c427a820a5,0x238b270e221fa764,0x262fa513a7d99e3e,0xa4c4a66d9e3e27d9,0xa5ed255f27f61a46
.quad 0x25a825a88000a800,0x25a8a5a8a8000000,0xa66da4c41e3e27d9,0xa55f25ed27f69a46,0x270e238ba21fa764,0x2513a62fa7d91e3e,0xa788a164247226a7,0xa4c4266d27a8a0a5,0x27d91e3ea5a8a5a8,0x2472a6a7a764221f,0xa7fe964826a72472,0xa41d26dd270ea38b,0x27f69a46a764a21f,0x238ba70ea6a72472,0xa7c31fc627d91e3e,0xa2d7273b262fa513
.quad 0x2764a21fa8008000,0x221fa764a5a825a8,0xa6dd241d27d99e3e,0xa16427882513a62f,0x262fa513a764221f,0x20a5a7a8a47226a7,0xa55f25ed26a7a472,0x9fc627c3238ba70e,0x2472a6a7a5a825a8,0x1e3ea7d9a21f2764,0xa2d7273b2472a6a7,0x9cb227ea20a5a7a8,0x20a5a7a8a21f2764,0x1a46a7f69e3e27d9,0x9cb227ea1e3ea7d9,0x964827fe1a46a7f6
.quad 0x8000a80028002800,0x8000a80000002800,0x1648a7fea8002800,0x1cb2a7ea9a4627f6,0x1a46a7f628002800,0x20a5a7a89e3e27d9,0x1cb2a7eaa8002800,0x22d7a73ba0a527a8,0x1e3ea7d928002800,0x2472a6a7a21f2764,0x1fc6a7c3a8002800,0x255fa5eda38b270e,0x20a5a7a828002800,0x262fa513a47226a7,0x2164a788a8002800,0x26dda41da513262f
.quad 0x221fa76428002800,0x2764a21fa5a825a8,0x22d7a73ba8002800,0x27c39fc6a62f2513,0x238ba70e28002800,0x27f69a46a6a72472,0x241da6dda8002800,0x27fe1648a70e238b,0x2472a6a728002800,0x27d91e3ea764221f,0x24c4a66da8002800,0x27882164a7a820a5,0x2513a62f28002800,0x270e238ba7d91e3e,0x255fa5eda8002800,0x266d24c4a7f61a46
.quad 0x25a8a5a828002800,0x25a825a8a8000000,0x25eda55fa8002800,0x24c4266da7f69a46,0x262fa51328002800,0x238b270ea7d99e3e,0x266da4c4a8002800,0x21642788a7a8a0a5,0x26a7a47228002800,0x1e3e27d9a764a21f,0x26dda41da8002800,0x164827fea70ea38b,0x270ea38b28002800,0x9a4627f6a6a7a472,0x273ba2d7a8002800,0x9fc627c3a62fa513
.quad 0x2764a21f28002800,0xa21f2764a5a8a5a8,0x2788a164a8002800,0xa41d26dda513a62f,0x27a8a0a528002800,0xa513262fa472a6a7,0x27c39fc6a8002800,0xa5ed255fa38ba70e,0x27d99e3e28002800,0xa6a72472a21fa764,0x27ea9cb2a8002800,0xa73b22d7a0a5a7a8,0x27f69a4628002800,0xa7a820a59e3ea7d9,0x27fe9648a8002800,0xa7ea1cb29a46a7f6
.quad 0x8000a80000002800,0x8000a80000002800,0x1fc6a7c39e3e27d9,0x2164a788a0a527a8,0x238ba70ea21f2764,0x2513a62fa47226a7,0x255fa5eda47226a7,0x26dda41da62f2513,0x26a7a472a5a825a8,0x27d99e3ea764221f,0x2788a164a6a72472,0x27ea1cb2a7f61a46,0x27f69a46a764221f,0x270e238ba7d99e3e,0x27ea1cb2a7d91e3e,0x255f25eda70ea38b
.quad 0x2764221fa8000000,0x221f2764a5a8a5a8,0x266d24c4a7d99e3e,0x164827fea38ba70e,0x2513262fa764a21f,0xa0a527a89e3ea7d9,0x22d7273ba6a7a472,0xa4c4266d1a46a7f6,0x1e3e27d9a5a8a5a8,0xa6a72472221fa764,0x964827fea472a6a7,0xa7c31fc62513a62f,0xa0a527a8a21fa764,0xa7f69a4626a7a472,0xa41d26dd9e3ea7d9,0xa73ba2d727a8a0a5
.quad 0xa5a825a88000a800,0xa5a8a5a828008000,0xa6dd241d1e3ea7d9,0xa2d7a73b27a820a5,0xa7a820a5221fa764,0x9a46a7f626a72472,0xa7fe16482472a6a7,0x1fc6a7c32513262f,0xa7d99e3e25a8a5a8,0x2472a6a7221f2764,0xa73ba2d726a7a472,0x266da4c41a4627f6,0xa62fa5132764a21f,0x27a8a0a59e3e27d9,0xa4c4a66d27d99e3e,0x27fe1648a38b270e
.quad 0xa21fa76428008000,0x2764221fa5a825a8,0x9cb2a7ea27d91e3e,0x25ed255fa70e238b,0x1a46a7f62764221f,0x238b270ea7d91e3e,0x2164a78826a72472,0x1cb227eaa7f69a46,0x2472a6a725a825a8,0x9e3e27d9a764a21f,0x25eda55f247226a7,0xa41d26dda62fa513,0x270ea38b221f2764,0xa62f2513a472a6a7,0x27c39fc61e3e27d9,0xa7882164a0a5a7a8
.quad 0x8000a80000002800,0x8000a80000002800,0x22d7a73ba21f2764,0x241da6dda38b270e,0x262fa513a5a825a8,0x270ea38ba6a72472,0x27c39fc6a764221f,0x27fe1648a7f61a46,0x27d91e3ea8008000,0x26a72472a764a21f,0x266d24c4a764a21f,0x22d7273ba513a62f,0x238b270ea5a8a5a8,0x9a4627f69e3ea7d9,0x164827fea21fa764,0xa4c4266d20a5a7a8
.quad 0xa21f27648000a800,0xa764221f25a8a5a8,0xa5ed255f221fa764,0xa7ea9cb227a8a0a5,0xa7a820a525a8a5a8,0xa62fa51327d91e3e,0xa7ea9cb22764a21f,0xa164a788262f2513,0xa6a7a47228008000,0x1e3ea7d9221f2764,0xa41da6dd2764221f,0x255fa5ed9a4627f6,0x9a46a7f625a825a8,0x27a8a0a5a47226a7,0x2164a788221f2764,0x27c31fc6a70e238b
.quad 0x25a8a5a800002800,0x25a825a8a8008000,0x2788a164a21f2764,0x1fc627c3a70ea38b,0x27f61a46a5a825a8,0xa0a527a8a472a6a7,0x26dd241da764221f,0xa5ed255f9a46a7f6,0x247226a7a8008000,0xa7d91e3e221fa764,0x1cb227eaa764a21f,0xa788a164262fa513,0xa0a527a8a5a8a5a8,0xa513a62f27d99e3e,0xa55f25eda21fa764,0x9cb2a7ea27a820a5
.quad 0xa764221f8000a800,0x221fa76425a825a8,0xa7fe9648221fa764,0x266da4c420a527a8,0xa70ea38b25a8a5a8,0x27f69a469e3e27d9,0xa4c4a66d2764a21f,0x273b22d7a513262f,0x9e3ea7d928008000,0x247226a7a764221f,0x1fc6a7c32764221f,0x164827fea7f69a46,0x2513a62f25a825a8,0xa38b270ea6a7a472,0x273ba2d7221f2764,0xa6dd241da38ba70e
.quad 0xa80000002800,0x8000a80000002800,0x24c4a66da47226a7,0x255fa5eda513262f,0x27a8a0a5a764221f,0x27f69a46a7d91e3e,0x27882164a7d99e3e,0x266d24c4a70ea38b,0x247226a7a5a8a5a8,0x1e3e27d9a21fa764,0x964827fe9e3ea7d9,0xa41d26dd20a5a7a8,0xa513262f221fa764,0xa7a820a526a7a472,0xa7c31fc626a7a472,0xa73ba2d727f61a46
.quad 0xa764a21f28008000,0xa21fa76425a825a8,0xa41da6dd26a72472,0x2164a7881a4627f6,0x1a46a7f6221f2764,0x270ea38ba47226a7,0x255fa5ed9e3e27d9,0x27c31fc6a7a820a5,0x27d99e3ea5a825a8,0x247226a7a764a21f,0x273b22d7a7d91e3e,0x9cb227eaa38ba70e,0x238b270ea764a21f,0xa62f25131e3ea7d9,0x9cb227eaa472a6a7,0xa7fe9648262fa513
.quad 0xa5a825a88000a800,0xa5a8a5a828008000,0xa7ea1cb22472a6a7,0x9648a7fe262f2513,0xa70ea38b2764a21f,0x2513a62f1e3e27d9,0xa2d7a73b27d91e3e,0x27ea9cb2a38b270e,0x1e3ea7d925a825a8,0x26a72472a764221f,0x25eda55f1e3e27d9,0x1fc627c3a7a8a0a5,0x27f69a46a21f2764,0xa38b270ea472a6a7,0x26dd241da6a72472,0xa78821641a46a7f6
.quad 0x221f2764a8000000,0xa764a21f25a8a5a8,0x9fc627c3a6a7a472,0xa2d7a73b27f69a46,0xa62f2513a21fa764,0x20a5a7a826a72472,0xa7fe16481e3ea7d9,0x26dda41d20a527a8,0xa6a7a47225a8a5a8,0x27d91e3ea21f2764,0xa164a78827d99e3e,0x24c4266da70e238b,0x20a5a7a82764221f,0x9a4627f6a7d99e3e,0x266da4c4247226a7,0xa5ed255fa513a62f
.quad 0xa80000002800,0x8000a80000002800,0x25eda55fa5a825a8,0x266da4c4a62f2513,0x27f61a46a8000000,0x27a820a5a7d99e3e,0x24c4266da5a8a5a8,0x21642788a38ba70e,0x9e3e27d90000a800,0xa47226a7221fa764,0xa6dd241d25a8a5a8,0xa7fe164827a8a0a5,0xa7a8a0a528008000,0xa513a62f26a72472,0xa2d7a73b25a825a8,0x1fc6a7c31a4627f6
.quad 0x221fa76400002800,0x2764a21fa5a825a8,0x2788a164a5a825a8,0x26dd241da7f69a46,0x270e238ba8000000,0x1a4627f6a472a6a7,0x1fc627c3a5a8a5a8,0xa5ed255f20a5a7a8,0xa47226a78000a800,0xa7d99e3e2764a21f,0xa7ea1cb225a8a5a8,0xa2d7a73b270e238b,0xa62fa51328008000,0x238ba70e1e3e27d9,0x9648a7fe25a825a8,0x27ea9cb2a513262f
.quad 0x25a8a5a800002800,0x25a825a8a8000000,0x27fe1648a5a825a8,0x9cb227eaa513a62f,0x2513262fa8000000,0xa70e238b1e3ea7d9,0x9cb227eaa5a8a5a8,0xa73ba2d7270ea38b,0xa6a724720000a800,0x9e3ea7d92764221f,0xa7c39fc625a8a5a8,0x255fa5ed20a527a8,0xa38ba70e28008000,0x27f61a46a47226a7,0x2164a78825a825a8,0x241d26dda7f61a46
.quad 0x2764a21f00002800,0xa21f2764a5a8a5a8,0x273b22d7a5a825a8,0xa7c31fc61a46a7f6,0x20a527a8a8000000,0xa62fa51326a7a472,0xa41d26dda5a8a5a8,0x1648a7fe27a820a5,0xa7d91e3e8000a800,0x26a7a472221f2764,0xa66da4c425a8a5a8,0x27882164a38b270e,0x9a46a7f628000000,0x20a527a8a7d91e3e,0x255fa5ed25a825a8,0xa4c4266da62fa513
.quad 0xa80000002800,0x8000a80000002800,0x26dda41da6a72472,0x273ba2d7a70e238b,0x270e238ba764a21f,0x262f2513a6a7a472,0x164827fe9e3ea7d9,0x9fc627c31a46a7f6,0xa6a7247225a8a5a8,0xa7d91e3e2764a21f,0xa73ba2d727d91e3e,0xa4c4a66d262f2513,0x9a46a7f6221f2764,0x238ba70e9e3e27d9,0x266da4c4a47226a7,0x27fe1648a7a820a5
.quad 0x2764221fa8000000,0x221f2764a5a8a5a8,0x1cb227eaa472a6a7,0xa55f25ed20a5a7a8,0xa62f2513221fa764,0xa7a8a0a527d99e3e,0xa788a16427d99e3e,0x9cb2a7ea2513262f,0x9e3ea7d925a825a8,0x26a7a472a21f2764,0x25eda55f9e3e27d9,0x26dd241da7f61a46,0x27a820a5a764221f,0x9a4627f6a472a6a7,0x1fc627c3a6a7a472,0xa7882164238ba70e
.quad 0xa5a825a80000a800,0xa5a8a5a828000000,0xa7c39fc626a7a472,0x2164a788238b270e,0xa0a5a7a82764221f,0x27f69a46a47226a7,0x255fa5ed1e3e27d9,0x241d26dda7f69a46,0x27d91e3ea5a825a8,0xa47226a7a21fa764,0x21642788a7d99e3e,0xa7ea9cb22513a62f,0xa513262fa21fa764,0xa0a5a7a827d91e3e,0xa7ea9cb22472a6a7,0x25eda55f20a527a8
.quad 0xa21fa76428008000,0x2764221fa5a825a8,0x24c4a66d247226a7,0x164827fea7a8a0a5,0x27f61a46a21f2764,0xa70e238b9e3ea7d9,0x22d7273ba7d91e3e,0xa66da4c4262fa513,0xa47226a7a5a8a5a8,0x1e3ea7d92764221f,0xa7fe96481e3ea7d9,0x27c39fc61a4627f6,0xa38ba70e2764a21f,0x2513262fa6a72472,0x241da6dd26a72472,0xa2d7273ba70ea38b
.quad 0xa80000002800,0x8000a80080002800,0x2788a164a764221f,0x27c39fc6a7a820a5,0x2513262fa5a8a5a8,0x238b270ea472a6a7,0xa41d26dd221fa764,0xa5ed255f2513a62f,0xa7d99e3e28000000,0xa6a7a4722764221f,0x9cb2a7ea221f2764,0x2164a7889a4627f6,0x270ea38ba5a825a8,0x27f61a46a7d91e3e,0x25ed255fa764a21f,0x1cb227eaa38ba70e
.quad 0xa21f27648000a800,0xa764221f25a8a5a8,0xa7fe96482764a21f,0xa4c4a66d270e238b,0xa0a5a7a825a825a8,0x2513a62f9e3e27d9,0x266da4c4a21f2764,0x273b22d7a7f61a46,0x26a72472a8000000,0x9e3e27d9a21fa764,0x9fc627c3a21fa764,0xa7fe1648262fa513,0xa7f61a4625a8a5a8,0xa0a5a7a826a72472,0xa2d7a73b2764221f,0x26dda41da0a527a8
.quad 0x25a8a5a800002800,0x25a825a8a8000000,0x273b22d7a764221f,0xa41d26dda0a5a7a8,0x9a4627f6a5a8a5a8,0xa7a8a0a526a7a472,0xa7c31fc6221fa764,0x1648a7fe262f2513,0xa472a6a728000000,0x27d99e3ea21f2764,0x24c4a66d221f2764,0x22d7273ba7f69a46,0x27a820a5a5a825a8,0xa62f25139e3ea7d9,0x164827fea764a21f,0xa66da4c4270ea38b
.quad 0xa764221f8000a800,0x221fa76425a825a8,0xa55fa5ed2764a21f,0x27ea1cb2a38b270e,0x238ba70e25a825a8,0x1a4627f6a7d99e3e,0x27ea1cb2a21f2764,0xa78821649a46a7f6,0x1e3e27d9a8000000,0xa472a6a72764a21f,0xa6dd241da21fa764,0x255fa5ed2513262f,0xa62fa51325a8a5a8,0x270e238ba47226a7,0x2164a7882764221f,0x9fc627c3a7a8a0a5
.quad 0xa80000002800,0x8000a80000002800,0x27ea9cb2a7d91e3e,0x27fe9648a7f61a46,0x20a527a8a21fa764,0x1a4627f69e3ea7d9,0xa73b22d726a7a472,0xa7ea1cb227a8a0a5,0xa472a6a725a825a8,0x9e3ea7d9221f2764,0x25eda55fa47226a7,0x27c39fc6a70e238b,0x262f2513a764a21f,0x20a527a8a472a6a7,0xa41d26dd1e3ea7d9,0xa7882164262fa513
.quad 0xa764a21f28000000,0xa21fa76425a825a8,0x1fc6a7c31e3e27d9,0x273ba2d7a513262f,0x27f61a46a764221f,0x238b270ea6a7a472,0x164827fea472a6a7,0xa6dd241d238ba70e,0xa7d91e3e25a8a5a8,0xa472a6a72764221f,0xa164a78826a72472,0x266da4c4a0a527a8,0x270ea38ba21f2764,0x2513262fa7d99e3e,0x24c4266da7d99e3e,0xa5ed255f1a46a7f6
.quad 0xa5a825a88000a800,0xa5a8a5a828008000,0xa66da4c427d99e3e,0x255fa5ed1a4627f6,0x238ba70e221f2764,0x262f2513a7d91e3e,0x27882164a6a72472,0xa4c4266da0a5a7a8,0x9e3e27d9a5a8a5a8,0xa6a7a4722764a21f,0xa7fe96482472a6a7,0x241da6dd238b270e,0x9a46a7f62764221f,0x270e238ba6a72472,0x27c39fc69e3e27d9,0xa2d7273ba513a62f
.quad 0x221f2764a8000000,0xa764a21f25a8a5a8,0xa6dd241d9e3ea7d9,0x2164a788262f2513,0xa513a62f2764a21f,0x27a820a5a47226a7,0x255fa5ed247226a7,0x9fc627c3a70ea38b,0x26a72472a5a825a8,0xa7d99e3e221fa764,0xa2d7273ba6a7a472,0x1cb2a7ea27a820a5,0xa7a8a0a5221fa764,0x27f61a469e3e27d9,0x1cb2a7ea27d91e3e,0x964827fea7f69a46
.quad 0x8000a80000002800,0x8000a80080002800,0x27fe1648a8000000,0x27ea1cb2a7f69a46,0x9a4627f68000a800,0xa0a527a81e3ea7d9,0xa7ea9cb228008000,0xa73ba2d727a820a5,0x1e3ea7d980002800,0x2472a6a7a21f2764,0x27c31fc6a8000000,0x25ed255fa70ea38b,0xa0a527a88000a800,0xa62f25132472a6a7,0xa788a16428000000,0xa41da6dd262f2513
.quad 0x221fa76400002800,0x2764a21fa5a825a8,0x273b22d7a8000000,0x1fc627c3a513a62f,0xa38b270e8000a800,0xa7f61a4626a7a472,0xa6dda41d28008000,0x1648a7fe238b270e,0x2472a6a700002800,0x27d91e3ea764221f,0x266d24c4a8000000,0xa1642788a0a5a7a8,0xa513262f8000a800,0xa70ea38b27d99e3e,0xa5eda55f28000000,0x24c4a66d1a4627f6
.quad 0x25a8a5a800002800,0x25a825a8a8000000,0x255f25eda8000000,0xa66d24c41a46a7f6,0xa62f25138000a800,0xa38ba70e27d91e3e,0xa4c4a66d28000000,0x2788a164a0a527a8,0x26a7a47280002800,0x1e3e27d9a764a21f,0x241d26dda8000000,0xa7fe1648238ba70e,0xa70e238b8000a800,0x1a46a7f626a72472,0xa2d7a73b28008000,0x27c31fc6a513262f
.quad 0x2764a21f00002800,0xa21f2764a5a8a5a8,0x21642788a8008000,0xa6dda41d262fa513,0xa7a820a58000a800,0x2513a62f247226a7,0x9fc6a7c328008000,0x255f25eda70e238b,0x27d99e3e00002800,0xa6a72472a21fa764,0x1cb227eaa8000000,0xa2d7a73b27a8a0a5,0xa7f61a460000a800,0x27a8a0a51e3e27d9,0x9648a7fe28008000,0x1cb227eaa7f61a46
.quad 0x8000a80000002800,0x8000a80000002800,0x27c31fc6a7d99e3e,0x27882164a7a8a0a5,0xa38b270e221fa764,0xa513262f2472a6a7,0xa5eda55f26a72472,0xa41da6dd2513262f,0x26a7a472a5a825a8,0x27d99e3ea764221f,0x21642788a472a6a7,0x9cb227ea9a46a7f6,0xa7f61a462764a21f,0xa70ea38b27d91e3e,0x1cb2a7ea1e3e27d9,0x25eda55fa38b270e
.quad 0x2764221fa8000000,0x221f2764a5a8a5a8,0xa4c4266d1e3ea7d9,0xa7fe1648270ea38b,0xa513a62f2764221f,0x20a5a7a81e3e27d9,0x273ba2d7a47226a7,0x266d24c4a7f69a46,0x1e3e27d9a5a8a5a8,0xa6a72472221fa764,0xa7fe964826a7a472,0x9fc6a7c3262f2513,0x20a5a7a8221f2764,0x27f61a46a6a72472,0x26dd241da7d91e3e,0xa2d7273ba0a5a7a8
.quad 0xa5a825a88000a800,0xa5a8a5a828008000,0xa41da6dd27d91e3e,0x273ba2d7a0a527a8,0x27a8a0a5a21f2764,0x1a4627f6a6a7a472,0x164827fea6a7a472,0xa7c39fc6262fa513,0xa7d99e3e25a8a5a8,0x2472a6a7221f2764,0x22d7a73b247226a7,0x24c4266da7f61a46,0x262f2513a764221f,0xa7a820a51e3ea7d9,0xa66d24c49e3ea7d9,0x1648a7fe270e238b
.quad 0xa21fa76428008000,0x2764221fa5a825a8,0x27ea9cb29e3e27d9,0xa55f25eda38ba70e,0x9a4627f6a764a21f,0xa38ba70e27d99e3e,0xa788a1642472a6a7,0x27ea9cb29a4627f6,0x2472a6a725a825a8,0x9e3e27d9a764a21f,0x255f25eda6a72472,0xa6dda41d2513a62f,0xa70e238ba21fa764,0x262fa513247226a7,0x9fc6a7c327d99e3e,0x21642788a7a820a5
.quad 0x8000a80000002800,0x8000a80080002800,0x273b22d7a764a21f,0x26dd241da70ea38b,0xa62f251325a8a5a8,0xa70e238b26a7a472,0x9fc6a7c3221f2764,0x1648a7fe1a4627f6,0x27d91e3ea8000000,0x26a72472a764a21f,0xa4c4266d221fa764,0xa73b22d7262fa513,0xa38ba70e25a825a8,0x1a46a7f61e3e27d9,0x27fe9648a764221f,0x266d24c4a7a8a0a5
.quad 0xa21f27648000a800,0xa764221f25a8a5a8,0xa55fa5ed2764221f,0x1cb2a7ea20a527a8,0x27a8a0a5a5a825a8,0x262f2513a7d99e3e,0x9cb227eaa21fa764,0xa78821642513a62f,0xa6a7a47228008000,0x1e3ea7d9221f2764,0x26dda41da21f2764,0x25ed255fa7f69a46,0x1a4627f6a5a8a5a8,0xa7a820a52472a6a7,0xa788a1642764a21f,0x1fc6a7c3238b270e
.quad 0x25a8a5a880002800,0x25a825a8a8008000,0x21642788a764a21f,0xa7c31fc6238ba70e,0xa7f69a4625a8a5a8,0x20a5a7a8247226a7,0x241da6dd221f2764,0x255f25eda7f61a46,0x247226a7a8008000,0xa7d91e3e221fa764,0xa7ea1cb2221fa764,0x2164a7882513262f,0x20a5a7a825a825a8,0x2513262fa7d91e3e,0x25ed255fa764221f,0xa7ea1cb220a5a7a8
.quad 0xa764221f8000a800,0x221fa76425a825a8,0x1648a7fe2764221f,0x24c4266da7a820a5,0x270e238ba5a825a8,0xa7f61a461e3ea7d9,0xa66d24c4a21fa764,0x22d7a73b262f2513,0x9e3ea7d928008000,0x247226a7a764221f,0x27c31fc6a21f2764,0xa7fe16481a46a7f6,0xa513262fa5a8a5a8,0x238ba70e26a72472,0xa2d7a73b2764a21f,0x241d26dda70e238b
.quad 0x8000a80000002800,0xa80000002800,0x266d24c4a6a7a472,0x25ed255fa62fa513,0xa7a820a52764a21f,0xa7f61a4627d99e3e,0x2164a7889e3e27d9,0x24c4a66da38b270e,0x247226a7a5a8a5a8,0x1e3e27d9a21fa764,0xa7fe964827d99e3e,0xa6dda41d27a820a5,0x2513a62fa21f2764,0x27a8a0a5a6a72472,0x1fc627c3a472a6a7,0xa2d7273b1a46a7f6
.quad 0xa764a21f28000000,0xa21fa76425a825a8,0x26dda41da47226a7,0x27882164a7f61a46,0x9a4627f6a21fa764,0xa70e238b2472a6a7,0xa5eda55f27d91e3e,0x1fc6a7c320a527a8,0x27d99e3ea5a825a8,0x247226a7a764a21f,0xa2d7273b9e3ea7d9,0xa7ea9cb2270ea38b,0xa38ba70e2764221f,0x262fa5139e3e27d9,0x27ea1cb2a6a72472,0x964827fea513a62f
.quad 0xa5a825a80000a800,0xa5a8a5a828000000,0x9cb2a7ea26a72472,0x27fe9648a513262f,0x270e238ba764221f,0xa513262f9e3ea7d9,0xa73b22d71e3ea7d9,0x9cb2a7ea270e238b,0x1e3ea7d925a825a8,0x26a72472a764221f,0x255f25eda7d91e3e,0xa7c31fc620a5a7a8,0xa7f61a46221fa764,0x238ba70e247226a7,0x241da6dd247226a7,0x21642788a7f69a46
.quad 0x221f2764a8000000,0xa764a21f25a8a5a8,0xa7c39fc62472a6a7,0x273ba2d71a4627f6,0x262fa513221f2764,0xa0a527a8a6a7a472,0x164827fea7d99e3e,0xa41da6dd27a8a0a5,0xa6a7a47225a8a5a8,0x27d91e3ea21f2764,0x2788a1641e3e27d9,0xa66d24c4a38ba70e,0xa0a527a8a764a21f,0x1a46a7f627d91e3e,0xa4c4a66d26a7a472,0x255f25eda62f2513
.quad 0x8000a80000002800,0x8000a80080002800,0x255f25eda5a8a5a8,0x24c4266da513a62f,0xa7f69a4628000000,0xa7a8a0a527d91e3e,0x266da4c4a5a825a8,0x2788a164a70e238b,0x9e3e27d90000a800,0xa47226a7221fa764,0xa41da6dd25a825a8,0x9648a7fe20a527a8,0x27a820a5a8008000,0x2513262fa6a7a472,0xa73b22d725a8a5a8,0xa7c39fc627f69a46
.quad 0x221fa76400002800,0x2764a21fa5a825a8,0x21642788a5a8a5a8,0xa41d26dd1a46a7f6,0xa70ea38b28008000,0x9a46a7f6247226a7,0x27c39fc6a5a825a8,0x255f25eda7a8a0a5,0xa47226a78000a800,0xa7d99e3e2764a21f,0x9cb2a7ea25a825a8,0x273ba2d7a38b270e,0x262f2513a8000000,0xa38b270e9e3ea7d9,0xa7fe164825a8a5a8,0x9cb2a7ea262f2513
.quad 0x25a8a5a800002800,0x25a825a8a8000000,0x964827fea5a8a5a8,0xa7ea9cb2262fa513,0xa513a62f28008000,0x270ea38b9e3e27d9,0x27ea1cb2a5a825a8,0xa2d7273ba38ba70e,0xa6a724720000a800,0x9e3ea7d92764221f,0x1fc6a7c325a825a8,0x25ed255fa7a820a5,0x238b270ea8000000,0xa7f69a462472a6a7,0xa788a16425a8a5a8,0x26dda41d1a4627f6
.quad 0x2764a21f00002800,0xa21f2764a5a8a5a8,0xa2d7273ba5a8a5a8,0x9fc6a7c327f61a46,0xa0a5a7a828000000,0x262f2513a6a72472,0x26dd241da5a825a8,0xa7fe964820a5a7a8,0xa7d91e3e8000a800,0x26a7a472221f2764,0x24c4a66d25a825a8,0xa1642788a70ea38b,0x1a4627f6a8008000,0xa0a5a7a827d99e3e,0xa5eda55f25a8a5a8,0x266d24c4a513262f
.quad 0x8000a80080002800,0xa80000002800,0x241d26dda472a6a7,0x22d7273ba38ba70e,0xa70ea38b2764221f,0xa62fa51326a72472,0x27fe9648a7d91e3e,0x27c31fc6a7f69a46,0xa6a7247225a8a5a8,0xa7d91e3e2764a21f,0x22d7a73b9e3e27d9,0x266da4c4a513262f,0x1a4627f6a21fa764,0xa38b270e1e3ea7d9,0xa4c4a66d26a72472,0x1648a7fe20a527a8
.quad 0x2764221fa8000000,0x221f2764a5a8a5a8,0xa7ea1cb226a7a472,0xa5eda55f27a820a5,0x262fa513a21f2764,0x27a820a5a7d91e3e,0xa16427889e3ea7d9,0xa7ea1cb2262fa513,0x9e3ea7d925a825a8,0x26a7a472a21f2764,0x255f25eda7d99e3e,0xa41d26dd9a46a7f6,0xa7a8a0a52764a21f,0x1a46a7f6247226a7,0x27c39fc6a47226a7,0x21642788a70ea38b
.quad 0xa5a825a88000a800,0xa5a8a5a828008000,0x1fc6a7c3247226a7,0x27882164a70e238b,0x20a527a8a764a21f,0xa7f61a462472a6a7,0xa5eda55f27d99e3e,0x26dda41d9a4627f6,0x27d91e3ea5a825a8,0xa47226a7a21fa764,0xa78821641e3ea7d9,0x1cb2a7ea262f2513,0x2513a62f221f2764,0x20a527a8a7d99e3e,0x9cb227eaa6a7a472,0xa55fa5ed27a8a0a5
.quad 0xa21fa76428008000,0x2764221fa5a825a8,0x266d24c4a6a72472,0xa7fe164820a5a7a8,0xa7f69a46221fa764,0x270ea38b1e3e27d9,0x273ba2d71e3e27d9,0xa4c4266da513a62f,0xa47226a7a5a8a5a8,0x1e3ea7d92764221f,0x1648a7fe27d91e3e,0x1fc627c3a7f61a46,0x238b270ea764221f,0xa513a62f26a7a472,0xa6dda41d2472a6a7,0x273b22d7a38b270e
.quad 0x8000a80000002800,0x8000a80080002800,0x21642788a21fa764,0x1fc627c3a0a5a7a8,0xa513a62f25a825a8,0xa38ba70e247226a7,0x26dd241da764a21f,0x255f25eda62fa513,0xa7d99e3e28000000,0xa6a7a4722764221f,0x27ea9cb2a764221f,0x27882164a7f69a46,0xa70e238b25a8a5a8,0xa7f69a4627d99e3e,0x255fa5eda21f2764,0x27ea9cb2a70e238b
.quad 0xa21f27640000a800,0xa764221f25a8a5a8,0x1648a7fe221f2764,0x266da4c4a38b270e,0x20a527a8a5a8a5a8,0xa513262f1e3ea7d9,0xa4c4a66d2764221f,0x22d7a73b1a4627f6,0x26a72472a8000000,0x9e3e27d9a21fa764,0xa7c39fc62764a21f,0x9648a7fe2513262f,0x27f69a46a5a825a8,0x20a527a8a6a7a472,0xa73b22d7221fa764,0xa41da6dd27a820a5
.quad 0x25a8a5a800002800,0x25a825a8a8000000,0xa2d7273ba21fa764,0xa6dda41d27a8a0a5,0x1a46a7f625a825a8,0x27a820a5a6a72472,0x1fc627c3a764a21f,0xa7fe96482513a62f,0xa472a6a728000000,0x27d99e3ea21f2764,0x266d24c4a764221f,0xa73b22d71a46a7f6,0xa7a8a0a525a8a5a8,0x262fa5131e3e27d9,0x27fe9648a21f2764,0xa4c4266da38ba70e
.quad 0xa764221f8000a800,0x221fa76425a825a8,0x25eda55f221f2764,0x9cb227eaa70ea38b,0xa38b270ea5a8a5a8,0x9a46a7f627d91e3e,0x1cb2a7ea2764221f,0x21642788a7f61a46,0x1e3e27d9a8000000,0xa472a6a72764a21f,0xa41da6dd2764a21f,0x25ed255fa62f2513,0x262f2513a5a825a8,0xa70ea38b2472a6a7,0xa788a164221fa764,0x27c31fc6a0a527a8
.quad 0x8000a80000002800,0xa80000002800,0x1cb227ea9e3ea7d9,0x164827fe9a46a7f6,0xa0a5a7a8221f2764,0x9a46a7f61e3e27d9,0x22d7273ba472a6a7,0x1cb227eaa0a5a7a8,0xa472a6a725a825a8,0x9e3ea7d9221f2764,0x255f25eda6a7a472,0x1fc627c3a38ba70e,0xa62fa5132764221f,0xa0a5a7a8247226a7,0x26dd241da7d99e3e,0x21642788a513a62f
.quad 0xa764a21f28008000,0xa21fa76425a825a8,0x27c31fc6a7d91e3e,0x22d7273ba62fa513,0xa7f69a462764a21f,0xa38ba70e26a72472,0x27fe9648a6a72472,0x241d26dda70ea38b,0xa7d91e3e25a8a5a8,0xa472a6a72764221f,0x2788a164a47226a7,0x24c4266da7a8a0a5,0xa70e238b221fa764,0xa513a62f27d91e3e,0x266da4c49e3e27d9,0x255f25eda7f69a46
.quad 0xa5a825a88000a800,0xa5a8a5a828008000,0x24c4a66d1e3e27d9,0x25ed255fa7f61a46,0xa38b270ea21fa764,0xa62fa51327d99e3e,0x2164a788247226a7,0x266d24c4a7a820a5,0x9e3e27d9a5a8a5a8,0xa6a7a4722764a21f,0x1648a7fe26a72472,0x26dd241da70e238b,0x1a4627f6a764a21f,0xa70ea38b26a7a472,0x9fc6a7c327d91e3e,0x273b22d7a62f2513
.quad 0x221f2764a8000000,0xa764a21f25a8a5a8,0xa41da6dd27d99e3e,0x27882164a513262f,0x2513262fa764221f,0xa7a8a0a52472a6a7,0xa5eda55f26a7a472,0x27c31fc6a38b270e,0x26a72472a5a825a8,0xa7d99e3e221fa764,0xa73ba2d72472a6a7,0x27ea1cb2a0a527a8,0x27a820a5a21f2764,0xa7f69a461e3ea7d9,0xa7ea9cb21e3ea7d9,0x27fe16489a4627f6
.quad 0x2800800028002800,0xa80000008000a800,0x27fe1648a8002800,0xa7ea9cb21a46a7f6,0x27f61a4628002800,0xa7a8a0a51e3ea7d9,0x27ea1cb2a8002800,0xa73ba2d720a5a7a8,0x27d91e3e28002800,0xa6a7a472221fa764,0x27c31fc6a8002800,0xa5eda55f238ba70e,0x27a820a528002800,0xa513a62f2472a6a7,0x27882164a8002800,0xa41da6dd2513a62f
.quad 0x2764221f28002800,0xa21fa76425a8a5a8,0x273b22d7a8002800,0x9fc6a7c3262fa513,0x270e238b28002800,0x9a46a7f626a7a472,0x26dd241da8002800,0x1648a7fe270ea38b,0x26a7247228002800,0x1e3ea7d92764a21f,0x266d24c4a8002800,0x2164a78827a8a0a5,0x262f251328002800,0x238ba70e27d99e3e,0x25ed255fa8002800,0x24c4a66d27f69a46
.quad 0x25a825a828002800,0x25a8a5a828008000,0x255f25eda8002800,0x266da4c427f61a46,0x2513262f28002800,0x270ea38b27d91e3e,0x24c4266da8002800,0x2788a16427a820a5,0x247226a728002800,0x27d99e3e2764221f,0x241d26dda8002800,0x27fe9648270e238b,0x238b270e28002800,0x27f61a4626a72472,0x22d7273ba8002800,0x27c31fc6262f2513
.quad 0x221f276428002800,0x2764221f25a825a8,0x21642788a8002800,0x26dd241d2513262f,0x20a527a828002800,0x262f2513247226a7,0x1fc627c3a8002800,0x255f25ed238b270e,0x1e3e27d928002800,0x247226a7221f2764,0x1cb227eaa8002800,0x22d7273b20a527a8,0x1a4627f628002800,0x20a527a81e3e27d9,0x164827fea8002800,0x1cb227ea1a4627f6
.quad 0x2800800000002800,0xa80080008000a800,0x27c31fc69e3e27d9,0xa788a16420a5a7a8,0x270e238ba21f2764,0xa62fa5132472a6a7,0x25ed255fa47226a7,0xa41da6dd262fa513,0x247226a7a5a825a8,0x9e3ea7d92764a21f,0x21642788a6a72472,0x1cb2a7ea27f69a46,0x1a4627f6a764221f,0x238ba70e27d91e3e,0x9cb227eaa7d91e3e,0x25eda55f270e238b
.quad 0xa21f2764a8008000,0x2764a21f25a825a8,0xa4c4266da7d99e3e,0x27fe9648238b270e,0xa62f2513a764a21f,0x27a820a51e3e27d9,0xa73b22d7a6a7a472,0x266d24c49a4627f6,0xa7d91e3ea5a8a5a8,0x247226a7a21f2764,0xa7fe9648a472a6a7,0x1fc627c3a513262f,0xa7a8a0a5a21fa764,0x9a4627f6a6a72472,0xa6dda41d9e3ea7d9,0xa2d7273ba7a820a5
.quad 0xa5a8a5a88000a800,0xa5a825a8a8008000,0xa41da6dd1e3ea7d9,0xa73b22d7a7a8a0a5,0xa0a5a7a8221fa764,0xa7f61a46a6a7a472,0x9648a7fe2472a6a7,0xa7c39fc6a513a62f,0x1e3ea7d925a8a5a8,0xa6a7a472a21fa764,0x22d7a73b26a7a472,0xa4c4a66d9a46a7f6,0x2513a62f2764a21f,0xa0a5a7a81e3ea7d9,0x266da4c427d99e3e,0x1648a7fe238ba70e
.quad 0x2764a21f28008000,0x221fa76425a8a5a8,0x27ea9cb227d91e3e,0x255fa5ed270ea38b,0x27f61a462764221f,0x270ea38b27d99e3e,0x2788216426a72472,0x27ea9cb227f61a46,0x26a7247225a825a8,0x27d91e3e2764221f,0x255f25ed247226a7,0x26dd241d262f2513,0x238b270e221f2764,0x2513262f247226a7,0x1fc627c31e3e27d9,0x2164278820a527a8
.quad 0x2800800000002800,0xa80000008000a800,0x273b22d7a21f2764,0xa6dda41d238ba70e,0x2513262fa5a825a8,0xa38ba70e26a7a472,0x1fc627c3a764221f,0x1648a7fe27f69a46,0x9e3e27d9a8008000,0x2472a6a72764221f,0xa4c4266da764a21f,0x273ba2d72513262f,0xa70e238ba5a8a5a8,0x27f61a461e3e27d9,0xa7fe1648a21fa764,0x266d24c4a0a527a8
.quad 0xa764a21f0000a800,0x221f2764a5a825a8,0xa55fa5ed221fa764,0x9cb227eaa7a820a5,0xa0a5a7a825a8a5a8,0xa513262fa7d99e3e,0x1cb2a7ea2764a21f,0xa7882164a62fa513,0x2472a6a728008000,0xa7d99e3ea21fa764,0x26dda41d2764221f,0xa5eda55f1a46a7f6,0x27f69a4625a825a8,0xa0a5a7a82472a6a7,0x27882164221f2764,0x1fc6a7c3270ea38b
.quad 0x25a825a800002800,0x25a8a5a828008000,0x21642788a21f2764,0x27c39fc6270e238b,0x9a4627f6a5a825a8,0x27a820a5247226a7,0xa41d26dda764221f,0x255f25ed1a4627f6,0xa6a72472a8008000,0x1e3e27d9a21f2764,0xa7ea1cb2a764a21f,0xa1642788a62f2513,0xa7a8a0a5a5a8a5a8,0xa62f2513a7d91e3e,0xa5eda55fa21fa764,0xa7ea1cb2a7a8a0a5
.quad 0xa21fa7648000a800,0xa764a21fa5a8a5a8,0x1648a7fe221fa764,0xa4c4a66da0a5a7a8,0x238ba70e25a8a5a8,0x9a46a7f61e3ea7d9,0x266da4c42764a21f,0x22d7a73b2513a62f,0x27d99e3e28008000,0x26a7a4722764a21f,0x27c31fc62764221f,0x27fe964827f61a46,0x262f251325a825a8,0x270e238b26a72472,0x22d7273b221f2764,0x241d26dd238b270e
.quad 0x2800800000002800,0xa80000000000a800,0x266d24c4a47226a7,0xa5eda55f2513a62f,0x20a527a8a764221f,0x9a46a7f627d99e3e,0xa1642788a7d99e3e,0x24c4a66d270e238b,0xa6a72472a5a8a5a8,0x27d99e3e221f2764,0xa7fe96489e3ea7d9,0x26dd241da0a527a8,0xa62fa513221fa764,0x20a527a8a6a72472,0x9fc6a7c326a7a472,0xa2d7273ba7f69a46
.quad 0x221fa76428000000,0xa764221fa5a8a5a8,0x26dda41d26a72472,0xa788a1649a46a7f6,0x27f61a46221f2764,0xa38ba70e2472a6a7,0x25ed255f9e3e27d9,0x1fc6a7c327a8a0a5,0x1e3e27d9a5a825a8,0x26a7a4722764221f,0xa2d7273ba7d91e3e,0x27ea1cb2238b270e,0xa70e238ba764a21f,0x2513262f9e3e27d9,0xa7ea9cb2a472a6a7,0x964827fea62f2513
.quad 0xa5a8a5a80000a800,0xa5a825a8a8000000,0x9cb2a7ea2472a6a7,0xa7fe1648a62fa513,0x238ba70e2764a21f,0xa62fa5139e3ea7d9,0x273ba2d727d91e3e,0x9cb2a7ea238ba70e,0x27d91e3e25a825a8,0x2472a6a72764a21f,0x255f25ed1e3e27d9,0x27c39fc627a820a5,0x1a4627f6a21f2764,0x270e238b247226a7,0xa41d26dda6a72472,0x216427889a4627f6
.quad 0xa764221fa8000000,0xa21f2764a5a825a8,0xa7c39fc6a6a7a472,0xa73b22d7a7f61a46,0xa513a62fa21fa764,0xa7a8a0a5a6a7a472,0x9648a7fe1e3ea7d9,0xa41da6dda0a5a7a8,0x2472a6a725a8a5a8,0x1e3ea7d9221fa764,0x2788a16427d99e3e,0x266da4c4270ea38b,0x27a820a52764221f,0x27f61a4627d91e3e,0x24c4266d247226a7,0x255f25ed2513262f
.quad 0x2800800000002800,0xa80000008000a800,0x255f25eda5a825a8,0xa4c4a66d262fa513,0x9a4627f6a8000000,0x20a5a7a827d91e3e,0xa66d24c4a5a8a5a8,0x2788a164238b270e,0xa7d99e3e0000a800,0x26a72472a21f2764,0xa41da6dd25a8a5a8,0x164827fea7a820a5,0x20a5a7a828008000,0xa62f2513a6a7a472,0x273ba2d725a825a8,0xa7c39fc69a46a7f6
.quad 0x2764221f80002800,0xa21fa76425a8a5a8,0x21642788a5a825a8,0x241da6dd27f61a46,0xa38b270ea8000000,0x27f69a46247226a7,0xa7c31fc6a5a8a5a8,0x255f25eda0a527a8,0xa6a7a4728000a800,0x9e3e27d9a764221f,0x9cb2a7ea25a8a5a8,0xa73b22d7a70ea38b,0x2513a62f28000000,0xa70ea38b9e3ea7d9,0x27fe964825a825a8,0x9cb2a7ea2513a62f
.quad 0x25a825a800002800,0x25a8a5a828000000,0x964827fea5a825a8,0x27ea1cb22513262f,0xa62f2513a8000000,0x238b270e9e3e27d9,0xa7ea9cb2a5a8a5a8,0xa2d7273ba70e238b,0xa472a6a70000a800,0xa7d91e3ea764a21f,0x1fc6a7c325a8a5a8,0xa5eda55fa0a5a7a8,0x270ea38b28008000,0x1a46a7f62472a6a7,0x2788216425a825a8,0x26dda41d27f69a46
.quad 0x221f276400002800,0x2764221f25a825a8,0xa2d7273ba5a825a8,0x1fc627c39a4627f6,0xa7a820a5a8000000,0xa513262fa6a72472,0xa6dda41da5a8a5a8,0xa7fe9648a7a8a0a5,0x9e3ea7d98000a800,0xa472a6a7a21fa764,0x24c4a66d25a8a5a8,0x2164a788238ba70e,0x27f69a4628000000,0x27a8a0a527d99e3e,0x25ed255f25a825a8,0x266d24c4262f2513
.quad 0x2800000000002800,0xa80000008000a800,0x241d26dda6a72472,0xa2d7a73b270ea38b,0xa38b270ea764a21f,0x2513a62f26a72472,0xa7fe16489e3ea7d9,0x27c31fc69a4627f6,0xa472a6a725a8a5a8,0x1e3e27d9a764221f,0x22d7a73b27d91e3e,0xa66d24c4a62fa513,0x27f69a46221f2764,0xa70ea38b1e3ea7d9,0x24c4266da47226a7,0x1648a7fe27a8a0a5
.quad 0xa21f2764a8008000,0x2764a21f25a825a8,0xa7ea1cb2a472a6a7,0x25ed255fa0a527a8,0xa513a62f221fa764,0xa0a527a8a7d91e3e,0x2164a78827d99e3e,0xa7ea1cb2a513a62f,0x27d99e3e25a825a8,0xa472a6a7221fa764,0x255f25ed9e3e27d9,0x241da6dd27f69a46,0xa0a527a8a764221f,0x27f61a46247226a7,0xa7c31fc6a6a7a472,0x21642788a38b270e
.quad 0xa5a8a5a88000a800,0xa5a825a8a8000000,0x1fc6a7c326a7a472,0xa788a164a38ba70e,0x27a8a0a52764221f,0x9a46a7f62472a6a7,0x25ed255f1e3e27d9,0x26dda41d27f61a46,0x9e3e27d9a5a825a8,0x26a72472221f2764,0xa7882164a7d99e3e,0x9cb227eaa513262f,0xa62fa513a21fa764,0xa7a820a5a7d99e3e,0x1cb2a7ea2472a6a7,0xa55fa5eda0a5a7a8
.quad 0x2764a21f28008000,0x221fa76425a8a5a8,0x266d24c4247226a7,0x27fe964827a820a5,0x9a4627f6a21f2764,0x238b270e1e3e27d9,0xa73b22d7a7d91e3e,0xa4c4266da62f2513,0xa6a7a472a5a8a5a8,0xa7d99e3ea764a21f,0x1648a7fe1e3ea7d9,0x9fc6a7c39a46a7f6,0x270ea38b2764a21f,0x262fa51326a7a472,0x26dd241d26a72472,0x273b22d7270e238b
.quad 0x2800800000002800,0xa80000008000a800,0x21642788a764221f,0x9fc6a7c327a8a0a5,0xa62f2513a5a8a5a8,0x270ea38b247226a7,0xa6dda41d221fa764,0x255f25eda513262f,0x1e3ea7d928008000,0xa47226a7a764a21f,0x27ea9cb2221f2764,0xa788a1641a46a7f6,0x238b270ea5a825a8,0x1a46a7f627d99e3e,0xa55f25eda764a21f,0x27ea9cb2238b270e
.quad 0xa764a21f0000a800,0x221f2764a5a825a8,0x1648a7fe2764a21f,0xa66d24c4a70ea38b,0x27a8a0a525a825a8,0xa62fa5131e3ea7d9,0x24c4266da21f2764,0x22d7a73b27f69a46,0xa47226a7a8000000,0x27d91e3e221f2764,0xa7c39fc6a21fa764,0x164827fea62f2513,0x9a46a7f625a8a5a8,0xa7a820a5a6a7a472,0x273ba2d72764221f,0xa41da6dd20a5a7a8
.quad 0x25a825a880002800,0x25a8a5a828008000,0xa2d7273ba764221f,0x26dd241d20a527a8,0xa7f69a46a5a8a5a8,0xa0a527a8a6a72472,0x9fc6a7c3221fa764,0xa7fe9648a62fa513,0x26a7a47228008000,0x9e3ea7d9221fa764,0x266d24c4221f2764,0x273ba2d727f61a46,0xa0a527a8a5a825a8,0x2513262f1e3e27d9,0xa7fe1648a764a21f,0xa4c4266da70e238b
.quad 0xa21fa7648000a800,0xa764a21fa5a8a5a8,0x25eda55f2764a21f,0x1cb2a7ea238ba70e,0x270e238b25a825a8,0x27f69a4627d91e3e,0x9cb227eaa21f2764,0x216427881a4627f6,0xa7d91e3ea8000000,0xa6a72472a764221f,0xa41da6dda21fa764,0xa5eda55fa513a62f,0x2513a62f25a8a5a8,0x238ba70e2472a6a7,0x278821642764221f,0x27c31fc627a820a5
.quad 0x2800800080002800,0xa80000008000a800,0x1cb227eaa7d91e3e,0x9648a7fe27f69a46,0xa7a820a5a21fa764,0x27f69a461e3e27d9,0xa2d7a73b26a7a472,0x1cb227eaa7a820a5,0x26a7a47225a825a8,0xa7d91e3ea21fa764,0x255f25eda47226a7,0x9fc6a7c3270ea38b,0xa513262fa764a21f,0x27a8a0a5247226a7,0xa6dda41d1e3ea7d9,0x21642788a62f2513
.quad 0x221fa76428000000,0xa764221fa5a8a5a8,0x27c31fc61e3e27d9,0xa2d7a73b2513a62f,0x9a4627f6a764221f,0x270ea38b26a72472,0xa7fe1648a472a6a7,0x241d26dda38b270e,0x9e3ea7d925a8a5a8,0xa6a72472a764a21f,0x2788a16426a72472,0xa4c4a66d20a5a7a8,0x238b270ea21f2764,0x262fa51327d91e3e,0xa66d24c4a7d99e3e,0x255f25ed9a4627f6
.quad 0xa5a8a5a88000a800,0xa5a825a8a8008000,0x24c4a66d27d99e3e,0xa5eda55f9a46a7f6,0x270e238b221f2764,0x2513a62f27d99e3e,0xa1642788a6a72472,0x266d24c420a527a8,0xa7d99e3ea5a8a5a8,0xa47226a7a764221f,0x1648a7fe2472a6a7,0xa6dda41da38ba70e,0x27f69a462764221f,0x238ba70e26a7a472,0x1fc627c39e3e27d9,0x273b22d72513262f
.quad 0xa764221fa8000000,0xa21f2764a5a825a8,0xa41da6dd9e3ea7d9,0xa788a164a62fa513,0x262fa5132764a21f,0x20a5a7a82472a6a7,0x25ed255f247226a7,0x27c31fc6270e238b,0xa47226a7a5a825a8,0x9e3e27d9a21f2764,0xa73ba2d7a6a7a472,0xa7ea9cb2a7a8a0a5,0x20a5a7a8221fa764,0x1a46a7f61e3ea7d9,0x27ea1cb227d91e3e,0x27fe164827f61a46
.quad 0x2800000000002800,0xa80080008000a800,0x964827fea8000000,0x1cb2a7ea27f61a46,0xa7f69a468000a800,0x27a820a59e3e27d9,0x1cb2a7ea28000000,0xa2d7273ba7a8a0a5,0x27d91e3e80002800,0xa6a7a472221fa764,0x9fc627c3a8000000,0x255fa5ed270e238b,0xa7a8a0a58000a800,0x2513262fa47226a7,0x2164a78828008000,0xa6dd241da62fa513
.quad 0x2764221f80002800,0xa21fa76425a8a5a8,0xa2d7273ba8008000,0x27c39fc62513262f,0xa70ea38b8000a800,0x1a4627f6a6a72472,0x241da6dd28008000,0xa7fe9648a38ba70e,0x26a7247200002800,0x1e3ea7d92764a21f,0xa4c4266da8000000,0x2788216420a527a8,0xa62fa5130000a800,0xa38b270ea7d91e3e,0x255fa5ed28008000,0xa66da4c49a46a7f6
.quad 0x25a825a800002800,0x25a8a5a828008000,0xa5ed255fa8000000,0x24c4266d9a4627f6,0xa513a62f8000a800,0xa70e238ba7d99e3e,0x266da4c428000000,0xa164a78820a5a7a8,0x247226a780002800,0x27d99e3e2764221f,0xa6dd241da8000000,0x164827fea38b270e,0xa38ba70e8000a800,0xa7f69a46a6a7a472,0x273ba2d728008000,0x1fc6a7c32513a62f
.quad 0x221f276400002800,0x2764221f25a825a8,0xa7882164a8008000,0xa41d26dda62f2513,0xa0a5a7a88000a800,0xa62fa513a472a6a7,0x27c39fc628008000,0x25eda55f270ea38b,0x1e3e27d900002800,0x247226a7221f2764,0xa7ea1cb2a8000000,0xa73b22d7a7a820a5,0x9a46a7f60000a800,0xa0a5a7a89e3ea7d9,0x27fe964828008000,0x27ea9cb227f69a46
.quad 0x2800800000002800,0xa80000008000a800,0x9fc627c3a7d99e3e,0x2164a78827a820a5,0xa70ea38b221fa764,0x262f2513a47226a7,0x255fa5ed26a72472,0xa6dd241da513a62f,0x247226a7a5a825a8,0x9e3ea7d92764a21f,0xa7882164a472a6a7,0x27ea1cb21a4627f6,0x9a46a7f62764a21f,0xa38b270ea7d99e3e,0x27ea1cb21e3e27d9,0xa55fa5ed238ba70e
.quad 0xa21f2764a8000000,0x2764a21f25a825a8,0xa66da4c41e3ea7d9,0x164827fea70e238b,0x262fa5132764221f,0xa7a8a0a59e3ea7d9,0x22d7273ba47226a7,0x24c4a66d27f61a46,0xa7d91e3ea5a8a5a8,0x247226a7a21f2764,0x1648a7fe26a7a472,0xa7c31fc6a62fa513,0x27a820a5221f2764,0x1a46a7f626a7a472,0xa41d26dda7d91e3e,0x273b22d720a527a8
.quad 0xa5a8a5a80000a800,0xa5a825a8a8000000,0x26dda41d27d91e3e,0xa2d7a73b20a5a7a8,0x20a527a8a21f2764,0x27f69a4626a72472,0xa7fe1648a6a7a472,0x9fc627c3a62f2513,0x1e3ea7d925a8a5a8,0xa6a7a472a21fa764,0x273b22d7247226a7,0x266da4c427f69a46,0xa513262fa764221f,0x20a527a89e3e27d9,0xa4c4a66d9e3ea7d9,0xa7fe9648a70ea38b
.quad 0x2764a21f28008000,0x221fa76425a8a5a8,0x1cb227ea9e3e27d9,0x25ed255f238b270e,0xa7f69a46a764a21f,0xa70e238ba7d91e3e,0x2164a7882472a6a7,0x9cb2a7ea1a46a7f6,0x26a7247225a825a8,0x27d91e3e2764221f,0xa5ed255fa6a72472,0xa41d26dda513262f,0xa38ba70ea21fa764,0xa513a62fa472a6a7,0x27c39fc627d99e3e,0x2788a16427a8a0a5
.quad 0x2800800000002800,0xa80000000000a800,0xa2d7273ba764a21f,0x241da6dd270e238b,0xa513a62f25a8a5a8,0x238b270ea6a72472,0x27c39fc6221f2764,0xa7fe96489a46a7f6,0x9e3e27d9a8008000,0x2472a6a72764221f,0xa66da4c4221fa764,0x22d7273ba62f2513,0x270ea38b25a825a8,0xa7f69a469e3ea7d9,0x164827fea764221f,0x24c4a66d27a820a5
.quad 0xa764a21f0000a800,0x221f2764a5a825a8,0x25eda55f2764221f,0xa7ea9cb2a0a5a7a8,0x20a527a8a5a825a8,0x2513a62f27d91e3e,0xa7ea9cb2a21fa764,0x21642788a513262f,0x2472a6a728008000,0xa7d99e3ea21fa764,0x241d26dda21f2764,0x255fa5ed27f61a46,0xa7f61a46a5a8a5a8,0x20a527a8a47226a7,0x2164a7882764a21f,0xa7c39fc6a38ba70e
.quad 0x25a825a800002800,0x25a8a5a828000000,0xa7882164a764a21f,0x1fc627c3a38b270e,0x1a46a7f625a8a5a8,0xa7a8a0a5a472a6a7,0x26dd241d221f2764,0x25eda55f27f69a46,0xa6a72472a8008000,0x1e3e27d9a21f2764,0x9cb2a7ea221fa764,0xa788a164a513a62f,0x27a820a525a825a8,0x262fa51327d99e3e,0xa55f25eda764221f,0x1cb227eaa0a527a8
.quad 0xa21fa7648000a800,0xa764a21fa5a8a5a8,0x27fe16482764221f,0x266da4c427a8a0a5,0xa38b270ea5a825a8,0x1a4627f69e3e27d9,0xa4c4a66da21fa764,0xa73ba2d7a62fa513,0x27d99e3e28008000,0x26a7a4722764a21f,0x9fc627c3a21f2764,0x164827fe9a4627f6,0xa62fa513a5a8a5a8,0xa70ea38ba6a7a472,0x273ba2d72764a21f,0x26dda41d270ea38b
.quad 0x2800800000002800,0xa80000008000a800,0xa4c4266da6a7a472,0x255fa5ed262f2513,0xa0a5a7a82764a21f,0x1a4627f6a7d91e3e,0x278821649e3e27d9,0xa66da4c4238ba70e,0xa6a72472a5a8a5a8,0x27d99e3e221f2764,0x1648a7fe27d99e3e,0xa41d26dda7a8a0a5,0x262f2513a21f2764,0xa0a5a7a826a7a472,0xa7c31fc6a472a6a7,0x273b22d79a4627f6
.quad 0x221fa76428000000,0xa764221fa5a8a5a8,0x241d26dda47226a7,0x2164a78827f69a46,0xa7f69a46a21fa764,0x238b270ea47226a7,0x255fa5ed27d91e3e,0xa7c39fc6a0a5a7a8,0x1e3e27d9a5a825a8,0x26a7a4722764221f,0xa73ba2d79e3ea7d9,0x9cb227eaa70e238b,0x270ea38b2764221f,0xa513a62f1e3ea7d9,0x9cb227eaa6a72472,0x27fe16482513262f
.quad 0xa5a8a5a88000a800,0xa5a825a8a8000000,0x27ea9cb226a72472,0x9648a7fe2513a62f,0xa38b270ea764221f,0x262f25131e3e27d9,0xa2d7a73b1e3ea7d9,0xa7ea1cb2a70ea38b,0x27d91e3e25a825a8,0x2472a6a72764a21f,0xa5ed255fa7d91e3e,0x1fc627c3a0a527a8,0x9a46a7f6221fa764,0xa70ea38ba472a6a7,0x26dd241d247226a7,0x2788a16427f61a46
.quad 0xa764221fa8000000,0xa21f2764a5a825a8,0x1fc6a7c32472a6a7,0xa2d7a73b9a46a7f6,0x2513262f221f2764,0x27a820a526a72472,0xa7fe1648a7d99e3e,0xa6dd241da7a820a5,0x2472a6a725a8a5a8,0x1e3ea7d9221fa764,0x216427881e3e27d9,0x24c4266d238b270e,0xa7a8a0a5a764a21f,0xa7f69a46a7d99e3e,0x266da4c426a7a472,0x25eda55f262fa513
.quad 0x2800000000002800,0xa80000008000a800,0xa5ed255fa5a8a5a8,0x266da4c42513262f,0x1a46a7f628008000,0xa0a527a8a7d99e3e,0x24c4266da5a825a8,0xa164a788270ea38b,0xa7d99e3e8000a800,0x26a72472a21f2764,0x26dda41d25a825a8,0xa7fe1648a0a5a7a8,0xa0a527a8a8000000,0x262fa51326a72472,0xa2d7a73b25a8a5a8,0x9fc627c3a7f61a46
.quad 0x2764221f80002800,0xa21fa76425a8a5a8,0xa7882164a5a8a5a8,0x26dd241d9a4627f6,0x238ba70e28008000,0xa7f61a46a472a6a7,0x1fc627c3a5a825a8,0x25eda55f27a820a5,0xa6a7a4728000a800,0x9e3e27d9a764221f,0x27ea9cb225a825a8,0xa2d7a73b238ba70e,0xa513262fa8008000,0x270e238b1e3e27d9,0x9648a7fe25a8a5a8,0xa7ea1cb2a62fa513
.quad 0x25a825a880002800,0x25a8a5a828008000,0xa7fe9648a5a8a5a8,0x9cb227eaa62f2513,0x262fa51328008000,0xa38ba70e1e3ea7d9,0x9cb227eaa5a825a8,0x273b22d7238b270e,0xa472a6a78000a800,0xa7d91e3ea764a21f,0x27c31fc625a825a8,0x255fa5ed27a8a0a5,0xa70e238ba8008000,0x9a4627f6a47226a7,0x2164a78825a8a5a8,0xa41da6dd9a46a7f6
.quad 0x221f276400002800,0x2764221f25a825a8,0xa73ba2d7a5a8a5a8,0xa7c31fc6a7f69a46,0x27a8a0a528008000,0x2513a62f26a7a472,0xa41d26dda5a825a8,0x964827fea0a527a8,0x9e3ea7d98000a800,0xa472a6a7a21fa764,0x266d24c425a825a8,0x27882164270e238b,0xa7f61a46a8008000,0xa7a820a5a7d91e3e,0x255fa5ed25a8a5a8,0x24c4a66d2513a62f
.quad 0x2800800000002800,0xa80000008000a800,0xa6dd241da472a6a7,0x273ba2d7238b270e,0x238ba70e2764221f,0xa513262fa6a7a472,0x164827fea7d91e3e,0x1fc6a7c327f61a46,0xa472a6a725a8a5a8,0x1e3e27d9a764221f,0x273b22d79e3e27d9,0xa4c4a66d2513a62f,0xa7f61a46a21fa764,0x270e238b9e3e27d9,0x266da4c426a72472,0xa7fe9648a0a5a7a8
.quad 0xa21f2764a8000000,0x2764a21f25a825a8,0x9cb2a7ea26a7a472,0xa55f25eda7a8a0a5,0x2513262fa21f2764,0x20a5a7a827d99e3e,0xa788a1649e3ea7d9,0x1cb227eaa62f2513,0x27d99e3e25a825a8,0xa472a6a7221fa764,0xa5ed255fa7d99e3e,0x26dd241d1a4627f6,0x20a5a7a82764a21f,0xa7f69a46a472a6a7,0x1fc627c3a47226a7,0x2788a164270e238b
.quad 0xa5a8a5a88000a800,0xa5a825a8a8008000,0x27c31fc6247226a7,0x2164a788270ea38b,0xa7a820a5a764a21f,0x1a4627f6a47226a7,0x255fa5ed27d99e3e,0xa41da6dd1a46a7f6,0x9e3e27d9a5a825a8,0x26a72472221f2764,0xa164a7881e3ea7d9,0xa7ea9cb2a62fa513,0x262f2513221f2764,0x27a8a0a527d91e3e,0xa7ea9cb2a6a7a472,0xa5ed255fa7a820a5
.quad 0x2764a21f28008000,0x221fa76425a8a5a8,0xa4c4266da6a72472,0x164827fea0a527a8,0x1a46a7f6221fa764,0xa38ba70e9e3ea7d9,0x22d7273b1e3e27d9,0x266d24c42513262f,0xa6a7a472a5a8a5a8,0xa7d99e3ea764a21f,0x27fe164827d91e3e,0x27c39fc627f69a46,0xa70e238ba764221f,0xa62f2513a6a72472,0x241da6dd2472a6a7,0x22d7a73b238ba70e
.quad 0x2800800080002800,0xa80080008000a800,0xa7882164a21fa764,0x27c39fc620a527a8,0x262fa51325a825a8,0xa70e238ba472a6a7,0xa41d26dda764a21f,0x25eda55f262f2513,0x1e3ea7d928000000,0xa47226a7a764a21f,0x1cb227eaa764221f,0x2164a78827f61a46,0xa38ba70e25a8a5a8,0x9a4627f6a7d91e3e,0x25ed255fa21f2764,0x9cb2a7ea270ea38b
.quad 0xa764a21f0000a800,0x221f2764a5a825a8,0x27fe1648221f2764,0xa4c4a66d238ba70e,0xa7a820a5a5a8a5a8,0x262f25139e3e27d9,0x266da4c42764221f,0xa73ba2d79a46a7f6,0xa47226a7a8000000,0x27d91e3e221f2764,0x1fc6a7c32764a21f,0xa7fe1648a513a62f,0x1a4627f6a5a825a8,0x27a8a0a526a72472,0xa2d7a73b221fa764,0xa6dd241da7a8a0a5
.quad 0x25a825a800002800,0x25a8a5a828008000,0xa73ba2d7a21fa764,0xa41d26dda7a820a5,0x27f61a4625a825a8,0x20a5a7a826a7a472,0xa7c31fc6a764a21f,0x964827fea513262f,0x26a7a47228008000,0x9e3ea7d9221fa764,0xa4c4266da764221f,0x22d7273b9a4627f6,0x20a5a7a825a8a5a8,0xa513a62f9e3ea7d9,0x164827fea21f2764,0x266d24c4238b270e
.quad 0xa21fa7648000a800,0xa764a21fa5a8a5a8,0x255f25ed221f2764,0x27ea1cb2270e238b,0xa70ea38ba5a8a5a8,0xa7f61a46a7d99e3e,0x27ea1cb22764221f,0x2788a16427f69a46,0xa7d91e3ea8000000,0xa6a72472a764221f,0x26dda41d2764a21f,0x255fa5ed262fa513,0xa513262fa5a825a8,0xa38b270ea47226a7,0x2164a788221fa764,0x1fc6a7c320a5a7a8
.quad 0x2800800000002800,0xa80080008000a800,0xa7ea1cb29e3ea7d9,0x27fe96481a4627f6,0x27a8a0a5221f2764,0xa7f61a469e3ea7d9,0xa73b22d7a472a6a7,0x27ea9cb220a527a8,0x26a7a47225a825a8,0xa7d91e3ea21fa764,0xa5ed255fa6a7a472,0x27c39fc6238b270e,0x2513a62f2764221f,0xa7a820a5a472a6a7,0xa41d26dda7d99e3e,0x2788a1642513262f
.quad 0x221fa76428000000,0xa764221fa5a8a5a8,0x9fc627c3a7d91e3e,0x273ba2d7262f2513,0x1a46a7f62764a21f,0xa70e238ba6a7a472,0x164827fea6a72472,0x26dda41d270e238b,0x9e3ea7d925a8a5a8,0xa6a72472a764a21f,0x21642788a47226a7,0x266da4c427a820a5,0xa38ba70e221fa764,0xa62f2513a7d99e3e,0x24c4266d9e3e27d9,0x25eda55f27f61a46
.quad 0xa5a8a5a80000a800,0xa5a825a8a8000000,0x266d24c41e3e27d9,0x255fa5ed27f69a46,0xa70ea38ba21fa764,0xa513262fa7d91e3e,0x27882164247226a7,0x24c4a66d27a8a0a5,0xa7d99e3ea5a8a5a8,0xa47226a7a764221f,0x27fe164826a72472,0x241da6dd270ea38b,0xa7f61a46a764a21f,0xa38b270ea6a72472,0x27c39fc627d91e3e,0x22d7a73b262fa513
.quad 0xa764221fa8000000,0xa21f2764a5a825a8,0x26dda41d27d99e3e,0x2164a7882513a62f,0xa62f2513a764221f,0xa0a527a8a47226a7,0x255fa5ed26a7a472,0x1fc6a7c3238ba70e,0xa47226a7a5a825a8,0x9e3e27d9a21f2764,0x22d7a73b2472a6a7,0x1cb2a7ea20a5a7a8,0xa0a527a8a21f2764,0x9a4627f69e3e27d9,0x1cb2a7ea1e3ea7d9,0x1648a7fe1a46a7f6
.quad 0x924827ffa8002800,0x98b527fa964827fe,0x98b527fa28002800,0x9f0327ce9cb227ea,0x9bd627f1a8002800,0xa1c227779fc627c3,0x9d7927e228002800,0xa3e326f6a1642788,0x9f0327cea8002800,0xa4ec264fa2d7273b,0xa04427b628002800,0xa5cb2584a41d26dd,0xa1052799a8002800,0xa68a249ba4c4266d,0xa1c2277728002800,0xa7252332a55f25ed
.quad 0xa27c2750a8002800,0xa7992105a5ed255f,0xa332272528002800,0xa7e21d79a66d24c4,0xa3e326f6a8002800,0xa7ff1248a6dd241d,0xa44826c228002800,0xa7f19bd6a73b22d7,0xa49b268aa8002800,0xa7b6a044a7882164,0xa4ec264f28002800,0xa750a27ca7c31fc6,0xa53a260fa8002800,0xa6c2a448a7ea1cb2,0xa58425cb28002800,0xa60fa53aa7fe1648
.quad 0xa5cb2584a8002800,0xa53aa60fa7fe9648,0xa60f253a28002800,0xa448a6c2a7ea9cb2,0xa64f24eca8002800,0xa27ca750a7c39fc6,0xa68a249b28002800,0xa044a7b6a788a164,0xa6c22448a8002800,0x9bd6a7f1a73ba2d7,0xa6f623e328002800,0x1248a7ffa6dda41d,0xa7252332a8002800,0x1d79a7e2a66da4c4,0xa750227c28002800,0x2105a799a5eda55f
.quad 0xa77721c2a8002800,0x2332a725a55fa5ed,0xa799210528002800,0x249ba68aa4c4a66d,0xa7b62044a8002800,0x2584a5cba41da6dd,0xa7ce1f0328002800,0x264fa4eca2d7a73b,0xa7e21d79a8002800,0x26f6a3e3a164a788,0xa7f11bd628002800,0x2777a1c29fc6a7c3,0xa7fa18b5a8002800,0x27ce9f039cb2a7ea,0xa7ff124828002800,0x27fa98b59648a7fe
.quad 0x9bd627f19a4627f6,0x9d7927e29cb227ea,0xa1c22777a0a527a8,0xa3e326f6a2d7273b,0xa49b268aa38b270e,0xa60f253aa55f25ed,0xa60f253aa513262f,0xa77721c2a6dd241d,0xa7252332a62f2513,0xa7ff1248a7c31fc6,0xa7ce1f03a70e238b,0xa799a105a7fe9648,0xa7ff9248a7a820a5,0xa64fa4eca788a164,0xa7b6a044a7f61a46,0xa448a6c2a66da4c4
.quad 0xa6f6a3e3a7f69a46,0x9f03a7cea4c4a66d,0xa5cba584a7a8a0a5,0x1bd6a7f1a164a788,0xa448a6c2a70ea38b,0x2332a7259648a7fe,0xa105a799a62fa513,0x25cba5841fc6a7c3,0x98b5a7faa513a62f,0x2750a27c241da6dd,0x1d79a7e2a38ba70e,0x27fa98b525eda55f,0x227ca750a0a5a7a8,0x27b62044273ba2d7,0x24eca64f9a46a7f6,0x268a249b27ea9cb2
.quad 0x264fa4ec1a46a7f6,0x249b268a27ea1cb2,0x2750a27c20a5a7a8,0x204427b6273b22d7,0x27e29d79238ba70e,0x98b527fa25ed255f,0x27fa18b52513a62f,0xa27c2750241d26dd,0x27992105262fa513,0xa58425cb1fc627c3,0x26c22448270ea38b,0xa7252332964827fe,0x258425cb27a8a0a5,0xa7f11bd6a1642788,0x23e326f627f69a46,0xa7ce9f03a4c4266d
.quad 0x204427b627f61a46,0xa6c2a448a66d24c4,0x124827ff27a820a5,0xa4eca64fa7882164,0x9f0327ce270e238b,0xa105a799a7fe1648,0xa3322725262f2513,0x1248a7ffa7c39fc6,0xa53a260f2513262f,0x21c2a777a6dda41d,0xa68a249b238b270e,0x253aa60fa55fa5ed,0xa77721c220a527a8,0x26f6a3e3a2d7a73b,0xa7f11bd61a4627f6,0x27e29d799cb2a7ea
.quad 0x9f0327ce9e3e27d9,0xa04427b69fc627c3,0xa4ec264fa47226a7,0xa5cb2584a55f25ed,0xa7252332a6a72472,0xa7ce1f03a7882164,0xa7ff1248a7d91e3e,0xa799a105a7ea9cb2,0xa750a27ca7d99e3e,0xa53aa60fa66da4c4,0xa53aa60fa6a7a472,0x9d79a7e2a2d7a73b,0xa044a7b6a472a6a7,0x21c2a7771648a7fe,0x1d79a7e29e3ea7d9,0x264fa4ec241da6dd
.quad 0x249ba68a1e3ea7d9,0x27f19bd626dda41d,0x26f6a3e32472a6a7,0x2750227c27fe9648,0x27fa98b526a7a472,0x249b268a273b22d7,0x277721c227d99e3e,0x18b527fa24c4266d,0x258425cb27d91e3e,0xa33227251cb227ea,0x2105279926a72472,0xa6c22448a1642788,0x9bd627f1247226a7,0xa7ff1248a5ed255f,0xa44826c21e3e27d9,0xa6f6a3e3a7c31fc6
.quad 0xa6c224489e3e27d9,0xa3e3a6f6a7c39fc6,0xa7f11bd6a47226a7,0x1248a7ffa5eda55f,0xa799a105a6a72472,0x2448a6c2a164a788,0xa5cba584a7d91e3e,0x2725a3321cb2a7ea,0xa1c2a777a7d99e3e,0x27fa18b524c4a66d,0x18b5a7faa6a7a472,0x268a249b273ba2d7,0x23e3a6f6a472a6a7,0x227c275027fe1648,0x268aa49b9e3ea7d9,0x9bd627f126dd241d
.quad 0x27e29d791e3ea7d9,0xa4ec264f241d26dd,0x27b620442472a6a7,0xa77721c2164827fe,0x260f253a26a7a472,0xa7e29d79a2d7273b,0x227c275027d99e3e,0xa60fa53aa66d24c4,0x924827ff27d91e3e,0xa105a799a7ea1cb2,0xa332272526a72472,0x1f03a7cea788a164,0xa64f24ec247226a7,0x2584a5cba55fa5ed,0xa7ce1f031e3e27d9,0x27b6a0449fc6a7c3
.quad 0xa1052799a0a527a8,0xa1c22777a1642788,0xa68a249ba62f2513,0xa7252332a6dd241d,0xa7ff9248a7f61a46,0xa7b6a044a7ea9cb2,0xa64fa4eca70ea38b,0xa448a6c2a55fa5ed,0xa044a7b6a38ba70e,0x1d79a7e29648a7fe,0x21c2a7771a46a7f6,0x264fa4ec24c4a66d,0x26c2a4482513a62f,0x27fa18b527c39fc6,0x27fa18b527a8a0a5,0x258425cb273b22d7
.quad 0x260f253a27a820a5,0x124827ff22d7273b,0x1f0327ce2513262f,0xa53a260f9fc627c3,0xa27c27501a4627f6,0xa7f11bd6a66d24c4,0xa6f623e3a38b270e,0xa68aa49ba7fe9648,0xa7f19bd6a70e238b,0x9f03a7cea5eda55f,0xa5cba584a7f69a46,0x23e3a6f69cb2a7ea,0x9d79a7e2a62fa513,0x2799a105241da6dd,0x2332a725a0a5a7a8,0x2750227c2788a164
.quad 0x2725a33220a5a7a8,0x227c275027882164,0x27e21d79262fa513,0xa1052799241d26dd,0x258425cb27f69a46,0xa6f623e39cb227ea,0x1bd627f1270e238b,0xa7ce9f03a5ed255f,0xa3e326f6238b270e,0xa49ba68aa7fe1648,0xa750227c9a4627f6,0x1bd6a7f1a66da4c4,0xa7ce9f03a513262f,0x260fa53a9fc6a7c3,0xa53aa60fa7a820a5,0x27ff124822d7a73b
.quad 0x98b5a7faa7a8a0a5,0x25cb2584273ba2d7,0x2448a6c2a513a62f,0x18b527fa27c31fc6,0x2777a1c29a46a7f6,0xa4ec264f24c4266d,0x27b62044238ba70e,0xa7e21d79964827fe,0x24ec264f270ea38b,0xa6c2a448a55f25ed,0x124827ff27f61a46,0xa044a7b6a7ea1cb2,0xa49b268a262f2513,0x2332a725a6dda41d,0xa799210520a527a8,0x2777a1c2a164a788
.quad 0xa27c2750a21f2764,0xa3322725a2d7273b,0xa7992105a764221f,0xa7e21d79a7c31fc6,0xa6f6a3e3a764a21f,0xa5cba584a66da4c4,0x9f03a7cea21fa764,0x1bd6a7f19648a7fe,0x249ba68a221fa764,0x26f6a3e325eda55f,0x27f19bd62764a21f,0x2750227c27ea1cb2,0x260f253a2764221f,0x1f0327ce241d26dd,0x124827ff221f2764,0xa53a260fa1642788
.quad 0xa5cb2584a21f2764,0xa7fa98b5a7882164,0xa7fa98b5a764221f,0xa448a6c2a6dda41d,0xa4eca64fa764a21f,0x21c2a7779cb2a7ea,0x1d79a7e2a21fa764,0x27b6a044255fa5ed,0x26c2a448221fa764,0x264f24ec27fe1648,0x27b620442764a21f,0x924827ff24c4266d,0x233227252764221f,0xa68a249b9fc627c3,0xa1c22777221f2764,0xa799a105a73b22d7
.quad 0xa77721c2a21f2764,0xa105a799a73ba2d7,0xa725a332a764221f,0x249ba68a9fc6a7c3,0xa044a7b6a764a21f,0x27ff924824c4a66d,0x2448a6c2a21fa764,0x24ec264f27fe9648,0x27e29d79221fa764,0xa04427b6255f25ed,0x264f24ec2764a21f,0xa77721c29cb227ea,0x18b527fa2764221f,0xa6c2a448a6dd241d,0xa58425cb221f2764,0x98b5a7faa788a164
.quad 0xa7ff9248a21f2764,0x260fa53aa164a788,0xa53aa60fa764221f,0x27ce1f03241da6dd,0x1bd6a7f1a764a21f,0x227c275027ea9cb2,0x268aa49ba21fa764,0xa3e326f625ed255f,0x27ce1f03221fa764,0xa7f11bd6964827fe,0x23e326f62764a21f,0xa584a5cba66d24c4,0xa10527992764221f,0x1d79a7e2a7c39fc6,0xa750227c221f2764,0x2725a332a2d7a73b
.quad 0xa3e326f6a38b270e,0xa44826c2a41d26dd,0xa7ff1248a7f61a46,0xa7f19bd6a7fe9648,0xa448a6c2a513a62f,0xa105a799a2d7a73b,0x2332a72520a5a7a8,0x25cba58424c4a66d,0x27fa98b527a8a0a5,0x277721c227ea1cb2,0x249b268a262f2513,0x18b527fa21642788,0xa27c27509a4627f6,0xa6f623e3a55f25ed,0xa7f11bd6a70e238b,0xa68aa49ba7c39fc6
.quad 0xa4eca64fa70ea38b,0x1d79a7e29fc6a7c3,0x21c2a7779a46a7f6,0x27b6a04425eda55f,0x27e29d79262fa513,0x253a260f27882164,0x253a260f27a820a5,0xa27c27501cb227ea,0xa105279920a527a8,0xa7ff1248a66d24c4,0xa7ce1f03a513262f,0xa332a725a73ba2d7,0xa584a5cba7f69a46,0x24eca64f9648a7fe,0x2044a7b6a38ba70e,0x27ce1f0326dda41d
.quad 0x27b6a044238ba70e,0x1f0327ce26dd241d,0x25cb258427f69a46,0xa64f24ec964827fe,0x9f0327ce2513262f,0xa725a332a73b22d7,0xa7992105a0a527a8,0x1248a7ffa66da4c4,0xa60fa53aa7a820a5,0x2750a27c1cb2a7ea,0x1d79a7e2a62fa513,0x260f253a2788a164,0x2777a1c21a46a7f6,0xa04427b625ed255f,0x264f24ec270ea38b,0xa7e21d799fc627c3
.quad 0x9bd627f1270e238b,0xa49ba68aa7c31fc6,0xa750227c1a4627f6,0x23e3a6f6a55fa5ed,0xa68aa49ba62f2513,0x27fa18b52164a788,0x18b5a7faa7a8a0a5,0x21c2277727ea9cb2,0x2725a332a0a5a7a8,0xa58425cb24c4266d,0x26c224482513a62f,0xa799a105a2d7273b,0x924827ff27f61a46,0x9bd6a7f1a7fe1648,0xa6f623e3238b270e,0x26c2a448a41da6dd
.quad 0xa49b268aa47226a7,0xa4ec264fa4c4266d,0xa7b6a044a7d99e3e,0xa750a27ca788a164,0x98b5a7fa9e3ea7d9,0x1d79a7e21648a7fe,0x2750a27c26a7a472,0x27fa98b527c39fc6,0x258425cb26a72472,0x21052799241d26dd,0xa33227259e3e27d9,0xa6c22448a55f25ed,0xa7f19bd6a7d91e3e,0xa5cba584a73ba2d7,0x9f03a7cea472a6a7,0x23e3a6f61cb2a7ea
.quad 0x26c2a4482472a6a7,0x27b6204427ea9cb2,0x264f24ec27d91e3e,0x924827ff22d7273b,0xa10527991e3e27d9,0xa7ce1f03a5ed255f,0xa7ff1248a6a72472,0xa332a725a6dda41d,0xa1c2a777a6a7a472,0x260fa53a1fc6a7c3,0x260fa53a1e3ea7d9,0x268a249b27fe9648,0x26f623e327d99e3e,0xa1c2277721642788,0x9d7927e2247226a7,0xa7f19bd6a66d24c4
.quad 0xa7e21d79a47226a7,0x9bd6a7f1a66da4c4,0xa3e3a6f6a7d99e3e,0x2777a1c22164a788,0x253aa60f9e3ea7d9,0x249b268a27fe1648,0x277721c226a7a472,0xa53a260f1fc627c3,0x924827ff26a72472,0xa725a332a6dd241d,0xa79921059e3e27d9,0x1f03a7cea5eda55f,0xa4eca64fa7d91e3e,0x27ff924822d7a73b,0x2448a6c2a472a6a7,0x204427b627ea1cb2
.quad 0x27ce1f032472a6a7,0xa6f623e31cb227ea,0x1bd627f127d91e3e,0xa584a5cba73b22d7,0xa72523321e3e27d9,0x2448a6c2a55fa5ed,0xa5cba584a6a72472,0x27992105241da6dd,0x227ca750a6a7a472,0x98b527fa27c31fc6,0x27fa18b51e3ea7d9,0xa7e21d79164827fe,0x204427b627d99e3e,0xa27ca750a7882164,0xa68a249b247226a7,0x264fa4eca4c4a66d
.quad 0xa53a260fa513262f,0xa58425cba55f25ed,0xa6c2a448a70ea38b,0xa60fa53aa66da4c4,0x227ca75020a5a7a8,0x24eca64f241da6dd,0x27b6204427f61a46,0x268a249b273b22d7,0x9bd627f11a4627f6,0xa44826c2a1642788,0xa7ff1248a7a820a5,0xa6f6a3e3a7c39fc6,0x9d79a7e2a38ba70e,0x2332a7251cb2a7ea,0x2799a105262fa513,0x2750227c27fe1648
.quad 0x23322725262f2513,0xa1c22777164827fe,0xa68a249ba38b270e,0xa799a105a7ea1cb2,0xa584a5cba7a8a0a5,0x2044a7b69fc6a7c3,0x24eca64f1a46a7f6,0x27ce1f032788a164,0x26f623e327f69a46,0x9d7927e222d7273b,0xa1c2277720a527a8,0xa7f19bd6a6dd241d,0xa7ce9f03a70e238b,0x18b5a7faa4c4a66d,0x18b5a7faa513a62f,0x27ff124825eda55f
.quad 0x27fa98b52513a62f,0x124827ff25ed255f,0x1f0327ce270e238b,0xa7fa18b5a4c4266d,0xa77721c2a0a527a8,0x9bd6a7f1a6dda41d,0xa3e3a6f6a7f69a46,0x27e29d7922d7a73b,0x264fa4ec9a46a7f6,0x1f0327ce27882164,0x25cb258427a8a0a5,0xa7b620449fc627c3,0xa49b268a238b270e,0xa105a799a7ea9cb2,0xa725a332a62f2513,0x2777a1c21648a7fe
.quad 0x2105a799a62fa513,0x227c275027fe9648,0x27e21d79238ba70e,0xa72523321cb227ea,0x924827ff27a820a5,0xa3e3a6f6a7c31fc6,0xa7f11bd69a4627f6,0x26c2a448a164a788,0xa044a7b6a7f61a46,0x249b268a273ba2d7,0x2750a27ca0a5a7a8,0xa64f24ec241d26dd,0x244826c2270ea38b,0xa53aa60fa66d24c4,0xa60f253a2513262f,0x25cba584a55fa5ed
.quad 0xa5cb2584a5a825a8,0xa60f253aa5ed255f,0xa53aa60fa5a8a5a8,0xa448a6c2a4c4a66d,0x264fa4ec25a8a5a8,0x2750a27c26dda41d,0x249b268a25a825a8,0x204427b622d7273b,0xa6c22448a5a825a8,0xa7f11bd6a7882164,0xa3e3a6f6a5a8a5a8,0x1248a7ff9fc6a7c3,0x2725a33225a8a5a8,0x27e21d7927ea9cb2,0x227c275025a825a8,0xa1052799164827fe
.quad 0xa77721c2a5a825a8,0xa725a332a7fe9648,0xa105a799a5a8a5a8,0x249ba68a1cb2a7ea,0x27b6a04425a8a5a8,0x25cb258427c31fc6,0x1f0327ce25a825a8,0xa64f24eca1642788,0xa7e21d79a5a825a8,0xa3e3a6f6a73ba2d7,0x9bd6a7f1a5a8a5a8,0x2777a1c2241da6dd,0x27fa98b525a8a5a8,0x1f0327ce266d24c4,0x124827ff25a825a8,0xa7fa18b5a55f25ed
.quad 0xa7ff9248a5a825a8,0x18b5a7faa55fa5ed,0x18b5a7faa5a8a5a8,0x27ce1f03266da4c4,0x27f11bd625a8a5a8,0xa1c22777241d26dd,0x9d7927e225a825a8,0xa6f6a3e3a73b22d7,0xa7ce9f03a5a825a8,0x24eca64fa164a788,0x2044a7b6a5a8a5a8,0x258425cb27c39fc6,0x2799210525a8a5a8,0xa68a249b1cb227ea,0xa1c2277725a825a8,0xa332a725a7fe1648
.quad 0xa750a27ca5a825a8,0x2799a1051648a7fe,0x2332a725a5a8a5a8,0x1d7927e227ea1cb2,0x26f623e325a8a5a8,0xa7ff12489fc627c3,0xa44826c225a825a8,0x1bd6a7f1a788a164,0xa68aa49ba5a825a8,0x27b6204422d7a73b,0x24eca64fa5a8a5a8,0xa27c275026dd241d,0x260f253a25a8a5a8,0xa6c2a448a4c4266d,0xa58425cb25a825a8,0x253aa60fa5eda55f
.quad 0xa64f24eca62f2513,0xa68a249ba66d24c4,0xa27ca750a38ba70e,0xa044a7b6a164a788,0x27e29d7927a8a0a5,0x27fa18b527fe9648,0x98b527fa1a4627f6,0xa27c27509fc627c3,0xa799a105a7f69a46,0xa5cba584a6dda41d,0x2448a6c220a5a7a8,0x2725a33225eda55f,0x258425cb270e238b,0x1bd627f122d7273b,0xa6f623e3a513262f,0xa7ce9f03a7ea1cb2
.quad 0xa044a7b6a513a62f,0x2448a6c21cb2a7ea,0x27ff9248270ea38b,0x24ec264f273b22d7,0x9f0327ce20a527a8,0xa7992105a55f25ed,0xa725a332a7f61a46,0x1248a7ffa41da6dd,0x253aa60f1a46a7f6,0x277721c227c39fc6,0x249b268a27a820a5,0xa53a260f964827fe,0xa77721c2a38b270e,0xa3e3a6f6a788a164,0x9bd6a7f1a62fa513,0x27e29d7924c4a66d
.quad 0x27f11bd6262fa513,0x9d7927e224c4266d,0xa1c22777238b270e,0xa6f6a3e3a7882164,0xa68aa49ba7a820a5,0x260fa53a9648a7fe,0x260fa53a9a46a7f6,0x21c2277727c31fc6,0x2332272527f61a46,0xa7ff1248a41d26dd,0xa7ce1f03a0a527a8,0x2105a799a55fa5ed,0x1248a7ffa70ea38b,0x264f24ec273ba2d7,0x27b620442513a62f,0xa6c224481cb227ea
.quad 0xa3e326f62513262f,0x9f03a7cea7ea9cb2,0xa5cba584a70e238b,0x27f11bd622d7a73b,0x26c2a448a0a5a7a8,0xa332272525ed255f,0x2105279927f69a46,0xa584a5cba6dd241d,0xa7fa18b59a4627f6,0x2750a27c9fc6a7c3,0x1d79a7e2a7a8a0a5,0x18b527fa27fe1648,0x2750227c238ba70e,0xa7b6a044a1642788,0xa4ec264f262f2513,0x249ba68aa66da4c4
.quad 0xa6c22448a6a72472,0xa6f623e3a6dd241d,0x9bd6a7f19e3ea7d9,0x1248a7ff9648a7fe,0x2799210527d91e3e,0x26c22448273b22d7,0xa58425cba47226a7,0xa7252332a66d24c4,0xa1c2a777a472a6a7,0x18b5a7fa9cb2a7ea,0x27fa18b527d99e3e,0x268a249b27882164,0xa3e326f69e3e27d9,0xa750227ca5ed255f,0xa49ba68aa6a7a472,0x1bd6a7f19fc6a7c3
.quad 0x27e29d7926a7a472,0x264f24ec27c31fc6,0xa04427b61e3e27d9,0xa77721c2a55f25ed,0xa60fa53aa7d99e3e,0x1d79a7e2a164a788,0x2750a27c2472a6a7,0x260f253a27ea1cb2,0x924827ff247226a7,0xa7992105a4c4266d,0xa725a332a7d91e3e,0x1f03a7cea2d7a73b,0x264fa4ec1e3ea7d9,0x25cb258427fe1648,0x1f0327ce26a72472,0xa7b62044a41d26dd
.quad 0xa7ce9f03a6a72472,0x2044a7b6a41da6dd,0x24eca64f9e3ea7d9,0x258425cb27fe9648,0x2332272527d91e3e,0xa7ce1f03a2d7273b,0xa7ff1248a47226a7,0x2105a799a4c4a66d,0x227ca750a472a6a7,0x253a260f27ea9cb2,0x253a260f27d99e3e,0xa7e21d79a1642788,0xa7b620449e3e27d9,0x21c2a777a55fa5ed,0x1d79a7e2a6a7a472,0x24ec264f27c39fc6
.quad 0x268a249b26a7a472,0xa7f11bd69fc627c3,0xa6f623e31e3e27d9,0x227ca750a5eda55f,0x98b5a7faa7d99e3e,0x249b268a2788a164,0x277721c22472a6a7,0xa7fa18b59cb227ea,0xa5cb2584247226a7,0x2332a725a66da4c4,0xa105a799a7d91e3e,0x244826c2273ba2d7,0x27f11bd61e3ea7d9,0xa7ff1248964827fe,0xa44826c226a72472,0x23e3a6f6a6dda41d
.quad 0xa7252332a70e238b,0xa750227ca73b22d7,0x1d79a7e21a46a7f6,0x2105a7991fc6a7c3,0x258425cb262f2513,0x23e326f624c4266d,0xa7f11bd6a7a820a5,0xa7ce9f03a7fe9648,0x23e3a6f620a5a7a8,0x268aa49b255fa5ed,0x227c27502513262f,0x9bd627f11cb227ea,0xa7ce9f03a7f61a46,0xa53aa60fa6dda41d,0x260fa53a238ba70e,0x27ff12482788a164
.quad 0x18b527fa238b270e,0xa58425cba1642788,0xa6c2a448a7f69a46,0x98b5a7faa41da6dd,0x2777a1c22513a62f,0x264f24ec27ea1cb2,0xa04427b620a527a8,0xa7e21d79a5ed255f,0xa4eca64fa7a8a0a5,0x2448a6c29648a7fe,0x27ff9248262fa513,0x204427b6266d24c4,0xa49b268a1a4627f6,0xa725a332a7c31fc6,0xa105a799a70ea38b,0x2777a1c222d7a73b
.quad 0x27992105270ea38b,0xa1c2277722d7273b,0xa68a249b9a4627f6,0xa332a725a7c39fc6,0x1248a7ffa62fa513,0x27b62044266da4c4,0x264f24ec27a8a0a5,0xa6c22448964827fe,0xa7b62044a0a527a8,0x1d79a7e2a5eda55f,0x21c2a777a513a62f,0x24ec264f27ea9cb2,0x244826c227f69a46,0xa7fa98b5a41d26dd,0xa7fa98b5a38b270e,0x25cba584a164a788
.quad 0x253aa60fa38ba70e,0x124827ff27882164,0x1f0327ce27f61a46,0xa60fa53aa6dd241d,0xa750a27ca513262f,0x27f19bd61cb2a7ea,0x26f6a3e3a0a5a7a8,0xa49b268a255f25ed,0x9bd627f127a820a5,0x9f03a7cea7fe1648,0xa5cba584a62f2513,0x26f623e324c4a66d,0x27e29d799a46a7f6,0xa79921051fc627c3,0xa3322725270e238b,0x227ca750a73ba2d7
.quad 0xa77721c2a764221f,0xa7992105a7882164,0x2332a725221fa764,0x249ba68a241da6dd,0x204427b6221f2764,0x124827ff1cb227ea,0xa6c2a448a764a21f,0xa4eca64fa5eda55f,0x27e29d792764a21f,0x27b6204427fe1648,0xa4ec264fa21f2764,0xa77721c2a66d24c4,0x98b5a7faa21fa764,0x2448a6c21fc6a7c3,0x25cb25842764221f,0x18b527fa22d7273b
.quad 0xa7ff9248a764221f,0xa53aa60fa73ba2d7,0x260fa53a221fa764,0x27ce1f0327c39fc6,0x9bd627f1221f2764,0xa750227ca4c4266d,0xa49ba68aa764a21f,0x23e3a6f69648a7fe,0x27ce1f032764a21f,0x1bd627f1255f25ed,0xa6f623e3a21f2764,0xa584a5cba7ea9cb2,0x2105a799a21fa764,0x27e21d7926dda41d,0x227c27502764221f,0xa7252332a1642788
.quad 0xa750a27ca764221f,0x2332a725a164a788,0x2799a105221fa764,0x1d7927e226dd241d,0xa3e326f6221f2764,0xa5cba584a7ea1cb2,0x9f03a7cea764a21f,0x27f11bd6255fa5ed,0x268a249b2764a21f,0xa6f623e3964827fe,0xa7f11bd6a21f2764,0x227ca750a4c4a66d,0x253aa60fa21fa764,0x1f0327ce27c31fc6,0x124827ff2764221f,0xa60fa53aa73b22d7
.quad 0xa584a5cba764221f,0x27fa18b522d7a73b,0x27fa18b5221fa764,0xa6c224481fc627c3,0xa64f24ec221f2764,0x21c2a777a66da4c4,0x1d79a7e2a764a21f,0x204427b627fe9648,0x244826c22764a21f,0xa64fa4eca5ed255f,0xa7b6a044a21f2764,0x27ff12481cb2a7ea,0x2725a332a21fa764,0xa68a249b241d26dd,0xa1c227772764221f,0x2105a799a788a164
.quad 0xa7b62044a7a820a5,0xa7ce1f03a7c31fc6,0x2584a5cb2513a62f,0x264fa4ec25eda55f,0x9f0327ce9a4627f6,0xa3322725a1642788,0xa105a799a38ba70e,0x1248a7ff9cb2a7ea,0x260f253a270e238b,0x227c275024c4266d,0xa7e29d79a7f61a46,0xa60fa53aa73ba2d7,0x2777a1c2262fa513,0x27b6204427fe9648,0xa4ec264fa0a527a8,0xa7e21d79a6dd241d
.quad 0x1bd6a7f1a0a5a7a8,0x268aa49b241da6dd,0x227c2750262f2513,0xa3e326f6964827fe,0xa68aa49ba7f69a46,0x18b5a7faa2d7a73b,0x27fa18b5270ea38b,0x21c22777266d24c4,0xa7252332a38b270e,0xa5cba584a7ea9cb2,0x2448a6c29a46a7f6,0x279921052788a164,0x924827ff2513262f,0xa7f11bd6a55f25ed,0xa3e3a6f6a7a8a0a5,0x26c2a4481fc6a7c3
.quad 0x26f623e327a8a0a5,0xa44826c21fc627c3,0xa7ff1248a513262f,0x1bd6a7f1a55fa5ed,0x26c2a4481a46a7f6,0x2105279927882164,0xa3322725238b270e,0xa584a5cba7ea1cb2,0x98b5a7faa70ea38b,0x277721c2266da4c4,0x249b268a27f69a46,0xa7fa18b5a2d7273b,0xa750a27ca62f2513,0x26f6a3e39648a7fe,0x27f19bd620a5a7a8,0xa49b268a241d26dd
.quad 0xa64f24ec20a527a8,0x1d79a7e2a6dda41d,0x21c2a777a62fa513,0x204427b627fe1648,0x1d7927e227f61a46,0xa53aa60fa73b22d7,0xa53aa60fa70e238b,0x2750227c24c4a66d,0x27992105238ba70e,0xa7ff12489cb227ea,0xa7ce1f031a4627f6,0x2725a332a164a788,0x25cba584a513a62f,0xa4ec264f25ed255f,0xa04427b627a820a5,0x1f03a7cea7c39fc6
.quad 0xa7e21d79a7d91e3e,0xa7f11bd6a7ea1cb2,0x26f6a3e326a7a472,0x2777a1c2273ba2d7,0xa53a260fa47226a7,0xa68a249ba5ed255f,0x21c2a7771e3ea7d9,0x253aa60f241da6dd,0x924827ff1e3e27d9,0xa33227259fc627c3,0xa105a799a472a6a7,0x1f03a7ce9648a7fe,0x24ec264f26a72472,0x124827ff21642788,0xa6c2a448a7d99e3e,0xa044a7b6a4c4a66d
.quad 0x27ce1f0327d99e3e,0x23e326f6266d24c4,0xa7f11bd6a6a72472,0xa584a5cba788a164,0x2725a3322472a6a7,0x26c2244827fe1648,0xa58425cb9e3e27d9,0xa799a105a7c31fc6,0x227ca7509e3ea7d9,0x27fa18b526dda41d,0x98b527fa247226a7,0xa7e21d79a55f25ed,0xa044a7b6a6a7a472,0x2750a27c22d7a73b,0x249b268a27d91e3e,0xa64f24ec9cb227ea
.quad 0xa68aa49ba7d91e3e,0x24eca64f9cb2a7ea,0x27b6204426a7a472,0xa27c275022d7273b,0xa7fa18b5a47226a7,0x1d79a7e2a55fa5ed,0x2750a27c1e3ea7d9,0x18b527fa26dd241d,0xa5cb25841e3e27d9,0xa105a799a7c39fc6,0x2332a725a472a6a7,0x244826c227fe9648,0x9bd627f126a72472,0xa5cba584a7882164,0x9f03a7cea7d99e3e,0x26f623e3266da4c4
.quad 0x244826c227d99e3e,0xa7b6a044a4c4266d,0xa64fa4eca6a72472,0x27ff12482164a788,0x279921052472a6a7,0xa7ce1f03964827fe,0xa7ff12489e3e27d9,0x2725a3329fc6a7c3,0x2777a1c29e3ea7d9,0xa60f253a241d26dd,0xa60f253a247226a7,0x249ba68aa5eda55f,0x23e3a6f6a6a7a472,0xa1c22777273b22d7,0x9d7927e227d91e3e,0x1bd6a7f1a7ea9cb2
.quad 0xa7fa18b5a7f61a46,0xa7ff1248a7fe1648,0x27ce9f0327a8a0a5,0x27fa98b527ea9cb2,0xa77721c2a70e238b,0xa7f11bd6a7c31fc6,0x26f6a3e3262fa513,0x27e29d792788a164,0xa64f24eca513262f,0xa7ce1f03a73b22d7,0x2584a5cb238ba70e,0x27b6a04426dda41d,0xa49b268aa0a527a8,0xa7992105a66d24c4,0x2332a7251a46a7f6,0x2777a1c225eda55f
.quad 0xa10527991a4627f6,0xa750227ca55f25ed,0x1d79a7e2a0a5a7a8,0x2725a33224c4a66d,0x924827ff238b270e,0xa6f623e3a41d26dd,0x9bd6a7f1a513a62f,0x26c2a44822d7a73b,0x204427b6262f2513,0xa68a249ba1642788,0xa27ca750a70ea38b,0x264fa4ec1fc6a7c3,0x244826c227a820a5,0xa60f253a9cb227ea,0xa53aa60fa7f69a46,0x25cba5841648a7fe
.quad 0x260f253a27f69a46,0xa58425cb164827fe,0xa6c2a448a7a820a5,0x253aa60f9cb2a7ea,0x2750227c270ea38b,0xa4ec264f1fc627c3,0xa7b6a044a62f2513,0x249ba68aa164a788,0x27f11bd62513a62f,0xa44826c222d7273b,0xa7ff1248a38b270e,0x23e3a6f6a41da6dd,0x27e29d7920a5a7a8,0xa332272524c4266d,0xa79921059a4627f6,0x227ca750a55fa5ed
.quad 0x2725a3329a46a7f6,0xa1c2277725ed255f,0xa68a249b20a527a8,0x2105a799a66da4c4,0x25cba584a38ba70e,0xa04427b626dd241d,0xa4ec264f2513262f,0x1f03a7cea73ba2d7,0x23e3a6f6a62fa513,0x9d7927e227882164,0xa1c22777270e238b,0x1bd6a7f1a7c39fc6,0x1f03a7cea7a8a0a5,0x98b527fa27ea1cb2,0x98b527fa27f61a46,0x1248a7ffa7fe9648
.quad 0xa7ff9248a8002800,0x27fa18b51648a7fe,0xa7fa98b528002800,0x27ce1f031cb2a7ea,0xa7f19bd6a8002800,0x277721c21fc6a7c3,0xa7e29d7928002800,0x26f623e32164a788,0xa7ce9f03a8002800,0x264f24ec22d7a73b,0xa7b6a04428002800,0x258425cb241da6dd,0xa799a105a8002800,0x249b268a24c4a66d,0xa777a1c228002800,0x23322725255fa5ed
.quad 0xa750a27ca8002800,0x2105279925eda55f,0xa725a33228002800,0x1d7927e2266da4c4,0xa6f6a3e3a8002800,0x124827ff26dda41d,0xa6c2a44828002800,0x9bd627f1273ba2d7,0xa68aa49ba8002800,0xa04427b62788a164,0xa64fa4ec28002800,0xa27c275027c39fc6,0xa60fa53aa8002800,0xa44826c227ea9cb2,0xa5cba58428002800,0xa53a260f27fe9648
.quad 0xa584a5cba8002800,0xa60f253a27fe1648,0xa53aa60f28002800,0xa6c2244827ea1cb2,0xa4eca64fa8002800,0xa750227c27c31fc6,0xa49ba68a28002800,0xa7b6204427882164,0xa448a6c2a8002800,0xa7f11bd6273b22d7,0xa3e3a6f628002800,0xa7ff924826dd241d,0xa332a725a8002800,0xa7e29d79266d24c4,0xa27ca75028002800,0xa799a10525ed255f
.quad 0xa1c2a777a8002800,0xa725a332255f25ed,0xa105a79928002800,0xa68aa49b24c4266d,0xa044a7b6a8002800,0xa5cba584241d26dd,0x9f03a7ce28002800,0xa4eca64f22d7273b,0x9d79a7e2a8002800,0xa3e3a6f621642788,0x9bd6a7f128002800,0xa1c2a7771fc627c3,0x98b5a7faa8002800,0x9f03a7ce1cb227ea,0x9248a7ff28002800,0x98b5a7fa164827fe
.quad 0xa7f19bd69a4627f6,0x27e21d791cb2a7ea,0xa777a1c2a0a527a8,0x26f623e322d7a73b,0xa68aa49ba38b270e,0x253a260f255fa5ed,0xa53aa60fa513262f,0x21c2277726dda41d,0xa332a725a62f2513,0x124827ff27c39fc6,0x9f03a7cea70e238b,0xa105279927fe1648,0x1248a7ffa7a820a5,0xa4ec264f27882164,0x2044a7b6a7f61a46,0xa6c22448266d24c4
.quad 0x23e3a6f6a7f69a46,0xa7ce1f0324c4266d,0x2584a5cba7a8a0a5,0xa7f19bd621642788,0x26c2a448a70ea38b,0xa725a332164827fe,0x2799a105a62fa513,0xa584a5cb9fc627c3,0x27fa98b5a513a62f,0xa27ca750a41d26dd,0x27e21d79a38ba70e,0x98b5a7faa5ed255f,0x2750227ca0a5a7a8,0x2044a7b6a73b22d7,0x264f24ec9a46a7f6,0x249ba68aa7ea1cb2
.quad 0x24ec264f1a46a7f6,0x268aa49ba7ea9cb2,0x227c275020a5a7a8,0x27b6a044a73ba2d7,0x1d7927e2238ba70e,0x27fa18b5a5eda55f,0x98b527fa2513a62f,0x2750227ca41da6dd,0xa1052799262fa513,0x25cb25849fc6a7c3,0xa44826c2270ea38b,0x233227251648a7fe,0xa5cb258427a8a0a5,0x1bd627f12164a788,0xa6f623e327f69a46,0x9f0327ce24c4a66d
.quad 0xa7b6204427f61a46,0xa44826c2266da4c4,0xa7ff124827a820a5,0xa64f24ec2788a164,0xa7ce9f03270e238b,0xa799210527fe9648,0xa725a332262f2513,0xa7ff924827c31fc6,0xa60fa53a2513262f,0xa777a1c226dd241d,0xa49ba68a238b270e,0xa60fa53a255f25ed,0xa1c2a77720a527a8,0xa3e3a6f622d7273b,0x9bd6a7f11a4627f6,0x9d79a7e21cb227ea
.quad 0xa7ce9f039e3e27d9,0x27b620441fc6a7c3,0xa64fa4eca47226a7,0x258425cb255fa5ed,0xa332a725a6a72472,0x1f0327ce2788a164,0x9248a7ffa7d91e3e,0xa105279927ea1cb2,0x227ca750a7d99e3e,0xa60f253a266d24c4,0x260fa53aa6a7a472,0xa7e21d7922d7273b,0x27b6a044a472a6a7,0xa777a1c2964827fe,0x27e21d799e3ea7d9,0xa4eca64fa41d26dd
.quad 0x268a249b1e3ea7d9,0x9bd6a7f1a6dd241d,0x23e326f62472a6a7,0x227ca750a7fe1648,0x18b527fa26a7a472,0x268aa49ba73ba2d7,0xa1c2277727d99e3e,0x27fa98b5a4c4a66d,0xa5cb258427d91e3e,0x272523329cb2a7ea,0xa799210526a72472,0x244826c22164a788,0xa7f19bd6247226a7,0x124827ff25eda55f,0xa6c2a4481e3e27d9,0xa3e326f627c39fc6
.quad 0xa448a6c29e3e27d9,0xa6f623e327c31fc6,0x9bd6a7f1a47226a7,0xa7ff924825ed255f,0x2105a799a6a72472,0xa6c2a44821642788,0x2584a5cba7d91e3e,0xa332a7259cb227ea,0x2777a1c2a7d99e3e,0x18b5a7faa4c4266d,0x27fa18b5a6a7a472,0x249ba68aa73b22d7,0x26f623e3a472a6a7,0x2750a27ca7fe9648,0x249b268a9e3ea7d9,0x27f11bd6a6dda41d
.quad 0x1d7927e21e3ea7d9,0x264f24eca41da6dd,0xa04427b62472a6a7,0x21c227779648a7fe,0xa53a260f26a7a472,0x9d7927e222d7a73b,0xa750227c27d99e3e,0xa53a260f266da4c4,0xa7ff924827d91e3e,0xa799210527ea9cb2,0xa725a33226a72472,0xa7ce9f0327882164,0xa4eca64f247226a7,0xa5cba584255f25ed,0x9f03a7ce1e3e27d9,0xa044a7b61fc627c3
.quad 0xa799a105a0a527a8,0x277721c22164a788,0xa49ba68aa62f2513,0x2332272526dda41d,0x1248a7ffa7f61a46,0xa04427b627ea1cb2,0x24eca64fa70ea38b,0xa6c22448255f25ed,0x27b6a044a38ba70e,0xa7e29d79164827fe,0x277721c21a46a7f6,0xa4eca64fa4c4266d,0x244826c22513a62f,0x18b5a7faa7c31fc6,0x98b527fa27a8a0a5,0x25cba584a73ba2d7
.quad 0xa53a260f27a820a5,0x27ff9248a2d7a73b,0xa7ce1f032513262f,0x260f253a1fc6a7c3,0xa750a27c1a4627f6,0x1bd627f1266da4c4,0xa3e3a6f6a38b270e,0xa49b268a27fe1648,0x1bd6a7f1a70e238b,0xa7ce1f0325ed255f,0x2584a5cba7f69a46,0xa6f6a3e31cb227ea,0x27e29d79a62fa513,0xa105a799a41d26dd,0x27252332a0a5a7a8,0x227ca750a7882164
.quad 0x2332272520a5a7a8,0x2750a27ca788a164,0x9d7927e2262fa513,0x27992105a41da6dd,0xa5cb258427f69a46,0x23e326f61cb2a7ea,0xa7f11bd6270e238b,0x9f0327ce25eda55f,0xa6f6a3e3238b270e,0xa68a249b27fe9648,0xa27ca7509a4627f6,0xa7f19bd6266d24c4,0x1f03a7cea513262f,0xa53aa60f1fc627c3,0x260fa53aa7a820a5,0x1248a7ffa2d7273b
.quad 0x27fa98b5a7a8a0a5,0x2584a5cba73b22d7,0x26c22448a513a62f,0x27fa98b5a7c39fc6,0x21c227779a46a7f6,0x264f24eca4c4a66d,0xa04427b6238ba70e,0x1d7927e21648a7fe,0xa64f24ec270ea38b,0xa44826c2255fa5ed,0xa7ff124827f61a46,0xa7b6204427ea9cb2,0xa68aa49b262f2513,0xa725a33226dd241d,0xa105a79920a527a8,0xa1c2a77721642788
.quad 0xa750a27ca21f2764,0x2725233222d7a73b,0xa105a799a764221f,0x1d7927e227c39fc6,0x23e3a6f6a764a21f,0xa58425cb266d24c4,0x27ce9f03a21fa764,0xa7f19bd6164827fe,0x268a249b221fa764,0xa3e3a6f6a5ed255f,0x1bd627f12764a21f,0x227ca750a7ea9cb2,0xa53a260f2764221f,0x27ce9f03a41da6dd,0xa7ff1248221f2764,0x260f253a2164a788
.quad 0xa584a5cba21f2764,0x98b527fa2788a164,0x18b5a7faa764221f,0xa6c2244826dd241d,0x264fa4eca764a21f,0xa777a1c21cb227ea,0x27e21d79a21fa764,0xa044a7b6a55f25ed,0x244826c2221fa764,0x24eca64fa7fe9648,0xa04427b62764a21f,0x27ff1248a4c4a66d,0xa72523322764221f,0x249b268a1fc6a7c3,0xa777a1c2221f2764,0xa1052799273ba2d7
.quad 0xa1c2a777a21f2764,0xa7992105273b22d7,0x2332a725a764221f,0xa68aa49b1fc627c3,0x27b6a044a764a21f,0x9248a7ffa4c4266d,0x26c22448a21fa764,0x264fa4eca7fe1648,0x1d7927e2221fa764,0x27b62044a55fa5ed,0xa4ec264f2764a21f,0x21c227771cb2a7ea,0xa7fa18b52764221f,0xa44826c226dda41d,0xa5cba584221f2764,0xa7fa18b527882164
.quad 0x1248a7ffa21f2764,0xa53aa60f21642788,0x260fa53aa764221f,0x1f03a7cea41d26dd,0x27f11bd6a764a21f,0x2750a27ca7ea1cb2,0x249b268aa21fa764,0x26f623e3a5eda55f,0x9f0327ce221fa764,0x1bd627f11648a7fe,0xa6f623e32764a21f,0xa5cb2584266da4c4,0xa799a1052764221f,0xa7e29d7927c31fc6,0xa27ca750221f2764,0xa332a72522d7273b
.quad 0xa6f6a3e3a38b270e,0x26c22448241da6dd,0x9248a7ffa7f61a46,0x9bd627f127fe1648,0x26c2a448a513a62f,0xa799210522d7273b,0x2725233220a5a7a8,0xa584a5cba4c4266d,0x18b527fa27a8a0a5,0x21c2a777a7ea9cb2,0xa68a249b262f2513,0x27fa98b5a164a788,0xa750a27c9a4627f6,0x23e326f6255fa5ed,0x9bd6a7f1a70e238b,0xa49b268a27c31fc6
.quad 0x264fa4eca70ea38b,0xa7e29d791fc627c3,0x277721c29a46a7f6,0xa044a7b6a5ed255f,0x1d7927e2262fa513,0x260fa53aa788a164,0xa60f253a27a820a5,0x2750227c9cb2a7ea,0xa799a10520a527a8,0x124827ff266da4c4,0x9f03a7cea513262f,0xa7252332273b22d7,0x25cba584a7f69a46,0xa64fa4ec164827fe,0x27b62044a38ba70e,0x1f03a7cea6dd241d
.quad 0x204427b6238ba70e,0x27ce9f03a6dda41d,0xa58425cb27f69a46,0x24ec264f1648a7fe,0xa7ce9f032513262f,0xa3322725273ba2d7,0xa105a799a0a527a8,0xa7ff9248266d24c4,0x253aa60fa7a820a5,0xa27ca7509cb227ea,0x27e21d79a62fa513,0x253aa60fa7882164,0x21c227771a46a7f6,0x27b62044a5eda55f,0xa4ec264f270ea38b,0x1d7927e21fc6a7c3
.quad 0xa7f19bd6270e238b,0xa68a249b27c39fc6,0xa27ca7501a4627f6,0xa6f6a3e3255f25ed,0x249ba68aa62f2513,0x18b5a7faa1642788,0x27fa18b5a7a8a0a5,0x2777a1c2a7ea1cb2,0x23322725a0a5a7a8,0x25cb2584a4c4a66d,0xa44826c22513a62f,0xa105279922d7a73b,0xa7ff924827f61a46,0xa7f11bd627fe9648,0xa3e3a6f6238b270e,0xa448a6c2241d26dd
.quad 0xa68aa49ba47226a7,0x264f24ec24c4a66d,0x2044a7b6a7d99e3e,0xa27c275027882164,0x27fa98b59e3ea7d9,0xa7e29d79964827fe,0x227c275026a7a472,0x98b5a7faa7c31fc6,0xa5cb258426a72472,0x2799a105a41da6dd,0xa725a3329e3e27d9,0x244826c2255fa5ed,0x1bd6a7f1a7d91e3e,0xa58425cb273b22d7,0x27ce9f03a472a6a7,0xa6f6a3e39cb227ea
.quad 0x244826c22472a6a7,0x2044a7b6a7ea1cb2,0xa4ec264f27d91e3e,0x27ff1248a2d7a73b,0xa799a1051e3e27d9,0x1f0327ce25eda55f,0x9248a7ffa6a72472,0xa725233226dd241d,0x2777a1c2a6a7a472,0xa53aa60f9fc627c3,0x253a260f1e3ea7d9,0x249ba68aa7fe1648,0xa3e326f627d99e3e,0x277721c2a164a788,0xa7e29d79247226a7,0x9bd627f1266da4c4
.quad 0x9d79a7e2a47226a7,0xa7f11bd6266d24c4,0x26f6a3e3a7d99e3e,0xa1c2a777a1642788,0x260f253a9e3ea7d9,0x268aa49ba7fe9648,0xa1c2277726a7a472,0x260f253a9fc6a7c3,0xa7ff924826a72472,0xa332272526dda41d,0xa105a7999e3e27d9,0xa7ce9f0325ed255f,0x264fa4eca7d91e3e,0x9248a7ffa2d7273b,0x26c22448a472a6a7,0x27b6a044a7ea9cb2
.quad 0x9f0327ce2472a6a7,0x23e326f69cb2a7ea,0xa7f11bd627d91e3e,0xa5cb2584273ba2d7,0xa332a7251e3e27d9,0xa6c2a448255f25ed,0x2584a5cba6a72472,0x2105a799a41d26dd,0x2750227ca6a7a472,0x27fa18b5a7c39fc6,0x98b527fa1e3ea7d9,0x1d7927e29648a7fe,0xa7b6204427d99e3e,0xa750227c2788a164,0xa49ba68a247226a7,0xa4eca64f24c4266d
.quad 0xa60fa53aa513262f,0x25cb2584255fa5ed,0x2448a6c2a70ea38b,0xa53a260f266d24c4,0x2750227c20a5a7a8,0xa64fa4eca41d26dd,0xa04427b627f61a46,0x249ba68aa73ba2d7,0xa7f19bd61a4627f6,0x26c224482164a788,0x9248a7ffa7a820a5,0xa3e326f627c31fc6,0x27e29d79a38ba70e,0xa725a3329cb227ea,0x21052799262fa513,0x227ca750a7fe9648
.quad 0xa7252332262f2513,0x277721c29648a7fe,0xa49ba68aa38b270e,0xa105279927ea9cb2,0x25cba584a7a8a0a5,0xa7b6a0441fc627c3,0x264f24ec1a46a7f6,0x1f03a7cea7882164,0xa3e326f627f69a46,0x27e21d79a2d7a73b,0xa777a1c220a527a8,0x9bd627f126dda41d,0x1f03a7cea70e238b,0xa7fa98b524c4266d,0x27fa18b5a513a62f,0x1248a7ffa5ed255f
.quad 0x18b527fa2513a62f,0x27ff9248a5eda55f,0xa7ce1f03270e238b,0x18b527fa24c4a66d,0xa1c2a777a0a527a8,0xa7f11bd626dd241d,0x26f6a3e3a7f69a46,0x9d79a7e2a2d7273b,0x24ec264f9a46a7f6,0x27ce9f03a788a164,0xa58425cb27a8a0a5,0x204427b61fc6a7c3,0xa68aa49b238b270e,0xa799210527ea1cb2,0x2332a725a62f2513,0xa1c2a777964827fe
.quad 0x27992105a62fa513,0x2750a27ca7fe1648,0x9d7927e2238ba70e,0x233227259cb2a7ea,0xa7ff924827a820a5,0xa6f623e327c39fc6,0x9bd6a7f19a4627f6,0xa448a6c221642788,0x27b6a044a7f61a46,0x268aa49ba73b22d7,0x227c2750a0a5a7a8,0x24ec264fa41da6dd,0xa6c22448270ea38b,0xa60f253a266da4c4,0xa53aa60f2513262f,0xa584a5cb255f25ed
.quad 0xa584a5cba5a825a8,0x253a260f25eda55f,0x260fa53aa5a8a5a8,0xa6c2244824c4266d,0x24ec264f25a8a5a8,0xa27ca750a6dd241d,0xa68a249b25a825a8,0x27b6a044a2d7a73b,0xa448a6c2a5a825a8,0x1bd627f12788a164,0x26f6a3e3a5a8a5a8,0xa7ff92481fc627c3,0x2332272525a8a5a8,0x1d79a7e2a7ea1cb2,0xa750227c25a825a8,0x279921059648a7fe
.quad 0xa1c2a777a5a825a8,0xa332272527fe1648,0x2799a105a5a8a5a8,0xa68aa49b9cb227ea,0x204427b625a8a5a8,0x2584a5cba7c39fc6,0xa7ce1f0325a825a8,0x24ec264f2164a788,0x9d79a7e2a5a825a8,0xa6f623e3273b22d7,0x27f19bd6a5a8a5a8,0xa1c2a777a41d26dd,0x18b527fa25a8a5a8,0x27ce9f03a66da4c4,0xa7ff124825a825a8,0x18b527fa255fa5ed
.quad 0x1248a7ffa5a825a8,0xa7fa98b5255f25ed,0x27fa18b5a5a8a5a8,0x1f03a7cea66d24c4,0x9bd627f125a8a5a8,0x277721c2a41da6dd,0xa7e29d7925a825a8,0xa3e326f6273ba2d7,0x1f03a7cea5a825a8,0xa64fa4ec21642788,0x27b62044a5a8a5a8,0x25cba584a7c31fc6,0xa105279925a8a5a8,0x249b268a9cb2a7ea,0xa777a1c225a825a8,0xa725233227fe9648
.quad 0x227ca750a5a825a8,0xa105a799964827fe,0x27252332a5a8a5a8,0x27e29d79a7ea9cb2,0xa3e326f625a8a5a8,0x124827ff1fc6a7c3,0xa6c2a44825a825a8,0xa7f19bd627882164,0x249ba68aa5a825a8,0x2044a7b6a2d7273b,0x264f24eca5a8a5a8,0x2750227ca6dda41d,0xa53a260f25a8a5a8,0xa44826c224c4a66d,0xa5cba58425a825a8,0xa60fa53a25ed255f
.quad 0xa4eca64fa62f2513,0x249b268a266da4c4,0x2750a27ca38ba70e,0xa7b6204421642788,0x1d7927e227a8a0a5,0x18b5a7faa7fe1648,0xa7fa98b51a4627f6,0x2750227c1fc6a7c3,0x2105a799a7f69a46,0xa58425cb26dd241d,0x26c2244820a5a7a8,0xa332a725a5ed255f,0xa5cb2584270e238b,0x27f19bd6a2d7a73b,0xa3e3a6f6a513262f,0x9f0327ce27ea9cb2
.quad 0x27b6a044a513a62f,0xa6c2a4489cb227ea,0x124827ff270ea38b,0x264fa4eca73ba2d7,0xa7ce9f0320a527a8,0x21052799255fa5ed,0x2332a725a7f61a46,0xa7ff9248241d26dd,0x260f253a1a46a7f6,0x21c2a777a7c31fc6,0xa68a249b27a820a5,0x260f253a1648a7fe,0xa1c2a777a38b270e,0xa6f623e327882164,0x27f19bd6a62fa513,0x9d79a7e2a4c4266d
.quad 0x9bd627f1262fa513,0x27e21d79a4c4a66d,0xa777a1c2238b270e,0xa3e326f62788a164,0x249ba68aa7a820a5,0xa53aa60f164827fe,0x253a260f9a46a7f6,0x2777a1c2a7c39fc6,0xa725233227f61a46,0x124827ff241da6dd,0x9f03a7cea0a527a8,0xa799a105255f25ed,0x27ff1248a70ea38b,0x24eca64fa73b22d7,0xa04427b62513a62f,0x244826c29cb2a7ea
.quad 0xa6f6a3e32513262f,0xa7ce1f0327ea1cb2,0x2584a5cba70e238b,0x1bd6a7f1a2d7273b,0x244826c2a0a5a7a8,0x27252332a5eda55f,0xa799210527f69a46,0xa5cb258426dda41d,0x98b5a7fa9a4627f6,0xa27ca7501fc627c3,0x27e21d79a7a8a0a5,0x27fa98b5a7fe9648,0xa27c2750238ba70e,0xa04427b62164a788,0xa64fa4ec262f2513,0xa68aa49b266d24c4
.quad 0xa448a6c2a6a72472,0x23e326f626dda41d,0x27f19bd69e3ea7d9,0xa7ff9248164827fe,0xa105279927d91e3e,0x2448a6c2a73ba2d7,0xa5cba584a47226a7,0x23322725266da4c4,0x2777a1c2a472a6a7,0xa7fa98b51cb227ea,0x98b527fa27d99e3e,0x249ba68aa788a164,0xa6f6a3e39e3e27d9,0x227c275025eda55f,0x268aa49ba6a7a472,0xa7f19bd61fc627c3
.quad 0x1d7927e226a7a472,0x24eca64fa7c39fc6,0xa7b6a0441e3e27d9,0x21c22777255fa5ed,0x253aa60fa7d99e3e,0xa7e29d7921642788,0x227c27502472a6a7,0x253aa60fa7ea9cb2,0xa7ff9248247226a7,0x2105279924c4a66d,0x2332a725a7d91e3e,0xa7ce9f0322d7273b,0x24ec264f1e3ea7d9,0x2584a5cba7fe9648,0xa7ce1f0326a72472,0x204427b6241da6dd
.quad 0x1f03a7cea6a72472,0xa7b6a044241d26dd,0x264f24ec9e3ea7d9,0x25cba584a7fe1648,0xa725233227d91e3e,0x1f0327ce22d7a73b,0x9248a7ffa47226a7,0xa799a10524c4266d,0x2750227ca472a6a7,0x260fa53aa7ea1cb2,0xa60f253a27d99e3e,0x1d7927e22164a788,0xa044a7b69e3e27d9,0xa777a1c2255f25ed,0x27e21d79a6a7a472,0x264fa4eca7c31fc6
.quad 0xa49b268a26a7a472,0x1bd627f11fc6a7c3,0xa3e3a6f61e3e27d9,0xa750a27c25ed255f,0x27fa98b5a7d99e3e,0x268aa49ba7882164,0xa1c227772472a6a7,0x18b527fa1cb2a7ea,0xa584a5cb247226a7,0xa725a332266d24c4,0x2799a105a7d91e3e,0x26c2a448a73b22d7,0x9bd627f11e3ea7d9,0x124827ff1648a7fe,0xa6c2a44826a72472,0xa6f6a3e326dd241d
.quad 0xa332a725a70e238b,0x227c2750273ba2d7,0x27e21d791a46a7f6,0xa799a1059fc627c3,0xa5cb2584262f2513,0x26f6a3e3a4c4a66d,0x9bd6a7f1a7a820a5,0x9f0327ce27fe1648,0x26f623e320a5a7a8,0xa49ba68aa55f25ed,0xa750227c2513262f,0x27f11bd69cb2a7ea,0x1f03a7cea7f61a46,0xa60f253a26dd241d,0x253a260f238ba70e,0x1248a7ffa7882164
.quad 0xa7fa18b5238b270e,0x25cb25842164a788,0x2448a6c2a7f69a46,0xa7fa18b5241d26dd,0x21c227772513a62f,0x24eca64fa7ea9cb2,0xa7b6a04420a527a8,0x1d7927e225eda55f,0x264fa4eca7a8a0a5,0xa6c2a448164827fe,0x124827ff262fa513,0x27b6a044a66da4c4,0xa68aa49b1a4627f6,0xa332272527c39fc6,0x2799a105a70ea38b,0xa1c2a777a2d7273b
.quad 0xa1052799270ea38b,0x277721c2a2d7a73b,0xa49ba68a9a4627f6,0xa725233227c31fc6,0x27ff1248a62fa513,0x2044a7b6a66d24c4,0xa4ec264f27a8a0a5,0x244826c21648a7fe,0xa044a7b6a0a527a8,0xa7e29d7925ed255f,0x277721c2a513a62f,0x264fa4eca7ea1cb2,0xa6c2244827f69a46,0x98b527fa241da6dd,0x18b5a7faa38b270e,0xa584a5cb21642788
.quad 0x260f253aa38ba70e,0x27ff9248a788a164,0xa7ce1f0327f61a46,0xa53a260f26dda41d,0x227ca750a513262f,0x9bd6a7f19cb227ea,0x23e326f6a0a5a7a8,0x268a249ba55fa5ed,0xa7f19bd627a820a5,0xa7ce1f0327fe9648,0x2584a5cba62f2513,0x23e3a6f6a4c4266d,0x1d7927e29a46a7f6,0x210527999fc6a7c3,0xa725a332270e238b,0xa750a27c273b22d7
.quad 0xa1c2a777a764221f,0x210527992788a164,0x27252332221fa764,0xa68aa49ba41d26dd,0xa7b62044221f2764,0x27ff92489cb2a7ea,0x2448a6c2a764a21f,0xa64f24ec25ed255f,0x1d7927e22764a21f,0x2044a7b6a7fe9648,0xa64fa4eca21f2764,0x21c22777266da4c4,0x27fa98b5a21fa764,0xa6c2a4489fc627c3,0xa58425cb2764221f,0x27fa98b5a2d7a73b
.quad 0x1248a7ffa764221f,0xa60f253a273b22d7,0x253a260f221fa764,0x1f03a7cea7c31fc6,0xa7f19bd6221f2764,0x227c275024c4a66d,0x268aa49ba764a21f,0xa6f6a3e3164827fe,0x9f0327ce2764a21f,0x27f19bd6a55fa5ed,0xa3e3a6f6a21f2764,0xa5cb258427ea1cb2,0x27992105a21fa764,0x1d79a7e2a6dd241d,0xa750227c2764221f,0x233227252164a788
.quad 0x227ca750a764221f,0xa725a33221642788,0x21052799221fa764,0x27e29d79a6dda41d,0xa6f6a3e3221f2764,0xa58425cb27ea9cb2,0x27ce9f03a764a21f,0x1bd6a7f1a55f25ed,0xa49b268a2764a21f,0x23e326f61648a7fe,0x9bd6a7f1a21f2764,0xa750a27c24c4266d,0x260f253aa21fa764,0x27ce9f03a7c39fc6,0xa7ff12482764221f,0xa53a260f273ba2d7
.quad 0x25cba584a764221f,0x18b5a7faa2d7273b,0x98b527fa221fa764,0x244826c29fc6a7c3,0xa4eca64f221f2764,0xa777a1c2266d24c4,0x27e21d79a764a21f,0x27b6a044a7fe1648,0xa6c224482764a21f,0xa4ec264f25eda55f,0x2044a7b6a21f2764,0x1248a7ff9cb227ea,0x23322725a21fa764,0x249b268aa41da6dd,0xa777a1c22764221f,0xa799a10527882164
.quad 0xa044a7b6a7a820a5,0x1f0327ce27c39fc6,0x25cb25842513a62f,0xa4eca64fa5ed255f,0xa7ce9f039a4627f6,0x272523322164a788,0x2799a105a38ba70e,0xa7ff92481cb227ea,0xa53a260f270e238b,0x2750a27ca4c4a66d,0x1d79a7e2a7f61a46,0xa53a260f273b22d7,0x21c22777262fa513,0x2044a7b6a7fe1648,0xa64fa4eca0a527a8,0x1d7927e226dda41d
.quad 0x27f11bd6a0a5a7a8,0xa49ba68aa41d26dd,0xa750227c262f2513,0x26f623e31648a7fe,0x249ba68aa7f69a46,0xa7fa98b522d7273b,0x98b527fa270ea38b,0x2777a1c2a66da4c4,0xa332a725a38b270e,0xa58425cb27ea1cb2,0x26c224489a46a7f6,0x2105a799a7882164,0xa7ff92482513262f,0x1bd627f1255fa5ed,0x26f6a3e3a7a8a0a5,0xa448a6c29fc627c3
.quad 0xa3e326f627a8a0a5,0x26c224489fc6a7c3,0x9248a7ffa513262f,0xa7f19bd6255f25ed,0x244826c21a46a7f6,0x2799a105a788a164,0xa725a332238b270e,0xa5cb258427ea9cb2,0x27fa98b5a70ea38b,0x21c2a777a66d24c4,0xa68a249b27f69a46,0x18b527fa22d7a73b,0x227ca750a62f2513,0xa3e3a6f6164827fe,0x1bd627f120a5a7a8,0x268a249ba41da6dd
.quad 0xa4eca64f20a527a8,0xa7e29d7926dd241d,0x277721c2a62fa513,0x27b6a044a7fe9648,0xa7e21d7927f61a46,0xa60f253a273ba2d7,0x260fa53aa70e238b,0x227ca750a4c4266d,0xa1052799238ba70e,0x124827ff1cb2a7ea,0x9f03a7ce1a4627f6,0xa332a72521642788,0x258425cba513a62f,0x264f24eca5eda55f,0xa7b6a04427a820a5,0xa7ce9f0327c31fc6
.quad 0x9d79a7e2a7d91e3e,0x1bd627f127ea9cb2,0x23e326f626a7a472,0xa1c2a777a73b22d7,0xa60fa53aa47226a7,0x249b268a25eda55f,0x277721c21e3ea7d9,0xa60fa53aa41d26dd,0xa7ff92481e3e27d9,0x272523321fc6a7c3,0x2799a105a472a6a7,0xa7ce9f03164827fe,0xa64f24ec26a72472,0x27ff9248a164a788,0x2448a6c2a7d99e3e,0xa7b6204424c4266d
.quad 0x9f0327ce27d99e3e,0x26f6a3e3a66da4c4,0x9bd6a7f1a6a72472,0xa5cb258427882164,0x233227252472a6a7,0x2448a6c2a7fe9648,0xa5cba5849e3e27d9,0xa105279927c39fc6,0x2750227c9e3ea7d9,0x18b5a7faa6dd241d,0xa7fa98b5247226a7,0x1d7927e2255fa5ed,0x27b6a044a6a7a472,0xa27ca750a2d7273b,0xa68a249b27d91e3e,0x24ec264f1cb2a7ea
.quad 0x249ba68aa7d91e3e,0xa64fa4ec1cb227ea,0xa04427b626a7a472,0x2750227ca2d7a73b,0x98b5a7faa47226a7,0xa7e29d79255f25ed,0x227c27501e3ea7d9,0x27fa98b5a6dda41d,0xa584a5cb1e3e27d9,0xa799210527c31fc6,0x27252332a472a6a7,0x26c2a448a7fe1648,0xa7f19bd626a72472,0xa58425cb2788a164,0x27ce9f03a7d99e3e,0x23e3a6f6a66d24c4
.quad 0xa6c2244827d99e3e,0xa04427b624c4a66d,0x24eca64fa6a72472,0x1248a7ffa1642788,0xa10527992472a6a7,0x1f0327ce1648a7fe,0x9248a7ff9e3e27d9,0xa332a7251fc627c3,0x21c227779e3ea7d9,0x253a260fa41da6dd,0xa53aa60f247226a7,0xa68aa49b25ed255f,0x26f623e3a6a7a472,0x277721c2a73ba2d7,0xa7e29d7927d91e3e,0xa7f19bd627ea1cb2
.quad 0x98b5a7faa7f61a46,0x124827ff27fe9648,0x1f0327ce27a8a0a5,0x98b5a7faa7ea1cb2,0xa1c2a777a70e238b,0x1bd627f127c39fc6,0x23e326f6262fa513,0x9d79a7e2a7882164,0xa4eca64fa513262f,0x1f0327ce273ba2d7,0x25cb2584238ba70e,0xa044a7b6a6dd241d,0xa68aa49ba0a527a8,0x21052799266da4c4,0x272523321a46a7f6,0xa1c2a777a5ed255f
.quad 0xa799a1051a4627f6,0x227c2750255fa5ed,0x27e21d79a0a5a7a8,0xa332a725a4c4266d,0xa7ff9248238b270e,0x23e326f6241da6dd,0x27f19bd6a513a62f,0xa448a6c2a2d7273b,0xa7b62044262f2513,0x249b268a2164a788,0x2750a27ca70ea38b,0xa4eca64f9fc627c3,0xa6c2244827a820a5,0x253a260f1cb2a7ea,0x260fa53aa7f69a46,0xa584a5cb964827fe
.quad 0xa53a260f27f69a46,0x25cb25849648a7fe,0x2448a6c2a7a820a5,0xa60fa53a1cb227ea,0xa27c2750270ea38b,0x264f24ec9fc6a7c3,0x2044a7b6a62f2513,0xa68aa49b21642788,0x9bd627f12513a62f,0x26c22448a2d7a73b,0x9248a7ffa38b270e,0xa6f6a3e3241d26dd,0x1d7927e220a5a7a8,0x27252332a4c4a66d,0xa105a7999a4627f6,0xa750a27c255f25ed
.quad 0x233227259a46a7f6,0x277721c2a5eda55f,0xa49ba68a20a527a8,0xa799a105266d24c4,0x258425cba38ba70e,0x27b62044a6dda41d,0xa64fa4ec2513262f,0xa7ce9f03273b22d7,0x26f623e3a62fa513,0x27e21d79a788a164,0xa777a1c2270e238b,0xa7f19bd627c31fc6,0x27ce1f03a7a8a0a5,0x27fa18b5a7ea9cb2,0xa7fa98b527f61a46,0xa7ff924827fe1648
.quad 0x1248a7ffa8002800,0x18b5a7fa964827fe,0x18b5a7fa28002800,0x1f03a7ce9cb227ea,0x1bd6a7f1a8002800,0x21c2a7779fc627c3,0x1d79a7e228002800,0x23e3a6f6a1642788,0x1f03a7cea8002800,0x24eca64fa2d7273b,0x2044a7b628002800,0x25cba584a41d26dd,0x2105a799a8002800,0x268aa49ba4c4266d,0x21c2a77728002800,0x2725a332a55f25ed
.quad 0x227ca750a8002800,0x2799a105a5ed255f,0x2332a72528002800,0x27e29d79a66d24c4,0x23e3a6f6a8002800,0x27ff9248a6dd241d,0x2448a6c228002800,0x27f11bd6a73b22d7,0x249ba68aa8002800,0x27b62044a7882164,0x24eca64f28002800,0x2750227ca7c31fc6,0x253aa60fa8002800,0x26c22448a7ea1cb2,0x2584a5cb28002800,0x260f253aa7fe1648
.quad 0x25cba584a8002800,0x253a260fa7fe9648,0x260fa53a28002800,0x244826c2a7ea9cb2,0x264fa4eca8002800,0x227c2750a7c39fc6,0x268aa49b28002800,0x204427b6a788a164,0x26c2a448a8002800,0x1bd627f1a73ba2d7,0x26f6a3e328002800,0x924827ffa6dda41d,0x2725a332a8002800,0x9d7927e2a66da4c4,0x2750a27c28002800,0xa1052799a5eda55f
.quad 0x2777a1c2a8002800,0xa3322725a55fa5ed,0x2799a10528002800,0xa49b268aa4c4a66d,0x27b6a044a8002800,0xa58425cba41da6dd,0x27ce9f0328002800,0xa64f24eca2d7a73b,0x27e29d79a8002800,0xa6f623e3a164a788,0x27f19bd628002800,0xa77721c29fc6a7c3,0x27fa98b5a8002800,0xa7ce1f039cb2a7ea,0x27ff924828002800,0xa7fa18b59648a7fe
.quad 0x1bd6a7f19a4627f6,0x1d79a7e29cb227ea,0x21c2a777a0a527a8,0x23e3a6f6a2d7273b,0x249ba68aa38b270e,0x260fa53aa55f25ed,0x260fa53aa513262f,0x2777a1c2a6dd241d,0x2725a332a62f2513,0x27ff9248a7c31fc6,0x27ce9f03a70e238b,0x27992105a7fe9648,0x27ff1248a7a820a5,0x264f24eca788a164,0x27b62044a7f61a46,0x244826c2a66da4c4
.quad 0x26f623e3a7f69a46,0x1f0327cea4c4a66d,0x25cb2584a7a8a0a5,0x9bd627f1a164a788,0x244826c2a70ea38b,0xa33227259648a7fe,0x21052799a62fa513,0xa5cb25841fc6a7c3,0x18b527faa513a62f,0xa750227c241da6dd,0x9d7927e2a38ba70e,0xa7fa18b525eda55f,0xa27c2750a0a5a7a8,0xa7b6a044273ba2d7,0xa4ec264f9a46a7f6,0xa68aa49b27ea9cb2
.quad 0xa64f24ec1a46a7f6,0xa49ba68a27ea1cb2,0xa750227c20a5a7a8,0xa044a7b6273b22d7,0xa7e21d79238ba70e,0x18b5a7fa25ed255f,0xa7fa98b52513a62f,0x227ca750241d26dd,0xa799a105262fa513,0x2584a5cb1fc627c3,0xa6c2a448270ea38b,0x2725a332964827fe,0xa584a5cb27a8a0a5,0x27f19bd6a1642788,0xa3e3a6f627f69a46,0x27ce1f03a4c4266d
.quad 0xa044a7b627f61a46,0x26c22448a66d24c4,0x9248a7ff27a820a5,0x24ec264fa7882164,0x1f03a7ce270e238b,0x21052799a7fe1648,0x2332a725262f2513,0x924827ffa7c39fc6,0x253aa60f2513262f,0xa1c22777a6dda41d,0x268aa49b238b270e,0xa53a260fa55fa5ed,0x2777a1c220a527a8,0xa6f623e3a2d7a73b,0x27f19bd61a4627f6,0xa7e21d799cb2a7ea
.quad 0x1f03a7ce9e3e27d9,0x2044a7b69fc627c3,0x24eca64fa47226a7,0x25cba584a55f25ed,0x2725a332a6a72472,0x27ce9f03a7882164,0x27ff9248a7d91e3e,0x27992105a7ea9cb2,0x2750227ca7d99e3e,0x253a260fa66da4c4,0x253a260fa6a7a472,0x1d7927e2a2d7a73b,0x204427b6a472a6a7,0xa1c227771648a7fe,0x9d7927e29e3ea7d9,0xa64f24ec241da6dd
.quad 0xa49b268a1e3ea7d9,0xa7f11bd626dda41d,0xa6f623e32472a6a7,0xa750a27c27fe9648,0xa7fa18b526a7a472,0xa49ba68a273b22d7,0xa777a1c227d99e3e,0x98b5a7fa24c4266d,0xa584a5cb27d91e3e,0x2332a7251cb227ea,0xa105a79926a72472,0x26c2a448a1642788,0x1bd6a7f1247226a7,0x27ff9248a5ed255f,0x2448a6c21e3e27d9,0x26f623e3a7c31fc6
.quad 0x26c2a4489e3e27d9,0x23e326f6a7c39fc6,0x27f19bd6a47226a7,0x924827ffa5eda55f,0x27992105a6a72472,0xa44826c2a164a788,0x25cb2584a7d91e3e,0xa72523321cb2a7ea,0x21c22777a7d99e3e,0xa7fa98b524c4a66d,0x98b527faa6a7a472,0xa68aa49b273ba2d7,0xa3e326f6a472a6a7,0xa27ca75027fe1648,0xa68a249b9e3ea7d9,0x1bd6a7f126dd241d
.quad 0xa7e21d791e3ea7d9,0x24eca64f241d26dd,0xa7b6a0442472a6a7,0x2777a1c2164827fe,0xa60fa53a26a7a472,0x27e21d79a2d7273b,0xa27ca75027d99e3e,0x260f253aa66d24c4,0x1248a7ff27d91e3e,0x21052799a7ea1cb2,0x2332a72526a72472,0x9f0327cea788a164,0x264fa4ec247226a7,0xa58425cba55fa5ed,0x27ce9f031e3e27d9,0xa7b620449fc6a7c3
.quad 0x2105a799a0a527a8,0x21c2a777a1642788,0x268aa49ba62f2513,0x2725a332a6dd241d,0x27ff1248a7f61a46,0x27b62044a7ea9cb2,0x264f24eca70ea38b,0x244826c2a55fa5ed,0x204427b6a38ba70e,0x9d7927e29648a7fe,0xa1c227771a46a7f6,0xa64f24ec24c4a66d,0xa6c224482513a62f,0xa7fa98b527c39fc6,0xa7fa98b527a8a0a5,0xa584a5cb273b22d7
.quad 0xa60fa53a27a820a5,0x9248a7ff22d7273b,0x9f03a7ce2513262f,0x253aa60f9fc627c3,0x227ca7501a4627f6,0x27f19bd6a66d24c4,0x26f6a3e3a38b270e,0x268a249ba7fe9648,0x27f11bd6a70e238b,0x1f0327cea5eda55f,0x25cb2584a7f69a46,0xa3e326f69cb2a7ea,0x1d7927e2a62fa513,0xa7992105241da6dd,0xa3322725a0a5a7a8,0xa750a27c2788a164
.quad 0xa725233220a5a7a8,0xa27ca75027882164,0xa7e29d79262fa513,0x2105a799241d26dd,0xa584a5cb27f69a46,0x26f6a3e39cb227ea,0x9bd6a7f1270e238b,0x27ce1f03a5ed255f,0x23e3a6f6238b270e,0x249b268aa7fe1648,0x2750a27c9a4627f6,0x9bd627f1a66da4c4,0x27ce1f03a513262f,0xa60f253a9fc6a7c3,0x253a260fa7a820a5,0xa7ff924822d7a73b
.quad 0x18b527faa7a8a0a5,0xa5cba584273ba2d7,0xa44826c2a513a62f,0x98b5a7fa27c31fc6,0xa77721c29a46a7f6,0x24eca64f24c4266d,0xa7b6a044238ba70e,0x27e29d79964827fe,0xa4eca64f270ea38b,0x26c22448a55f25ed,0x9248a7ff27f61a46,0x204427b6a7ea1cb2,0x249ba68a262f2513,0xa3322725a6dda41d,0x2799a10520a527a8,0xa77721c2a164a788
.quad 0x227ca750a21f2764,0x2332a725a2d7273b,0x2799a105a764221f,0x27e29d79a7c31fc6,0x26f623e3a764a21f,0x25cb2584a66da4c4,0x1f0327cea21fa764,0x9bd627f19648a7fe,0xa49b268a221fa764,0xa6f623e325eda55f,0xa7f11bd62764a21f,0xa750a27c27ea1cb2,0xa60fa53a2764221f,0x9f03a7ce241d26dd,0x9248a7ff221f2764,0x253aa60fa1642788
.quad 0x25cba584a21f2764,0x27fa18b5a7882164,0x27fa18b5a764221f,0x244826c2a6dda41d,0x24ec264fa764a21f,0xa1c227779cb2a7ea,0x9d7927e2a21fa764,0xa7b62044255fa5ed,0xa6c22448221fa764,0xa64fa4ec27fe1648,0xa7b6a0442764a21f,0x1248a7ff24c4266d,0xa332a7252764221f,0x268aa49b9fc627c3,0x21c2a777221f2764,0x27992105a73b22d7
.quad 0x2777a1c2a21f2764,0x21052799a73ba2d7,0x27252332a764221f,0xa49b268a9fc6a7c3,0x204427b6a764a21f,0xa7ff124824c4a66d,0xa44826c2a21fa764,0xa4eca64f27fe9648,0xa7e21d79221fa764,0x2044a7b6255f25ed,0xa64fa4ec2764a21f,0x2777a1c29cb227ea,0x98b5a7fa2764221f,0x26c22448a6dd241d,0x2584a5cb221f2764,0x18b527faa788a164
.quad 0x27ff1248a21f2764,0xa60f253aa164a788,0x253a260fa764221f,0xa7ce9f03241da6dd,0x9bd627f1a764a21f,0xa27ca75027ea9cb2,0xa68a249ba21fa764,0x23e3a6f625ed255f,0xa7ce9f03221fa764,0x27f19bd6964827fe,0xa3e3a6f62764a21f,0x258425cba66d24c4,0x2105a7992764221f,0x9d7927e2a7c39fc6,0x2750a27c221f2764,0xa7252332a2d7a73b
.quad 0x23e3a6f6a38b270e,0x2448a6c2a41d26dd,0x27ff9248a7f61a46,0x27f11bd6a7fe9648,0x244826c2a513a62f,0x21052799a2d7a73b,0xa332272520a5a7a8,0xa5cb258424c4a66d,0xa7fa18b527a8a0a5,0xa777a1c227ea1cb2,0xa49ba68a262f2513,0x98b5a7fa21642788,0x227ca7509a4627f6,0x26f6a3e3a55f25ed,0x27f19bd6a70e238b,0x268a249ba7c39fc6
.quad 0x24ec264fa70ea38b,0x9d7927e29fc6a7c3,0xa1c227779a46a7f6,0xa7b6204425eda55f,0xa7e21d79262fa513,0xa53aa60f27882164,0xa53aa60f27a820a5,0x227ca7501cb227ea,0x2105a79920a527a8,0x27ff9248a66d24c4,0x27ce9f03a513262f,0x23322725a73ba2d7,0x258425cba7f69a46,0xa4ec264f9648a7fe,0xa04427b6a38ba70e,0xa7ce9f0326dda41d
.quad 0xa7b62044238ba70e,0x9f03a7ce26dd241d,0xa5cba58427f69a46,0x264fa4ec964827fe,0x1f03a7ce2513262f,0x27252332a73b22d7,0x2799a105a0a527a8,0x924827ffa66da4c4,0x260f253aa7a820a5,0xa750227c1cb2a7ea,0x9d7927e2a62fa513,0xa60fa53a2788a164,0xa77721c21a46a7f6,0x2044a7b625ed255f,0xa64fa4ec270ea38b,0x27e29d799fc627c3
.quad 0x1bd6a7f1270e238b,0x249b268aa7c31fc6,0x2750a27c1a4627f6,0xa3e326f6a55fa5ed,0x268a249ba62f2513,0xa7fa98b52164a788,0x98b527faa7a8a0a5,0xa1c2a77727ea9cb2,0xa7252332a0a5a7a8,0x2584a5cb24c4266d,0xa6c2a4482513a62f,0x27992105a2d7273b,0x1248a7ff27f61a46,0x1bd627f1a7fe1648,0x26f6a3e3238b270e,0xa6c22448a41da6dd
.quad 0x249ba68aa47226a7,0x24eca64fa4c4266d,0x27b62044a7d99e3e,0x2750227ca788a164,0x18b527fa9e3ea7d9,0x9d7927e21648a7fe,0xa750227c26a7a472,0xa7fa18b527c39fc6,0xa584a5cb26a72472,0xa105a799241d26dd,0x2332a7259e3e27d9,0x26c2a448a55f25ed,0x27f11bd6a7d91e3e,0x25cb2584a73ba2d7,0x1f0327cea472a6a7,0xa3e326f61cb2a7ea
.quad 0xa6c224482472a6a7,0xa7b6a04427ea9cb2,0xa64fa4ec27d91e3e,0x1248a7ff22d7273b,0x2105a7991e3e27d9,0x27ce9f03a5ed255f,0x27ff9248a6a72472,0x23322725a6dda41d,0x21c22777a6a7a472,0xa60f253a1fc6a7c3,0xa60f253a1e3ea7d9,0xa68aa49b27fe9648,0xa6f6a3e327d99e3e,0x21c2a77721642788,0x1d79a7e2247226a7,0x27f11bd6a66d24c4
.quad 0x27e29d79a47226a7,0x1bd627f1a66da4c4,0x23e326f6a7d99e3e,0xa77721c22164a788,0xa53a260f9e3ea7d9,0xa49ba68a27fe1648,0xa777a1c226a7a472,0x253aa60f1fc627c3,0x1248a7ff26a72472,0x27252332a6dd241d,0x2799a1059e3e27d9,0x9f0327cea5eda55f,0x24ec264fa7d91e3e,0xa7ff124822d7a73b,0xa44826c2a472a6a7,0xa044a7b627ea1cb2
.quad 0xa7ce9f032472a6a7,0x26f6a3e31cb227ea,0x9bd6a7f127d91e3e,0x258425cba73b22d7,0x2725a3321e3e27d9,0xa44826c2a55fa5ed,0x25cb2584a6a72472,0xa799a105241da6dd,0xa27c2750a6a7a472,0x18b5a7fa27c31fc6,0xa7fa98b51e3ea7d9,0x27e29d79164827fe,0xa044a7b627d99e3e,0x227c2750a7882164,0x268aa49b247226a7,0xa64f24eca4c4a66d
.quad 0x253aa60fa513262f,0x2584a5cba55f25ed,0x26c22448a70ea38b,0x260f253aa66da4c4,0xa27c275020a5a7a8,0xa4ec264f241da6dd,0xa7b6a04427f61a46,0xa68aa49b273b22d7,0x1bd6a7f11a4627f6,0x2448a6c2a1642788,0x27ff9248a7a820a5,0x26f623e3a7c39fc6,0x1d7927e2a38ba70e,0xa33227251cb2a7ea,0xa7992105262fa513,0xa750a27c27fe1648
.quad 0xa332a725262f2513,0x21c2a777164827fe,0x268aa49ba38b270e,0x27992105a7ea1cb2,0x258425cba7a8a0a5,0xa04427b69fc6a7c3,0xa4ec264f1a46a7f6,0xa7ce9f032788a164,0xa6f6a3e327f69a46,0x1d79a7e222d7273b,0x21c2a77720a527a8,0x27f11bd6a6dd241d,0x27ce1f03a70e238b,0x98b527faa4c4a66d,0x98b527faa513a62f,0xa7ff924825eda55f
.quad 0xa7fa18b52513a62f,0x9248a7ff25ed255f,0x9f03a7ce270e238b,0x27fa98b5a4c4266d,0x2777a1c2a0a527a8,0x1bd627f1a6dda41d,0x23e326f6a7f69a46,0xa7e21d7922d7a73b,0xa64f24ec9a46a7f6,0x9f03a7ce27882164,0xa5cba58427a8a0a5,0x27b6a0449fc627c3,0x249ba68a238b270e,0x21052799a7ea9cb2,0x27252332a62f2513,0xa77721c21648a7fe
.quad 0xa1052799a62fa513,0xa27ca75027fe9648,0xa7e29d79238ba70e,0x2725a3321cb227ea,0x1248a7ff27a820a5,0x23e326f6a7c31fc6,0x27f19bd69a4627f6,0xa6c22448a164a788,0x204427b6a7f61a46,0xa49ba68a273ba2d7,0xa750227ca0a5a7a8,0x264fa4ec241d26dd,0xa448a6c2270ea38b,0x253a260fa66d24c4,0x260fa53a2513262f,0xa5cb2584a55fa5ed
.quad 0x25cba584a5a825a8,0x260fa53aa5ed255f,0x253a260fa5a8a5a8,0x244826c2a4c4a66d,0xa64f24ec25a8a5a8,0xa750227c26dda41d,0xa49ba68a25a825a8,0xa044a7b622d7273b,0x26c2a448a5a825a8,0x27f19bd6a7882164,0x23e326f6a5a8a5a8,0x924827ff9fc6a7c3,0xa725233225a8a5a8,0xa7e29d7927ea9cb2,0xa27ca75025a825a8,0x2105a799164827fe
.quad 0x2777a1c2a5a825a8,0x27252332a7fe9648,0x21052799a5a8a5a8,0xa49b268a1cb2a7ea,0xa7b6204425a8a5a8,0xa5cba58427c31fc6,0x9f03a7ce25a825a8,0x264fa4eca1642788,0x27e29d79a5a825a8,0x23e326f6a73ba2d7,0x1bd627f1a5a8a5a8,0xa77721c2241da6dd,0xa7fa18b525a8a5a8,0x9f03a7ce266d24c4,0x9248a7ff25a825a8,0x27fa98b5a55f25ed
.quad 0x27ff1248a5a825a8,0x98b527faa55fa5ed,0x98b527faa5a8a5a8,0xa7ce9f03266da4c4,0xa7f19bd625a8a5a8,0x21c2a777241d26dd,0x1d79a7e225a825a8,0x26f623e3a73b22d7,0x27ce1f03a5a825a8,0xa4ec264fa164a788,0xa04427b6a5a8a5a8,0xa584a5cb27c39fc6,0xa799a10525a8a5a8,0x268aa49b1cb227ea,0x21c2a77725a825a8,0x23322725a7fe1648
.quad 0x2750227ca5a825a8,0xa79921051648a7fe,0xa3322725a5a8a5a8,0x9d79a7e227ea1cb2,0xa6f6a3e325a8a5a8,0x27ff92489fc627c3,0x2448a6c225a825a8,0x9bd627f1a788a164,0x268a249ba5a825a8,0xa7b6a04422d7a73b,0xa4ec264fa5a8a5a8,0x227ca75026dd241d,0xa60fa53a25a8a5a8,0x26c22448a4c4266d,0x2584a5cb25a825a8,0xa53a260fa5eda55f
.quad 0x264fa4eca62f2513,0x268aa49ba66d24c4,0x227c2750a38ba70e,0x204427b6a164a788,0xa7e21d7927a8a0a5,0xa7fa98b527fe9648,0x18b5a7fa1a4627f6,0x227ca7509fc627c3,0x27992105a7f69a46,0x25cb2584a6dda41d,0xa44826c220a5a7a8,0xa725233225eda55f,0xa584a5cb270e238b,0x9bd6a7f122d7273b,0x26f6a3e3a513262f,0x27ce1f03a7ea1cb2
.quad 0x204427b6a513a62f,0xa44826c21cb2a7ea,0xa7ff1248270ea38b,0xa4eca64f273b22d7,0x1f03a7ce20a527a8,0x2799a105a55f25ed,0x27252332a7f61a46,0x924827ffa41da6dd,0xa53a260f1a46a7f6,0xa777a1c227c39fc6,0xa49ba68a27a820a5,0x253aa60f964827fe,0x2777a1c2a38b270e,0x23e326f6a788a164,0x1bd627f1a62fa513,0xa7e21d7924c4a66d
.quad 0xa7f19bd6262fa513,0x1d79a7e224c4266d,0x21c2a777238b270e,0x26f623e3a7882164,0x268a249ba7a820a5,0xa60f253a9648a7fe,0xa60f253a9a46a7f6,0xa1c2a77727c31fc6,0xa332a72527f61a46,0x27ff9248a41d26dd,0x27ce9f03a0a527a8,0xa1052799a55fa5ed,0x924827ffa70ea38b,0xa64fa4ec273ba2d7,0xa7b6a0442513a62f,0x26c2a4481cb227ea
.quad 0x23e3a6f62513262f,0x1f0327cea7ea9cb2,0x25cb2584a70e238b,0xa7f19bd622d7a73b,0xa6c22448a0a5a7a8,0x2332a72525ed255f,0xa105a79927f69a46,0x258425cba6dd241d,0x27fa98b59a4627f6,0xa750227c9fc6a7c3,0x9d7927e2a7a8a0a5,0x98b5a7fa27fe1648,0xa750a27c238ba70e,0x27b62044a1642788,0x24eca64f262f2513,0xa49b268aa66da4c4
.quad 0x26c2a448a6a72472,0x26f6a3e3a6dd241d,0x1bd627f19e3ea7d9,0x924827ff9648a7fe,0xa799a10527d91e3e,0xa6c2a448273b22d7,0x2584a5cba47226a7,0x2725a332a66d24c4,0x21c22777a472a6a7,0x98b527fa9cb2a7ea,0xa7fa98b527d99e3e,0xa68aa49b27882164,0x23e3a6f69e3e27d9,0x2750a27ca5ed255f,0x249b268aa6a7a472,0x9bd627f19fc6a7c3
.quad 0xa7e21d7926a7a472,0xa64fa4ec27c31fc6,0x2044a7b61e3e27d9,0x2777a1c2a55f25ed,0x260f253aa7d99e3e,0x9d7927e2a164a788,0xa750227c2472a6a7,0xa60fa53a27ea1cb2,0x1248a7ff247226a7,0x2799a105a4c4266d,0x27252332a7d91e3e,0x9f0327cea2d7a73b,0xa64f24ec1e3ea7d9,0xa5cba58427fe1648,0x9f03a7ce26a72472,0x27b6a044a41d26dd
.quad 0x27ce1f03a6a72472,0xa04427b6a41da6dd,0xa4ec264f9e3ea7d9,0xa584a5cb27fe9648,0xa332a72527d91e3e,0x27ce9f03a2d7273b,0x27ff9248a47226a7,0xa1052799a4c4a66d,0xa27c2750a472a6a7,0xa53aa60f27ea9cb2,0xa53aa60f27d99e3e,0x27e29d79a1642788,0x27b6a0449e3e27d9,0xa1c22777a55fa5ed,0x9d7927e2a6a7a472,0xa4eca64f27c39fc6
.quad 0xa68aa49b26a7a472,0x27f19bd69fc627c3,0x26f6a3e31e3e27d9,0xa27c2750a5eda55f,0x18b527faa7d99e3e,0xa49ba68a2788a164,0xa777a1c22472a6a7,0x27fa98b59cb227ea,0x25cba584247226a7,0xa3322725a66da4c4,0x21052799a7d91e3e,0xa448a6c2273ba2d7,0xa7f19bd61e3ea7d9,0x27ff9248964827fe,0x2448a6c226a72472,0xa3e326f6a6dda41d
.quad 0x2725a332a70e238b,0x2750a27ca73b22d7,0x9d7927e21a46a7f6,0xa10527991fc6a7c3,0xa584a5cb262f2513,0xa3e3a6f624c4266d,0x27f19bd6a7a820a5,0x27ce1f03a7fe9648,0xa3e326f620a5a7a8,0xa68a249b255fa5ed,0xa27ca7502513262f,0x1bd6a7f11cb227ea,0x27ce1f03a7f61a46,0x253a260fa6dda41d,0xa60f253a238ba70e,0xa7ff92482788a164
.quad 0x98b5a7fa238b270e,0x2584a5cba1642788,0x26c22448a7f69a46,0x18b527faa41da6dd,0xa77721c22513a62f,0xa64fa4ec27ea1cb2,0x2044a7b620a527a8,0x27e29d79a5ed255f,0x24ec264fa7a8a0a5,0xa44826c29648a7fe,0xa7ff1248262fa513,0xa044a7b6266d24c4,0x249ba68a1a4627f6,0x27252332a7c31fc6,0x21052799a70ea38b,0xa77721c222d7a73b
.quad 0xa799a105270ea38b,0x21c2a77722d7273b,0x268aa49b9a4627f6,0x23322725a7c39fc6,0x924827ffa62fa513,0xa7b6a044266da4c4,0xa64fa4ec27a8a0a5,0x26c2a448964827fe,0x27b6a044a0a527a8,0x9d7927e2a5eda55f,0xa1c22777a513a62f,0xa4eca64f27ea9cb2,0xa448a6c227f69a46,0x27fa18b5a41d26dd,0x27fa18b5a38b270e,0xa5cb2584a164a788
.quad 0xa53a260fa38ba70e,0x9248a7ff27882164,0x9f03a7ce27f61a46,0x260f253aa6dd241d,0x2750227ca513262f,0xa7f11bd61cb2a7ea,0xa6f623e3a0a5a7a8,0x249ba68a255f25ed,0x1bd6a7f127a820a5,0x1f0327cea7fe1648,0x25cb2584a62f2513,0xa6f6a3e324c4a66d,0xa7e21d799a46a7f6,0x2799a1051fc627c3,0x2332a725270e238b,0xa27c2750a73ba2d7
.quad 0x2777a1c2a764221f,0x2799a105a7882164,0xa3322725221fa764,0xa49b268a241da6dd,0xa044a7b6221f2764,0x9248a7ff1cb227ea,0x26c22448a764a21f,0x24ec264fa5eda55f,0xa7e21d792764a21f,0xa7b6a04427fe1648,0x24eca64fa21f2764,0x2777a1c2a66d24c4,0x18b527faa21fa764,0xa44826c21fc6a7c3,0xa5cba5842764221f,0x98b5a7fa22d7273b
.quad 0x27ff1248a764221f,0x253a260fa73ba2d7,0xa60f253a221fa764,0xa7ce9f0327c39fc6,0x1bd6a7f1221f2764,0x2750a27ca4c4266d,0x249b268aa764a21f,0xa3e326f69648a7fe,0xa7ce9f032764a21f,0x9bd6a7f1255f25ed,0x26f6a3e3a21f2764,0x258425cba7ea9cb2,0xa1052799a21fa764,0xa7e29d7926dda41d,0xa27ca7502764221f,0x2725a332a1642788
.quad 0x2750227ca764221f,0xa3322725a164a788,0xa7992105221fa764,0x9d79a7e226dd241d,0x23e3a6f6221f2764,0x25cb2584a7ea1cb2,0x1f0327cea764a21f,0xa7f19bd6255fa5ed,0xa68aa49b2764a21f,0x26f6a3e3964827fe,0x27f19bd6a21f2764,0xa27c2750a4c4a66d,0xa53a260fa21fa764,0x9f03a7ce27c31fc6,0x9248a7ff2764221f,0x260f253aa73b22d7
.quad 0x258425cba764221f,0xa7fa98b522d7a73b,0xa7fa98b5221fa764,0x26c2a4481fc627c3,0x264fa4ec221f2764,0xa1c22777a66da4c4,0x9d7927e2a764a21f,0xa044a7b627fe9648,0xa448a6c22764a21f,0x264f24eca5ed255f,0x27b62044a21f2764,0xa7ff92481cb2a7ea,0xa7252332a21fa764,0x268aa49b241d26dd,0x21c2a7772764221f,0xa1052799a788a164
.quad 0x27b6a044a7a820a5,0x27ce9f03a7c31fc6,0xa58425cb2513a62f,0xa64f24ec25eda55f,0x1f03a7ce9a4627f6,0x2332a725a1642788,0x21052799a38ba70e,0x924827ff9cb2a7ea,0xa60fa53a270e238b,0xa27ca75024c4266d,0x27e21d79a7f61a46,0x260f253aa73ba2d7,0xa77721c2262fa513,0xa7b6a04427fe9648,0x24eca64fa0a527a8,0x27e29d79a6dd241d
.quad 0x9bd627f1a0a5a7a8,0xa68a249b241da6dd,0xa27ca750262f2513,0x23e3a6f6964827fe,0x268a249ba7f69a46,0x98b527faa2d7a73b,0xa7fa98b5270ea38b,0xa1c2a777266d24c4,0x2725a332a38b270e,0x25cb2584a7ea9cb2,0xa44826c29a46a7f6,0xa799a1052788a164,0x1248a7ff2513262f,0x27f19bd6a55f25ed,0x23e326f6a7a8a0a5,0xa6c224481fc6a7c3
.quad 0xa6f6a3e327a8a0a5,0x2448a6c21fc627c3,0x27ff9248a513262f,0x9bd627f1a55fa5ed,0xa6c224481a46a7f6,0xa105a79927882164,0x2332a725238b270e,0x258425cba7ea1cb2,0x18b527faa70ea38b,0xa777a1c2266da4c4,0xa49ba68a27f69a46,0x27fa98b5a2d7273b,0x2750227ca62f2513,0xa6f623e39648a7fe,0xa7f11bd620a5a7a8,0x249ba68a241d26dd
.quad 0x264fa4ec20a527a8,0x9d7927e2a6dda41d,0xa1c22777a62fa513,0xa044a7b627fe1648,0x9d79a7e227f61a46,0x253a260fa73b22d7,0x253a260fa70e238b,0xa750a27c24c4a66d,0xa799a105238ba70e,0x27ff92489cb227ea,0x27ce9f031a4627f6,0xa7252332a164a788,0xa5cb2584a513a62f,0x24eca64f25ed255f,0x2044a7b627a820a5,0x9f0327cea7c39fc6
.quad 0x27e29d79a7d91e3e,0x27f19bd6a7ea1cb2,0xa6f623e326a7a472,0xa77721c2273ba2d7,0x253aa60fa47226a7,0x268aa49ba5ed255f,0xa1c227771e3ea7d9,0xa53a260f241da6dd,0x1248a7ff1e3e27d9,0x2332a7259fc627c3,0x21052799a472a6a7,0x9f0327ce9648a7fe,0xa4eca64f26a72472,0x9248a7ff21642788,0x26c22448a7d99e3e,0x204427b6a4c4a66d
.quad 0xa7ce9f0327d99e3e,0xa3e3a6f6266d24c4,0x27f19bd6a6a72472,0x258425cba788a164,0xa72523322472a6a7,0xa6c2a44827fe1648,0x2584a5cb9e3e27d9,0x27992105a7c31fc6,0xa27c27509e3ea7d9,0xa7fa98b526dda41d,0x18b5a7fa247226a7,0x27e29d79a55f25ed,0x204427b6a6a7a472,0xa750227c22d7a73b,0xa49ba68a27d91e3e,0x264fa4ec9cb227ea
.quad 0x268a249ba7d91e3e,0xa4ec264f9cb2a7ea,0xa7b6a04426a7a472,0x227ca75022d7273b,0x27fa98b5a47226a7,0x9d7927e2a55fa5ed,0xa750227c1e3ea7d9,0x98b5a7fa26dd241d,0x25cba5841e3e27d9,0x21052799a7c39fc6,0xa3322725a472a6a7,0xa448a6c227fe9648,0x1bd6a7f126a72472,0x25cb2584a7882164,0x1f0327cea7d99e3e,0xa6f6a3e3266da4c4
.quad 0xa448a6c227d99e3e,0x27b62044a4c4266d,0x264f24eca6a72472,0xa7ff92482164a788,0xa799a1052472a6a7,0x27ce9f03964827fe,0x27ff92489e3e27d9,0xa72523329fc6a7c3,0xa77721c29e3ea7d9,0x260fa53a241d26dd,0x260fa53a247226a7,0xa49b268aa5eda55f,0xa3e326f6a6a7a472,0x21c2a777273b22d7,0x1d79a7e227d91e3e,0x9bd627f1a7ea9cb2
.quad 0x27fa98b5a7f61a46,0x27ff9248a7fe1648,0xa7ce1f0327a8a0a5,0xa7fa18b527ea9cb2,0x2777a1c2a70e238b,0x27f19bd6a7c31fc6,0xa6f623e3262fa513,0xa7e21d792788a164,0x264fa4eca513262f,0x27ce9f03a73b22d7,0xa58425cb238ba70e,0xa7b6204426dda41d,0x249ba68aa0a527a8,0x2799a105a66d24c4,0xa33227251a46a7f6,0xa77721c225eda55f
.quad 0x2105a7991a4627f6,0x2750a27ca55f25ed,0x9d7927e2a0a5a7a8,0xa725233224c4a66d,0x1248a7ff238b270e,0x26f6a3e3a41d26dd,0x1bd627f1a513a62f,0xa6c2244822d7a73b,0xa044a7b6262f2513,0x268aa49ba1642788,0x227c2750a70ea38b,0xa64f24ec1fc6a7c3,0xa448a6c227a820a5,0x260fa53a9cb227ea,0x253a260fa7f69a46,0xa5cb25841648a7fe
.quad 0xa60fa53a27f69a46,0x2584a5cb164827fe,0x26c22448a7a820a5,0xa53a260f9cb2a7ea,0xa750a27c270ea38b,0x24eca64f1fc627c3,0x27b62044a62f2513,0xa49b268aa164a788,0xa7f19bd62513a62f,0x2448a6c222d7273b,0x27ff9248a38b270e,0xa3e326f6a41da6dd,0xa7e21d7920a5a7a8,0x2332a72524c4266d,0x2799a1059a4627f6,0xa27c2750a55fa5ed
.quad 0xa72523329a46a7f6,0x21c2a77725ed255f,0x268aa49b20a527a8,0xa1052799a66da4c4,0xa5cb2584a38ba70e,0x2044a7b626dd241d,0x24eca64f2513262f,0x9f0327cea73ba2d7,0xa3e326f6a62fa513,0x1d79a7e227882164,0x21c2a777270e238b,0x9bd627f1a7c39fc6,0x9f0327cea7a8a0a5,0x18b5a7fa27ea1cb2,0x18b5a7fa27f61a46,0x924827ffa7fe9648
.quad 0x27ff1248a8002800,0xa7fa98b51648a7fe,0x27fa18b528002800,0xa7ce9f031cb2a7ea,0x27f11bd6a8002800,0xa777a1c21fc6a7c3,0x27e21d7928002800,0xa6f6a3e32164a788,0x27ce1f03a8002800,0xa64fa4ec22d7a73b,0x27b6204428002800,0xa584a5cb241da6dd,0x27992105a8002800,0xa49ba68a24c4a66d,0x277721c228002800,0xa332a725255fa5ed
.quad 0x2750227ca8002800,0xa105a79925eda55f,0x2725233228002800,0x9d79a7e2266da4c4,0x26f623e3a8002800,0x9248a7ff26dda41d,0x26c2244828002800,0x1bd6a7f1273ba2d7,0x268a249ba8002800,0x2044a7b62788a164,0x264f24ec28002800,0x227ca75027c39fc6,0x260f253aa8002800,0x2448a6c227ea9cb2,0x25cb258428002800,0x253aa60f27fe9648
.quad 0x258425cba8002800,0x260fa53a27fe1648,0x253a260f28002800,0x26c2a44827ea1cb2,0x24ec264fa8002800,0x2750a27c27c31fc6,0x249b268a28002800,0x27b6a04427882164,0x244826c2a8002800,0x27f19bd6273b22d7,0x23e326f628002800,0x27ff124826dd241d,0x23322725a8002800,0x27e21d79266d24c4,0x227c275028002800,0x2799210525ed255f
.quad 0x21c22777a8002800,0x27252332255f25ed,0x2105279928002800,0x268a249b24c4266d,0x204427b6a8002800,0x25cb2584241d26dd,0x1f0327ce28002800,0x24ec264f22d7273b,0x1d7927e2a8002800,0x23e326f621642788,0x1bd627f128002800,0x21c227771fc627c3,0x18b527faa8002800,0x1f0327ce1cb227ea,0x124827ff28002800,0x18b527fa164827fe
.quad 0x27f11bd69a4627f6,0xa7e29d791cb2a7ea,0x277721c2a0a527a8,0xa6f6a3e322d7a73b,0x268a249ba38b270e,0xa53aa60f255fa5ed,0x253a260fa513262f,0xa1c2a77726dda41d,0x23322725a62f2513,0x9248a7ff27c39fc6,0x1f0327cea70e238b,0x2105a79927fe1648,0x924827ffa7a820a5,0x24eca64f27882164,0xa04427b6a7f61a46,0x26c2a448266d24c4
.quad 0xa3e326f6a7f69a46,0x27ce9f0324c4266d,0xa58425cba7a8a0a5,0x27f11bd621642788,0xa6c22448a70ea38b,0x27252332164827fe,0xa7992105a62fa513,0x258425cb9fc627c3,0xa7fa18b5a513a62f,0x227c2750a41d26dd,0xa7e29d79a38ba70e,0x18b527faa5ed255f,0xa750a27ca0a5a7a8,0xa04427b6a73b22d7,0xa64fa4ec9a46a7f6,0xa49b268aa7ea1cb2
.quad 0xa4eca64f1a46a7f6,0xa68a249ba7ea9cb2,0xa27ca75020a5a7a8,0xa7b62044a73ba2d7,0x9d79a7e2238ba70e,0xa7fa98b5a5eda55f,0x18b5a7fa2513a62f,0xa750a27ca41da6dd,0x2105a799262fa513,0xa5cba5849fc6a7c3,0x2448a6c2270ea38b,0xa332a7251648a7fe,0x25cba58427a8a0a5,0x9bd6a7f12164a788,0x26f6a3e327f69a46,0x1f03a7ce24c4a66d
.quad 0x27b6a04427f61a46,0x2448a6c2266da4c4,0x27ff924827a820a5,0x264fa4ec2788a164,0x27ce1f03270e238b,0x2799a10527fe9648,0x27252332262f2513,0x27ff124827c31fc6,0x260f253a2513262f,0x277721c226dd241d,0x249b268a238b270e,0x260f253a255f25ed,0x21c2277720a527a8,0x23e326f622d7273b,0x1bd627f11a4627f6,0x1d7927e21cb227ea
.quad 0x27ce1f039e3e27d9,0xa7b6a0441fc6a7c3,0x264f24eca47226a7,0xa584a5cb255fa5ed,0x23322725a6a72472,0x9f03a7ce2788a164,0x124827ffa7d91e3e,0x2105a79927ea1cb2,0xa27c2750a7d99e3e,0x260fa53a266d24c4,0xa60f253aa6a7a472,0x27e29d7922d7273b,0xa7b62044a472a6a7,0x277721c2964827fe,0xa7e29d799e3ea7d9,0x24ec264fa41d26dd
.quad 0xa68aa49b1e3ea7d9,0x1bd627f1a6dd241d,0xa3e3a6f62472a6a7,0xa27c2750a7fe1648,0x98b5a7fa26a7a472,0xa68a249ba73ba2d7,0x21c2a77727d99e3e,0xa7fa18b5a4c4a66d,0x25cba58427d91e3e,0xa725a3329cb2a7ea,0x2799a10526a72472,0xa448a6c22164a788,0x27f11bd6247226a7,0x9248a7ff25eda55f,0x26c224481e3e27d9,0x23e3a6f627c39fc6
.quad 0x244826c29e3e27d9,0x26f6a3e327c31fc6,0x1bd627f1a47226a7,0x27ff124825ed255f,0xa1052799a6a72472,0x26c2244821642788,0xa58425cba7d91e3e,0x233227259cb227ea,0xa77721c2a7d99e3e,0x98b527faa4c4266d,0xa7fa98b5a6a7a472,0xa49b268aa73b22d7,0xa6f6a3e3a472a6a7,0xa750227ca7fe9648,0xa49ba68a9e3ea7d9,0xa7f19bd6a6dda41d
.quad 0x9d79a7e21e3ea7d9,0xa64fa4eca41da6dd,0x2044a7b62472a6a7,0xa1c2a7779648a7fe,0x253aa60f26a7a472,0x1d79a7e222d7a73b,0x2750a27c27d99e3e,0x253aa60f266da4c4,0x27ff124827d91e3e,0x2799a10527ea9cb2,0x2725233226a72472,0x27ce1f0327882164,0x24ec264f247226a7,0x25cb2584255f25ed,0x1f0327ce1e3e27d9,0x204427b61fc627c3
.quad 0x27992105a0a527a8,0xa777a1c22164a788,0x249b268aa62f2513,0xa332a72526dda41d,0x924827ffa7f61a46,0x2044a7b627ea1cb2,0xa4ec264fa70ea38b,0x26c2a448255f25ed,0xa7b62044a38ba70e,0x27e21d79164827fe,0xa777a1c21a46a7f6,0x24ec264fa4c4266d,0xa448a6c22513a62f,0x98b527faa7c31fc6,0x18b5a7fa27a8a0a5,0xa5cb2584a73ba2d7
.quad 0x253aa60f27a820a5,0xa7ff1248a2d7a73b,0x27ce9f032513262f,0xa60fa53a1fc6a7c3,0x2750227c1a4627f6,0x9bd6a7f1266da4c4,0x23e326f6a38b270e,0x249ba68a27fe1648,0x9bd627f1a70e238b,0x27ce9f0325ed255f,0xa58425cba7f69a46,0x26f623e31cb227ea,0xa7e21d79a62fa513,0x21052799a41d26dd,0xa725a332a0a5a7a8,0xa27c2750a7882164
.quad 0xa332a72520a5a7a8,0xa750227ca788a164,0x1d79a7e2262fa513,0xa799a105a41da6dd,0x25cba58427f69a46,0xa3e3a6f61cb2a7ea,0x27f19bd6270e238b,0x1f03a7ce25eda55f,0x26f623e3238b270e,0x268aa49b27fe9648,0x227c27509a4627f6,0x27f11bd6266d24c4,0x9f0327cea513262f,0x253a260f1fc627c3,0xa60f253aa7a820a5,0x924827ffa2d7273b
.quad 0xa7fa18b5a7a8a0a5,0xa58425cba73b22d7,0xa6c2a448a513a62f,0xa7fa18b5a7c39fc6,0xa1c2a7779a46a7f6,0xa64fa4eca4c4a66d,0x2044a7b6238ba70e,0x9d79a7e21648a7fe,0x264fa4ec270ea38b,0x2448a6c2255fa5ed,0x27ff924827f61a46,0x27b6a04427ea9cb2,0x268a249b262f2513,0x2725233226dd241d,0x2105279920a527a8,0x21c2277721642788
.quad 0x2750227ca21f2764,0xa725a33222d7a73b,0x21052799a764221f,0x9d79a7e227c39fc6,0xa3e326f6a764a21f,0x2584a5cb266d24c4,0xa7ce1f03a21fa764,0x27f11bd6164827fe,0xa68aa49b221fa764,0x23e326f6a5ed255f,0x9bd6a7f12764a21f,0xa27c2750a7ea9cb2,0x253aa60f2764221f,0xa7ce1f03a41da6dd,0x27ff9248221f2764,0xa60fa53a2164a788
.quad 0x258425cba21f2764,0x18b5a7fa2788a164,0x98b527faa764221f,0x26c2a44826dd241d,0xa64f24eca764a21f,0x277721c21cb227ea,0xa7e29d79a21fa764,0x204427b6a55f25ed,0xa448a6c2221fa764,0xa4ec264fa7fe9648,0x2044a7b62764a21f,0xa7ff9248a4c4a66d,0x2725a3322764221f,0xa49ba68a1fc6a7c3,0x277721c2221f2764,0x2105a799273ba2d7
.quad 0x21c22777a21f2764,0x2799a105273b22d7,0xa3322725a764221f,0x268a249b1fc627c3,0xa7b62044a764a21f,0x124827ffa4c4266d,0xa6c2a448a21fa764,0xa64f24eca7fe1648,0x9d79a7e2221fa764,0xa7b6a044a55fa5ed,0x24eca64f2764a21f,0xa1c2a7771cb2a7ea,0x27fa98b52764221f,0x2448a6c226dda41d,0x25cb2584221f2764,0x27fa98b527882164
.quad 0x924827ffa21f2764,0x253a260f21642788,0xa60f253aa764221f,0x9f0327cea41d26dd,0xa7f19bd6a764a21f,0xa750227ca7ea1cb2,0xa49ba68aa21fa764,0xa6f6a3e3a5eda55f,0x1f03a7ce221fa764,0x9bd6a7f11648a7fe,0x26f6a3e32764a21f,0x25cba584266da4c4,0x279921052764221f,0x27e21d7927c31fc6,0x227c2750221f2764,0x2332272522d7273b
.quad 0x26f623e3a38b270e,0xa6c2a448241da6dd,0x124827ffa7f61a46,0x1bd6a7f127fe1648,0xa6c22448a513a62f,0x2799a10522d7273b,0xa725a33220a5a7a8,0x258425cba4c4266d,0x98b5a7fa27a8a0a5,0xa1c22777a7ea9cb2,0x268aa49b262f2513,0xa7fa18b5a164a788,0x2750227c9a4627f6,0xa3e3a6f6255fa5ed,0x1bd627f1a70e238b,0x249ba68a27c31fc6
.quad 0xa64f24eca70ea38b,0x27e21d791fc627c3,0xa777a1c29a46a7f6,0x204427b6a5ed255f,0x9d79a7e2262fa513,0xa60f253aa788a164,0x260fa53a27a820a5,0xa750a27c9cb2a7ea,0x2799210520a527a8,0x9248a7ff266da4c4,0x1f0327cea513262f,0x2725a332273b22d7,0xa5cb2584a7f69a46,0x264f24ec164827fe,0xa7b6a044a38ba70e,0x9f0327cea6dd241d
.quad 0xa044a7b6238ba70e,0xa7ce1f03a6dda41d,0x2584a5cb27f69a46,0xa4eca64f1648a7fe,0x27ce1f032513262f,0x2332a725273ba2d7,0x21052799a0a527a8,0x27ff1248266d24c4,0xa53a260fa7a820a5,0x227c27509cb227ea,0xa7e29d79a62fa513,0xa53a260fa7882164,0xa1c2a7771a46a7f6,0xa7b6a044a5eda55f,0x24eca64f270ea38b,0x9d79a7e21fc6a7c3
.quad 0x27f11bd6270e238b,0x268aa49b27c39fc6,0x227c27501a4627f6,0x26f623e3255f25ed,0xa49b268aa62f2513,0x98b527faa1642788,0xa7fa98b5a7a8a0a5,0xa77721c2a7ea1cb2,0xa332a725a0a5a7a8,0xa5cba584a4c4a66d,0x2448a6c22513a62f,0x2105a79922d7a73b,0x27ff124827f61a46,0x27f19bd627fe9648,0x23e326f6238b270e,0x244826c2241d26dd
.quad 0x268a249ba47226a7,0xa64fa4ec24c4a66d,0xa04427b6a7d99e3e,0x227ca75027882164,0xa7fa18b59e3ea7d9,0x27e21d79964827fe,0xa27ca75026a7a472,0x18b527faa7c31fc6,0x25cba58426a72472,0xa7992105a41da6dd,0x272523329e3e27d9,0xa448a6c2255fa5ed,0x9bd627f1a7d91e3e,0x2584a5cb273b22d7,0xa7ce1f03a472a6a7,0x26f623e39cb227ea
.quad 0xa448a6c22472a6a7,0xa04427b6a7ea1cb2,0x24eca64f27d91e3e,0xa7ff9248a2d7a73b,0x279921051e3e27d9,0x9f03a7ce25eda55f,0x124827ffa6a72472,0x2725a33226dd241d,0xa77721c2a6a7a472,0x253a260f9fc627c3,0xa53aa60f1e3ea7d9,0xa49b268aa7fe1648,0x23e3a6f627d99e3e,0xa777a1c2a164a788,0x27e21d79247226a7,0x1bd6a7f1266da4c4
.quad 0x1d7927e2a47226a7,0x27f19bd6266d24c4,0xa6f623e3a7d99e3e,0x21c22777a1642788,0xa60fa53a9e3ea7d9,0xa68a249ba7fe9648,0x21c2a77726a7a472,0xa60fa53a9fc6a7c3,0x27ff124826a72472,0x2332a72526dda41d,0x210527999e3e27d9,0x27ce1f0325ed255f,0xa64f24eca7d91e3e,0x124827ffa2d7273b,0xa6c2a448a472a6a7,0xa7b62044a7ea9cb2
.quad 0x1f03a7ce2472a6a7,0xa3e3a6f69cb2a7ea,0x27f19bd627d91e3e,0x25cba584273ba2d7,0x233227251e3e27d9,0x26c22448255f25ed,0xa58425cba6a72472,0xa1052799a41d26dd,0xa750a27ca6a7a472,0xa7fa98b5a7c39fc6,0x18b5a7fa1e3ea7d9,0x9d79a7e29648a7fe,0x27b6a04427d99e3e,0x2750a27c2788a164,0x249b268a247226a7,0x24ec264f24c4266d
.quad 0x260f253aa513262f,0xa5cba584255fa5ed,0xa44826c2a70ea38b,0x253aa60f266d24c4,0xa750a27c20a5a7a8,0x264f24eca41d26dd,0x2044a7b627f61a46,0xa49b268aa73ba2d7,0x27f11bd61a4627f6,0xa6c2a4482164a788,0x124827ffa7a820a5,0x23e3a6f627c31fc6,0xa7e21d79a38ba70e,0x272523329cb227ea,0xa105a799262fa513,0xa27c2750a7fe9648
.quad 0x2725a332262f2513,0xa777a1c29648a7fe,0x249b268aa38b270e,0x2105a79927ea9cb2,0xa5cb2584a7a8a0a5,0x27b620441fc627c3,0xa64fa4ec1a46a7f6,0x9f0327cea7882164,0x23e3a6f627f69a46,0xa7e29d79a2d7a73b,0x277721c220a527a8,0x1bd6a7f126dda41d,0x9f0327cea70e238b,0x27fa18b524c4266d,0xa7fa98b5a513a62f,0x924827ffa5ed255f
.quad 0x98b5a7fa2513a62f,0xa7ff1248a5eda55f,0x27ce9f03270e238b,0x98b5a7fa24c4a66d,0x21c22777a0a527a8,0x27f19bd626dd241d,0xa6f623e3a7f69a46,0x1d7927e2a2d7273b,0xa4eca64f9a46a7f6,0xa7ce1f03a788a164,0x2584a5cb27a8a0a5,0xa044a7b61fc6a7c3,0x268a249b238b270e,0x2799a10527ea1cb2,0xa3322725a62f2513,0x21c22777964827fe
.quad 0xa799a105a62fa513,0xa750227ca7fe1648,0x1d79a7e2238ba70e,0xa332a7259cb2a7ea,0x27ff124827a820a5,0x26f6a3e327c39fc6,0x1bd627f19a4627f6,0x244826c221642788,0xa7b62044a7f61a46,0xa68a249ba73b22d7,0xa27ca750a0a5a7a8,0xa4eca64fa41da6dd,0x26c2a448270ea38b,0x260fa53a266da4c4,0x253a260f2513262f,0x258425cb255f25ed
.quad 0x258425cba5a825a8,0xa53aa60f25eda55f,0xa60f253aa5a8a5a8,0x26c2a44824c4266d,0xa4eca64f25a8a5a8,0x227c2750a6dd241d,0x268aa49b25a825a8,0xa7b62044a2d7a73b,0x244826c2a5a825a8,0x9bd6a7f12788a164,0xa6f623e3a5a8a5a8,0x27ff12481fc627c3,0xa332a72525a8a5a8,0x9d7927e2a7ea1cb2,0x2750a27c25a825a8,0xa799a1059648a7fe
.quad 0x21c22777a5a825a8,0x2332a72527fe1648,0xa7992105a5a8a5a8,0x268a249b9cb227ea,0xa044a7b625a8a5a8,0xa58425cba7c39fc6,0x27ce9f0325a825a8,0xa4eca64f2164a788,0x1d7927e2a5a825a8,0x26f6a3e3273b22d7,0xa7f11bd6a5a8a5a8,0x21c22777a41d26dd,0x98b5a7fa25a8a5a8,0xa7ce1f03a66da4c4,0x27ff924825a825a8,0x98b5a7fa255fa5ed
.quad 0x924827ffa5a825a8,0x27fa18b5255f25ed,0xa7fa98b5a5a8a5a8,0x9f0327cea66d24c4,0x1bd6a7f125a8a5a8,0xa777a1c2a41da6dd,0x27e21d7925a825a8,0x23e3a6f6273ba2d7,0x9f0327cea5a825a8,0x264f24ec21642788,0xa7b6a044a5a8a5a8,0xa5cb2584a7c31fc6,0x2105a79925a8a5a8,0xa49ba68a9cb2a7ea,0x277721c225a825a8,0x2725a33227fe9648
.quad 0xa27c2750a5a825a8,0x21052799964827fe,0xa725a332a5a8a5a8,0xa7e21d79a7ea9cb2,0x23e3a6f625a8a5a8,0x9248a7ff1fc6a7c3,0x26c2244825a825a8,0x27f11bd627882164,0xa49b268aa5a825a8,0xa04427b6a2d7273b,0xa64fa4eca5a8a5a8,0xa750a27ca6dda41d,0x253aa60f25a8a5a8,0x2448a6c224c4a66d,0x25cb258425a825a8,0x260f253a25ed255f
.quad 0x24ec264fa62f2513,0xa49ba68a266da4c4,0xa750227ca38ba70e,0x27b6a04421642788,0x9d79a7e227a8a0a5,0x98b527faa7fe1648,0x27fa18b51a4627f6,0xa750a27c1fc6a7c3,0xa1052799a7f69a46,0x2584a5cb26dd241d,0xa6c2a44820a5a7a8,0x23322725a5ed255f,0x25cba584270e238b,0xa7f11bd6a2d7a73b,0x23e326f6a513262f,0x1f03a7ce27ea9cb2
.quad 0xa7b62044a513a62f,0x26c224489cb227ea,0x9248a7ff270ea38b,0xa64f24eca73ba2d7,0x27ce1f0320a527a8,0xa105a799255fa5ed,0xa3322725a7f61a46,0x27ff1248241d26dd,0xa60fa53a1a46a7f6,0xa1c22777a7c31fc6,0x268aa49b27a820a5,0xa60fa53a1648a7fe,0x21c22777a38b270e,0x26f6a3e327882164,0xa7f11bd6a62fa513,0x1d7927e2a4c4266d
.quad 0x1bd6a7f1262fa513,0xa7e29d79a4c4a66d,0x277721c2238b270e,0x23e3a6f62788a164,0xa49b268aa7a820a5,0x253a260f164827fe,0xa53aa60f9a46a7f6,0xa77721c2a7c39fc6,0x2725a33227f61a46,0x9248a7ff241da6dd,0x1f0327cea0a527a8,0x27992105255f25ed,0xa7ff9248a70ea38b,0xa4ec264fa73b22d7,0x2044a7b62513a62f,0xa448a6c29cb2a7ea
.quad 0x26f623e32513262f,0x27ce9f0327ea1cb2,0xa58425cba70e238b,0x9bd627f1a2d7273b,0xa448a6c2a0a5a7a8,0xa725a332a5eda55f,0x2799a10527f69a46,0x25cba58426dda41d,0x18b527fa9a4627f6,0x227c27501fc627c3,0xa7e29d79a7a8a0a5,0xa7fa18b5a7fe9648,0x227ca750238ba70e,0x2044a7b62164a788,0x264f24ec262f2513,0x268a249b266d24c4
.quad 0x244826c2a6a72472,0xa3e3a6f626dda41d,0xa7f11bd69e3ea7d9,0x27ff1248164827fe,0x2105a79927d91e3e,0xa44826c2a73ba2d7,0x25cb2584a47226a7,0xa332a725266da4c4,0xa77721c2a472a6a7,0x27fa18b51cb227ea,0x18b5a7fa27d99e3e,0xa49b268aa788a164,0x26f623e39e3e27d9,0xa27ca75025eda55f,0xa68a249ba6a7a472,0x27f11bd61fc627c3
.quad 0x9d79a7e226a7a472,0xa4ec264fa7c39fc6,0x27b620441e3e27d9,0xa1c2a777255fa5ed,0xa53a260fa7d99e3e,0x27e21d7921642788,0xa27ca7502472a6a7,0xa53a260fa7ea9cb2,0x27ff1248247226a7,0xa105a79924c4a66d,0xa3322725a7d91e3e,0x27ce1f0322d7273b,0xa4eca64f1e3ea7d9,0xa58425cba7fe9648,0x27ce9f0326a72472,0xa044a7b6241da6dd
.quad 0x9f0327cea6a72472,0x27b62044241d26dd,0xa64fa4ec9e3ea7d9,0xa5cb2584a7fe1648,0x2725a33227d91e3e,0x9f03a7ce22d7a73b,0x124827ffa47226a7,0x2799210524c4266d,0xa750a27ca472a6a7,0xa60f253aa7ea1cb2,0x260fa53a27d99e3e,0x9d79a7e22164a788,0x204427b69e3e27d9,0x277721c2255f25ed,0xa7e29d79a6a7a472,0xa64f24eca7c31fc6
.quad 0x249ba68a26a7a472,0x9bd6a7f11fc6a7c3,0x23e326f61e3e27d9,0x2750227c25ed255f,0xa7fa18b5a7d99e3e,0xa68a249ba7882164,0x21c2a7772472a6a7,0x98b5a7fa1cb2a7ea,0x258425cb247226a7,0x27252332266d24c4,0xa7992105a7d91e3e,0xa6c22448a73b22d7,0x1bd6a7f11e3ea7d9,0x9248a7ff1648a7fe,0x26c2244826a72472,0x26f623e326dd241d
.quad 0x23322725a70e238b,0xa27ca750273ba2d7,0xa7e29d791a46a7f6,0x279921059fc627c3,0x25cba584262f2513,0xa6f623e3a4c4a66d,0x1bd627f1a7a820a5,0x1f03a7ce27fe1648,0xa6f6a3e320a5a7a8,0x249b268aa55f25ed,0x2750a27c2513262f,0xa7f19bd69cb2a7ea,0x9f0327cea7f61a46,0x260fa53a26dd241d,0xa53aa60f238ba70e,0x924827ffa7882164
.quad 0x27fa98b5238b270e,0xa5cba5842164a788,0xa44826c2a7f69a46,0x27fa98b5241d26dd,0xa1c2a7772513a62f,0xa4ec264fa7ea9cb2,0x27b6204420a527a8,0x9d79a7e225eda55f,0xa64f24eca7a8a0a5,0x26c22448164827fe,0x9248a7ff262fa513,0xa7b62044a66da4c4,0x268a249b1a4627f6,0x2332a72527c39fc6,0xa7992105a70ea38b,0x21c22777a2d7273b
.quad 0x2105a799270ea38b,0xa777a1c2a2d7a73b,0x249b268a9a4627f6,0x2725a33227c31fc6,0xa7ff9248a62fa513,0xa04427b6a66d24c4,0x24eca64f27a8a0a5,0xa448a6c21648a7fe,0x204427b6a0a527a8,0x27e21d7925ed255f,0xa777a1c2a513a62f,0xa64f24eca7ea1cb2,0x26c2a44827f69a46,0x18b5a7fa241da6dd,0x98b527faa38b270e,0x258425cb21642788
.quad 0xa60fa53aa38ba70e,0xa7ff1248a788a164,0x27ce9f0327f61a46,0x253aa60f26dda41d,0xa27c2750a513262f,0x1bd627f19cb227ea,0xa3e3a6f6a0a5a7a8,0xa68aa49ba55fa5ed,0x27f11bd627a820a5,0x27ce9f0327fe9648,0xa58425cba62f2513,0xa3e326f6a4c4266d,0x9d79a7e29a46a7f6,0xa105a7999fc6a7c3,0x27252332270e238b,0x2750227c273b22d7
.quad 0x21c22777a764221f,0xa105a7992788a164,0xa725a332221fa764,0x268a249ba41d26dd,0x27b6a044221f2764,0xa7ff12489cb2a7ea,0xa44826c2a764a21f,0x264fa4ec25ed255f,0x9d79a7e22764a21f,0xa04427b6a7fe9648,0x264f24eca21f2764,0xa1c2a777266da4c4,0xa7fa18b5a21fa764,0x26c224489fc627c3,0x2584a5cb2764221f,0xa7fa18b5a2d7a73b
.quad 0x924827ffa764221f,0x260fa53a273b22d7,0xa53aa60f221fa764,0x9f0327cea7c31fc6,0x27f11bd6221f2764,0xa27ca75024c4a66d,0xa68a249ba764a21f,0x26f623e3164827fe,0x1f03a7ce2764a21f,0xa7f11bd6a55fa5ed,0x23e326f6a21f2764,0x25cba58427ea1cb2,0xa799a105a21fa764,0x9d7927e2a6dd241d,0x2750a27c2764221f,0xa332a7252164a788
.quad 0xa27c2750a764221f,0x2725233221642788,0xa105a799221fa764,0xa7e21d79a6dda41d,0x26f623e3221f2764,0x2584a5cb27ea9cb2,0xa7ce1f03a764a21f,0x9bd627f1a55f25ed,0x249ba68a2764a21f,0xa3e3a6f61648a7fe,0x1bd627f1a21f2764,0x2750227c24c4266d,0xa60fa53aa21fa764,0xa7ce1f03a7c39fc6,0x27ff92482764221f,0x253aa60f273ba2d7
.quad 0xa5cb2584a764221f,0x98b527faa2d7273b,0x18b5a7fa221fa764,0xa448a6c29fc6a7c3,0x24ec264f221f2764,0x277721c2266d24c4,0xa7e29d79a764a21f,0xa7b62044a7fe1648,0x26c2a4482764a21f,0x24eca64f25eda55f,0xa04427b6a21f2764,0x924827ff9cb227ea,0xa332a725a21fa764,0xa49ba68aa41da6dd,0x277721c22764221f,0x2799210527882164
.quad 0x204427b6a7a820a5,0x9f03a7ce27c39fc6,0xa5cba5842513a62f,0x24ec264fa5ed255f,0x27ce1f039a4627f6,0xa725a3322164a788,0xa7992105a38ba70e,0x27ff12481cb227ea,0x253aa60f270e238b,0xa750227ca4c4a66d,0x9d7927e2a7f61a46,0x253aa60f273b22d7,0xa1c2a777262fa513,0xa04427b6a7fe1648,0x264f24eca0a527a8,0x9d79a7e226dda41d
.quad 0xa7f19bd6a0a5a7a8,0x249b268aa41d26dd,0x2750a27c262f2513,0xa6f6a3e31648a7fe,0xa49b268aa7f69a46,0x27fa18b522d7273b,0x18b5a7fa270ea38b,0xa77721c2a66da4c4,0x23322725a38b270e,0x2584a5cb27ea1cb2,0xa6c2a4489a46a7f6,0xa1052799a7882164,0x27ff12482513262f,0x9bd6a7f1255fa5ed,0xa6f623e3a7a8a0a5,0x244826c29fc627c3
.quad 0x23e3a6f627a8a0a5,0xa6c2a4489fc6a7c3,0x124827ffa513262f,0x27f11bd6255f25ed,0xa448a6c21a46a7f6,0xa7992105a788a164,0x27252332238b270e,0x25cba58427ea9cb2,0xa7fa18b5a70ea38b,0xa1c22777a66d24c4,0x268aa49b27f69a46,0x98b5a7fa22d7a73b,0xa27c2750a62f2513,0x23e326f6164827fe,0x9bd6a7f120a5a7a8,0xa68aa49ba41da6dd
.quad 0x24ec264f20a527a8,0x27e21d7926dd241d,0xa777a1c2a62fa513,0xa7b62044a7fe9648,0x27e29d7927f61a46,0x260fa53a273ba2d7,0xa60f253aa70e238b,0xa27c2750a4c4266d,0x2105a799238ba70e,0x9248a7ff1cb2a7ea,0x1f0327ce1a4627f6,0x2332272521642788,0xa584a5cba513a62f,0xa64fa4eca5eda55f,0x27b6204427a820a5,0x27ce1f0327c31fc6
.quad 0x1d7927e2a7d91e3e,0x9bd6a7f127ea9cb2,0xa3e3a6f626a7a472,0x21c22777a73b22d7,0x260f253aa47226a7,0xa49ba68a25eda55f,0xa777a1c21e3ea7d9,0x260f253aa41d26dd,0x27ff12481e3e27d9,0xa725a3321fc6a7c3,0xa7992105a472a6a7,0x27ce1f03164827fe,0x264fa4ec26a72472,0xa7ff1248a164a788,0xa44826c2a7d99e3e,0x27b6a04424c4266d
.quad 0x1f03a7ce27d99e3e,0xa6f623e3a66da4c4,0x1bd627f1a6a72472,0x25cba58427882164,0xa332a7252472a6a7,0xa44826c2a7fe9648,0x25cb25849e3e27d9,0x2105a79927c39fc6,0xa750a27c9e3ea7d9,0x98b527faa6dd241d,0x27fa18b5247226a7,0x9d79a7e2255fa5ed,0xa7b62044a6a7a472,0x227c2750a2d7273b,0x268aa49b27d91e3e,0xa4eca64f1cb2a7ea
.quad 0xa49b268aa7d91e3e,0x264f24ec1cb227ea,0x2044a7b626a7a472,0xa750a27ca2d7a73b,0x18b527faa47226a7,0x27e21d79255f25ed,0xa27ca7501e3ea7d9,0xa7fa18b5a6dda41d,0x258425cb1e3e27d9,0x2799a10527c31fc6,0xa725a332a472a6a7,0xa6c22448a7fe1648,0x27f11bd626a72472,0x2584a5cb2788a164,0xa7ce1f03a7d99e3e,0xa3e326f6a66d24c4
.quad 0x26c2a44827d99e3e,0x2044a7b624c4a66d,0xa4ec264fa6a72472,0x924827ffa1642788,0x2105a7992472a6a7,0x9f03a7ce1648a7fe,0x124827ff9e3e27d9,0x233227251fc627c3,0xa1c2a7779e3ea7d9,0xa53aa60fa41da6dd,0x253a260f247226a7,0x268a249b25ed255f,0xa6f6a3e3a6a7a472,0xa777a1c2a73ba2d7,0x27e21d7927d91e3e,0x27f11bd627ea1cb2
.quad 0x18b527faa7f61a46,0x9248a7ff27fe9648,0x9f03a7ce27a8a0a5,0x18b527faa7ea1cb2,0x21c22777a70e238b,0x9bd6a7f127c39fc6,0xa3e3a6f6262fa513,0x1d7927e2a7882164,0x24ec264fa513262f,0x9f03a7ce273ba2d7,0xa5cba584238ba70e,0x204427b6a6dd241d,0x268a249ba0a527a8,0xa105a799266da4c4,0xa725a3321a46a7f6,0x21c22777a5ed255f
.quad 0x279921051a4627f6,0xa27ca750255fa5ed,0xa7e29d79a0a5a7a8,0x23322725a4c4266d,0x27ff1248238b270e,0xa3e3a6f6241da6dd,0xa7f11bd6a513a62f,0x244826c2a2d7273b,0x27b6a044262f2513,0xa49ba68a2164a788,0xa750227ca70ea38b,0x24ec264f9fc627c3,0x26c2a44827a820a5,0xa53aa60f1cb2a7ea,0xa60f253aa7f69a46,0x258425cb964827fe
.quad 0x253aa60f27f69a46,0xa5cba5849648a7fe,0xa44826c2a7a820a5,0x260f253a1cb227ea,0x227ca750270ea38b,0xa64fa4ec9fc6a7c3,0xa04427b6a62f2513,0x268a249b21642788,0x1bd6a7f12513a62f,0xa6c2a448a2d7a73b,0x124827ffa38b270e,0x26f623e3241d26dd,0x9d79a7e220a5a7a8,0xa725a332a4c4a66d,0x210527999a4627f6,0x2750227c255f25ed
.quad 0xa332a7259a46a7f6,0xa777a1c2a5eda55f,0x249b268a20a527a8,0x27992105266d24c4,0xa584a5cba38ba70e,0xa7b6a044a6dda41d,0x264f24ec2513262f,0x27ce1f03273b22d7,0xa6f6a3e3a62fa513,0xa7e29d79a788a164,0x277721c2270e238b,0x27f11bd627c31fc6,0xa7ce9f03a7a8a0a5,0xa7fa98b5a7ea9cb2,0x27fa18b527f61a46,0x27ff124827fe1648
.quad 0x3400340034003400,0x3400340034003400,0,0,0x35a8000034003400,0xb5a83400b400,0,0,0x3400b40034003400,0xb4003400b400b400,0,0,0xb5a834003400,0x35a80000b4003400,0,0
.quad 0xb400b40034003400,0xb400b40034003400,0,0,0xb5a8800034003400,0x800035a83400b400,0,0,0xb400340034003400,0x3400b400b400b400,0,0,0x800035a834003400,0xb5a88000b4003400,0,0
.quad 0,0,0x3400340034003400,0x3400340034003400,0,0,0x353ab054353a3054,0xb054b53a3054b53a,0,0,0xb5a835a80000,0x800035a8b5a88000,0,0,0xb53ab054353ab054,0x3054b53a3054353a
.quad 0,0,0xb40034003400b400,0xb40034003400b400,0,0,0x3054353a3054b53a,0x353ab054b53ab054,0,0,0x35a800000000b5a8,0xb5a88000800035a8,0,0,0x3054b53ab054b53a,0x353a3054353ab054
.quad 0x34003400,0,0,0,0xb400b400,0,0,0,0x34003400,0,0,0,0xb400b400,0,0,0
.quad 0x34003400,0,0,0,0xb400b400,0,0,0,0x34003400,0,0,0,0xb400b400,0,0,0
.quad 0,0,0,0,0,0,0,0,0,0,0,0,0,0,0,0
.quad 0,0,0,0,0,0,0,0,0,0,0,0,0,0,0,0
.quad 0x3400340034003400,0x3400340034003400,0xb4003400b4003400,0xb4003400b4003400,0x35a89471340333fa,0x9471b5a833fab403,0x147135a8b3fa3403,0x35a89471340333fa,0x33f3b406340633f3,0xb3f33406b406b3f3,0x340633f3b3f33406,0xb406b3f333f3b406,0x9aaab5a8340933ed,0x35a89aaab3ed3409,0x35a89aaab3ed3409,0x1aaa35a8b409b3ed
.quad 0xb40cb3e7340c33e7,0xb40cb3e7340c33e7,0x33e7b40cb3e7340c,0x33e7b40cb3e7340c,0xb5a81d8e341033e0,0x1d8e35a833e0b410,0x9d8eb5a8b3e03410,0xb5a81d8e341033e0,0xb3da3413341333da,0x33dab413b413b3da,0xb413b3dab3da3413,0x341333da33dab413,0x1fc635a8341633d4,0xb5a81fc6b3d43416,0xb5a81fc6b3d43416,0x9fc6b5a8b416b3d4
.quad 0x3400340034003400,0x3400340034003400,0xb4003400b4003400,0xb4003400b4003400,0xb5a81471b403b3fa,0x147135a8b3fa3403,0x9471b5a833fab403,0xb5a81471b403b3fa,0x33f3b406340633f3,0xb3f33406b406b3f3,0x340633f3b3f33406,0xb406b3f333f3b406,0x1aaa35a8b409b3ed,0xb5a81aaa33edb409,0xb5a81aaa33edb409,0x9aaab5a8340933ed
.quad 0xb40cb3e7340c33e7,0xb40cb3e7340c33e7,0x33e7b40cb3e7340c,0x33e7b40cb3e7340c,0x35a89d8eb410b3e0,0x9d8eb5a8b3e03410,0x1d8e35a833e0b410,0x35a89d8eb410b3e0,0xb3da3413341333da,0x33dab413b413b3da,0xb413b3dab3da3413,0x341333da33dab413,0x9fc6b5a8b416b3d4,0x35a89fc633d4b416,0x35a89fc633d4b416,0x1fc635a8341633d4
.quad 0,0,0,0,0,0,0,0,0,0,0,0,0,0,0,0
.quad 0,0,0,0,0,0,0,0,0,0,0,0,0,0,0,0
.quad 0,0,0,0,0,0,0,0,0,0,0,0,0,0,0,0
.quad 0,0,0,0,0,0,0,0,0,0,0,0,0,0,0,0
.quad 0x3400340034003400,0x3400340034003400,0xb4003400b4003400,0xb4003400b4003400,0x35a89871340633f3,0x9871b5a833f3b406,0x187135a8b3f33406,0x35a89871340633f3,0x33e7b40c340c33e7,0xb3e7340cb40cb3e7,0x340c33e7b3e7340c,0xb40cb3e733e7b40c,0x9eaab5a8341333da,0x35a89eaab3da3413,0x35a89eaab3da3413,0x1eaa35a8b413b3da
.quad 0xb419b3cd341933cd,0xb419b3cd341933cd,0x33cdb419b3cd3419,0x33cdb419b3cd3419,0xb5a7218d341f33c0,0x218d35a733c0b41f,0xa18db5a7b3c0341f,0xb5a7218d341f33c0,0xb3b33425342533b3,0x33b3b425b425b3b3,0xb425b3b3b3b33425,0x342533b333b3b425,0x23c635a7342b33a6,0xb5a723c6b3a6342b,0xb5a723c6b3a6342b,0xa3c6b5a7b42bb3a6
.quad 0x3400340034003400,0x3400340034003400,0xb4003400b4003400,0xb4003400b4003400,0xb5a81871b406b3f3,0x187135a8b3f33406,0x9871b5a833f3b406,0xb5a81871b406b3f3,0x33e7b40c340c33e7,0xb3e7340cb40cb3e7,0x340c33e7b3e7340c,0xb40cb3e733e7b40c,0x1eaa35a8b413b3da,0xb5a81eaa33dab413,0xb5a81eaa33dab413,0x9eaab5a8341333da
.quad 0xb419b3cd341933cd,0xb419b3cd341933cd,0x33cdb419b3cd3419,0x33cdb419b3cd3419,0x35a7a18db41fb3c0,0xa18db5a7b3c0341f,0x218d35a733c0b41f,0x35a7a18db41fb3c0,0xb3b33425342533b3,0x33b3b425b425b3b3,0xb425b3b3b3b33425,0x342533b333b3b425,0xa3c6b5a7b42bb3a6,0x35a7a3c633a6b42b,0x35a7a3c633a6b42b,0x23c635a7342b33a6
.quad 0,0,0,0,0,0,0,0,0,0,0,0,0,0,0,0
.quad 0,0,0,0,0,0,0,0,0,0,0,0,0,0,0,0
.quad 0,0,0,0,0,0,0,0,0,0,0,0,0,0,0,0
.quad 0,0,0,0,0,0,0,0,0,0,0,0,0,0,0,0
.quad 0x3400340034003400,0x3400340034003400,0xb4003400b4003400,0xb4003400b4003400,0x35a89aaa340933ed,0x9aaab5a833edb409,0x1aaa35a8b3ed3409,0x35a89aaa340933ed,0x33dab413341333da,0xb3da3413b413b3da,0x341333dab3da3413,0xb413b3da33dab413,0xa0ffb5a8341c33c7,0x35a8a0ffb3c7341c,0x35a8a0ffb3c7341c,0x20ff35a8b41cb3c7
.quad 0xb425b3b3342533b3,0xb425b3b3342533b3,0x33b3b425b3b33425,0x33b3b425b3b33425,0xb5a7242a342e33a0,0x242a35a733a0b42e,0xa42ab5a7b3a0342e,0xb5a7242a342e33a0,0xb38c34373437338c,0x338cb437b437b38c,0xb437b38cb38c3437,0x3437338c338cb437,0x25d435a534403378,0xb5a525d4b3783440,0xb5a525d4b3783440,0xa5d4b5a5b440b378
.quad 0x3400340034003400,0x3400340034003400,0xb4003400b4003400,0xb4003400b4003400,0xb5a81aaab409b3ed,0x1aaa35a8b3ed3409,0x9aaab5a833edb409,0xb5a81aaab409b3ed,0x33dab413341333da,0xb3da3413b413b3da,0x341333dab3da3413,0xb413b3da33dab413,0x20ff35a8b41cb3c7,0xb5a820ff33c7b41c,0xb5a820ff33c7b41c,0xa0ffb5a8341c33c7
.quad 0xb425b3b3342533b3,0xb425b3b3342533b3,0x33b3b425b3b33425,0x33b3b425b3b33425,0x35a7a42ab42eb3a0,0xa42ab5a7b3a0342e,0x242a35a733a0b42e,0x35a7a42ab42eb3a0,0xb38c34373437338c,0x338cb437b437b38c,0xb437b38cb38c3437,0x3437338c338cb437,0xa5d4b5a5b440b378,0x35a5a5d43378b440,0x35a5a5d43378b440,0x25d435a534403378
.quad 0,0,0,0,0,0,0,0,0,0,0,0,0,0,0,0
.quad 0,0,0,0,0,0,0,0,0,0,0,0,0,0,0,0
.quad 0,0,0,0,0,0,0,0,0,0,0,0,0,0,0,0
.quad 0,0,0,0,0,0,0,0,0,0,0,0,0,0,0,0
.quad 0x3400340034003400,0x3400340034003400,0xb4003400b4003400,0xb4003400b4003400,0x35a89c71340c33e7,0x9c71b5a833e7b40c,0x1c7135a8b3e7340c,0x35a89c71340c33e7,0x33cdb419341933cd,0xb3cd3419b419b3cd,0x341933cdb3cd3419,0xb419b3cd33cdb419,0xa2aab5a7342533b3,0x35a7a2aab3b33425,0x35a7a2aab3b33425,0x22aa35a7b425b3b3
.quad 0xb431b39934313399,0xb431b39934313399,0x3399b431b3993431,0x3399b431b3993431,0xb5a5258d343d337f,0x258d35a5337fb43d,0xa58db5a5b37f343d,0xb5a5258d343d337f,0xb364344934493364,0x3364b449b449b364,0xb449b364b3643449,0x344933643364b449,0x27c435a334543349,0xb5a327c4b3493454,0xb5a327c4b3493454,0xa7c4b5a3b454b349
.quad 0x3400340034003400,0x3400340034003400,0xb4003400b4003400,0xb4003400b4003400,0xb5a81c71b40cb3e7,0x1c7135a8b3e7340c,0x9c71b5a833e7b40c,0xb5a81c71b40cb3e7,0x33cdb419341933cd,0xb3cd3419b419b3cd,0x341933cdb3cd3419,0xb419b3cd33cdb419,0x22aa35a7b425b3b3,0xb5a722aa33b3b425,0xb5a722aa33b3b425,0xa2aab5a7342533b3
.quad 0xb431b39934313399,0xb431b39934313399,0x3399b431b3993431,0x3399b431b3993431,0x35a5a58db43db37f,0xa58db5a5b37f343d,0x258d35a5337fb43d,0x35a5a58db43db37f,0xb364344934493364,0x3364b449b449b364,0xb449b364b3643449,0x344933643364b449,0xa7c4b5a3b454b349,0x35a3a7c43349b454,0x35a3a7c43349b454,0x27c435a334543349
.quad 0,0,0,0,0,0,0,0,0,0,0,0,0,0,0,0
.quad 0,0,0,0,0,0,0,0,0,0,0,0,0,0,0,0
.quad 0,0,0,0,0,0,0,0,0,0,0,0,0,0,0,0
.quad 0,0,0,0,0,0,0,0,0,0,0,0,0,0,0,0
.quad 0x3400340034003400,0x3400340034003400,0xb4003400b4003400,0xb4003400b4003400,0x35a89d8e341033e0,0x9d8eb5a833e0b410,0x1d8e35a8b3e03410,0x35a89d8e341033e0,0x33c0b41f341f33c0,0xb3c0341fb41fb3c0,0x341f33c0b3c0341f,0xb41fb3c033c0b41f,0xa42ab5a7342e33a0,0x35a7a42ab3a0342e,0x35a7a42ab3a0342e,0x242a35a7b42eb3a0
.quad 0xb43db37f343d337f,0xb43db37f343d337f,0x337fb43db37f343d,0x337fb43db37f343d,0xb5a426ef344b335d,0x26ef35a4335db44b,0xa6efb5a4b35d344b,0xb5a426ef344b335d,0xb33b345a345a333b,0x333bb45ab45ab33b,0xb45ab33bb33b345a,0x345a333b333bb45a,0x28da35a034683319,0xb5a028dab3193468,0xb5a028dab3193468,0xa8dab5a0b468b319
.quad 0x3400340034003400,0x3400340034003400,0xb4003400b4003400,0xb4003400b4003400,0xb5a81d8eb410b3e0,0x1d8e35a8b3e03410,0x9d8eb5a833e0b410,0xb5a81d8eb410b3e0,0x33c0b41f341f33c0,0xb3c0341fb41fb3c0,0x341f33c0b3c0341f,0xb41fb3c033c0b41f,0x242a35a7b42eb3a0,0xb5a7242a33a0b42e,0xb5a7242a33a0b42e,0xa42ab5a7342e33a0
.quad 0xb43db37f343d337f,0xb43db37f343d337f,0x337fb43db37f343d,0x337fb43db37f343d,0x35a4a6efb44bb35d,0xa6efb5a4b35d344b,0x26ef35a4335db44b,0x35a4a6efb44bb35d,0xb33b345a345a333b,0x333bb45ab45ab33b,0xb45ab33bb33b345a,0x345a333b333bb45a,0xa8dab5a0b468b319,0x35a0a8da3319b468,0x35a0a8da3319b468,0x28da35a034683319
.quad 0,0,0,0,0,0,0,0,0,0,0,0,0,0,0,0
.quad 0,0,0,0,0,0,0,0,0,0,0,0,0,0,0,0
.quad 0,0,0,0,0,0,0,0,0,0,0,0,0,0,0,0
.quad 0,0,0,0,0,0,0,0,0,0,0,0,0,0,0,0
.quad 0x3400340034003400,0x3400340034003400,0xb4003400b4003400,0xb4003400b4003400,0x35a89eaa341333da,0x9eaab5a833dab413,0x1eaa35a8b3da3413,0x35a89eaa341333da,0x33b3b425342533b3,0xb3b33425b425b3b3,0x342533b3b3b33425,0xb425b3b333b3b425,0xa4ffb5a63437338c,0x35a6a4ffb38c3437,0x35a6a4ffb38c3437,0x24ff35a6b437b38c
.quad 0xb449b36434493364,0xb449b36434493364,0x3364b449b3643449,0x3364b449b3643449,0xb5a22829345a333b,0x282935a2333bb45a,0xa829b5a2b33b345a,0xb5a22829345a333b,0xb312346b346b3312,0x3312b46bb46bb312,0xb46bb312b312346b,0x346b33123312b46b,0x29d1359c347b32e8,0xb59c29d1b2e8347b,0xb59c29d1b2e8347b,0xa9d1b59cb47bb2e8
.quad 0x3400340034003400,0x3400340034003400,0xb4003400b4003400,0xb4003400b4003400,0xb5a81eaab413b3da,0x1eaa35a8b3da3413,0x9eaab5a833dab413,0xb5a81eaab413b3da,0x33b3b425342533b3,0xb3b33425b425b3b3,0x342533b3b3b33425,0xb425b3b333b3b425,0x24ff35a6b437b38c,0xb5a624ff338cb437,0xb5a624ff338cb437,0xa4ffb5a63437338c
.quad 0xb449b36434493364,0xb449b36434493364,0x3364b449b3643449,0x3364b449b3643449,0x35a2a829b45ab33b,0xa829b5a2b33b345a,0x282935a2333bb45a,0x35a2a829b45ab33b,0xb312346b346b3312,0x3312b46bb46bb312,0xb46bb312b312346b,0x346b33123312b46b,0xa9d1b59cb47bb2e8,0x359ca9d132e8b47b,0x359ca9d132e8b47b,0x29d1359c347b32e8
.quad 0,0,0,0,0,0,0,0,0,0,0,0,0,0,0,0
.quad 0,0,0,0,0,0,0,0,0,0,0,0,0,0,0,0
.quad 0,0,0,0,0,0,0,0,0,0,0,0,0,0,0,0
.quad 0,0,0,0,0,0,0,0,0,0,0,0,0,0,0,0
.quad 0x3400340034003400,0x3400340034003400,0xb4003400b4003400,0xb4003400b4003400,0x35a89fc6341633d4,0x9fc6b5a833d4b416,0x1fc635a8b3d43416,0x35a89fc6341633d4,0x33a6b42b342b33a6,0xb3a6342bb42bb3a6,0x342b33a6b3a6342b,0xb42bb3a633a6b42b,0xa5d4b5a534403378,0x35a5a5d4b3783440,0x35a5a5d4b3783440,0x25d435a5b440b378
.quad 0xb454b34934543349,0xb454b34934543349,0x3349b454b3493454,0x3349b454b3493454,0xb5a028da34683319,0x28da35a03319b468,0xa8dab5a0b3193468,0xb5a028da34683319,0xb2e8347b347b32e8,0x32e8b47bb47bb2e8,0xb47bb2e8b2e8347b,0x347b32e832e8b47b,0x2ac73598348e32b6,0xb5982ac7b2b6348e,0xb5982ac7b2b6348e,0xaac7b598b48eb2b6
.quad 0x3400340034003400,0x3400340034003400,0xb4003400b4003400,0xb4003400b4003400,0xb5a81fc6b416b3d4,0x1fc635a8b3d43416,0x9fc6b5a833d4b416,0xb5a81fc6b416b3d4,0x33a6b42b342b33a6,0xb3a6342bb42bb3a6,0x342b33a6b3a6342b,0xb42bb3a633a6b42b,0x25d435a5b440b378,0xb5a525d43378b440,0xb5a525d43378b440,0xa5d4b5a534403378
.quad 0xb454b34934543349,0xb454b34934543349,0x3349b454b3493454,0x3349b454b3493454,0x35a0a8dab468b319,0xa8dab5a0b3193468,0x28da35a03319b468,0x35a0a8dab468b319,0xb2e8347b347b32e8,0x32e8b47bb47bb2e8,0xb47bb2e8b2e8347b,0x347b32e832e8b47b,0xaac7b598b48eb2b6,0x3598aac732b6b48e,0x3598aac732b6b48e,0x2ac73598348e32b6
.quad 0,0,0,0,0,0,0,0,0,0,0,0,0,0,0,0
.quad 0,0,0,0,0,0,0,0,0,0,0,0,0,0,0,0
.quad 0,0,0,0,0,0,0,0,0,0,0,0,0,0,0,0
.quad 0,0,0,0,0,0,0,0,0,0,0,0,0,0,0,0
.quad 0x3400340034003400,0x3400340034003400,0xb4003400b4003400,0xb4003400b4003400,0x35a8a071341933cd,0xa071b5a833cdb419,0x207135a8b3cd3419,0x35a8a071341933cd,0x3399b43134313399,0xb3993431b431b399,0x34313399b3993431,0xb431b3993399b431,0xa6a9b5a434493364,0x35a4a6a9b3643449,0x35a4a6a9b3643449,0x26a935a4b449b364
.quad 0xb45fb32d345f332d,0xb45fb32d345f332d,0x332db45fb32d345f,0x332db45fb32d345f,0xb59d298a347632f6,0x298a359d32f6b476,0xa98ab59db2f63476,0xb59d298a347632f6,0xb2bd348b348b32bd,0x32bdb48bb48bb2bd,0xb48bb2bdb2bd348b,0x348b32bd32bdb48b,0x2bbd359334a03284,0xb5932bbdb28434a0,0xb5932bbdb28434a0,0xabbdb593b4a0b284
.quad 0x3400340034003400,0x3400340034003400,0xb4003400b4003400,0xb4003400b4003400,0xb5a82071b419b3cd,0x207135a8b3cd3419,0xa071b5a833cdb419,0xb5a82071b419b3cd,0x3399b43134313399,0xb3993431b431b399,0x34313399b3993431,0xb431b3993399b431,0x26a935a4b449b364,0xb5a426a93364b449,0xb5a426a93364b449,0xa6a9b5a434493364
.quad 0xb45fb32d345f332d,0xb45fb32d345f332d,0x332db45fb32d345f,0x332db45fb32d345f,0x359da98ab476b2f6,0xa98ab59db2f63476,0x298a359d32f6b476,0x359da98ab476b2f6,0xb2bd348b348b32bd,0x32bdb48bb48bb2bd,0xb48bb2bdb2bd348b,0x348b32bd32bdb48b,0xabbdb593b4a0b284,0x3593abbd3284b4a0,0x3593abbd3284b4a0,0x2bbd359334a03284
.quad 0,0,0,0,0,0,0,0,0,0,0,0,0,0,0,0
.quad 0,0,0,0,0,0,0,0,0,0,0,0,0,0,0,0
.quad 0,0,0,0,0,0,0,0,0,0,0,0,0,0,0,0
.quad 0,0,0,0,0,0,0,0,0,0,0,0,0,0,0,0
.quad 0x3400340034003400,0x3400340034003400,0xb4003400b4003400,0xb4003400b4003400,0x35a8a0ff341c33c7,0xa0ffb5a833c7b41c,0x20ff35a8b3c7341c,0x35a8a0ff341c33c7,0x338cb4373437338c,0xb38c3437b437b38c,0x3437338cb38c3437,0xb437b38c338cb437,0xa77db5a334513350,0x35a3a77db3503451,0x35a3a77db3503451,0x277d35a3b451b350
.quad 0xb46bb312346b3312,0xb46bb312346b3312,0x3312b46bb312346b,0x3312b46bb312346b,0xb59a2a3a348332d3,0x2a3a359a32d3b483,0xaa3ab59ab2d33483,0xb59a2a3a348332d3,0xb292349b349b3292,0x3292b49bb49bb292,0xb49bb292b292349b,0x349b32923292b49b,0x2c59358d34b23250,0xb58d2c59b25034b2,0xb58d2c59b25034b2,0xac59b58db4b2b250
.quad 0x3400340034003400,0x3400340034003400,0xb4003400b4003400,0xb4003400b4003400,0xb5a820ffb41cb3c7,0x20ff35a8b3c7341c,0xa0ffb5a833c7b41c,0xb5a820ffb41cb3c7,0x338cb4373437338c,0xb38c3437b437b38c,0x3437338cb38c3437,0xb437b38c338cb437,0x277d35a3b451b350,0xb5a3277d3350b451,0xb5a3277d3350b451,0xa77db5a334513350
.quad 0xb46bb312346b3312,0xb46bb312346b3312,0x3312b46bb312346b,0x3312b46bb312346b,0x359aaa3ab483b2d3,0xaa3ab59ab2d33483,0x2a3a359a32d3b483,0x359aaa3ab483b2d3,0xb292349b349b3292,0x3292b49bb49bb292,0xb49bb292b292349b,0x349b32923292b49b,0xac59b58db4b2b250,0x358dac593250b4b2,0x358dac593250b4b2,0x2c59358d34b23250
.quad 0,0,0,0,0,0,0,0,0,0,0,0,0,0,0,0
.quad 0,0,0,0,0,0,0,0,0,0,0,0,0,0,0,0
.quad 0,0,0,0,0,0,0,0,0,0,0,0,0,0,0,0
.quad 0,0,0,0,0,0,0,0,0,0,0,0,0,0,0,0
.quad 0x3400340034003400,0x3400340034003400,0xb4003400b4003400,0xb4003400b4003400,0x35a7a18d341f33c0,0xa18db5a733c0b41f,0x218d35a7b3c0341f,0x35a7a18d341f33c0,0x337fb43d343d337f,0xb37f343db43db37f,0x343d337fb37f343d,0xb43db37f337fb43d,0xa829b5a2345a333b,0x35a2a829b33b345a,0x35a2a829b33b345a,0x282935a2b45ab33b
.quad 0xb476b2f6347632f6,0xb476b2f6347632f6,0x32f6b476b2f63476,0x32f6b476b2f63476,0xb5972aea349032af,0x2aea359732afb490,0xaaeab597b2af3490,0xb5972aea349032af,0xb26734aa34aa3267,0x3267b4aab4aab267,0xb4aab267b26734aa,0x34aa32673267b4aa,0x2cd2358734c3321d,0xb5872cd2b21d34c3,0xb5872cd2b21d34c3,0xacd2b587b4c3b21d
.quad 0x3400340034003400,0x3400340034003400,0xb4003400b4003400,0xb4003400b4003400,0xb5a7218db41fb3c0,0x218d35a7b3c0341f,0xa18db5a733c0b41f,0xb5a7218db41fb3c0,0x337fb43d343d337f,0xb37f343db43db37f,0x343d337fb37f343d,0xb43db37f337fb43d,0x282935a2b45ab33b,0xb5a22829333bb45a,0xb5a22829333bb45a,0xa829b5a2345a333b
.quad 0xb476b2f6347632f6,0xb476b2f6347632f6,0x32f6b476b2f63476,0x32f6b476b2f63476,0x3597aaeab490b2af,0xaaeab597b2af3490,0x2aea359732afb490,0x3597aaeab490b2af,0xb26734aa34aa3267,0x3267b4aab4aab267,0xb4aab267b26734aa,0x34aa32673267b4aa,0xacd2b587b4c3b21d,0x3587acd2321db4c3,0x3587acd2321db4c3,0x2cd2358734c3321d
.quad 0,0,0,0,0,0,0,0,0,0,0,0,0,0,0,0
.quad 0,0,0,0,0,0,0,0,0,0,0,0,0,0,0,0
.quad 0,0,0,0,0,0,0,0,0,0,0,0,0,0,0,0
.quad 0,0,0,0,0,0,0,0,0,0,0,0,0,0,0,0
.quad 0x3400340034003400,0x3400340034003400,0xb4003400b4003400,0xb4003400b4003400,0x35a7a21c342233ba,0xa21cb5a733bab422,0x221c35a7b3ba3422,0x35a7a21c342233ba,0x3371b44334433371,0xb3713443b443b371,0x34433371b3713443,0xb443b3713371b443,0xa893b5a134623327,0x35a1a893b3273462,0x35a1a893b3273462,0x289335a1b462b327
.quad 0xb480b2da348032da,0xb480b2da348032da,0x32dab480b2da3480,0x32dab480b2da3480,0xb5942b9a349d328b,0x2b9a3594328bb49d,0xab9ab594b28b349d,0xb5942b9a349d328b,0xb23a34b934b9323a,0x323ab4b9b4b9b23a,0xb4b9b23ab23a34b9,0x34b9323a323ab4b9,0x2d4c358034d331e8,0xb5802d4cb1e834d3,0xb5802d4cb1e834d3,0xad4cb580b4d3b1e8
.quad 0x3400340034003400,0x3400340034003400,0xb4003400b4003400,0xb4003400b4003400,0xb5a7221cb422b3ba,0x221c35a7b3ba3422,0xa21cb5a733bab422,0xb5a7221cb422b3ba,0x3371b44334433371,0xb3713443b443b371,0x34433371b3713443,0xb443b3713371b443,0x289335a1b462b327,0xb5a128933327b462,0xb5a128933327b462,0xa893b5a134623327
.quad 0xb480b2da348032da,0xb480b2da348032da,0x32dab480b2da3480,0x32dab480b2da3480,0x3594ab9ab49db28b,0xab9ab594b28b349d,0x2b9a3594328bb49d,0x3594ab9ab49db28b,0xb23a34b934b9323a,0x323ab4b9b4b9b23a,0xb4b9b23ab23a34b9,0x34b9323a323ab4b9,0xad4cb580b4d3b1e8,0x3580ad4c31e8b4d3,0x3580ad4c31e8b4d3,0x2d4c358034d331e8
.quad 0,0,0,0,0,0,0,0,0,0,0,0,0,0,0,0
.quad 0,0,0,0,0,0,0,0,0,0,0,0,0,0,0,0
.quad 0,0,0,0,0,0,0,0,0,0,0,0,0,0,0,0
.quad 0,0,0,0,0,0,0,0,0,0,0,0,0,0,0,0
.quad 0x3400340034003400,0x3400340034003400,0xb4003400b4003400,0xb4003400b4003400,0x35a7a2aa342533b3,0xa2aab5a733b3b425,0x22aa35a7b3b33425,0x35a7a2aa342533b3,0x3364b44934493364,0xb3643449b449b364,0x34493364b3643449,0xb449b3643364b449,0xa8fdb59f346b3312,0x359fa8fdb312346b,0x359fa8fdb312346b,0x28fd359fb46bb312
.quad 0xb48bb2bd348b32bd,0xb48bb2bd348b32bd,0x32bdb48bb2bd348b,0x32bdb48bb2bd348b,0xb5902c2434aa3267,0x2c2435903267b4aa,0xac24b590b26734aa,0xb5902c2434aa3267,0xb20e34c734c7320e,0x320eb4c7b4c7b20e,0xb4c7b20eb20e34c7,0x34c7320e320eb4c7,0x2dc4357834e331b2,0xb5782dc4b1b234e3,0xb5782dc4b1b234e3,0xadc4b578b4e3b1b2
.quad 0x3400340034003400,0x3400340034003400,0xb4003400b4003400,0xb4003400b4003400,0xb5a722aab425b3b3,0x22aa35a7b3b33425,0xa2aab5a733b3b425,0xb5a722aab425b3b3,0x3364b44934493364,0xb3643449b449b364,0x34493364b3643449,0xb449b3643364b449,0x28fd359fb46bb312,0xb59f28fd3312b46b,0xb59f28fd3312b46b,0xa8fdb59f346b3312
.quad 0xb48bb2bd348b32bd,0xb48bb2bd348b32bd,0x32bdb48bb2bd348b,0x32bdb48bb2bd348b,0x3590ac24b4aab267,0xac24b590b26734aa,0x2c2435903267b4aa,0x3590ac24b4aab267,0xb20e34c734c7320e,0x320eb4c7b4c7b20e,0xb4c7b20eb20e34c7,0x34c7320e320eb4c7,0xadc4b578b4e3b1b2,0x3578adc431b2b4e3,0x3578adc431b2b4e3,0x2dc4357834e331b2
.quad 0,0,0,0,0,0,0,0,0,0,0,0,0,0,0,0
.quad 0,0,0,0,0,0,0,0,0,0,0,0,0,0,0,0
.quad 0,0,0,0,0,0,0,0,0,0,0,0,0,0,0,0
.quad 0,0,0,0,0,0,0,0,0,0,0,0,0,0,0,0
.quad 0x3400340034003400,0x3400340034003400,0xb4003400b4003400,0xb4003400b4003400,0x35a7a338342833ad,0xa338b5a733adb428,0x233835a7b3ad3428,0x35a7a338342833ad,0x3356b44e344e3356,0xb356344eb44eb356,0x344e3356b356344e,0xb44eb3563356b44e,0xa967b59e347332fd,0x359ea967b2fd3473,0x359ea967b2fd3473,0x2967359eb473b2fd
.quad 0xb496b2a1349632a1,0xb496b2a1349632a1,0x32a1b496b2a13496,0x32a1b496b2a13496,0xb58b2c7c34b73242,0x2c7c358b3242b4b7,0xac7cb58bb24234b7,0xb58b2c7c34b73242,0xb1e034d634d631e0,0x31e0b4d6b4d6b1e0,0xb4d6b1e0b1e034d6,0x34d631e031e0b4d6,0x2e3c357034f3317c,0xb5702e3cb17c34f3,0xb5702e3cb17c34f3,0xae3cb570b4f3b17c
.quad 0x3400340034003400,0x3400340034003400,0xb4003400b4003400,0xb4003400b4003400,0xb5a72338b428b3ad,0x233835a7b3ad3428,0xa338b5a733adb428,0xb5a72338b428b3ad,0x3356b44e344e3356,0xb356344eb44eb356,0x344e3356b356344e,0xb44eb3563356b44e,0x2967359eb473b2fd,0xb59e296732fdb473,0xb59e296732fdb473,0xa967b59e347332fd
.quad 0xb496b2a1349632a1,0xb496b2a1349632a1,0x32a1b496b2a13496,0x32a1b496b2a13496,0x358bac7cb4b7b242,0xac7cb58bb24234b7,0x2c7c358b3242b4b7,0x358bac7cb4b7b242,0xb1e034d634d631e0,0x31e0b4d6b4d6b1e0,0xb4d6b1e0b1e034d6,0x34d631e031e0b4d6,0xae3cb570b4f3b17c,0x3570ae3c317cb4f3,0x3570ae3c317cb4f3,0x2e3c357034f3317c
.quad 0,0,0,0,0,0,0,0,0,0,0,0,0,0,0,0
.quad 0,0,0,0,0,0,0,0,0,0,0,0,0,0,0,0
.quad 0,0,0,0,0,0,0,0,0,0,0,0,0,0,0,0
.quad 0,0,0,0,0,0,0,0,0,0,0,0,0,0,0,0
.quad 0x3400340034003400,0x3400340034003400,0xb4003400b4003400,0xb4003400b4003400,0x35a7a3c6342b33a6,0xa3c6b5a733a6b42b,0x23c635a7b3a6342b,0x35a7a3c6342b33a6,0x3349b45434543349,0xb3493454b454b349,0x34543349b3493454,0xb454b3493349b454,0xa9d1b59c347b32e8,0x359ca9d1b2e8347b,0x359ca9d1b2e8347b,0x29d1359cb47bb2e8
.quad 0xb4a0b28434a03284,0xb4a0b28434a03284,0x3284b4a0b28434a0,0x3284b4a0b28434a0,0xb5872cd234c3321d,0x2cd23587321db4c3,0xacd2b587b21d34c3,0xb5872cd234c3321d,0xb1b234e334e331b2,0x31b2b4e3b4e3b1b2,0xb4e3b1b2b1b234e3,0x34e331b231b2b4e3,0x2eb3356735013146,0xb5672eb3b1463501,0xb5672eb3b1463501,0xaeb3b567b501b146
.quad 0x3400340034003400,0x3400340034003400,0xb4003400b4003400,0xb4003400b4003400,0xb5a723c6b42bb3a6,0x23c635a7b3a6342b,0xa3c6b5a733a6b42b,0xb5a723c6b42bb3a6,0x3349b45434543349,0xb3493454b454b349,0x34543349b3493454,0xb454b3493349b454,0x29d1359cb47bb2e8,0xb59c29d132e8b47b,0xb59c29d132e8b47b,0xa9d1b59c347b32e8
.quad 0xb4a0b28434a03284,0xb4a0b28434a03284,0x3284b4a0b28434a0,0x3284b4a0b28434a0,0x3587acd2b4c3b21d,0xacd2b587b21d34c3,0x2cd23587321db4c3,0x3587acd2b4c3b21d,0xb1b234e334e331b2,0x31b2b4e3b4e3b1b2,0xb4e3b1b2b1b234e3,0x34e331b231b2b4e3,0xaeb3b567b501b146,0x3567aeb33146b501,0x3567aeb33146b501,0x2eb3356735013146
.quad 0,0,0,0,0,0,0,0,0,0,0,0,0,0,0,0
.quad 0,0,0,0,0,0,0,0,0,0,0,0,0,0,0,0
.quad 0,0,0,0,0,0,0,0,0,0,0,0,0,0,0,0
.quad 0,0,0,0,0,0,0,0,0,0,0,0,0,0,0,0
.quad 0x3400340034003400,0x3400340034003400,0xb4003400b4003400,0xb4003400b4003400,0x35a7a42a342e33a0,0xa42ab5a733a0b42e,0x242a35a7b3a0342e,0x35a7a42a342e33a0,0x333bb45a345a333b,0xb33b345ab45ab33b,0x345a333bb33b345a,0xb45ab33b333bb45a,0xaa3ab59a348332d3,0x359aaa3ab2d33483,0x359aaa3ab2d33483,0x2a3a359ab483b2d3
.quad 0xb4aab26734aa3267,0xb4aab26734aa3267,0x3267b4aab26734aa,0x3267b4aab26734aa,0xb5822d2934cf31f7,0x2d29358231f7b4cf,0xad29b582b1f734cf,0xb5822d2934cf31f7,0xb18434f034f03184,0x3184b4f0b4f0b184,0xb4f0b184b18434f0,0x34f031843184b4f0,0x2f2a355e3510310e,0xb55e2f2ab10e3510,0xb55e2f2ab10e3510,0xaf2ab55eb510b10e
.quad 0x3400340034003400,0x3400340034003400,0xb4003400b4003400,0xb4003400b4003400,0xb5a7242ab42eb3a0,0x242a35a7b3a0342e,0xa42ab5a733a0b42e,0xb5a7242ab42eb3a0,0x333bb45a345a333b,0xb33b345ab45ab33b,0x345a333bb33b345a,0xb45ab33b333bb45a,0x2a3a359ab483b2d3,0xb59a2a3a32d3b483,0xb59a2a3a32d3b483,0xaa3ab59a348332d3
.quad 0xb4aab26734aa3267,0xb4aab26734aa3267,0x3267b4aab26734aa,0x3267b4aab26734aa,0x3582ad29b4cfb1f7,0xad29b582b1f734cf,0x2d29358231f7b4cf,0x3582ad29b4cfb1f7,0xb18434f034f03184,0x3184b4f0b4f0b184,0xb4f0b184b18434f0,0x34f031843184b4f0,0xaf2ab55eb510b10e,0x355eaf2a310eb510,0x355eaf2a310eb510,0x2f2a355e3510310e
.quad 0,0,0,0,0,0,0,0,0,0,0,0,0,0,0,0
.quad 0,0,0,0,0,0,0,0,0,0,0,0,0,0,0,0
.quad 0,0,0,0,0,0,0,0,0,0,0,0,0,0,0,0
.quad 0,0,0,0,0,0,0,0,0,0,0,0,0,0,0,0
.quad 0x3400340034003400,0x3400340034003400,0xb4003400b4003400,0xb4003400b4003400,0x35a6a47134313399,0xa471b5a63399b431,0x247135a6b3993431,0x35a6a47134313399,0x332db45f345f332d,0xb32d345fb45fb32d,0x345f332db32d345f,0xb45fb32d332db45f,0xaaa4b598348b32bd,0x3598aaa4b2bd348b,0x3598aaa4b2bd348b,0x2aa43598b48bb2bd
.quad 0xb4b4b24934b43249,0xb4b4b24934b43249,0x3249b4b4b24934b4,0x3249b4b4b24934b4,0xb57d2d7f34da31d1,0x2d7f357d31d1b4da,0xad7fb57db1d134da,0xb57d2d7f34da31d1,0xb15534fd34fd3155,0x3155b4fdb4fdb155,0xb4fdb155b15534fd,0x34fd31553155b4fd,0x2f9f3554351d30d6,0xb5542f9fb0d6351d,0xb5542f9fb0d6351d,0xaf9fb554b51db0d6
.quad 0x3400340034003400,0x3400340034003400,0xb4003400b4003400,0xb4003400b4003400,0xb5a62471b431b399,0x247135a6b3993431,0xa471b5a63399b431,0xb5a62471b431b399,0x332db45f345f332d,0xb32d345fb45fb32d,0x345f332db32d345f,0xb45fb32d332db45f,0x2aa43598b48bb2bd,0xb5982aa432bdb48b,0xb5982aa432bdb48b,0xaaa4b598348b32bd
.quad 0xb4b4b24934b43249,0xb4b4b24934b43249,0x3249b4b4b24934b4,0x3249b4b4b24934b4,0x357dad7fb4dab1d1,0xad7fb57db1d134da,0x2d7f357d31d1b4da,0x357dad7fb4dab1d1,0xb15534fd34fd3155,0x3155b4fdb4fdb155,0xb4fdb155b15534fd,0x34fd31553155b4fd,0xaf9fb554b51db0d6,0x3554af9f30d6b51d,0x3554af9f30d6b51d,0x2f9f3554351d30d6
.quad 0,0,0,0,0,0,0,0,0,0,0,0,0,0,0,0
.quad 0,0,0,0,0,0,0,0,0,0,0,0,0,0,0,0
.quad 0,0,0,0,0,0,0,0,0,0,0,0,0,0,0,0
.quad 0,0,0,0,0,0,0,0,0,0,0,0,0,0,0,0
.quad 0x3400340034003400,0x3400340034003400,0xb4003400b4003400,0xb4003400b4003400,0x35a6a4b834343392,0xa4b8b5a63392b434,0x24b835a6b3923434,0x35a6a4b834343392,0x3320b46534653320,0xb3203465b465b320,0x34653320b3203465,0xb465b3203320b465,0xab0db596349332a8,0x3596ab0db2a83493,0x3596ab0db2a83493,0x2b0d3596b493b2a8
.quad 0xb4beb22b34be322b,0xb4beb22b34be322b,0x322bb4beb22b34be,0x322bb4beb22b34be,0xb5772dd634e531ab,0x2dd6357731abb4e5,0xadd6b577b1ab34e5,0xb5772dd634e531ab,0xb126350a350a3126,0x3126b50ab50ab126,0xb50ab126b126350a,0x350a31263126b50a,0x300a3549352a309e,0xb549300ab09e352a,0xb549300ab09e352a,0xb00ab549b52ab09e
.quad 0x3400340034003400,0x3400340034003400,0xb4003400b4003400,0xb4003400b4003400,0xb5a624b8b434b392,0x24b835a6b3923434,0xa4b8b5a63392b434,0xb5a624b8b434b392,0x3320b46534653320,0xb3203465b465b320,0x34653320b3203465,0xb465b3203320b465,0x2b0d3596b493b2a8,0xb5962b0d32a8b493,0xb5962b0d32a8b493,0xab0db596349332a8
.quad 0xb4beb22b34be322b,0xb4beb22b34be322b,0x322bb4beb22b34be,0x322bb4beb22b34be,0x3577add6b4e5b1ab,0xadd6b577b1ab34e5,0x2dd6357731abb4e5,0x3577add6b4e5b1ab,0xb126350a350a3126,0x3126b50ab50ab126,0xb50ab126b126350a,0x350a31263126b50a,0xb00ab549b52ab09e,0x3549b00a309eb52a,0x3549b00a309eb52a,0x300a3549352a309e
.quad 0,0,0,0,0,0,0,0,0,0,0,0,0,0,0,0
.quad 0,0,0,0,0,0,0,0,0,0,0,0,0,0,0,0
.quad 0,0,0,0,0,0,0,0,0,0,0,0,0,0,0,0
.quad 0,0,0,0,0,0,0,0,0,0,0,0,0,0,0,0
.quad 0x3400340034003400,0x3400340034003400,0xb4003400b4003400,0xb4003400b4003400,0x35a6a4ff3437338c,0xa4ffb5a6338cb437,0x24ff35a6b38c3437,0x35a6a4ff3437338c,0x3312b46b346b3312,0xb312346bb46bb312,0x346b3312b312346b,0xb46bb3123312b46b,0xab77b594349b3292,0x3594ab77b292349b,0x3594ab77b292349b,0x2b773594b49bb292
.quad 0xb4c7b20e34c7320e,0xb4c7b20e34c7320e,0x320eb4c7b20e34c7,0x320eb4c7b20e34c7,0xb5712e2b34f03184,0x2e2b35713184b4f0,0xae2bb571b18434f0,0xb5712e2b34f03184,0xb0f63515351530f6,0x30f6b515b515b0f6,0xb515b0f6b0f63515,0x351530f630f6b515,0x3044353d35363065,0xb53d3044b0653536,0xb53d3044b0653536,0xb044b53db536b065
.quad 0x3400340034003400,0x3400340034003400,0xb4003400b4003400,0xb4003400b4003400,0xb5a624ffb437b38c,0x24ff35a6b38c3437,0xa4ffb5a6338cb437,0xb5a624ffb437b38c,0x3312b46b346b3312,0xb312346bb46bb312,0x346b3312b312346b,0xb46bb3123312b46b,0x2b773594b49bb292,0xb5942b773292b49b,0xb5942b773292b49b,0xab77b594349b3292
.quad 0xb4c7b20e34c7320e,0xb4c7b20e34c7320e,0x320eb4c7b20e34c7,0x320eb4c7b20e34c7,0x3571ae2bb4f0b184,0xae2bb571b18434f0,0x2e2b35713184b4f0,0x3571ae2bb4f0b184,0xb0f63515351530f6,0x30f6b515b515b0f6,0xb515b0f6b0f63515,0x351530f630f6b515,0xb044b53db536b065,0x353db0443065b536,0x353db0443065b536,0x3044353d35363065
.quad 0,0,0,0,0,0,0,0,0,0,0,0,0,0,0,0
.quad 0,0,0,0,0,0,0,0,0,0,0,0,0,0,0,0
.quad 0,0,0,0,0,0,0,0,0,0,0,0,0,0,0,0
.quad 0,0,0,0,0,0,0,0,0,0,0,0,0,0,0,0
.quad 0x3400340034003400,0x3400340034003400,0xb4003400b4003400,0xb4003400b4003400,0x35a6a546343a3385,0xa546b5a63385b43a,0x254635a6b385343a,0x35a6a546343a3385,0x3304b47034703304,0xb3043470b470b304,0x34703304b3043470,0xb470b3043304b470,0xabe0b59234a3327c,0x3592abe0b27c34a3,0x3592abe0b27c34a3,0x2be03592b4a3b27c
.quad 0xb4d1b1ef34d131ef,0xb4d1b1ef34d131ef,0x31efb4d1b1ef34d1,0x31efb4d1b1ef34d1,0xb56b2e8034fb315d,0x2e80356b315db4fb,0xae80b56bb15d34fb,0xb56b2e8034fb315d,0xb0c63521352130c6,0x30c6b521b521b0c6,0xb521b0c6b0c63521,0x352130c630c6b521,0x307d35313542302b,0xb531307db02b3542,0xb531307db02b3542,0xb07db531b542b02b
.quad 0x3400340034003400,0x3400340034003400,0xb4003400b4003400,0xb4003400b4003400,0xb5a62546b43ab385,0x254635a6b385343a,0xa546b5a63385b43a,0xb5a62546b43ab385,0x3304b47034703304,0xb3043470b470b304,0x34703304b3043470,0xb470b3043304b470,0x2be03592b4a3b27c,0xb5922be0327cb4a3,0xb5922be0327cb4a3,0xabe0b59234a3327c
.quad 0xb4d1b1ef34d131ef,0xb4d1b1ef34d131ef,0x31efb4d1b1ef34d1,0x31efb4d1b1ef34d1,0x356bae80b4fbb15d,0xae80b56bb15d34fb,0x2e80356b315db4fb,0x356bae80b4fbb15d,0xb0c63521352130c6,0x30c6b521b521b0c6,0xb521b0c6b0c63521,0x352130c630c6b521,0xb07db531b542b02b,0x3531b07d302bb542,0x3531b07d302bb542,0x307d35313542302b
.quad 0,0,0,0,0,0,0,0,0,0,0,0,0,0,0,0
.quad 0,0,0,0,0,0,0,0,0,0,0,0,0,0,0,0
.quad 0,0,0,0,0,0,0,0,0,0,0,0,0,0,0,0
.quad 0,0,0,0,0,0,0,0,0,0,0,0,0,0,0,0
.quad 0x3400340034003400,0x3400340034003400,0xb4003400b4003400,0xb4003400b4003400,0x35a5a58d343d337f,0xa58db5a5337fb43d,0x258d35a5b37f343d,0x35a5a58d343d337f,0x32f6b476347632f6,0xb2f63476b476b2f6,0x347632f6b2f63476,0xb476b2f632f6b476,0xac24b59034aa3267,0x3590ac24b26734aa,0x3590ac24b26734aa,0x2c243590b4aab267
.quad 0xb4dab1d134da31d1,0xb4dab1d134da31d1,0x31d1b4dab1d134da,0x31d1b4dab1d134da,0xb5652ed535053136,0x2ed535653136b505,0xaed5b565b1363505,0xb5652ed535053136,0xb096352c352c3096,0x3096b52cb52cb096,0xb52cb096b096352c,0x352c30963096b52c,0x30b63525354d2fe2,0xb52530b6afe2354d,0xb52530b6afe2354d,0xb0b6b525b54dafe2
.quad 0x3400340034003400,0x3400340034003400,0xb4003400b4003400,0xb4003400b4003400,0xb5a5258db43db37f,0x258d35a5b37f343d,0xa58db5a5337fb43d,0xb5a5258db43db37f,0x32f6b476347632f6,0xb2f63476b476b2f6,0x347632f6b2f63476,0xb476b2f632f6b476,0x2c243590b4aab267,0xb5902c243267b4aa,0xb5902c243267b4aa,0xac24b59034aa3267
.quad 0xb4dab1d134da31d1,0xb4dab1d134da31d1,0x31d1b4dab1d134da,0x31d1b4dab1d134da,0x3565aed5b505b136,0xaed5b565b1363505,0x2ed535653136b505,0x3565aed5b505b136,0xb096352c352c3096,0x3096b52cb52cb096,0xb52cb096b096352c,0x352c30963096b52c,0xb0b6b525b54dafe2,0x3525b0b62fe2b54d,0x3525b0b62fe2b54d,0x30b63525354d2fe2
.quad 0,0,0,0,0,0,0,0,0,0,0,0,0,0,0,0
.quad 0,0,0,0,0,0,0,0,0,0,0,0,0,0,0,0
.quad 0,0,0,0,0,0,0,0,0,0,0,0,0,0,0,0
.quad 0,0,0,0,0,0,0,0,0,0,0,0,0,0,0,0
.quad 0x3400340034003400,0x3400340034003400,0xb4003400b4003400,0xb4003400b4003400,0x35a5a5d434403378,0xa5d4b5a53378b440,0x25d435a5b3783440,0x35a5a5d434403378,0x32e8b47b347b32e8,0xb2e8347bb47bb2e8,0x347b32e8b2e8347b,0xb47bb2e832e8b47b,0xac59b58d34b23250,0x358dac59b25034b2,0x358dac59b25034b2,0x2c59358db4b2b250
.quad 0xb4e3b1b234e331b2,0xb4e3b1b234e331b2,0x31b2b4e3b1b234e3,0x31b2b4e3b1b234e3,0xb55e2f2a3510310e,0x2f2a355e310eb510,0xaf2ab55eb10e3510,0xb55e2f2a3510310e,0xb065353635363065,0x3065b536b536b065,0xb536b065b0653536,0x353630653065b536,0x30ee351735582f6d,0xb51730eeaf6d3558,0xb51730eeaf6d3558,0xb0eeb517b558af6d
.quad 0x3400340034003400,0x3400340034003400,0xb4003400b4003400,0xb4003400b4003400,0xb5a525d4b440b378,0x25d435a5b3783440,0xa5d4b5a53378b440,0xb5a525d4b440b378,0x32e8b47b347b32e8,0xb2e8347bb47bb2e8,0x347b32e8b2e8347b,0xb47bb2e832e8b47b,0x2c59358db4b2b250,0xb58d2c593250b4b2,0xb58d2c593250b4b2,0xac59b58d34b23250
.quad 0xb4e3b1b234e331b2,0xb4e3b1b234e331b2,0x31b2b4e3b1b234e3,0x31b2b4e3b1b234e3,0x355eaf2ab510b10e,0xaf2ab55eb10e3510,0x2f2a355e310eb510,0x355eaf2ab510b10e,0xb065353635363065,0x3065b536b536b065,0xb536b065b0653536,0x353630653065b536,0xb0eeb517b558af6d,0x3517b0ee2f6db558,0x3517b0ee2f6db558,0x30ee351735582f6d
.quad 0,0,0,0,0,0,0,0,0,0,0,0,0,0,0,0
.quad 0,0,0,0,0,0,0,0,0,0,0,0,0,0,0,0
.quad 0,0,0,0,0,0,0,0,0,0,0,0,0,0,0,0
.quad 0,0,0,0,0,0,0,0,0,0,0,0,0,0,0,0
.quad 0x3400340034003400,0x3400340034003400,0xb4003400b4003400,0xb4003400b4003400,0x35a5a61b34433371,0xa61bb5a53371b443,0x261b35a5b3713443,0x35a5a61b34433371,0x32dab480348032da,0xb2da3480b480b2da,0x348032dab2da3480,0xb480b2da32dab480,0xac8db58b34b9323a,0x358bac8db23a34b9,0x358bac8db23a34b9,0x2c8d358bb4b9b23a
.quad 0xb4ecb19434ec3194,0xb4ecb19434ec3194,0x3194b4ecb19434ec,0x3194b4ecb19434ec,0xb5562f7e351930e6,0x2f7e355630e6b519,0xaf7eb556b0e63519,0xb5562f7e351930e6,0xb033354135413033,0x3033b541b541b033,0xb541b033b0333541,0x354130333033b541,0x3126350a35622ef7,0xb50a3126aef73562,0xb50a3126aef73562,0xb126b50ab562aef7
.quad 0x3400340034003400,0x3400340034003400,0xb4003400b4003400,0xb4003400b4003400,0xb5a5261bb443b371,0x261b35a5b3713443,0xa61bb5a53371b443,0xb5a5261bb443b371,0x32dab480348032da,0xb2da3480b480b2da,0x348032dab2da3480,0xb480b2da32dab480,0x2c8d358bb4b9b23a,0xb58b2c8d323ab4b9,0xb58b2c8d323ab4b9,0xac8db58b34b9323a
.quad 0xb4ecb19434ec3194,0xb4ecb19434ec3194,0x3194b4ecb19434ec,0x3194b4ecb19434ec,0x3556af7eb519b0e6,0xaf7eb556b0e63519,0x2f7e355630e6b519,0x3556af7eb519b0e6,0xb033354135413033,0x3033b541b541b033,0xb541b033b0333541,0x354130333033b541,0xb126b50ab562aef7,0x350ab1262ef7b562,0x350ab1262ef7b562,0x3126350a35622ef7
.quad 0,0,0,0,0,0,0,0,0,0,0,0,0,0,0,0
.quad 0,0,0,0,0,0,0,0,0,0,0,0,0,0,0,0
.quad 0,0,0,0,0,0,0,0,0,0,0,0,0,0,0,0
.quad 0,0,0,0,0,0,0,0,0,0,0,0,0,0,0,0
.quad 0x3400340034003400,0x3400340034003400,0xb4003400b4003400,0xb4003400b4003400,0x35a5a6623446336b,0xa662b5a5336bb446,0x266235a5b36b3446,0x35a5a6623446336b,0x32ccb486348632cc,0xb2cc3486b486b2cc,0x348632ccb2cc3486,0xb486b2cc32ccb486,0xacc1b58834c03224,0x3588acc1b22434c0,0x3588acc1b22434c0,0x2cc13588b4c0b224
.quad 0xb4f5b17534f53175,0xb4f5b17534f53175,0x3175b4f5b17534f5,0x3175b4f5b17534f5,0xb54f2fd2352330be,0x2fd2354f30beb523,0xafd2b54fb0be3523,0xb54f2fd2352330be,0xb002354a354a3002,0x3002b54ab54ab002,0xb54ab002b002354a,0x354a30023002b54a,0x315d34fb356b2e80,0xb4fb315dae80356b,0xb4fb315dae80356b,0xb15db4fbb56bae80
.quad 0x3400340034003400,0x3400340034003400,0xb4003400b4003400,0xb4003400b4003400,0xb5a52662b446b36b,0x266235a5b36b3446,0xa662b5a5336bb446,0xb5a52662b446b36b,0x32ccb486348632cc,0xb2cc3486b486b2cc,0x348632ccb2cc3486,0xb486b2cc32ccb486,0x2cc13588b4c0b224,0xb5882cc13224b4c0,0xb5882cc13224b4c0,0xacc1b58834c03224
.quad 0xb4f5b17534f53175,0xb4f5b17534f53175,0x3175b4f5b17534f5,0x3175b4f5b17534f5,0x354fafd2b523b0be,0xafd2b54fb0be3523,0x2fd2354f30beb523,0x354fafd2b523b0be,0xb002354a354a3002,0x3002b54ab54ab002,0xb54ab002b002354a,0x354a30023002b54a,0xb15db4fbb56bae80,0x34fbb15d2e80b56b,0x34fbb15d2e80b56b,0x315d34fb356b2e80
.quad 0,0,0,0,0,0,0,0,0,0,0,0,0,0,0,0
.quad 0,0,0,0,0,0,0,0,0,0,0,0,0,0,0,0
.quad 0,0,0,0,0,0,0,0,0,0,0,0,0,0,0,0
.quad 0,0,0,0,0,0,0,0,0,0,0,0,0,0,0,0
.quad 0x3400340034003400,0x3400340034003400,0xb4003400b4003400,0xb4003400b4003400,0x35a4a6a934493364,0xa6a9b5a43364b449,0x26a935a4b3643449,0x35a4a6a934493364,0x32bdb48b348b32bd,0xb2bd348bb48bb2bd,0x348b32bdb2bd348b,0xb48bb2bd32bdb48b,0xacf5b58534c7320e,0x3585acf5b20e34c7,0x3585acf5b20e34c7,0x2cf53585b4c7b20e
.quad 0xb4fdb15534fd3155,0xb4fdb15534fd3155,0x3155b4fdb15534fd,0x3155b4fdb15534fd,0xb5473012352c3096,0x301235473096b52c,0xb012b547b096352c,0xb5473012352c3096,0xaf9f355435542f9f,0x2f9fb554b554af9f,0xb554af9faf9f3554,0x35542f9f2f9fb554,0x319434ec35742e09,0xb4ec3194ae093574,0xb4ec3194ae093574,0xb194b4ecb574ae09
.quad 0x3400340034003400,0x3400340034003400,0xb4003400b4003400,0xb4003400b4003400,0xb5a426a9b449b364,0x26a935a4b3643449,0xa6a9b5a43364b449,0xb5a426a9b449b364,0x32bdb48b348b32bd,0xb2bd348bb48bb2bd,0x348b32bdb2bd348b,0xb48bb2bd32bdb48b,0x2cf53585b4c7b20e,0xb5852cf5320eb4c7,0xb5852cf5320eb4c7,0xacf5b58534c7320e
.quad 0xb4fdb15534fd3155,0xb4fdb15534fd3155,0x3155b4fdb15534fd,0x3155b4fdb15534fd,0x3547b012b52cb096,0xb012b547b096352c,0x301235473096b52c,0x3547b012b52cb096,0xaf9f355435542f9f,0x2f9fb554b554af9f,0xb554af9faf9f3554,0x35542f9f2f9fb554,0xb194b4ecb574ae09,0x34ecb1942e09b574,0x34ecb1942e09b574,0x319434ec35742e09
.quad 0,0,0,0,0,0,0,0,0,0,0,0,0,0,0,0
.quad 0,0,0,0,0,0,0,0,0,0,0,0,0,0,0,0
.quad 0,0,0,0,0,0,0,0,0,0,0,0,0,0,0,0
.quad 0,0,0,0,0,0,0,0,0,0,0,0,0,0,0,0
.quad 0x3400340034003400,0x3400340034003400,0xb4003400b4003400,0xb4003400b4003400,0x35a4a6ef344b335d,0xa6efb5a4335db44b,0x26ef35a4b35d344b,0x35a4a6ef344b335d,0x32afb490349032af,0xb2af3490b490b2af,0x349032afb2af3490,0xb490b2af32afb490,0xad29b58234cf31f7,0x3582ad29b1f734cf,0x3582ad29b1f734cf,0x2d293582b4cfb1f7
.quad 0xb505b13635053136,0xb505b13635053136,0x3136b505b1363505,0x3136b505b1363505,0xb53f303c3535306d,0x303c353f306db535,0xb03cb53fb06d3535,0xb53f303c3535306d,0xaf3b355c355c2f3b,0x2f3bb55cb55caf3b,0xb55caf3baf3b355c,0x355c2f3b2f3bb55c,0x31c934dc357c2d91,0xb4dc31c9ad91357c,0xb4dc31c9ad91357c,0xb1c9b4dcb57cad91
.quad 0x3400340034003400,0x3400340034003400,0xb4003400b4003400,0xb4003400b4003400,0xb5a426efb44bb35d,0x26ef35a4b35d344b,0xa6efb5a4335db44b,0xb5a426efb44bb35d,0x32afb490349032af,0xb2af3490b490b2af,0x349032afb2af3490,0xb490b2af32afb490,0x2d293582b4cfb1f7,0xb5822d2931f7b4cf,0xb5822d2931f7b4cf,0xad29b58234cf31f7
.quad 0xb505b13635053136,0xb505b13635053136,0x3136b505b1363505,0x3136b505b1363505,0x353fb03cb535b06d,0xb03cb53fb06d3535,0x303c353f306db535,0x353fb03cb535b06d,0xaf3b355c355c2f3b,0x2f3bb55cb55caf3b,0xb55caf3baf3b355c,0x355c2f3b2f3bb55c,0xb1c9b4dcb57cad91,0x34dcb1c92d91b57c,0x34dcb1c92d91b57c,0x31c934dc357c2d91
.quad 0,0,0,0,0,0,0,0,0,0,0,0,0,0,0,0
.quad 0,0,0,0,0,0,0,0,0,0,0,0,0,0,0,0
.quad 0,0,0,0,0,0,0,0,0,0,0,0,0,0,0,0
.quad 0,0,0,0,0,0,0,0,0,0,0,0,0,0,0,0
.quad 0x3400340034003400,0x3400340034003400,0xb4003400b4003400,0xb4003400b4003400,0x35a4a736344e3356,0xa736b5a43356b44e,0x273635a4b356344e,0x35a4a736344e3356,0x32a1b496349632a1,0xb2a13496b496b2a1,0x349632a1b2a13496,0xb496b2a132a1b496,0xad5db57f34d631e0,0x357fad5db1e034d6,0x357fad5db1e034d6,0x2d5d357fb4d6b1e0
.quad 0xb50eb116350e3116,0xb50eb116350e3116,0x3116b50eb116350e,0x3116b50eb116350e,0xb5363065353d3044,0x306535363044b53d,0xb065b536b044353d,0xb5363065353d3044,0xaed5356535652ed5,0x2ed5b565b565aed5,0xb565aed5aed53565,0x35652ed52ed5b565,0x31fe34cc35832d18,0xb4cc31fead183583,0xb4cc31fead183583,0xb1feb4ccb583ad18
.quad 0x3400340034003400,0x3400340034003400,0xb4003400b4003400,0xb4003400b4003400,0xb5a42736b44eb356,0x273635a4b356344e,0xa736b5a43356b44e,0xb5a42736b44eb356,0x32a1b496349632a1,0xb2a13496b496b2a1,0x349632a1b2a13496,0xb496b2a132a1b496,0x2d5d357fb4d6b1e0,0xb57f2d5d31e0b4d6,0xb57f2d5d31e0b4d6,0xad5db57f34d631e0
.quad 0xb50eb116350e3116,0xb50eb116350e3116,0x3116b50eb116350e,0x3116b50eb116350e,0x3536b065b53db044,0xb065b536b044353d,0x306535363044b53d,0x3536b065b53db044,0xaed5356535652ed5,0x2ed5b565b565aed5,0xb565aed5aed53565,0x35652ed52ed5b565,0xb1feb4ccb583ad18,0x34ccb1fe2d18b583,0x34ccb1fe2d18b583,0x31fe34cc35832d18
.quad 0,0,0,0,0,0,0,0,0,0,0,0,0,0,0,0
.quad 0,0,0,0,0,0,0,0,0,0,0,0,0,0,0,0
.quad 0,0,0,0,0,0,0,0,0,0,0,0,0,0,0,0
.quad 0,0,0,0,0,0,0,0,0,0,0,0,0,0,0,0
.quad 0x3400340034003400,0x3400340034003400,0xb4003400b4003400,0xb4003400b4003400,0x35a3a77d34513350,0xa77db5a33350b451,0x277d35a3b3503451,0x35a3a77d34513350,0x3292b49b349b3292,0xb292349bb49bb292,0x349b3292b292349b,0xb49bb2923292b49b,0xad91b57c34dc31c9,0x357cad91b1c934dc,0x357cad91b1c934dc,0x2d91357cb4dcb1c9
.quad 0xb515b0f6351530f6,0xb515b0f6351530f6,0x30f6b515b0f63515,0x30f6b515b0f63515,0xb52e308e3546301b,0x308e352e301bb546,0xb08eb52eb01b3546,0xb52e308e3546301b,0xae6f356c356c2e6f,0x2e6fb56cb56cae6f,0xb56cae6fae6f356c,0x356c2e6f2e6fb56c,0x323334bb358a2c9e,0xb4bb3233ac9e358a,0xb4bb3233ac9e358a,0xb233b4bbb58aac9e
.quad 0x3400340034003400,0x3400340034003400,0xb4003400b4003400,0xb4003400b4003400,0xb5a3277db451b350,0x277d35a3b3503451,0xa77db5a33350b451,0xb5a3277db451b350,0x3292b49b349b3292,0xb292349bb49bb292,0x349b3292b292349b,0xb49bb2923292b49b,0x2d91357cb4dcb1c9,0xb57c2d9131c9b4dc,0xb57c2d9131c9b4dc,0xad91b57c34dc31c9
.quad 0xb515b0f6351530f6,0xb515b0f6351530f6,0x30f6b515b0f63515,0x30f6b515b0f63515,0x352eb08eb546b01b,0xb08eb52eb01b3546,0x308e352e301bb546,0x352eb08eb546b01b,0xae6f356c356c2e6f,0x2e6fb56cb56cae6f,0xb56cae6fae6f356c,0x356c2e6f2e6fb56c,0xb233b4bbb58aac9e,0x34bbb2332c9eb58a,0x34bbb2332c9eb58a,0x323334bb358a2c9e
.quad 0,0,0,0,0,0,0,0,0,0,0,0,0,0,0,0
.quad 0,0,0,0,0,0,0,0,0,0,0,0,0,0,0,0
.quad 0,0,0,0,0,0,0,0,0,0,0,0,0,0,0,0
.quad 0,0,0,0,0,0,0,0,0,0,0,0,0,0,0,0
.quad 0x3400340034003400,0x3400340034003400,0xb4003400b4003400,0xb4003400b4003400,0x35a3a7c434543349,0xa7c4b5a33349b454,0x27c435a3b3493454,0x35a3a7c434543349,0x3284b4a034a03284,0xb28434a0b4a0b284,0x34a03284b28434a0,0xb4a0b2843284b4a0,0xadc4b57834e331b2,0x3578adc4b1b234e3,0x3578adc4b1b234e3,0x2dc43578b4e3b1b2
.quad 0xb51db0d6351d30d6,0xb51db0d6351d30d6,0x30d6b51db0d6351d,0x30d6b51db0d6351d,0xb52530b6354d2fe2,0x30b635252fe2b54d,0xb0b6b525afe2354d,0xb52530b6354d2fe2,0xae09357435742e09,0x2e09b574b574ae09,0xb574ae09ae093574,0x35742e092e09b574,0x326734aa35902c24,0xb4aa3267ac243590,0xb4aa3267ac243590,0xb267b4aab590ac24
.quad 0x3400340034003400,0x3400340034003400,0xb4003400b4003400,0xb4003400b4003400,0xb5a327c4b454b349,0x27c435a3b3493454,0xa7c4b5a33349b454,0xb5a327c4b454b349,0x3284b4a034a03284,0xb28434a0b4a0b284,0x34a03284b28434a0,0xb4a0b2843284b4a0,0x2dc43578b4e3b1b2,0xb5782dc431b2b4e3,0xb5782dc431b2b4e3,0xadc4b57834e331b2
.quad 0xb51db0d6351d30d6,0xb51db0d6351d30d6,0x30d6b51db0d6351d,0x30d6b51db0d6351d,0x3525b0b6b54dafe2,0xb0b6b525afe2354d,0x30b635252fe2b54d,0x3525b0b6b54dafe2,0xae09357435742e09,0x2e09b574b574ae09,0xb574ae09ae093574,0x35742e092e09b574,0xb267b4aab590ac24,0x34aab2672c24b590,0x34aab2672c24b590,0x326734aa35902c24
.quad 0,0,0,0,0,0,0,0,0,0,0,0,0,0,0,0
.quad 0,0,0,0,0,0,0,0,0,0,0,0,0,0,0,0
.quad 0,0,0,0,0,0,0,0,0,0,0,0,0,0,0,0
.quad 0,0,0,0,0,0,0,0,0,0,0,0,0,0,0,0
.quad 0x3400340034003400,0x3400340034003400,0xb4003400b4003400,0xb4003400b4003400,0x35a2a80534573342,0xa805b5a23342b457,0x280535a2b3423457,0x35a2a80534573342,0x3275b4a534a53275,0xb27534a5b4a5b275,0x34a53275b27534a5,0xb4a5b2753275b4a5,0xadf8b57534ea319b,0x3575adf8b19b34ea,0x3575adf8b19b34ea,0x2df83575b4eab19b
.quad 0xb525b0b6352530b6,0xb525b0b6352530b6,0x30b6b525b0b63525,0x30b6b525b0b63525,0xb51b30de35552f8f,0x30de351b2f8fb555,0xb0deb51baf8f3555,0xb51b30de35552f8f,0xada2357b357b2da2,0x2da2b57bb57bada2,0xb57bada2ada2357b,0x357b2da22da2b57b,0x3299349835952b53,0xb4983299ab533595,0xb4983299ab533595,0xb299b498b595ab53
.quad 0x3400340034003400,0x3400340034003400,0xb4003400b4003400,0xb4003400b4003400,0xb5a22805b457b342,0x280535a2b3423457,0xa805b5a23342b457,0xb5a22805b457b342,0x3275b4a534a53275,0xb27534a5b4a5b275,0x34a53275b27534a5,0xb4a5b2753275b4a5,0x2df83575b4eab19b,0xb5752df8319bb4ea,0xb5752df8319bb4ea,0xadf8b57534ea319b
.quad 0xb525b0b6352530b6,0xb525b0b6352530b6,0x30b6b525b0b63525,0x30b6b525b0b63525,0x351bb0deb555af8f,0xb0deb51baf8f3555,0x30de351b2f8fb555,0x351bb0deb555af8f,0xada2357b357b2da2,0x2da2b57bb57bada2,0xb57bada2ada2357b,0x357b2da22da2b57b,0xb299b498b595ab53,0x3498b2992b53b595,0x3498b2992b53b595,0x3299349835952b53
.quad 0,0,0,0,0,0,0,0,0,0,0,0,0,0,0,0
.quad 0,0,0,0,0,0,0,0,0,0,0,0,0,0,0,0
.quad 0,0,0,0,0,0,0,0,0,0,0,0,0,0,0,0
.quad 0,0,0,0,0,0,0,0,0,0,0,0,0,0,0,0
.quad 0x3400340034003400,0x3400340034003400,0xb4003400b4003400,0xb4003400b4003400,0x35a2a829345a333b,0xa829b5a2333bb45a,0x282935a2b33b345a,0x35a2a829345a333b,0x3267b4aa34aa3267,0xb26734aab4aab267,0x34aa3267b26734aa,0xb4aab2673267b4aa,0xae2bb57134f03184,0x3571ae2bb18434f0,0x3571ae2bb18434f0,0x2e2b3571b4f0b184
.quad 0xb52cb096352c3096,0xb52cb096352c3096,0x3096b52cb096352c,0x3096b52cb096352c,0xb5113106355c2f3b,0x310635112f3bb55c,0xb106b511af3b355c,0xb5113106355c2f3b,0xad3a358135812d3a,0x2d3ab581b581ad3a,0xb581ad3aad3a3581,0x35812d3a2d3ab581,0x32cc3486359a2a5e,0xb48632ccaa5e359a,0xb48632ccaa5e359a,0xb2ccb486b59aaa5e
.quad 0x3400340034003400,0x3400340034003400,0xb4003400b4003400,0xb4003400b4003400,0xb5a22829b45ab33b,0x282935a2b33b345a,0xa829b5a2333bb45a,0xb5a22829b45ab33b,0x3267b4aa34aa3267,0xb26734aab4aab267,0x34aa3267b26734aa,0xb4aab2673267b4aa,0x2e2b3571b4f0b184,0xb5712e2b3184b4f0,0xb5712e2b3184b4f0,0xae2bb57134f03184
.quad 0xb52cb096352c3096,0xb52cb096352c3096,0x3096b52cb096352c,0x3096b52cb096352c,0x3511b106b55caf3b,0xb106b511af3b355c,0x310635112f3bb55c,0x3511b106b55caf3b,0xad3a358135812d3a,0x2d3ab581b581ad3a,0xb581ad3aad3a3581,0x35812d3a2d3ab581,0xb2ccb486b59aaa5e,0x3486b2cc2a5eb59a,0x3486b2cc2a5eb59a,0x32cc3486359a2a5e
.quad 0,0,0,0,0,0,0,0,0,0,0,0,0,0,0,0
.quad 0,0,0,0,0,0,0,0,0,0,0,0,0,0,0,0
.quad 0,0,0,0,0,0,0,0,0,0,0,0,0,0,0,0
.quad 0,0,0,0,0,0,0,0,0,0,0,0,0,0,0,0
.quad 0x3400340034003400,0x3400340034003400,0xb4003400b4003400,0xb4003400b4003400,0x35a2a84c345d3334,0xa84cb5a23334b45d,0x284c35a2b334345d,0x35a2a84c345d3334,0x3258b4af34af3258,0xb25834afb4afb258,0x34af3258b25834af,0xb4afb2583258b4af,0xae5eb56e34f7316d,0x356eae5eb16d34f7,0x356eae5eb16d34f7,0x2e5e356eb4f7b16d
.quad 0xb533b07535333075,0xb533b07535333075,0x3075b533b0753533,0x3075b533b0753533,0xb507312e35632ee6,0x312e35072ee6b563,0xb12eb507aee63563,0xb507312e35632ee6,0xacd2358735872cd2,0x2cd2b587b587acd2,0xb587acd2acd23587,0x35872cd22cd2b587,0x32fd3473359e2967,0xb47332fda967359e,0xb47332fda967359e,0xb2fdb473b59ea967
.quad 0x3400340034003400,0x3400340034003400,0xb4003400b4003400,0xb4003400b4003400,0xb5a2284cb45db334,0x284c35a2b334345d,0xa84cb5a23334b45d,0xb5a2284cb45db334,0x3258b4af34af3258,0xb25834afb4afb258,0x34af3258b25834af,0xb4afb2583258b4af,0x2e5e356eb4f7b16d,0xb56e2e5e316db4f7,0xb56e2e5e316db4f7,0xae5eb56e34f7316d
.quad 0xb533b07535333075,0xb533b07535333075,0x3075b533b0753533,0x3075b533b0753533,0x3507b12eb563aee6,0xb12eb507aee63563,0x312e35072ee6b563,0x3507b12eb563aee6,0xacd2358735872cd2,0x2cd2b587b587acd2,0xb587acd2acd23587,0x35872cd22cd2b587,0xb2fdb473b59ea967,0x3473b2fd2967b59e,0x3473b2fd2967b59e,0x32fd3473359e2967
.quad 0,0,0,0,0,0,0,0,0,0,0,0,0,0,0,0
.quad 0,0,0,0,0,0,0,0,0,0,0,0,0,0,0,0
.quad 0,0,0,0,0,0,0,0,0,0,0,0,0,0,0,0
.quad 0,0,0,0,0,0,0,0,0,0,0,0,0,0,0,0
.quad 0x3400340034003400,0x3400340034003400,0xb4003400b4003400,0xb4003400b4003400,0x35a1a870345f332d,0xa870b5a1332db45f,0x287035a1b32d345f,0x35a1a870345f332d,0x3249b4b434b43249,0xb24934b4b4b4b249,0x34b43249b24934b4,0xb4b4b2493249b4b4,0xae92b56a34fd3155,0x356aae92b15534fd,0x356aae92b15534fd,0x2e92356ab4fdb155
.quad 0xb53ab054353a3054,0xb53ab054353a3054,0x3054b53ab054353a,0x3054b53ab054353a,0xb4fd3155356a2e92,0x315534fd2e92b56a,0xb155b4fdae92356a,0xb4fd3155356a2e92,0xac6a358c358c2c6a,0x2c6ab58cb58cac6a,0xb58cac6aac6a358c,0x358c2c6a2c6ab58c,0x332d345f35a12870,0xb45f332da87035a1,0xb45f332da87035a1,0xb32db45fb5a1a870
.quad 0x3400340034003400,0x3400340034003400,0xb4003400b4003400,0xb4003400b4003400,0xb5a12870b45fb32d,0x287035a1b32d345f,0xa870b5a1332db45f,0xb5a12870b45fb32d,0x3249b4b434b43249,0xb24934b4b4b4b249,0x34b43249b24934b4,0xb4b4b2493249b4b4,0x2e92356ab4fdb155,0xb56a2e923155b4fd,0xb56a2e923155b4fd,0xae92b56a34fd3155
.quad 0xb53ab054353a3054,0xb53ab054353a3054,0x3054b53ab054353a,0x3054b53ab054353a,0x34fdb155b56aae92,0xb155b4fdae92356a,0x315534fd2e92b56a,0x34fdb155b56aae92,0xac6a358c358c2c6a,0x2c6ab58cb58cac6a,0xb58cac6aac6a358c,0x358c2c6a2c6ab58c,0xb32db45fb5a1a870,0x345fb32d2870b5a1,0x345fb32d2870b5a1,0x332d345f35a12870
.quad 0,0,0,0,0,0,0,0,0,0,0,0,0,0,0,0
.quad 0,0,0,0,0,0,0,0,0,0,0,0,0,0,0,0
.quad 0,0,0,0,0,0,0,0,0,0,0,0,0,0,0,0
.quad 0,0,0,0,0,0,0,0,0,0,0,0,0,0,0,0
.quad 0x3400340034003400,0x3400340034003400,0xb4003400b4003400,0xb4003400b4003400,0x35a1a89334623327,0xa893b5a13327b462,0x289335a1b3273462,0x35a1a89334623327,0x323ab4b934b9323a,0xb23a34b9b4b9b23a,0x34b9323ab23a34b9,0xb4b9b23a323ab4b9,0xaec4b5663503313e,0x3566aec4b13e3503,0x3566aec4b13e3503,0x2ec43566b503b13e
.quad 0xb541b03335413033,0xb541b03335413033,0x3033b541b0333541,0x3033b541b0333541,0xb4f3317c35702e3c,0x317c34f32e3cb570,0xb17cb4f3ae3c3570,0xb4f3317c35702e3c,0xac01359135912c01,0x2c01b591b591ac01,0xb591ac01ac013591,0x35912c012c01b591,0x335d344b35a426ef,0xb44b335da6ef35a4,0xb44b335da6ef35a4,0xb35db44bb5a4a6ef
.quad 0x3400340034003400,0x3400340034003400,0xb4003400b4003400,0xb4003400b4003400,0xb5a12893b462b327,0x289335a1b3273462,0xa893b5a13327b462,0xb5a12893b462b327,0x323ab4b934b9323a,0xb23a34b9b4b9b23a,0x34b9323ab23a34b9,0xb4b9b23a323ab4b9,0x2ec43566b503b13e,0xb5662ec4313eb503,0xb5662ec4313eb503,0xaec4b5663503313e
.quad 0xb541b03335413033,0xb541b03335413033,0x3033b541b0333541,0x3033b541b0333541,0x34f3b17cb570ae3c,0xb17cb4f3ae3c3570,0x317c34f32e3cb570,0x34f3b17cb570ae3c,0xac01359135912c01,0x2c01b591b591ac01,0xb591ac01ac013591,0x35912c012c01b591,0xb35db44bb5a4a6ef,0x344bb35d26efb5a4,0x344bb35d26efb5a4,0x335d344b35a426ef
.quad 0,0,0,0,0,0,0,0,0,0,0,0,0,0,0,0
.quad 0,0,0,0,0,0,0,0,0,0,0,0,0,0,0,0
.quad 0,0,0,0,0,0,0,0,0,0,0,0,0,0,0,0
.quad 0,0,0,0,0,0,0,0,0,0,0,0,0,0,0,0
.quad 0x3400340034003400,0x3400340034003400,0xb4003400b4003400,0xb4003400b4003400,0x35a0a8b634653320,0xa8b6b5a03320b465,0x28b635a0b3203465,0x35a0a8b634653320,0x322bb4be34be322b,0xb22b34beb4beb22b,0x34be322bb22b34be,0xb4beb22b322bb4be,0xaef7b562350a3126,0x3562aef7b126350a,0x3562aef7b126350a,0x2ef73562b50ab126
.quad 0xb547b01235473012,0xb547b01235473012,0x3012b547b0123547,0x3012b547b0123547,0xb4e831a335762de7,0x31a334e82de7b576,0xb1a3b4e8ade73576,0xb4e831a335762de7,0xab30359635962b30,0x2b30b596b596ab30,0xb596ab30ab303596,0x35962b302b30b596,0x338c343735a624ff,0xb437338ca4ff35a6,0xb437338ca4ff35a6,0xb38cb437b5a6a4ff
.quad 0x3400340034003400,0x3400340034003400,0xb4003400b4003400,0xb4003400b4003400,0xb5a028b6b465b320,0x28b635a0b3203465,0xa8b6b5a03320b465,0xb5a028b6b465b320,0x322bb4be34be322b,0xb22b34beb4beb22b,0x34be322bb22b34be,0xb4beb22b322bb4be,0x2ef73562b50ab126,0xb5622ef73126b50a,0xb5622ef73126b50a,0xaef7b562350a3126
.quad 0xb547b01235473012,0xb547b01235473012,0x3012b547b0123547,0x3012b547b0123547,0x34e8b1a3b576ade7,0xb1a3b4e8ade73576,0x31a334e82de7b576,0x34e8b1a3b576ade7,0xab30359635962b30,0x2b30b596b596ab30,0xb596ab30ab303596,0x35962b302b30b596,0xb38cb437b5a6a4ff,0x3437b38c24ffb5a6,0x3437b38c24ffb5a6,0x338c343735a624ff
.quad 0,0,0,0,0,0,0,0,0,0,0,0,0,0,0,0
.quad 0,0,0,0,0,0,0,0,0,0,0,0,0,0,0,0
.quad 0,0,0,0,0,0,0,0,0,0,0,0,0,0,0,0
.quad 0,0,0,0,0,0,0,0,0,0,0,0,0,0,0,0
.quad 0x3400340034003400,0x3400340034003400,0xb4003400b4003400,0xb4003400b4003400,0x35a0a8da34683319,0xa8dab5a03319b468,0x28da35a0b3193468,0x35a0a8da34683319,0x321db4c334c3321d,0xb21d34c3b4c3b21d,0x34c3321db21d34c3,0xb4c3b21d321db4c3,0xaf2ab55e3510310e,0x355eaf2ab10e3510,0x355eaf2ab10e3510,0x2f2a355eb510b10e
.quad 0xb54dafe2354d2fe2,0xb54dafe2354d2fe2,0x2fe2b54dafe2354d,0x2fe2b54dafe2354d,0xb4dc31c9357c2d91,0x31c934dc2d91b57c,0xb1c9b4dcad91357c,0xb4dc31c9357c2d91,0xaa5e359a359a2a5e,0x2a5eb59ab59aaa5e,0xb59aaa5eaa5e359a,0x359a2a5e2a5eb59a,0x33ba342235a7221c,0xb42233baa21c35a7,0xb42233baa21c35a7,0xb3bab422b5a7a21c
.quad 0x3400340034003400,0x3400340034003400,0xb4003400b4003400,0xb4003400b4003400,0xb5a028dab468b319,0x28da35a0b3193468,0xa8dab5a03319b468,0xb5a028dab468b319,0x321db4c334c3321d,0xb21d34c3b4c3b21d,0x34c3321db21d34c3,0xb4c3b21d321db4c3,0x2f2a355eb510b10e,0xb55e2f2a310eb510,0xb55e2f2a310eb510,0xaf2ab55e3510310e
.quad 0xb54dafe2354d2fe2,0xb54dafe2354d2fe2,0x2fe2b54dafe2354d,0x2fe2b54dafe2354d,0x34dcb1c9b57cad91,0xb1c9b4dcad91357c,0x31c934dc2d91b57c,0x34dcb1c9b57cad91,0xaa5e359a359a2a5e,0x2a5eb59ab59aaa5e,0xb59aaa5eaa5e359a,0x359a2a5e2a5eb59a,0xb3bab422b5a7a21c,0x3422b3ba221cb5a7,0x3422b3ba221cb5a7,0x33ba342235a7221c
.quad 0,0,0,0,0,0,0,0,0,0,0,0,0,0,0,0
.quad 0,0,0,0,0,0,0,0,0,0,0,0,0,0,0,0
.quad 0,0,0,0,0,0,0,0,0,0,0,0,0,0,0,0
.quad 0,0,0,0,0,0,0,0,0,0,0,0,0,0,0,0
.quad 0x3400340034003400,0x3400340034003400,0xb4003400b4003400,0xb4003400b4003400,0x359fa8fd346b3312,0xa8fdb59f3312b46b,0x28fd359fb312346b,0x359fa8fd346b3312,0x320eb4c734c7320e,0xb20e34c7b4c7b20e,0x34c7320eb20e34c7,0xb4c7b20e320eb4c7,0xaf5cb559351530f6,0x3559af5cb0f63515,0x3559af5cb0f63515,0x2f5c3559b515b0f6
.quad 0xb554af9f35542f9f,0xb554af9f35542f9f,0x2f9fb554af9f3554,0x2f9fb554af9f3554,0xb4d131ef35812d3a,0x31ef34d12d3ab581,0xb1efb4d1ad3a3581,0xb4d131ef35812d3a,0xa98a359d359d298a,0x298ab59db59da98a,0xb59da98aa98a359d,0x359d298a298ab59d,0x33e7340c35a81c71,0xb40c33e79c7135a8,0xb40c33e79c7135a8,0xb3e7b40cb5a89c71
.quad 0x3400340034003400,0x3400340034003400,0xb4003400b4003400,0xb4003400b4003400,0xb59f28fdb46bb312,0x28fd359fb312346b,0xa8fdb59f3312b46b,0xb59f28fdb46bb312,0x320eb4c734c7320e,0xb20e34c7b4c7b20e,0x34c7320eb20e34c7,0xb4c7b20e320eb4c7,0x2f5c3559b515b0f6,0xb5592f5c30f6b515,0xb5592f5c30f6b515,0xaf5cb559351530f6
.quad 0xb554af9f35542f9f,0xb554af9f35542f9f,0x2f9fb554af9f3554,0x2f9fb554af9f3554,0x34d1b1efb581ad3a,0xb1efb4d1ad3a3581,0x31ef34d12d3ab581,0x34d1b1efb581ad3a,0xa98a359d359d298a,0x298ab59db59da98a,0xb59da98aa98a359d,0x359d298a298ab59d,0xb3e7b40cb5a89c71,0x340cb3e71c71b5a8,0x340cb3e71c71b5a8,0x33e7340c35a81c71
.quad 0,0,0,0,0,0,0,0,0,0,0,0,0,0,0,0
.quad 0,0,0,0,0,0,0,0,0,0,0,0,0,0,0,0
.quad 0,0,0,0,0,0,0,0,0,0,0,0,0,0,0,0
.quad 0,0,0,0,0,0,0,0,0,0,0,0,0,0,0,0
.quad 0x3400340034003400,0x3400340034003400,0xb4003400b4003400,0xb4003400b4003400,0x359fa920346d330b,0xa920b59f330bb46d,0x2920359fb30b346d,0x359fa920346d330b,0x31feb4cc34cc31fe,0xb1fe34ccb4ccb1fe,0x34cc31feb1fe34cc,0xb4ccb1fe31feb4cc,0xaf8fb555351b30de,0x3555af8fb0de351b,0x3555af8fb0de351b,0x2f8f3555b51bb0de
.quad 0xb559af5c35592f5c,0xb559af5c35592f5c,0x2f5cb559af5c3559,0x2f5cb559af5c3559,0xb4c5321535862ce4,0x321534c52ce4b586,0xb215b4c5ace43586,0xb4c5321535862ce4,0xa8b635a035a028b6,0x28b6b5a0b5a0a8b6,0xb5a0a8b6a8b635a0,0x35a028b628b6b5a0,0x340933ed35a89aaa,0xb3ed34091aaa35a8,0xb3ed34091aaa35a8,0xb409b3edb5a81aaa
.quad 0x3400340034003400,0x3400340034003400,0xb4003400b4003400,0xb4003400b4003400,0xb59f2920b46db30b,0x2920359fb30b346d,0xa920b59f330bb46d,0xb59f2920b46db30b,0x31feb4cc34cc31fe,0xb1fe34ccb4ccb1fe,0x34cc31feb1fe34cc,0xb4ccb1fe31feb4cc,0x2f8f3555b51bb0de,0xb5552f8f30deb51b,0xb5552f8f30deb51b,0xaf8fb555351b30de
.quad 0xb559af5c35592f5c,0xb559af5c35592f5c,0x2f5cb559af5c3559,0x2f5cb559af5c3559,0x34c5b215b586ace4,0xb215b4c5ace43586,0x321534c52ce4b586,0x34c5b215b586ace4,0xa8b635a035a028b6,0x28b6b5a0b5a0a8b6,0xb5a0a8b6a8b635a0,0x35a028b628b6b5a0,0xb409b3edb5a81aaa,0x33edb4099aaab5a8,0x33edb4099aaab5a8,0x340933ed35a89aaa
.quad 0,0,0,0,0,0,0,0,0,0,0,0,0,0,0,0
.quad 0,0,0,0,0,0,0,0,0,0,0,0,0,0,0,0
.quad 0,0,0,0,0,0,0,0,0,0,0,0,0,0,0,0
.quad 0,0,0,0,0,0,0,0,0,0,0,0,0,0,0,0
.quad 0x3400340034003400,0x3400340034003400,0xb4003400b4003400,0xb4003400b4003400,0x359ea94434703304,0xa944b59e3304b470,0x2944359eb3043470,0x359ea94434703304,0x31efb4d134d131ef,0xb1ef34d1b4d1b1ef,0x34d131efb1ef34d1,0xb4d1b1ef31efb4d1,0xafc1b550352130c6,0x3550afc1b0c63521,0x3550afc1b0c63521,0x2fc13550b521b0c6
.quad 0xb55faf19355f2f19,0xb55faf19355f2f19,0x2f19b55faf19355f,0x2f19b55faf19355f,0xb4b9323a358b2c8d,0x323a34b92c8db58b,0xb23ab4b9ac8d358b,0xb4b9323a358b2c8d,0xa7c435a335a327c4,0x27c4b5a3b5a3a7c4,0xb5a3a7c4a7c435a3,0x35a327c427c4b5a3,0x341f33c035a7a18d,0xb3c0341f218d35a7,0xb3c0341f218d35a7,0xb41fb3c0b5a7218d
.quad 0x3400340034003400,0x3400340034003400,0xb4003400b4003400,0xb4003400b4003400,0xb59e2944b470b304,0x2944359eb3043470,0xa944b59e3304b470,0xb59e2944b470b304,0x31efb4d134d131ef,0xb1ef34d1b4d1b1ef,0x34d131efb1ef34d1,0xb4d1b1ef31efb4d1,0x2fc13550b521b0c6,0xb5502fc130c6b521,0xb5502fc130c6b521,0xafc1b550352130c6
.quad 0xb55faf19355f2f19,0xb55faf19355f2f19,0x2f19b55faf19355f,0x2f19b55faf19355f,0x34b9b23ab58bac8d,0xb23ab4b9ac8d358b,0x323a34b92c8db58b,0x34b9b23ab58bac8d,0xa7c435a335a327c4,0x27c4b5a3b5a3a7c4,0xb5a3a7c4a7c435a3,0x35a327c427c4b5a3,0xb41fb3c0b5a7218d,0x33c0b41fa18db5a7,0x33c0b41fa18db5a7,0x341f33c035a7a18d
.quad 0,0,0,0,0,0,0,0,0,0,0,0,0,0,0,0
.quad 0,0,0,0,0,0,0,0,0,0,0,0,0,0,0,0
.quad 0,0,0,0,0,0,0,0,0,0,0,0,0,0,0,0
.quad 0,0,0,0,0,0,0,0,0,0,0,0,0,0,0,0
.quad 0x3400340034003400,0x3400340034003400,0xb4003400b4003400,0xb4003400b4003400,0x359ea967347332fd,0xa967b59e32fdb473,0x2967359eb2fd3473,0x359ea967347332fd,0x31e0b4d634d631e0,0xb1e034d6b4d6b1e0,0x34d631e0b1e034d6,0xb4d6b1e031e0b4d6,0xaff3b54c352630ae,0x354caff3b0ae3526,0x354caff3b0ae3526,0x2ff3354cb526b0ae
.quad 0xb565aed535652ed5,0xb565aed535652ed5,0x2ed5b565aed53565,0x2ed5b565aed53565,0xb4ad325f358f2c36,0x325f34ad2c36b58f,0xb25fb4adac36358f,0xb4ad325f358f2c36,0xa61b35a535a5261b,0x261bb5a5b5a5a61b,0xb5a5a61ba61b35a5,0x35a5261b261bb5a5,0x3434339235a6a4b8,0xb392343424b835a6,0xb392343424b835a6,0xb434b392b5a624b8
.quad 0x3400340034003400,0x3400340034003400,0xb4003400b4003400,0xb4003400b4003400,0xb59e2967b473b2fd,0x2967359eb2fd3473,0xa967b59e32fdb473,0xb59e2967b473b2fd,0x31e0b4d634d631e0,0xb1e034d6b4d6b1e0,0x34d631e0b1e034d6,0xb4d6b1e031e0b4d6,0x2ff3354cb526b0ae,0xb54c2ff330aeb526,0xb54c2ff330aeb526,0xaff3b54c352630ae
.quad 0xb565aed535652ed5,0xb565aed535652ed5,0x2ed5b565aed53565,0x2ed5b565aed53565,0x34adb25fb58fac36,0xb25fb4adac36358f,0x325f34ad2c36b58f,0x34adb25fb58fac36,0xa61b35a535a5261b,0x261bb5a5b5a5a61b,0xb5a5a61ba61b35a5,0x35a5261b261bb5a5,0xb434b392b5a624b8,0x3392b434a4b8b5a6,0x3392b434a4b8b5a6,0x3434339235a6a4b8
.quad 0,0,0,0,0,0,0,0,0,0,0,0,0,0,0,0
.quad 0,0,0,0,0,0,0,0,0,0,0,0,0,0,0,0
.quad 0,0,0,0,0,0,0,0,0,0,0,0,0,0,0,0
.quad 0,0,0,0,0,0,0,0,0,0,0,0,0,0,0,0
.quad 0x3400340034003400,0x3400340034003400,0xb4003400b4003400,0xb4003400b4003400,0x359da98a347632f6,0xa98ab59d32f6b476,0x298a359db2f63476,0x359da98a347632f6,0x31d1b4da34da31d1,0xb1d134dab4dab1d1,0x34da31d1b1d134da,0xb4dab1d131d1b4da,0xb012b547352c3096,0x3547b012b096352c,0x3547b012b096352c,0x30123547b52cb096
.quad 0xb56aae92356a2e92,0xb56aae92356a2e92,0x2e92b56aae92356a,0x2e92b56aae92356a,0xb4a0328435932bbd,0x328434a02bbdb593,0xb284b4a0abbd3593,0xb4a0328435932bbd,0xa47135a635a62471,0x2471b5a6b5a6a471,0xb5a6a471a47135a6,0x35a624712471b5a6,0x3449336435a4a6a9,0xb364344926a935a4,0xb364344926a935a4,0xb449b364b5a426a9
.quad 0x3400340034003400,0x3400340034003400,0xb4003400b4003400,0xb4003400b4003400,0xb59d298ab476b2f6,0x298a359db2f63476,0xa98ab59d32f6b476,0xb59d298ab476b2f6,0x31d1b4da34da31d1,0xb1d134dab4dab1d1,0x34da31d1b1d134da,0xb4dab1d131d1b4da,0x30123547b52cb096,0xb54730123096b52c,0xb54730123096b52c,0xb012b547352c3096
.quad 0xb56aae92356a2e92,0xb56aae92356a2e92,0x2e92b56aae92356a,0x2e92b56aae92356a,0x34a0b284b593abbd,0xb284b4a0abbd3593,0x328434a02bbdb593,0x34a0b284b593abbd,0xa47135a635a62471,0x2471b5a6b5a6a471,0xb5a6a471a47135a6,0x35a624712471b5a6,0xb449b364b5a426a9,0x3364b449a6a9b5a4,0x3364b449a6a9b5a4,0x3449336435a4a6a9
.quad 0,0,0,0,0,0,0,0,0,0,0,0,0,0,0,0
.quad 0,0,0,0,0,0,0,0,0,0,0,0,0,0,0,0
.quad 0,0,0,0,0,0,0,0,0,0,0,0,0,0,0,0
.quad 0,0,0,0,0,0,0,0,0,0,0,0,0,0,0,0
.quad 0x3400340034003400,0x3400340034003400,0xb4003400b4003400,0xb4003400b4003400,0x359da9ad347832ef,0xa9adb59d32efb478,0x29ad359db2ef3478,0x359da9ad347832ef,0x31c2b4df34df31c2,0xb1c234dfb4dfb1c2,0x34df31c2b1c234df,0xb4dfb1c231c2b4df,0xb02bb5423531307d,0x3542b02bb07d3531,0x3542b02bb07d3531,0x302b3542b531b07d
.quad 0xb56fae4d356f2e4d,0xb56fae4d356f2e4d,0x2e4db56fae4d356f,0x2e4db56fae4d356f,0xb49332a835962b0d,0x32a834932b0db596,0xb2a8b493ab0d3596,0xb49332a835962b0d,0xa18d35a735a7218d,0x218db5a7b5a7a18d,0xb5a7a18da18d35a7,0x35a7218d218db5a7,0x345d333435a2a84c,0xb334345d284c35a2,0xb334345d284c35a2,0xb45db334b5a2284c
.quad 0x3400340034003400,0x3400340034003400,0xb4003400b4003400,0xb4003400b4003400,0xb59d29adb478b2ef,0x29ad359db2ef3478,0xa9adb59d32efb478,0xb59d29adb478b2ef,0x31c2b4df34df31c2,0xb1c234dfb4dfb1c2,0x34df31c2b1c234df,0xb4dfb1c231c2b4df,0x302b3542b531b07d,0xb542302b307db531,0xb542302b307db531,0xb02bb5423531307d
.quad 0xb56fae4d356f2e4d,0xb56fae4d356f2e4d,0x2e4db56fae4d356f,0x2e4db56fae4d356f,0x3493b2a8b596ab0d,0xb2a8b493ab0d3596,0x32a834932b0db596,0x3493b2a8b596ab0d,0xa18d35a735a7218d,0x218db5a7b5a7a18d,0xb5a7a18da18d35a7,0x35a7218d218db5a7,0xb45db334b5a2284c,0x3334b45da84cb5a2,0x3334b45da84cb5a2,0x345d333435a2a84c
.quad 0,0,0,0,0,0,0,0,0,0,0,0,0,0,0,0
.quad 0,0,0,0,0,0,0,0,0,0,0,0,0,0,0,0
.quad 0,0,0,0,0,0,0,0,0,0,0,0,0,0,0,0
.quad 0,0,0,0,0,0,0,0,0,0,0,0,0,0,0,0
.quad 0x3400340034003400,0x3400340034003400,0xb4003400b4003400,0xb4003400b4003400,0x359ca9d1347b32e8,0xa9d1b59c32e8b47b,0x29d1359cb2e8347b,0x359ca9d1347b32e8,0x31b2b4e334e331b2,0xb1b234e3b4e3b1b2,0x34e331b2b1b234e3,0xb4e3b1b231b2b4e3,0xb044b53d35363065,0x353db044b0653536,0x353db044b0653536,0x3044353db536b065
.quad 0xb574ae0935742e09,0xb574ae0935742e09,0x2e09b574ae093574,0x2e09b574ae093574,0xb48632cc359a2a5e,0x32cc34862a5eb59a,0xb2ccb486aa5e359a,0xb48632cc359a2a5e,0x9c7135a835a81c71,0x1c71b5a8b5a89c71,0xb5a89c719c7135a8,0x35a81c711c71b5a8,0x34703304359ea944,0xb30434702944359e,0xb30434702944359e,0xb470b304b59e2944
.quad 0x3400340034003400,0x3400340034003400,0xb4003400b4003400,0xb4003400b4003400,0xb59c29d1b47bb2e8,0x29d1359cb2e8347b,0xa9d1b59c32e8b47b,0xb59c29d1b47bb2e8,0x31b2b4e334e331b2,0xb1b234e3b4e3b1b2,0x34e331b2b1b234e3,0xb4e3b1b231b2b4e3,0x3044353db536b065,0xb53d30443065b536,0xb53d30443065b536,0xb044b53d35363065
.quad 0xb574ae0935742e09,0xb574ae0935742e09,0x2e09b574ae093574,0x2e09b574ae093574,0x3486b2ccb59aaa5e,0xb2ccb486aa5e359a,0x32cc34862a5eb59a,0x3486b2ccb59aaa5e,0x9c7135a835a81c71,0x1c71b5a8b5a89c71,0xb5a89c719c7135a8,0x35a81c711c71b5a8,0xb470b304b59e2944,0x3304b470a944b59e,0x3304b470a944b59e,0x34703304359ea944
.quad 0,0,0,0,0,0,0,0,0,0,0,0,0,0,0,0
.quad 0,0,0,0,0,0,0,0,0,0,0,0,0,0,0,0
.quad 0,0,0,0,0,0,0,0,0,0,0,0,0,0,0,0
.quad 0,0,0,0,0,0,0,0,0,0,0,0,0,0,0,0
.quad 0x3400340034003400,0x3400340034003400,0xb4003400b4003400,0xb4003400b4003400,0x359ca9f4347e32e1,0xa9f4b59c32e1b47e,0x29f4359cb2e1347e,0x359ca9f4347e32e1,0x31a3b4e834e831a3,0xb1a334e8b4e8b1a3,0x34e831a3b1a334e8,0xb4e8b1a331a3b4e8,0xb05db538353c304c,0x3538b05db04c353c,0x3538b05db04c353c,0x305d3538b53cb04c
.quad 0xb578adc435782dc4,0xb578adc435782dc4,0x2dc4b578adc43578,0x2dc4b578adc43578,0xb47832ef359d29ad,0x32ef347829adb59d,0xb2efb478a9ad359d,0xb47832ef359d29ad,0x187135a835a89871,0x9871b5a8b5a81871,0xb5a81871187135a8,0x35a898719871b5a8,0x348332d3359aaa3a,0xb2d334832a3a359a,0xb2d334832a3a359a,0xb483b2d3b59a2a3a
.quad 0x3400340034003400,0x3400340034003400,0xb4003400b4003400,0xb4003400b4003400,0xb59c29f4b47eb2e1,0x29f4359cb2e1347e,0xa9f4b59c32e1b47e,0xb59c29f4b47eb2e1,0x31a3b4e834e831a3,0xb1a334e8b4e8b1a3,0x34e831a3b1a334e8,0xb4e8b1a331a3b4e8,0x305d3538b53cb04c,0xb538305d304cb53c,0xb538305d304cb53c,0xb05db538353c304c
.quad 0xb578adc435782dc4,0xb578adc435782dc4,0x2dc4b578adc43578,0x2dc4b578adc43578,0x3478b2efb59da9ad,0xb2efb478a9ad359d,0x32ef347829adb59d,0x3478b2efb59da9ad,0x187135a835a89871,0x9871b5a8b5a81871,0xb5a81871187135a8,0x35a898719871b5a8,0xb483b2d3b59a2a3a,0x32d3b483aa3ab59a,0x32d3b483aa3ab59a,0x348332d3359aaa3a
.quad 0,0,0,0,0,0,0,0,0,0,0,0,0,0,0,0
.quad 0,0,0,0,0,0,0,0,0,0,0,0,0,0,0,0
.quad 0,0,0,0,0,0,0,0,0,0,0,0,0,0,0,0
.quad 0,0,0,0,0,0,0,0,0,0,0,0,0,0,0,0
.quad 0x3400340034003400,0x3400340034003400,0xb4003400b4003400,0xb4003400b4003400,0x359baa17348032da,0xaa17b59b32dab480,0x2a17359bb2da3480,0x359baa17348032da,0x3194b4ec34ec3194,0xb19434ecb4ecb194,0x34ec3194b19434ec,0xb4ecb1943194b4ec,0xb075b53335413033,0x3533b075b0333541,0x3533b075b0333541,0x30753533b541b033
.quad 0xb57dad7f357d2d7f,0xb57dad7f357d2d7f,0x2d7fb57dad7f357d,0x2d7fb57dad7f357d,0xb46b3312359f28fd,0x3312346b28fdb59f,0xb312b46ba8fd359f,0xb46b3312359f28fd,0x207135a835a8a071,0xa071b5a8b5a82071,0xb5a82071207135a8,0x35a8a071a071b5a8,0x349632a13596ab30,0xb2a134962b303596,0xb2a134962b303596,0xb496b2a1b5962b30
.quad 0x3400340034003400,0x3400340034003400,0xb4003400b4003400,0xb4003400b4003400,0xb59b2a17b480b2da,0x2a17359bb2da3480,0xaa17b59b32dab480,0xb59b2a17b480b2da,0x3194b4ec34ec3194,0xb19434ecb4ecb194,0x34ec3194b19434ec,0xb4ecb1943194b4ec,0x30753533b541b033,0xb53330753033b541,0xb53330753033b541,0xb075b53335413033
.quad 0xb57dad7f357d2d7f,0xb57dad7f357d2d7f,0x2d7fb57dad7f357d,0x2d7fb57dad7f357d,0x346bb312b59fa8fd,0xb312b46ba8fd359f,0x3312346b28fdb59f,0x346bb312b59fa8fd,0x207135a835a8a071,0xa071b5a8b5a82071,0xb5a82071207135a8,0x35a8a071a071b5a8,0xb496b2a1b5962b30,0x32a1b496ab30b596,0x32a1b496ab30b596,0x349632a13596ab30
.quad 0,0,0,0,0,0,0,0,0,0,0,0,0,0,0,0
.quad 0,0,0,0,0,0,0,0,0,0,0,0,0,0,0,0
.quad 0,0,0,0,0,0,0,0,0,0,0,0,0,0,0,0
.quad 0,0,0,0,0,0,0,0,0,0,0,0,0,0,0,0
.quad 0x3400340034003400,0x3400340034003400,0xb4003400b4003400,0xb4003400b4003400,0x359aaa3a348332d3,0xaa3ab59a32d3b483,0x2a3a359ab2d33483,0x359aaa3a348332d3,0x3184b4f034f03184,0xb18434f0b4f0b184,0x34f03184b18434f0,0xb4f0b1843184b4f0,0xb08eb52e3546301b,0x352eb08eb01b3546,0x352eb08eb01b3546,0x308e352eb546b01b
.quad 0xb581ad3a35812d3a,0xb581ad3a35812d3a,0x2d3ab581ad3a3581,0x2d3ab581ad3a3581,0xb45d333435a2284c,0x3334345d284cb5a2,0xb334b45da84c35a2,0xb45d333435a2284c,0x23c635a735a7a3c6,0xa3c6b5a7b5a723c6,0xb5a723c623c635a7,0x35a7a3c6a3c6b5a7,0x34a8326e3590ac13,0xb26e34a82c133590,0xb26e34a82c133590,0xb4a8b26eb5902c13
.quad 0x3400340034003400,0x3400340034003400,0xb4003400b4003400,0xb4003400b4003400,0xb59a2a3ab483b2d3,0x2a3a359ab2d33483,0xaa3ab59a32d3b483,0xb59a2a3ab483b2d3,0x3184b4f034f03184,0xb18434f0b4f0b184,0x34f03184b18434f0,0xb4f0b1843184b4f0,0x308e352eb546b01b,0xb52e308e301bb546,0xb52e308e301bb546,0xb08eb52e3546301b
.quad 0xb581ad3a35812d3a,0xb581ad3a35812d3a,0x2d3ab581ad3a3581,0x2d3ab581ad3a3581,0x345db334b5a2a84c,0xb334b45da84c35a2,0x3334345d284cb5a2,0x345db334b5a2a84c,0x23c635a735a7a3c6,0xa3c6b5a7b5a723c6,0xb5a723c623c635a7,0x35a7a3c6a3c6b5a7,0xb4a8b26eb5902c13,0x326eb4a8ac13b590,0x326eb4a8ac13b590,0x34a8326e3590ac13
.quad 0,0,0,0,0,0,0,0,0,0,0,0,0,0,0,0
.quad 0,0,0,0,0,0,0,0,0,0,0,0,0,0,0,0
.quad 0,0,0,0,0,0,0,0,0,0,0,0,0,0,0,0
.quad 0,0,0,0,0,0,0,0,0,0,0,0,0,0,0,0
.quad 0x3400340034003400,0x3400340034003400,0xb4003400b4003400,0xb4003400b4003400,0x359aaa5e348632cc,0xaa5eb59a32ccb486,0x2a5e359ab2cc3486,0x359aaa5e348632cc,0x3175b4f534f53175,0xb17534f5b4f5b175,0x34f53175b17534f5,0xb4f5b1753175b4f5,0xb0a6b528354a3002,0x3528b0a6b002354a,0x3528b0a6b002354a,0x30a63528b54ab002
.quad 0xb585acf535852cf5,0xb585acf535852cf5,0x2cf5b585acf53585,0x2cf5b585acf53585,0xb44e335635a42736,0x3356344e2736b5a4,0xb356b44ea73635a4,0xb44e335635a42736,0x258d35a535a5a58d,0xa58db5a5b5a5258d,0xb5a5258d258d35a5,0x35a5a58da58db5a5,0x34b9323a358bac8d,0xb23a34b92c8d358b,0xb23a34b92c8d358b,0xb4b9b23ab58b2c8d
.quad 0x3400340034003400,0x3400340034003400,0xb4003400b4003400,0xb4003400b4003400,0xb59a2a5eb486b2cc,0x2a5e359ab2cc3486,0xaa5eb59a32ccb486,0xb59a2a5eb486b2cc,0x3175b4f534f53175,0xb17534f5b4f5b175,0x34f53175b17534f5,0xb4f5b1753175b4f5,0x30a63528b54ab002,0xb52830a63002b54a,0xb52830a63002b54a,0xb0a6b528354a3002
.quad 0xb585acf535852cf5,0xb585acf535852cf5,0x2cf5b585acf53585,0x2cf5b585acf53585,0x344eb356b5a4a736,0xb356b44ea73635a4,0x3356344e2736b5a4,0x344eb356b5a4a736,0x258d35a535a5a58d,0xa58db5a5b5a5258d,0xb5a5258d258d35a5,0x35a5a58da58db5a5,0xb4b9b23ab58b2c8d,0x323ab4b9ac8db58b,0x323ab4b9ac8db58b,0x34b9323a358bac8d
.quad 0,0,0,0,0,0,0,0,0,0,0,0,0,0,0,0
.quad 0,0,0,0,0,0,0,0,0,0,0,0,0,0,0,0
.quad 0,0,0,0,0,0,0,0,0,0,0,0,0,0,0,0
.quad 0,0,0,0,0,0,0,0,0,0,0,0,0,0,0,0
.quad 0x3400340034003400,0x3400340034003400,0xb4003400b4003400,0xb4003400b4003400,0x3599aa81348932c4,0xaa81b59932c4b489,0x2a813599b2c43489,0x3599aa81348932c4,0x3165b4f934f93165,0xb16534f9b4f9b165,0x34f93165b16534f9,0xb4f9b1653165b4f9,0xb0beb523354f2fd2,0x3523b0beafd2354f,0x3523b0beafd2354f,0x30be3523b54fafd2
.quad 0xb589acb035892cb0,0xb589acb035892cb0,0x2cb0b589acb03589,0x2cb0b589acb03589,0xb440337835a525d4,0x3378344025d4b5a5,0xb378b440a5d435a5,0xb440337835a525d4,0x273635a435a4a736,0xa736b5a4b5a42736,0xb5a42736273635a4,0x35a4a736a736b5a4,0x34ca32063584ad07,0xb20634ca2d073584,0xb20634ca2d073584,0xb4cab206b5842d07
.quad 0x3400340034003400,0x3400340034003400,0xb4003400b4003400,0xb4003400b4003400,0xb5992a81b489b2c4,0x2a813599b2c43489,0xaa81b59932c4b489,0xb5992a81b489b2c4,0x3165b4f934f93165,0xb16534f9b4f9b165,0x34f93165b16534f9,0xb4f9b1653165b4f9,0x30be3523b54fafd2,0xb52330be2fd2b54f,0xb52330be2fd2b54f,0xb0beb523354f2fd2
.quad 0xb589acb035892cb0,0xb589acb035892cb0,0x2cb0b589acb03589,0x2cb0b589acb03589,0x3440b378b5a5a5d4,0xb378b440a5d435a5,0x3378344025d4b5a5,0x3440b378b5a5a5d4,0x273635a435a4a736,0xa736b5a4b5a42736,0xb5a42736273635a4,0x35a4a736a736b5a4,0xb4cab206b5842d07,0x3206b4caad07b584,0x3206b4caad07b584,0x34ca32063584ad07
.quad 0,0,0,0,0,0,0,0,0,0,0,0,0,0,0,0
.quad 0,0,0,0,0,0,0,0,0,0,0,0,0,0,0,0
.quad 0,0,0,0,0,0,0,0,0,0,0,0,0,0,0,0
.quad 0,0,0,0,0,0,0,0,0,0,0,0,0,0,0,0
.quad 0x3400340034003400,0x3400340034003400,0xb4003400b4003400,0xb4003400b4003400,0x3598aaa4348b32bd,0xaaa4b59832bdb48b,0x2aa43598b2bd348b,0x3598aaa4348b32bd,0x3155b4fd34fd3155,0xb15534fdb4fdb155,0x34fd3155b15534fd,0xb4fdb1553155b4fd,0xb0d6b51d35542f9f,0x351db0d6af9f3554,0x351db0d6af9f3554,0x30d6351db554af9f
.quad 0xb58cac6a358c2c6a,0xb58cac6a358c2c6a,0x2c6ab58cac6a358c,0x2c6ab58cac6a358c,0xb431339935a62471,0x339934312471b5a6,0xb399b431a47135a6,0xb431339935a62471,0x287035a135a1a870,0xa870b5a1b5a12870,0xb5a12870287035a1,0x35a1a870a870b5a1,0x34da31d1357dad7f,0xb1d134da2d7f357d,0xb1d134da2d7f357d,0xb4dab1d1b57d2d7f
.quad 0x3400340034003400,0x3400340034003400,0xb4003400b4003400,0xb4003400b4003400,0xb5982aa4b48bb2bd,0x2aa43598b2bd348b,0xaaa4b59832bdb48b,0xb5982aa4b48bb2bd,0x3155b4fd34fd3155,0xb15534fdb4fdb155,0x34fd3155b15534fd,0xb4fdb1553155b4fd,0x30d6351db554af9f,0xb51d30d62f9fb554,0xb51d30d62f9fb554,0xb0d6b51d35542f9f
.quad 0xb58cac6a358c2c6a,0xb58cac6a358c2c6a,0x2c6ab58cac6a358c,0x2c6ab58cac6a358c,0x3431b399b5a6a471,0xb399b431a47135a6,0x339934312471b5a6,0x3431b399b5a6a471,0x287035a135a1a870,0xa870b5a1b5a12870,0xb5a12870287035a1,0x35a1a870a870b5a1,0xb4dab1d1b57d2d7f,0x31d1b4daad7fb57d,0x31d1b4daad7fb57d,0x34da31d1357dad7f
.quad 0,0,0,0,0,0,0,0,0,0,0,0,0,0,0,0
.quad 0,0,0,0,0,0,0,0,0,0,0,0,0,0,0,0
.quad 0,0,0,0,0,0,0,0,0,0,0,0,0,0,0,0
.quad 0,0,0,0,0,0,0,0,0,0,0,0,0,0,0,0
.quad 0x3400340034003400,0x3400340034003400,0xb4003400b4003400,0xb4003400b4003400,0x3598aac7348e32b6,0xaac7b59832b6b48e,0x2ac73598b2b6348e,0x3598aac7348e32b6,0x3146b50135013146,0xb1463501b501b146,0x35013146b1463501,0xb501b1463146b501,0xb0eeb51735582f6d,0x3517b0eeaf6d3558,0x3517b0eeaf6d3558,0x30ee3517b558af6d
.quad 0xb590ac2435902c24,0xb590ac2435902c24,0x2c24b590ac243590,0x2c24b590ac243590,0xb42233ba35a7221c,0x33ba3422221cb5a7,0xb3bab422a21c35a7,0xb42233ba35a7221c,0x2944359e359ea944,0xa944b59eb59e2944,0xb59e29442944359e,0x359ea944a944b59e,0x34ea319b3575adf8,0xb19b34ea2df83575,0xb19b34ea2df83575,0xb4eab19bb5752df8
.quad 0x3400340034003400,0x3400340034003400,0xb4003400b4003400,0xb4003400b4003400,0xb5982ac7b48eb2b6,0x2ac73598b2b6348e,0xaac7b59832b6b48e,0xb5982ac7b48eb2b6,0x3146b50135013146,0xb1463501b501b146,0x35013146b1463501,0xb501b1463146b501,0x30ee3517b558af6d,0xb51730ee2f6db558,0xb51730ee2f6db558,0xb0eeb51735582f6d
.quad 0xb590ac2435902c24,0xb590ac2435902c24,0x2c24b590ac243590,0x2c24b590ac243590,0x3422b3bab5a7a21c,0xb3bab422a21c35a7,0x33ba3422221cb5a7,0x3422b3bab5a7a21c,0x2944359e359ea944,0xa944b59eb59e2944,0xb59e29442944359e,0x359ea944a944b59e,0xb4eab19bb5752df8,0x319bb4eaadf8b575,0x319bb4eaadf8b575,0x34ea319b3575adf8
.quad 0,0,0,0,0,0,0,0,0,0,0,0,0,0,0,0
.quad 0,0,0,0,0,0,0,0,0,0,0,0,0,0,0,0
.quad 0,0,0,0,0,0,0,0,0,0,0,0,0,0,0,0
.quad 0,0,0,0,0,0,0,0,0,0,0,0,0,0,0,0
.quad 0x3400340034003400,0x3400340034003400,0xb4003400b4003400,0xb4003400b4003400,0x3597aaea349032af,0xaaeab59732afb490,0x2aea3597b2af3490,0x3597aaea349032af,0x3136b50535053136,0xb1363505b505b136,0x35053136b1363505,0xb505b1363136b505,0xb106b511355c2f3b,0x3511b106af3b355c,0x3511b106af3b355c,0x31063511b55caf3b
.quad 0xb593abbd35932bbd,0xb593abbd35932bbd,0x2bbdb593abbd3593,0x2bbdb593abbd3593,0xb41333da35a81eaa,0x33da34131eaab5a8,0xb3dab4139eaa35a8,0xb41333da35a81eaa,0x2a17359b359baa17,0xaa17b59bb59b2a17,0xb59b2a172a17359b,0x359baa17aa17b59b,0x34f93165356cae6f,0xb16534f92e6f356c,0xb16534f92e6f356c,0xb4f9b165b56c2e6f
.quad 0x3400340034003400,0x3400340034003400,0xb4003400b4003400,0xb4003400b4003400,0xb5972aeab490b2af,0x2aea3597b2af3490,0xaaeab59732afb490,0xb5972aeab490b2af,0x3136b50535053136,0xb1363505b505b136,0x35053136b1363505,0xb505b1363136b505,0x31063511b55caf3b,0xb51131062f3bb55c,0xb51131062f3bb55c,0xb106b511355c2f3b
.quad 0xb593abbd35932bbd,0xb593abbd35932bbd,0x2bbdb593abbd3593,0x2bbdb593abbd3593,0x3413b3dab5a89eaa,0xb3dab4139eaa35a8,0x33da34131eaab5a8,0x3413b3dab5a89eaa,0x2a17359b359baa17,0xaa17b59bb59b2a17,0xb59b2a172a17359b,0x359baa17aa17b59b,0xb4f9b165b56c2e6f,0x3165b4f9ae6fb56c,0x3165b4f9ae6fb56c,0x34f93165356cae6f
.quad 0,0,0,0,0,0,0,0,0,0,0,0,0,0,0,0
.quad 0,0,0,0,0,0,0,0,0,0,0,0,0,0,0,0
.quad 0,0,0,0,0,0,0,0,0,0,0,0,0,0,0,0
.quad 0,0,0,0,0,0,0,0,0,0,0,0,0,0,0,0
.quad 0x3400340034003400,0x3400340034003400,0xb4003400b4003400,0xb4003400b4003400,0x3596ab0d349332a8,0xab0db59632a8b493,0x2b0d3596b2a83493,0x3596ab0d349332a8,0x3126b50a350a3126,0xb126350ab50ab126,0x350a3126b126350a,0xb50ab1263126b50a,0xb11eb50c35602f08,0x350cb11eaf083560,0x350cb11eaf083560,0x311e350cb560af08
.quad 0xb596ab3035962b30,0xb596ab3035962b30,0x2b30b596ab303596,0x2b30b596ab303596,0xb40333fa35a81471,0x33fa34031471b5a8,0xb3fab403947135a8,0xb40333fa35a81471,0x2aea35973597aaea,0xaaeab597b5972aea,0xb5972aea2aea3597,0x3597aaeaaaeab597,0x3507312e3563aee6,0xb12e35072ee63563,0xb12e35072ee63563,0xb507b12eb5632ee6
.quad 0x3400340034003400,0x3400340034003400,0xb4003400b4003400,0xb4003400b4003400,0xb5962b0db493b2a8,0x2b0d3596b2a83493,0xab0db59632a8b493,0xb5962b0db493b2a8,0x3126b50a350a3126,0xb126350ab50ab126,0x350a3126b126350a,0xb50ab1263126b50a,0x311e350cb560af08,0xb50c311e2f08b560,0xb50c311e2f08b560,0xb11eb50c35602f08
.quad 0xb596ab3035962b30,0xb596ab3035962b30,0x2b30b596ab303596,0x2b30b596ab303596,0x3403b3fab5a89471,0xb3fab403947135a8,0x33fa34031471b5a8,0x3403b3fab5a89471,0x2aea35973597aaea,0xaaeab597b5972aea,0xb5972aea2aea3597,0x3597aaeaaaeab597,0xb507b12eb5632ee6,0x312eb507aee6b563,0x312eb507aee6b563,0x3507312e3563aee6
.quad 0,0,0,0,0,0,0,0,0,0,0,0,0,0,0,0
.quad 0,0,0,0,0,0,0,0,0,0,0,0,0,0,0,0
.quad 0,0,0,0,0,0,0,0,0,0,0,0,0,0,0,0
.quad 0,0,0,0,0,0,0,0,0,0,0,0,0,0,0,0
.quad 0x3400340034003400,0x3400340034003400,0xb4003400b4003400,0xb4003400b4003400,0x3596ab30349632a1,0xab30b59632a1b496,0x2b303596b2a13496,0x3596ab30349632a1,0x3116b50e350e3116,0xb116350eb50eb116,0x350e3116b116350e,0xb50eb1163116b50e,0xb136b50535652ed5,0x3505b136aed53565,0x3505b136aed53565,0x31363505b565aed5
.quad 0xb598aaa435982aa4,0xb598aaa435982aa4,0x2aa4b598aaa43598,0x2aa4b598aaa43598,0xb3e7340c35a89c71,0x340c33e79c71b5a8,0xb40cb3e71c7135a8,0xb3e7340c35a89c71,0x2bbd35933593abbd,0xabbdb593b5932bbd,0xb5932bbd2bbd3593,0x3593abbdabbdb593,0x351530f63559af5c,0xb0f635152f5c3559,0xb0f635152f5c3559,0xb515b0f6b5592f5c
.quad 0x3400340034003400,0x3400340034003400,0xb4003400b4003400,0xb4003400b4003400,0xb5962b30b496b2a1,0x2b303596b2a13496,0xab30b59632a1b496,0xb5962b30b496b2a1,0x3116b50e350e3116,0xb116350eb50eb116,0x350e3116b116350e,0xb50eb1163116b50e,0x31363505b565aed5,0xb50531362ed5b565,0xb50531362ed5b565,0xb136b50535652ed5
.quad 0xb598aaa435982aa4,0xb598aaa435982aa4,0x2aa4b598aaa43598,0x2aa4b598aaa43598,0x33e7b40cb5a81c71,0xb40cb3e71c7135a8,0x340c33e79c71b5a8,0x33e7b40cb5a81c71,0x2bbd35933593abbd,0xabbdb593b5932bbd,0xb5932bbd2bbd3593,0x3593abbdabbdb593,0xb515b0f6b5592f5c,0x30f6b515af5cb559,0x30f6b515af5cb559,0x351530f63559af5c
.quad 0,0,0,0,0,0,0,0,0,0,0,0,0,0,0,0
.quad 0,0,0,0,0,0,0,0,0,0,0,0,0,0,0,0
.quad 0,0,0,0,0,0,0,0,0,0,0,0,0,0,0,0
.quad 0,0,0,0,0,0,0,0,0,0,0,0,0,0,0,0
.quad 0x3400340034003400,0x3400340034003400,0xb4003400b4003400,0xb4003400b4003400,0x3595ab5334983299,0xab53b5953299b498,0x2b533595b2993498,0x3595ab5334983299,0x3106b51135113106,0xb1063511b511b106,0x35113106b1063511,0xb511b1063106b511,0xb14db4ff35692ea3,0x34ffb14daea33569,0x34ffb14daea33569,0x314d34ffb569aea3
.quad 0xb59baa17359b2a17,0xb59baa17359b2a17,0x2a17b59baa17359b,0x2a17b59baa17359b,0xb3c7341c35a8a0ff,0x341c33c7a0ffb5a8,0xb41cb3c720ff35a8,0xb3c7341c35a8a0ff,0x2c47358e358eac47,0xac47b58eb58e2c47,0xb58e2c472c47358e,0x358eac47ac47b58e,0x352330be354fafd2,0xb0be35232fd2354f,0xb0be35232fd2354f,0xb523b0beb54f2fd2
.quad 0x3400340034003400,0x3400340034003400,0xb4003400b4003400,0xb4003400b4003400,0xb5952b53b498b299,0x2b533595b2993498,0xab53b5953299b498,0xb5952b53b498b299,0x3106b51135113106,0xb1063511b511b106,0x35113106b1063511,0xb511b1063106b511,0x314d34ffb569aea3,0xb4ff314d2ea3b569,0xb4ff314d2ea3b569,0xb14db4ff35692ea3
.quad 0xb59baa17359b2a17,0xb59baa17359b2a17,0x2a17b59baa17359b,0x2a17b59baa17359b,0x33c7b41cb5a820ff,0xb41cb3c720ff35a8,0x341c33c7a0ffb5a8,0x33c7b41cb5a820ff,0x2c47358e358eac47,0xac47b58eb58e2c47,0xb58e2c472c47358e,0x358eac47ac47b58e,0xb523b0beb54f2fd2,0x30beb523afd2b54f,0x30beb523afd2b54f,0x352330be354fafd2
.quad 0,0,0,0,0,0,0,0,0,0,0,0,0,0,0,0
.quad 0,0,0,0,0,0,0,0,0,0,0,0,0,0,0,0
.quad 0,0,0,0,0,0,0,0,0,0,0,0,0,0,0,0
.quad 0,0,0,0,0,0,0,0,0,0,0,0,0,0,0,0
.quad 0x3400340034003400,0x3400340034003400,0xb4003400b4003400,0xb4003400b4003400,0x3594ab77349b3292,0xab77b5943292b49b,0x2b773594b292349b,0x3594ab77349b3292,0x30f6b515351530f6,0xb0f63515b515b0f6,0x351530f6b0f63515,0xb515b0f630f6b515,0xb165b4f9356c2e6f,0x34f9b165ae6f356c,0x34f9b165ae6f356c,0x316534f9b56cae6f
.quad 0xb59da98a359d298a,0xb59da98a359d298a,0x298ab59da98a359d,0x298ab59da98a359d,0xb3a6342b35a7a3c6,0x342b33a6a3c6b5a7,0xb42bb3a623c635a7,0xb3a6342b35a7a3c6,0x2cb035893589acb0,0xacb0b589b5892cb0,0xb5892cb02cb03589,0x3589acb0acb0b589,0x352f30853544b023,0xb085352f30233544,0xb085352f30233544,0xb52fb085b5443023
.quad 0x3400340034003400,0x3400340034003400,0xb4003400b4003400,0xb4003400b4003400,0xb5942b77b49bb292,0x2b773594b292349b,0xab77b5943292b49b,0xb5942b77b49bb292,0x30f6b515351530f6,0xb0f63515b515b0f6,0x351530f6b0f63515,0xb515b0f630f6b515,0x316534f9b56cae6f,0xb4f931652e6fb56c,0xb4f931652e6fb56c,0xb165b4f9356c2e6f
.quad 0xb59da98a359d298a,0xb59da98a359d298a,0x298ab59da98a359d,0x298ab59da98a359d,0x33a6b42bb5a723c6,0xb42bb3a623c635a7,0x342b33a6a3c6b5a7,0x33a6b42bb5a723c6,0x2cb035893589acb0,0xacb0b589b5892cb0,0xb5892cb02cb03589,0x3589acb0acb0b589,0xb52fb085b5443023,0x3085b52fb023b544,0x3085b52fb023b544,0x352f30853544b023
.quad 0,0,0,0,0,0,0,0,0,0,0,0,0,0,0,0
.quad 0,0,0,0,0,0,0,0,0,0,0,0,0,0,0,0
.quad 0,0,0,0,0,0,0,0,0,0,0,0,0,0,0,0
.quad 0,0,0,0,0,0,0,0,0,0,0,0,0,0,0,0
.quad 0x3400340034003400,0x3400340034003400,0xb4003400b4003400,0xb4003400b4003400,0x3594ab9a349d328b,0xab9ab594328bb49d,0x2b9a3594b28b349d,0x3594ab9a349d328b,0x30e6b519351930e6,0xb0e63519b519b0e6,0x351930e6b0e63519,0xb519b0e630e6b519,0xb17cb4f335702e3c,0x34f3b17cae3c3570,0x34f3b17cae3c3570,0x317c34f3b570ae3c
.quad 0xb59fa8fd359f28fd,0xb59fa8fd359f28fd,0x28fdb59fa8fd359f,0x28fdb59fa8fd359f,0xb385343a35a6a546,0x343a3385a546b5a6,0xb43ab385254635a6,0xb385343a35a6a546,0x2d1835833583ad18,0xad18b583b5832d18,0xb5832d182d183583,0x3583ad18ad18b583,0x353c304c3538b05d,0xb04c353c305d3538,0xb04c353c305d3538,0xb53cb04cb538305d
.quad 0x3400340034003400,0x3400340034003400,0xb4003400b4003400,0xb4003400b4003400,0xb5942b9ab49db28b,0x2b9a3594b28b349d,0xab9ab594328bb49d,0xb5942b9ab49db28b,0x30e6b519351930e6,0xb0e63519b519b0e6,0x351930e6b0e63519,0xb519b0e630e6b519,0x317c34f3b570ae3c,0xb4f3317c2e3cb570,0xb4f3317c2e3cb570,0xb17cb4f335702e3c
.quad 0xb59fa8fd359f28fd,0xb59fa8fd359f28fd,0x28fdb59fa8fd359f,0x28fdb59fa8fd359f,0x3385b43ab5a62546,0xb43ab385254635a6,0x343a3385a546b5a6,0x3385b43ab5a62546,0x2d1835833583ad18,0xad18b583b5832d18,0xb5832d182d183583,0x3583ad18ad18b583,0xb53cb04cb538305d,0x304cb53cb05db538,0x304cb53cb05db538,0x353c304c3538b05d
.quad 0,0,0,0,0,0,0,0,0,0,0,0,0,0,0,0
.quad 0,0,0,0,0,0,0,0,0,0,0,0,0,0,0,0
.quad 0,0,0,0,0,0,0,0,0,0,0,0,0,0,0,0
.quad 0,0,0,0,0,0,0,0,0,0,0,0,0,0,0,0
.quad 0x3400340034003400,0x3400340034003400,0xb4003400b4003400,0xb4003400b4003400,0x3593abbd34a03284,0xabbdb5933284b4a0,0x2bbd3593b28434a0,0x3593abbd34a03284,0x30d6b51d351d30d6,0xb0d6351db51db0d6,0x351d30d6b0d6351d,0xb51db0d630d6b51d,0xb194b4ec35742e09,0x34ecb194ae093574,0x34ecb194ae093574,0x319434ecb574ae09
.quad 0xb5a1a87035a12870,0xb5a1a87035a12870,0x2870b5a1a87035a1,0x2870b5a1a87035a1,0xb364344935a4a6a9,0x34493364a6a9b5a4,0xb449b36426a935a4,0xb364344935a4a6a9,0x2d7f357d357dad7f,0xad7fb57db57d2d7f,0xb57d2d7f2d7f357d,0x357dad7fad7fb57d,0x35473012352cb096,0xb01235473096352c,0xb01235473096352c,0xb547b012b52c3096
.quad 0x3400340034003400,0x3400340034003400,0xb4003400b4003400,0xb4003400b4003400,0xb5932bbdb4a0b284,0x2bbd3593b28434a0,0xabbdb5933284b4a0,0xb5932bbdb4a0b284,0x30d6b51d351d30d6,0xb0d6351db51db0d6,0x351d30d6b0d6351d,0xb51db0d630d6b51d,0x319434ecb574ae09,0xb4ec31942e09b574,0xb4ec31942e09b574,0xb194b4ec35742e09
.quad 0xb5a1a87035a12870,0xb5a1a87035a12870,0x2870b5a1a87035a1,0x2870b5a1a87035a1,0x3364b449b5a426a9,0xb449b36426a935a4,0x34493364a6a9b5a4,0x3364b449b5a426a9,0x2d7f357d357dad7f,0xad7fb57db57d2d7f,0xb57d2d7f2d7f357d,0x357dad7fad7fb57d,0xb547b012b52c3096,0x3012b547b096b52c,0x3012b547b096b52c,0x35473012352cb096
.quad 0,0,0,0,0,0,0,0,0,0,0,0,0,0,0,0
.quad 0,0,0,0,0,0,0,0,0,0,0,0,0,0,0,0
.quad 0,0,0,0,0,0,0,0,0,0,0,0,0,0,0,0
.quad 0,0,0,0,0,0,0,0,0,0,0,0,0,0,0,0
.quad 0x3400340034003400,0x3400340034003400,0xb4003400b4003400,0xb4003400b4003400,0x3592abe034a3327c,0xabe0b592327cb4a3,0x2be03592b27c34a3,0x3592abe034a3327c,0x30c6b521352130c6,0xb0c63521b521b0c6,0x352130c6b0c63521,0xb521b0c630c6b521,0xb1abb4e535772dd6,0x34e5b1abadd63577,0x34e5b1abadd63577,0x31ab34e5b577add6
.quad 0xb5a3a7c435a327c4,0xb5a3a7c435a327c4,0x27c4b5a3a7c435a3,0x27c4b5a3a7c435a3,0xb342345735a2a805,0x34573342a805b5a2,0xb457b342280535a2,0xb342345735a2a805,0x2de735763576ade7,0xade7b576b5762de7,0xb5762de72de73576,0x3576ade7ade7b576,0x35522fb0351fb0ce,0xafb0355230ce351f,0xafb0355230ce351f,0xb552afb0b51f30ce
.quad 0x3400340034003400,0x3400340034003400,0xb4003400b4003400,0xb4003400b4003400,0xb5922be0b4a3b27c,0x2be03592b27c34a3,0xabe0b592327cb4a3,0xb5922be0b4a3b27c,0x30c6b521352130c6,0xb0c63521b521b0c6,0x352130c6b0c63521,0xb521b0c630c6b521,0x31ab34e5b577add6,0xb4e531ab2dd6b577,0xb4e531ab2dd6b577,0xb1abb4e535772dd6
.quad 0xb5a3a7c435a327c4,0xb5a3a7c435a327c4,0x27c4b5a3a7c435a3,0x27c4b5a3a7c435a3,0x3342b457b5a22805,0xb457b342280535a2,0x34573342a805b5a2,0x3342b457b5a22805,0x2de735763576ade7,0xade7b576b5762de7,0xb5762de72de73576,0x3576ade7ade7b576,0xb552afb0b51f30ce,0x2fb0b552b0ceb51f,0x2fb0b552b0ceb51f,0x35522fb0351fb0ce
.quad 0,0,0,0,0,0,0,0,0,0,0,0,0,0,0,0
.quad 0,0,0,0,0,0,0,0,0,0,0,0,0,0,0,0
.quad 0,0,0,0,0,0,0,0,0,0,0,0,0,0,0,0
.quad 0,0,0,0,0,0,0,0,0,0,0,0,0,0,0,0
.quad 0x3400340034003400,0x3400340034003400,0xb4003400b4003400,0xb4003400b4003400,0x3591ac0134a53275,0xac01b5913275b4a5,0x2c013591b27534a5,0x3591ac0134a53275,0x30b6b525352530b6,0xb0b63525b525b0b6,0x352530b6b0b63525,0xb525b0b630b6b525,0xb1c2b4df357b2da2,0x34dfb1c2ada2357b,0x34dfb1c2ada2357b,0x31c234dfb57bada2
.quad 0xb5a4a6a935a426a9,0xb5a4a6a935a426a9,0x26a9b5a4a6a935a4,0x26a9b5a4a6a935a4,0xb320346535a0a8b6,0x34653320a8b6b5a0,0xb465b32028b635a0,0xb320346535a0a8b6,0x2e4d356f356fae4d,0xae4db56fb56f2e4d,0xb56f2e4d2e4d356f,0x356fae4dae4db56f,0x355c2f3b3511b106,0xaf3b355c31063511,0xaf3b355c31063511,0xb55caf3bb5113106
.quad 0x3400340034003400,0x3400340034003400,0xb4003400b4003400,0xb4003400b4003400,0xb5912c01b4a5b275,0x2c013591b27534a5,0xac01b5913275b4a5,0xb5912c01b4a5b275,0x30b6b525352530b6,0xb0b63525b525b0b6,0x352530b6b0b63525,0xb525b0b630b6b525,0x31c234dfb57bada2,0xb4df31c22da2b57b,0xb4df31c22da2b57b,0xb1c2b4df357b2da2
.quad 0xb5a4a6a935a426a9,0xb5a4a6a935a426a9,0x26a9b5a4a6a935a4,0x26a9b5a4a6a935a4,0x3320b465b5a028b6,0xb465b32028b635a0,0x34653320a8b6b5a0,0x3320b465b5a028b6,0x2e4d356f356fae4d,0xae4db56fb56f2e4d,0xb56f2e4d2e4d356f,0x356fae4dae4db56f,0xb55caf3bb5113106,0x2f3bb55cb106b511,0x2f3bb55cb106b511,0x355c2f3b3511b106
.quad 0,0,0,0,0,0,0,0,0,0,0,0,0,0,0,0
.quad 0,0,0,0,0,0,0,0,0,0,0,0,0,0,0,0
.quad 0,0,0,0,0,0,0,0,0,0,0,0,0,0,0,0
.quad 0,0,0,0,0,0,0,0,0,0,0,0,0,0,0,0
.quad 0x3400340034003400,0x3400340034003400,0xb4003400b4003400,0xb4003400b4003400,0x3590ac1334a8326e,0xac13b590326eb4a8,0x2c133590b26e34a8,0x3590ac1334a8326e,0x30a6b528352830a6,0xb0a63528b528b0a6,0x352830a6b0a63528,0xb528b0a630a6b528,0xb1d9b4d8357e2d6e,0x34d8b1d9ad6e357e,0x34d8b1d9ad6e357e,0x31d934d8b57ead6e
.quad 0xb5a5a58d35a5258d,0xb5a5a58d35a5258d,0x258db5a5a58d35a5,0x258db5a5a58d35a5,0xb2fd3473359ea967,0x347332fda967b59e,0xb473b2fd2967359e,0xb2fd3473359ea967,0x2eb335673567aeb3,0xaeb3b567b5672eb3,0xb5672eb32eb33567,0x3567aeb3aeb3b567,0x35662ec43503b13e,0xaec43566313e3503,0xaec43566313e3503,0xb566aec4b503313e
.quad 0x3400340034003400,0x3400340034003400,0xb4003400b4003400,0xb4003400b4003400,0xb5902c13b4a8b26e,0x2c133590b26e34a8,0xac13b590326eb4a8,0xb5902c13b4a8b26e,0x30a6b528352830a6,0xb0a63528b528b0a6,0x352830a6b0a63528,0xb528b0a630a6b528,0x31d934d8b57ead6e,0xb4d831d92d6eb57e,0xb4d831d92d6eb57e,0xb1d9b4d8357e2d6e
.quad 0xb5a5a58d35a5258d,0xb5a5a58d35a5258d,0x258db5a5a58d35a5,0x258db5a5a58d35a5,0x32fdb473b59e2967,0xb473b2fd2967359e,0x347332fda967b59e,0x32fdb473b59e2967,0x2eb335673567aeb3,0xaeb3b567b5672eb3,0xb5672eb32eb33567,0x3567aeb3aeb3b567,0xb566aec4b503313e,0x2ec4b566b13eb503,0x2ec4b566b13eb503,0x35662ec43503b13e
.quad 0,0,0,0,0,0,0,0,0,0,0,0,0,0,0,0
.quad 0,0,0,0,0,0,0,0,0,0,0,0,0,0,0,0
.quad 0,0,0,0,0,0,0,0,0,0,0,0,0,0,0,0
.quad 0,0,0,0,0,0,0,0,0,0,0,0,0,0,0,0
.quad 0x3400340034003400,0x3400340034003400,0xb4003400b4003400,0xb4003400b4003400,0x3590ac2434aa3267,0xac24b5903267b4aa,0x2c243590b26734aa,0x3590ac2434aa3267,0x3096b52c352c3096,0xb096352cb52cb096,0x352c3096b096352c,0xb52cb0963096b52c,0xb1efb4d135812d3a,0x34d1b1efad3a3581,0x34d1b1efad3a3581,0x31ef34d1b581ad3a
.quad 0xb5a6a47135a62471,0xb5a6a47135a62471,0x2471b5a6a47135a6,0x2471b5a6a47135a6,0xb2da3480359baa17,0x348032daaa17b59b,0xb480b2da2a17359b,0xb2da3480359baa17,0x2f19355f355faf19,0xaf19b55fb55f2f19,0xb55f2f192f19355f,0x355faf19af19b55f,0x356f2e4d34f5b175,0xae4d356f317534f5,0xae4d356f317534f5,0xb56fae4db4f53175
.quad 0x3400340034003400,0x3400340034003400,0xb4003400b4003400,0xb4003400b4003400,0xb5902c24b4aab267,0x2c243590b26734aa,0xac24b5903267b4aa,0xb5902c24b4aab267,0x3096b52c352c3096,0xb096352cb52cb096,0x352c3096b096352c,0xb52cb0963096b52c,0x31ef34d1b581ad3a,0xb4d131ef2d3ab581,0xb4d131ef2d3ab581,0xb1efb4d135812d3a
.quad 0xb5a6a47135a62471,0xb5a6a47135a62471,0x2471b5a6a47135a6,0x2471b5a6a47135a6,0x32dab480b59b2a17,0xb480b2da2a17359b,0x348032daaa17b59b,0x32dab480b59b2a17,0x2f19355f355faf19,0xaf19b55fb55f2f19,0xb55f2f192f19355f,0x355faf19af19b55f,0xb56fae4db4f53175,0x2e4db56fb175b4f5,0x2e4db56fb175b4f5,0x356f2e4d34f5b175
.quad 0,0,0,0,0,0,0,0,0,0,0,0,0,0,0,0
.quad 0,0,0,0,0,0,0,0,0,0,0,0,0,0,0,0
.quad 0,0,0,0,0,0,0,0,0,0,0,0,0,0,0,0
.quad 0,0,0,0,0,0,0,0,0,0,0,0,0,0,0,0
.quad 0x3400340034003400,0x3400340034003400,0xb4003400b4003400,0xb4003400b4003400,0x358fac3634ad325f,0xac36b58f325fb4ad,0x2c36358fb25f34ad,0x358fac3634ad325f,0x3085b52f352f3085,0xb085352fb52fb085,0x352f3085b085352f,0xb52fb0853085b52f,0xb206b4ca35842d07,0x34cab206ad073584,0x34cab206ad073584,0x320634cab584ad07
.quad 0xb5a7a2aa35a722aa,0xb5a7a2aa35a722aa,0x22aab5a7a2aa35a7,0x22aab5a7a2aa35a7,0xb2b6348e3598aac7,0x348e32b6aac7b598,0xb48eb2b62ac73598,0xb2b6348e3598aac7,0x2f7e35563556af7e,0xaf7eb556b5562f7e,0xb5562f7e2f7e3556,0x3556af7eaf7eb556,0x35772dd634e5b1ab,0xadd6357731ab34e5,0xadd6357731ab34e5,0xb577add6b4e531ab
.quad 0x3400340034003400,0x3400340034003400,0xb4003400b4003400,0xb4003400b4003400,0xb58f2c36b4adb25f,0x2c36358fb25f34ad,0xac36b58f325fb4ad,0xb58f2c36b4adb25f,0x3085b52f352f3085,0xb085352fb52fb085,0x352f3085b085352f,0xb52fb0853085b52f,0x320634cab584ad07,0xb4ca32062d07b584,0xb4ca32062d07b584,0xb206b4ca35842d07
.quad 0xb5a7a2aa35a722aa,0xb5a7a2aa35a722aa,0x22aab5a7a2aa35a7,0x22aab5a7a2aa35a7,0x32b6b48eb5982ac7,0xb48eb2b62ac73598,0x348e32b6aac7b598,0x32b6b48eb5982ac7,0x2f7e35563556af7e,0xaf7eb556b5562f7e,0xb5562f7e2f7e3556,0x3556af7eaf7eb556,0xb577add6b4e531ab,0x2dd6b577b1abb4e5,0x2dd6b577b1abb4e5,0x35772dd634e5b1ab
.quad 0,0,0,0,0,0,0,0,0,0,0,0,0,0,0,0
.quad 0,0,0,0,0,0,0,0,0,0,0,0,0,0,0,0
.quad 0,0,0,0,0,0,0,0,0,0,0,0,0,0,0,0
.quad 0,0,0,0,0,0,0,0,0,0,0,0,0,0,0,0
.quad 0x3400340034003400,0x3400340034003400,0xb4003400b4003400,0xb4003400b4003400,0x358eac4734af3258,0xac47b58e3258b4af,0x2c47358eb25834af,0x358eac4734af3258,0x3075b53335333075,0xb0753533b533b075,0x35333075b0753533,0xb533b0753075b533,0xb21db4c335872cd2,0x34c3b21dacd23587,0x34c3b21dacd23587,0x321d34c3b587acd2
.quad 0xb5a8a07135a82071,0xb5a8a07135a82071,0x2071b5a8a07135a8,0x2071b5a8a07135a8,0xb292349b3594ab77,0x349b3292ab77b594,0xb49bb2922b773594,0xb292349b3594ab77,0x2fe2354d354dafe2,0xafe2b54db54d2fe2,0xb54d2fe22fe2354d,0x354dafe2afe2b54d,0x357f2d5d34d6b1e0,0xad5d357f31e034d6,0xad5d357f31e034d6,0xb57fad5db4d631e0
.quad 0x3400340034003400,0x3400340034003400,0xb4003400b4003400,0xb4003400b4003400,0xb58e2c47b4afb258,0x2c47358eb25834af,0xac47b58e3258b4af,0xb58e2c47b4afb258,0x3075b53335333075,0xb0753533b533b075,0x35333075b0753533,0xb533b0753075b533,0x321d34c3b587acd2,0xb4c3321d2cd2b587,0xb4c3321d2cd2b587,0xb21db4c335872cd2
.quad 0xb5a8a07135a82071,0xb5a8a07135a82071,0x2071b5a8a07135a8,0x2071b5a8a07135a8,0x3292b49bb5942b77,0xb49bb2922b773594,0x349b3292ab77b594,0x3292b49bb5942b77,0x2fe2354d354dafe2,0xafe2b54db54d2fe2,0xb54d2fe22fe2354d,0x354dafe2afe2b54d,0xb57fad5db4d631e0,0x2d5db57fb1e0b4d6,0x2d5db57fb1e0b4d6,0x357f2d5d34d6b1e0
.quad 0,0,0,0,0,0,0,0,0,0,0,0,0,0,0,0
.quad 0,0,0,0,0,0,0,0,0,0,0,0,0,0,0,0
.quad 0,0,0,0,0,0,0,0,0,0,0,0,0,0,0,0
.quad 0,0,0,0,0,0,0,0,0,0,0,0,0,0,0,0
.quad 0x3400340034003400,0x3400340034003400,0xb4003400b4003400,0xb4003400b4003400,0x358dac5934b23250,0xac59b58d3250b4b2,0x2c59358db25034b2,0x358dac5934b23250,0x3065b53635363065,0xb0653536b536b065,0x35363065b0653536,0xb536b0653065b536,0xb233b4bb358a2c9e,0x34bbb233ac9e358a,0x34bbb233ac9e358a,0x323334bbb58aac9e
.quad 0xb5a89c7135a81c71,0xb5a89c7135a81c71,0x1c71b5a89c7135a8,0x1c71b5a89c7135a8,0xb26e34a83590ac13,0x34a8326eac13b590,0xb4a8b26e2c133590,0xb26e34a83590ac13,0x302335443544b023,0xb023b544b5443023,0xb544302330233544,0x3544b023b023b544,0x35862ce434c5b215,0xace43586321534c5,0xace43586321534c5,0xb586ace4b4c53215
.quad 0x3400340034003400,0x3400340034003400,0xb4003400b4003400,0xb4003400b4003400,0xb58d2c59b4b2b250,0x2c59358db25034b2,0xac59b58d3250b4b2,0xb58d2c59b4b2b250,0x3065b53635363065,0xb0653536b536b065,0x35363065b0653536,0xb536b0653065b536,0x323334bbb58aac9e,0xb4bb32332c9eb58a,0xb4bb32332c9eb58a,0xb233b4bb358a2c9e
.quad 0xb5a89c7135a81c71,0xb5a89c7135a81c71,0x1c71b5a89c7135a8,0x1c71b5a89c7135a8,0x326eb4a8b5902c13,0xb4a8b26e2c133590,0x34a8326eac13b590,0x326eb4a8b5902c13,0x302335443544b023,0xb023b544b5443023,0xb544302330233544,0x3544b023b023b544,0xb586ace4b4c53215,0x2ce4b586b215b4c5,0x2ce4b586b215b4c5,0x35862ce434c5b215
.quad 0,0,0,0,0,0,0,0,0,0,0,0,0,0,0,0
.quad 0,0,0,0,0,0,0,0,0,0,0,0,0,0,0,0
.quad 0,0,0,0,0,0,0,0,0,0,0,0,0,0,0,0
.quad 0,0,0,0,0,0,0,0,0,0,0,0,0,0,0,0
.quad 0x3400340034003400,0x3400340034003400,0xb4003400b4003400,0xb4003400b4003400,0x358cac6a34b43249,0xac6ab58c3249b4b4,0x2c6a358cb24934b4,0x358cac6a34b43249,0x3054b53a353a3054,0xb054353ab53ab054,0x353a3054b054353a,0xb53ab0543054b53a,0xb249b4b4358c2c6a,0x34b4b249ac6a358c,0x34b4b249ac6a358c,0x324934b4b58cac6a
.quad 0xb5a8800035a80000,0xb5a8800035a80000,0xb5a8000035a8,0xb5a8800035a8,0xb24934b4358cac6a,0x34b43249ac6ab58c,0xb4b4b2492c6a358c,0xb24934b4358cac6a,0x3054353a353ab054,0xb054b53ab53a3054,0xb53a30543054353a,0x353ab054b054b53a,0x358c2c6a34b4b249,0xac6a358c324934b4,0xac6a358c324934b4,0xb58cac6ab4b43249
.quad 0x3400340034003400,0x3400340034003400,0xb4003400b4003400,0xb4003400b4003400,0xb58c2c6ab4b4b249,0x2c6a358cb24934b4,0xac6ab58c3249b4b4,0xb58c2c6ab4b4b249,0x3054b53a353a3054,0xb054353ab53ab054,0x353a3054b054353a,0xb53ab0543054b53a,0x324934b4b58cac6a,0xb4b432492c6ab58c,0xb4b432492c6ab58c,0xb249b4b4358c2c6a
.quad 0xb5a8800035a80000,0xb5a8800035a88000,0xb5a8800035a8,0xb5a8800035a8,0x3249b4b4b58c2c6a,0xb4b4b2492c6a358c,0x34b43249ac6ab58c,0x3249b4b4b58c2c6a,0x3054353a353ab054,0xb054b53ab53a3054,0xb53a30543054353a,0x353ab054b054b53a,0xb58cac6ab4b43249,0x2c6ab58cb249b4b4,0x2c6ab58cb249b4b4,0x358c2c6a34b4b249
.quad 0,0,0,0,0,0,0,0,0,0,0,0,0,0,0,0
.quad 0,0,0,0,0,0,0,0,0,0,0,0,0,0,0,0
.quad 0,0,0,0,0,0,0,0,0,0,0,0,0,0,0,0
.quad 0,0,0,0,0,0,0,0,0,0,0,0,0,0,0,0
.quad 0x3400340034003400,0x3400340034003400,0xb4003400b4003400,0xb4003400b4003400,0x358bac7c34b73242,0xac7cb58b3242b4b7,0x2c7c358bb24234b7,0x358bac7c34b73242,0x3044b53d353d3044,0xb044353db53db044,0x353d3044b044353d,0xb53db0443044b53d,0xb25fb4ad358f2c36,0x34adb25fac36358f,0x34adb25fac36358f,0x325f34adb58fac36
.quad 0xb5a81c7135a89c71,0xb5a81c7135a89c71,0x9c71b5a81c7135a8,0x9c71b5a81c7135a8,0xb22434c03588acc1,0x34c03224acc1b588,0xb4c0b2242cc13588,0xb22434c03588acc1,0x3085352f352fb085,0xb085b52fb52f3085,0xb52f30853085352f,0x352fb085b085b52f,0x35922be034a3b27c,0xabe03592327c34a3,0xabe03592327c34a3,0xb592abe0b4a3327c
.quad 0x3400340034003400,0x3400340034003400,0xb4003400b4003400,0xb4003400b4003400,0xb58b2c7cb4b7b242,0x2c7c358bb24234b7,0xac7cb58b3242b4b7,0xb58b2c7cb4b7b242,0x3044b53d353d3044,0xb044353db53db044,0x353d3044b044353d,0xb53db0443044b53d,0x325f34adb58fac36,0xb4ad325f2c36b58f,0xb4ad325f2c36b58f,0xb25fb4ad358f2c36
.quad 0xb5a81c7135a89c71,0xb5a81c7135a89c71,0x9c71b5a81c7135a8,0x9c71b5a81c7135a8,0x3224b4c0b5882cc1,0xb4c0b2242cc13588,0x34c03224acc1b588,0x3224b4c0b5882cc1,0x3085352f352fb085,0xb085b52fb52f3085,0xb52f30853085352f,0x352fb085b085b52f,0xb592abe0b4a3327c,0x2be0b592b27cb4a3,0x2be0b592b27cb4a3,0x35922be034a3b27c
.quad 0,0,0,0,0,0,0,0,0,0,0,0,0,0,0,0
.quad 0,0,0,0,0,0,0,0,0,0,0,0,0,0,0,0
.quad 0,0,0,0,0,0,0,0,0,0,0,0,0,0,0,0
.quad 0,0,0,0,0,0,0,0,0,0,0,0,0,0,0,0
.quad 0x3400340034003400,0x3400340034003400,0xb4003400b4003400,0xb4003400b4003400,0x358bac8d34b9323a,0xac8db58b323ab4b9,0x2c8d358bb23a34b9,0x358bac8d34b9323a,0x3033b54135413033,0xb0333541b541b033,0x35413033b0333541,0xb541b0333033b541,0xb275b4a535912c01,0x34a5b275ac013591,0x34a5b275ac013591,0x327534a5b591ac01
.quad 0xb5a8207135a8a071,0xb5a8207135a8a071,0xa071b5a8207135a8,0xa071b5a8207135a8,0xb1fe34cc3583ad18,0x34cc31fead18b583,0xb4ccb1fe2d183583,0xb1fe34cc3583ad18,0x30b635253525b0b6,0xb0b6b525b52530b6,0xb52530b630b63525,0x3525b0b6b0b6b525,0x35972aea3490b2af,0xaaea359732af3490,0xaaea359732af3490,0xb597aaeab49032af
.quad 0x3400340034003400,0x3400340034003400,0xb4003400b4003400,0xb4003400b4003400,0xb58b2c8db4b9b23a,0x2c8d358bb23a34b9,0xac8db58b323ab4b9,0xb58b2c8db4b9b23a,0x3033b54135413033,0xb0333541b541b033,0x35413033b0333541,0xb541b0333033b541,0x327534a5b591ac01,0xb4a532752c01b591,0xb4a532752c01b591,0xb275b4a535912c01
.quad 0xb5a8207135a8a071,0xb5a8207135a8a071,0xa071b5a8207135a8,0xa071b5a8207135a8,0x31feb4ccb5832d18,0xb4ccb1fe2d183583,0x34cc31fead18b583,0x31feb4ccb5832d18,0x30b635253525b0b6,0xb0b6b525b52530b6,0xb52530b630b63525,0x3525b0b6b0b6b525,0xb597aaeab49032af,0x2aeab597b2afb490,0x2aeab597b2afb490,0x35972aea3490b2af
.quad 0,0,0,0,0,0,0,0,0,0,0,0,0,0,0,0
.quad 0,0,0,0,0,0,0,0,0,0,0,0,0,0,0,0
.quad 0,0,0,0,0,0,0,0,0,0,0,0,0,0,0,0
.quad 0,0,0,0,0,0,0,0,0,0,0,0,0,0,0,0
.quad 0x3400340034003400,0x3400340034003400,0xb4003400b4003400,0xb4003400b4003400,0x358aac9e34bb3233,0xac9eb58a3233b4bb,0x2c9e358ab23334bb,0x358aac9e34bb3233,0x3023b54435443023,0xb0233544b544b023,0x35443023b0233544,0xb544b0233023b544,0xb28bb49d35942b9a,0x349db28bab9a3594,0x349db28bab9a3594,0x328b349db594ab9a
.quad 0xb5a722aa35a7a2aa,0xb5a722aa35a7a2aa,0xa2aab5a722aa35a7,0xa2aab5a722aa35a7,0xb1d934d8357ead6e,0x34d831d9ad6eb57e,0xb4d8b1d92d6e357e,0xb1d934d8357ead6e,0x30e635193519b0e6,0xb0e6b519b51930e6,0xb51930e630e63519,0x3519b0e6b0e6b519,0x359c29f4347eb2e1,0xa9f4359c32e1347e,0xa9f4359c32e1347e,0xb59ca9f4b47e32e1
.quad 0x3400340034003400,0x3400340034003400,0xb4003400b4003400,0xb4003400b4003400,0xb58a2c9eb4bbb233,0x2c9e358ab23334bb,0xac9eb58a3233b4bb,0xb58a2c9eb4bbb233,0x3023b54435443023,0xb0233544b544b023,0x35443023b0233544,0xb544b0233023b544,0x328b349db594ab9a,0xb49d328b2b9ab594,0xb49d328b2b9ab594,0xb28bb49d35942b9a
.quad 0xb5a722aa35a7a2aa,0xb5a722aa35a7a2aa,0xa2aab5a722aa35a7,0xa2aab5a722aa35a7,0x31d9b4d8b57e2d6e,0xb4d8b1d92d6e357e,0x34d831d9ad6eb57e,0x31d9b4d8b57e2d6e,0x30e635193519b0e6,0xb0e6b519b51930e6,0xb51930e630e63519,0x3519b0e6b0e6b519,0xb59ca9f4b47e32e1,0x29f4b59cb2e1b47e,0x29f4b59cb2e1b47e,0x359c29f4347eb2e1
.quad 0,0,0,0,0,0,0,0,0,0,0,0,0,0,0,0
.quad 0,0,0,0,0,0,0,0,0,0,0,0,0,0,0,0
.quad 0,0,0,0,0,0,0,0,0,0,0,0,0,0,0,0
.quad 0,0,0,0,0,0,0,0,0,0,0,0,0,0,0,0
.quad 0x3400340034003400,0x3400340034003400,0xb4003400b4003400,0xb4003400b4003400,0x3589acb034be322b,0xacb0b589322bb4be,0x2cb03589b22b34be,0x3589acb034be322b,0x3012b54735473012,0xb0123547b547b012,0x35473012b0123547,0xb547b0123012b547,0xb2a1b49635962b30,0x3496b2a1ab303596,0x3496b2a1ab303596,0x32a13496b596ab30
.quad 0xb5a6247135a6a471,0xb5a6247135a6a471,0xa471b5a6247135a6,0xa471b5a6247135a6,0xb1b234e33578adc4,0x34e331b2adc4b578,0xb4e3b1b22dc43578,0xb1b234e33578adc4,0x3116350e350eb116,0xb116b50eb50e3116,0xb50e31163116350e,0x350eb116b116b50e,0x359f28fd346bb312,0xa8fd359f3312346b,0xa8fd359f3312346b,0xb59fa8fdb46b3312
.quad 0x3400340034003400,0x3400340034003400,0xb4003400b4003400,0xb4003400b4003400,0xb5892cb0b4beb22b,0x2cb03589b22b34be,0xacb0b589322bb4be,0xb5892cb0b4beb22b,0x3012b54735473012,0xb0123547b547b012,0x35473012b0123547,0xb547b0123012b547,0x32a13496b596ab30,0xb49632a12b30b596,0xb49632a12b30b596,0xb2a1b49635962b30
.quad 0xb5a6247135a6a471,0xb5a6247135a6a471,0xa471b5a6247135a6,0xa471b5a6247135a6,0x31b2b4e3b5782dc4,0xb4e3b1b22dc43578,0x34e331b2adc4b578,0x31b2b4e3b5782dc4,0x3116350e350eb116,0xb116b50eb50e3116,0xb50e31163116350e,0x350eb116b116b50e,0xb59fa8fdb46b3312,0x28fdb59fb312b46b,0x28fdb59fb312b46b,0x359f28fd346bb312
.quad 0,0,0,0,0,0,0,0,0,0,0,0,0,0,0,0
.quad 0,0,0,0,0,0,0,0,0,0,0,0,0,0,0,0
.quad 0,0,0,0,0,0,0,0,0,0,0,0,0,0,0,0
.quad 0,0,0,0,0,0,0,0,0,0,0,0,0,0,0,0
.quad 0x3400340034003400,0x3400340034003400,0xb4003400b4003400,0xb4003400b4003400,0x3588acc134c03224,0xacc1b5883224b4c0,0x2cc13588b22434c0,0x3588acc134c03224,0x3002b54a354a3002,0xb002354ab54ab002,0x354a3002b002354a,0xb54ab0023002b54a,0xb2b6b48e35982ac7,0x348eb2b6aac73598,0x348eb2b6aac73598,0x32b6348eb598aac7
.quad 0xb5a5258d35a5a58d,0xb5a5258d35a5a58d,0xa58db5a5258d35a5,0xa58db5a5258d35a5,0xb18c34ee3573ae1a,0x34ee318cae1ab573,0xb4eeb18c2e1a3573,0xb18c34ee3573ae1a,0x314635013501b146,0xb146b501b5013146,0xb501314631463501,0x3501b146b146b501,0x35a228053457b342,0xa80535a233423457,0xa80535a233423457,0xb5a2a805b4573342
.quad 0x3400340034003400,0x3400340034003400,0xb4003400b4003400,0xb4003400b4003400,0xb5882cc1b4c0b224,0x2cc13588b22434c0,0xacc1b5883224b4c0,0xb5882cc1b4c0b224,0x3002b54a354a3002,0xb002354ab54ab002,0x354a3002b002354a,0xb54ab0023002b54a,0x32b6348eb598aac7,0xb48e32b62ac7b598,0xb48e32b62ac7b598,0xb2b6b48e35982ac7
.quad 0xb5a5258d35a5a58d,0xb5a5258d35a5a58d,0xa58db5a5258d35a5,0xa58db5a5258d35a5,0x318cb4eeb5732e1a,0xb4eeb18c2e1a3573,0x34ee318cae1ab573,0x318cb4eeb5732e1a,0x314635013501b146,0xb146b501b5013146,0xb501314631463501,0x3501b146b146b501,0xb5a2a805b4573342,0x2805b5a2b342b457,0x2805b5a2b342b457,0x35a228053457b342
.quad 0,0,0,0,0,0,0,0,0,0,0,0,0,0,0,0
.quad 0,0,0,0,0,0,0,0,0,0,0,0,0,0,0,0
.quad 0,0,0,0,0,0,0,0,0,0,0,0,0,0,0,0
.quad 0,0,0,0,0,0,0,0,0,0,0,0,0,0,0,0
.quad 0x3400340034003400,0x3400340034003400,0xb4003400b4003400,0xb4003400b4003400,0x3587acd234c3321d,0xacd2b587321db4c3,0x2cd23587b21d34c3,0x3587acd234c3321d,0x2fe2b54d354d2fe2,0xafe2354db54dafe2,0x354d2fe2afe2354d,0xb54dafe22fe2b54d,0xb2ccb486359a2a5e,0x3486b2ccaa5e359a,0x3486b2ccaa5e359a,0x32cc3486b59aaa5e
.quad 0xb5a426a935a4a6a9,0xb5a426a935a4a6a9,0xa6a9b5a426a935a4,0xa6a9b5a426a935a4,0xb16534f9356cae6f,0x34f93165ae6fb56c,0xb4f9b1652e6f356c,0xb16534f9356cae6f,0x317534f534f5b175,0xb175b4f5b4f53175,0xb4f53175317534f5,0x34f5b175b175b4f5,0x35a5261b3443b371,0xa61b35a533713443,0xa61b35a533713443,0xb5a5a61bb4433371
.quad 0x3400340034003400,0x3400340034003400,0xb4003400b4003400,0xb4003400b4003400,0xb5872cd2b4c3b21d,0x2cd23587b21d34c3,0xacd2b587321db4c3,0xb5872cd2b4c3b21d,0x2fe2b54d354d2fe2,0xafe2354db54dafe2,0x354d2fe2afe2354d,0xb54dafe22fe2b54d,0x32cc3486b59aaa5e,0xb48632cc2a5eb59a,0xb48632cc2a5eb59a,0xb2ccb486359a2a5e
.quad 0xb5a426a935a4a6a9,0xb5a426a935a4a6a9,0xa6a9b5a426a935a4,0xa6a9b5a426a935a4,0x3165b4f9b56c2e6f,0xb4f9b1652e6f356c,0x34f93165ae6fb56c,0x3165b4f9b56c2e6f,0x317534f534f5b175,0xb175b4f5b4f53175,0xb4f53175317534f5,0x34f5b175b175b4f5,0xb5a5a61bb4433371,0x261bb5a5b371b443,0x261bb5a5b371b443,0x35a5261b3443b371
.quad 0,0,0,0,0,0,0,0,0,0,0,0,0,0,0,0
.quad 0,0,0,0,0,0,0,0,0,0,0,0,0,0,0,0
.quad 0,0,0,0,0,0,0,0,0,0,0,0,0,0,0,0
.quad 0,0,0,0,0,0,0,0,0,0,0,0,0,0,0,0
.quad 0x3400340034003400,0x3400340034003400,0xb4003400b4003400,0xb4003400b4003400,0x3586ace434c53215,0xace4b5863215b4c5,0x2ce43586b21534c5,0x3586ace434c53215,0x2fc1b55035502fc1,0xafc13550b550afc1,0x35502fc1afc13550,0xb550afc12fc1b550,0xb2e1b47e359c29f4,0x347eb2e1a9f4359c,0x347eb2e1a9f4359c,0x32e1347eb59ca9f4
.quad 0xb5a327c435a3a7c4,0xb5a327c435a3a7c4,0xa7c4b5a327c435a3,0xa7c4b5a327c435a3,0xb13e35033566aec4,0x3503313eaec4b566,0xb503b13e2ec43566,0xb13e35033566aec4,0x31a334e834e8b1a3,0xb1a3b4e8b4e831a3,0xb4e831a331a334e8,0x34e8b1a3b1a3b4e8,0x35a7242a342eb3a0,0xa42a35a733a0342e,0xa42a35a733a0342e,0xb5a7a42ab42e33a0
.quad 0x3400340034003400,0x3400340034003400,0xb4003400b4003400,0xb4003400b4003400,0xb5862ce4b4c5b215,0x2ce43586b21534c5,0xace4b5863215b4c5,0xb5862ce4b4c5b215,0x2fc1b55035502fc1,0xafc13550b550afc1,0x35502fc1afc13550,0xb550afc12fc1b550,0x32e1347eb59ca9f4,0xb47e32e129f4b59c,0xb47e32e129f4b59c,0xb2e1b47e359c29f4
.quad 0xb5a327c435a3a7c4,0xb5a327c435a3a7c4,0xa7c4b5a327c435a3,0xa7c4b5a327c435a3,0x313eb503b5662ec4,0xb503b13e2ec43566,0x3503313eaec4b566,0x313eb503b5662ec4,0x31a334e834e8b1a3,0xb1a3b4e8b4e831a3,0xb4e831a331a334e8,0x34e8b1a3b1a3b4e8,0xb5a7a42ab42e33a0,0x242ab5a7b3a0b42e,0x242ab5a7b3a0b42e,0x35a7242a342eb3a0
.quad 0,0,0,0,0,0,0,0,0,0,0,0,0,0,0,0
.quad 0,0,0,0,0,0,0,0,0,0,0,0,0,0,0,0
.quad 0,0,0,0,0,0,0,0,0,0,0,0,0,0,0,0
.quad 0,0,0,0,0,0,0,0,0,0,0,0,0,0,0,0
.quad 0x3400340034003400,0x3400340034003400,0xb4003400b4003400,0xb4003400b4003400,0x3585acf534c7320e,0xacf5b585320eb4c7,0x2cf53585b20e34c7,0x3585acf534c7320e,0x2f9fb55435542f9f,0xaf9f3554b554af9f,0x35542f9faf9f3554,0xb554af9f2f9fb554,0xb2f6b476359d298a,0x3476b2f6a98a359d,0x3476b2f6a98a359d,0x32f63476b59da98a
.quad 0xb5a1287035a1a870,0xb5a1287035a1a870,0xa870b5a1287035a1,0xa870b5a1287035a1,0xb116350e355faf19,0x350e3116af19b55f,0xb50eb1162f19355f,0xb116350e355faf19,0x31d134da34dab1d1,0xb1d1b4dab4da31d1,0xb4da31d131d134da,0x34dab1d1b1d1b4da,0x35a820713419b3cd,0xa07135a833cd3419,0xa07135a833cd3419,0xb5a8a071b41933cd
.quad 0x3400340034003400,0x3400340034003400,0xb4003400b4003400,0xb4003400b4003400,0xb5852cf5b4c7b20e,0x2cf53585b20e34c7,0xacf5b585320eb4c7,0xb5852cf5b4c7b20e,0x2f9fb55435542f9f,0xaf9f3554b554af9f,0x35542f9faf9f3554,0xb554af9f2f9fb554,0x32f63476b59da98a,0xb47632f6298ab59d,0xb47632f6298ab59d,0xb2f6b476359d298a
.quad 0xb5a1287035a1a870,0xb5a1287035a1a870,0xa870b5a1287035a1,0xa870b5a1287035a1,0x3116b50eb55f2f19,0xb50eb1162f19355f,0x350e3116af19b55f,0x3116b50eb55f2f19,0x31d134da34dab1d1,0xb1d1b4dab4da31d1,0xb4da31d131d134da,0x34dab1d1b1d1b4da,0xb5a8a071b41933cd,0x2071b5a8b3cdb419,0x2071b5a8b3cdb419,0x35a820713419b3cd
.quad 0,0,0,0,0,0,0,0,0,0,0,0,0,0,0,0
.quad 0,0,0,0,0,0,0,0,0,0,0,0,0,0,0,0
.quad 0,0,0,0,0,0,0,0,0,0,0,0,0,0,0,0
.quad 0,0,0,0,0,0,0,0,0,0,0,0,0,0,0,0
.quad 0x3400340034003400,0x3400340034003400,0xb4003400b4003400,0xb4003400b4003400,0x3584ad0734ca3206,0xad07b5843206b4ca,0x2d073584b20634ca,0x3584ad0734ca3206,0x2f7eb55635562f7e,0xaf7e3556b556af7e,0x35562f7eaf7e3556,0xb556af7e2f7eb556,0xb30bb46d359f2920,0x346db30ba920359f,0x346db30ba920359f,0x330b346db59fa920
.quad 0xb59f28fd359fa8fd,0xb59f28fd359fa8fd,0xa8fdb59f28fd359f,0xa8fdb59f28fd359f,0xb0ee35173558af6d,0x351730eeaf6db558,0xb517b0ee2f6d3558,0xb0ee35173558af6d,0x31fe34cc34ccb1fe,0xb1feb4ccb4cc31fe,0xb4cc31fe31fe34cc,0x34ccb1feb1feb4cc,0x35a814713403b3fa,0x947135a833fa3403,0x947135a833fa3403,0xb5a89471b40333fa
.quad 0x3400340034003400,0x3400340034003400,0xb4003400b4003400,0xb4003400b4003400,0xb5842d07b4cab206,0x2d073584b20634ca,0xad07b5843206b4ca,0xb5842d07b4cab206,0x2f7eb55635562f7e,0xaf7e3556b556af7e,0x35562f7eaf7e3556,0xb556af7e2f7eb556,0x330b346db59fa920,0xb46d330b2920b59f,0xb46d330b2920b59f,0xb30bb46d359f2920
.quad 0xb59f28fd359fa8fd,0xb59f28fd359fa8fd,0xa8fdb59f28fd359f,0xa8fdb59f28fd359f,0x30eeb517b5582f6d,0xb517b0ee2f6d3558,0x351730eeaf6db558,0x30eeb517b5582f6d,0x31fe34cc34ccb1fe,0xb1feb4ccb4cc31fe,0xb4cc31fe31fe34cc,0x34ccb1feb1feb4cc,0xb5a89471b40333fa,0x1471b5a8b3fab403,0x1471b5a8b3fab403,0x35a814713403b3fa
.quad 0,0,0,0,0,0,0,0,0,0,0,0,0,0,0,0
.quad 0,0,0,0,0,0,0,0,0,0,0,0,0,0,0,0
.quad 0,0,0,0,0,0,0,0,0,0,0,0,0,0,0,0
.quad 0,0,0,0,0,0,0,0,0,0,0,0,0,0,0,0
.quad 0x3400340034003400,0x3400340034003400,0xb4003400b4003400,0xb4003400b4003400,0x3583ad1834cc31fe,0xad18b58331feb4cc,0x2d183583b1fe34cc,0x3583ad1834cc31fe,0x2f5cb55935592f5c,0xaf5c3559b559af5c,0x35592f5caf5c3559,0xb559af5c2f5cb559,0xb320b46535a028b6,0x3465b320a8b635a0,0x3465b320a8b635a0,0x33203465b5a0a8b6
.quad 0xb59d298a359da98a,0xb59d298a359da98a,0xa98ab59d298a359d,0xa98ab59d298a359d,0xb0c635213550afc1,0x352130c6afc1b550,0xb521b0c62fc13550,0xb0c635213550afc1,0x322b34be34beb22b,0xb22bb4beb4be322b,0xb4be322b322b34be,0x34beb22bb22bb4be,0x35a89eaa33dab413,0x1eaa35a8341333da,0x1eaa35a8341333da,0xb5a81eaab3da3413
.quad 0x3400340034003400,0x3400340034003400,0xb4003400b4003400,0xb4003400b4003400,0xb5832d18b4ccb1fe,0x2d183583b1fe34cc,0xad18b58331feb4cc,0xb5832d18b4ccb1fe,0x2f5cb55935592f5c,0xaf5c3559b559af5c,0x35592f5caf5c3559,0xb559af5c2f5cb559,0x33203465b5a0a8b6,0xb465332028b6b5a0,0xb465332028b6b5a0,0xb320b46535a028b6
.quad 0xb59d298a359da98a,0xb59d298a359da98a,0xa98ab59d298a359d,0xa98ab59d298a359d,0x30c6b521b5502fc1,0xb521b0c62fc13550,0x352130c6afc1b550,0x30c6b521b5502fc1,0x322b34be34beb22b,0xb22bb4beb4be322b,0xb4be322b322b34be,0x34beb22bb22bb4be,0xb5a81eaab3da3413,0x9eaab5a8b413b3da,0x9eaab5a8b413b3da,0x35a89eaa33dab413
.quad 0,0,0,0,0,0,0,0,0,0,0,0,0,0,0,0
.quad 0,0,0,0,0,0,0,0,0,0,0,0,0,0,0,0
.quad 0,0,0,0,0,0,0,0,0,0,0,0,0,0,0,0
.quad 0,0,0,0,0,0,0,0,0,0,0,0,0,0,0,0
.quad 0x3400340034003400,0x3400340034003400,0xb4003400b4003400,0xb4003400b4003400,0x3582ad2934cf31f7,0xad29b58231f7b4cf,0x2d293582b1f734cf,0x3582ad2934cf31f7,0x2f3bb55c355c2f3b,0xaf3b355cb55caf3b,0x355c2f3baf3b355c,0xb55caf3b2f3bb55c,0xb334b45d35a2284c,0x345db334a84c35a2,0x345db334a84c35a2,0x3334345db5a2a84c
.quad 0xb59b2a17359baa17,0xb59b2a17359baa17,0xaa17b59b2a17359b,0xaa17b59b2a17359b,0xb09e352a3549b00a,0x352a309eb00ab549,0xb52ab09e300a3549,0xb09e352a3549b00a,0x325834af34afb258,0xb258b4afb4af3258,0xb4af3258325834af,0x34afb258b258b4af,0x35a7a33833adb428,0x233835a7342833ad,0x233835a7342833ad,0xb5a72338b3ad3428
.quad 0x3400340034003400,0x3400340034003400,0xb4003400b4003400,0xb4003400b4003400,0xb5822d29b4cfb1f7,0x2d293582b1f734cf,0xad29b58231f7b4cf,0xb5822d29b4cfb1f7,0x2f3bb55c355c2f3b,0xaf3b355cb55caf3b,0x355c2f3baf3b355c,0xb55caf3b2f3bb55c,0x3334345db5a2a84c,0xb45d3334284cb5a2,0xb45d3334284cb5a2,0xb334b45d35a2284c
.quad 0xb59b2a17359baa17,0xb59b2a17359baa17,0xaa17b59b2a17359b,0xaa17b59b2a17359b,0x309eb52ab549300a,0xb52ab09e300a3549,0x352a309eb00ab549,0x309eb52ab549300a,0x325834af34afb258,0xb258b4afb4af3258,0xb4af3258325834af,0x34afb258b258b4af,0xb5a72338b3ad3428,0xa338b5a7b428b3ad,0xa338b5a7b428b3ad,0x35a7a33833adb428
.quad 0,0,0,0,0,0,0,0,0,0,0,0,0,0,0,0
.quad 0,0,0,0,0,0,0,0,0,0,0,0,0,0,0,0
.quad 0,0,0,0,0,0,0,0,0,0,0,0,0,0,0,0
.quad 0,0,0,0,0,0,0,0,0,0,0,0,0,0,0,0
.quad 0x3400340034003400,0x3400340034003400,0xb4003400b4003400,0xb4003400b4003400,0x3581ad3a34d131ef,0xad3ab58131efb4d1,0x2d3a3581b1ef34d1,0x3581ad3a34d131ef,0x2f19b55f355f2f19,0xaf19355fb55faf19,0x355f2f19af19355f,0xb55faf192f19b55f,0xb349b45435a327c4,0x3454b349a7c435a3,0x3454b349a7c435a3,0x33493454b5a3a7c4
.quad 0xb5982aa43598aaa4,0xb5982aa43598aaa4,0xaaa4b5982aa43598,0xaaa4b5982aa43598,0xb07535333541b033,0x35333075b033b541,0xb533b07530333541,0xb07535333541b033,0x328434a034a0b284,0xb284b4a0b4a03284,0xb4a03284328434a0,0x34a0b284b284b4a0,0x35a5a58d337fb43d,0x258d35a5343d337f,0x258d35a5343d337f,0xb5a5258db37f343d
.quad 0x3400340034003400,0x3400340034003400,0xb4003400b4003400,0xb4003400b4003400,0xb5812d3ab4d1b1ef,0x2d3a3581b1ef34d1,0xad3ab58131efb4d1,0xb5812d3ab4d1b1ef,0x2f19b55f355f2f19,0xaf19355fb55faf19,0x355f2f19af19355f,0xb55faf192f19b55f,0x33493454b5a3a7c4,0xb454334927c4b5a3,0xb454334927c4b5a3,0xb349b45435a327c4
.quad 0xb5982aa43598aaa4,0xb5982aa43598aaa4,0xaaa4b5982aa43598,0xaaa4b5982aa43598,0x3075b533b5413033,0xb533b07530333541,0x35333075b033b541,0x3075b533b5413033,0x328434a034a0b284,0xb284b4a0b4a03284,0xb4a03284328434a0,0x34a0b284b284b4a0,0xb5a5258db37f343d,0xa58db5a5b43db37f,0xa58db5a5b43db37f,0x35a5a58d337fb43d
.quad 0,0,0,0,0,0,0,0,0,0,0,0,0,0,0,0
.quad 0,0,0,0,0,0,0,0,0,0,0,0,0,0,0,0
.quad 0,0,0,0,0,0,0,0,0,0,0,0,0,0,0,0
.quad 0,0,0,0,0,0,0,0,0,0,0,0,0,0,0,0
.quad 0x3400340034003400,0x3400340034003400,0xb4003400b4003400,0xb4003400b4003400,0x3580ad4c34d331e8,0xad4cb58031e8b4d3,0x2d4c3580b1e834d3,0x3580ad4c34d331e8,0x2ef7b56235622ef7,0xaef73562b562aef7,0x35622ef7aef73562,0xb562aef72ef7b562,0xb35db44b35a426ef,0x344bb35da6ef35a4,0x344bb35da6ef35a4,0x335d344bb5a4a6ef
.quad 0xb5962b303596ab30,0xb5962b303596ab30,0xab30b5962b303596,0xab30b5962b303596,0xb04c353c3538b05d,0x353c304cb05db538,0xb53cb04c305d3538,0xb04c353c3538b05d,0x32af34903490b2af,0xb2afb490b49032af,0xb49032af32af3490,0x3490b2afb2afb490,0x35a3a77d3350b451,0x277d35a334513350,0x277d35a334513350,0xb5a3277db3503451
.quad 0x3400340034003400,0x3400340034003400,0xb4003400b4003400,0xb4003400b4003400,0xb5802d4cb4d3b1e8,0x2d4c3580b1e834d3,0xad4cb58031e8b4d3,0xb5802d4cb4d3b1e8,0x2ef7b56235622ef7,0xaef73562b562aef7,0x35622ef7aef73562,0xb562aef72ef7b562,0x335d344bb5a4a6ef,0xb44b335d26efb5a4,0xb44b335d26efb5a4,0xb35db44b35a426ef
.quad 0xb5962b303596ab30,0xb5962b303596ab30,0xab30b5962b303596,0xab30b5962b303596,0x304cb53cb538305d,0xb53cb04c305d3538,0x353c304cb05db538,0x304cb53cb538305d,0x32af34903490b2af,0xb2afb490b49032af,0xb49032af32af3490,0x3490b2afb2afb490,0xb5a3277db3503451,0xa77db5a3b451b350,0xa77db5a3b451b350,0x35a3a77d3350b451
.quad 0,0,0,0,0,0,0,0,0,0,0,0,0,0,0,0
.quad 0,0,0,0,0,0,0,0,0,0,0,0,0,0,0,0
.quad 0,0,0,0,0,0,0,0,0,0,0,0,0,0,0,0
.quad 0,0,0,0,0,0,0,0,0,0,0,0,0,0,0,0
.quad 0x3400340034003400,0x3400340034003400,0xb4003400b4003400,0xb4003400b4003400,0x357fad5d34d631e0,0xad5db57f31e0b4d6,0x2d5d357fb1e034d6,0x357fad5d34d631e0,0x2ed5b56535652ed5,0xaed53565b565aed5,0x35652ed5aed53565,0xb565aed52ed5b565,0xb371b44335a5261b,0x3443b371a61b35a5,0x3443b371a61b35a5,0x33713443b5a5a61b
.quad 0xb5932bbd3593abbd,0xb5932bbd3593abbd,0xabbdb5932bbd3593,0xabbdb5932bbd3593,0xb0233544352fb085,0x35443023b085b52f,0xb544b0233085352f,0xb0233544352fb085,0x32da34803480b2da,0xb2dab480b48032da,0xb48032da32da3480,0x3480b2dab2dab480,0x35a0a8b63320b465,0x28b635a034653320,0x28b635a034653320,0xb5a028b6b3203465
.quad 0x3400340034003400,0x3400340034003400,0xb4003400b4003400,0xb4003400b4003400,0xb57f2d5db4d6b1e0,0x2d5d357fb1e034d6,0xad5db57f31e0b4d6,0xb57f2d5db4d6b1e0,0x2ed5b56535652ed5,0xaed53565b565aed5,0x35652ed5aed53565,0xb565aed52ed5b565,0x33713443b5a5a61b,0xb4433371261bb5a5,0xb4433371261bb5a5,0xb371b44335a5261b
.quad 0xb5932bbd3593abbd,0xb5932bbd3593abbd,0xabbdb5932bbd3593,0xabbdb5932bbd3593,0x3023b544b52f3085,0xb544b0233085352f,0x35443023b085b52f,0x3023b544b52f3085,0x32da34803480b2da,0xb2dab480b48032da,0xb48032da32da3480,0x3480b2dab2dab480,0xb5a028b6b3203465,0xa8b6b5a0b465b320,0xa8b6b5a0b465b320,0x35a0a8b63320b465
.quad 0,0,0,0,0,0,0,0,0,0,0,0,0,0,0,0
.quad 0,0,0,0,0,0,0,0,0,0,0,0,0,0,0,0
.quad 0,0,0,0,0,0,0,0,0,0,0,0,0,0,0,0
.quad 0,0,0,0,0,0,0,0,0,0,0,0,0,0,0,0
.quad 0x3400340034003400,0x3400340034003400,0xb4003400b4003400,0xb4003400b4003400,0x357ead6e34d831d9,0xad6eb57e31d9b4d8,0x2d6e357eb1d934d8,0x357ead6e34d831d9,0x2eb3b56735672eb3,0xaeb33567b567aeb3,0x35672eb3aeb33567,0xb567aeb32eb3b567,0xb385b43a35a62546,0x343ab385a54635a6,0x343ab385a54635a6,0x3385343ab5a6a546
.quad 0xb5902c243590ac24,0xb5902c243590ac24,0xac24b5902c243590,0xac24b5902c243590,0xaff3354c3526b0ae,0x354c2ff3b0aeb526,0xb54caff330ae3526,0xaff3354c3526b0ae,0x330434703470b304,0xb304b470b4703304,0xb470330433043470,0x3470b304b304b470,0x359da9ad32efb478,0x29ad359d347832ef,0x29ad359d347832ef,0xb59d29adb2ef3478
.quad 0x3400340034003400,0x3400340034003400,0xb4003400b4003400,0xb4003400b4003400,0xb57e2d6eb4d8b1d9,0x2d6e357eb1d934d8,0xad6eb57e31d9b4d8,0xb57e2d6eb4d8b1d9,0x2eb3b56735672eb3,0xaeb33567b567aeb3,0x35672eb3aeb33567,0xb567aeb32eb3b567,0x3385343ab5a6a546,0xb43a33852546b5a6,0xb43a33852546b5a6,0xb385b43a35a62546
.quad 0xb5902c243590ac24,0xb5902c243590ac24,0xac24b5902c243590,0xac24b5902c243590,0x2ff3b54cb52630ae,0xb54caff330ae3526,0x354c2ff3b0aeb526,0x2ff3b54cb52630ae,0x330434703470b304,0xb304b470b4703304,0xb470330433043470,0x3470b304b304b470,0xb59d29adb2ef3478,0xa9adb59db478b2ef,0xa9adb59db478b2ef,0x359da9ad32efb478
.quad 0,0,0,0,0,0,0,0,0,0,0,0,0,0,0,0
.quad 0,0,0,0,0,0,0,0,0,0,0,0,0,0,0,0
.quad 0,0,0,0,0,0,0,0,0,0,0,0,0,0,0,0
.quad 0,0,0,0,0,0,0,0,0,0,0,0,0,0,0,0
.quad 0x3400340034003400,0x3400340034003400,0xb4003400b4003400,0xb4003400b4003400,0x357dad7f34da31d1,0xad7fb57d31d1b4da,0x2d7f357db1d134da,0x357dad7f34da31d1,0x2e92b56a356a2e92,0xae92356ab56aae92,0x356a2e92ae92356a,0xb56aae922e92b56a,0xb399b43135a62471,0x3431b399a47135a6,0x3431b399a47135a6,0x33993431b5a6a471
.quad 0xb58c2c6a358cac6a,0xb58c2c6a358cac6a,0xac6ab58c2c6a358c,0xac6ab58c2c6a358c,0xaf9f3554351db0d6,0x35542f9fb0d6b51d,0xb554af9f30d6351d,0xaf9f3554351db0d6,0x332d345f345fb32d,0xb32db45fb45f332d,0xb45f332d332d345f,0x345fb32db32db45f,0x3598aaa432bdb48b,0x2aa43598348b32bd,0x2aa43598348b32bd,0xb5982aa4b2bd348b
.quad 0x3400340034003400,0x3400340034003400,0xb4003400b4003400,0xb4003400b4003400,0xb57d2d7fb4dab1d1,0x2d7f357db1d134da,0xad7fb57d31d1b4da,0xb57d2d7fb4dab1d1,0x2e92b56a356a2e92,0xae92356ab56aae92,0x356a2e92ae92356a,0xb56aae922e92b56a,0x33993431b5a6a471,0xb43133992471b5a6,0xb43133992471b5a6,0xb399b43135a62471
.quad 0xb58c2c6a358cac6a,0xb58c2c6a358cac6a,0xac6ab58c2c6a358c,0xac6ab58c2c6a358c,0x2f9fb554b51d30d6,0xb554af9f30d6351d,0x35542f9fb0d6b51d,0x2f9fb554b51d30d6,0x332d345f345fb32d,0xb32db45fb45f332d,0xb45f332d332d345f,0x345fb32db32db45f,0xb5982aa4b2bd348b,0xaaa4b598b48bb2bd,0xaaa4b598b48bb2bd,0x3598aaa432bdb48b
.quad 0,0,0,0,0,0,0,0,0,0,0,0,0,0,0,0
.quad 0,0,0,0,0,0,0,0,0,0,0,0,0,0,0,0
.quad 0,0,0,0,0,0,0,0,0,0,0,0,0,0,0,0
.quad 0,0,0,0,0,0,0,0,0,0,0,0,0,0,0,0
.quad 0x3400340034003400,0x3400340034003400,0xb4003400b4003400,0xb4003400b4003400,0x357cad9134dc31c9,0xad91b57c31c9b4dc,0x2d91357cb1c934dc,0x357cad9134dc31c9,0x2e6fb56c356c2e6f,0xae6f356cb56cae6f,0x356c2e6fae6f356c,0xb56cae6f2e6fb56c,0xb3adb42835a72338,0x3428b3ada33835a7,0x3428b3ada33835a7,0x33ad3428b5a7a338
.quad 0xb5892cb03589acb0,0xb5892cb03589acb0,0xacb0b5892cb03589,0xacb0b5892cb03589,0xaf4c355b3513b0fe,0x355b2f4cb0feb513,0xb55baf4c30fe3513,0xaf4c355b3513b0fe,0x3356344e344eb356,0xb356b44eb44e3356,0xb44e33563356344e,0x344eb356b356b44e,0x3594ab9a328bb49d,0x2b9a3594349d328b,0x2b9a3594349d328b,0xb5942b9ab28b349d
.quad 0x3400340034003400,0x3400340034003400,0xb4003400b4003400,0xb4003400b4003400,0xb57c2d91b4dcb1c9,0x2d91357cb1c934dc,0xad91b57c31c9b4dc,0xb57c2d91b4dcb1c9,0x2e6fb56c356c2e6f,0xae6f356cb56cae6f,0x356c2e6fae6f356c,0xb56cae6f2e6fb56c,0x33ad3428b5a7a338,0xb42833ad2338b5a7,0xb42833ad2338b5a7,0xb3adb42835a72338
.quad 0xb5892cb03589acb0,0xb5892cb03589acb0,0xacb0b5892cb03589,0xacb0b5892cb03589,0x2f4cb55bb51330fe,0xb55baf4c30fe3513,0x355b2f4cb0feb513,0x2f4cb55bb51330fe,0x3356344e344eb356,0xb356b44eb44e3356,0xb44e33563356344e,0x344eb356b356b44e,0xb5942b9ab28b349d,0xab9ab594b49db28b,0xab9ab594b49db28b,0x3594ab9a328bb49d
.quad 0,0,0,0,0,0,0,0,0,0,0,0,0,0,0,0
.quad 0,0,0,0,0,0,0,0,0,0,0,0,0,0,0,0
.quad 0,0,0,0,0,0,0,0,0,0,0,0,0,0,0,0
.quad 0,0,0,0,0,0,0,0,0,0,0,0,0,0,0,0
.quad 0x3400340034003400,0x3400340034003400,0xb4003400b4003400,0xb4003400b4003400,0x357bada234df31c2,0xada2b57b31c2b4df,0x2da2357bb1c234df,0x357bada234df31c2,0x2e4db56f356f2e4d,0xae4d356fb56fae4d,0x356f2e4dae4d356f,0xb56fae4d2e4db56f,0xb3c0b41f35a7218d,0x341fb3c0a18d35a7,0x341fb3c0a18d35a7,0x33c0341fb5a7a18d
.quad 0xb5852cf53585acf5,0xb5852cf53585acf5,0xacf5b5852cf53585,0xacf5b5852cf53585,0xaef73562350ab126,0x35622ef7b126b50a,0xb562aef73126350a,0xaef73562350ab126,0x337f343d343db37f,0xb37fb43db43d337f,0xb43d337f337f343d,0x343db37fb37fb43d,0x358eac473258b4af,0x2c47358e34af3258,0x2c47358e34af3258,0xb58e2c47b25834af
.quad 0x3400340034003400,0x3400340034003400,0xb4003400b4003400,0xb4003400b4003400,0xb57b2da2b4dfb1c2,0x2da2357bb1c234df,0xada2b57b31c2b4df,0xb57b2da2b4dfb1c2,0x2e4db56f356f2e4d,0xae4d356fb56fae4d,0x356f2e4dae4d356f,0xb56fae4d2e4db56f,0x33c0341fb5a7a18d,0xb41f33c0218db5a7,0xb41f33c0218db5a7,0xb3c0b41f35a7218d
.quad 0xb5852cf53585acf5,0xb5852cf53585acf5,0xacf5b5852cf53585,0xacf5b5852cf53585,0x2ef7b562b50a3126,0xb562aef73126350a,0x35622ef7b126b50a,0x2ef7b562b50a3126,0x337f343d343db37f,0xb37fb43db43d337f,0xb43d337f337f343d,0x343db37fb37fb43d,0xb58e2c47b25834af,0xac47b58eb4afb258,0xac47b58eb4afb258,0x358eac473258b4af
.quad 0,0,0,0,0,0,0,0,0,0,0,0,0,0,0,0
.quad 0,0,0,0,0,0,0,0,0,0,0,0,0,0,0,0
.quad 0,0,0,0,0,0,0,0,0,0,0,0,0,0,0,0
.quad 0,0,0,0,0,0,0,0,0,0,0,0,0,0,0,0
.quad 0x3400340034003400,0x3400340034003400,0xb4003400b4003400,0xb4003400b4003400,0x3579adb334e131ba,0xadb3b57931bab4e1,0x2db33579b1ba34e1,0x3579adb334e131ba,0x2e2bb57135712e2b,0xae2b3571b571ae2b,0x35712e2bae2b3571,0xb571ae2b2e2bb571,0xb3d4b41635a81fc6,0x3416b3d49fc635a8,0x3416b3d49fc635a8,0x33d43416b5a89fc6
.quad 0xb5812d3a3581ad3a,0xb5812d3a3581ad3a,0xad3ab5812d3a3581,0xad3ab5812d3a3581,0xaea3356934ffb14d,0x35692ea3b14db4ff,0xb569aea3314d34ff,0xaea3356934ffb14d,0x33a6342b342bb3a6,0xb3a6b42bb42b33a6,0xb42b33a633a6342b,0x342bb3a6b3a6b42b,0x3588acc13224b4c0,0x2cc1358834c03224,0x2cc1358834c03224,0xb5882cc1b22434c0
.quad 0x3400340034003400,0x3400340034003400,0xb4003400b4003400,0xb4003400b4003400,0xb5792db3b4e1b1ba,0x2db33579b1ba34e1,0xadb3b57931bab4e1,0xb5792db3b4e1b1ba,0x2e2bb57135712e2b,0xae2b3571b571ae2b,0x35712e2bae2b3571,0xb571ae2b2e2bb571,0x33d43416b5a89fc6,0xb41633d41fc6b5a8,0xb41633d41fc6b5a8,0xb3d4b41635a81fc6
.quad 0xb5812d3a3581ad3a,0xb5812d3a3581ad3a,0xad3ab5812d3a3581,0xad3ab5812d3a3581,0x2ea3b569b4ff314d,0xb569aea3314d34ff,0x35692ea3b14db4ff,0x2ea3b569b4ff314d,0x33a6342b342bb3a6,0xb3a6b42bb42b33a6,0xb42b33a633a6342b,0x342bb3a6b3a6b42b,0xb5882cc1b22434c0,0xacc1b588b4c0b224,0xacc1b588b4c0b224,0x3588acc13224b4c0
.quad 0,0,0,0,0,0,0,0,0,0,0,0,0,0,0,0
.quad 0,0,0,0,0,0,0,0,0,0,0,0,0,0,0,0
.quad 0,0,0,0,0,0,0,0,0,0,0,0,0,0,0,0
.quad 0,0,0,0,0,0,0,0,0,0,0,0,0,0,0,0
.quad 0x3400340034003400,0x3400340034003400,0xb4003400b4003400,0xb4003400b4003400,0x3578adc434e331b2,0xadc4b57831b2b4e3,0x2dc43578b1b234e3,0x3578adc434e331b2,0x2e09b57435742e09,0xae093574b574ae09,0x35742e09ae093574,0xb574ae092e09b574,0xb3e7b40c35a81c71,0x340cb3e79c7135a8,0x340cb3e79c7135a8,0x33e7340cb5a89c71
.quad 0xb57d2d7f357dad7f,0xb57d2d7f357dad7f,0xad7fb57d2d7f357d,0xad7fb57d2d7f357d,0xae4d356f34f5b175,0x356f2e4db175b4f5,0xb56fae4d317534f5,0xae4d356f34f5b175,0x33cd34193419b3cd,0xb3cdb419b41933cd,0xb41933cd33cd3419,0x3419b3cdb3cdb419,0x3581ad3a31efb4d1,0x2d3a358134d131ef,0x2d3a358134d131ef,0xb5812d3ab1ef34d1
.quad 0x3400340034003400,0x3400340034003400,0xb4003400b4003400,0xb4003400b4003400,0xb5782dc4b4e3b1b2,0x2dc43578b1b234e3,0xadc4b57831b2b4e3,0xb5782dc4b4e3b1b2,0x2e09b57435742e09,0xae093574b574ae09,0x35742e09ae093574,0xb574ae092e09b574,0x33e7340cb5a89c71,0xb40c33e71c71b5a8,0xb40c33e71c71b5a8,0xb3e7b40c35a81c71
.quad 0xb57d2d7f357dad7f,0xb57d2d7f357dad7f,0xad7fb57d2d7f357d,0xad7fb57d2d7f357d,0x2e4db56fb4f53175,0xb56fae4d317534f5,0x356f2e4db175b4f5,0x2e4db56fb4f53175,0x33cd34193419b3cd,0xb3cdb419b41933cd,0xb41933cd33cd3419,0x3419b3cdb3cdb419,0xb5812d3ab1ef34d1,0xad3ab581b4d1b1ef,0xad3ab581b4d1b1ef,0x3581ad3a31efb4d1
.quad 0,0,0,0,0,0,0,0,0,0,0,0,0,0,0,0
.quad 0,0,0,0,0,0,0,0,0,0,0,0,0,0,0,0
.quad 0,0,0,0,0,0,0,0,0,0,0,0,0,0,0,0
.quad 0,0,0,0,0,0,0,0,0,0,0,0,0,0,0,0
.quad 0x3400340034003400,0x3400340034003400,0xb4003400b4003400,0xb4003400b4003400,0x3577add634e531ab,0xadd6b57731abb4e5,0x2dd63577b1ab34e5,0x3577add634e531ab,0x2de7b57635762de7,0xade73576b576ade7,0x35762de7ade73576,0xb576ade72de7b576,0xb3fab40335a81471,0x3403b3fa947135a8,0x3403b3fa947135a8,0x33fa3403b5a89471
.quad 0xb5782dc43578adc4,0xb5782dc43578adc4,0xadc4b5782dc43578,0xadc4b5782dc43578,0xadf8357534eab19b,0x35752df8b19bb4ea,0xb575adf8319b34ea,0xadf8357534eab19b,0x33f334063406b3f3,0xb3f3b406b40633f3,0xb40633f333f33406,0x3406b3f3b3f3b406,0x3579adb331bab4e1,0x2db3357934e131ba,0x2db3357934e131ba,0xb5792db3b1ba34e1
.quad 0x3400340034003400,0x3400340034003400,0xb4003400b4003400,0xb4003400b4003400,0xb5772dd6b4e5b1ab,0x2dd63577b1ab34e5,0xadd6b57731abb4e5,0xb5772dd6b4e5b1ab,0x2de7b57635762de7,0xade73576b576ade7,0x35762de7ade73576,0xb576ade72de7b576,0x33fa3403b5a89471,0xb40333fa1471b5a8,0xb40333fa1471b5a8,0xb3fab40335a81471
.quad 0xb5782dc43578adc4,0xb5782dc43578adc4,0xadc4b5782dc43578,0xadc4b5782dc43578,0x2df8b575b4ea319b,0xb575adf8319b34ea,0x35752df8b19bb4ea,0x2df8b575b4ea319b,0x33f334063406b3f3,0xb3f3b406b40633f3,0xb40633f333f33406,0x3406b3f3b3f3b406,0xb5792db3b1ba34e1,0xadb3b579b4e1b1ba,0xadb3b579b4e1b1ba,0x3579adb331bab4e1
.quad 0,0,0,0,0,0,0,0,0,0,0,0,0,0,0,0
.quad 0,0,0,0,0,0,0,0,0,0,0,0,0,0,0,0
.quad 0,0,0,0,0,0,0,0,0,0,0,0,0,0,0,0
.quad 0,0,0,0,0,0,0,0,0,0,0,0,0,0,0,0
.quad 0x3400340034003400,0x3400340034003400,0xb4003400b4003400,0xb4003400b4003400,0x3576ade734e831a3,0xade7b57631a3b4e8,0x2de73576b1a334e8,0x3576ade734e831a3,0x2dc4b57835782dc4,0xadc43578b578adc4,0x35782dc4adc43578,0xb578adc42dc4b578,0xb406b3f335a89871,0x33f3b406187135a8,0x33f3b406187135a8,0x340633f3b5a81871
.quad 0xb5742e093574ae09,0xb5742e093574ae09,0xae09b5742e093574,0xae09b5742e093574,0xada2357b34dfb1c2,0x357b2da2b1c2b4df,0xb57bada231c234df,0xada2357b34dfb1c2,0x340c33e733e7b40c,0xb40cb3e7b3e7340c,0xb3e7340c340c33e7,0x33e7b40cb40cb3e7,0x3571ae2b3184b4f0,0x2e2b357134f03184,0x2e2b357134f03184,0xb5712e2bb18434f0
.quad 0x3400340034003400,0x3400340034003400,0xb4003400b4003400,0xb4003400b4003400,0xb5762de7b4e8b1a3,0x2de73576b1a334e8,0xade7b57631a3b4e8,0xb5762de7b4e8b1a3,0x2dc4b57835782dc4,0xadc43578b578adc4,0x35782dc4adc43578,0xb578adc42dc4b578,0x340633f3b5a81871,0xb3f334069871b5a8,0xb3f334069871b5a8,0xb406b3f335a89871
.quad 0xb5742e093574ae09,0xb5742e093574ae09,0xae09b5742e093574,0xae09b5742e093574,0x2da2b57bb4df31c2,0xb57bada231c234df,0x357b2da2b1c2b4df,0x2da2b57bb4df31c2,0x340c33e733e7b40c,0xb40cb3e7b3e7340c,0xb3e7340c340c33e7,0x33e7b40cb40cb3e7,0xb5712e2bb18434f0,0xae2bb571b4f0b184,0xae2bb571b4f0b184,0x3571ae2b3184b4f0
.quad 0,0,0,0,0,0,0,0,0,0,0,0,0,0,0,0
.quad 0,0,0,0,0,0,0,0,0,0,0,0,0,0,0,0
.quad 0,0,0,0,0,0,0,0,0,0,0,0,0,0,0,0
.quad 0,0,0,0,0,0,0,0,0,0,0,0,0,0,0,0
.quad 0x3400340034003400,0x3400340034003400,0xb4003400b4003400,0xb4003400b4003400,0x3575adf834ea319b,0xadf8b575319bb4ea,0x2df83575b19b34ea,0x3575adf834ea319b,0x2da2b57b357b2da2,0xada2357bb57bada2,0x357b2da2ada2357b,0xb57bada22da2b57b,0xb410b3e035a89d8e,0x33e0b4101d8e35a8,0x33e0b4101d8e35a8,0x341033e0b5a81d8e
.quad 0xb56f2e4d356fae4d,0xb56f2e4d356fae4d,0xae4db56f2e4d356f,0xae4db56f2e4d356f,0xad4c358034d3b1e8,0x35802d4cb1e8b4d3,0xb580ad4c31e834d3,0xad4c358034d3b1e8,0x341f33c033c0b41f,0xb41fb3c0b3c0341f,0xb3c0341f341f33c0,0x33c0b41fb41fb3c0,0x3569aea3314db4ff,0x2ea3356934ff314d,0x2ea3356934ff314d,0xb5692ea3b14d34ff
.quad 0x3400340034003400,0x3400340034003400,0xb4003400b4003400,0xb4003400b4003400,0xb5752df8b4eab19b,0x2df83575b19b34ea,0xadf8b575319bb4ea,0xb5752df8b4eab19b,0x2da2b57b357b2da2,0xada2357bb57bada2,0x357b2da2ada2357b,0xb57bada22da2b57b,0x341033e0b5a81d8e,0xb3e034109d8eb5a8,0xb3e034109d8eb5a8,0xb410b3e035a89d8e
.quad 0xb56f2e4d356fae4d,0xb56f2e4d356fae4d,0xae4db56f2e4d356f,0xae4db56f2e4d356f,0x2d4cb580b4d331e8,0xb580ad4c31e834d3,0x35802d4cb1e8b4d3,0x2d4cb580b4d331e8,0x341f33c033c0b41f,0xb41fb3c0b3c0341f,0xb3c0341f341f33c0,0x33c0b41fb41fb3c0,0xb5692ea3b14d34ff,0xaea3b569b4ffb14d,0xaea3b569b4ffb14d,0x3569aea3314db4ff
.quad 0,0,0,0,0,0,0,0,0,0,0,0,0,0,0,0
.quad 0,0,0,0,0,0,0,0,0,0,0,0,0,0,0,0
.quad 0,0,0,0,0,0,0,0,0,0,0,0,0,0,0,0
.quad 0,0,0,0,0,0,0,0,0,0,0,0,0,0,0,0
.quad 0x3400340034003400,0x3400340034003400,0xb4003400b4003400,0xb4003400b4003400,0x3574ae0934ec3194,0xae09b5743194b4ec,0x2e093574b19434ec,0x3574ae0934ec3194,0x2d7fb57d357d2d7f,0xad7f357db57dad7f,0x357d2d7fad7f357d,0xb57dad7f2d7fb57d,0xb419b3cd35a8a071,0x33cdb419207135a8,0x33cdb419207135a8,0x341933cdb5a82071
.quad 0xb56a2e92356aae92,0xb56a2e92356aae92,0xae92b56a2e92356a,0xae92b56a2e92356a,0xacf5358534c7b20e,0x35852cf5b20eb4c7,0xb585acf5320e34c7,0xacf5358534c7b20e,0x343133993399b431,0xb431b399b3993431,0xb399343134313399,0x3399b431b431b399,0x355faf193116b50e,0x2f19355f350e3116,0x2f19355f350e3116,0xb55f2f19b116350e
.quad 0x3400340034003400,0x3400340034003400,0xb4003400b4003400,0xb4003400b4003400,0xb5742e09b4ecb194,0x2e093574b19434ec,0xae09b5743194b4ec,0xb5742e09b4ecb194,0x2d7fb57d357d2d7f,0xad7f357db57dad7f,0x357d2d7fad7f357d,0xb57dad7f2d7fb57d,0x341933cdb5a82071,0xb3cd3419a071b5a8,0xb3cd3419a071b5a8,0xb419b3cd35a8a071
.quad 0xb56a2e92356aae92,0xb56a2e92356aae92,0xae92b56a2e92356a,0xae92b56a2e92356a,0x2cf5b585b4c7320e,0xb585acf5320e34c7,0x35852cf5b20eb4c7,0x2cf5b585b4c7320e,0x343133993399b431,0xb431b399b3993431,0xb399343134313399,0x3399b431b431b399,0xb55f2f19b116350e,0xaf19b55fb50eb116,0xaf19b55fb50eb116,0x355faf193116b50e
.quad 0,0,0,0,0,0,0,0,0,0,0,0,0,0,0,0
.quad 0,0,0,0,0,0,0,0,0,0,0,0,0,0,0,0
.quad 0,0,0,0,0,0,0,0,0,0,0,0,0,0,0,0
.quad 0,0,0,0,0,0,0,0,0,0,0,0,0,0,0,0
.quad 0x3400340034003400,0x3400340034003400,0xb4003400b4003400,0xb4003400b4003400,0x3573ae1a34ee318c,0xae1ab573318cb4ee,0x2e1a3573b18c34ee,0x3573ae1a34ee318c,0x2d5db57f357f2d5d,0xad5d357fb57fad5d,0x357f2d5dad5d357f,0xb57fad5d2d5db57f,0xb422b3ba35a7a21c,0x33bab422221c35a7,0x33bab422221c35a7,0x342233bab5a7221c
.quad 0xb5652ed53565aed5,0xb5652ed53565aed5,0xaed5b5652ed53565,0xaed5b5652ed53565,0xac9e358a34bbb233,0x358a2c9eb233b4bb,0xb58aac9e323334bb,0xac9e358a34bbb233,0x344333713371b443,0xb443b371b3713443,0xb371344334433371,0x3371b443b443b371,0x3555af8f30deb51b,0x2f8f3555351b30de,0x2f8f3555351b30de,0xb5552f8fb0de351b
.quad 0x3400340034003400,0x3400340034003400,0xb4003400b4003400,0xb4003400b4003400,0xb5732e1ab4eeb18c,0x2e1a3573b18c34ee,0xae1ab573318cb4ee,0xb5732e1ab4eeb18c,0x2d5db57f357f2d5d,0xad5d357fb57fad5d,0x357f2d5dad5d357f,0xb57fad5d2d5db57f,0x342233bab5a7221c,0xb3ba3422a21cb5a7,0xb3ba3422a21cb5a7,0xb422b3ba35a7a21c
.quad 0xb5652ed53565aed5,0xb5652ed53565aed5,0xaed5b5652ed53565,0xaed5b5652ed53565,0x2c9eb58ab4bb3233,0xb58aac9e323334bb,0x358a2c9eb233b4bb,0x2c9eb58ab4bb3233,0x344333713371b443,0xb443b371b3713443,0xb371344334433371,0x3371b443b443b371,0xb5552f8fb0de351b,0xaf8fb555b51bb0de,0xaf8fb555b51bb0de,0x3555af8f30deb51b
.quad 0,0,0,0,0,0,0,0,0,0,0,0,0,0,0,0
.quad 0,0,0,0,0,0,0,0,0,0,0,0,0,0,0,0
.quad 0,0,0,0,0,0,0,0,0,0,0,0,0,0,0,0
.quad 0,0,0,0,0,0,0,0,0,0,0,0,0,0,0,0
.quad 0x3400340034003400,0x3400340034003400,0xb4003400b4003400,0xb4003400b4003400,0x3571ae2b34f03184,0xae2bb5713184b4f0,0x2e2b3571b18434f0,0x3571ae2b34f03184,0x2d3ab58135812d3a,0xad3a3581b581ad3a,0x35812d3aad3a3581,0xb581ad3a2d3ab581,0xb42bb3a635a7a3c6,0x33a6b42b23c635a7,0x33a6b42b23c635a7,0x342b33a6b5a723c6
.quad 0xb55f2f19355faf19,0xb55f2f19355faf19,0xaf19b55f2f19355f,0xaf19b55f2f19355f,0xac47358e34afb258,0x358e2c47b258b4af,0xb58eac47325834af,0xac47358e34afb258,0x345433493349b454,0xb454b349b3493454,0xb349345434543349,0x3349b454b454b349,0x354ab00230a6b528,0x3002354a352830a6,0x3002354a352830a6,0xb54a3002b0a63528
.quad 0x3400340034003400,0x3400340034003400,0xb4003400b4003400,0xb4003400b4003400,0xb5712e2bb4f0b184,0x2e2b3571b18434f0,0xae2bb5713184b4f0,0xb5712e2bb4f0b184,0x2d3ab58135812d3a,0xad3a3581b581ad3a,0x35812d3aad3a3581,0xb581ad3a2d3ab581,0x342b33a6b5a723c6,0xb3a6342ba3c6b5a7,0xb3a6342ba3c6b5a7,0xb42bb3a635a7a3c6
.quad 0xb55f2f19355faf19,0xb55f2f19355faf19,0xaf19b55f2f19355f,0xaf19b55f2f19355f,0x2c47b58eb4af3258,0xb58eac47325834af,0x358e2c47b258b4af,0x2c47b58eb4af3258,0x345433493349b454,0xb454b349b3493454,0xb349345434543349,0x3349b454b454b349,0xb54a3002b0a63528,0xb002b54ab528b0a6,0xb002b54ab528b0a6,0x354ab00230a6b528
.quad 0,0,0,0,0,0,0,0,0,0,0,0,0,0,0,0
.quad 0,0,0,0,0,0,0,0,0,0,0,0,0,0,0,0
.quad 0,0,0,0,0,0,0,0,0,0,0,0,0,0,0,0
.quad 0,0,0,0,0,0,0,0,0,0,0,0,0,0,0,0
.quad 0x3400340034003400,0x3400340034003400,0xb4003400b4003400,0xb4003400b4003400,0x3570ae3c34f3317c,0xae3cb570317cb4f3,0x2e3c3570b17c34f3,0x3570ae3c34f3317c,0x2d18b58335832d18,0xad183583b583ad18,0x35832d18ad183583,0xb583ad182d18b583,0xb434b39235a6a4b8,0x3392b43424b835a6,0x3392b43424b835a6,0x34343392b5a624b8
.quad 0xb5592f5c3559af5c,0xb5592f5c3559af5c,0xaf5cb5592f5c3559,0xaf5cb5592f5c3559,0xabe0359234a3b27c,0x35922be0b27cb4a3,0xb592abe0327c34a3,0xabe0359234a3b27c,0x346533203320b465,0xb465b320b3203465,0xb320346534653320,0x3320b465b465b320,0x353fb03c306db535,0x303c353f3535306d,0x303c353f3535306d,0xb53f303cb06d3535
.quad 0x3400340034003400,0x3400340034003400,0xb4003400b4003400,0xb4003400b4003400,0xb5702e3cb4f3b17c,0x2e3c3570b17c34f3,0xae3cb570317cb4f3,0xb5702e3cb4f3b17c,0x2d18b58335832d18,0xad183583b583ad18,0x35832d18ad183583,0xb583ad182d18b583,0x34343392b5a624b8,0xb3923434a4b8b5a6,0xb3923434a4b8b5a6,0xb434b39235a6a4b8
.quad 0xb5592f5c3559af5c,0xb5592f5c3559af5c,0xaf5cb5592f5c3559,0xaf5cb5592f5c3559,0x2be0b592b4a3327c,0xb592abe0327c34a3,0x35922be0b27cb4a3,0x2be0b592b4a3327c,0x346533203320b465,0xb465b320b3203465,0xb320346534653320,0x3320b465b465b320,0xb53f303cb06d3535,0xb03cb53fb535b06d,0xb03cb53fb535b06d,0x353fb03c306db535
.quad 0,0,0,0,0,0,0,0,0,0,0,0,0,0,0,0
.quad 0,0,0,0,0,0,0,0,0,0,0,0,0,0,0,0
.quad 0,0,0,0,0,0,0,0,0,0,0,0,0,0,0,0
.quad 0,0,0,0,0,0,0,0,0,0,0,0,0,0,0,0
.quad 0x3400340034003400,0x3400340034003400,0xb4003400b4003400,0xb4003400b4003400,0x356fae4d34f53175,0xae4db56f3175b4f5,0x2e4d356fb17534f5,0x356fae4d34f53175,0x2cf5b58535852cf5,0xacf53585b585acf5,0x35852cf5acf53585,0xb585acf52cf5b585,0xb43db37f35a5a58d,0x337fb43d258d35a5,0x337fb43d258d35a5,0x343d337fb5a5258d
.quad 0xb5542f9f3554af9f,0xb5542f9f3554af9f,0xaf9fb5542f9f3554,0xaf9fb5542f9f3554,0xab3035963496b2a1,0x35962b30b2a1b496,0xb596ab3032a13496,0xab3035963496b2a1,0x347632f632f6b476,0xb476b2f6b2f63476,0xb2f63476347632f6,0x32f6b476b476b2f6,0x3533b0753033b541,0x3075353335413033,0x3075353335413033,0xb5333075b0333541
.quad 0x3400340034003400,0x3400340034003400,0xb4003400b4003400,0xb4003400b4003400,0xb56f2e4db4f5b175,0x2e4d356fb17534f5,0xae4db56f3175b4f5,0xb56f2e4db4f5b175,0x2cf5b58535852cf5,0xacf53585b585acf5,0x35852cf5acf53585,0xb585acf52cf5b585,0x343d337fb5a5258d,0xb37f343da58db5a5,0xb37f343da58db5a5,0xb43db37f35a5a58d
.quad 0xb5542f9f3554af9f,0xb5542f9f3554af9f,0xaf9fb5542f9f3554,0xaf9fb5542f9f3554,0x2b30b596b49632a1,0xb596ab3032a13496,0x35962b30b2a1b496,0x2b30b596b49632a1,0x347632f632f6b476,0xb476b2f6b2f63476,0xb2f63476347632f6,0x32f6b476b476b2f6,0xb5333075b0333541,0xb075b533b541b033,0xb075b533b541b033,0x3533b0753033b541
.quad 0,0,0,0,0,0,0,0,0,0,0,0,0,0,0,0
.quad 0,0,0,0,0,0,0,0,0,0,0,0,0,0,0,0
.quad 0,0,0,0,0,0,0,0,0,0,0,0,0,0,0,0
.quad 0,0,0,0,0,0,0,0,0,0,0,0,0,0,0,0
.quad 0x3400340034003400,0x3400340034003400,0xb4003400b4003400,0xb4003400b4003400,0x356eae5e34f7316d,0xae5eb56e316db4f7,0x2e5e356eb16d34f7,0x356eae5e34f7316d,0x2cd2b58735872cd2,0xacd23587b587acd2,0x35872cd2acd23587,0xb587acd22cd2b587,0xb446b36b35a5a662,0x336bb446266235a5,0x336bb446266235a5,0x3446336bb5a52662
.quad 0xb54d2fe2354dafe2,0xb54d2fe2354dafe2,0xafe2b54d2fe2354d,0xafe2b54d2fe2354d,0xaa8135993489b2c4,0x35992a81b2c4b489,0xb599aa8132c43489,0xaa8135993489b2c4,0x348632cc32ccb486,0xb486b2ccb2cc3486,0xb2cc3486348632cc,0x32ccb486b486b2cc,0x3526b0ae2ff3b54c,0x30ae3526354c2ff3,0x30ae3526354c2ff3,0xb52630aeaff3354c
.quad 0x3400340034003400,0x3400340034003400,0xb4003400b4003400,0xb4003400b4003400,0xb56e2e5eb4f7b16d,0x2e5e356eb16d34f7,0xae5eb56e316db4f7,0xb56e2e5eb4f7b16d,0x2cd2b58735872cd2,0xacd23587b587acd2,0x35872cd2acd23587,0xb587acd22cd2b587,0x3446336bb5a52662,0xb36b3446a662b5a5,0xb36b3446a662b5a5,0xb446b36b35a5a662
.quad 0xb54d2fe2354dafe2,0xb54d2fe2354dafe2,0xafe2b54d2fe2354d,0xafe2b54d2fe2354d,0x2a81b599b48932c4,0xb599aa8132c43489,0x35992a81b2c4b489,0x2a81b599b48932c4,0x348632cc32ccb486,0xb486b2ccb2cc3486,0xb2cc3486348632cc,0x32ccb486b486b2cc,0xb52630aeaff3354c,0xb0aeb526b54caff3,0xb0aeb526b54caff3,0x3526b0ae2ff3b54c
.quad 0,0,0,0,0,0,0,0,0,0,0,0,0,0,0,0
.quad 0,0,0,0,0,0,0,0,0,0,0,0,0,0,0,0
.quad 0,0,0,0,0,0,0,0,0,0,0,0,0,0,0,0
.quad 0,0,0,0,0,0,0,0,0,0,0,0,0,0,0,0
.quad 0x3400340034003400,0x3400340034003400,0xb4003400b4003400,0xb4003400b4003400,0x356cae6f34f93165,0xae6fb56c3165b4f9,0x2e6f356cb16534f9,0x356cae6f34f93165,0x2cb0b58935892cb0,0xacb03589b589acb0,0x35892cb0acb03589,0xb589acb02cb0b589,0xb44eb35635a4a736,0x3356b44e273635a4,0x3356b44e273635a4,0x344e3356b5a42736
.quad 0xb54730123547b012,0xb54730123547b012,0xb012b54730123547,0xb012b54730123547,0xa9d1359c347bb2e8,0x359c29d1b2e8b47b,0xb59ca9d132e8347b,0xa9d1359c347bb2e8,0x349632a132a1b496,0xb496b2a1b2a13496,0xb2a13496349632a1,0x32a1b496b496b2a1,0x3519b0e62f7eb556,0x30e6351935562f7e,0x30e6351935562f7e,0xb51930e6af7e3556
.quad 0x3400340034003400,0x3400340034003400,0xb4003400b4003400,0xb4003400b4003400,0xb56c2e6fb4f9b165,0x2e6f356cb16534f9,0xae6fb56c3165b4f9,0xb56c2e6fb4f9b165,0x2cb0b58935892cb0,0xacb03589b589acb0,0x35892cb0acb03589,0xb589acb02cb0b589,0x344e3356b5a42736,0xb356344ea736b5a4,0xb356344ea736b5a4,0xb44eb35635a4a736
.quad 0xb54730123547b012,0xb54730123547b012,0xb012b54730123547,0xb012b54730123547,0x29d1b59cb47b32e8,0xb59ca9d132e8347b,0x359c29d1b2e8b47b,0x29d1b59cb47b32e8,0x349632a132a1b496,0xb496b2a1b2a13496,0xb2a13496349632a1,0x32a1b496b496b2a1,0xb51930e6af7e3556,0xb0e6b519b556af7e,0xb0e6b519b556af7e,0x3519b0e62f7eb556
.quad 0,0,0,0,0,0,0,0,0,0,0,0,0,0,0,0
.quad 0,0,0,0,0,0,0,0,0,0,0,0,0,0,0,0
.quad 0,0,0,0,0,0,0,0,0,0,0,0,0,0,0,0
.quad 0,0,0,0,0,0,0,0,0,0,0,0,0,0,0,0
.quad 0x3400340034003400,0x3400340034003400,0xb4003400b4003400,0xb4003400b4003400,0x356bae8034fb315d,0xae80b56b315db4fb,0x2e80356bb15d34fb,0x356bae8034fb315d,0x2c8db58b358b2c8d,0xac8d358bb58bac8d,0x358b2c8dac8d358b,0xb58bac8d2c8db58b,0xb457b34235a2a805,0x3342b457280535a2,0x3342b457280535a2,0x34573342b5a22805
.quad 0xb54130333541b033,0xb54130333541b033,0xb033b54130333541,0xb033b54130333541,0xa920359f346db30b,0x359f2920b30bb46d,0xb59fa920330b346d,0xa920359f346db30b,0x34a532753275b4a5,0xb4a5b275b27534a5,0xb27534a534a53275,0x3275b4a5b4a5b275,0x350cb11e2f08b560,0x311e350c35602f08,0x311e350c35602f08,0xb50c311eaf083560
.quad 0x3400340034003400,0x3400340034003400,0xb4003400b4003400,0xb4003400b4003400,0xb56b2e80b4fbb15d,0x2e80356bb15d34fb,0xae80b56b315db4fb,0xb56b2e80b4fbb15d,0x2c8db58b358b2c8d,0xac8d358bb58bac8d,0x358b2c8dac8d358b,0xb58bac8d2c8db58b,0x34573342b5a22805,0xb3423457a805b5a2,0xb3423457a805b5a2,0xb457b34235a2a805
.quad 0xb54130333541b033,0xb54130333541b033,0xb033b54130333541,0xb033b54130333541,0x2920b59fb46d330b,0xb59fa920330b346d,0x359f2920b30bb46d,0x2920b59fb46d330b,0x34a532753275b4a5,0xb4a5b275b27534a5,0xb27534a534a53275,0x3275b4a5b4a5b275,0xb50c311eaf083560,0xb11eb50cb560af08,0xb11eb50cb560af08,0x350cb11e2f08b560
.quad 0,0,0,0,0,0,0,0,0,0,0,0,0,0,0,0
.quad 0,0,0,0,0,0,0,0,0,0,0,0,0,0,0,0
.quad 0,0,0,0,0,0,0,0,0,0,0,0,0,0,0,0
.quad 0,0,0,0,0,0,0,0,0,0,0,0,0,0,0,0
.quad 0x3400340034003400,0x3400340034003400,0xb4003400b4003400,0xb4003400b4003400,0x356aae9234fd3155,0xae92b56a3155b4fd,0x2e92356ab15534fd,0x356aae9234fd3155,0x2c6ab58c358c2c6a,0xac6a358cb58cac6a,0x358c2c6aac6a358c,0xb58cac6a2c6ab58c,0xb45fb32d35a1a870,0x332db45f287035a1,0x332db45f287035a1,0x345f332db5a12870
.quad 0xb53a3054353ab054,0xb53a3054353ab054,0xb054b53a3054353a,0xb054b53a3054353a,0xa87035a1345fb32d,0x35a12870b32db45f,0xb5a1a870332d345f,0xa87035a1345fb32d,0x34b432493249b4b4,0xb4b4b249b24934b4,0xb24934b434b43249,0x3249b4b4b4b4b249,0x34fdb1552e92b56a,0x315534fd356a2e92,0x315534fd356a2e92,0xb4fd3155ae92356a
.quad 0x3400340034003400,0x3400340034003400,0xb4003400b4003400,0xb4003400b4003400,0xb56a2e92b4fdb155,0x2e92356ab15534fd,0xae92b56a3155b4fd,0xb56a2e92b4fdb155,0x2c6ab58c358c2c6a,0xac6a358cb58cac6a,0x358c2c6aac6a358c,0xb58cac6a2c6ab58c,0x345f332db5a12870,0xb32d345fa870b5a1,0xb32d345fa870b5a1,0xb45fb32d35a1a870
.quad 0xb53a3054353ab054,0xb53a3054353ab054,0xb054b53a3054353a,0xb054b53a3054353a,0x2870b5a1b45f332d,0xb5a1a870332d345f,0x35a12870b32db45f,0x2870b5a1b45f332d,0x34b432493249b4b4,0xb4b4b249b24934b4,0xb24934b434b43249,0x3249b4b4b4b4b249,0xb4fd3155ae92356a,0xb155b4fdb56aae92,0xb155b4fdb56aae92,0x34fdb1552e92b56a
.quad 0,0,0,0,0,0,0,0,0,0,0,0,0,0,0,0
.quad 0,0,0,0,0,0,0,0,0,0,0,0,0,0,0,0
.quad 0,0,0,0,0,0,0,0,0,0,0,0,0,0,0,0
.quad 0,0,0,0,0,0,0,0,0,0,0,0,0,0,0,0
.quad 0x3400340034003400,0x3400340034003400,0xb4003400b4003400,0xb4003400b4003400,0x3569aea334ff314d,0xaea3b569314db4ff,0x2ea33569b14d34ff,0x3569aea334ff314d,0x2c47b58e358e2c47,0xac47358eb58eac47,0x358e2c47ac47358e,0xb58eac472c47b58e,0xb468b31935a0a8da,0x3319b46828da35a0,0x3319b46828da35a0,0x34683319b5a028da
.quad 0xb53330753533b075,0xb53330753533b075,0xb075b53330753533,0xb075b53330753533,0xa77d35a33451b350,0x35a3277db350b451,0xb5a3a77d33503451,0xa77d35a33451b350,0x34c3321d321db4c3,0xb4c3b21db21d34c3,0xb21d34c334c3321d,0x321db4c3b4c3b21d,0x34eeb18c2e1ab573,0x318c34ee35732e1a,0x318c34ee35732e1a,0xb4ee318cae1a3573
.quad 0x3400340034003400,0x3400340034003400,0xb4003400b4003400,0xb4003400b4003400,0xb5692ea3b4ffb14d,0x2ea33569b14d34ff,0xaea3b569314db4ff,0xb5692ea3b4ffb14d,0x2c47b58e358e2c47,0xac47358eb58eac47,0x358e2c47ac47358e,0xb58eac472c47b58e,0x34683319b5a028da,0xb3193468a8dab5a0,0xb3193468a8dab5a0,0xb468b31935a0a8da
.quad 0xb53330753533b075,0xb53330753533b075,0xb075b53330753533,0xb075b53330753533,0x277db5a3b4513350,0xb5a3a77d33503451,0x35a3277db350b451,0x277db5a3b4513350,0x34c3321d321db4c3,0xb4c3b21db21d34c3,0xb21d34c334c3321d,0x321db4c3b4c3b21d,0xb4ee318cae1a3573,0xb18cb4eeb573ae1a,0xb18cb4eeb573ae1a,0x34eeb18c2e1ab573
.quad 0,0,0,0,0,0,0,0,0,0,0,0,0,0,0,0
.quad 0,0,0,0,0,0,0,0,0,0,0,0,0,0,0,0
.quad 0,0,0,0,0,0,0,0,0,0,0,0,0,0,0,0
.quad 0,0,0,0,0,0,0,0,0,0,0,0,0,0,0,0
.quad 0x3400340034003400,0x3400340034003400,0xb4003400b4003400,0xb4003400b4003400,0x3567aeb335013146,0xaeb3b5673146b501,0x2eb33567b1463501,0x3567aeb335013146,0x2c24b59035902c24,0xac243590b590ac24,0x35902c24ac243590,0xb590ac242c24b590,0xb470b304359ea944,0x3304b4702944359e,0x3304b4702944359e,0x34703304b59e2944
.quad 0xb52c3096352cb096,0xb52c3096352cb096,0xb096b52c3096352c,0xb096b52c3096352c,0xa61b35a53443b371,0x35a5261bb371b443,0xb5a5a61b33713443,0xa61b35a53443b371,0x34d131ef31efb4d1,0xb4d1b1efb1ef34d1,0xb1ef34d134d131ef,0x31efb4d1b4d1b1ef,0x34dfb1c22da2b57b,0x31c234df357b2da2,0x31c234df357b2da2,0xb4df31c2ada2357b
.quad 0x3400340034003400,0x3400340034003400,0xb4003400b4003400,0xb4003400b4003400,0xb5672eb3b501b146,0x2eb33567b1463501,0xaeb3b5673146b501,0xb5672eb3b501b146,0x2c24b59035902c24,0xac243590b590ac24,0x35902c24ac243590,0xb590ac242c24b590,0x34703304b59e2944,0xb3043470a944b59e,0xb3043470a944b59e,0xb470b304359ea944
.quad 0xb52c3096352cb096,0xb52c3096352cb096,0xb096b52c3096352c,0xb096b52c3096352c,0x261bb5a5b4433371,0xb5a5a61b33713443,0x35a5261bb371b443,0x261bb5a5b4433371,0x34d131ef31efb4d1,0xb4d1b1efb1ef34d1,0xb1ef34d134d131ef,0x31efb4d1b4d1b1ef,0xb4df31c2ada2357b,0xb1c2b4dfb57bada2,0xb1c2b4dfb57bada2,0x34dfb1c22da2b57b
.quad 0,0,0,0,0,0,0,0,0,0,0,0,0,0,0,0
.quad 0,0,0,0,0,0,0,0,0,0,0,0,0,0,0,0
.quad 0,0,0,0,0,0,0,0,0,0,0,0,0,0,0,0
.quad 0,0,0,0,0,0,0,0,0,0,0,0,0,0,0,0
.quad 0x3400340034003400,0x3400340034003400,0xb4003400b4003400,0xb4003400b4003400,0x3566aec43503313e,0xaec4b566313eb503,0x2ec43566b13e3503,0x3566aec43503313e,0x2c01b59135912c01,0xac013591b591ac01,0x35912c01ac013591,0xb591ac012c01b591,0xb478b2ef359da9ad,0x32efb47829ad359d,0x32efb47829ad359d,0x347832efb59d29ad
.quad 0xb52530b63525b0b6,0xb52530b63525b0b6,0xb0b6b52530b63525,0xb0b6b52530b63525,0xa4b835a63434b392,0x35a624b8b392b434,0xb5a6a4b833923434,0xa4b835a63434b392,0x34df31c231c2b4df,0xb4dfb1c2b1c234df,0xb1c234df34df31c2,0x31c2b4dfb4dfb1c2,0x34cfb1f72d29b582,0x31f734cf35822d29,0x31f734cf35822d29,0xb4cf31f7ad293582
.quad 0x3400340034003400,0x3400340034003400,0xb4003400b4003400,0xb4003400b4003400,0xb5662ec4b503b13e,0x2ec43566b13e3503,0xaec4b566313eb503,0xb5662ec4b503b13e,0x2c01b59135912c01,0xac013591b591ac01,0x35912c01ac013591,0xb591ac012c01b591,0x347832efb59d29ad,0xb2ef3478a9adb59d,0xb2ef3478a9adb59d,0xb478b2ef359da9ad
.quad 0xb52530b63525b0b6,0xb52530b63525b0b6,0xb0b6b52530b63525,0xb0b6b52530b63525,0x24b8b5a6b4343392,0xb5a6a4b833923434,0x35a624b8b392b434,0x24b8b5a6b4343392,0x34df31c231c2b4df,0xb4dfb1c2b1c234df,0xb1c234df34df31c2,0x31c2b4dfb4dfb1c2,0xb4cf31f7ad293582,0xb1f7b4cfb582ad29,0xb1f7b4cfb582ad29,0x34cfb1f72d29b582
.quad 0,0,0,0,0,0,0,0,0,0,0,0,0,0,0,0
.quad 0,0,0,0,0,0,0,0,0,0,0,0,0,0,0,0
.quad 0,0,0,0,0,0,0,0,0,0,0,0,0,0,0,0
.quad 0,0,0,0,0,0,0,0,0,0,0,0,0,0,0,0
.quad 0x3400340034003400,0x3400340034003400,0xb4003400b4003400,0xb4003400b4003400,0x3565aed535053136,0xaed5b5653136b505,0x2ed53565b1363505,0x3565aed535053136,0x2bbdb59335932bbd,0xabbd3593b593abbd,0x35932bbdabbd3593,0xb593abbd2bbdb593,0xb480b2da359baa17,0x32dab4802a17359b,0x32dab4802a17359b,0x348032dab59b2a17
.quad 0xb51d30d6351db0d6,0xb51d30d6351db0d6,0xb0d6b51d30d6351d,0xb0d6b51d30d6351d,0xa2aa35a73425b3b3,0x35a722aab3b3b425,0xb5a7a2aa33b33425,0xa2aa35a73425b3b3,0x34ec31943194b4ec,0xb4ecb194b19434ec,0xb19434ec34ec3194,0x3194b4ecb4ecb194,0x34beb22b2cb0b589,0x322b34be35892cb0,0x322b34be35892cb0,0xb4be322bacb03589
.quad 0x3400340034003400,0x3400340034003400,0xb4003400b4003400,0xb4003400b4003400,0xb5652ed5b505b136,0x2ed53565b1363505,0xaed5b5653136b505,0xb5652ed5b505b136,0x2bbdb59335932bbd,0xabbd3593b593abbd,0x35932bbdabbd3593,0xb593abbd2bbdb593,0x348032dab59b2a17,0xb2da3480aa17b59b,0xb2da3480aa17b59b,0xb480b2da359baa17
.quad 0xb51d30d6351db0d6,0xb51d30d6351db0d6,0xb0d6b51d30d6351d,0xb0d6b51d30d6351d,0x22aab5a7b42533b3,0xb5a7a2aa33b33425,0x35a722aab3b3b425,0x22aab5a7b42533b3,0x34ec31943194b4ec,0xb4ecb194b19434ec,0xb19434ec34ec3194,0x3194b4ecb4ecb194,0xb4be322bacb03589,0xb22bb4beb589acb0,0xb22bb4beb589acb0,0x34beb22b2cb0b589
.quad 0,0,0,0,0,0,0,0,0,0,0,0,0,0,0,0
.quad 0,0,0,0,0,0,0,0,0,0,0,0,0,0,0,0
.quad 0,0,0,0,0,0,0,0,0,0,0,0,0,0,0,0
.quad 0,0,0,0,0,0,0,0,0,0,0,0,0,0,0,0
.quad 0x3400340034003400,0x3400340034003400,0xb4003400b4003400,0xb4003400b4003400,0x3563aee63507312e,0xaee6b563312eb507,0x2ee63563b12e3507,0x3563aee63507312e,0x2b77b59435942b77,0xab773594b594ab77,0x35942b77ab773594,0xb594ab772b77b594,0xb489b2c43599aa81,0x32c4b4892a813599,0x32c4b4892a813599,0x348932c4b5992a81
.quad 0xb51530f63515b0f6,0xb51530f63515b0f6,0xb0f6b51530f63515,0xb0f6b51530f63515,0x9fc635a83416b3d4,0x35a81fc6b3d4b416,0xb5a89fc633d43416,0x9fc635a83416b3d4,0x34f931653165b4f9,0xb4f9b165b16534f9,0xb16534f934f93165,0x3165b4f9b4f9b165,0x34adb25f2c36b58f,0x325f34ad358f2c36,0x325f34ad358f2c36,0xb4ad325fac36358f
.quad 0x3400340034003400,0x3400340034003400,0xb4003400b4003400,0xb4003400b4003400,0xb5632ee6b507b12e,0x2ee63563b12e3507,0xaee6b563312eb507,0xb5632ee6b507b12e,0x2b77b59435942b77,0xab773594b594ab77,0x35942b77ab773594,0xb594ab772b77b594,0x348932c4b5992a81,0xb2c43489aa81b599,0xb2c43489aa81b599,0xb489b2c43599aa81
.quad 0xb51530f63515b0f6,0xb51530f63515b0f6,0xb0f6b51530f63515,0xb0f6b51530f63515,0x1fc6b5a8b41633d4,0xb5a89fc633d43416,0x35a81fc6b3d4b416,0x1fc6b5a8b41633d4,0x34f931653165b4f9,0xb4f9b165b16534f9,0xb16534f934f93165,0x3165b4f9b4f9b165,0xb4ad325fac36358f,0xb25fb4adb58fac36,0xb25fb4adb58fac36,0x34adb25f2c36b58f
.quad 0,0,0,0,0,0,0,0,0,0,0,0,0,0,0,0
.quad 0,0,0,0,0,0,0,0,0,0,0,0,0,0,0,0
.quad 0,0,0,0,0,0,0,0,0,0,0,0,0,0,0,0
.quad 0,0,0,0,0,0,0,0,0,0,0,0,0,0,0,0
.quad 0x3400340034003400,0x3400340034003400,0xb4003400b4003400,0xb4003400b4003400,0x3562aef7350a3126,0xaef7b5623126b50a,0x2ef73562b126350a,0x3562aef7350a3126,0x2b30b59635962b30,0xab303596b596ab30,0x35962b30ab303596,0xb596ab302b30b596,0xb490b2af3597aaea,0x32afb4902aea3597,0x32afb4902aea3597,0x349032afb5972aea
.quad 0xb50e3116350eb116,0xb50e3116350eb116,0xb116b50e3116350e,0xb116b50e3116350e,0x987135a83406b3f3,0x35a81871b3f3b406,0xb5a8987133f33406,0x987135a83406b3f3,0x350531363136b505,0xb505b136b1363505,0xb136350535053136,0x3136b505b505b136,0x349bb2922b77b594,0x3292349b35942b77,0x3292349b35942b77,0xb49b3292ab773594
.quad 0x3400340034003400,0x3400340034003400,0xb4003400b4003400,0xb4003400b4003400,0xb5622ef7b50ab126,0x2ef73562b126350a,0xaef7b5623126b50a,0xb5622ef7b50ab126,0x2b30b59635962b30,0xab303596b596ab30,0x35962b30ab303596,0xb596ab302b30b596,0x349032afb5972aea,0xb2af3490aaeab597,0xb2af3490aaeab597,0xb490b2af3597aaea
.quad 0xb50e3116350eb116,0xb50e3116350eb116,0xb116b50e3116350e,0xb116b50e3116350e,0x1871b5a8b40633f3,0xb5a8987133f33406,0x35a81871b3f3b406,0x1871b5a8b40633f3,0x350531363136b505,0xb505b136b1363505,0xb136350535053136,0x3136b505b505b136,0xb49b3292ab773594,0xb292b49bb594ab77,0xb292b49bb594ab77,0x349bb2922b77b594
.quad 0,0,0,0,0,0,0,0,0,0,0,0,0,0,0,0
.quad 0,0,0,0,0,0,0,0,0,0,0,0,0,0,0,0
.quad 0,0,0,0,0,0,0,0,0,0,0,0,0,0,0,0
.quad 0,0,0,0,0,0,0,0,0,0,0,0,0,0,0,0
.quad 0x3400340034003400,0x3400340034003400,0xb4003400b4003400,0xb4003400b4003400,0x3560af08350c311e,0xaf08b560311eb50c,0x2f083560b11e350c,0x3560af08350c311e,0x2aeab59735972aea,0xaaea3597b597aaea,0x35972aeaaaea3597,0xb597aaea2aeab597,0xb498b2993595ab53,0x3299b4982b533595,0x3299b4982b533595,0x34983299b5952b53
.quad 0xb50531363505b136,0xb50531363505b136,0xb136b50531363505,0xb136b50531363505,0x1aaa35a833edb409,0x35a89aaab409b3ed,0xb5a81aaa340933ed,0x1aaa35a833edb409,0x351131063106b511,0xb511b106b1063511,0xb106351135113106,0x3106b511b511b106,0x3489b2c42a81b599,0x32c4348935992a81,0x32c4348935992a81,0xb48932c4aa813599
.quad 0x3400340034003400,0x3400340034003400,0xb4003400b4003400,0xb4003400b4003400,0xb5602f08b50cb11e,0x2f083560b11e350c,0xaf08b560311eb50c,0xb5602f08b50cb11e,0x2aeab59735972aea,0xaaea3597b597aaea,0x35972aeaaaea3597,0xb597aaea2aeab597,0x34983299b5952b53,0xb2993498ab53b595,0xb2993498ab53b595,0xb498b2993595ab53
.quad 0xb50531363505b136,0xb50531363505b136,0xb136b50531363505,0xb136b50531363505,0x9aaab5a8b3ed3409,0xb5a81aaa340933ed,0x35a89aaab409b3ed,0x9aaab5a8b3ed3409,0x351131063106b511,0xb511b106b1063511,0xb106351135113106,0x3106b511b511b106,0xb48932c4aa813599,0xb2c4b489b599aa81,0xb2c4b489b599aa81,0x3489b2c42a81b599
.quad 0,0,0,0,0,0,0,0,0,0,0,0,0,0,0,0
.quad 0,0,0,0,0,0,0,0,0,0,0,0,0,0,0,0
.quad 0,0,0,0,0,0,0,0,0,0,0,0,0,0,0,0
.quad 0,0,0,0,0,0,0,0,0,0,0,0,0,0,0,0
.quad 0x3400340034003400,0x3400340034003400,0xb4003400b4003400,0xb4003400b4003400,0x355faf19350e3116,0xaf19b55f3116b50e,0x2f19355fb116350e,0x355faf19350e3116,0x2aa4b59835982aa4,0xaaa43598b598aaa4,0x35982aa4aaa43598,0xb598aaa42aa4b598,0xb4a0b2843593abbd,0x3284b4a02bbd3593,0x3284b4a02bbd3593,0x34a03284b5932bbd
.quad 0xb4fd315534fdb155,0xb4fd315534fdb155,0xb155b4fd315534fd,0xb155b4fd315534fd,0x207135a833cdb419,0x35a8a071b419b3cd,0xb5a82071341933cd,0x207135a833cdb419,0x351d30d630d6b51d,0xb51db0d6b0d6351d,0xb0d6351d351d30d6,0x30d6b51db51db0d6,0x3476b2f6298ab59d,0x32f63476359d298a,0x32f63476359d298a,0xb47632f6a98a359d
.quad 0x3400340034003400,0x3400340034003400,0xb4003400b4003400,0xb4003400b4003400,0xb55f2f19b50eb116,0x2f19355fb116350e,0xaf19b55f3116b50e,0xb55f2f19b50eb116,0x2aa4b59835982aa4,0xaaa43598b598aaa4,0x35982aa4aaa43598,0xb598aaa42aa4b598,0x34a03284b5932bbd,0xb28434a0abbdb593,0xb28434a0abbdb593,0xb4a0b2843593abbd
.quad 0xb4fd315534fdb155,0xb4fd315534fdb155,0xb155b4fd315534fd,0xb155b4fd315534fd,0xa071b5a8b3cd3419,0xb5a82071341933cd,0x35a8a071b419b3cd,0xa071b5a8b3cd3419,0x351d30d630d6b51d,0xb51db0d6b0d6351d,0xb0d6351d351d30d6,0x30d6b51db51db0d6,0xb47632f6a98a359d,0xb2f6b476b59da98a,0xb2f6b476b59da98a,0x3476b2f6298ab59d
.quad 0,0,0,0,0,0,0,0,0,0,0,0,0,0,0,0
.quad 0,0,0,0,0,0,0,0,0,0,0,0,0,0,0,0
.quad 0,0,0,0,0,0,0,0,0,0,0,0,0,0,0,0
.quad 0,0,0,0,0,0,0,0,0,0,0,0,0,0,0,0
.quad 0x3400340034003400,0x3400340034003400,0xb4003400b4003400,0xb4003400b4003400,0x355eaf2a3510310e,0xaf2ab55e310eb510,0x2f2a355eb10e3510,0x355eaf2a3510310e,0x2a5eb59a359a2a5e,0xaa5e359ab59aaa5e,0x359a2a5eaa5e359a,0xb59aaa5e2a5eb59a,0xb4a8b26e3590ac13,0x326eb4a82c133590,0x326eb4a82c133590,0x34a8326eb5902c13
.quad 0xb4f5317534f5b175,0xb4f5317534f5b175,0xb175b4f5317534f5,0xb175b4f5317534f5,0x233835a733adb428,0x35a7a338b428b3ad,0xb5a72338342833ad,0x233835a733adb428,0x352830a630a6b528,0xb528b0a6b0a63528,0xb0a63528352830a6,0x30a6b528b528b0a6,0x3462b3272893b5a1,0x3327346235a12893,0x3327346235a12893,0xb4623327a89335a1
.quad 0x3400340034003400,0x3400340034003400,0xb4003400b4003400,0xb4003400b4003400,0xb55e2f2ab510b10e,0x2f2a355eb10e3510,0xaf2ab55e310eb510,0xb55e2f2ab510b10e,0x2a5eb59a359a2a5e,0xaa5e359ab59aaa5e,0x359a2a5eaa5e359a,0xb59aaa5e2a5eb59a,0x34a8326eb5902c13,0xb26e34a8ac13b590,0xb26e34a8ac13b590,0xb4a8b26e3590ac13
.quad 0xb4f5317534f5b175,0xb4f5317534f5b175,0xb175b4f5317534f5,0xb175b4f5317534f5,0xa338b5a7b3ad3428,0xb5a72338342833ad,0x35a7a338b428b3ad,0xa338b5a7b3ad3428,0x352830a630a6b528,0xb528b0a6b0a63528,0xb0a63528352830a6,0x30a6b528b528b0a6,0xb4623327a89335a1,0xb327b462b5a1a893,0xb327b462b5a1a893,0x3462b3272893b5a1
.quad 0,0,0,0,0,0,0,0,0,0,0,0,0,0,0,0
.quad 0,0,0,0,0,0,0,0,0,0,0,0,0,0,0,0
.quad 0,0,0,0,0,0,0,0,0,0,0,0,0,0,0,0
.quad 0,0,0,0,0,0,0,0,0,0,0,0,0,0,0,0
.quad 0x3400340034003400,0x3400340034003400,0xb4003400b4003400,0xb4003400b4003400,0x355caf3b35113106,0xaf3bb55c3106b511,0x2f3b355cb1063511,0x355caf3b35113106,0x2a17b59b359b2a17,0xaa17359bb59baa17,0x359b2a17aa17359b,0xb59baa172a17b59b,0xb4afb258358eac47,0x3258b4af2c47358e,0x3258b4af2c47358e,0x34af3258b58e2c47
.quad 0xb4ec319434ecb194,0xb4ec319434ecb194,0xb194b4ec319434ec,0xb194b4ec319434ec,0x24ff35a6338cb437,0x35a6a4ffb437b38c,0xb5a624ff3437338c,0x24ff35a6338cb437,0x353330753075b533,0xb533b075b0753533,0xb075353335333075,0x3075b533b533b075,0x344eb3562736b5a4,0x3356344e35a42736,0x3356344e35a42736,0xb44e3356a73635a4
.quad 0x3400340034003400,0x3400340034003400,0xb4003400b4003400,0xb4003400b4003400,0xb55c2f3bb511b106,0x2f3b355cb1063511,0xaf3bb55c3106b511,0xb55c2f3bb511b106,0x2a17b59b359b2a17,0xaa17359bb59baa17,0x359b2a17aa17359b,0xb59baa172a17b59b,0x34af3258b58e2c47,0xb25834afac47b58e,0xb25834afac47b58e,0xb4afb258358eac47
.quad 0xb4ec319434ecb194,0xb4ec319434ecb194,0xb194b4ec319434ec,0xb194b4ec319434ec,0xa4ffb5a6b38c3437,0xb5a624ff3437338c,0x35a6a4ffb437b38c,0xa4ffb5a6b38c3437,0x353330753075b533,0xb533b075b0753533,0xb075353335333075,0x3075b533b533b075,0xb44e3356a73635a4,0xb356b44eb5a4a736,0xb356b44eb5a4a736,0x344eb3562736b5a4
.quad 0,0,0,0,0,0,0,0,0,0,0,0,0,0,0,0
.quad 0,0,0,0,0,0,0,0,0,0,0,0,0,0,0,0
.quad 0,0,0,0,0,0,0,0,0,0,0,0,0,0,0,0
.quad 0,0,0,0,0,0,0,0,0,0,0,0,0,0,0,0
.quad 0x3400340034003400,0x3400340034003400,0xb4003400b4003400,0xb4003400b4003400,0x355baf4c351330fe,0xaf4cb55b30feb513,0x2f4c355bb0fe3513,0x355baf4c351330fe,0x29d1b59c359c29d1,0xa9d1359cb59ca9d1,0x359c29d1a9d1359c,0xb59ca9d129d1b59c,0xb4b7b242358bac7c,0x3242b4b72c7c358b,0x3242b4b72c7c358b,0x34b73242b58b2c7c
.quad 0xb4e331b234e3b1b2,0xb4e331b234e3b1b2,0xb1b2b4e331b234e3,0xb1b2b4e331b234e3,0x266235a5336bb446,0x35a5a662b446b36b,0xb5a526623446336b,0x266235a5336bb446,0x353d30443044b53d,0xb53db044b044353d,0xb044353d353d3044,0x3044b53db53db044,0x343ab3852546b5a6,0x3385343a35a62546,0x3385343a35a62546,0xb43a3385a54635a6
.quad 0x3400340034003400,0x3400340034003400,0xb4003400b4003400,0xb4003400b4003400,0xb55b2f4cb513b0fe,0x2f4c355bb0fe3513,0xaf4cb55b30feb513,0xb55b2f4cb513b0fe,0x29d1b59c359c29d1,0xa9d1359cb59ca9d1,0x359c29d1a9d1359c,0xb59ca9d129d1b59c,0x34b73242b58b2c7c,0xb24234b7ac7cb58b,0xb24234b7ac7cb58b,0xb4b7b242358bac7c
.quad 0xb4e331b234e3b1b2,0xb4e331b234e3b1b2,0xb1b2b4e331b234e3,0xb1b2b4e331b234e3,0xa662b5a5b36b3446,0xb5a526623446336b,0x35a5a662b446b36b,0xa662b5a5b36b3446,0x353d30443044b53d,0xb53db044b044353d,0xb044353d353d3044,0x3044b53db53db044,0xb43a3385a54635a6,0xb385b43ab5a6a546,0xb385b43ab5a6a546,0x343ab3852546b5a6
.quad 0,0,0,0,0,0,0,0,0,0,0,0,0,0,0,0
.quad 0,0,0,0,0,0,0,0,0,0,0,0,0,0,0,0
.quad 0,0,0,0,0,0,0,0,0,0,0,0,0,0,0,0
.quad 0,0,0,0,0,0,0,0,0,0,0,0,0,0,0,0
.quad 0x3400340034003400,0x3400340034003400,0xb4003400b4003400,0xb4003400b4003400,0x3559af5c351530f6,0xaf5cb55930f6b515,0x2f5c3559b0f63515,0x3559af5c351530f6,0x298ab59d359d298a,0xa98a359db59da98a,0x359d298aa98a359d,0xb59da98a298ab59d,0xb4beb22b3589acb0,0x322bb4be2cb03589,0x322bb4be2cb03589,0x34be322bb5892cb0
.quad 0xb4da31d134dab1d1,0xb4da31d134dab1d1,0xb1d1b4da31d134da,0xb1d1b4da31d134da,0x27c435a33349b454,0x35a3a7c4b454b349,0xb5a327c434543349,0x27c435a33349b454,0x354730123012b547,0xb547b012b0123547,0xb012354735473012,0x3012b547b547b012,0x3425b3b322aab5a7,0x33b3342535a722aa,0x33b3342535a722aa,0xb42533b3a2aa35a7
.quad 0x3400340034003400,0x3400340034003400,0xb4003400b4003400,0xb4003400b4003400,0xb5592f5cb515b0f6,0x2f5c3559b0f63515,0xaf5cb55930f6b515,0xb5592f5cb515b0f6,0x298ab59d359d298a,0xa98a359db59da98a,0x359d298aa98a359d,0xb59da98a298ab59d,0x34be322bb5892cb0,0xb22b34beacb0b589,0xb22b34beacb0b589,0xb4beb22b3589acb0
.quad 0xb4da31d134dab1d1,0xb4da31d134dab1d1,0xb1d1b4da31d134da,0xb1d1b4da31d134da,0xa7c4b5a3b3493454,0xb5a327c434543349,0x35a3a7c4b454b349,0xa7c4b5a3b3493454,0x354730123012b547,0xb547b012b0123547,0xb012354735473012,0x3012b547b547b012,0xb42533b3a2aa35a7,0xb3b3b425b5a7a2aa,0xb3b3b425b5a7a2aa,0x3425b3b322aab5a7
.quad 0,0,0,0,0,0,0,0,0,0,0,0,0,0,0,0
.quad 0,0,0,0,0,0,0,0,0,0,0,0,0,0,0,0
.quad 0,0,0,0,0,0,0,0,0,0,0,0,0,0,0,0
.quad 0,0,0,0,0,0,0,0,0,0,0,0,0,0,0,0
.quad 0x3400340034003400,0x3400340034003400,0xb4003400b4003400,0xb4003400b4003400,0x3558af6d351730ee,0xaf6db55830eeb517,0x2f6d3558b0ee3517,0x3558af6d351730ee,0x2944b59e359e2944,0xa944359eb59ea944,0x359e2944a944359e,0xb59ea9442944b59e,0xb4c5b2153586ace4,0x3215b4c52ce43586,0x3215b4c52ce43586,0x34c53215b5862ce4
.quad 0xb4d131ef34d1b1ef,0xb4d131ef34d1b1ef,0xb1efb4d131ef34d1,0xb1efb4d131ef34d1,0x289335a13327b462,0x35a1a893b462b327,0xb5a1289334623327,0x289335a13327b462,0x35502fc12fc1b550,0xb550afc1afc13550,0xafc1355035502fc1,0x2fc1b550b550afc1,0x3410b3e01d8eb5a8,0x33e0341035a81d8e,0x33e0341035a81d8e,0xb41033e09d8e35a8
.quad 0x3400340034003400,0x3400340034003400,0xb4003400b4003400,0xb4003400b4003400,0xb5582f6db517b0ee,0x2f6d3558b0ee3517,0xaf6db55830eeb517,0xb5582f6db517b0ee,0x2944b59e359e2944,0xa944359eb59ea944,0x359e2944a944359e,0xb59ea9442944b59e,0x34c53215b5862ce4,0xb21534c5ace4b586,0xb21534c5ace4b586,0xb4c5b2153586ace4
.quad 0xb4d131ef34d1b1ef,0xb4d131ef34d1b1ef,0xb1efb4d131ef34d1,0xb1efb4d131ef34d1,0xa893b5a1b3273462,0xb5a1289334623327,0x35a1a893b462b327,0xa893b5a1b3273462,0x35502fc12fc1b550,0xb550afc1afc13550,0xafc1355035502fc1,0x2fc1b550b550afc1,0xb41033e09d8e35a8,0xb3e0b410b5a89d8e,0xb3e0b410b5a89d8e,0x3410b3e01d8eb5a8
.quad 0,0,0,0,0,0,0,0,0,0,0,0,0,0,0,0
.quad 0,0,0,0,0,0,0,0,0,0,0,0,0,0,0,0
.quad 0,0,0,0,0,0,0,0,0,0,0,0,0,0,0,0
.quad 0,0,0,0,0,0,0,0,0,0,0,0,0,0,0,0
.quad 0x3400340034003400,0x3400340034003400,0xb4003400b4003400,0xb4003400b4003400,0x3556af7e351930e6,0xaf7eb55630e6b519,0x2f7e3556b0e63519,0x3556af7e351930e6,0x28fdb59f359f28fd,0xa8fd359fb59fa8fd,0x359f28fda8fd359f,0xb59fa8fd28fdb59f,0xb4ccb1fe3583ad18,0x31feb4cc2d183583,0x31feb4cc2d183583,0x34cc31feb5832d18
.quad 0xb4c7320e34c7b20e,0xb4c7320e34c7b20e,0xb20eb4c7320e34c7,0xb20eb4c7320e34c7,0x2944359e3304b470,0x359ea944b470b304,0xb59e294434703304,0x2944359e3304b470,0x35592f5c2f5cb559,0xb559af5caf5c3559,0xaf5c355935592f5c,0x2f5cb559b559af5c,0x33f3b4069871b5a8,0x340633f335a89871,0x340633f335a89871,0xb3f33406187135a8
.quad 0x3400340034003400,0x3400340034003400,0xb4003400b4003400,0xb4003400b4003400,0xb5562f7eb519b0e6,0x2f7e3556b0e63519,0xaf7eb55630e6b519,0xb5562f7eb519b0e6,0x28fdb59f359f28fd,0xa8fd359fb59fa8fd,0x359f28fda8fd359f,0xb59fa8fd28fdb59f,0x34cc31feb5832d18,0xb1fe34ccad18b583,0xb1fe34ccad18b583,0xb4ccb1fe3583ad18
.quad 0xb4c7320e34c7b20e,0xb4c7320e34c7b20e,0xb20eb4c7320e34c7,0xb20eb4c7320e34c7,0xa944b59eb3043470,0xb59e294434703304,0x359ea944b470b304,0xa944b59eb3043470,0x35592f5c2f5cb559,0xb559af5caf5c3559,0xaf5c355935592f5c,0x2f5cb559b559af5c,0xb3f33406187135a8,0xb406b3f3b5a81871,0xb406b3f3b5a81871,0x33f3b4069871b5a8
.quad 0,0,0,0,0,0,0,0,0,0,0,0,0,0,0,0
.quad 0,0,0,0,0,0,0,0,0,0,0,0,0,0,0,0
.quad 0,0,0,0,0,0,0,0,0,0,0,0,0,0,0,0
.quad 0,0,0,0,0,0,0,0,0,0,0,0,0,0,0,0
.quad 0x3400340034003400,0x3400340034003400,0xb4003400b4003400,0xb4003400b4003400,0x3555af8f351b30de,0xaf8fb55530deb51b,0x2f8f3555b0de351b,0x3555af8f351b30de,0x28b6b5a035a028b6,0xa8b635a0b5a0a8b6,0x35a028b6a8b635a0,0xb5a0a8b628b6b5a0,0xb4d3b1e83580ad4c,0x31e8b4d32d4c3580,0x31e8b4d32d4c3580,0x34d331e8b5802d4c
.quad 0xb4be322b34beb22b,0xb4be322b34beb22b,0xb22bb4be322b34be,0xb22bb4be322b34be,0x29f4359c32e1b47e,0x359ca9f4b47eb2e1,0xb59c29f4347e32e1,0x29f4359c32e1b47e,0x35622ef72ef7b562,0xb562aef7aef73562,0xaef7356235622ef7,0x2ef7b562b562aef7,0x33c7b41ca0ffb5a8,0x341c33c735a8a0ff,0x341c33c735a8a0ff,0xb3c7341c20ff35a8
.quad 0x3400340034003400,0x3400340034003400,0xb4003400b4003400,0xb4003400b4003400,0xb5552f8fb51bb0de,0x2f8f3555b0de351b,0xaf8fb55530deb51b,0xb5552f8fb51bb0de,0x28b6b5a035a028b6,0xa8b635a0b5a0a8b6,0x35a028b6a8b635a0,0xb5a0a8b628b6b5a0,0x34d331e8b5802d4c,0xb1e834d3ad4cb580,0xb1e834d3ad4cb580,0xb4d3b1e83580ad4c
.quad 0xb4be322b34beb22b,0xb4be322b34beb22b,0xb22bb4be322b34be,0xb22bb4be322b34be,0xa9f4b59cb2e1347e,0xb59c29f4347e32e1,0x359ca9f4b47eb2e1,0xa9f4b59cb2e1347e,0x35622ef72ef7b562,0xb562aef7aef73562,0xaef7356235622ef7,0x2ef7b562b562aef7,0xb3c7341c20ff35a8,0xb41cb3c7b5a820ff,0xb41cb3c7b5a820ff,0x33c7b41ca0ffb5a8
.quad 0,0,0,0,0,0,0,0,0,0,0,0,0,0,0,0
.quad 0,0,0,0,0,0,0,0,0,0,0,0,0,0,0,0
.quad 0,0,0,0,0,0,0,0,0,0,0,0,0,0,0,0
.quad 0,0,0,0,0,0,0,0,0,0,0,0,0,0,0,0
.quad 0x3400340034003400,0x3400340034003400,0xb4003400b4003400,0xb4003400b4003400,0x3554af9f351d30d6,0xaf9fb55430d6b51d,0x2f9f3554b0d6351d,0x3554af9f351d30d6,0x2870b5a135a12870,0xa87035a1b5a1a870,0x35a12870a87035a1,0xb5a1a8702870b5a1,0xb4dab1d1357dad7f,0x31d1b4da2d7f357d,0x31d1b4da2d7f357d,0x34da31d1b57d2d7f
.quad 0xb4b4324934b4b249,0xb4b4324934b4b249,0xb249b4b4324934b4,0xb249b4b4324934b4,0x2aa4359832bdb48b,0x3598aaa4b48bb2bd,0xb5982aa4348b32bd,0x2aa4359832bdb48b,0x356a2e922e92b56a,0xb56aae92ae92356a,0xae92356a356a2e92,0x2e92b56ab56aae92,0x3399b431a471b5a6,0x3431339935a6a471,0x3431339935a6a471,0xb3993431247135a6
.quad 0x3400340034003400,0x3400340034003400,0xb4003400b4003400,0xb4003400b4003400,0xb5542f9fb51db0d6,0x2f9f3554b0d6351d,0xaf9fb55430d6b51d,0xb5542f9fb51db0d6,0x2870b5a135a12870,0xa87035a1b5a1a870,0x35a12870a87035a1,0xb5a1a8702870b5a1,0x34da31d1b57d2d7f,0xb1d134daad7fb57d,0xb1d134daad7fb57d,0xb4dab1d1357dad7f
.quad 0xb4b4324934b4b249,0xb4b4324934b4b249,0xb249b4b4324934b4,0xb249b4b4324934b4,0xaaa4b598b2bd348b,0xb5982aa4348b32bd,0x3598aaa4b48bb2bd,0xaaa4b598b2bd348b,0x356a2e922e92b56a,0xb56aae92ae92356a,0xae92356a356a2e92,0x2e92b56ab56aae92,0xb3993431247135a6,0xb431b399b5a62471,0xb431b399b5a62471,0x3399b431a471b5a6
.quad 0,0,0,0,0,0,0,0,0,0,0,0,0,0,0,0
.quad 0,0,0,0,0,0,0,0,0,0,0,0,0,0,0,0
.quad 0,0,0,0,0,0,0,0,0,0,0,0,0,0,0,0
.quad 0,0,0,0,0,0,0,0,0,0,0,0,0,0,0,0
.quad 0x3400340034003400,0x3400340034003400,0xb4003400b4003400,0xb4003400b4003400,0x3552afb0351f30ce,0xafb0b55230ceb51f,0x2fb03552b0ce351f,0x3552afb0351f30ce,0x2829b5a235a22829,0xa82935a2b5a2a829,0x35a22829a82935a2,0xb5a2a8292829b5a2,0xb4e1b1ba3579adb3,0x31bab4e12db33579,0x31bab4e12db33579,0x34e131bab5792db3
.quad 0xb4aa326734aab267,0xb4aa326734aab267,0xb267b4aa326734aa,0xb267b4aa326734aa,0x2b5335953299b498,0x3595ab53b498b299,0xb5952b5334983299,0x2b5335953299b498,0x35712e2b2e2bb571,0xb571ae2bae2b3571,0xae2b357135712e2b,0x2e2bb571b571ae2b,0x336bb446a662b5a5,0x3446336b35a5a662,0x3446336b35a5a662,0xb36b3446266235a5
.quad 0x3400340034003400,0x3400340034003400,0xb4003400b4003400,0xb4003400b4003400,0xb5522fb0b51fb0ce,0x2fb03552b0ce351f,0xafb0b55230ceb51f,0xb5522fb0b51fb0ce,0x2829b5a235a22829,0xa82935a2b5a2a829,0x35a22829a82935a2,0xb5a2a8292829b5a2,0x34e131bab5792db3,0xb1ba34e1adb3b579,0xb1ba34e1adb3b579,0xb4e1b1ba3579adb3
.quad 0xb4aa326734aab267,0xb4aa326734aab267,0xb267b4aa326734aa,0xb267b4aa326734aa,0xab53b595b2993498,0xb5952b5334983299,0x3595ab53b498b299,0xab53b595b2993498,0x35712e2b2e2bb571,0xb571ae2bae2b3571,0xae2b357135712e2b,0x2e2bb571b571ae2b,0xb36b3446266235a5,0xb446b36bb5a52662,0xb446b36bb5a52662,0x336bb446a662b5a5
.quad 0,0,0,0,0,0,0,0,0,0,0,0,0,0,0,0
.quad 0,0,0,0,0,0,0,0,0,0,0,0,0,0,0,0
.quad 0,0,0,0,0,0,0,0,0,0,0,0,0,0,0,0
.quad 0,0,0,0,0,0,0,0,0,0,0,0,0,0,0,0
.quad 0x3400340034003400,0x3400340034003400,0xb4003400b4003400,0xb4003400b4003400,0x3550afc1352130c6,0xafc1b55030c6b521,0x2fc13550b0c63521,0x3550afc1352130c6,0x27c4b5a335a327c4,0xa7c435a3b5a3a7c4,0x35a327c4a7c435a3,0xb5a3a7c427c4b5a3,0xb4e8b1a33576ade7,0x31a3b4e82de73576,0x31a3b4e82de73576,0x34e831a3b5762de7
.quad 0xb4a0328434a0b284,0xb4a0328434a0b284,0xb284b4a0328434a0,0xb284b4a0328434a0,0x2c0135913275b4a5,0x3591ac01b4a5b275,0xb5912c0134a53275,0x2c0135913275b4a5,0x35782dc42dc4b578,0xb578adc4adc43578,0xadc4357835782dc4,0x2dc4b578b578adc4,0x333bb45aa829b5a2,0x345a333b35a2a829,0x345a333b35a2a829,0xb33b345a282935a2
.quad 0x3400340034003400,0x3400340034003400,0xb4003400b4003400,0xb4003400b4003400,0xb5502fc1b521b0c6,0x2fc13550b0c63521,0xafc1b55030c6b521,0xb5502fc1b521b0c6,0x27c4b5a335a327c4,0xa7c435a3b5a3a7c4,0x35a327c4a7c435a3,0xb5a3a7c427c4b5a3,0x34e831a3b5762de7,0xb1a334e8ade7b576,0xb1a334e8ade7b576,0xb4e8b1a33576ade7
.quad 0xb4a0328434a0b284,0xb4a0328434a0b284,0xb284b4a0328434a0,0xb284b4a0328434a0,0xac01b591b27534a5,0xb5912c0134a53275,0x3591ac01b4a5b275,0xac01b591b27534a5,0x35782dc42dc4b578,0xb578adc4adc43578,0xadc4357835782dc4,0x2dc4b578b578adc4,0xb33b345a282935a2,0xb45ab33bb5a22829,0xb45ab33bb5a22829,0x333bb45aa829b5a2
.quad 0,0,0,0,0,0,0,0,0,0,0,0,0,0,0,0
.quad 0,0,0,0,0,0,0,0,0,0,0,0,0,0,0,0
.quad 0,0,0,0,0,0,0,0,0,0,0,0,0,0,0,0
.quad 0,0,0,0,0,0,0,0,0,0,0,0,0,0,0,0
.quad 0x3400340034003400,0x3400340034003400,0xb4003400b4003400,0xb4003400b4003400,0x354fafd2352330be,0xafd2b54f30beb523,0x2fd2354fb0be3523,0x354fafd2352330be,0x2736b5a435a42736,0xa73635a4b5a4a736,0x35a42736a73635a4,0xb5a4a7362736b5a4,0xb4eeb18c3573ae1a,0x318cb4ee2e1a3573,0x318cb4ee2e1a3573,0x34ee318cb5732e1a
.quad 0xb49632a13496b2a1,0xb49632a13496b2a1,0xb2a1b49632a13496,0xb2a1b49632a13496,0x2c59358d3250b4b2,0x358dac59b4b2b250,0xb58d2c5934b23250,0x2c59358d3250b4b2,0x357f2d5d2d5db57f,0xb57fad5dad5d357f,0xad5d357f357f2d5d,0x2d5db57fb57fad5d,0x330bb46da920b59f,0x346d330b359fa920,0x346d330b359fa920,0xb30b346d2920359f
.quad 0x3400340034003400,0x3400340034003400,0xb4003400b4003400,0xb4003400b4003400,0xb54f2fd2b523b0be,0x2fd2354fb0be3523,0xafd2b54f30beb523,0xb54f2fd2b523b0be,0x2736b5a435a42736,0xa73635a4b5a4a736,0x35a42736a73635a4,0xb5a4a7362736b5a4,0x34ee318cb5732e1a,0xb18c34eeae1ab573,0xb18c34eeae1ab573,0xb4eeb18c3573ae1a
.quad 0xb49632a13496b2a1,0xb49632a13496b2a1,0xb2a1b49632a13496,0xb2a1b49632a13496,0xac59b58db25034b2,0xb58d2c5934b23250,0x358dac59b4b2b250,0xac59b58db25034b2,0x357f2d5d2d5db57f,0xb57fad5dad5d357f,0xad5d357f357f2d5d,0x2d5db57fb57fad5d,0xb30b346d2920359f,0xb46db30bb59f2920,0xb46db30bb59f2920,0x330bb46da920b59f
.quad 0,0,0,0,0,0,0,0,0,0,0,0,0,0,0,0
.quad 0,0,0,0,0,0,0,0,0,0,0,0,0,0,0,0
.quad 0,0,0,0,0,0,0,0,0,0,0,0,0,0,0,0
.quad 0,0,0,0,0,0,0,0,0,0,0,0,0,0,0,0
.quad 0x3400340034003400,0x3400340034003400,0xb4003400b4003400,0xb4003400b4003400,0x354dafe2352530b6,0xafe2b54d30b6b525,0x2fe2354db0b63525,0x354dafe2352530b6,0x26a9b5a435a426a9,0xa6a935a4b5a4a6a9,0x35a426a9a6a935a4,0xb5a4a6a926a9b5a4,0xb4f5b175356fae4d,0x3175b4f52e4d356f,0x3175b4f52e4d356f,0x34f53175b56f2e4d
.quad 0xb48b32bd348bb2bd,0xb48b32bd348bb2bd,0xb2bdb48b32bd348b,0xb2bdb48b32bd348b,0x2cb03589322bb4be,0x3589acb0b4beb22b,0xb5892cb034be322b,0x2cb03589322bb4be,0x35852cf52cf5b585,0xb585acf5acf53585,0xacf5358535852cf5,0x2cf5b585b585acf5,0x32dab480aa17b59b,0x348032da359baa17,0x348032da359baa17,0xb2da34802a17359b
.quad 0x3400340034003400,0x3400340034003400,0xb4003400b4003400,0xb4003400b4003400,0xb54d2fe2b525b0b6,0x2fe2354db0b63525,0xafe2b54d30b6b525,0xb54d2fe2b525b0b6,0x26a9b5a435a426a9,0xa6a935a4b5a4a6a9,0x35a426a9a6a935a4,0xb5a4a6a926a9b5a4,0x34f53175b56f2e4d,0xb17534f5ae4db56f,0xb17534f5ae4db56f,0xb4f5b175356fae4d
.quad 0xb48b32bd348bb2bd,0xb48b32bd348bb2bd,0xb2bdb48b32bd348b,0xb2bdb48b32bd348b,0xacb0b589b22b34be,0xb5892cb034be322b,0x3589acb0b4beb22b,0xacb0b589b22b34be,0x35852cf52cf5b585,0xb585acf5acf53585,0xacf5358535852cf5,0x2cf5b585b585acf5,0xb2da34802a17359b,0xb480b2dab59b2a17,0xb480b2dab59b2a17,0x32dab480aa17b59b
.quad 0,0,0,0,0,0,0,0,0,0,0,0,0,0,0,0
.quad 0,0,0,0,0,0,0,0,0,0,0,0,0,0,0,0
.quad 0,0,0,0,0,0,0,0,0,0,0,0,0,0,0,0
.quad 0,0,0,0,0,0,0,0,0,0,0,0,0,0,0,0
.quad 0x3400340034003400,0x3400340034003400,0xb4003400b4003400,0xb4003400b4003400,0x354caff3352630ae,0xaff3b54c30aeb526,0x2ff3354cb0ae3526,0x354caff3352630ae,0x261bb5a535a5261b,0xa61b35a5b5a5a61b,0x35a5261ba61b35a5,0xb5a5a61b261bb5a5,0xb4fbb15d356bae80,0x315db4fb2e80356b,0x315db4fb2e80356b,0x34fb315db56b2e80
.quad 0xb48032da3480b2da,0xb48032da3480b2da,0xb2dab48032da3480,0xb2dab48032da3480,0x2d0735843206b4ca,0x3584ad07b4cab206,0xb5842d0734ca3206,0x2d0735843206b4ca,0x358b2c8d2c8db58b,0xb58bac8dac8d358b,0xac8d358b358b2c8d,0x2c8db58bb58bac8d,0x32a8b493ab0db596,0x349332a83596ab0d,0x349332a83596ab0d,0xb2a834932b0d3596
.quad 0x3400340034003400,0x3400340034003400,0xb4003400b4003400,0xb4003400b4003400,0xb54c2ff3b526b0ae,0x2ff3354cb0ae3526,0xaff3b54c30aeb526,0xb54c2ff3b526b0ae,0x261bb5a535a5261b,0xa61b35a5b5a5a61b,0x35a5261ba61b35a5,0xb5a5a61b261bb5a5,0x34fb315db56b2e80,0xb15d34fbae80b56b,0xb15d34fbae80b56b,0xb4fbb15d356bae80
.quad 0xb48032da3480b2da,0xb48032da3480b2da,0xb2dab48032da3480,0xb2dab48032da3480,0xad07b584b20634ca,0xb5842d0734ca3206,0x3584ad07b4cab206,0xad07b584b20634ca,0x358b2c8d2c8db58b,0xb58bac8dac8d358b,0xac8d358b358b2c8d,0x2c8db58bb58bac8d,0xb2a834932b0d3596,0xb493b2a8b5962b0d,0xb493b2a8b5962b0d,0x32a8b493ab0db596
.quad 0,0,0,0,0,0,0,0,0,0,0,0,0,0,0,0
.quad 0,0,0,0,0,0,0,0,0,0,0,0,0,0,0,0
.quad 0,0,0,0,0,0,0,0,0,0,0,0,0,0,0,0
.quad 0,0,0,0,0,0,0,0,0,0,0,0,0,0,0,0
.quad 0x3400340034003400,0x3400340034003400,0xb4003400b4003400,0xb4003400b4003400,0x354ab002352830a6,0xb002b54a30a6b528,0x3002354ab0a63528,0x354ab002352830a6,0x258db5a535a5258d,0xa58d35a5b5a5a58d,0x35a5258da58d35a5,0xb5a5a58d258db5a5,0xb501b1463567aeb3,0x3146b5012eb33567,0x3146b5012eb33567,0x35013146b5672eb3
.quad 0xb47632f63476b2f6,0xb47632f63476b2f6,0xb2f6b47632f63476,0xb2f6b47632f63476,0x2d5d357f31e0b4d6,0x357fad5db4d6b1e0,0xb57f2d5d34d631e0,0x2d5d357f31e0b4d6,0x35902c242c24b590,0xb590ac24ac243590,0xac24359035902c24,0x2c24b590b590ac24,0x3275b4a5ac01b591,0x34a532753591ac01,0x34a532753591ac01,0xb27534a52c013591
.quad 0x3400340034003400,0x3400340034003400,0xb4003400b4003400,0xb4003400b4003400,0xb54a3002b528b0a6,0x3002354ab0a63528,0xb002b54a30a6b528,0xb54a3002b528b0a6,0x258db5a535a5258d,0xa58d35a5b5a5a58d,0x35a5258da58d35a5,0xb5a5a58d258db5a5,0x35013146b5672eb3,0xb1463501aeb3b567,0xb1463501aeb3b567,0xb501b1463567aeb3
.quad 0xb47632f63476b2f6,0xb47632f63476b2f6,0xb2f6b47632f63476,0xb2f6b47632f63476,0xad5db57fb1e034d6,0xb57f2d5d34d631e0,0x357fad5db4d6b1e0,0xad5db57fb1e034d6,0x35902c242c24b590,0xb590ac24ac243590,0xac24359035902c24,0x2c24b590b590ac24,0xb27534a52c013591,0xb4a5b275b5912c01,0xb4a5b275b5912c01,0x3275b4a5ac01b591
.quad 0,0,0,0,0,0,0,0,0,0,0,0,0,0,0,0
.quad 0,0,0,0,0,0,0,0,0,0,0,0,0,0,0,0
.quad 0,0,0,0,0,0,0,0,0,0,0,0,0,0,0,0
.quad 0,0,0,0,0,0,0,0,0,0,0,0,0,0,0,0
.quad 0x3400340034003400,0x3400340034003400,0xb4003400b4003400,0xb4003400b4003400,0x3549b00a352a309e,0xb00ab549309eb52a,0x300a3549b09e352a,0x3549b00a352a309e,0x24ffb5a635a624ff,0xa4ff35a6b5a6a4ff,0x35a624ffa4ff35a6,0xb5a6a4ff24ffb5a6,0xb507b12e3563aee6,0x312eb5072ee63563,0x312eb5072ee63563,0x3507312eb5632ee6
.quad 0xb46b3312346bb312,0xb46b3312346bb312,0xb312b46b3312346b,0xb312b46b3312346b,0x2db3357931bab4e1,0x3579adb3b4e1b1ba,0xb5792db334e131ba,0x2db3357931bab4e1,0x35942b772b77b594,0xb594ab77ab773594,0xab77359435942b77,0x2b77b594b594ab77,0x3242b4b7ac7cb58b,0x34b73242358bac7c,0x34b73242358bac7c,0xb24234b72c7c358b
.quad 0x3400340034003400,0x3400340034003400,0xb4003400b4003400,0xb4003400b4003400,0xb549300ab52ab09e,0x300a3549b09e352a,0xb00ab549309eb52a,0xb549300ab52ab09e,0x24ffb5a635a624ff,0xa4ff35a6b5a6a4ff,0x35a624ffa4ff35a6,0xb5a6a4ff24ffb5a6,0x3507312eb5632ee6,0xb12e3507aee6b563,0xb12e3507aee6b563,0xb507b12e3563aee6
.quad 0xb46b3312346bb312,0xb46b3312346bb312,0xb312b46b3312346b,0xb312b46b3312346b,0xadb3b579b1ba34e1,0xb5792db334e131ba,0x3579adb3b4e1b1ba,0xadb3b579b1ba34e1,0x35942b772b77b594,0xb594ab77ab773594,0xab77359435942b77,0x2b77b594b594ab77,0xb24234b72c7c358b,0xb4b7b242b58b2c7c,0xb4b7b242b58b2c7c,0x3242b4b7ac7cb58b
.quad 0,0,0,0,0,0,0,0,0,0,0,0,0,0,0,0
.quad 0,0,0,0,0,0,0,0,0,0,0,0,0,0,0,0
.quad 0,0,0,0,0,0,0,0,0,0,0,0,0,0,0,0
.quad 0,0,0,0,0,0,0,0,0,0,0,0,0,0,0,0
.quad 0x3400340034003400,0x3400340034003400,0xb4003400b4003400,0xb4003400b4003400,0x3547b012352c3096,0xb012b5473096b52c,0x30123547b096352c,0x3547b012352c3096,0x2471b5a635a62471,0xa47135a6b5a6a471,0x35a62471a47135a6,0xb5a6a4712471b5a6,0xb50eb116355faf19,0x3116b50e2f19355f,0x3116b50e2f19355f,0x350e3116b55f2f19
.quad 0xb45f332d345fb32d,0xb45f332d345fb32d,0xb32db45f332d345f,0xb32db45f332d345f,0x2e0935743194b4ec,0x3574ae09b4ecb194,0xb5742e0934ec3194,0x2e0935743194b4ec,0x35982aa42aa4b598,0xb598aaa4aaa43598,0xaaa4359835982aa4,0x2aa4b598b598aaa4,0x320eb4c7acf5b585,0x34c7320e3585acf5,0x34c7320e3585acf5,0xb20e34c72cf53585
.quad 0x3400340034003400,0x3400340034003400,0xb4003400b4003400,0xb4003400b4003400,0xb5473012b52cb096,0x30123547b096352c,0xb012b5473096b52c,0xb5473012b52cb096,0x2471b5a635a62471,0xa47135a6b5a6a471,0x35a62471a47135a6,0xb5a6a4712471b5a6,0x350e3116b55f2f19,0xb116350eaf19b55f,0xb116350eaf19b55f,0xb50eb116355faf19
.quad 0xb45f332d345fb32d,0xb45f332d345fb32d,0xb32db45f332d345f,0xb32db45f332d345f,0xae09b574b19434ec,0xb5742e0934ec3194,0x3574ae09b4ecb194,0xae09b574b19434ec,0x35982aa42aa4b598,0xb598aaa4aaa43598,0xaaa4359835982aa4,0x2aa4b598b598aaa4,0xb20e34c72cf53585,0xb4c7b20eb5852cf5,0xb4c7b20eb5852cf5,0x320eb4c7acf5b585
.quad 0,0,0,0,0,0,0,0,0,0,0,0,0,0,0,0
.quad 0,0,0,0,0,0,0,0,0,0,0,0,0,0,0,0
.quad 0,0,0,0,0,0,0,0,0,0,0,0,0,0,0,0
.quad 0,0,0,0,0,0,0,0,0,0,0,0,0,0,0,0
.quad 0x3400340034003400,0x3400340034003400,0xb4003400b4003400,0xb4003400b4003400,0x3546b01b352e308e,0xb01bb546308eb52e,0x301b3546b08e352e,0x3546b01b352e308e,0x23c6b5a735a723c6,0xa3c635a7b5a7a3c6,0x35a723c6a3c635a7,0xb5a7a3c623c6b5a7,0xb513b0fe355baf4c,0x30feb5132f4c355b,0x30feb5132f4c355b,0x351330feb55b2f4c
.quad 0xb45433493454b349,0xb45433493454b349,0xb349b45433493454,0xb349b45433493454,0x2e5e356e316db4f7,0x356eae5eb4f7b16d,0xb56e2e5e34f7316d,0x2e5e356e316db4f7,0x359c29d129d1b59c,0xb59ca9d1a9d1359c,0xa9d1359c359c29d1,0x29d1b59cb59ca9d1,0x31d9b4d8ad6eb57e,0x34d831d9357ead6e,0x34d831d9357ead6e,0xb1d934d82d6e357e
.quad 0x3400340034003400,0x3400340034003400,0xb4003400b4003400,0xb4003400b4003400,0xb546301bb52eb08e,0x301b3546b08e352e,0xb01bb546308eb52e,0xb546301bb52eb08e,0x23c6b5a735a723c6,0xa3c635a7b5a7a3c6,0x35a723c6a3c635a7,0xb5a7a3c623c6b5a7,0x351330feb55b2f4c,0xb0fe3513af4cb55b,0xb0fe3513af4cb55b,0xb513b0fe355baf4c
.quad 0xb45433493454b349,0xb45433493454b349,0xb349b45433493454,0xb349b45433493454,0xae5eb56eb16d34f7,0xb56e2e5e34f7316d,0x356eae5eb4f7b16d,0xae5eb56eb16d34f7,0x359c29d129d1b59c,0xb59ca9d1a9d1359c,0xa9d1359c359c29d1,0x29d1b59cb59ca9d1,0xb1d934d82d6e357e,0xb4d8b1d9b57e2d6e,0xb4d8b1d9b57e2d6e,0x31d9b4d8ad6eb57e
.quad 0,0,0,0,0,0,0,0,0,0,0,0,0,0,0,0
.quad 0,0,0,0,0,0,0,0,0,0,0,0,0,0,0,0
.quad 0,0,0,0,0,0,0,0,0,0,0,0,0,0,0,0
.quad 0,0,0,0,0,0,0,0,0,0,0,0,0,0,0,0
.quad 0x3400340034003400,0x3400340034003400,0xb4003400b4003400,0xb4003400b4003400,0x3544b023352f3085,0xb023b5443085b52f,0x30233544b085352f,0x3544b023352f3085,0x22aab5a735a722aa,0xa2aa35a7b5a7a2aa,0x35a722aaa2aa35a7,0xb5a7a2aa22aab5a7,0xb519b0e63556af7e,0x30e6b5192f7e3556,0x30e6b5192f7e3556,0x351930e6b5562f7e
.quad 0xb44933643449b364,0xb44933643449b364,0xb364b44933643449,0xb364b44933643449,0x2eb335673146b501,0x3567aeb3b501b146,0xb5672eb335013146,0x2eb335673146b501,0x359f28fd28fdb59f,0xb59fa8fda8fd359f,0xa8fd359f359f28fd,0x28fdb59fb59fa8fd,0x31a3b4e8ade7b576,0x34e831a33576ade7,0x34e831a33576ade7,0xb1a334e82de73576
.quad 0x3400340034003400,0x3400340034003400,0xb4003400b4003400,0xb4003400b4003400,0xb5443023b52fb085,0x30233544b085352f,0xb023b5443085b52f,0xb5443023b52fb085,0x22aab5a735a722aa,0xa2aa35a7b5a7a2aa,0x35a722aaa2aa35a7,0xb5a7a2aa22aab5a7,0x351930e6b5562f7e,0xb0e63519af7eb556,0xb0e63519af7eb556,0xb519b0e63556af7e
.quad 0xb44933643449b364,0xb44933643449b364,0xb364b44933643449,0xb364b44933643449,0xaeb3b567b1463501,0xb5672eb335013146,0x3567aeb3b501b146,0xaeb3b567b1463501,0x359f28fd28fdb59f,0xb59fa8fda8fd359f,0xa8fd359f359f28fd,0x28fdb59fb59fa8fd,0xb1a334e82de73576,0xb4e8b1a3b5762de7,0xb4e8b1a3b5762de7,0x31a3b4e8ade7b576
.quad 0,0,0,0,0,0,0,0,0,0,0,0,0,0,0,0
.quad 0,0,0,0,0,0,0,0,0,0,0,0,0,0,0,0
.quad 0,0,0,0,0,0,0,0,0,0,0,0,0,0,0,0
.quad 0,0,0,0,0,0,0,0,0,0,0,0,0,0,0,0
.quad 0x3400340034003400,0x3400340034003400,0xb4003400b4003400,0xb4003400b4003400,0x3542b02b3531307d,0xb02bb542307db531,0x302b3542b07d3531,0x3542b02b3531307d,0x218db5a735a7218d,0xa18d35a7b5a7a18d,0x35a7218da18d35a7,0xb5a7a18d218db5a7,0xb51fb0ce3552afb0,0x30ceb51f2fb03552,0x30ceb51f2fb03552,0x351f30ceb5522fb0
.quad 0xb43d337f343db37f,0xb43d337f343db37f,0xb37fb43d337f343d,0xb37fb43d337f343d,0x2f083560311eb50c,0x3560af08b50cb11e,0xb5602f08350c311e,0x2f083560311eb50c,0x35a228292829b5a2,0xb5a2a829a82935a2,0xa82935a235a22829,0x2829b5a2b5a2a829,0x316db4f7ae5eb56e,0x34f7316d356eae5e,0x34f7316d356eae5e,0xb16d34f72e5e356e
.quad 0x3400340034003400,0x3400340034003400,0xb4003400b4003400,0xb4003400b4003400,0xb542302bb531b07d,0x302b3542b07d3531,0xb02bb542307db531,0xb542302bb531b07d,0x218db5a735a7218d,0xa18d35a7b5a7a18d,0x35a7218da18d35a7,0xb5a7a18d218db5a7,0x351f30ceb5522fb0,0xb0ce351fafb0b552,0xb0ce351fafb0b552,0xb51fb0ce3552afb0
.quad 0xb43d337f343db37f,0xb43d337f343db37f,0xb37fb43d337f343d,0xb37fb43d337f343d,0xaf08b560b11e350c,0xb5602f08350c311e,0x3560af08b50cb11e,0xaf08b560b11e350c,0x35a228292829b5a2,0xb5a2a829a82935a2,0xa82935a235a22829,0x2829b5a2b5a2a829,0xb16d34f72e5e356e,0xb4f7b16db56e2e5e,0xb4f7b16db56e2e5e,0x316db4f7ae5eb56e
.quad 0,0,0,0,0,0,0,0,0,0,0,0,0,0,0,0
.quad 0,0,0,0,0,0,0,0,0,0,0,0,0,0,0,0
.quad 0,0,0,0,0,0,0,0,0,0,0,0,0,0,0,0
.quad 0,0,0,0,0,0,0,0,0,0,0,0,0,0,0,0
.quad 0x3400340034003400,0x3400340034003400,0xb4003400b4003400,0xb4003400b4003400,0x3541b03335333075,0xb033b5413075b533,0x30333541b0753533,0x3541b03335333075,0x2071b5a835a82071,0xa07135a8b5a8a071,0x35a82071a07135a8,0xb5a8a0712071b5a8,0xb525b0b6354dafe2,0x30b6b5252fe2354d,0x30b6b5252fe2354d,0x352530b6b54d2fe2
.quad 0xb43133993431b399,0xb43133993431b399,0xb399b43133993431,0xb399b43133993431,0x2f5c355930f6b515,0x3559af5cb515b0f6,0xb5592f5c351530f6,0x2f5c355930f6b515,0x35a426a926a9b5a4,0xb5a4a6a9a6a935a4,0xa6a935a435a426a9,0x26a9b5a4b5a4a6a9,0x3136b505aed5b565,0x350531363565aed5,0x350531363565aed5,0xb13635052ed53565
.quad 0x3400340034003400,0x3400340034003400,0xb4003400b4003400,0xb4003400b4003400,0xb5413033b533b075,0x30333541b0753533,0xb033b5413075b533,0xb5413033b533b075,0x2071b5a835a82071,0xa07135a8b5a8a071,0x35a82071a07135a8,0xb5a8a0712071b5a8,0x352530b6b54d2fe2,0xb0b63525afe2b54d,0xb0b63525afe2b54d,0xb525b0b6354dafe2
.quad 0xb43133993431b399,0xb43133993431b399,0xb399b43133993431,0xb399b43133993431,0xaf5cb559b0f63515,0xb5592f5c351530f6,0x3559af5cb515b0f6,0xaf5cb559b0f63515,0x35a426a926a9b5a4,0xb5a4a6a9a6a935a4,0xa6a935a435a426a9,0x26a9b5a4b5a4a6a9,0xb13635052ed53565,0xb505b136b5652ed5,0xb505b136b5652ed5,0x3136b505aed5b565
.quad 0,0,0,0,0,0,0,0,0,0,0,0,0,0,0,0
.quad 0,0,0,0,0,0,0,0,0,0,0,0,0,0,0,0
.quad 0,0,0,0,0,0,0,0,0,0,0,0,0,0,0,0
.quad 0,0,0,0,0,0,0,0,0,0,0,0,0,0,0,0
.quad 0x3400340034003400,0x3400340034003400,0xb4003400b4003400,0xb4003400b4003400,0x353fb03c3535306d,0xb03cb53f306db535,0x303c353fb06d3535,0x353fb03c3535306d,0x1eaab5a835a81eaa,0x9eaa35a8b5a89eaa,0x35a81eaa9eaa35a8,0xb5a89eaa1eaab5a8,0xb52ab09e3549b00a,0x309eb52a300a3549,0x309eb52a300a3549,0x352a309eb549300a
.quad 0xb42533b33425b3b3,0xb42533b33425b3b3,0xb3b3b42533b33425,0xb3b3b42533b33425,0x2fb0355230ceb51f,0x3552afb0b51fb0ce,0xb5522fb0351f30ce,0x2fb0355230ceb51f,0x35a624ff24ffb5a6,0xb5a6a4ffa4ff35a6,0xa4ff35a635a624ff,0x24ffb5a6b5a6a4ff,0x30feb513af4cb55b,0x351330fe355baf4c,0x351330fe355baf4c,0xb0fe35132f4c355b
.quad 0x3400340034003400,0x3400340034003400,0xb4003400b4003400,0xb4003400b4003400,0xb53f303cb535b06d,0x303c353fb06d3535,0xb03cb53f306db535,0xb53f303cb535b06d,0x1eaab5a835a81eaa,0x9eaa35a8b5a89eaa,0x35a81eaa9eaa35a8,0xb5a89eaa1eaab5a8,0x352a309eb549300a,0xb09e352ab00ab549,0xb09e352ab00ab549,0xb52ab09e3549b00a
.quad 0xb42533b33425b3b3,0xb42533b33425b3b3,0xb3b3b42533b33425,0xb3b3b42533b33425,0xafb0b552b0ce351f,0xb5522fb0351f30ce,0x3552afb0b51fb0ce,0xafb0b552b0ce351f,0x35a624ff24ffb5a6,0xb5a6a4ffa4ff35a6,0xa4ff35a635a624ff,0x24ffb5a6b5a6a4ff,0xb0fe35132f4c355b,0xb513b0feb55b2f4c,0xb513b0feb55b2f4c,0x30feb513af4cb55b
.quad 0,0,0,0,0,0,0,0,0,0,0,0,0,0,0,0
.quad 0,0,0,0,0,0,0,0,0,0,0,0,0,0,0,0
.quad 0,0,0,0,0,0,0,0,0,0,0,0,0,0,0,0
.quad 0,0,0,0,0,0,0,0,0,0,0,0,0,0,0,0
.quad 0x3400340034003400,0x3400340034003400,0xb4003400b4003400,0xb4003400b4003400,0x353db04435363065,0xb044b53d3065b536,0x3044353db0653536,0x353db04435363065,0x1c71b5a835a81c71,0x9c7135a8b5a89c71,0x35a81c719c7135a8,0xb5a89c711c71b5a8,0xb52fb0853544b023,0x3085b52f30233544,0x3085b52f30233544,0x352f3085b5443023
.quad 0xb41933cd3419b3cd,0xb41933cd3419b3cd,0xb3cdb41933cd3419,0xb3cdb41933cd3419,0x3002354a30a6b528,0x354ab002b528b0a6,0xb54a3002352830a6,0x3002354a30a6b528,0x35a722aa22aab5a7,0xb5a7a2aaa2aa35a7,0xa2aa35a735a722aa,0x22aab5a7b5a7a2aa,0x30c6b521afc1b550,0x352130c63550afc1,0x352130c63550afc1,0xb0c635212fc13550
.quad 0x3400340034003400,0x3400340034003400,0xb4003400b4003400,0xb4003400b4003400,0xb53d3044b536b065,0x3044353db0653536,0xb044b53d3065b536,0xb53d3044b536b065,0x1c71b5a835a81c71,0x9c7135a8b5a89c71,0x35a81c719c7135a8,0xb5a89c711c71b5a8,0x352f3085b5443023,0xb085352fb023b544,0xb085352fb023b544,0xb52fb0853544b023
.quad 0xb41933cd3419b3cd,0xb41933cd3419b3cd,0xb3cdb41933cd3419,0xb3cdb41933cd3419,0xb002b54ab0a63528,0xb54a3002352830a6,0x354ab002b528b0a6,0xb002b54ab0a63528,0x35a722aa22aab5a7,0xb5a7a2aaa2aa35a7,0xa2aa35a735a722aa,0x22aab5a7b5a7a2aa,0xb0c635212fc13550,0xb521b0c6b5502fc1,0xb521b0c6b5502fc1,0x30c6b521afc1b550
.quad 0,0,0,0,0,0,0,0,0,0,0,0,0,0,0,0
.quad 0,0,0,0,0,0,0,0,0,0,0,0,0,0,0,0
.quad 0,0,0,0,0,0,0,0,0,0,0,0,0,0,0,0
.quad 0,0,0,0,0,0,0,0,0,0,0,0,0,0,0,0
.quad 0x3400340034003400,0x3400340034003400,0xb4003400b4003400,0xb4003400b4003400,0x353cb04c3538305d,0xb04cb53c305db538,0x304c353cb05d3538,0x353cb04c3538305d,0x1871b5a835a81871,0x987135a8b5a89871,0x35a81871987135a8,0xb5a898711871b5a8,0xb535b06d353fb03c,0x306db535303c353f,0x306db535303c353f,0x3535306db53f303c
.quad 0xb40c33e7340cb3e7,0xb40c33e7340cb3e7,0xb3e7b40c33e7340c,0xb3e7b40c33e7340c,0x302b3542307db531,0x3542b02bb531b07d,0xb542302b3531307d,0x302b3542307db531,0x35a81eaa1eaab5a8,0xb5a89eaa9eaa35a8,0x9eaa35a835a81eaa,0x1eaab5a8b5a89eaa,0x308eb52eb01bb546,0x352e308e3546b01b,0x352e308e3546b01b,0xb08e352e301b3546
.quad 0x3400340034003400,0x3400340034003400,0xb4003400b4003400,0xb4003400b4003400,0xb53c304cb538b05d,0x304c353cb05d3538,0xb04cb53c305db538,0xb53c304cb538b05d,0x1871b5a835a81871,0x987135a8b5a89871,0x35a81871987135a8,0xb5a898711871b5a8,0x3535306db53f303c,0xb06d3535b03cb53f,0xb06d3535b03cb53f,0xb535b06d353fb03c
.quad 0xb40c33e7340cb3e7,0xb40c33e7340cb3e7,0xb3e7b40c33e7340c,0xb3e7b40c33e7340c,0xb02bb542b07d3531,0xb542302b3531307d,0x3542b02bb531b07d,0xb02bb542b07d3531,0x35a81eaa1eaab5a8,0xb5a89eaa9eaa35a8,0x9eaa35a835a81eaa,0x1eaab5a8b5a89eaa,0xb08e352e301b3546,0xb52eb08eb546301b,0xb52eb08eb546301b,0x308eb52eb01bb546
.quad 0,0,0,0,0,0,0,0,0,0,0,0,0,0,0,0
.quad 0,0,0,0,0,0,0,0,0,0,0,0,0,0,0,0
.quad 0,0,0,0,0,0,0,0,0,0,0,0,0,0,0,0
.quad 0,0,0,0,0,0,0,0,0,0,0,0,0,0,0,0
```

```asm
; @launch grid=(256,1,1) block=(512,1,1) lds=159552
.amdgcn_target "amdgcn-amd-amdhsa--gfx950"
.text
.globl parallel_sum__spectral_fnet__moe_arch_mod__prompt_kernel
.p2align 8
.type parallel_sum__spectral_fnet__moe_arch_mod__prompt_kernel,@function
parallel_sum__spectral_fnet__moe_arch_mod__prompt_kernel:
  s_load_dwordx2 s[4:5], s[0:1], 0
  s_load_dwordx2 s[8:9], s[0:1], 96
  s_load_dwordx2 s[12:13], s[0:1], 80
  s_getpc_b64 s[26:27]
L_pc:
  s_add_u32 s16, s26, L_tab@rel32@lo+4
  s_addc_u32 s17, s27, L_tab@rel32@hi+12
  v_lshrrev_b32 v3, 6, v0
  v_and_b32 v1, 63, v0
  s_mov_b32 s7, 0x20000
  v_readfirstlane_b32 s3, v3
  s_mov_b32 s11, 0x20000
  s_mov_b32 s19, 0x20000
  s_mov_b32 s23, 0x20000
  v_lshlrev_b32 v2, 4, v1
  s_mov_b32 s18, 85888
  s_cmp_ge_u32 s2, 128
  s_cbranch_scc1 L_ffn0
  s_load_dwordx2 s[20:21], s[0:1], 48
  s_mov_b32 s47, s2
  s_and_b32 s30, s2, 7
  s_sub_u32 s31, 16, s30
  s_cmp_eq_u32 s30, 0
  s_cselect_b32 s31, 8, s31
  s_bitcmp1_b32 s2, 3
  s_cselect_b32 s30, s31, s30
  s_and_b32 s2, s2, 0x70
  s_or_b32 s2, s2, s30
  s_mov_b32 s18, 217088
  s_lshl_b32 s30, s3, 8
  v_and_b32 v16, 15, v1
  v_lshrrev_b32 v17, 4, v1
  v_cmp_eq_u32 vcc, 4, v16
  v_mov_b32 v64, 0x3f803f80
  v_lshl_add_u32 v18, v17, 4, s30
  s_add_u32 s30, s30, s2
  s_cmp_eq_u32 s2, 0
  s_cselect_b32 s32, 896, 0
  v_cndmask_b32_e64 v32, 0, v64, vcc
  s_cmp_ge_u32 s3, 4
  s_cselect_b32 s32, s32, 0
  s_sub_u32 s30, s30, s32
  s_sub_u32 s31, 2048, s30
  s_cmp_eq_u32 s30, 0
  s_cselect_b32 s31, 1024, s31
  s_lshl_b32 s32, s30, 11
  s_lshl_b32 s33, s31, 11
  s_mul_i32 s34, s3, 4128
  s_mov_b32 s6, 0x400000
  s_mov_b32 s22, 2048
  s_lshl_b32 s38, s3, 9
  s_add_u32 m0, s38, 35328
  s_mov_b32 exec_hi, 0
  buffer_load_dwordx4 v2, s[16:19], s38 offen lds
  s_mov_b32 exec_hi, -1
  s_lshl_b32 s46, s3, 11
  s_add_u32 s39, s46, 39424
  s_add_u32 s46, s46, 4096
  s_cmp_eq_u32 s2, 0
  s_cselect_b32 s37, 2048, 0
  s_add_u32 s37, s37, s46
  s_cmp_eq_u32 s3, 6
  s_cselect_b32 s46, s37, s46
  s_lshl_b32 s37, s2, 10
  s_add_u32 s37, s37, 86016
  s_cmp_eq_u32 s3, 7
  s_cselect_b32 s46, s37, s46
  s_mov_b32 m0, s39
  s_nop 0
  buffer_load_dwordx4 v2, s[16:19], s46 offen lds
  buffer_load_dwordx4 v2, s[16:19], s46 offen offset:1024 lds
  v_mov_b32 v33, v32
  v_mov_b32 v34, v32
  v_mov_b32 v35, v32
  v_mov_b32 v36, v32
  v_mov_b32 v37, v32
  v_mov_b32 v38, v32
  v_mov_b32 v39, v32
  v_mov_b32 v40, v32
  v_mov_b32 v41, v32
  v_mov_b32 v42, v32
  v_mov_b32 v43, v32
  v_mov_b32 v44, v32
  v_mov_b32 v45, v32
  v_mov_b32 v46, v32
  v_mov_b32 v47, v32
  s_mov_b32 m0, s34
  s_waitcnt lgkmcnt(0)
  s_mov_b32 exec_lo, 0x01010101
  s_mov_b32 exec_hi, 0x01010101
  buffer_load_dwordx4 v[32:35], v18, s[20:23], 0 offen offset:0
  buffer_load_dwordx4 v[36:39], v18, s[20:23], 0 offen offset:64
  buffer_load_dwordx4 v[40:43], v18, s[20:23], 0 offen offset:128
  buffer_load_dwordx4 v[44:47], v18, s[20:23], 0 offen offset:192
  s_mov_b64 exec, -1
  buffer_load_dwordx4 v2, s[4:7], s32 offen lds
  buffer_load_dwordx4 v2, s[4:7], s32 offen offset:1024 lds
  s_add_u32 m0, m0, 2064
  s_load_dword s24, s[8:9], 0
  buffer_load_dwordx4 v2, s[4:7], s33 offen lds
  buffer_load_dwordx4 v2, s[4:7], s33 offen offset:1024 lds
  s_branch L_fft1
L_ffn0:
  s_cmp_ge_u32 s2, 256
  s_cbranch_scc1 L_end
  s_sub_u32 s30, s2, 128
  s_lshr_b32 s31, s30, 3
  s_lshl_b32 s31, s31, 13
  s_sub_u32 s32, s31, 16384
  s_cselect_b32 s31, s31, s32
  s_cselect_b64 s[16:17], s[26:27], s[16:17]
  s_cselect_b32 s32, L_end-L_pc, s18
  v_and_b32 v4, 0x1f8, v0
  v_lshl_add_u32 v4, v4, 4, s31
  v_min_u32 v4, s32, v4
  global_load_dword v57, v4, s[16:17]
  s_load_dwordx2 s[38:39], s[0:1], 48
  v_and_b32 v58, 0x7f0, v0
  v_lshlrev_b32 v58, 2, v58
  s_load_dwordx4 s[16:19], s[0:1], 56
  s_load_dwordx2 s[40:41], s[0:1], 72
  s_lshr_b32 s31, s30, 4
  s_and_b32 s32, s30, 15
  s_lshl_b32 s33, s32, 3
  s_add_u32 s33, s33, s3
  s_mul_i32 s33, s33, 57344
  s_mul_i32 s34, s31, 896
  s_add_u32 s33, s33, s34
  s_and_b32 s34, s3, 3
  s_mul_i32 s34, s34, 3712
  s_lshr_b32 s35, s3, 2
  s_mul_i32 s35, s35, 29696
  s_add_u32 m0, s34, s35
  s_mov_b32 s22, 7340032
  s_mov_b32 exec_hi, 0x00ffffff
  s_waitcnt lgkmcnt(0)
  s_mov_b64 s[20:21], s[18:19]
  s_mov_b32 s18, 7340032
  s_mov_b32 s19, 0x20000
  s_load_dword s24, s[8:9], 0
  s_cmp_lt_u32 s30, 8
  s_cbranch_scc0 L_npr
  global_load_dword v59, v58, s[38:39]
L_npr:
  s_waitcnt vmcnt(0)
  buffer_load_dwordx4 v2, s[16:19], s33 offen nt lds
  s_add_u32 m0, m0, 59392
  s_nop 0
  buffer_load_dwordx4 v2, s[20:23], s33 offen nt lds
  s_sub_u32 m0, m0, 58464
  s_add_u32 s33, s33, 7168
  buffer_load_dwordx4 v2, s[16:19], s33 offen nt lds
  s_add_u32 m0, m0, 59392
  s_nop 0
  buffer_load_dwordx4 v2, s[20:23], s33 offen nt lds
  s_sub_u32 m0, m0, 58464
  s_add_u32 s33, s33, 7168
  buffer_load_dwordx4 v2, s[16:19], s33 offen nt lds
  s_add_u32 m0, m0, 59392
  s_nop 0
  buffer_load_dwordx4 v2, s[20:23], s33 offen nt lds
  s_sub_u32 m0, m0, 58464
  s_add_u32 s33, s33, 7168
  buffer_load_dwordx4 v2, s[16:19], s33 offen nt lds
  s_add_u32 m0, m0, 59392
  s_nop 0
  buffer_load_dwordx4 v2, s[20:23], s33 offen nt lds
  s_sub_u32 m0, m0, 47328
  s_add_u32 s33, s33, 7168
  buffer_load_dwordx4 v2, s[16:19], s33 offen nt lds
  s_add_u32 m0, m0, 59392
  s_nop 0
  buffer_load_dwordx4 v2, s[20:23], s33 offen nt lds
  s_sub_u32 m0, m0, 58464
  s_add_u32 s33, s33, 7168
  buffer_load_dwordx4 v2, s[16:19], s33 offen nt lds
  s_add_u32 m0, m0, 59392
  s_nop 0
  buffer_load_dwordx4 v2, s[20:23], s33 offen nt lds
  s_sub_u32 m0, m0, 58464
  s_add_u32 s33, s33, 7168
  buffer_load_dwordx4 v2, s[16:19], s33 offen nt lds
  s_add_u32 m0, m0, 59392
  s_nop 0
  buffer_load_dwordx4 v2, s[20:23], s33 offen nt lds
  s_sub_u32 m0, m0, 58464
  s_add_u32 s33, s33, 7168
  buffer_load_dwordx4 v2, s[16:19], s33 offen nt lds
  s_add_u32 m0, m0, 59392
  s_nop 0
  buffer_load_dwordx4 v2, s[20:23], s33 offen nt lds
  s_mov_b32 exec_hi, -1
  s_branch L_ffn1
L_fft1:
  s_bfe_u32 s41, s2, 0x10003
  s_load_dwordx2 s[30:31], s[0:1], 72
  s_min_u32 s36, s47, 111
  s_lshl_b32 s36, s36, 16
  s_lshr_b32 s37, s3, 1
  s_lshl_b32 s37, s37, 14
  s_add_u32 s36, s36, s37
  s_and_b32 s37, s3, 1
  s_lshl_b32 s37, s37, 12
  s_add_u32 s36, s36, s37
  v_and_b32 v19, 1, v17
  v_and_b32 v20, 2, v17
  v_lshl_add_u32 v3, v16, 7, s36
  v_lshl_add_u32 v3, v19, 11, v3
  v_lshl_add_u32 v3, v20, 12, v3
  s_and_b32 s40, s2, 7
  s_lshr_b32 s42, s2, 4
  s_and_b32 s43, s2, 15
  v_lshrrev_b32 v19, 3, v0
  v_and_b32 v20, 7, v0
  v_lshl_add_u32 v19, v19, 4, s43
  s_lshl_b32 s44, s42, 7
  v_lshl_add_u32 v20, v20, 4, s44
  v_lshl_add_u32 v172, v19, 11, v20
  v_sub_u32 v19, 1024, v19
  v_sub_u32 v20, 2032, v20
  v_add_u32 v174, 0x200000, v172
  v_lshl_add_u32 v175, v19, 11, v20
  v_add_u32 v173, 0x200000, v175
  v_and_b32 v173, 0x3fffff, v173
  v_mul_u32_u24 v5, 2064, v16
  v_add_u32 v5, v5, v18
  s_mov_b32 s36, 55808
  v_lshl_add_u32 v8, v1, 5, s36
  v_lshrrev_b32 v19, 3, v1
  v_add_u32 v19, s3, v19
  v_and_b32 v20, 7, v19
  v_lshl_add_u32 v6, v20, 2, v8
  v_lshlrev_b32 v21, 1, v17
  v_sub_u32 v19, v19, v21
  v_add_u32 v19, 6, v19
  v_and_b32 v19, 7, v19
  v_lshlrev_b32 v19, 2, v19
  v_lshl_add_u32 v20, v16, 5, v19
  v_add_u32 v20, 57344, v20
  v_add_u32 v21, 2048, v6
  s_mov_b32 s36, 0x00f0000f
  s_mov_b32 s37, 0xf0000f00
  v_cndmask_b32_e64 v7, v21, v20, s[36:37]
  v_bfe_u32 v20, v1, 2, 2
  v_and_b32 v21, 3, v1
  v_lshrrev_b32 v22, 5, v1
  v_lshl_add_u32 v22, v22, 3, v20
  v_and_b32 v23, 1, v17
  v_lshlrev_b32 v22, 6, v22
  v_lshl_add_u32 v22, v23, 5, v22
  v_lshl_add_u32 v22, v21, 3, v22
  v_add_u32 v4, s34, v22
  v_mov_b32 v65, v64
  v_mov_b32 v66, v64
  v_mov_b32 v67, v64
  v_mov_b32 v11, 0xfffcfffc
  s_mov_b32 s10, 8388608
  s_mov_b32 s14, 0x400000
  s_mov_b32 s15, 0x20000
  s_lshl_b32 s34, s3, 1
  s_add_u32 s35, s34, 17
  s_add_u32 s34, s34, 16
  s_mov_b32 s48, 0x22222222
  s_mov_b32 s49, 0x22222222
  s_mov_b32 s50, 0x44444444
  s_mov_b32 s51, 0x44444444
  s_mov_b32 s52, 0x88888888
  s_mov_b32 s53, 0x88888888
  v_lshrrev_b32 v20, 1, v16
  v_lshlrev_b32 v20, 8, v20
  s_cmp_eq_u32 s2, 0
  s_cselect_b32 s36, 896, 0
  s_cselect_b32 s55, 0x10000, 0
  s_mov_b32 s54, 0xffff0000
  v_bfe_u32 v21, v1, 3, 1
  v_mul_u32_u24 v21, s36, v21
  v_add_u32 v20, s2, v20
  v_sub_u32 v20, v20, v21
  v_sub_u32 v21, 0x800, v20
  v_cmp_eq_u32 vcc, 0, v20
  v_mov_b32 v22, 0x400
  s_mov_b32 s36, 0xaaaaaaaa
  s_mov_b32 s37, s36
  v_cndmask_b32_e64 v21, v21, v22, vcc
  v_cndmask_b32_e64 v20, v20, v21, s[36:37]
  v_sub_u32 v9, 0xffff, v20
  v_and_b32 v21, 15, v20
  v_and_b32 v20, 0x7f0, v20
  v_lshl_add_u32 v10, v21, 12, v20
  v_mov_b32 v21, 0x800
  s_nop 1
  v_mov_b32_dpp v10, v21 quad_perm:[0,1,2,3] row_mask:0xd bank_mask:0xf
  s_waitcnt vmcnt(0)
  v_mfma_f32_16x16x32_bf16 v[76:79], v[32:35], v[64:67], 0
  v_mfma_f32_16x16x32_bf16 v[76:79], v[36:39], v[64:67], v[76:79]
  v_mfma_f32_16x16x32_bf16 v[76:79], v[40:43], v[64:67], v[76:79]
  v_mfma_f32_16x16x32_bf16 v[76:79], v[44:47], v[64:67], v[76:79]
  s_waitcnt lgkmcnt(0)
  s_barrier
  ds_read_b128 v[48:51], v5 offset:0
  ds_read_b128 v[52:55], v5 offset:64
  ds_read_b128 v[56:59], v5 offset:128
  ds_read_b128 v[60:63], v5 offset:192
  ds_read_b64_tr_b16 v[132:133], v4 offset:0
  ds_read_b64_tr_b16 v[134:135], v4 offset:256
  ds_read_b64_tr_b16 v[136:137], v4 offset:1024
  ds_read_b64_tr_b16 v[138:139], v4 offset:1280
  ds_read_b128 v[112:115], v2 offset:35328
  ds_read_b128 v[116:119], v2 offset:36352
  s_add_u32 s24, s24, 1
  s_and_b32 s29, s24, 0xff
  s_waitcnt lgkmcnt(9)
  v_mfma_f32_16x16x32_bf16 v[72:75], v[48:51], v[48:51], 0
  v_mfma_f32_16x16x32_bf16 v[68:71], v[32:35], v[48:51], 0
  s_waitcnt lgkmcnt(8)
  v_mfma_f32_16x16x32_bf16 v[72:75], v[52:55], v[52:55], v[72:75]
  v_mfma_f32_16x16x32_bf16 v[68:71], v[36:39], v[52:55], v[68:71]
  s_waitcnt lgkmcnt(7)
  v_mfma_f32_16x16x32_bf16 v[72:75], v[56:59], v[56:59], v[72:75]
  v_mfma_f32_16x16x32_bf16 v[68:71], v[40:43], v[56:59], v[68:71]
  s_waitcnt lgkmcnt(6)
  v_mfma_f32_16x16x32_bf16 v[72:75], v[60:63], v[60:63], v[72:75]
  v_mfma_f32_16x16x32_bf16 v[68:71], v[44:47], v[60:63], v[68:71]
  ds_read_b128 v[120:123], v2 offset:37376
  ds_read_b128 v[124:127], v2 offset:38400
  ds_read_b64_tr_b16 v[140:141], v4 offset:2064
  ds_read_b64_tr_b16 v[142:143], v4 offset:2320
  ds_read_b64_tr_b16 v[144:145], v4 offset:3088
  ds_read_b64_tr_b16 v[146:147], v4 offset:3344
  s_nop 0
  v_cndmask_b32_e64 v72, v72, v73, s[48:49]
  v_cndmask_b32_e64 v74, v74, v75, s[52:53]
  v_mov_b32_dpp v68, v76 quad_perm:[0,1,2,3] row_mask:0x4 bank_mask:0xf
  s_or_b64 s[50:51], s[50:51], s[52:53]
  ds_write_b32 v6, v68
  v_cndmask_b32_e64 v72, v72, v74, s[50:51]
  ds_write_b32 v7, v72
  s_waitcnt lgkmcnt(8)
  v_mfma_f32_32x32x16_bf16 v[176:191], v[132:135], v[112:115], 0
  v_mfma_f32_32x32x16_bf16 v[176:191], v[136:139], v[116:119], v[176:191]
  s_waitcnt lgkmcnt(0)
  s_barrier
  ds_read_b128 v[28:31], v8
  ds_read_b128 v[68:71], v8 offset:16
  ds_read_b128 v[20:23], v2 offset:51712
  ds_read_b128 v[12:15], v2 offset:47616
  ds_read_b128 v[80:83], v2 offset:39424
  ds_read_b128 v[84:87], v2 offset:40448
  ds_read_b128 v[88:91], v2 offset:41472
  ds_read_b128 v[92:95], v2 offset:42496
  ds_read_b128 v[96:99], v2 offset:43520
  ds_read_b128 v[100:103], v2 offset:44544
  ds_read_b128 v[104:107], v2 offset:45568
  ds_read_b128 v[108:111], v2 offset:46592
  ds_read_b128 v[128:131], v2 offset:53760
  ds_read_b128 v[24:27], v2 offset:52736
  s_cmp_eq_u32 s3, 7
  s_cbranch_scc1 L_cw
  v_mfma_f32_32x32x16_bf16 v[192:207], v[132:135], v[120:123], 0
  s_waitcnt lgkmcnt(12)
  v_pk_add_f32 v[28:29], v[28:29], v[30:31]
  v_pk_add_f32 v[68:69], v[68:69], v[70:71]
  v_pk_add_f32 v[28:29], v[28:29], v[68:69]
  v_add_f32 v68, v28, v29
  v_add_f32 v31, v28, v29
  s_nop 1
  v_permlane32_swap_b32 v68, v31
  v_mfma_f32_32x32x16_bf16 v[192:207], v[136:139], v[124:127], v[192:207]
  v_mov_b32 v69, v31
  v_mul_f32 v29, 0x3a800000, v68
  v_mul_f32 v31, 0x3a800000, v31
  v_fma_f32 v31, -v29, v29, v31
  v_max_f32 v31, 0, v31
  v_mfma_f32_32x32x16_bf16 v[208:223], v[140:143], v[112:115], 0
  v_cvt_pk_bf16_f32 v31, v31, v31
  v_and_b32 v31, 0xffff0000, v31
  v_add_f32 v31, 0x3727c5ac, v31
  v_cvt_pk_bf16_f32 v31, v31, v31
  v_and_b32 v31, 0xffff0000, v31
  v_sqrt_f32 v31, v31
  v_mfma_f32_32x32x16_bf16 v[208:223], v[144:147], v[116:119], v[208:223]
  v_mov_b32 v18, s24
  v_cvt_pk_bf16_f32 v19, v29, v31
  v_and_b32 v16, 0xffff0000, v19
  v_rcp_f32 v16, v16
  v_lshlrev_b32 v17, 16, v19
  v_mfma_f32_32x32x16_bf16 v[224:239], v[140:143], v[120:123], 0
  v_mul_f32 v17, v17, v16
  v_readlane_b32 s56, v16, s34
  v_readlane_b32 s57, v16, s35
  v_readlane_b32 s58, v17, s34
  v_readlane_b32 s59, v17, s35
  v_mfma_f32_32x32x16_bf16 v[224:239], v[144:147], v[124:127], v[224:239]
L_nocand:
  s_lshl_b32 s63, s41, 15
  s_lshl_b32 s38, s3, 13
  s_add_u32 m0, s38, 79552
  s_add_u32 s63, s63, s38
  s_add_u32 s63, s63, 20480
  s_mov_b32 s60, s57
  s_mov_b32 s61, s59
  s_or_b32 s62, s2, s3
  s_cselect_b32 s57, s57, 0
  s_cselect_b32 s59, s59, 0
  s_mul_i32 s36, s3, 2176
  s_lshl_b32 s37, s3, 5
  s_waitcnt lgkmcnt(10)
  v_add_u32 v21, s37, v21
  v_add_u32 v12, s36, v12
  v_add_u32 v13, s36, v13
  v_add_u32 v14, s36, v14
  v_add_u32 v15, s36, v15
  v_and_b32 v21, 0xff, v21
  v_add_u32 v20, v20, v21
L_job:
  v_mul_f32 v18, s58, v23
  v_mul_f32 v19, s59, v23
  v_add_f32 v16, v18, v19
  v_sub_f32 v17, v18, v19
  v_pk_fma_f32 v[156:157], v[176:177], s[56:57], v[16:17] op_sel:[0,0,0] op_sel_hi:[1,0,0]
  v_pk_fma_f32 v[158:159], v[192:193], s[56:57], v[16:17] op_sel:[0,0,1] op_sel_hi:[1,0,1]
  v_pk_fma_f32 v[156:157], v[224:225], s[56:57], v[156:157] op_sel:[0,1,0] op_sel_hi:[1,1,1]
  v_pk_fma_f32 v[158:159], v[208:209], s[56:57], v[158:159] op_sel:[0,1,0] op_sel_hi:[1,1,1] neg_lo:[1,0,0] neg_hi:[1,0,0]
  s_waitcnt lgkmcnt(2)
  v_cvt_pk_f16_f32 v160, v156, v157
  v_cvt_pk_f16_f32 v161, v158, v159
  v_pk_mul_f16 v162, v160, v80
  v_pk_mul_f16 v163, v161, v80
  v_pk_fma_f16 v132, v161, v82, v162
  v_pk_fma_f16 v134, v160, v82, v163 neg_lo:[1,0,0] neg_hi:[1,0,0]
  v_pk_fma_f32 v[164:165], v[178:179], s[56:57], v[16:17] op_sel:[0,0,0] op_sel_hi:[1,0,0]
  v_pk_fma_f32 v[166:167], v[194:195], s[56:57], v[16:17] op_sel:[0,0,1] op_sel_hi:[1,0,1]
  v_pk_fma_f32 v[164:165], v[226:227], s[56:57], v[164:165] op_sel:[0,1,0] op_sel_hi:[1,1,1]
  v_pk_fma_f32 v[166:167], v[210:211], s[56:57], v[166:167] op_sel:[0,1,0] op_sel_hi:[1,1,1] neg_lo:[1,0,0] neg_hi:[1,0,0]
  v_cvt_pk_f16_f32 v168, v164, v165
  v_cvt_pk_f16_f32 v169, v166, v167
  v_pk_mul_f16 v170, v168, v81
  v_pk_mul_f16 v171, v169, v81
  v_pk_fma_f16 v133, v169, v83, v170
  v_pk_fma_f16 v135, v168, v83, v171 neg_lo:[1,0,0] neg_hi:[1,0,0]
  v_pk_fma_f32 v[156:157], v[180:181], s[56:57], v[16:17] op_sel:[0,0,0] op_sel_hi:[1,0,0]
  v_pk_fma_f32 v[158:159], v[196:197], s[56:57], v[16:17] op_sel:[0,0,1] op_sel_hi:[1,0,1]
  v_pk_fma_f32 v[156:157], v[228:229], s[56:57], v[156:157] op_sel:[0,1,0] op_sel_hi:[1,1,1]
  v_pk_fma_f32 v[158:159], v[212:213], s[56:57], v[158:159] op_sel:[0,1,0] op_sel_hi:[1,1,1] neg_lo:[1,0,0] neg_hi:[1,0,0]
  s_nop 1
  v_mfma_f32_32x32x16_f16 v[112:127], v[132:135], v[96:99], 0
  v_cvt_pk_f16_f32 v160, v156, v157
  v_cvt_pk_f16_f32 v161, v158, v159
  v_pk_mul_f16 v162, v160, v84
  v_pk_mul_f16 v163, v161, v84
  v_pk_fma_f16 v136, v161, v86, v162
  v_pk_fma_f16 v138, v160, v86, v163 neg_lo:[1,0,0] neg_hi:[1,0,0]
  v_pk_fma_f32 v[164:165], v[182:183], s[56:57], v[16:17] op_sel:[0,0,0] op_sel_hi:[1,0,0]
  v_pk_fma_f32 v[166:167], v[198:199], s[56:57], v[16:17] op_sel:[0,0,1] op_sel_hi:[1,0,1]
  v_pk_fma_f32 v[164:165], v[230:231], s[56:57], v[164:165] op_sel:[0,1,0] op_sel_hi:[1,1,1]
  v_pk_fma_f32 v[166:167], v[214:215], s[56:57], v[166:167] op_sel:[0,1,0] op_sel_hi:[1,1,1] neg_lo:[1,0,0] neg_hi:[1,0,0]
  v_cvt_pk_f16_f32 v168, v164, v165
  v_cvt_pk_f16_f32 v169, v166, v167
  v_pk_mul_f16 v170, v168, v85
  v_pk_mul_f16 v171, v169, v85
  v_pk_fma_f16 v137, v169, v87, v170
  v_pk_fma_f16 v139, v168, v87, v171 neg_lo:[1,0,0] neg_hi:[1,0,0]
  v_pk_fma_f32 v[156:157], v[184:185], s[56:57], v[16:17] op_sel:[0,0,0] op_sel_hi:[1,0,0]
  v_pk_fma_f32 v[158:159], v[200:201], s[56:57], v[16:17] op_sel:[0,0,1] op_sel_hi:[1,0,1]
  v_pk_fma_f32 v[156:157], v[232:233], s[56:57], v[156:157] op_sel:[0,1,0] op_sel_hi:[1,1,1]
  v_pk_fma_f32 v[158:159], v[216:217], s[56:57], v[158:159] op_sel:[0,1,0] op_sel_hi:[1,1,1] neg_lo:[1,0,0] neg_hi:[1,0,0]
  s_nop 1
  v_mfma_f32_32x32x16_f16 v[112:127], v[136:139], v[100:103], v[112:127]
  s_cmp_ge_u32 s3, 4
  s_cbranch_scc1 L_yb0
  buffer_load_dwordx4 v2, s[16:19], s63 offen offset:0 lds
  buffer_load_dwordx4 v2, s[16:19], s63 offen offset:1024 lds
L_yb0:
  v_cvt_pk_f16_f32 v160, v156, v157
  v_cvt_pk_f16_f32 v161, v158, v159
  v_pk_mul_f16 v162, v160, v88
  v_pk_mul_f16 v163, v161, v88
  v_pk_fma_f16 v140, v161, v90, v162
  v_pk_fma_f16 v142, v160, v90, v163 neg_lo:[1,0,0] neg_hi:[1,0,0]
  v_pk_fma_f32 v[164:165], v[186:187], s[56:57], v[16:17] op_sel:[0,0,0] op_sel_hi:[1,0,0]
  v_pk_fma_f32 v[166:167], v[202:203], s[56:57], v[16:17] op_sel:[0,0,1] op_sel_hi:[1,0,1]
  v_pk_fma_f32 v[164:165], v[234:235], s[56:57], v[164:165] op_sel:[0,1,0] op_sel_hi:[1,1,1]
  v_pk_fma_f32 v[166:167], v[218:219], s[56:57], v[166:167] op_sel:[0,1,0] op_sel_hi:[1,1,1] neg_lo:[1,0,0] neg_hi:[1,0,0]
  s_cmp_ge_u32 s3, 4
  s_cbranch_scc1 L_yb1
  buffer_load_dwordx4 v2, s[16:19], s63 offen offset:2048 lds
  buffer_load_dwordx4 v2, s[16:19], s63 offen offset:3072 lds
L_yb1:
  v_cvt_pk_f16_f32 v168, v164, v165
  v_cvt_pk_f16_f32 v169, v166, v167
  v_pk_mul_f16 v170, v168, v89
  v_pk_mul_f16 v171, v169, v89
  v_pk_fma_f16 v141, v169, v91, v170
  v_pk_fma_f16 v143, v168, v91, v171 neg_lo:[1,0,0] neg_hi:[1,0,0]
  v_pk_fma_f32 v[156:157], v[188:189], s[56:57], v[16:17] op_sel:[0,0,0] op_sel_hi:[1,0,0]
  v_pk_fma_f32 v[158:159], v[204:205], s[56:57], v[16:17] op_sel:[0,0,1] op_sel_hi:[1,0,1]
  v_pk_fma_f32 v[156:157], v[236:237], s[56:57], v[156:157] op_sel:[0,1,0] op_sel_hi:[1,1,1]
  v_pk_fma_f32 v[158:159], v[220:221], s[56:57], v[158:159] op_sel:[0,1,0] op_sel_hi:[1,1,1] neg_lo:[1,0,0] neg_hi:[1,0,0]
  s_nop 1
  v_mfma_f32_32x32x16_f16 v[112:127], v[140:143], v[104:107], v[112:127]
  s_cmp_ge_u32 s3, 4
  s_cbranch_scc1 L_yb2
  s_add_u32 m0, m0, 4096
  s_add_u32 s63, s63, 4096
  buffer_load_dwordx4 v2, s[16:19], s63 offen offset:0 lds
  buffer_load_dwordx4 v2, s[16:19], s63 offen offset:1024 lds
L_yb2:
  v_cvt_pk_f16_f32 v160, v156, v157
  v_cvt_pk_f16_f32 v161, v158, v159
  v_pk_mul_f16 v162, v160, v92
  v_pk_mul_f16 v163, v161, v92
  v_pk_fma_f16 v144, v161, v94, v162
  v_pk_fma_f16 v146, v160, v94, v163 neg_lo:[1,0,0] neg_hi:[1,0,0]
  v_pk_fma_f32 v[164:165], v[190:191], s[56:57], v[16:17] op_sel:[0,0,0] op_sel_hi:[1,0,0]
  v_pk_fma_f32 v[166:167], v[206:207], s[56:57], v[16:17] op_sel:[0,0,1] op_sel_hi:[1,0,1]
  v_pk_fma_f32 v[164:165], v[238:239], s[56:57], v[164:165] op_sel:[0,1,0] op_sel_hi:[1,1,1]
  v_pk_fma_f32 v[166:167], v[222:223], s[56:57], v[166:167] op_sel:[0,1,0] op_sel_hi:[1,1,1] neg_lo:[1,0,0] neg_hi:[1,0,0]
  s_cmp_ge_u32 s3, 4
  s_cbranch_scc1 L_yb3
  buffer_load_dwordx4 v2, s[16:19], s63 offen offset:2048 lds
  buffer_load_dwordx4 v2, s[16:19], s63 offen offset:3072 lds
  s_sub_u32 m0, m0, 4096
  s_sub_u32 s63, s63, 4096
L_yb3:
  v_cvt_pk_f16_f32 v168, v164, v165
  v_cvt_pk_f16_f32 v169, v166, v167
  v_pk_mul_f16 v170, v168, v93
  v_pk_mul_f16 v171, v169, v93
  v_pk_fma_f16 v145, v169, v95, v170
  v_pk_fma_f16 v147, v168, v95, v171 neg_lo:[1,0,0] neg_hi:[1,0,0]
  s_nop 1
  v_mfma_f32_32x32x16_f16 v[112:127], v[144:147], v[108:111], v[112:127]
  s_and_b32 s37, s24, 0x3333
  s_and_b32 s38, s24, 0xcccc
  s_lshl_b32 s38, s38, 14
  s_or_b32 s37, s37, s38
  s_and_b32 s25, s37, 0x30003
  s_lshr_b32 s38, s37, 4
  s_and_b32 s26, s38, 0x30003
  s_lshr_b32 s38, s37, 8
  s_and_b32 s27, s38, 0x30003
  s_lshr_b32 s38, s37, 12
  s_and_b32 s28, s38, 0x30003
  s_nop 0
  v_cvt_pk_f16_f32 v148, v112, v113
  v_cvt_pk_f16_f32 v149, v114, v115
  v_cvt_pk_f16_f32 v150, v116, v117
  v_cvt_pk_f16_f32 v151, v118, v119
  ds_write_b128 v12, v[148:151]
  v_cvt_pk_f16_f32 v152, v120, v121
  v_cvt_pk_f16_f32 v153, v122, v123
  v_cvt_pk_f16_f32 v154, v124, v125
  v_cvt_pk_f16_f32 v155, v126, v127
  ds_write_b128 v13, v[152:155]
  ds_write_b16_d16_hi v14, v151
  ds_write_b16_d16_hi v15, v155
  s_cmp_lg_u32 s62, 0
  s_cbranch_scc0 L_job2
L_jobx:
  s_lshl_b32 s37, s2, 14
  s_lshl_b32 s38, s3, 8
  s_add_u32 s37, s37, s38
  s_add_u32 s37, s37, 1048576
  s_waitcnt lgkmcnt(0)
  s_barrier
  ds_read_b64_tr_b16 v[132:133], v20 offset:0
  ds_read_b64_tr_b16 v[134:135], v20 offset:4352
  ds_read_b64_tr_b16 v[136:137], v20 offset:8
  ds_read_b64_tr_b16 v[138:139], v20 offset:4360
  ds_read_b64_tr_b16 v[140:141], v20 offset:256
  ds_read_b64_tr_b16 v[142:143], v20 offset:4608
  ds_read_b64_tr_b16 v[144:145], v20 offset:264
  ds_read_b64_tr_b16 v[146:147], v20 offset:4616
  s_cmp_lg_u32 s3, 6
  s_cbranch_scc1 L_noext0
  ds_read_u16 v176, v24 offset:0
  ds_read_u16 v180, v25 offset:0
  ds_read_u16 v177, v24 offset:2176
  ds_read_u16 v181, v25 offset:2176
  ds_read_u16 v178, v24 offset:4352
  ds_read_u16 v182, v25 offset:4352
  ds_read_u16 v179, v24 offset:6528
  ds_read_u16 v183, v25 offset:6528
  s_lshl_b32 s38, s2, 9
  s_add_u32 s38, s38, 65536
  s_add_u32 s39, s38, 64
  v_mov_b32 v193, s24
  v_mov_b32 v195, s24
  s_waitcnt lgkmcnt(0)
  v_lshl_or_b32 v176, v180, 16, v176
  v_lshl_or_b32 v177, v181, 16, v177
  v_lshl_or_b32 v178, v182, 16, v178
  v_lshl_or_b32 v179, v183, 16, v179
  s_nop 1
  v_mfma_f32_16x16x32_f16 v[188:191], v[128:131], v[176:179], 0
L_noext0:
  s_waitcnt lgkmcnt(6)
  v_mfma_f32_16x16x32_f16 v[156:159], v[128:131], v[132:135], 0
  s_waitcnt lgkmcnt(4)
  v_mfma_f32_16x16x32_f16 v[160:163], v[128:131], v[136:139], 0
  s_waitcnt lgkmcnt(2)
  v_mfma_f32_16x16x32_f16 v[164:167], v[128:131], v[140:143], 0
  s_waitcnt lgkmcnt(0)
  v_mfma_f32_16x16x32_f16 v[168:171], v[128:131], v[144:147], 0
  s_cmp_lg_u32 s3, 6
  s_cbranch_scc1 L_noext
  v_cvt_pk_f16_f32 v192, v188, v189
  v_cvt_pk_f16_f32 v194, v190, v191
  s_mov_b32 exec_lo, 0xff00ff
  s_mov_b32 exec_hi, 0xff00ff
  buffer_store_dwordx2 v[192:193], v26, s[8:11], s38 offen sc1
  buffer_store_dwordx2 v[194:195], v26, s[8:11], s39 offen sc1
  s_mov_b64 exec, -1
L_noext:
  s_nop 1
  v_cvt_pk_f16_f32 v148, v156, v160
  s_nop 2
  v_cvt_pk_f16_f32 v149, v164, v168
  v_cvt_pk_f16_f32 v150, v157, v161
  v_cvt_pk_f16_f32 v151, v165, v169
  v_add_u32 v148, 0x20002, v148
  v_add_u32 v149, 0x20002, v149
  v_add_u32 v150, 0x20002, v150
  v_add_u32 v151, 0x20002, v151
  v_and_or_b32 v148, v148, v11, s25
  v_and_or_b32 v149, v149, v11, s26
  v_and_or_b32 v150, v150, v11, s27
  v_and_or_b32 v151, v151, v11, s28
  buffer_store_dwordx4 v[148:151], v22, s[8:11], s37 offen offset:0 sc1
  v_cvt_pk_f16_f32 v152, v158, v162
  v_cvt_pk_f16_f32 v153, v166, v170
  v_cvt_pk_f16_f32 v154, v159, v163
  v_cvt_pk_f16_f32 v155, v167, v171
  v_add_u32 v152, 0x20002, v152
  v_add_u32 v153, 0x20002, v153
  v_add_u32 v154, 0x20002, v154
  v_add_u32 v155, 0x20002, v155
  v_and_or_b32 v152, v152, v11, s25
  v_and_or_b32 v153, v153, v11, s26
  v_and_or_b32 v154, v154, v11, s27
  v_and_or_b32 v155, v155, v11, s28
  buffer_store_dwordx4 v[152:155], v22, s[8:11], s37 offen offset:2048 sc1
  s_barrier
  s_mov_b32 exec_lo, 0
  global_load_dword v27, v3, s[30:31]
  s_mov_b64 exec, -1
  s_cmp_eq_u32 s3, 5
  s_cbranch_scc1 L_y01
  s_cmp_lg_u32 s3, 7
  s_cbranch_scc1 L_y03
  s_and_b32 s45, s2, 7
  s_lshl_b32 s45, s45, 11
  s_add_u32 s45, s45, 131072
  buffer_load_dwordx4 v[164:167], v2, s[8:11], s45 offen sc1
  buffer_load_dwordx4 v[168:171], v2, s[8:11], s45 offen offset:1024 sc1
  s_branch L_y03
L_y01:
  s_sub_u32 s45, 16, s43
  s_and_b32 s45, s45, 15
  s_cselect_b32 s37, 0, 16
  s_lshl_b32 s45, s45, 12
  s_lshl_b32 s44, s43, 12
  s_add_u32 s45, s45, s37
  s_add_u32 s44, s44, 196608
  s_add_u32 s45, s45, 196608
  buffer_load_dwordx3 v[112:114], v2, s[8:11], s44 offen offset:0 sc1
  buffer_load_dwordx3 v[116:118], v2, s[8:11], s44 offen offset:1024 sc1
  buffer_load_dwordx3 v[120:122], v2, s[8:11], s45 offen offset:0 sc1
  buffer_load_dwordx3 v[124:126], v2, s[8:11], s45 offen offset:1024 sc1
L_y03:
  buffer_load_dwordx4 v[240:243], v172, s[4:7], 0 offen
  buffer_load_dwordx4 v[244:247], v173, s[4:7], 0 offen
  buffer_load_dwordx4 v[248:251], v174, s[4:7], 0 offen
  buffer_load_dwordx4 v[252:255], v175, s[4:7], 0 offen
  ds_read_b128 v[4:7], v2 offset:48640
  ds_read_b128 v[8:11], v2 offset:49664
  ds_read_b64 v[230:231], v2 offset:50696
  v_and_b32 v228, 0x1f8, v0
  v_sub_u32 v229, 57336, v228
  v_add_u32 v228, 55808, v228
  s_and_b32 s52, s3, 3
  s_lshl_b32 s36, s52, 13
  s_add_u32 s36, s36, 79552
  v_add_u32 v236, s36, v2
  s_lshl_b32 s48, s40, 11
  s_lshl_b32 s49, s42, 8
  s_add_u32 s48, s48, s49
  s_add_u32 s48, s48, 1048576
  s_lshl_b32 s36, s3, 16
  s_sub_u32 s49, s48, s36
  s_add_u32 s48, s48, s36
  s_add_u32 s32, s48, 524288
  s_add_u32 s33, s49, 999424
  s_add_u32 s49, s49, 1523712
  s_cmp_eq_u32 s41, 0
  s_mov_b32 s50, 0xbc00bc00
  s_cmov_b32 s50, 0x3c003c00
  s_lshr_b32 s51, s3, 2
  s_cmp_eq_u32 s3, 0
  s_cselect_b32 s38, 0xffff, 0
  s_mov_b32 s39, 0
  v_mov_b32 v232, s25
  v_mov_b32 v233, s26
  v_mov_b32 v234, s27
  v_mov_b32 v235, s28
  v_mov_b32 v25, 0x40000000
  s_lshl_b32 s36, s3, 10
  s_lshl_b32 s37, s51, 6
  s_waitcnt lgkmcnt(0)
  v_add_u32 v24, 0x100000, v5
  v_add_u32 v6, s36, v6
  v_cndmask_b32_e64 v24, v24, v5, s[38:39]
  v_xor_b32 v7, s37, v7
  s_mul_i32 s36, s52, 4608
  s_lshl_b32 s37, s51, 5
  v_add_u32 v11, s36, v11
  s_add_u32 s36, s36, s37
  s_mul_i32 s37, s3, 1152
  v_add_u32 v9, s36, v9
  v_add_u32 v10, s37, v10
  s_cmp_lg_u32 s3, 5
  s_cbranch_scc1 L_y02
  s_mov_b32 s63, 0
  s_waitcnt vmcnt(4)
  s_branch P_1_c
P_1:
  buffer_load_dwordx3 v[112:114], v2, s[8:11], s44 offen offset:0 sc1
  buffer_load_dwordx3 v[116:118], v2, s[8:11], s44 offen offset:1024 sc1
  buffer_load_dwordx3 v[120:122], v2, s[8:11], s45 offen offset:0 sc1
  buffer_load_dwordx3 v[124:126], v2, s[8:11], s45 offen offset:1024 sc1
  s_waitcnt vmcnt(0)
P_1_c:
  v_cmp_ne_u32 vcc, s24, v114
  v_cmp_ne_u32 s[38:39], s24, v118
  s_or_b64 vcc, vcc, s[38:39]
  v_cmp_ne_u32 s[38:39], s24, v122
  s_or_b64 vcc, vcc, s[38:39]
  v_cmp_ne_u32 s[38:39], s24, v126
  s_or_b64 vcc, vcc, s[38:39]
  s_cbranch_vccz P_1_x
  s_add_u32 s63, s63, 1
  s_cmp_lt_u32 s63, 65536
  s_cbranch_scc1 P_1
P_1_x:
  v_lshlrev_b32 v16, 3, v1
  v_add_f32 v112, 1.0, v112
  ds_write_b64 v16, v[112:113] offset:55808
  v_add_f32 v116, 1.0, v116
  ds_write_b64 v16, v[116:117] offset:56320
  v_add_f32 v120, 1.0, v120
  ds_write_b64 v16, v[120:121] offset:56832
  v_add_f32 v124, 1.0, v124
  ds_write_b64 v16, v[124:125] offset:57344
L_y02:
  s_cmp_lg_u32 s3, 7
  s_cbranch_scc1 L_y1
  s_mov_b32 s63, 0
  s_waitcnt vmcnt(4)
  s_branch P_2_c
P_2:
  buffer_load_dwordx4 v[164:167], v2, s[8:11], s45 offen sc1
  buffer_load_dwordx4 v[168:171], v2, s[8:11], s45 offen offset:1024 sc1
  s_waitcnt vmcnt(0)
P_2_c:
  v_cmp_ne_u32 vcc, s24, v166
  v_cmp_ne_u32 s[38:39], s24, v170
  s_or_b64 vcc, vcc, s[38:39]
  s_cbranch_vccz P_2_x
  s_add_u32 s63, s63, 1
  s_cmp_lt_u32 s63, 65536
  s_cbranch_scc1 P_2
P_2_x:
  v_max_u32 v166, v164, v168
  v_min_u32 v170, v164, v168
  v_max3_u32 v167, v170, v165, v169
  s_nop 0
  v_min_u32_dpp v170, v166, v166 row_ror:8 row_mask:0xf bank_mask:0xf
  v_max_u32_dpp v167, v167, v167 row_ror:8 row_mask:0xf bank_mask:0xf
  v_max_u32_dpp v166, v166, v166 row_ror:8 row_mask:0xf bank_mask:0xf
  v_max_u32 v167, v167, v170
  s_nop 0
  v_min_u32_dpp v170, v166, v166 row_ror:4 row_mask:0xf bank_mask:0xf
  v_max_u32_dpp v167, v167, v167 row_ror:4 row_mask:0xf bank_mask:0xf
  v_max_u32_dpp v166, v166, v166 row_ror:4 row_mask:0xf bank_mask:0xf
  v_max_u32 v167, v167, v170
  s_nop 0
  v_min_u32_dpp v170, v166, v166 row_ror:2 row_mask:0xf bank_mask:0xf
  v_max_u32_dpp v167, v167, v167 row_ror:2 row_mask:0xf bank_mask:0xf
  v_max_u32_dpp v166, v166, v166 row_ror:2 row_mask:0xf bank_mask:0xf
  v_max_u32 v167, v167, v170
  s_nop 0
  v_min_u32_dpp v170, v166, v166 row_ror:1 row_mask:0xf bank_mask:0xf
  v_max_u32_dpp v167, v167, v167 row_ror:1 row_mask:0xf bank_mask:0xf
  v_max_u32_dpp v166, v166, v166 row_ror:1 row_mask:0xf bank_mask:0xf
  v_max_u32 v167, v167, v170
  s_nop 0
  v_min_u32_dpp v170, v166, v166 row_bcast:15 row_mask:0xa bank_mask:0xf
  v_max_u32_dpp v167, v167, v167 row_bcast:15 row_mask:0xa bank_mask:0xf
  v_max_u32_dpp v166, v166, v166 row_bcast:15 row_mask:0xa bank_mask:0xf
  v_max_u32 v167, v167, v170
  s_nop 0
  v_min_u32_dpp v170, v166, v166 row_bcast:31 row_mask:0xc bank_mask:0xf
  v_max_u32_dpp v167, v167, v167 row_bcast:31 row_mask:0xc bank_mask:0xf
  v_max_u32_dpp v166, v166, v166 row_bcast:31 row_mask:0xc bank_mask:0xf
  v_max_u32 v167, v167, v170
  v_readlane_b32 s46, v166, 63
  v_readlane_b32 s47, v167, 63
  s_nop 0
  v_mov_b32 v16, s46
  v_mov_b32 v17, s47
  v_mov_b32 v18, 0
  ds_write_b64 v18, v[16:17] offset:59904
L_y1:
  s_lshl_b32 s37, s40, 6
  s_lshl_b32 s38, s42, 3
  s_add_u32 s37, s37, s38
  s_add_u32 s45, s37, 65536
  v_mov_b32 v18, 0
  s_waitcnt vmcnt(6) lgkmcnt(0)
  s_barrier
  s_cmp_lg_u32 s3, 6
  s_cbranch_scc1 L_y0
  buffer_load_dwordx2 v[164:165], v230, s[8:11], s45 offen sc1
  buffer_load_dwordx2 v[166:167], v231, s[8:11], s45 offen sc1
L_y0:
  buffer_load_dwordx4 v[96:99], v4, s[8:11], s48 offen sc1
  buffer_load_dwordx4 v[100:103], v24, s[8:11], s33 offen sc1
  buffer_load_dwordx4 v[104:107], v4, s[8:11], s32 offen sc1
  buffer_load_dwordx4 v[108:111], v5, s[8:11], s49 offen sc1
  ds_read_b64 v[16:17], v18 offset:59904
  ds_read2_b64 v[112:115], v228 offset1:64
  ds_read2_b64 v[116:119], v229 offset1:64
  ds_read_b128 v[32:35], v236 offset:0
  ds_read_b128 v[36:39], v236 offset:1024
  ds_read_b128 v[40:43], v236 offset:2048
  ds_read_b128 v[44:47], v236 offset:3072
  ds_read_b128 v[48:51], v236 offset:4096
  ds_read_b128 v[52:55], v236 offset:5120
  ds_read_b128 v[56:59], v236 offset:6144
  ds_read_b128 v[60:63], v236 offset:7168
  s_waitcnt lgkmcnt(10)
  v_readfirstlane_b32 s46, v16
  v_readfirstlane_b32 s47, v17
  s_and_b32 s46, s46, 0xffff
  s_and_b32 s47, s47, 0xffff
  s_sub_u32 s46, 0xffff, s46
  s_sub_u32 s47, 0xffff, s47
  v_lshrrev_b32 v16, 11, v172
  v_cmp_eq_u32 s[52:53], s46, v16
  v_cmp_eq_u32 vcc, s47, v16
  s_or_b64 s[52:53], s[52:53], vcc
  v_cndmask_b32_e64 v20, v172, v25, s[52:53]
  v_lshrrev_b32 v16, 11, v173
  v_cmp_eq_u32 s[54:55], s46, v16
  v_cmp_eq_u32 vcc, s47, v16
  s_or_b64 s[54:55], s[54:55], vcc
  v_cndmask_b32_e64 v21, v173, v25, s[54:55]
  v_lshrrev_b32 v16, 11, v174
  v_cmp_eq_u32 s[56:57], s46, v16
  v_cmp_eq_u32 vcc, s47, v16
  s_or_b64 s[56:57], s[56:57], vcc
  v_cndmask_b32_e64 v22, v174, v25, s[56:57]
  v_lshrrev_b32 v16, 11, v175
  v_cmp_eq_u32 s[58:59], s46, v16
  v_cmp_eq_u32 vcc, s47, v16
  s_or_b64 s[58:59], s[58:59], vcc
  v_cndmask_b32_e64 v23, v175, v25, s[58:59]
  s_waitcnt vmcnt(4)
  v_lshlrev_b32 v64, 16, v240
  v_and_b32 v65, 0xffff0000, v240
  s_waitcnt lgkmcnt(9)
  v_pk_fma_f32 v[64:65], v[64:65], v[112:113], v[112:113] op_sel:[0,0,1] op_sel_hi:[1,0,1] neg_lo:[0,0,1] neg_hi:[0,0,1]
  v_lshlrev_b32 v66, 16, v241
  v_and_b32 v67, 0xffff0000, v241
  v_pk_fma_f32 v[66:67], v[66:67], v[112:113], v[112:113] op_sel:[0,0,1] op_sel_hi:[1,0,1] neg_lo:[0,0,1] neg_hi:[0,0,1]
  v_lshlrev_b32 v68, 16, v242
  v_and_b32 v69, 0xffff0000, v242
  v_pk_fma_f32 v[68:69], v[68:69], v[112:113], v[112:113] op_sel:[0,0,1] op_sel_hi:[1,0,1] neg_lo:[0,0,1] neg_hi:[0,0,1]
  v_lshlrev_b32 v70, 16, v243
  v_and_b32 v71, 0xffff0000, v243
  v_pk_fma_f32 v[70:71], v[70:71], v[112:113], v[112:113] op_sel:[0,0,1] op_sel_hi:[1,0,1] neg_lo:[0,0,1] neg_hi:[0,0,1]
  v_lshlrev_b32 v80, 16, v248
  v_and_b32 v81, 0xffff0000, v248
  v_pk_fma_f32 v[80:81], v[80:81], v[114:115], v[114:115] op_sel:[0,0,1] op_sel_hi:[1,0,1] neg_lo:[0,0,1] neg_hi:[0,0,1]
  v_lshlrev_b32 v82, 16, v249
  v_and_b32 v83, 0xffff0000, v249
  v_pk_fma_f32 v[82:83], v[82:83], v[114:115], v[114:115] op_sel:[0,0,1] op_sel_hi:[1,0,1] neg_lo:[0,0,1] neg_hi:[0,0,1]
  v_lshlrev_b32 v84, 16, v250
  v_and_b32 v85, 0xffff0000, v250
  v_pk_fma_f32 v[84:85], v[84:85], v[114:115], v[114:115] op_sel:[0,0,1] op_sel_hi:[1,0,1] neg_lo:[0,0,1] neg_hi:[0,0,1]
  v_lshlrev_b32 v86, 16, v251
  v_and_b32 v87, 0xffff0000, v251
  v_pk_fma_f32 v[86:87], v[86:87], v[114:115], v[114:115] op_sel:[0,0,1] op_sel_hi:[1,0,1] neg_lo:[0,0,1] neg_hi:[0,0,1]
  v_lshlrev_b32 v88, 16, v252
  v_and_b32 v89, 0xffff0000, v252
  s_waitcnt lgkmcnt(8)
  v_pk_fma_f32 v[88:89], v[88:89], v[116:117], v[116:117] op_sel:[0,0,1] op_sel_hi:[1,0,1] neg_lo:[0,0,1] neg_hi:[0,0,1]
  v_lshlrev_b32 v90, 16, v253
  v_and_b32 v91, 0xffff0000, v253
  v_pk_fma_f32 v[90:91], v[90:91], v[116:117], v[116:117] op_sel:[0,0,1] op_sel_hi:[1,0,1] neg_lo:[0,0,1] neg_hi:[0,0,1]
  v_lshlrev_b32 v92, 16, v254
  v_and_b32 v93, 0xffff0000, v254
  v_pk_fma_f32 v[92:93], v[92:93], v[116:117], v[116:117] op_sel:[0,0,1] op_sel_hi:[1,0,1] neg_lo:[0,0,1] neg_hi:[0,0,1]
  v_lshlrev_b32 v94, 16, v255
  v_and_b32 v95, 0xffff0000, v255
  v_pk_fma_f32 v[94:95], v[94:95], v[116:117], v[116:117] op_sel:[0,0,1] op_sel_hi:[1,0,1] neg_lo:[0,0,1] neg_hi:[0,0,1]
  v_lshlrev_b32 v72, 16, v244
  v_and_b32 v73, 0xffff0000, v244
  v_pk_fma_f32 v[72:73], v[72:73], v[118:119], v[118:119] op_sel:[0,0,1] op_sel_hi:[1,0,1] neg_lo:[0,0,1] neg_hi:[0,0,1]
  v_lshlrev_b32 v74, 16, v245
  v_and_b32 v75, 0xffff0000, v245
  v_pk_fma_f32 v[74:75], v[74:75], v[118:119], v[118:119] op_sel:[0,0,1] op_sel_hi:[1,0,1] neg_lo:[0,0,1] neg_hi:[0,0,1]
  v_lshlrev_b32 v76, 16, v246
  v_and_b32 v77, 0xffff0000, v246
  v_pk_fma_f32 v[76:77], v[76:77], v[118:119], v[118:119] op_sel:[0,0,1] op_sel_hi:[1,0,1] neg_lo:[0,0,1] neg_hi:[0,0,1]
  v_lshlrev_b32 v78, 16, v247
  v_and_b32 v79, 0xffff0000, v247
  v_pk_fma_f32 v[78:79], v[78:79], v[118:119], v[118:119] op_sel:[0,0,1] op_sel_hi:[1,0,1] neg_lo:[0,0,1] neg_hi:[0,0,1]
  s_cmp_lg_u32 s3, 6
  s_cbranch_scc1 L_y2
  s_mov_b32 s63, 0
  s_waitcnt vmcnt(4)
  s_branch P_3_c
P_3:
  buffer_load_dwordx2 v[164:165], v230, s[8:11], s45 offen sc1
  buffer_load_dwordx2 v[166:167], v231, s[8:11], s45 offen sc1
  s_waitcnt vmcnt(0)
P_3_c:
  v_cmp_ne_u32 vcc, s24, v165
  v_cmp_ne_u32 s[38:39], s24, v167
  s_or_b64 vcc, vcc, s[38:39]
  s_cbranch_vccz P_3_x
  s_add_u32 s63, s63, 1
  s_cmp_lt_u32 s63, 65536
  s_cbranch_scc1 P_3
P_3_x:
  s_cmp_eq_u32 s41, 0
  s_mov_b32 s38, 0x07060100
  s_cmov_b32 s38, 0x05040100
  v_lshrrev_b32 v17, 16, v164
  v_perm_b32 v16, v166, v164, s38
  s_mov_b64 exec, 1
  v_mov_b32 v164, v16
  v_mov_b32 v166, v17
  s_mov_b64 exec, -1
  v_lshrrev_b32 v18, 7, v230
  v_pk_fma_f16 v164, v166, s50, v164 neg_hi:[0,1,0]
  ds_write_b32 v18, v164 offset:16384
L_y2:
  s_mov_b32 s63, 0
  s_waitcnt vmcnt(0)
  s_branch P_4_c
P_4:
  buffer_load_dwordx4 v[96:99], v4, s[8:11], s48 offen sc1
  buffer_load_dwordx4 v[100:103], v24, s[8:11], s33 offen sc1
  buffer_load_dwordx4 v[104:107], v4, s[8:11], s32 offen sc1
  buffer_load_dwordx4 v[108:111], v5, s[8:11], s49 offen sc1
  s_waitcnt vmcnt(0)
P_4_c:
  v_xor_b32 v96, v232, v96
  v_xor_b32 v97, v233, v97
  v_xor_b32 v98, v234, v98
  v_xor_b32 v99, v235, v99
  v_xor_b32 v100, v232, v100
  v_xor_b32 v101, v233, v101
  v_xor_b32 v102, v234, v102
  v_xor_b32 v103, v235, v103
  v_xor_b32 v104, v232, v104
  v_xor_b32 v105, v233, v105
  v_xor_b32 v106, v234, v106
  v_xor_b32 v107, v235, v107
  v_xor_b32 v108, v232, v108
  v_xor_b32 v109, v233, v109
  v_xor_b32 v110, v234, v110
  v_xor_b32 v111, v235, v111
  v_or3_b32 v16, v96, v97, v98
  v_or3_b32 v16, v16, v99, v100
  v_or3_b32 v16, v16, v101, v102
  v_or3_b32 v16, v16, v103, v104
  v_or3_b32 v16, v16, v105, v106
  v_or3_b32 v16, v16, v107, v108
  v_or3_b32 v16, v16, v109, v110
  v_or_b32 v16, v16, v111
  v_and_b32 v16, 0x30003, v16
  v_cmp_ne_u32 vcc, 0, v16
  s_cbranch_vccz P_4_x
  s_add_u32 s63, s63, 1
  s_cmp_lt_u32 s63, 65536
  s_cbranch_scc1 P_4
P_4_x:
  s_cmp_lg_u32 s3, 0
  s_cbranch_scc1 L_y3
  s_cmp_eq_u32 s41, 0
  s_cselect_b64 s[38:39], 0, -1
  s_mov_b64 exec, 0xffff
  v_cndmask_b32_e64 v16, v100, v102, s[38:39]
  v_cndmask_b32_e64 v17, v101, v103, s[38:39]
  v_mov_b32 v100, v98
  v_mov_b32 v101, v99
  v_mov_b32 v98, v16
  v_mov_b32 v99, v17
  v_mov_b32 v102, 0
  v_mov_b32 v103, 0
  s_mov_b64 exec, -1
L_y3:
  v_pk_fma_f16 v96, v100, s50, v96
  v_pk_fma_f16 v97, v101, s50, v97
  v_pk_fma_f16 v98, v102, s50, v98 neg_lo:[0,1,0] neg_hi:[0,1,0]
  v_pk_fma_f16 v99, v103, s50, v99 neg_lo:[0,1,0] neg_hi:[0,1,0]
  ds_write_b128 v6, v[96:99] offset:0
  v_pk_fma_f16 v104, v108, s50, v104
  v_pk_fma_f16 v105, v109, s50, v105
  v_pk_fma_f16 v106, v110, s50, v106 neg_lo:[0,1,0] neg_hi:[0,1,0]
  v_pk_fma_f16 v107, v111, s50, v107 neg_lo:[0,1,0] neg_hi:[0,1,0]
  ds_write_b128 v6, v[104:107] offset:8192
  v_mov_b32 v18, 0
  s_waitcnt lgkmcnt(0)
  s_barrier
  s_cmp_lg_u32 s51, 0
  s_cbranch_scc1 L_y4
  ds_read_b64_tr_b16 v[132:133], v7 offset:0
  ds_read_b64_tr_b16 v[134:135], v7 offset:512
  ds_read_b64_tr_b16 v[136:137], v7 offset:2048
  ds_read_b64_tr_b16 v[138:139], v7 offset:2560
  ds_read_b64_tr_b16 v[140:141], v7 offset:4096
  ds_read_b64_tr_b16 v[142:143], v7 offset:4608
  ds_read_b64_tr_b16 v[144:145], v7 offset:6144
  ds_read_b64_tr_b16 v[146:147], v7 offset:6656
  ds_read_b64_tr_b16 v[148:149], v7 offset:8192
  ds_read_b64_tr_b16 v[150:151], v7 offset:8704
  ds_read_b64_tr_b16 v[152:153], v7 offset:10240
  ds_read_b64_tr_b16 v[154:155], v7 offset:10752
  ds_read_b64_tr_b16 v[156:157], v7 offset:12288
  ds_read_b64_tr_b16 v[158:159], v7 offset:12800
  s_waitcnt lgkmcnt(12)
  v_mfma_f32_32x32x16_f16 v[208:223], v[132:135], v[32:35], 0
  ds_read_b64_tr_b16 v[160:161], v7 offset:14336
  ds_read_b64_tr_b16 v[162:163], v7 offset:14848
  s_waitcnt lgkmcnt(12)
  v_mfma_f32_32x32x16_f16 v[208:223], v[136:139], v[36:39], v[208:223]
  s_waitcnt lgkmcnt(10)
  v_mfma_f32_32x32x16_f16 v[208:223], v[140:143], v[40:43], v[208:223]
  s_waitcnt lgkmcnt(8)
  v_mfma_f32_32x32x16_f16 v[208:223], v[144:147], v[44:47], v[208:223]
  s_waitcnt lgkmcnt(6)
  v_mfma_f32_32x32x16_f16 v[208:223], v[148:151], v[48:51], v[208:223]
  s_waitcnt lgkmcnt(4)
  v_mfma_f32_32x32x16_f16 v[208:223], v[152:155], v[52:55], v[208:223]
  s_waitcnt lgkmcnt(2)
  v_mfma_f32_32x32x16_f16 v[208:223], v[156:159], v[56:59], v[208:223]
  s_waitcnt lgkmcnt(0)
  v_mfma_f32_32x32x16_f16 v[208:223], v[160:163], v[60:63], v[208:223]
  s_nop 11
  v_cvt_pk_f16_f32 v112, v221, v208
  v_cvt_pk_f16_f32 v113, v212, v216
  v_cvt_pk_f16_f32 v114, v220, v209
  v_cvt_pk_f16_f32 v115, v213, v217
  ds_write_b128 v9, v[112:115] offset:16896
  v_cvt_pk_f16_f32 v116, v210, v214
  v_cvt_pk_f16_f32 v117, v218, v222
  v_cvt_pk_f16_f32 v118, v211, v215
  v_cvt_pk_f16_f32 v119, v219, v223
  ds_write_b128 v9, v[116:119] offset:16912
  s_branch L_y5
L_y4:
  ds_read_b64_tr_b16 v[132:133], v7 offset:0
  ds_read_b64_tr_b16 v[134:135], v7 offset:512
  ds_read_b128 v[176:179], v8 offset:16384
  ds_read_b64_tr_b16 v[136:137], v7 offset:2048
  ds_read_b64_tr_b16 v[138:139], v7 offset:2560
  ds_read_b128 v[180:183], v8 offset:16416
  ds_read_b64_tr_b16 v[140:141], v7 offset:4096
  ds_read_b64_tr_b16 v[142:143], v7 offset:4608
  ds_read_b128 v[184:187], v8 offset:16448
  ds_read_b64_tr_b16 v[144:145], v7 offset:6144
  ds_read_b64_tr_b16 v[146:147], v7 offset:6656
  ds_read_b128 v[188:191], v8 offset:16480
  s_waitcnt lgkmcnt(10)
  v_mfma_f32_32x32x16_f16 v[208:223], v[132:135], v[32:35], 0
  ds_read_b64_tr_b16 v[148:149], v7 offset:8192
  ds_read_b64_tr_b16 v[150:151], v7 offset:8704
  ds_read_b128 v[192:195], v8 offset:16512
  s_waitcnt lgkmcnt(10)
  v_mfma_f32_32x32x16_f16 v[208:223], v[136:139], v[36:39], v[208:223]
  ds_read_b64_tr_b16 v[152:153], v7 offset:10240
  ds_read_b64_tr_b16 v[154:155], v7 offset:10752
  ds_read_b128 v[196:199], v8 offset:16544
  v_pk_mul_f16 v224, v32, v176
  v_pk_mul_f16 v225, v33, v177
  v_pk_mul_f16 v226, v34, v178
  v_pk_mul_f16 v227, v35, v179
  s_waitcnt lgkmcnt(10)
  v_mfma_f32_32x32x16_f16 v[208:223], v[140:143], v[40:43], v[208:223]
  ds_read_b64_tr_b16 v[156:157], v7 offset:12288
  ds_read_b64_tr_b16 v[158:159], v7 offset:12800
  ds_read_b128 v[200:203], v8 offset:16576
  v_pk_fma_f16 v224, v36, v180, v224
  v_pk_fma_f16 v225, v37, v181, v225
  v_pk_fma_f16 v226, v38, v182, v226
  v_pk_fma_f16 v227, v39, v183, v227
  s_waitcnt lgkmcnt(10)
  v_mfma_f32_32x32x16_f16 v[208:223], v[144:147], v[44:47], v[208:223]
  ds_read_b64_tr_b16 v[160:161], v7 offset:14336
  ds_read_b64_tr_b16 v[162:163], v7 offset:14848
  ds_read_b128 v[204:207], v8 offset:16608
  v_pk_fma_f16 v224, v40, v184, v224
  v_pk_fma_f16 v225, v41, v185, v225
  v_pk_fma_f16 v226, v42, v186, v226
  v_pk_fma_f16 v227, v43, v187, v227
  s_waitcnt lgkmcnt(10)
  v_mfma_f32_32x32x16_f16 v[208:223], v[148:151], v[48:51], v[208:223]
  v_pk_fma_f16 v224, v44, v188, v224
  v_pk_fma_f16 v225, v45, v189, v225
  v_pk_fma_f16 v226, v46, v190, v226
  v_pk_fma_f16 v227, v47, v191, v227
  s_waitcnt lgkmcnt(7)
  v_mfma_f32_32x32x16_f16 v[208:223], v[152:155], v[52:55], v[208:223]
  v_pk_fma_f16 v224, v48, v192, v224
  v_pk_fma_f16 v225, v49, v193, v225
  v_pk_fma_f16 v226, v50, v194, v226
  v_pk_fma_f16 v227, v51, v195, v227
  s_waitcnt lgkmcnt(4)
  v_mfma_f32_32x32x16_f16 v[208:223], v[156:159], v[56:59], v[208:223]
  v_pk_fma_f16 v224, v52, v196, v224
  v_pk_fma_f16 v225, v53, v197, v225
  v_pk_fma_f16 v226, v54, v198, v226
  v_pk_fma_f16 v227, v55, v199, v227
  s_waitcnt lgkmcnt(1)
  v_mfma_f32_32x32x16_f16 v[208:223], v[160:163], v[60:63], v[208:223]
  v_pk_fma_f16 v224, v56, v200, v224
  v_pk_fma_f16 v225, v57, v201, v225
  v_pk_fma_f16 v226, v58, v202, v226
  v_pk_fma_f16 v227, v59, v203, v227
  s_waitcnt lgkmcnt(0)
  v_pk_fma_f16 v224, v60, v204, v224
  v_pk_fma_f16 v225, v61, v205, v225
  v_pk_fma_f16 v226, v62, v206, v226
  v_pk_fma_f16 v227, v63, v207, v227
  s_mov_b32 s37, 0x3c003c00
  v_pk_add_f16 v224, v224, v225
  v_pk_add_f16 v226, v226, v227
  v_dot2c_f32_f16 v18, s37, v224
  v_dot2c_f32_f16 v18, s37, v226
  s_nop 2
  v_mov_b32 v19, v18
  s_nop 1
  v_permlane32_swap_b32 v18, v19
  v_add_f32 v18, v18, v19
  v_cvt_f16_f32 v18, v18
  ds_write_b16 v11, v18 offset:16896
  v_cvt_pk_f16_f32 v112, v221, v223
  v_cvt_pk_f16_f32 v113, v219, v215
  v_cvt_pk_f16_f32 v114, v211, v222
  v_cvt_pk_f16_f32 v115, v218, v214
  ds_write_b128 v9, v[112:115] offset:16896
  v_cvt_pk_f16_f32 v116, v210, v217
  v_cvt_pk_f16_f32 v117, v213, v209
  v_cvt_pk_f16_f32 v118, v220, v216
  v_cvt_pk_f16_f32 v119, v212, v208
  ds_write_b128 v9, v[116:119] offset:16912
L_y5:
  s_mov_b32 s37, 0x42800000
  s_or_b64 s[60:61], s[52:53], s[54:55]
  s_or_b64 s[38:39], s[56:57], s[58:59]
  s_waitcnt lgkmcnt(0)
  s_barrier
  ds_read_b128 v[96:99], v10 offset:16896
  ds_read_u16 v100, v10 offset:16912
  ds_read_b128 v[104:107], v10 offset:26112
  ds_read_u16 v108, v10 offset:26128
  s_or_b64 s[60:61], s[60:61], s[38:39]
  s_cbranch_scc1 L_sel
  s_waitcnt lgkmcnt(3)
  v_fma_mix_f32 v64, v96, s37, v64 op_sel:[0,0,0] op_sel_hi:[1,0,0]
  v_fma_mix_f32 v65, v96, s37, v65 op_sel:[1,0,0] op_sel_hi:[1,0,0]
  v_fma_mix_f32 v66, v97, s37, v66 op_sel:[0,0,0] op_sel_hi:[1,0,0]
  v_fma_mix_f32 v67, v97, s37, v67 op_sel:[1,0,0] op_sel_hi:[1,0,0]
  v_fma_mix_f32 v68, v98, s37, v68 op_sel:[0,0,0] op_sel_hi:[1,0,0]
  v_fma_mix_f32 v69, v98, s37, v69 op_sel:[1,0,0] op_sel_hi:[1,0,0]
  v_fma_mix_f32 v70, v99, s37, v70 op_sel:[0,0,0] op_sel_hi:[1,0,0]
  v_fma_mix_f32 v71, v99, s37, v71 op_sel:[1,0,0] op_sel_hi:[1,0,0]
  v_cvt_pk_bf16_f32 v132, v64, v65
  v_cvt_pk_bf16_f32 v133, v66, v67
  v_cvt_pk_bf16_f32 v134, v68, v69
  v_cvt_pk_bf16_f32 v135, v70, v71
  buffer_store_dwordx4 v[132:135], v20, s[12:15], 0 offen
  s_waitcnt lgkmcnt(2)
  v_fma_mix_f32 v72, v100, s37, v72 op_sel:[0,0,0] op_sel_hi:[1,0,0]
  v_fma_mix_f32 v73, v99, s37, v73 op_sel:[1,0,0] op_sel_hi:[1,0,0]
  v_fma_mix_f32 v74, v99, s37, v74 op_sel:[0,0,0] op_sel_hi:[1,0,0]
  v_fma_mix_f32 v75, v98, s37, v75 op_sel:[1,0,0] op_sel_hi:[1,0,0]
  v_fma_mix_f32 v76, v98, s37, v76 op_sel:[0,0,0] op_sel_hi:[1,0,0]
  v_fma_mix_f32 v77, v97, s37, v77 op_sel:[1,0,0] op_sel_hi:[1,0,0]
  v_fma_mix_f32 v78, v97, s37, v78 op_sel:[0,0,0] op_sel_hi:[1,0,0]
  v_fma_mix_f32 v79, v96, s37, v79 op_sel:[1,0,0] op_sel_hi:[1,0,0]
  v_cvt_pk_bf16_f32 v136, v72, v73
  v_cvt_pk_bf16_f32 v137, v74, v75
  v_cvt_pk_bf16_f32 v138, v76, v77
  v_cvt_pk_bf16_f32 v139, v78, v79
  buffer_store_dwordx4 v[136:139], v21, s[12:15], 0 offen
  s_waitcnt lgkmcnt(1)
  v_fma_mix_f32 v80, v104, s37, v80 op_sel:[0,0,0] op_sel_hi:[1,0,0]
  v_fma_mix_f32 v81, v104, s37, v81 op_sel:[1,0,0] op_sel_hi:[1,0,0]
  v_fma_mix_f32 v82, v105, s37, v82 op_sel:[0,0,0] op_sel_hi:[1,0,0]
  v_fma_mix_f32 v83, v105, s37, v83 op_sel:[1,0,0] op_sel_hi:[1,0,0]
  v_fma_mix_f32 v84, v106, s37, v84 op_sel:[0,0,0] op_sel_hi:[1,0,0]
  v_fma_mix_f32 v85, v106, s37, v85 op_sel:[1,0,0] op_sel_hi:[1,0,0]
  v_fma_mix_f32 v86, v107, s37, v86 op_sel:[0,0,0] op_sel_hi:[1,0,0]
  v_fma_mix_f32 v87, v107, s37, v87 op_sel:[1,0,0] op_sel_hi:[1,0,0]
  v_cvt_pk_bf16_f32 v140, v80, v81
  v_cvt_pk_bf16_f32 v141, v82, v83
  v_cvt_pk_bf16_f32 v142, v84, v85
  v_cvt_pk_bf16_f32 v143, v86, v87
  buffer_store_dwordx4 v[140:143], v22, s[12:15], 0 offen
  s_waitcnt lgkmcnt(0)
  v_fma_mix_f32 v88, v108, s37, v88 op_sel:[0,0,0] op_sel_hi:[1,0,0]
  v_fma_mix_f32 v89, v107, s37, v89 op_sel:[1,0,0] op_sel_hi:[1,0,0]
  v_fma_mix_f32 v90, v107, s37, v90 op_sel:[0,0,0] op_sel_hi:[1,0,0]
  v_fma_mix_f32 v91, v106, s37, v91 op_sel:[1,0,0] op_sel_hi:[1,0,0]
  v_fma_mix_f32 v92, v106, s37, v92 op_sel:[0,0,0] op_sel_hi:[1,0,0]
  v_fma_mix_f32 v93, v105, s37, v93 op_sel:[1,0,0] op_sel_hi:[1,0,0]
  v_fma_mix_f32 v94, v105, s37, v94 op_sel:[0,0,0] op_sel_hi:[1,0,0]
  v_fma_mix_f32 v95, v104, s37, v95 op_sel:[1,0,0] op_sel_hi:[1,0,0]
  v_cvt_pk_bf16_f32 v144, v88, v89
  v_cvt_pk_bf16_f32 v145, v90, v91
  v_cvt_pk_bf16_f32 v146, v92, v93
  v_cvt_pk_bf16_f32 v147, v94, v95
  buffer_store_dwordx4 v[144:147], v23, s[12:15], 0 offen
  s_branch L_fin
L_sel:
  s_waitcnt lgkmcnt(3)
  v_fma_mix_f32 v64, v96, s37, v64 op_sel:[0,0,0] op_sel_hi:[1,0,0]
  v_fma_mix_f32 v65, v96, s37, v65 op_sel:[1,0,0] op_sel_hi:[1,0,0]
  v_fma_mix_f32 v66, v97, s37, v66 op_sel:[0,0,0] op_sel_hi:[1,0,0]
  v_fma_mix_f32 v67, v97, s37, v67 op_sel:[1,0,0] op_sel_hi:[1,0,0]
  v_fma_mix_f32 v68, v98, s37, v68 op_sel:[0,0,0] op_sel_hi:[1,0,0]
  v_fma_mix_f32 v69, v98, s37, v69 op_sel:[1,0,0] op_sel_hi:[1,0,0]
  v_fma_mix_f32 v70, v99, s37, v70 op_sel:[0,0,0] op_sel_hi:[1,0,0]
  v_fma_mix_f32 v71, v99, s37, v71 op_sel:[1,0,0] op_sel_hi:[1,0,0]
  s_cmp_eq_u64 s[52:53], 0
  s_cbranch_scc1 L_selx0
  s_mov_b64 exec, s[52:53]
  v_lshrrev_b32 v16, 11, v172
  v_and_b32 v17, 2047, v172
  v_cmp_eq_u32 vcc, s47, v16
  v_lshlrev_b32 v17, 1, v17
  v_add_u32 v16, 4096, v17
  v_mov_b32 v18, 0xffffff00
  v_cndmask_b32_e64 v16, v17, v16, vcc
  s_mov_b32 s38, 4096
  v_and_or_b32 v176, v64, v18, s29
  v_and_or_b32 v177, v65, v18, s29
  v_and_or_b32 v178, v66, v18, s29
  v_and_or_b32 v179, v67, v18, s29
  v_and_or_b32 v180, v68, v18, s29
  v_and_or_b32 v181, v69, v18, s29
  v_and_or_b32 v182, v70, v18, s29
  v_and_or_b32 v183, v71, v18, s29
  buffer_store_dwordx4 v[176:179], v16, s[8:11], s38 offen sc1
  buffer_store_dwordx4 v[180:183], v16, s[8:11], s38 offen offset:16 sc1
  s_mov_b64 exec, -1
L_selx0:
  v_cvt_pk_bf16_f32 v132, v64, v65
  v_cvt_pk_bf16_f32 v133, v66, v67
  v_cvt_pk_bf16_f32 v134, v68, v69
  v_cvt_pk_bf16_f32 v135, v70, v71
  buffer_store_dwordx4 v[132:135], v20, s[12:15], 0 offen
  s_waitcnt lgkmcnt(2)
  v_fma_mix_f32 v72, v100, s37, v72 op_sel:[0,0,0] op_sel_hi:[1,0,0]
  v_fma_mix_f32 v73, v99, s37, v73 op_sel:[1,0,0] op_sel_hi:[1,0,0]
  v_fma_mix_f32 v74, v99, s37, v74 op_sel:[0,0,0] op_sel_hi:[1,0,0]
  v_fma_mix_f32 v75, v98, s37, v75 op_sel:[1,0,0] op_sel_hi:[1,0,0]
  v_fma_mix_f32 v76, v98, s37, v76 op_sel:[0,0,0] op_sel_hi:[1,0,0]
  v_fma_mix_f32 v77, v97, s37, v77 op_sel:[1,0,0] op_sel_hi:[1,0,0]
  v_fma_mix_f32 v78, v97, s37, v78 op_sel:[0,0,0] op_sel_hi:[1,0,0]
  v_fma_mix_f32 v79, v96, s37, v79 op_sel:[1,0,0] op_sel_hi:[1,0,0]
  s_cmp_eq_u64 s[54:55], 0
  s_cbranch_scc1 L_selx1
  s_mov_b64 exec, s[54:55]
  v_lshrrev_b32 v16, 11, v173
  v_and_b32 v17, 2047, v173
  v_cmp_eq_u32 vcc, s47, v16
  v_lshlrev_b32 v17, 1, v17
  v_add_u32 v16, 4096, v17
  v_mov_b32 v18, 0xffffff00
  v_cndmask_b32_e64 v16, v17, v16, vcc
  s_mov_b32 s38, 4096
  v_and_or_b32 v176, v72, v18, s29
  v_and_or_b32 v177, v73, v18, s29
  v_and_or_b32 v178, v74, v18, s29
  v_and_or_b32 v179, v75, v18, s29
  v_and_or_b32 v180, v76, v18, s29
  v_and_or_b32 v181, v77, v18, s29
  v_and_or_b32 v182, v78, v18, s29
  v_and_or_b32 v183, v79, v18, s29
  buffer_store_dwordx4 v[176:179], v16, s[8:11], s38 offen sc1
  buffer_store_dwordx4 v[180:183], v16, s[8:11], s38 offen offset:16 sc1
  s_mov_b64 exec, -1
L_selx1:
  v_cvt_pk_bf16_f32 v136, v72, v73
  v_cvt_pk_bf16_f32 v137, v74, v75
  v_cvt_pk_bf16_f32 v138, v76, v77
  v_cvt_pk_bf16_f32 v139, v78, v79
  buffer_store_dwordx4 v[136:139], v21, s[12:15], 0 offen
  s_waitcnt lgkmcnt(1)
  v_fma_mix_f32 v80, v104, s37, v80 op_sel:[0,0,0] op_sel_hi:[1,0,0]
  v_fma_mix_f32 v81, v104, s37, v81 op_sel:[1,0,0] op_sel_hi:[1,0,0]
  v_fma_mix_f32 v82, v105, s37, v82 op_sel:[0,0,0] op_sel_hi:[1,0,0]
  v_fma_mix_f32 v83, v105, s37, v83 op_sel:[1,0,0] op_sel_hi:[1,0,0]
  v_fma_mix_f32 v84, v106, s37, v84 op_sel:[0,0,0] op_sel_hi:[1,0,0]
  v_fma_mix_f32 v85, v106, s37, v85 op_sel:[1,0,0] op_sel_hi:[1,0,0]
  v_fma_mix_f32 v86, v107, s37, v86 op_sel:[0,0,0] op_sel_hi:[1,0,0]
  v_fma_mix_f32 v87, v107, s37, v87 op_sel:[1,0,0] op_sel_hi:[1,0,0]
  s_cmp_eq_u64 s[56:57], 0
  s_cbranch_scc1 L_selx2
  s_mov_b64 exec, s[56:57]
  v_lshrrev_b32 v16, 11, v174
  v_and_b32 v17, 2047, v174
  v_cmp_eq_u32 vcc, s47, v16
  v_lshlrev_b32 v17, 1, v17
  v_add_u32 v16, 4096, v17
  v_mov_b32 v18, 0xffffff00
  v_cndmask_b32_e64 v16, v17, v16, vcc
  s_mov_b32 s38, 4096
  v_and_or_b32 v176, v80, v18, s29
  v_and_or_b32 v177, v81, v18, s29
  v_and_or_b32 v178, v82, v18, s29
  v_and_or_b32 v179, v83, v18, s29
  v_and_or_b32 v180, v84, v18, s29
  v_and_or_b32 v181, v85, v18, s29
  v_and_or_b32 v182, v86, v18, s29
  v_and_or_b32 v183, v87, v18, s29
  buffer_store_dwordx4 v[176:179], v16, s[8:11], s38 offen sc1
  buffer_store_dwordx4 v[180:183], v16, s[8:11], s38 offen offset:16 sc1
  s_mov_b64 exec, -1
L_selx2:
  v_cvt_pk_bf16_f32 v140, v80, v81
  v_cvt_pk_bf16_f32 v141, v82, v83
  v_cvt_pk_bf16_f32 v142, v84, v85
  v_cvt_pk_bf16_f32 v143, v86, v87
  buffer_store_dwordx4 v[140:143], v22, s[12:15], 0 offen
  s_waitcnt lgkmcnt(0)
  v_fma_mix_f32 v88, v108, s37, v88 op_sel:[0,0,0] op_sel_hi:[1,0,0]
  v_fma_mix_f32 v89, v107, s37, v89 op_sel:[1,0,0] op_sel_hi:[1,0,0]
  v_fma_mix_f32 v90, v107, s37, v90 op_sel:[0,0,0] op_sel_hi:[1,0,0]
  v_fma_mix_f32 v91, v106, s37, v91 op_sel:[1,0,0] op_sel_hi:[1,0,0]
  v_fma_mix_f32 v92, v106, s37, v92 op_sel:[0,0,0] op_sel_hi:[1,0,0]
  v_fma_mix_f32 v93, v105, s37, v93 op_sel:[1,0,0] op_sel_hi:[1,0,0]
  v_fma_mix_f32 v94, v105, s37, v94 op_sel:[0,0,0] op_sel_hi:[1,0,0]
  v_fma_mix_f32 v95, v104, s37, v95 op_sel:[1,0,0] op_sel_hi:[1,0,0]
  s_cmp_eq_u64 s[58:59], 0
  s_cbranch_scc1 L_selx3
  s_mov_b64 exec, s[58:59]
  v_lshrrev_b32 v16, 11, v175
  v_and_b32 v17, 2047, v175
  v_cmp_eq_u32 vcc, s47, v16
  v_lshlrev_b32 v17, 1, v17
  v_add_u32 v16, 4096, v17
  v_mov_b32 v18, 0xffffff00
  v_cndmask_b32_e64 v16, v17, v16, vcc
  s_mov_b32 s38, 4096
  v_and_or_b32 v176, v88, v18, s29
  v_and_or_b32 v177, v89, v18, s29
  v_and_or_b32 v178, v90, v18, s29
  v_and_or_b32 v179, v91, v18, s29
  v_and_or_b32 v180, v92, v18, s29
  v_and_or_b32 v181, v93, v18, s29
  v_and_or_b32 v182, v94, v18, s29
  v_and_or_b32 v183, v95, v18, s29
  buffer_store_dwordx4 v[176:179], v16, s[8:11], s38 offen sc1
  buffer_store_dwordx4 v[180:183], v16, s[8:11], s38 offen offset:16 sc1
  s_mov_b64 exec, -1
L_selx3:
  v_cvt_pk_bf16_f32 v144, v88, v89
  v_cvt_pk_bf16_f32 v145, v90, v91
  v_cvt_pk_bf16_f32 v146, v92, v93
  v_cvt_pk_bf16_f32 v147, v94, v95
  buffer_store_dwordx4 v[144:147], v23, s[12:15], 0 offen
  s_branch L_fin
L_job2:
  s_mov_b32 s62, 1
  s_mov_b32 s56, 0
  s_mov_b32 s58, 0
  s_mov_b32 s57, s60
  s_mov_b32 s59, s61
  v_subrev_u32 v12, 2176, v12
  v_subrev_u32 v13, 2176, v13
  v_subrev_u32 v14, 2176, v14
  v_subrev_u32 v15, 2176, v15
  s_branch L_job
L_cw:
  s_setprio 2
  s_waitcnt lgkmcnt(12)
  v_pk_add_f32 v[28:29], v[28:29], v[30:31]
  v_pk_add_f32 v[68:69], v[68:69], v[70:71]
  v_pk_add_f32 v[28:29], v[28:29], v[68:69]
  v_add_f32 v68, v28, v29
  v_add_f32 v31, v28, v29
  s_nop 1
  v_permlane32_swap_b32 v68, v31
  v_mov_b32 v69, v31
  v_mul_f32 v29, 0x3a800000, v68
  v_mul_f32 v31, 0x3a800000, v31
  v_fma_f32 v31, -v29, v29, v31
  v_max_f32 v31, 0, v31
  v_cvt_pk_bf16_f32 v31, v31, v31
  v_and_b32 v31, 0xffff0000, v31
  v_add_f32 v31, 0x3727c5ac, v31
  v_cvt_pk_bf16_f32 v31, v31, v31
  v_and_b32 v31, 0xffff0000, v31
  v_sqrt_f32 v31, v31
  v_mov_b32 v18, s24
  v_cvt_pk_bf16_f32 v19, v29, v31
  v_and_b32 v16, 0xffff0000, v19
  v_rcp_f32 v16, v16
  v_lshlrev_b32 v17, 16, v19
  v_mul_f32 v17, v17, v16
  v_readlane_b32 s56, v16, s34
  v_readlane_b32 s57, v16, s35
  v_readlane_b32 s58, v17, s34
  v_readlane_b32 s59, v17, s35
  v_permlane16_swap_b32 v28, v68
  v_permlane16_swap_b32 v30, v69
  v_lshlrev_b32 v29, 16, v19
  v_fma_f32 v28, -v29, v30, v28
  v_mul_f32 v28, v28, v16
  v_cvt_pk_bf16_f32 v28, v28, v28
  s_lshl_b32 s37, s2, 4
  v_ashrrev_i32 v29, 31, v28
  s_add_u32 s37, s37, 98304
  v_or_b32 v29, 0x80000000, v29
  v_xor_b32 v28, v28, v29
  v_and_b32 v28, 0xffff0000, v28
  v_or_b32 v28, v28, v9
  v_mov_b32 v30, v18
  v_lshlrev_b32 v9, 11, v1
  v_min_u32_dpp v29, v28, v28 row_ror:8 row_mask:0xf bank_mask:0xf
  v_max_u32_dpp v28, v28, v28 row_ror:8 row_mask:0xf bank_mask:0xf
  s_nop 1
  v_min_u32_dpp v31, v28, v28 row_ror:4 row_mask:0xf bank_mask:0xf
  v_max_u32_dpp v29, v29, v29 row_ror:4 row_mask:0xf bank_mask:0xf
  v_max_u32_dpp v28, v28, v28 row_ror:4 row_mask:0xf bank_mask:0xf
  v_max_u32 v29, v29, v31
  s_nop 0
  v_min_u32_dpp v31, v28, v28 row_ror:2 row_mask:0xf bank_mask:0xf
  v_max_u32_dpp v29, v29, v29 row_ror:2 row_mask:0xf bank_mask:0xf
  v_max_u32_dpp v28, v28, v28 row_ror:2 row_mask:0xf bank_mask:0xf
  v_max_u32 v29, v29, v31
  s_nop 0
  v_min_u32_dpp v31, v28, v28 row_ror:1 row_mask:0xf bank_mask:0xf
  v_max_u32_dpp v29, v29, v29 row_ror:1 row_mask:0xf bank_mask:0xf
  v_max_u32_dpp v28, v28, v28 row_ror:1 row_mask:0xf bank_mask:0xf
  v_max_u32 v29, v29, v31
  s_mov_b64 exec, 0xff0000
  buffer_store_dwordx4 v[28:31], v9, s[8:11], s37 offen sc1
  s_mov_b64 exec, s[54:55]
  s_mov_b32 s37, 196608
  buffer_store_dwordx4 v[16:19], v10, s[8:11], s37 offen sc1
  s_mov_b64 exec, -1
  s_setprio 0
  v_mfma_f32_32x32x16_bf16 v[192:207], v[132:135], v[120:123], 0
  v_mfma_f32_32x32x16_bf16 v[192:207], v[136:139], v[124:127], v[192:207]
  v_mfma_f32_32x32x16_bf16 v[208:223], v[140:143], v[112:115], 0
  v_mfma_f32_32x32x16_bf16 v[208:223], v[144:147], v[116:119], v[208:223]
  v_mfma_f32_32x32x16_bf16 v[224:239], v[140:143], v[120:123], 0
  v_mfma_f32_32x32x16_bf16 v[224:239], v[144:147], v[124:127], v[224:239]
  s_branch L_nocand
L_ffn1:
  s_mov_b32 s6, 0x400000
  s_mov_b32 s10, 8388608
  s_mov_b32 s14, 0x400000
  s_mov_b32 s15, 0x20000
  s_mov_b32 s42, 7340032
  s_mov_b32 s43, 0x20000
  s_lshl_b32 s44, s30, 16
  v_mov_b32 v9, 0xffffff00
  v_bfe_u32 v16, v1, 2, 4
  v_and_b32 v17, 3, v1
  v_mul_u32_u24 v18, 2080, v16
  s_lshl_b32 s38, s3, 8
  v_lshl_add_u32 v11, v17, 3, s38
  v_add_u32 v11, v11, v18
  v_add_u32 v3, 118784, v11
  s_mul_i32 s37, s30, 4682
  s_lshr_b32 s37, s37, 16
  s_mul_i32 s38, s37, 14
  s_sub_u32 s38, s30, s38
  s_mul_i32 s37, s37, 114688
  s_lshl_b32 s38, s38, 9
  s_add_u32 s37, s37, s38
  s_add_u32 s48, s37, 3145728
  v_lshrrev_b32 v18, 5, v0
  v_and_b32 v19, 31, v0
  v_mul_u32_u24 v18, 7168, v18
  v_lshl_add_u32 v48, v19, 4, v18
  s_mov_b32 s36, 152384
  v_lshl_add_u32 v49, v0, 3, s36
  v_lshl_add_u32 v50, v1, 3, s36
  v_lshl_add_u32 v51, v0, 1, s36
  v_and_b32 v18, 1, v1
  v_and_b32 v19, 48, v1
  v_lshl_add_u32 v20, v18, 6, v19
  s_lshl_b32 s38, s3, 7
  s_add_u32 s38, s38, s36
  v_add_u32 v52, s38, v20
  s_lshl_b32 s38, s30, 13
  s_lshl_b32 s39, s3, 10
  s_add_u32 s38, s38, s39
  s_add_u32 s49, s38, 4194304
  v_lshrrev_b32 v20, 3, v0
  v_and_b32 v21, 7, v0
  v_lshlrev_b32 v20, 13, v20
  v_lshl_add_u32 v53, v21, 4, v20
  s_and_b32 s52, s30, 63
  s_lshl_b32 s50, s52, 7
  s_add_u32 s50, s50, 4194304
  s_add_u32 s51, s50, 524288
  s_mov_b32 s53, 4096
  v_lshl_add_u32 v54, v0, 2, s36
  v_lshl_add_u32 v55, v1, 2, s36
  s_and_b32 s45, s2, 7
  s_lshl_b32 s45, s45, 11
  s_add_u32 s45, s45, 131072
  s_waitcnt lgkmcnt(0)
  s_add_u32 s24, s24, 1
  s_and_b32 s29, s24, 0xff
  v_mov_b32 v10, s29
  v_mov_b32 v8, 0x40000000
  v_mov_b32 v7, 0
  s_not_b32 s36, s24
  v_mov_b32 v60, s36
  v_mov_b32 v61, s36
  v_mov_b32 v62, s36
  v_mov_b32 v63, s36
  s_cmp_lg_u32 s3, 7
  s_cbranch_scc1 L_f1
  s_waitcnt vmcnt(2)
  buffer_load_dwordx4 v[32:35], v2, s[8:11], s45 offen sc1
  buffer_load_dwordx4 v[36:39], v2, s[8:11], s45 offen offset:1024 sc1
  buffer_store_dwordx4 v[60:63], v2, s[8:11], s49 offen sc1
  s_and_b32 s36, s52, 62
  s_lshl_b32 s36, s36, 6
  s_add_u32 s36, s36, s53
  buffer_load_dword v59, off, s[8:11], s36 sc1
  s_add_u32 s36, s36, 4096
  buffer_load_dword v59, off, s[8:11], s36 sc1
  s_waitcnt vmcnt(5)
  s_barrier
  s_mov_b32 s63, 0
  s_waitcnt vmcnt(3)
  s_branch P_5_c
P_5:
  buffer_load_dwordx4 v[32:35], v2, s[8:11], s45 offen sc1
  buffer_load_dwordx4 v[36:39], v2, s[8:11], s45 offen offset:1024 sc1
  s_waitcnt vmcnt(0)
P_5_c:
  v_cmp_ne_u32 vcc, s24, v34
  v_cmp_ne_u32 s[38:39], s24, v38
  s_or_b64 vcc, vcc, s[38:39]
  s_cbranch_vccz P_5_x
  s_add_u32 s63, s63, 1
  s_cmp_lt_u32 s63, 65536
  s_cbranch_scc1 P_5
P_5_x:
  v_max_u32 v34, v32, v36
  v_min_u32 v38, v32, v36
  v_max3_u32 v35, v38, v33, v37
  s_nop 0
  v_min_u32_dpp v38, v34, v34 row_ror:8 row_mask:0xf bank_mask:0xf
  v_max_u32_dpp v35, v35, v35 row_ror:8 row_mask:0xf bank_mask:0xf
  v_max_u32_dpp v34, v34, v34 row_ror:8 row_mask:0xf bank_mask:0xf
  v_max_u32 v35, v35, v38
  s_nop 0
  v_min_u32_dpp v38, v34, v34 row_ror:4 row_mask:0xf bank_mask:0xf
  v_max_u32_dpp v35, v35, v35 row_ror:4 row_mask:0xf bank_mask:0xf
  v_max_u32_dpp v34, v34, v34 row_ror:4 row_mask:0xf bank_mask:0xf
  v_max_u32 v35, v35, v38
  s_nop 0
  v_min_u32_dpp v38, v34, v34 row_ror:2 row_mask:0xf bank_mask:0xf
  v_max_u32_dpp v35, v35, v35 row_ror:2 row_mask:0xf bank_mask:0xf
  v_max_u32_dpp v34, v34, v34 row_ror:2 row_mask:0xf bank_mask:0xf
  v_max_u32 v35, v35, v38
  s_nop 0
  v_min_u32_dpp v38, v34, v34 row_ror:1 row_mask:0xf bank_mask:0xf
  v_max_u32_dpp v35, v35, v35 row_ror:1 row_mask:0xf bank_mask:0xf
  v_max_u32_dpp v34, v34, v34 row_ror:1 row_mask:0xf bank_mask:0xf
  v_max_u32 v35, v35, v38
  s_nop 0
  v_min_u32_dpp v38, v34, v34 row_bcast:15 row_mask:0xa bank_mask:0xf
  v_max_u32_dpp v35, v35, v35 row_bcast:15 row_mask:0xa bank_mask:0xf
  v_max_u32_dpp v34, v34, v34 row_bcast:15 row_mask:0xa bank_mask:0xf
  v_max_u32 v35, v35, v38
  s_nop 0
  v_min_u32_dpp v38, v34, v34 row_bcast:31 row_mask:0xc bank_mask:0xf
  v_max_u32_dpp v35, v35, v35 row_bcast:31 row_mask:0xc bank_mask:0xf
  v_max_u32_dpp v34, v34, v34 row_bcast:31 row_mask:0xc bank_mask:0xf
  v_max_u32 v35, v35, v38
  v_readlane_b32 s46, v34, 63
  v_readlane_b32 s47, v35, 63
  s_and_b32 s36, s46, 0xffff
  s_sub_u32 s36, 0xffff, s36
  s_and_b32 s37, s47, 0xffff
  s_sub_u32 s37, 0xffff, s37
  s_lshl_b32 s38, s36, 11
  s_lshl_b32 s39, s37, 11
  s_lshl_b32 s33, s32, 7
  s_add_u32 s38, s38, s33
  s_add_u32 s39, s39, s33
  s_mov_b32 m0, 152064
  s_mov_b64 exec, 0xff
  buffer_load_dwordx4 v2, s[4:7], s38 offen lds
  s_mov_b32 m0, 152192
  s_and_b32 s33, s36, 15
  buffer_load_dwordx4 v2, s[4:7], s39 offen lds
  s_lshl_b32 s33, s33, 12
  s_and_b32 s36, s36, 0x7f0
  s_add_u32 s36, s36, s33
  s_add_u32 s36, s36, 196608
  s_and_b32 s33, s37, 15
  s_lshl_b32 s33, s33, 12
  s_and_b32 s37, s37, 0x7f0
  s_add_u32 s37, s37, s33
  s_add_u32 s37, s37, 196608
  s_mov_b64 exec, 1
  buffer_load_dwordx3 v[40:42], off, s[8:11], s36 sc1
  buffer_load_dwordx3 v[44:46], off, s[8:11], s37 sc1
  s_mov_b64 exec, -1
  s_cmp_ge_u32 s30, 112
  s_cbranch_scc1 L_f0
  s_mov_b32 m0, 118784
  s_mov_b32 s33, s44
  buffer_load_dwordx4 v2, s[40:43], s33 offen lds
  buffer_load_dwordx4 v2, s[40:43], s33 offen offset:1024 lds
  s_add_u32 m0, m0, 2080
  s_add_u32 s33, s33, 2048
  buffer_load_dwordx4 v2, s[40:43], s33 offen lds
  buffer_load_dwordx4 v2, s[40:43], s33 offen offset:1024 lds
  s_add_u32 m0, m0, 2080
  s_add_u32 s33, s33, 2048
  buffer_load_dwordx4 v2, s[40:43], s33 offen lds
  buffer_load_dwordx4 v2, s[40:43], s33 offen offset:1024 lds
  s_add_u32 m0, m0, 2080
  s_add_u32 s33, s33, 2048
  buffer_load_dwordx4 v2, s[40:43], s33 offen lds
  buffer_load_dwordx4 v2, s[40:43], s33 offen offset:1024 lds
  s_add_u32 m0, m0, 2080
  s_add_u32 s33, s33, 10240
  buffer_load_dwordx4 v2, s[40:43], s33 offen lds
  buffer_load_dwordx4 v2, s[40:43], s33 offen offset:1024 lds
  s_add_u32 m0, m0, 2080
  s_add_u32 s33, s33, 2048
  buffer_load_dwordx4 v2, s[40:43], s33 offen lds
  buffer_load_dwordx4 v2, s[40:43], s33 offen offset:1024 lds
  s_add_u32 m0, m0, 2080
  s_add_u32 s33, s33, 2048
  buffer_load_dwordx4 v2, s[40:43], s33 offen lds
  buffer_load_dwordx4 v2, s[40:43], s33 offen offset:1024 lds
  s_add_u32 m0, m0, 2080
  s_add_u32 s33, s33, 2048
  buffer_load_dwordx4 v2, s[40:43], s33 offen lds
  buffer_load_dwordx4 v2, s[40:43], s33 offen offset:1024 lds
  s_add_u32 m0, m0, 2080
  s_add_u32 s33, s33, 10240
  buffer_load_dwordx4 v2, s[40:43], s33 offen lds
  buffer_load_dwordx4 v2, s[40:43], s33 offen offset:1024 lds
  s_add_u32 m0, m0, 2080
  s_add_u32 s33, s33, 2048
  buffer_load_dwordx4 v2, s[40:43], s33 offen lds
  buffer_load_dwordx4 v2, s[40:43], s33 offen offset:1024 lds
  s_add_u32 m0, m0, 2080
  s_add_u32 s33, s33, 2048
  buffer_load_dwordx4 v2, s[40:43], s33 offen lds
  buffer_load_dwordx4 v2, s[40:43], s33 offen offset:1024 lds
  s_add_u32 m0, m0, 2080
  s_add_u32 s33, s33, 2048
  buffer_load_dwordx4 v2, s[40:43], s33 offen lds
  buffer_load_dwordx4 v2, s[40:43], s33 offen offset:1024 lds
  s_add_u32 m0, m0, 2080
  s_add_u32 s33, s33, 10240
  buffer_load_dwordx4 v2, s[40:43], s33 offen lds
  buffer_load_dwordx4 v2, s[40:43], s33 offen offset:1024 lds
  s_add_u32 m0, m0, 2080
  s_add_u32 s33, s33, 2048
  buffer_load_dwordx4 v2, s[40:43], s33 offen lds
  buffer_load_dwordx4 v2, s[40:43], s33 offen offset:1024 lds
  s_add_u32 m0, m0, 2080
  s_add_u32 s33, s33, 2048
  buffer_load_dwordx4 v2, s[40:43], s33 offen lds
  buffer_load_dwordx4 v2, s[40:43], s33 offen offset:1024 lds
  s_add_u32 m0, m0, 2080
  s_add_u32 s33, s33, 2048
  buffer_load_dwordx4 v2, s[40:43], s33 offen lds
  buffer_load_dwordx4 v2, s[40:43], s33 offen offset:1024 lds
  s_waitcnt vmcnt(32)
L_f0:
  s_mov_b64 exec, 1
  s_cmp_lt_u32 s30, 112
  s_cbranch_scc1 Q_6
  s_waitcnt vmcnt(0)
Q_6:
  s_mov_b32 s62, 0
  s_waitcnt vmcnt(63)
  s_branch P_7_c
P_7:
  buffer_load_dwordx3 v[40:42], off, s[8:11], s36 sc1
  buffer_load_dwordx3 v[44:46], off, s[8:11], s37 sc1
  s_waitcnt vmcnt(0)
P_7_c:
  v_cmp_ne_u32 vcc, s24, v42
  v_cmp_ne_u32 s[38:39], s24, v46
  s_or_b64 vcc, vcc, s[38:39]
  s_cbranch_vccz P_7_x
  s_add_u32 s62, s62, 1
  s_cmp_lt_u32 s62, 65536
  s_cbranch_scc1 P_7
P_7_x:
  v_mov_b32 v42, v41
  v_mov_b32 v41, v44
  v_mov_b32 v43, v45
  v_mov_b32 v44, 152320
  ds_write_b128 v44, v[40:43]
  s_waitcnt lgkmcnt(0)
  s_mov_b64 exec, -1
  s_barrier
  v_lshrrev_b32 v18, 5, v1
  v_mov_b32 v19, s47
  v_mov_b32 v20, s46
  s_nop 1
  v_mov_b32_dpp v19, v20 quad_perm:[0,1,2,3] row_mask:0x3 bank_mask:0xf
  s_lshr_b32 s38, s52, 1
  s_lshl_b32 s38, s38, 5
  s_and_b32 s39, s52, 1
  s_lshl_b32 s39, s39, 3
  s_add_u32 s38, s38, s39
  v_and_b32 v16, 16, v1
  v_add3_u32 v17, v21, v16, s38
  v_lshlrev_b32 v16, 12, v18
  v_lshl_add_u32 v7, v17, 2, v16
  v_ashrrev_i32 v16, 31, v19
  v_not_b32 v16, v16
  v_or_b32 v16, 0x80000000, v16
  v_xor_b32 v16, v16, v19
  v_and_b32 v16, 0xffff0000, v16
  v_mul_f32 v16, 0xbfb8aa3b, v16
  v_exp_f32 v16, v16
  v_and_b32 v19, 0xffff, v19
  v_add_f32 v16, 1.0, v16
  v_rcp_f32 v16, v16
  v_sub_u32 v19, 0xffff, v19
  v_lshlrev_b32 v19, 11, v19
  v_lshl_add_u32 v8, v17, 1, v19
  v_cvt_pk_bf16_f32 v16, v16, v16
  v_and_b32 v6, 0xffff0000, v16
  s_branch L_f2
L_f1:
  v_mul_u32_u24 v16, 928, v16
  s_lshl_b32 s36, s3, 7
  v_lshl_add_u32 v17, v17, 3, s36
  v_add_u32 v4, v16, v17
  v_add_u32 v5, 59392, v4
  v_lshl_add_u32 v6, v18, 7, v19
  v_add_u32 v6, 152064, v6
  v_mov_b32 v56, 152320
  s_mul_i32 s36, s30, 7168
  s_lshl_b32 s37, s3, 10
  s_add_u32 s36, s36, s37
  s_add_u32 s36, s36, 3145728
  buffer_store_dwordx4 v[60:63], v2, s[8:11], s36 offen sc1
  buffer_store_dwordx4 v[60:63], v2, s[8:11], s49 offen sc1
  v_mov_b32 v12, 0x3f803f80
  v_mov_b32 v13, 0x3f803f80
  v_mov_b32 v14, 0x3f803f80
  v_mov_b32 v15, 0x3f803f80
  s_waitcnt vmcnt(2)
  s_barrier
  ds_read_b64_tr_b16 v[64:65], v4 offset:0
  ds_read_b64_tr_b16 v[66:67], v4 offset:14848
  ds_read_b64_tr_b16 v[68:69], v4 offset:29696
  ds_read_b64_tr_b16 v[70:71], v4 offset:44544
  ds_read_b64_tr_b16 v[72:73], v5 offset:0
  ds_read_b64_tr_b16 v[74:75], v5 offset:14848
  ds_read_b64_tr_b16 v[76:77], v5 offset:29696
  ds_read_b64_tr_b16 v[78:79], v5 offset:44544
  ds_read_b64_tr_b16 v[80:81], v4 offset:32
  ds_read_b64_tr_b16 v[82:83], v4 offset:14880
  ds_read_b64_tr_b16 v[84:85], v4 offset:29728
  ds_read_b64_tr_b16 v[86:87], v4 offset:44576
  ds_read_b64_tr_b16 v[88:89], v5 offset:32
  ds_read_b64_tr_b16 v[90:91], v5 offset:14880
  ds_read_b64_tr_b16 v[92:93], v5 offset:29728
  ds_read_b64_tr_b16 v[94:95], v5 offset:44576
  ds_read_b64_tr_b16 v[96:97], v4 offset:64
  ds_read_b64_tr_b16 v[98:99], v4 offset:14912
  ds_read_b64_tr_b16 v[100:101], v4 offset:29760
  ds_read_b64_tr_b16 v[102:103], v4 offset:44608
  ds_read_b64_tr_b16 v[104:105], v5 offset:64
  ds_read_b64_tr_b16 v[106:107], v5 offset:14912
  ds_read_b64_tr_b16 v[108:109], v5 offset:29760
  ds_read_b64_tr_b16 v[110:111], v5 offset:44608
  ds_read_b64_tr_b16 v[112:113], v4 offset:96
  ds_read_b64_tr_b16 v[114:115], v4 offset:14944
  ds_read_b64_tr_b16 v[116:117], v4 offset:29792
  ds_read_b64_tr_b16 v[118:119], v4 offset:44640
  ds_read_b64_tr_b16 v[120:121], v5 offset:96
  ds_read_b64_tr_b16 v[122:123], v5 offset:14944
  ds_read_b64_tr_b16 v[124:125], v5 offset:29792
  ds_read_b64_tr_b16 v[126:127], v5 offset:44640
  s_waitcnt lgkmcnt(0)
  v_mfma_f32_16x16x32_bf16 v[128:131], v[12:15], v[64:67], 0
  v_mfma_f32_16x16x32_bf16 v[128:131], v[12:15], v[68:71], v[128:131]
  v_mfma_f32_16x16x32_bf16 v[132:135], v[12:15], v[72:75], 0
  v_mfma_f32_16x16x32_bf16 v[132:135], v[12:15], v[76:79], v[132:135]
  v_mfma_f32_16x16x32_bf16 v[136:139], v[12:15], v[80:83], 0
  v_mfma_f32_16x16x32_bf16 v[136:139], v[12:15], v[84:87], v[136:139]
  v_mfma_f32_16x16x32_bf16 v[140:143], v[12:15], v[88:91], 0
  v_mfma_f32_16x16x32_bf16 v[140:143], v[12:15], v[92:95], v[140:143]
  v_mfma_f32_16x16x32_bf16 v[144:147], v[12:15], v[96:99], 0
  v_mfma_f32_16x16x32_bf16 v[144:147], v[12:15], v[100:103], v[144:147]
  v_mfma_f32_16x16x32_bf16 v[148:151], v[12:15], v[104:107], 0
  v_mfma_f32_16x16x32_bf16 v[148:151], v[12:15], v[108:111], v[148:151]
  v_mfma_f32_16x16x32_bf16 v[152:155], v[12:15], v[112:115], 0
  v_mfma_f32_16x16x32_bf16 v[152:155], v[12:15], v[116:119], v[152:155]
  v_mfma_f32_16x16x32_bf16 v[156:159], v[12:15], v[120:123], 0
  v_mfma_f32_16x16x32_bf16 v[156:159], v[12:15], v[124:127], v[156:159]
  v_mov_b32 v16, v128
  s_nop 1
  v_mov_b32_dpp v16, v136 quad_perm:[0,1,2,3] row_mask:0x2 bank_mask:0xf
  s_nop 1
  v_mov_b32_dpp v16, v144 quad_perm:[0,1,2,3] row_mask:0x4 bank_mask:0xf
  s_nop 1
  v_mov_b32_dpp v16, v152 quad_perm:[0,1,2,3] row_mask:0x8 bank_mask:0xf
  v_mov_b32 v17, v132
  s_nop 1
  v_mov_b32_dpp v17, v140 quad_perm:[0,1,2,3] row_mask:0x2 bank_mask:0xf
  s_nop 1
  v_mov_b32_dpp v17, v148 quad_perm:[0,1,2,3] row_mask:0x4 bank_mask:0xf
  s_nop 1
  v_mov_b32_dpp v17, v156 quad_perm:[0,1,2,3] row_mask:0x8 bank_mask:0xf
  s_barrier
  ds_read_b128 v[20:23], v6
  ds_read_b128 v[24:27], v6 offset:64
  ds_read_b128 v[28:31], v56
  s_waitcnt lgkmcnt(2)
  v_mfma_f32_16x16x32_bf16 v[160:163], v[20:23], v[64:67], 0
  v_mfma_f32_16x16x32_bf16 v[164:167], v[20:23], v[72:75], 0
  v_mfma_f32_16x16x32_bf16 v[168:171], v[20:23], v[80:83], 0
  v_mfma_f32_16x16x32_bf16 v[172:175], v[20:23], v[88:91], 0
  v_mfma_f32_16x16x32_bf16 v[176:179], v[20:23], v[96:99], 0
  v_mfma_f32_16x16x32_bf16 v[180:183], v[20:23], v[104:107], 0
  v_mfma_f32_16x16x32_bf16 v[184:187], v[20:23], v[112:115], 0
  v_mfma_f32_16x16x32_bf16 v[188:191], v[20:23], v[120:123], 0
  s_waitcnt lgkmcnt(0)
  v_mfma_f32_16x16x32_bf16 v[160:163], v[24:27], v[68:71], v[160:163]
  v_pk_mul_f32 v[32:33], v[30:31], v[16:17] op_sel:[0,0] op_sel_hi:[1,0] neg_lo:[1,0] neg_hi:[1,0]
  s_nop 1
  v_mfma_f32_16x16x32_bf16 v[164:167], v[24:27], v[76:79], v[164:167]
  v_mul_f32 v34, -v30, v17
  v_mul_f32 v35, -v31, v17
  v_mfma_f32_16x16x32_bf16 v[168:171], v[24:27], v[84:87], v[168:171]
  v_mfma_f32_16x16x32_bf16 v[172:175], v[24:27], v[92:95], v[172:175]
  v_mfma_f32_16x16x32_bf16 v[176:179], v[24:27], v[100:103], v[176:179]
  v_mfma_f32_16x16x32_bf16 v[180:183], v[24:27], v[108:111], v[180:183]
  v_mfma_f32_16x16x32_bf16 v[184:187], v[24:27], v[116:119], v[184:187]
  v_mfma_f32_16x16x32_bf16 v[188:191], v[24:27], v[124:127], v[188:191]
  v_mov_b32 v40, v160
  s_nop 1
  v_mov_b32_dpp v40, v168 quad_perm:[0,1,2,3] row_mask:0x2 bank_mask:0xf
  s_nop 1
  v_mov_b32_dpp v40, v176 quad_perm:[0,1,2,3] row_mask:0x4 bank_mask:0xf
  s_nop 1
  v_mov_b32_dpp v40, v184 quad_perm:[0,1,2,3] row_mask:0x8 bank_mask:0xf
  v_mov_b32 v41, v161
  s_nop 1
  v_mov_b32_dpp v41, v169 quad_perm:[0,1,2,3] row_mask:0x2 bank_mask:0xf
  s_nop 1
  v_mov_b32_dpp v41, v177 quad_perm:[0,1,2,3] row_mask:0x4 bank_mask:0xf
  s_nop 1
  v_mov_b32_dpp v41, v185 quad_perm:[0,1,2,3] row_mask:0x8 bank_mask:0xf
  v_mov_b32 v42, v164
  s_nop 1
  v_mov_b32_dpp v42, v172 quad_perm:[0,1,2,3] row_mask:0x2 bank_mask:0xf
  s_nop 1
  v_mov_b32_dpp v42, v180 quad_perm:[0,1,2,3] row_mask:0x4 bank_mask:0xf
  s_nop 1
  v_mov_b32_dpp v42, v188 quad_perm:[0,1,2,3] row_mask:0x8 bank_mask:0xf
  v_mov_b32 v43, v165
  s_nop 1
  v_mov_b32_dpp v43, v173 quad_perm:[0,1,2,3] row_mask:0x2 bank_mask:0xf
  s_nop 1
  v_mov_b32_dpp v43, v181 quad_perm:[0,1,2,3] row_mask:0x4 bank_mask:0xf
  s_nop 1
  v_mov_b32_dpp v43, v189 quad_perm:[0,1,2,3] row_mask:0x8 bank_mask:0xf
  v_pk_fma_f32 v[40:41], v[40:41], v[28:29], v[32:33]
  v_pk_fma_f32 v[42:43], v[42:43], v[28:29], v[34:35]
  v_and_or_b32 v40, v40, v9, v10
  v_and_or_b32 v41, v41, v9, v10
  v_and_or_b32 v42, v42, v9, v10
  v_and_or_b32 v43, v43, v9, v10
  buffer_store_dwordx4 v[40:43], v2, s[8:11], s36 offen sc1
L_f2:
  s_cmp_ge_u32 s30, 112
  s_cbranch_scc1 L_red
  s_lshr_b32 s36, s3, 1
  s_lshl_b32 s36, s36, 3
  s_and_b32 s37, s3, 1
  s_lshl_b32 s37, s37, 1
  s_add_u32 s36, s36, s37
  s_add_u32 s36, s36, 4
  s_lshl_b32 s36, s36, 11
  s_add_u32 s33, s44, s36
  s_mul_i32 s36, s3, 4160
  s_add_u32 m0, s36, 0
  s_barrier
  buffer_load_dwordx4 v2, s[40:43], s33 offen lds
  buffer_load_dwordx4 v2, s[40:43], s33 offen offset:1024 lds
  s_add_u32 m0, m0, 2080
  s_add_u32 s33, s33, 2048
  buffer_load_dwordx4 v2, s[40:43], s33 offen lds
  buffer_load_dwordx4 v2, s[40:43], s33 offen offset:1024 lds
  s_mov_b32 s61, 0
P_8:
  buffer_load_dwordx4 v[24:27], v48, s[8:11], s48 offen sc1
  s_waitcnt vmcnt(0)
P_8_c:
  v_xor_b32 v24, v10, v24
  v_xor_b32 v25, v10, v25
  v_xor_b32 v26, v10, v26
  v_xor_b32 v27, v10, v27
  v_or3_b32 v16, v24, v25, v26
  v_or_b32 v16, v16, v27
  v_and_b32 v16, 0xff, v16
  v_cmp_ne_u32 vcc, 0, v16
  s_cbranch_vccz P_8_x
  s_add_u32 s61, s61, 1
  s_cmp_lt_u32 s61, 65536
  s_cbranch_scc1 P_8
P_8_x:
  v_permlane32_swap_b32 v24, v25
  v_permlane32_swap_b32 v26, v27
  v_add_f32 v24, v24, v25
  v_add_f32 v25, v26, v27
  ds_write_b64 v49, v[24:25] offset:0
  s_waitcnt vmcnt(0) lgkmcnt(0)
  s_barrier
  ds_read_b64 v[32:33], v50 offset:0
  ds_read_b64 v[34:35], v50 offset:512
  ds_read_b64 v[36:37], v50 offset:1024
  ds_read_b64 v[38:39], v50 offset:1536
  ds_read_b64 v[40:41], v50 offset:2048
  ds_read_b64 v[42:43], v50 offset:2560
  ds_read_b64 v[44:45], v50 offset:3072
  ds_read_b64 v[46:47], v50 offset:3584
  ds_read_b64_tr_b16 v[224:225], v3 offset:0
  ds_read_b64_tr_b16 v[226:227], v11 offset:0
  ds_read_b64_tr_b16 v[228:229], v3 offset:32
  ds_read_b64_tr_b16 v[230:231], v11 offset:32
  ds_read_b64_tr_b16 v[232:233], v3 offset:64
  ds_read_b64_tr_b16 v[234:235], v11 offset:64
  s_waitcnt lgkmcnt(12)
  v_pk_add_f32 v[32:33], v[32:33], v[34:35]
  s_waitcnt lgkmcnt(10)
  v_pk_add_f32 v[36:37], v[36:37], v[38:39]
  s_waitcnt lgkmcnt(8)
  v_pk_add_f32 v[40:41], v[40:41], v[42:43]
  s_waitcnt lgkmcnt(6)
  v_pk_add_f32 v[44:45], v[44:45], v[46:47]
  v_pk_add_f32 v[32:33], v[32:33], v[36:37]
  v_pk_add_f32 v[40:41], v[40:41], v[44:45]
  ds_read_b64_tr_b16 v[236:237], v3 offset:96
  ds_read_b64_tr_b16 v[238:239], v11 offset:96
  ds_read_b64_tr_b16 v[240:241], v3 offset:128
  ds_read_b64_tr_b16 v[242:243], v11 offset:128
  ds_read_b64_tr_b16 v[244:245], v3 offset:160
  ds_read_b64_tr_b16 v[246:247], v11 offset:160
  ds_read_b64_tr_b16 v[248:249], v3 offset:192
  v_pk_add_f32 v[32:33], v[32:33], v[40:41]
  v_cvt_pk_bf16_f32 v33, v32, v33
  v_lshlrev_b32 v32, 16, v33
  v_mul_f32 v34, 0xbfb8aa3b, v32
  v_exp_f32 v34, v34
  v_and_b32 v33, 0xffff0000, v33
  v_add_f32 v34, 1.0, v34
  v_rcp_f32 v34, v34
  s_waitcnt lgkmcnt(6)
  ds_read_b64_tr_b16 v[250:251], v11 offset:192
  ds_read_b64_tr_b16 v[252:253], v3 offset:224
  ds_read_b64_tr_b16 v[254:255], v11 offset:224
  v_mul_f32 v32, v32, v34
  v_cvt_pk_bf16_f32 v32, v32, v32
  v_and_b32 v32, 0xffff0000, v32
  v_mul_f32 v32, v32, v33
  v_cvt_pk_bf16_f32 v32, v32, v32
  ds_write_b16 v51, v32 offset:4096
  ds_read_b128 v[36:39], v52 offset:4096
  s_waitcnt lgkmcnt(0)
  v_mfma_f32_16x16x32_bf16 v[64:67], v[36:39], v[224:227], 0
  v_mfma_f32_16x16x32_bf16 v[68:71], v[36:39], v[228:231], 0
  v_mfma_f32_16x16x32_bf16 v[72:75], v[36:39], v[232:235], 0
  v_mfma_f32_16x16x32_bf16 v[76:79], v[36:39], v[236:239], 0
  v_mfma_f32_16x16x32_bf16 v[80:83], v[36:39], v[240:243], 0
  v_mfma_f32_16x16x32_bf16 v[84:87], v[36:39], v[244:247], 0
  v_mfma_f32_16x16x32_bf16 v[88:91], v[36:39], v[248:251], 0
  v_mfma_f32_16x16x32_bf16 v[92:95], v[36:39], v[252:255], 0
  s_nop 0
  v_mov_b32 v40, v64
  s_nop 1
  v_mov_b32_dpp v40, v72 quad_perm:[0,1,2,3] row_mask:0x2 bank_mask:0xf
  s_nop 1
  v_mov_b32_dpp v40, v80 quad_perm:[0,1,2,3] row_mask:0x4 bank_mask:0xf
  s_nop 1
  v_mov_b32_dpp v40, v88 quad_perm:[0,1,2,3] row_mask:0x8 bank_mask:0xf
  v_mov_b32 v41, v65
  s_nop 1
  v_mov_b32_dpp v41, v73 quad_perm:[0,1,2,3] row_mask:0x2 bank_mask:0xf
  s_nop 1
  v_mov_b32_dpp v41, v81 quad_perm:[0,1,2,3] row_mask:0x4 bank_mask:0xf
  s_nop 1
  v_mov_b32_dpp v41, v89 quad_perm:[0,1,2,3] row_mask:0x8 bank_mask:0xf
  v_mov_b32 v42, v68
  s_nop 1
  v_mov_b32_dpp v42, v76 quad_perm:[0,1,2,3] row_mask:0x2 bank_mask:0xf
  s_nop 1
  v_mov_b32_dpp v42, v84 quad_perm:[0,1,2,3] row_mask:0x4 bank_mask:0xf
  s_nop 1
  v_mov_b32_dpp v42, v92 quad_perm:[0,1,2,3] row_mask:0x8 bank_mask:0xf
  v_mov_b32 v43, v69
  s_nop 1
  v_mov_b32_dpp v43, v77 quad_perm:[0,1,2,3] row_mask:0x2 bank_mask:0xf
  s_nop 1
  v_mov_b32_dpp v43, v85 quad_perm:[0,1,2,3] row_mask:0x4 bank_mask:0xf
  s_nop 1
  v_mov_b32_dpp v43, v93 quad_perm:[0,1,2,3] row_mask:0x8 bank_mask:0xf
  v_and_or_b32 v40, v40, v9, v10
  v_and_or_b32 v41, v41, v9, v10
  v_and_or_b32 v42, v42, v9, v10
  v_and_or_b32 v43, v43, v9, v10
  buffer_store_dwordx4 v[40:43], v2, s[8:11], s49 offen sc1
L_red:
  s_sub_u32 s36, s30, 64
  s_cmp_ge_u32 s36, 64
  s_cbranch_scc1 L_fin
  s_cmp_ge_u32 s3, 6
  s_cbranch_scc1 L_r2
  s_mov_b32 s60, 0
P_9:
  buffer_load_dwordx4 v[20:23], v53, s[8:11], s50 offen sc1
  buffer_load_dwordx4 v[24:27], v53, s[8:11], s51 offen sc1
  s_waitcnt vmcnt(0)
P_9_c:
  v_xor_b32 v20, v10, v20
  v_xor_b32 v21, v10, v21
  v_xor_b32 v22, v10, v22
  v_xor_b32 v23, v10, v23
  v_xor_b32 v24, v10, v24
  v_xor_b32 v25, v10, v25
  v_xor_b32 v26, v10, v26
  v_xor_b32 v27, v10, v27
  v_or3_b32 v16, v20, v21, v22
  v_or3_b32 v16, v16, v23, v24
  v_or3_b32 v16, v16, v25, v26
  v_or_b32 v16, v16, v27
  v_and_b32 v16, 0xff, v16
  v_cmp_ne_u32 vcc, 0, v16
  s_cbranch_vccz P_9_x
  s_add_u32 s60, s60, 1
  s_cmp_lt_u32 s60, 65536
  s_cbranch_scc1 P_9
P_9_x:
  v_pk_add_f32 v[20:21], v[20:21], v[24:25]
  v_pk_add_f32 v[22:23], v[22:23], v[26:27]
  s_branch L_r3
L_r2:
  s_cmp_eq_u32 s3, 7
  s_cbranch_scc1 L_r4
  s_mov_b32 s60, 0
P_10:
  buffer_load_dwordx4 v[20:23], v53, s[8:11], s50 offen sc1
  s_waitcnt vmcnt(0)
P_10_c:
  v_xor_b32 v20, v10, v20
  v_xor_b32 v21, v10, v21
  v_xor_b32 v22, v10, v22
  v_xor_b32 v23, v10, v23
  v_or3_b32 v16, v20, v21, v22
  v_or_b32 v16, v16, v23
  v_and_b32 v16, 0xff, v16
  v_cmp_ne_u32 vcc, 0, v16
  s_cbranch_vccz P_10_x
  s_add_u32 s60, s60, 1
  s_cmp_lt_u32 s60, 65536
  s_cbranch_scc1 P_10
P_10_x:
  s_branch L_r3
L_r4:
  s_mov_b32 s60, 0
P_11:
  buffer_load_dwordx4 v[20:23], v53, s[8:11], s50 offen sc1
  buffer_load_dword v24, v7, s[8:11], s53 offen sc1
  s_waitcnt vmcnt(0)
P_11_c:
  v_xor_b32 v20, v10, v20
  v_xor_b32 v21, v10, v21
  v_xor_b32 v22, v10, v22
  v_xor_b32 v23, v10, v23
  v_xor_b32 v24, v10, v24
  v_or3_b32 v16, v20, v21, v22
  v_or3_b32 v16, v16, v23, v24
  v_and_b32 v16, 0xff, v16
  v_cmp_ne_u32 vcc, 0, v16
  s_cbranch_vccz P_11_x
  s_add_u32 s60, s60, 1
  s_cmp_lt_u32 s60, 65536
  s_cbranch_scc1 P_11
P_11_x:
L_r3:
  v_permlane32_swap_b32 v20, v21
  v_permlane32_swap_b32 v22, v23
  v_add_f32 v20, v20, v21
  v_add_f32 v22, v22, v23
  s_nop 1
  v_permlane16_swap_b32 v20, v22
  v_add_f32 v20, v20, v22
  s_nop 1
  v_add_f32_dpp v20, v20, v20 row_ror:8 row_mask:0xf bank_mask:0xf
  ds_write_b32 v54, v20 offset:5120
  s_waitcnt lgkmcnt(0)
  s_barrier
  s_cmp_lg_u32 s3, 7
  s_cbranch_scc1 L_fin
  ds_read_b32 v32, v55 offset:5120
  ds_read_b32 v33, v55 offset:5376
  ds_read_b32 v34, v55 offset:5632
  ds_read_b32 v35, v55 offset:5888
  ds_read_b32 v36, v55 offset:6144
  ds_read_b32 v37, v55 offset:6400
  ds_read_b32 v38, v55 offset:6656
  ds_read_b32 v39, v55 offset:6912
  s_waitcnt lgkmcnt(4)
  v_pk_add_f32 v[32:33], v[32:33], v[34:35]
  s_waitcnt lgkmcnt(0)
  v_pk_add_f32 v[36:37], v[36:37], v[38:39]
  v_pk_add_f32 v[32:33], v[32:33], v[36:37]
  v_add_f32 v20, v32, v33
  v_cvt_pk_bf16_f32 v20, v20, v20
  v_and_b32 v20, 0xffff0000, v20
  v_mul_f32 v20, v20, v6
  v_cvt_pk_bf16_f32 v20, v20, v20
  v_and_b32 v20, 0xffff0000, v20
  v_add_f32 v20, v20, v24
  v_cvt_pk_bf16_f32 v20, v20, v20
  s_mov_b32 exec_lo, 0xff00ff
  s_mov_b32 exec_hi, 0xff00ff
  buffer_store_short v20, v8, s[12:15], 0 offen
  s_cmp_lg_u32 s52, 0
  s_cbranch_scc1 L_fin
  v_mov_b32 v16, s24
  s_mov_b64 exec, 1
  buffer_store_dword v16, off, s[8:11], 0 sc1
L_fin:
L_end:
  s_endpgm
.section .rodata,"a"
.p2align 6
.amdhsa_kernel parallel_sum__spectral_fnet__moe_arch_mod__prompt_kernel
  .amdhsa_next_free_vgpr 256
  .amdhsa_next_free_sgpr 102
  .amdhsa_accum_offset 256
  .amdhsa_group_segment_fixed_size 0
  .amdhsa_kernarg_size 104
  .amdhsa_user_sgpr_count 2
  .amdhsa_user_sgpr_kernarg_segment_ptr 1
  .amdhsa_system_sgpr_workgroup_id_x 1
.end_amdhsa_kernel
.p2align 8
L_tab:
.quad 0x3fb23fa73f973f80,0x3f973fa73fb23fb5,0x3fa73fb53fa73f80,0xbf0b25003f0b3f80,0x3f493fa73fb23f80,0xbfb2bfa7bf492500,0x25003f803fb53f80,0xa5c0bf80bfb5bf80,0xbf80bf803f803f80,0xbf80bf803f803f80,0xbe8dbfa73f493f80,0x3f49bfa7be8d3fb5,0x3f0bbfb53f0b3f80,0x3fa7a708bfa73f80,0x3f97bfa73e8d3f80,0xbe8d3fa7bf9726f0
.quad 0xbf493f0b3fb23f80,0x3fb23f0bbf49bfb5,0xbfa725003fa73f80,0x3f0b3fb53f0bbf80,0xbfb2bf0b3f973f80,0xbf973f0b3fb2a5c0,0x3f803f803f803f80,0x3f803f803f803f80,0x3fb5bf8025003f80,0xbfb53f80a708bf80,0x3f97bf0bbe8d3f80,0xbe8dbf0b3f97bfb5,0x3f0ba5c0bf0b3f80,0x3fa7bfb53fa7bf80,0xbe8d3f0bbf493f80,0x3f49bf0b3e8da708
.quad 0x3e8d3f0b3f493f80,0xbf49bf0bbe8d2500,0xbf0b25003f0b3f80,0xbfa7bfb5bfa7bf80,0xbf97bf0b3e8d3f80,0x3e8dbf0bbf97bfb5,0xbfb5bf8025003f80,0x3fb53f80a580bf80,0x3f80bf80bf803f80,0x3f80bf80bf803f80,0x3fb2bf0bbf973f80,0x3f973f0bbfb225c0,0x3fa7a580bfa73f80,0xbf0b3fb5bf0bbf80,0x3f493f0bbfb23f80,0xbfb23f0b3f49bfb5
.quad 0xbf97bfa7be8d3f80,0x3e8d3fa73f97a580,0xbf0bbfb5bf0b3f80,0xbfa725c03fa73f80,0x3e8dbfa7bf493f80,0xbf49bfa73e8d3fb5,0xbf803f80bf803f80,0xbf803f80bf803f80,0x25c03f80bfb53f80,0x25c0bf803fb5bf80,0xbf493fa7bfb23f80,0x3fb2bfa73f492660,0xbfa73fb5bfa73f80,0x3f0b25c0bf0b3f80,0xbfb23fa7bf973f80,0xbf973fa7bfb23fb5
.quad 0x3e8d3f0b3f493f80,0xbf49bf0bbe8d2500,0xbfa7bfb5bfa7bf80,0x3f0ba5c0bf0bbf80,0x3f973f0bbe8dbf80,0xbe8d3f0b3f973fb5,0x26f03f803fb53f80,0xa708bf80bfb5bf80,0xbf80bf803f803f80,0xbf80bf803f803f80,0x3fb2bf0bbf973f80,0x3f973f0bbfb22728,0xbf0b3fb5bf0bbf80,0xbfa727483fa7bf80,0xbf49bf0b3fb2bf80,0x3fb2bf0bbf493fb5
.quad 0xbf97bfa7be8d3f80,0x3e8d3fa73f97a708,0x3fa7a708bfa7bf80,0xbf0bbfb5bf0b3f80,0xbe8d3fa73f49bf80,0x3f493fa7be8dbfb5,0x3f803f803f803f80,0x3f803f803f803f80,0x3fb5bf8027283f80,0xbfb53f802718bf80,0xbf493fa7bfb23f80,0x3fb2bfa73f49a758,0xbf0b27483f0bbf80,0xbfa73fb5bfa73f80,0x3fb2bfa73f97bf80,0x3f97bfa73fb2bfb5
.quad 0xbfb2bfa7bf97bf80,0xbf97bfa7bfb2bfb5,0x3f0ba580bf0bbf80,0x3fa73fb53fa73f80,0x3f493fa73fb23f80,0xbfb2bfa7bf4925c0,0xbfb5bf8025c03f80,0x3fb53f802660bf80,0x3f80bf80bf803f80,0x3f80bf80bf803f80,0x3e8d3fa7bf49bf80,0xbf493fa73e8dbfb5,0xbfa7a5003fa7bf80,0x3f0bbfb53f0b3f80,0x3f97bfa73e8d3f80,0xbe8d3fa7bf972500
.quad 0x3f49bf0bbfb2bf80,0xbfb2bf0b3f493fb5,0x3f0b3fb53f0bbf80,0x3fa725c0bfa7bf80,0xbfb2bf0b3f973f80,0xbf973f0b3fb225c0,0xbf803f80bf803f80,0xbf803f80bf803f80,0x27bc3f80bfb53f80,0xa842bf803fb5bf80,0xbf973f0b3e8dbf80,0x3e8d3f0bbf973fb5,0x3fa7bfb53fa7bf80,0xbf0b27d43f0bbf80,0xbe8d3f0bbf493f80,0x3f49bf0b3e8da660
.quad 0xbfb2bfa7bf97bf80,0xbf97bfa7bfb2bfb5,0x3fa73fb53fa73f80,0xbf0b26f03f0b3f80,0xbf49bfa7bfb2bf80,0x3fb23fa73f49a708,0x27183f803fb53f80,0xa728bf80bfb5bf80,0xbf80bf803f803f80,0xbf80bf803f803f80,0x3e8d3fa7bf49bf80,0xbf493fa73e8dbfb5,0x3f0bbfb53f0b3f80,0x3fa7a81cbfa73f80,0xbf973fa7be8dbf80,0x3e8dbfa73f9726d0
.quad 0x3f49bf0bbfb2bf80,0xbfb2bf0b3f493fb5,0xbfa727283fa73f80,0x3f0b3fb53f0bbf80,0x3fb23f0bbf97bf80,0x3f97bf0bbfb22748,0x3f803f803f803f80,0x3f803f803f803f80,0x3fb5bf80a7ec3f80,0xbfb53f802690bf80,0xbf973f0b3e8dbf80,0x3e8d3f0bbf973fb5,0x3f0b2690bf0b3f80,0x3fa7bfb53fa7bf80,0x3e8dbf0b3f49bf80,0xbf493f0bbe8d27a4
.quad 0xbe8dbf0bbf49bf80,0x3f493f0b3e8da580,0xbf0b25c03f0b3f80,0xbfa7bfb5bfa7bf80,0x3f973f0bbe8dbf80,0xbe8d3f0b3f973fb5,0xbfb5bf80a6203f80,0x3fb53f8025c0bf80,0x3f80bf80bf803f80,0x3f80bf80bf803f80,0xbfb23f0b3f97bf80,0xbf97bf0b3fb2a660,0x3fa7a660bfa73f80,0xbf0b3fb5bf0bbf80,0xbf49bf0b3fb2bf80,0x3fb2bf0bbf493fb5
.quad 0x3f973fa73e8dbf80,0xbe8dbfa7bf97a500,0xbf0bbfb5bf0b3f80,0xbfa727bc3fa73f80,0xbe8d3fa73f49bf80,0x3f493fa7be8dbfb5,0xbf803f80bf803f80,0xbf803f80bf803f80,0x27e43f80bfb53f80,0xa6f0bf803fb5bf80,0x3f49bfa73fb2bf80,0xbfb23fa7bf4927ec,0xbfa73fb5bfa73f80,0x3f0ba85abf0b3f80,0x3fb2bfa73f97bf80,0x3f97bfa73fb2bfb5
.quad 0xbe8dbf0bbf49bf80,0x3f493f0b3e8da5c0,0xbfa7bfb5bfa7bf80,0x3f0ba708bf0bbf80,0xbf97bf0b3e8d3f80,0x3e8dbf0bbf97bfb5,0x27283f803fb53f80,0xa738bf80bfb5bf80,0xbf80bf803f803f80,0xbf80bf803f803f80,0xbfb23f0b3f97bf80,0xbf97bf0b3fb22690,0xbf0b3fb5bf0bbf80,0xbfa727a43fa7bf80,0x3f493f0bbfb23f80,0xbfb23f0b3f49bfb5
.quad 0x3f973fa73e8dbf80,0xbe8dbfa7bf972748,0x3fa72718bfa7bf80,0xbf0bbfb5bf0b3f80,0x3e8dbfa7bf493f80,0xbf49bfa73e8d3fb5,0x3f803f803f803f80,0x3f803f803f803f80,0x3fb5bf8027a43f80,0xbfb53f80a836bf80,0x3f49bfa73fb2bf80,0xbfb23fa7bf4927bc,0xbf0ba8873f0bbf80,0xbfa73fb5bfa73f80,0xbfb23fa7bf973f80,0xbf973fa7bfb23fb5
.quad 0x3fb23fa73f973f80,0x3f973fa73fb23fb5,0x3f0b2660bf0bbf80,0x3fa73fb53fa73f80,0xbf49bfa7bfb2bf80,0x3fb23fa73f4925c0,0xbfb5bf80a5003f80,0x3fb53f800000bf80,0x3f80bf80bf803f80,0x3f80bf80bf803f80,0xbe8dbfa73f493f80,0x3f49bfa7be8d3fb5,0xbfa7a7783fa7bf80,0x3f0bbfb53f0b3f80,0xbf973fa7be8dbf80,0x3e8dbfa73f97a718
.quad 0xbf493f0b3fb23f80,0x3fb23f0bbf49bfb5,0x3f0b3fb53f0bbf80,0x3fa7a842bfa7bf80,0x3fb23f0bbf97bf80,0x3f97bf0bbfb227d4,0xbf803f80bf803f80,0xbf803f80bf803f80,0x28023f80bfb53f80,0xa866bf803fb5bf80,0x3f97bf0bbe8d3f80,0xbe8dbf0b3f97bfb5,0x3fa7bfb53fa7bf80,0xbf0b28a53f0bbf80,0x3e8dbf0b3f49bf80,0xbf493f0bbe8da6f0
.quad 0x3e8d3f0b3f493f80,0xbf49bf0bbe8d2500,0xbf0b25003f0b3f80,0xbfa7bfb5bfa7bf80,0xbf97bf0b3e8d3f80,0x3e8dbf0bbf97bfb5,0xbfb5bf8025003f80,0x3fb53f80a580bf80,0x3f80bf80bf803f80,0x3f80bf80bf803f80,0x3fb2bf0bbf973f80,0x3f973f0bbfb225c0,0x3fa7a580bfa73f80,0xbf0b3fb5bf0bbf80,0x3f493f0bbfb23f80,0xbfb23f0b3f49bfb5
.quad 0xbf97bfa7be8d3f80,0x3e8d3fa73f97a580,0xbf0bbfb5bf0b3f80,0xbfa725c03fa73f80,0x3e8dbfa7bf493f80,0xbf49bfa73e8d3fb5,0x3f803f803f803f80,0x3f803f803f803f80,0x25c03f80bfb53f80,0x25c0bf803fb5bf80,0xbf493fa7bfb23f80,0x3fb2bfa73f492660,0xbfa73fb5bfa73f80,0x3f0b25c0bf0b3f80,0xbfb23fa7bf973f80,0xbf973fa7bfb23fb5
.quad 0x3fb23fa73f973f80,0x3f973fa73fb23fb5,0x3fa73fb53fa73f80,0xbf0b25003f0b3f80,0x3f493fa73fb23f80,0xbfb2bfa7bf492500,0x25003f803fb53f80,0xa5c0bf80bfb5bf80,0xbf80bf803f803f80,0xbf80bf803f803f80,0xbe8dbfa73f493f80,0x3f49bfa7be8d3fb5,0x3f0bbfb53f0b3f80,0x3fa7a708bfa73f80,0x3f97bfa73e8d3f80,0xbe8d3fa7bf9726f0
.quad 0xbf493f0b3fb23f80,0x3fb23f0bbf49bfb5,0xbfa725003fa73f80,0x3f0b3fb53f0bbf80,0xbfb2bf0b3f973f80,0xbf973f0b3fb2a5c0,0xbf803f80bf803f80,0xbf803f80bf803f80,0x3fb5bf8025003f80,0xbfb53f80a708bf80,0x3f97bf0bbe8d3f80,0xbe8dbf0b3f97bfb5,0x3f0ba5c0bf0b3f80,0x3fa7bfb53fa7bf80,0xbe8d3f0bbf493f80,0x3f49bf0b3e8da708
.quad 0xbfb2bfa7bf97bf80,0xbf97bfa7bfb2bfb5,0x3f0ba580bf0bbf80,0x3fa73fb53fa73f80,0x3f493fa73fb23f80,0xbfb2bfa7bf4925c0,0xbfb5bf8025c03f80,0x3fb53f802660bf80,0x3f80bf80bf803f80,0x3f80bf80bf803f80,0x3e8d3fa7bf49bf80,0xbf493fa73e8dbfb5,0xbfa7a5003fa7bf80,0x3f0bbfb53f0b3f80,0x3f97bfa73e8d3f80,0xbe8d3fa7bf972500
.quad 0x3f49bf0bbfb2bf80,0xbfb2bf0b3f493fb5,0x3f0b3fb53f0bbf80,0x3fa725c0bfa7bf80,0xbfb2bf0b3f973f80,0xbf973f0b3fb225c0,0x3f803f803f803f80,0x3f803f803f803f80,0x27bc3f80bfb53f80,0xa842bf803fb5bf80,0xbf973f0b3e8dbf80,0x3e8d3f0bbf973fb5,0x3fa7bfb53fa7bf80,0xbf0b27d43f0bbf80,0xbe8d3f0bbf493f80,0x3f49bf0b3e8da660
.quad 0x3e8d3f0b3f493f80,0xbf49bf0bbe8d2500,0xbfa7bfb5bfa7bf80,0x3f0ba5c0bf0bbf80,0x3f973f0bbe8dbf80,0xbe8d3f0b3f973fb5,0x26f03f803fb53f80,0xa708bf80bfb5bf80,0xbf80bf803f803f80,0xbf80bf803f803f80,0x3fb2bf0bbf973f80,0x3f973f0bbfb22728,0xbf0b3fb5bf0bbf80,0xbfa727483fa7bf80,0xbf49bf0b3fb2bf80,0x3fb2bf0bbf493fb5
.quad 0xbf97bfa7be8d3f80,0x3e8d3fa73f97a708,0x3fa7a708bfa7bf80,0xbf0bbfb5bf0b3f80,0xbe8d3fa73f49bf80,0x3f493fa7be8dbfb5,0xbf803f80bf803f80,0xbf803f80bf803f80,0x3fb5bf8027283f80,0xbfb53f802718bf80,0xbf493fa7bfb23f80,0x3fb2bfa73f49a758,0xbf0b27483f0bbf80,0xbfa73fb5bfa73f80,0x3fb2bfa73f97bf80,0x3f97bfa73fb2bfb5
.quad 0xbe8dbf0bbf49bf80,0x3f493f0b3e8da580,0xbf0b25c03f0b3f80,0xbfa7bfb5bfa7bf80,0x3f973f0bbe8dbf80,0xbe8d3f0b3f973fb5,0xbfb5bf80a6203f80,0x3fb53f8025c0bf80,0x3f80bf80bf803f80,0x3f80bf80bf803f80,0xbfb23f0b3f97bf80,0xbf97bf0b3fb2a660,0x3fa7a660bfa73f80,0xbf0b3fb5bf0bbf80,0xbf49bf0b3fb2bf80,0x3fb2bf0bbf493fb5
.quad 0x3f973fa73e8dbf80,0xbe8dbfa7bf97a500,0xbf0bbfb5bf0b3f80,0xbfa727bc3fa73f80,0xbe8d3fa73f49bf80,0x3f493fa7be8dbfb5,0x3f803f803f803f80,0x3f803f803f803f80,0x27e43f80bfb53f80,0xa6f0bf803fb5bf80,0x3f49bfa73fb2bf80,0xbfb23fa7bf4927ec,0xbfa73fb5bfa73f80,0x3f0ba85abf0b3f80,0x3fb2bfa73f97bf80,0x3f97bfa73fb2bfb5
.quad 0xbfb2bfa7bf97bf80,0xbf97bfa7bfb2bfb5,0x3fa73fb53fa73f80,0xbf0b26f03f0b3f80,0xbf49bfa7bfb2bf80,0x3fb23fa73f49a708,0x27183f803fb53f80,0xa728bf80bfb5bf80,0xbf80bf803f803f80,0xbf80bf803f803f80,0x3e8d3fa7bf49bf80,0xbf493fa73e8dbfb5,0x3f0bbfb53f0b3f80,0x3fa7a81cbfa73f80,0xbf973fa7be8dbf80,0x3e8dbfa73f9726d0
.quad 0x3f49bf0bbfb2bf80,0xbfb2bf0b3f493fb5,0xbfa727283fa73f80,0x3f0b3fb53f0bbf80,0x3fb23f0bbf97bf80,0x3f97bf0bbfb22748,0xbf803f80bf803f80,0xbf803f80bf803f80,0x3fb5bf80a7ec3f80,0xbfb53f802690bf80,0xbf973f0b3e8dbf80,0x3e8d3f0bbf973fb5,0x3f0b2690bf0b3f80,0x3fa7bfb53fa7bf80,0x3e8dbf0b3f49bf80,0xbf493f0bbe8d27a4
.quad 0x3fb23fa73f973f80,0x3f973fa73fb23fb5,0x3f0b2660bf0bbf80,0x3fa73fb53fa73f80,0xbf49bfa7bfb2bf80,0x3fb23fa73f4925c0,0xbfb5bf80a5003f80,0x3fb53f800000bf80,0x3f80bf80bf803f80,0x3f80bf80bf803f80,0xbe8dbfa73f493f80,0x3f49bfa7be8d3fb5,0xbfa7a7783fa7bf80,0x3f0bbfb53f0b3f80,0xbf973fa7be8dbf80,0x3e8dbfa73f97a718
.quad 0xbf493f0b3fb23f80,0x3fb23f0bbf49bfb5,0x3f0b3fb53f0bbf80,0x3fa7a842bfa7bf80,0x3fb23f0bbf97bf80,0x3f97bf0bbfb227d4,0x3f803f803f803f80,0x3f803f803f803f80,0x28023f80bfb53f80,0xa866bf803fb5bf80,0x3f97bf0bbe8d3f80,0xbe8dbf0b3f97bfb5,0x3fa7bfb53fa7bf80,0xbf0b28a53f0bbf80,0x3e8dbf0b3f49bf80,0xbf493f0bbe8da6f0
.quad 0xbe8dbf0bbf49bf80,0x3f493f0b3e8da5c0,0xbfa7bfb5bfa7bf80,0x3f0ba708bf0bbf80,0xbf97bf0b3e8d3f80,0x3e8dbf0bbf97bfb5,0x27283f803fb53f80,0xa738bf80bfb5bf80,0xbf80bf803f803f80,0xbf80bf803f803f80,0xbfb23f0b3f97bf80,0xbf97bf0b3fb22690,0xbf0b3fb5bf0bbf80,0xbfa727a43fa7bf80,0x3f493f0bbfb23f80,0xbfb23f0b3f49bfb5
.quad 0x3f973fa73e8dbf80,0xbe8dbfa7bf972748,0x3fa72718bfa7bf80,0xbf0bbfb5bf0b3f80,0x3e8dbfa7bf493f80,0xbf49bfa73e8d3fb5,0xbf803f80bf803f80,0xbf803f80bf803f80,0x3fb5bf8027a43f80,0xbfb53f80a836bf80,0x3f49bfa73fb2bf80,0xbfb23fa7bf4927bc,0xbf0ba8873f0bbf80,0xbfa73fb5bfa73f80,0xbfb23fa7bf973f80,0xbf973fa7bfb23fb5
.quad 0x3c003c003c003c00,0x24b622481e480000,0x3bff3bff3c003c00,0x28b6264822480000,0x3bfd3bff3c003c00,0x2b1128b624b60000,0x3bfa3bfe3bff3c00,0x2cb52a4826480000,0x3bea3bf63bfe3c00,0x30b22e462a480000,0x3be43bf43bfd3c00,0x31472f0e2b110000,0x3bdd3bf13bfc3c00,0x31db2fd62bd90000,0x3bd63bed3bfb3c00,0x326f304e2c510000
.quad 0x3bf73bfc3bff3c00,0x2de22bd927da0000,0x3bf43bfa3bff3c00,0x2f0e2cb528b60000,0x3bef3bf83bfe3c00,0x301d2d7e297f0000,0x3c003c003c003c00,0,0x3bce3bea3bfa3c00,0x330330b22cb50000,0x3bc63be63bf93c00,0x339631152d1a0000,0x3bbc3be23bf83c00,0x341431792d7e0000,0x3bb23bdd3bf73c00,0x345d31db2de20000
.quad 0x3c003c003c003c00,0xa4b6a2489e488000,0x3bff3bff3c003c00,0xa8b6a648a2488000,0x3bfd3bff3c003c00,0xab11a8b6a4b68000,0x3bfa3bfe3bff3c00,0xacb5aa48a6488000,0x3bea3bf63bfe3c00,0xb0b2ae46aa488000,0x3be43bf43bfd3c00,0xb147af0eab118000,0x3bdd3bf13bfc3c00,0xb1dbafd6abd98000,0x3bd63bed3bfb3c00,0xb26fb04eac518000
.quad 0x3bf73bfc3bff3c00,0xade2abd9a7da8000,0x3bf43bfa3bff3c00,0xaf0eacb5a8b68000,0x3bef3bf83bfe3c00,0xb01dad7ea97f8000,0x3ba83bd93bf63c00,0xb4a5b23eae468000,0x3bce3bea3bfa3c00,0xb303b0b2acb58000,0x3bc63be63bf93c00,0xb396b115ad1a8000,0x3bbc3be23bf83c00,0xb414b179ad7e8000,0x3bb23bdd3bf73c00,0xb45db1dbade28000
.quad 0x3bfe3bff3bff3bff,0x297f28b627da2648,0x3bf83bfa3bfc3bfe,0x2d7e2cb52bd92a48,0x3bef3bf43bf73bfa,0x301d2f0e2de22cb5,0x3be23bea3bf13bf6,0x317930b22fd62e46,0x3b883ba83bc33bd9,0x356434a533c6323e,0x3b693b913bb23bce,0x36083534345d3303,0x3b463b773ba03bc3,0x36aa35c234d533c6,0x3b203b5a3b8c3bb6,0x3748364e354c3444
.quad 0x3bd13bdd3be83bf1,0x32d231db30e42fd6,0x3bbc3bce3bdd3bea,0x3414330331db30b2,0x3ba43bbc3bd13be2,0x34bd341432d23179,0x3c003c003c003c00,0,0x3af63b3b3b773ba8,0x37e336d735c234a5,0x3ac93b1a3b5f3b99,0x383d375e36373505,0x3a993af63b463b88,0x388737e336aa3564,0x3a653ad03b2b3b77,0x38ce3832371b35c2
.quad 0x3bfe3bff3bff3bff,0xa97fa8b6a7daa648,0x3bf83bfa3bfc3bfe,0xad7eacb5abd9aa48,0x3bef3bf43bf73bfa,0xb01daf0eade2acb5,0x3be23bea3bf13bf6,0xb179b0b2afd6ae46,0x3b883ba83bc33bd9,0xb564b4a5b3c6b23e,0x3b693b913bb23bce,0xb608b534b45db303,0x3b463b773ba03bc3,0xb6aab5c2b4d5b3c6,0x3b203b5a3b8c3bb6,0xb748b64eb54cb444
.quad 0x3bd13bdd3be83bf1,0xb2d2b1dbb0e4afd6,0x3bbc3bce3bdd3bea,0xb414b303b1dbb0b2,0x3ba43bbc3bd13be2,0xb4bdb414b2d2b179,0x3a2f3aa73b0e3b64,0xb913b872b78bb61f,0x3af63b3b3b773ba8,0xb7e3b6d7b5c2b4a5,0x3ac93b1a3b5f3b99,0xb83db75eb637b505,0x3a993af63b463b88,0xb887b7e3b6aab564,0x3a653ad03b2b3b77,0xb8ceb832b71bb5c2
.quad 0x3bfb3bfc3bfd3bfe,0x2c512bd92b112a48,0x3bed3bf13bf43bf6,0x304e2fd62f0e2e46,0x3bd63bdd3be43bea,0x326f31db314730b2,0x3bb63bc33bce3bd9,0x344433c63303323e,0x3add3b0e3b3b3b64,0x381d378b36d7361f,0x3a923ad03b083b3b,0x3891383237a136d7,0x3a3f3a8a3ad03b0e,0x3900389b3832378b,0x39e53a3f3a923add,0x396939003891381d
.quad 0x3b8c3ba03bb23bc3,0x354c34d5345d33c6,0x3b5a3b773b913ba8,0x364e35c2353434a5,0x3b203b463b693b88,0x374836aa36083564,0x3c003c003c003c00,0,0x398439ed3a4f3aa7,0x39cb395f38ec3872,0x391d39963a073a6d,0x3a2739ba394338c4,0x38b0393a39ba3a2f,0x3a7c3a0f39963913,0x383d38d8396939ed,0x3ac93a5e39e5395f
.quad 0x3bfb3bfc3bfd3bfe,0xac51abd9ab11aa48,0x3bed3bf13bf43bf6,0xb04eafd6af0eae46,0x3bd63bdd3be43bea,0xb26fb1dbb147b0b2,0x3bb63bc33bce3bd9,0xb444b3c6b303b23e,0x3add3b0e3b3b3b64,0xb81db78bb6d7b61f,0x3a923ad03b083b3b,0xb891b832b7a1b6d7,0x3a3f3a8a3ad03b0e,0xb900b89bb832b78b,0x39e53a3f3a923add,0xb969b900b891b81d
.quad 0x3b8c3ba03bb23bc3,0xb54cb4d5b45db3c6,0x3b5a3b773b913ba8,0xb64eb5c2b534b4a5,0x3b203b463b693b88,0xb748b6aab608b564,0x378b3872391339a8,0xbb0ebaa7ba2fb9a8,0x398439ed3a4f3aa7,0xb9cbb95fb8ecb872,0x391d39963a073a6d,0xba27b9bab943b8c4,0x38b0393a39ba3a2f,0xba7cba0fb996b913,0x383d38d8396939ed,0xbac9ba5eb9e5b95f
.quad 0x3bf73bf83bf93bfa,0x2de22d7e2d1a2cb5,0x3bdd3be23be63bea,0x31db3179311530b2,0x3bb23bbc3bc63bce,0x345d341433963303,0x3b773b883b993ba8,0x35c23564350534a5,0x39ed3a2f3a6d3aa7,0x395f391338c43872,0x396939ba3a073a4f,0x39e53996394338ec,0x38d8393a399639ed,0x3a5e3a0f39ba395f,0x383d38b0391d3984,0x3ac93a7c3a2739cb
.quad 0x3b2b3b463b5f3b77,0x371b36aa363735c2,0x3ad03af63b1a3b3b,0x383237e3375e36d7,0x3a653a993ac93af6,0x38ce3887383d37e3,0x3c003c003c003c00,0,0x3732381d389b3913,0x3b253add3a8a3a2f,0x35da37053812389b,0x3b723b303ae33a8a,0x347535c23705381d,0x3baf3b773b303add,0x320d347535da3732,0x3bdb3baf3b723b25
.quad 0x3bf73bf83bf93bfa,0xade2ad7ead1aacb5,0x3bdd3be23be63bea,0xb1dbb179b115b0b2,0x3bb23bbc3bc63bce,0xb45db414b396b303,0x3b773b883b993ba8,0xb5c2b564b505b4a5,0x39ed3a2f3a6d3aa7,0xb95fb913b8c4b872,0x396939ba3a073a4f,0xb9e5b996b943b8ec,0x38d8393a399639ed,0xba5eba0fb9bab95f,0x383d38b0391d3984,0xbac9ba7cba27b9cb
.quad 0x3b2b3b463b5f3b77,0xb71bb6aab637b5c2,0x3ad03af63b1a3b3b,0xb832b7e3b75eb6d7,0x3a653a993ac93af6,0xb8ceb887b83db7e3,0x2e46323e34a5361f,0xbbf6bbd9bba8bb64,0x3732381d389b3913,0xbb25baddba8aba2f,0x35da37053812389b,0xbb72bb30bae3ba8a,0x347535c23705381d,0xbbafbb77bb30badd,0x320d347535da3732,0xbbdbbbafbb72bb25
.quad 0x3bf23bf43bf53bf6,0x2f722f0e2eaa2e46,0x3bc93bce3bd43bd9,0x3365330332a1323e,0x3b843b913b9d3ba8,0x357c353434ed34a5,0x3b253b3b3b503b64,0x373236d7367c361f,0x38c43913395f39a8,0x3a6d3a2f39ed39a8,0x37f9385d38ba3913,0x3af03ab53a743a2f,0x364e373238073872,0x3b5a3b253ae93aa7,0x348d35933693378b,0x3bab3b803b4b3b0e
.quad 0x3aae3ad03af03b0e,0x3867383237f9378b,0x3a1f3a4f3a7c3aa7,0x392738ec38b03872,0x397b39ba39f63a2f,0x39d4399639563913,0x3c003c003c003c00,0,0x317933c63505361f,0x3be23bc33b993b64,0x2b11304e32d234a5,0x3bfd3bed3bd13ba8,0xabd926482f0e323e,0x3bfc3bff3bf43bd9,0xb1aaad7e1e482e46,0x3be03bf83c003bf6
.quad 0x3bf23bf43bf53bf6,0xaf72af0eaeaaae46,0x3bc93bce3bd43bd9,0xb365b303b2a1b23e,0x3b843b913b9d3ba8,0xb57cb534b4edb4a5,0x3b253b3b3b503b64,0xb732b6d7b67cb61f,0x38c43913395f39a8,0xba6dba2fb9edb9a8,0x37f9385d38ba3913,0xbaf0bab5ba74ba2f,0x364e373238073872,0xbb5abb25bae9baa7,0x348d35933693378b,0xbbabbb80bb4bbb0e
.quad 0x3aae3ad03af03b0e,0xb867b832b7f9b78b,0x3a1f3a4f3a7c3aa7,0xb927b8ecb8b0b872,0x397b39ba39f63a2f,0xb9d4b996b956b913,0xb4a5b23eae460000,0xbba8bbd9bbf6bc00,0x317933c63505361f,0xbbe2bbc3bb99bb64,0x2b11304e32d234a5,0xbbfdbbedbbd1bba8,0xabd926482f0e323e,0xbbfcbbffbbf4bbd9,0xb1aaad7e1e482e46,0xbbe0bbf8bc00bbf6
.quad 0x3bec3bed3bef3bf1,0x3080304e301d2fd6,0x3baf3bb63bbc3bc3,0x34753444341433c6,0x3b4b3b5a3b693b77,0x3693364e360835c2,0x3ac23add3af63b0e,0x3848381d37e3378b,0x36d7378b381d3872,0x3b3b3b0e3add3aa7,0x34bd359336653732,0x3ba43b803b553b25,0x3115330334753564,0x3be63bce3baf3b88,0x24b62d7e30e43303,0x3c003bf83be83bce
.quad 0x3a173a3f3a653a8a,0x3930390038ce389b,0x394d398439ba39ed,0x39fe39cb3996395f,0x386738b038f6393a,0x3aae3a7c3a473a0f,0x3c003c003c003c00,0,0xafd6aa4826482e46,0x3bf13bfe3bff3bf6,0xb42cb1dbaeaaa648,0x3bb93bdd3bf53bff,0xb64eb505b365b0b2,0x3b5a3b993bc93bea,0xb828b705b5abb444,0x3ad63b303b7b3bb6
.quad 0x3bec3bed3bef3bf1,0xb080b04eb01dafd6,0x3baf3bb63bbc3bc3,0xb475b444b414b3c6,0x3b4b3b5a3b693b77,0xb693b64eb608b5c2,0x3ac23add3af63b0e,0xb848b81db7e3b78b,0x36d7378b381d3872,0xbb3bbb0ebaddbaa7,0x34bd359336653732,0xbba4bb80bb55bb25,0x3115330334753564,0xbbe6bbcebbafbb88,0x24b62d7e30e43303,0xbc00bbf8bbe8bbce
.quad 0x3a173a3f3a653a8a,0xb930b900b8ceb89b,0x394d398439ba39ed,0xb9feb9cbb996b95f,0x386738b038f6393a,0xbaaeba7cba47ba0f,0xb913b872b78bb61f,0xba2fbaa7bb0ebb64,0xafd6aa4826482e46,0xbbf1bbfebbffbbf6,0xb42cb1dbaeaaa648,0xbbb9bbddbbf5bbff,0xb64eb505b365b0b2,0xbb5abb99bbc9bbea,0xb828b705b5abb444,0xbad6bb30bb7bbbb6
.quad 0x3be43be63be83bea,0x3147311530e430b2,0x3b913b993ba03ba8,0x3534350534d534a5,0x3b083b1a3b2b3b3b,0x37a1375e371b36d7,0x3a4f3a6d3a8a3aa7,0x38ec38c4389b3872,0x33c634a53564361f,0x3bc33ba83b883b64,0x2d1a304e320d33c6,0x3bf93bed3bdb3bc3,0xad7ea64828b62e46,0x3bf83bff3bff3bf6,0xb3f7b1dbaf72aa48,0x3bc03bdd3bf23bfe
.quad 0x3969399639c339ed,0x39e539ba398d395f,0x385d389b38d83913,0x3ab53a8a3a5e3a2f,0x3665370537a1381d,0x3b553b303b083add,0x3c003c003c003c00,0,0xb67cb564b444b23e,0x3b503b883bb63bd9,0xb867b7b7b693b564,0x3aae3b023b4b3b88,0xb972b8ecb85db78b,0x39dc3a4f3ab53b0e,0xba56b9dcb956b8c4,0x38e2397239f63a6d
.quad 0x3be43be63be83bea,0xb147b115b0e4b0b2,0x3b913b993ba03ba8,0xb534b505b4d5b4a5,0x3b083b1a3b2b3b3b,0xb7a1b75eb71bb6d7,0x3a4f3a6d3a8a3aa7,0xb8ecb8c4b89bb872,0x33c634a53564361f,0xbbc3bba8bb88bb64,0x2d1a304e320d33c6,0xbbf9bbedbbdbbbc3,0xad7ea64828b62e46,0xbbf8bbffbbffbbf6,0xb3f7b1dbaf72aa48,0xbbc0bbddbbf2bbfe
.quad 0x3969399639c339ed,0xb9e5b9bab98db95f,0x385d389b38d83913,0xbab5ba8aba5eba2f,0x3665370537a1381d,0xbb55bb30bb08badd,0xbb0ebaa7ba2fb9a8,0xb78bb872b913b9a8,0xb67cb564b444b23e,0xbb50bb88bbb6bbd9,0xb867b7b7b693b564,0xbaaebb02bb4bbb88,0xb972b8ecb85db78b,0xb9dcba4fbab5bb0e,0xba56b9dcb956b8c4,0xb8e2b972b9f6ba6d
.quad 0x3bdb3bdd3be03be2,0x320d31db31aa3179,0x3b6e3b773b803b88,0x35f135c235933564,0x3abc3ad03ae33af6,0x38523832381237e3,0x39cb39ed3a0f3a2f,0x3984395f393a3913,0x2a482e4630b2323e,0x3bfe3bf63bea3bd9,0xb080ad7ea7da2648,0x3bec3bf83bff3bff,0xb534b444b2a1b0b2,0x3b913bb63bd43bea,0xb7f9b705b608b505,0x3af03b303b693b99
.quad 0x38a638d83909393a,0x3a833a5e3a373a0f,0x36aa373237b7381d,0x3b463b253b023add,0x33963475351d35c2,0x3bc63baf3b953b77,0x3c003c003c003c00,0,0xb93ab8c4b848b78b,0x3a0f3a6d3ac23b0e,0xba47b9dcb969b8ec,0x38f6397239e53a4f,0xbb1abac2ba5eb9ed,0x375e384838d8395f,0xbbabbb6ebb20bac2,0x348d35f137483848
.quad 0x3bdb3bdd3be03be2,0xb20db1dbb1aab179,0x3b6e3b773b803b88,0xb5f1b5c2b593b564,0x3abc3ad03ae33af6,0xb852b832b812b7e3,0x39cb39ed3a0f3a2f,0xb984b95fb93ab913,0x2a482e4630b2323e,0xbbfebbf6bbeabbd9,0xb080ad7ea7da2648,0xbbecbbf8bbffbbff,0xb534b444b2a1b0b2,0xbb91bbb6bbd4bbea,0xb7f9b705b608b505,0xbaf0bb30bb69bb99
.quad 0x38a638d83909393a,0xba83ba5eba37ba0f,0x36aa373237b7381d,0xbb46bb25bb02badd,0x33963475351d35c2,0xbbc6bbafbb95bb77,0xbbf6bbd9bba8bb64,0xae46b23eb4a5b61f,0xb93ab8c4b848b78b,0xba0fba6dbac2bb0e,0xba47b9dcb969b8ec,0xb8f6b972b9e5ba4f,0xbb1abac2ba5eb9ed,0xb75eb848b8d8b95f,0xbbabbb6ebb20bac2,0xb48db5f1b748b848
.quad 0x3c003c003c003c00,0,0x3aa73b643bd93c00,0x3872361f323e0000,0x361f39a83b643c00,0x3b6439a8361f0000,0xb23e361f3aa73c00,0x3bd93b6438720000,0xb9a8000039a83c00,0x39a83c0039a80000,0xbbd9b61f38723c00,0x323e3b643aa70000,0xbb64b9a8361f3c00,0xb61f39a83b640000,0xb872bb64323e3c00,0xbaa7361f3bd90000
.quad 0x8000bc0000003c00,0xbc0000003c000000,0x3872bb64b23e3c00,0xbaa7b61f3bd90000,0x3b64b9a8b61f3c00,0xb61fb9a83b640000,0x3bd9b61fb8723c00,0x323ebb643aa70000,0x39a88000b9a83c00,0x39a8bc0039a80000,0x323e361fbaa73c00,0x3bd9bb6438720000,0xb61f39a8bb643c00,0x3b64b9a8361f0000,0xbaa73b64bbd93c00,0x3872b61f323e0000
.quad 0xbc003c00bc003c00,0x800000000000,0xbaa73b64bbd93c00,0xb872361fb23e0000,0xb61f39a8bb643c00,0xbb6439a8b61f0000,0x323e361fbaa73c00,0xbbd93b64b8720000,0x39a80000b9a83c00,0xb9a83c00b9a80000,0x3bd9b61fb8723c00,0xb23e3b64baa70000,0x3b64b9a8b61f3c00,0x361f39a8bb640000,0x3872bb64b23e3c00,0x3aa7361fbbd90000
.quad 0xbc0080003c00,0x3c000000bc000000,0xb872bb64323e3c00,0x3aa7b61fbbd90000,0xbb64b9a8361f3c00,0x361fb9a8bb640000,0xbbd9b61f38723c00,0xb23ebb64baa70000,0xb9a8800039a83c00,0xb9a8bc00b9a80000,0xb23e361f3aa73c00,0xbbd9bb64b8720000,0x361f39a83b643c00,0xbb64b9a8b61f0000,0x3aa73b643bd93c00,0xb872b61fb23e0000
.quad 0x3c003c003c003c00,0,0x323e361f387239a8,0x3bd93b643aa739a8,0xbb64b9a8b61f0000,0x361f39a83b643c00,0xb872bb64bbd9b9a8,0xbaa7b61f323e39a8,0x39a88000b9a8bc00,0xb9a8bc00b9a80000,0x3aa73b64323eb9a8,0x3872b61fbbd9b9a8,0xb61f39a83b648000,0x3b6439a8b61fbc00,0xbbd9b61f3aa739a8,0xb23e3b643872b9a8
.quad 0x8000bc0000003c00,0xbc0000003c008000,0x3bd9b61fbaa739a8,0xb23ebb64387239a8,0x361f39a8bb640000,0x3b64b9a8b61f3c00,0xbaa73b64b23eb9a8,0x3872361fbbd939a8,0xb9a8000039a8bc00,0xb9a83c00b9a80000,0x3872bb643bd9b9a8,0xbaa7361f323eb9a8,0x3b64b9a8361f8000,0x361fb9a83b64bc00,0xb23e361fb87239a8,0x3bd9bb643aa7b9a8
.quad 0xbc003c00bc003c00,0x800000008000,0xb23e361fb87239a8,0xbbd93b64baa739a8,0x3b64b9a8361f0000,0xb61f39a8bb643c00,0x3872bb643bd9b9a8,0x3aa7b61fb23e39a8,0xb9a8800039a8bc00,0x39a8bc0039a80000,0xbaa73b64b23eb9a8,0xb872b61f3bd9b9a8,0x361f39a8bb648000,0xbb6439a8361fbc00,0x3bd9b61fbaa739a8,0x323e3b64b872b9a8
.quad 0x8000bc0080003c00,0x3c000000bc008000,0xbbd9b61f3aa739a8,0x323ebb64b87239a8,0xb61f39a83b648000,0xbb64b9a8361f3c00,0x3aa73b64323eb9a8,0xb872361f3bd939a8,0x39a88000b9a8bc00,0x39a83c0039a80000,0xb872bb64bbd9b9a8,0x3aa7361fb23eb9a8,0xbb64b9a8b61f8000,0xb61fb9a8bb64bc00,0x323e361f387239a8,0xbbd9bb64baa7b9a8
.quad 0x3c003c003c003c00,0,0xb872b61fb23e0000,0x3aa73b643bd93c00,0xb61fb9a8bb64bc00,0xbb64b9a8b61f0000,0x3bd93b6438728000,0x323eb61fbaa7bc00,0xb9a8000039a83c00,0x39a83c0039a88000,0xb23ebb64baa70000,0xbbd9b61f38723c00,0x3b6439a8b61fbc00,0x361fb9a8bb640000,0xbaa7361f3bd98000,0x38723b64b23ebc00
.quad 0x8000bc0000003c00,0xbc0000003c008000,0x3aa7361fbbd90000,0x3872bb64b23e3c00,0xbb6439a8361fbc00,0x361f39a8bb640000,0x323ebb643aa78000,0xbbd9361f3872bc00,0x39a88000b9a83c00,0x39a8bc0039a88000,0xbbd93b64b8728000,0x323e361fbaa73c00,0x361fb9a83b64bc00,0xbb6439a8b61f0000,0x3872b61f323e8000,0x3aa7bb643bd9bc00
.quad 0xbc003c00bc003c00,0x800000008000,0x3872b61f323e8000,0xbaa73b64bbd93c00,0x361fb9a83b64bc00,0x3b64b9a8361f0000,0xbbd93b64b8728000,0xb23eb61f3aa7bc00,0x39a88000b9a83c00,0xb9a83c00b9a88000,0x323ebb643aa78000,0x3bd9b61fb8723c00,0xbb6439a8361fbc00,0xb61fb9a83b640000,0x3aa7361fbbd98000,0xb8723b64323ebc00
.quad 0xbc0080003c00,0x3c000000bc008000,0xbaa7361f3bd98000,0xb872bb64323e3c00,0x3b6439a8b61fbc00,0xb61f39a83b648000,0xb23ebb64baa78000,0x3bd9361fb872bc00,0xb9a8800039a83c00,0xb9a8bc00b9a88000,0x3bd93b6438728000,0xb23e361f3aa73c00,0xb61fb9a8bb64bc00,0x3b6439a8361f0000,0xb872b61fb23e8000,0xbaa7bb64bbd9bc00
.quad 0x3c003c003c003c00,0,0xbbd9bb64baa7b9a8,0x323e361f387239a8,0x3b6439a8361f8000,0xb61fb9a8bb64bc00,0xbaa7b61f323e39a8,0x38723b643bd939a8,0x39a88000b9a8bc00,0xb9a8bc00b9a80000,0xb872361f3bd939a8,0x3aa73b64323eb9a8,0x361fb9a8bb640000,0xbb64b9a8361f3c00,0xb23e3b643872b9a8,0x3bd9361fbaa7b9a8
.quad 0x8000bc0080003c00,0xbc0000003c008000,0x323e3b64b872b9a8,0x3bd9b61fbaa739a8,0xb61fb9a83b648000,0xbb6439a8361fbc00,0x3872361fbbd939a8,0x3aa7bb64323e39a8,0xb9a8800039a8bc00,0xb9a83c00b9a80000,0x3aa7b61fb23e39a8,0x3872bb643bd9b9a8,0xbb6439a8b61f8000,0xb61f39a8bb643c00,0x3bd9bb643aa7b9a8,0x323eb61f3872b9a8
.quad 0xbc003c00bc003c00,0x800080008000,0x3bd9bb643aa7b9a8,0xb23e361fb87239a8,0xbb6439a8b61f8000,0x361fb9a83b64bc00,0x3aa7b61fb23e39a8,0xb8723b64bbd939a8,0xb9a8800039a8bc00,0x39a8bc0039a80000,0x3872361fbbd939a8,0xbaa73b64b23eb9a8,0xb61fb9a83b640000,0x3b64b9a8b61f3c00,0x323e3b64b872b9a8,0xbbd9361f3aa7b9a8
.quad 0xbc0000003c00,0x3c008000bc008000,0xb23e3b643872b9a8,0xbbd9b61f3aa739a8,0x361fb9a8bb648000,0x3b6439a8b61fbc00,0xb872361f3bd939a8,0xbaa7bb64b23e39a8,0x39a80000b9a8bc00,0x39a83c0039a88000,0xbaa7b61f323e39a8,0xb872bb64bbd9b9a8,0x3b6439a8361f0000,0x361f39a83b643c00,0xbbd9bb64baa7b9a8,0xb23eb61fb872b9a8
.quad 0x3c003c003c003c00,0,0xbaa7bb64bbd9bc00,0xb872b61fb23e0000,0x361f39a83b643c00,0x3b6439a8361f8000,0x323eb61fbaa7bc00,0xbbd9bb64b8720000,0xb9a8000039a83c00,0x39a83c0039a88000,0x3bd9361fb872bc00,0xb23ebb64baa70000,0xbb64b9a8361f3c00,0xb61f39a83b648000,0x38723b64b23ebc00,0x3aa7b61fbbd90000
.quad 0x8000bc0080003c00,0xbc0000003c008000,0xb8723b64323ebc00,0x3aa7361fbbd90000,0x3b64b9a8b61f3c00,0xb61fb9a83b648000,0xbbd9361f3872bc00,0xb23e3b64baa70000,0x39a88000b9a83c00,0x39a8bc0039a88000,0xb23eb61f3aa7bc00,0xbbd93b64b8728000,0xb61f39a8bb643c00,0x3b64b9a8361f8000,0x3aa7bb643bd9bc00,0xb872361fb23e0000
.quad 0xbc003c00bc003c00,0x800080008000,0x3aa7bb643bd9bc00,0x3872b61f323e8000,0xb61f39a8bb643c00,0xbb6439a8b61f8000,0xb23eb61f3aa7bc00,0x3bd9bb6438720000,0x39a80000b9a83c00,0xb9a83c00b9a88000,0xbbd9361f3872bc00,0x323ebb643aa78000,0x3b64b9a8b61f3c00,0x361f39a8bb648000,0xb8723b64323ebc00,0xbaa7b61f3bd90000
.quad 0xbc0000003c00,0x3c000000bc008000,0x38723b64b23ebc00,0xbaa7361f3bd98000,0xbb64b9a8361f3c00,0x361fb9a8bb640000,0x3bd9361fb872bc00,0x323e3b643aa70000,0xb9a8000039a83c00,0xb9a8bc00b9a88000,0x323eb61fbaa7bc00,0x3bd93b6438728000,0x361f39a83b643c00,0xbb64b9a8b61f8000,0xbaa7bb64bbd9bc00,0x3872361f323e0000
.quad 0x3c003c003c003c00,0,0xb23eb61fb872b9a8,0xbbd9bb64baa7b9a8,0xbb64b9a8b61f0000,0x361f39a83b643c00,0x38723b643bd939a8,0x3aa7361fb23eb9a8,0x39a88000b9a8bc00,0xb9a8bc00b9a80000,0xbaa7bb64b23e39a8,0xb872361f3bd939a8,0xb61f39a83b648000,0x3b6439a8b61fbc00,0x3bd9361fbaa7b9a8,0x323ebb64b87239a8
.quad 0x8000bc0080003c00,0xbc0000003c008000,0xbbd9361f3aa7b9a8,0x323e3b64b872b9a8,0x361f39a8bb648000,0x3b64b9a8b61f3c00,0x3aa7bb64323e39a8,0xb872b61f3bd9b9a8,0xb9a8000039a8bc00,0xb9a83c00b9a80000,0xb8723b64bbd939a8,0x3aa7b61fb23e39a8,0x3b64b9a8361f8000,0x361fb9a83b64bc00,0x323eb61f3872b9a8,0xbbd93b64baa739a8
.quad 0xbc003c00bc003c00,0x800080008000,0x323eb61f3872b9a8,0x3bd9bb643aa7b9a8,0x3b64b9a8361f0000,0xb61f39a8bb643c00,0xb8723b64bbd939a8,0xbaa7361f323eb9a8,0xb9a8800039a8bc00,0x39a8bc0039a88000,0x3aa7bb64323e39a8,0x3872361fbbd939a8,0x361f39a8bb640000,0xbb6439a8361fbc00,0xbbd9361f3aa7b9a8,0xb23ebb64387239a8
.quad 0xbc0000003c00,0x3c000000bc008000,0x3bd9361fbaa7b9a8,0xb23e3b643872b9a8,0xb61f39a83b640000,0xbb64b9a8361f3c00,0xbaa7bb64b23e39a8,0x3872b61fbbd9b9a8,0x39a80000b9a8bc00,0x39a83c0039a80000,0x38723b643bd939a8,0xbaa7b61f323e39a8,0xbb64b9a8b61f8000,0xb61fb9a8bb64bc00,0xb23eb61fb872b9a8,0x3bd93b643aa739a8
.quad 0x3c003c003c003c00,0,0x3872361f323e8000,0xbaa7bb64bbd9bc00,0xb61fb9a8bb64bc00,0xbb64b9a8b61f0000,0xbbd9bb64b8720000,0xb23e361f3aa73c00,0xb9a8800039a83c00,0x39a83c0039a88000,0x323e3b643aa78000,0x3bd9361fb872bc00,0x3b6439a8b61fbc00,0x361fb9a8bb640000,0x3aa7b61fbbd98000,0xb872bb64323e3c00
.quad 0x8000bc0080003c00,0xbc0080003c008000,0xbaa7b61f3bd98000,0xb8723b64323ebc00,0xbb6439a8361fbc00,0x361f39a8bb640000,0xb23e3b64baa70000,0x3bd9b61fb8723c00,0x39a80000b9a83c00,0x39a8bc0039a88000,0x3bd9bb6438728000,0xb23eb61f3aa7bc00,0x361fb9a83b64bc00,0xbb6439a8b61f8000,0xb872361fb23e0000,0xbaa73b64bbd93c00
.quad 0xbc003c00bc003c00,0x80008000,0xb872361fb23e8000,0x3aa7bb643bd9bc00,0x361fb9a83b64bc00,0x3b64b9a8361f0000,0x3bd9bb6438720000,0x323e361fbaa73c00,0x39a88000b9a83c00,0xb9a83c00b9a88000,0xb23e3b64baa70000,0xbbd9361f3872bc00,0xbb6439a8361fbc00,0xb61fb9a83b640000,0xbaa7b61f3bd90000,0x3872bb64b23e3c00
.quad 0xbc0080003c00,0x3c008000bc008000,0x3aa7b61fbbd98000,0x38723b64b23ebc00,0x3b6439a8b61fbc00,0xb61f39a83b640000,0x323e3b643aa70000,0xbbd9b61f38723c00,0xb9a8000039a83c00,0xb9a8bc00b9a80000,0xbbd9bb64b8728000,0x323eb61fbaa7bc00,0xb61fb9a8bb64bc00,0x3b6439a8361f0000,0x3872361f323e0000,0x3aa73b643bd93c00
.quad 0x3c003c003c003c00,0,0x3bd93b643aa739a8,0xb23eb61fb872b9a8,0x3b6439a8361f8000,0xb61fb9a8bb64bc00,0x3aa7361fb23eb9a8,0xb872bb64bbd9b9a8,0x39a88000b9a8bc00,0xb9a8bc00b9a80000,0x3872b61fbbd9b9a8,0xbaa7bb64b23e39a8,0x361fb9a8bb648000,0xbb64b9a8361f3c00,0x323ebb64b87239a8,0xbbd9b61f3aa739a8
.quad 0x8000bc0080003c00,0xbc0000003c008000,0xb23ebb64387239a8,0xbbd9361f3aa7b9a8,0xb61fb9a83b648000,0xbb6439a8361fbc00,0xb872b61f3bd9b9a8,0xbaa73b64b23eb9a8,0xb9a8000039a8bc00,0xb9a83c00b9a88000,0xbaa7361f323eb9a8,0xb8723b64bbd939a8,0xbb6439a8b61f0000,0xb61f39a8bb643c00,0xbbd93b64baa739a8,0xb23e361fb87239a8
.quad 0xbc003c00bc003c00,0x800080008000,0xbbd93b64baa739a8,0x323eb61f3872b9a8,0xbb6439a8b61f0000,0x361fb9a83b64bc00,0xbaa7361f323eb9a8,0x3872bb643bd9b9a8,0xb9a8800039a8bc00,0x39a8bc0039a80000,0xb872b61f3bd9b9a8,0x3aa7bb64323e39a8,0xb61fb9a83b640000,0x3b64b9a8b61f3c00,0xb23ebb64387239a8,0x3bd9b61fbaa739a8
.quad 0xbc0080003c00,0x3c000000bc000000,0x323ebb64b87239a8,0x3bd9361fbaa7b9a8,0x361fb9a8bb648000,0x3b6439a8b61fbc00,0x3872b61fbbd9b9a8,0x3aa73b64323eb9a8,0x39a80000b9a8bc00,0x39a83c0039a80000,0x3aa7361fb23eb9a8,0x38723b643bd939a8,0x3b6439a8361f8000,0x361f39a83b643c00,0x3bd93b643aa739a8,0x323e361f387239a8
.quad 0xf7000000f2c0,0xf92e0000f70e,0xf4e00000f2d0,0xf4ee0000f2de,0xf4f00000f2e0,0xf4fe0000f2ee,0xf5000000f2f0,0xf50e0000f2fe,0xf5100000f300,0xf51e0000f30e,0xf5200000f310,0xf52e0000f31e,0xf5300000f320,0xf53e0000f32e,0xf5400000f330,0xf54e0000f33e
.quad 0xf5500000f340,0xf55e0000f34e,0xf5600000f350,0xf56e0000f35e,0xf5700000f360,0xf57e0000f36e,0xf5800000f370,0xf58e0000f37e,0xf5900000f380,0xf59e0000f38e,0xf5a00000f390,0xf5ae0000f39e,0xf5b00000f3a0,0xf5be0000f3ae,0xf5c00000f3b0,0xf5ce0000f3be
.quad 0xf4d00000f910,0xf4de0000f6e0,0xf7f00000fa00,0xf91e0000f7fe,0xf7e00000f9f0,0xfa0e0000f7ee,0xf7d00000f9e0,0xf9fe0000f7de,0xf7c00000f9d0,0xf9ee0000f7ce,0xf7b00000f9c0,0xf9de0000f7be,0xf7a00000f9b0,0xf9ce0000f7ae,0xf7900000f9a0,0xf9be0000f79e
.quad 0xf7800000f990,0xf9ae0000f78e,0xf7700000f980,0xf99e0000f77e,0xf7600000f970,0xf98e0000f76e,0xf7500000f960,0xf97e0000f75e,0xf7400000f950,0xf96e0000f74e,0xf7300000f940,0xf95e0000f73e,0xf7200000f930,0xf94e0000f72e,0xf7100000f920,0xf93e0000f71e
.quad 0xf8000000f3c0,0xf80e0000f3ce,0xf5e00000f3d0,0xf5ee0000f3de,0xf5f00000f3e0,0xf5fe0000f3ee,0xf6000000f3f0,0xf60e0000f3fe,0xf6100000f400,0xf61e0000f40e,0xf6200000f410,0xf62e0000f41e,0xf6300000f420,0xf63e0000f42e,0xf6400000f430,0xf64e0000f43e
.quad 0xf6500000f440,0xf65e0000f44e,0xf6600000f450,0xf66e0000f45e,0xf6700000f460,0xf67e0000f46e,0xf6800000f470,0xf68e0000f47e,0xf6900000f480,0xf69e0000f48e,0xf6a00000f490,0xf6ae0000f49e,0xf6b00000f4a0,0xf6be0000f4ae,0xf6c00000f4b0,0xf6ce0000f4be
.quad 0xf5d00000fa10,0xf5de0000fa1e,0xf8f00000fb00,0xf8fe0000fb0e,0xf8e00000faf0,0xf8ee0000fafe,0xf8d00000fae0,0xf8de0000faee,0xf8c00000fad0,0xf8ce0000fade,0xf8b00000fac0,0xf8be0000face,0xf8a00000fab0,0xf8ae0000fabe,0xf8900000faa0,0xf89e0000faae
.quad 0xf8800000fa90,0xf88e0000fa9e,0xf8700000fa80,0xf87e0000fa8e,0xf8600000fa70,0xf86e0000fa7e,0xf8500000fa60,0xf85e0000fa6e,0xf8400000fa50,0xf84e0000fa5e,0xf8300000fa40,0xf83e0000fa4e,0xf8200000fa30,0xf82e0000fa3e,0xf8100000fa20,0xf81e0000fa2e
.quad 0xc00000000000,0,0xc01000000010,0x8000000010,0xc02000000020,0x1000000020,0xc03000000030,0x9000000030,0xc04000000040,0x800000040,0xc05000000050,0x8800000050,0xc06000000060,0x1800000060,0xc07000000070,0x9800000070
.quad 0xc08000000080,0x14000000080,0xc09000000090,0x1c000000090,0xc0a0000000a0,0x150000000a0,0xc0b0000000b0,0x1d0000000b0,0xc0c0000000c0,0x148000000c0,0xc0d0000000d0,0x1c8000000d0,0xc0e0000000e0,0x158000000e0,0xc0f0000000f0,0x1d8000000f0
.quad 0x800000004000,0x2000000140,0x801000004010,0xa000000150,0x802000004020,0x3000000160,0x803000004030,0xb000000170,0x804000004040,0x2800000100,0x805000004050,0xa800000110,0x806000004060,0x3800000120,0x807000004070,0xb800000130
.quad 0x808000004080,0x160000001c0,0x809000004090,0x1e0000001d0,0x80a0000040a0,0x170000001e0,0x80b0000040b0,0x1f0000001f0,0x80c0000040c0,0x16800000180,0x80d0000040d0,0x1e800000190,0x80e0000040e0,0x178000001a0,0x80f0000040f0,0x1f8000001b0
.quad 0x400000008000,0x40000000200,0x401000008010,0x48000000210,0x402000008020,0x41000000220,0x403000008030,0x49000000230,0x404000008040,0x40800000240,0x405000008050,0x48800000250,0x406000008060,0x41800000260,0x407000008070,0x49800000270
.quad 0x408000008080,0x54000000280,0x409000008090,0x5c000000290,0x40a0000080a0,0x550000002a0,0x40b0000080b0,0x5d0000002b0,0x40c0000080c0,0x548000002c0,0x40d0000080d0,0x5c8000002d0,0x40e0000080e0,0x558000002e0,0x40f0000080f0,0x5d8000002f0
.quad 0xc000,0x42000000340,0x100000c010,0x4a000000350,0x200000c020,0x43000000360,0x300000c030,0x4b000000370,0x400000c040,0x42800000300,0x500000c050,0x4a800000310,0x600000c060,0x43800000320,0x700000c070,0x4b800000330
.quad 0x800000c080,0x560000003c0,0x900000c090,0x5e0000003d0,0xa00000c0a0,0x570000003e0,0xb00000c0b0,0x5f0000003f0,0xc00000c0c0,0x56800000380,0xd00000c0d0,0x5e800000390,0xe00000c0e0,0x578000003a0,0xf00000c0f0,0x5f8000003b0
.quad 0,0x8000000000,0x9000000000,0x11000000010,0x12000000000,0x1a000000020,0x1b000000000,0x23000000030,0x24000000000,0x2c000000040,0x2d000000000,0x35000000050,0x36000000000,0x3e000000060,0x3f000000000,0x47000000070
.quad 0x48000000000,0x50000000090,0x51000000000,0x590000000a0,0x5a000000000,0x620000000b0,0x63000000000,0x6b0000000c0,0x6c000000000,0x740000000d0,0x75000000000,0x7d0000000e0,0x7e000000000,0x860000000f0,0x87000000000,0x8f000000100
.quad 0x90000000000,0x98000000120,0x99000000000,0xa1000000130,0xa2000000000,0xaa000000140,0xab000000000,0xb3000000150,0xb4000000000,0xbc000000160,0xbd000000000,0xc5000000170,0xc6000000000,0xce000000180,0xcf000000000,0xd7000000190
.quad 0xd8000000000,0xe00000001b0,0xe1000000000,0xe90000001c0,0xea000000000,0xf20000001d0,0xf3000000000,0xfb0000001e0,0xfc000000000,0x1040000001f0,0x105000000000,0x10d000000200,0x10e000000000,0x116000000210,0x117000000000,0x11f000000220
.quad 0x4000000010,0x8000000240,0xd000000010,0x11000000250,0x16000000010,0x1a000000260,0x1f000000010,0x23000000270,0x28000000010,0x2c000000280,0x31000000010,0x35000000290,0x3a000000010,0x3e0000002a0,0x43000000010,0x470000002b0
.quad 0x4c000000010,0x500000002d0,0x55000000010,0x590000002e0,0x5e000000010,0x620000002f0,0x67000000010,0x6b000000300,0x70000000010,0x74000000310,0x79000000010,0x7d000000320,0x82000000010,0x86000000330,0x8b000000010,0x8f000000340
.quad 0x94000000010,0x98000000360,0x9d000000010,0xa1000000370,0xa6000000010,0xaa000000380,0xaf000000010,0xb3000000390,0xb8000000010,0xbc0000003a0,0xc1000000010,0xc50000003b0,0xca000000010,0xce0000003c0,0xd3000000010,0xd70000003d0
.quad 0xdc000000010,0xe00000003f0,0xe5000000010,0xe9000000400,0xee000000010,0xf2000000410,0xf7000000010,0xfb000000420,0x100000000010,0x104000000430,0x109000000010,0x10d000000440,0x112000000010,0x116000000450,0x11b000000010,0x11f000000460
.quad 0x7000000000,0x800000000000,0x7000000000,0xfe0000000200,0x7000000000,0xfc0000000400,0x7000000000,0xfa0000000600,0x7000000000,0xf80000000800,0x7000000000,0xf60000000a00,0x7000000000,0xf40000000c00,0x7000000000,0xf20000000e00
.quad 0x6000000010,0xf00000001000,0x6000000010,0xee0000001200,0x6000000010,0xec0000001400,0x6000000010,0xea0000001600,0x6000000010,0xe80000001800,0x6000000010,0xe60000001a00,0x6000000010,0xe40000001c00,0x6000000010,0xe20000001e00
.quad 0x5000000020,0xe00000002000,0x5000000020,0xde0000002200,0x5000000020,0xdc0000002400,0x5000000020,0xda0000002600,0x5000000020,0xd80000002800,0x5000000020,0xd60000002a00,0x5000000020,0xd40000002c00,0x5000000020,0xd20000002e00
.quad 0x4000000030,0xd00000003000,0x4000000030,0xce0000003200,0x4000000030,0xcc0000003400,0x4000000030,0xca0000003600,0x4000000030,0xc80000003800,0x4000000030,0xc60000003a00,0x4000000030,0xc40000003c00,0x4000000030,0xc20000003e00
.quad 0x3000000040,0xc00000004000,0x3000000040,0xbe0000004200,0x3000000040,0xbc0000004400,0x3000000040,0xba0000004600,0x3000000040,0xb80000004800,0x3000000040,0xb60000004a00,0x3000000040,0xb40000004c00,0x3000000040,0xb20000004e00
.quad 0x2000000050,0xb00000005000,0x2000000050,0xae0000005200,0x2000000050,0xac0000005400,0x2000000050,0xaa0000005600,0x2000000050,0xa80000005800,0x2000000050,0xa60000005a00,0x2000000050,0xa40000005c00,0x2000000050,0xa20000005e00
.quad 0x1000000060,0xa00000006000,0x1000000060,0x9e0000006200,0x1000000060,0x9c0000006400,0x1000000060,0x9a0000006600,0x1000000060,0x980000006800,0x1000000060,0x960000006a00,0x1000000060,0x940000006c00,0x1000000060,0x920000006e00
.quad 0x70,0x900000007000,0x70,0x8e0000007200,0x70,0x8c0000007400,0x70,0x8a0000007600,0x70,0x880000007800,0x70,0x860000007a00,0x70,0x840000007c00,0x70,0x820000007e00
.quad 0xf2c0,0,0x100000f4d0,0x10,0x100000f2c0,0x20,0x200000f4d0,0x30,0xf700,0x40,0x100000f910,0x50,0x100000f700,0x60,0x200000f910,0x70
.quad 0xfb40,0x80,0x100000fd50,0x90,0x100000fb40,0xa0,0x200000fd50,0xc2000000000000b0,0xff80,0xc0,0x1000010190,0xd0,0x100000ff80,0xe0,0x2000010190,0xf0
.quad 0x114c0,0x1000,0x10000116d0,0x1010,0x10000114c0,0x1020,0x20000116d0,0x1030,0x11900,0x1040,0x1000011b10,0x1050,0x1000011900,0x1060,0x2000011b10,0x1070
.quad 0x11d40,0x1080,0x1000011f50,0x1090,0x1000011d40,0x10a0,0x2000011f50,0x10b0,0x12180,0x10c0,0x1000012390,0x10d0,0x1000012180,0x10e0,0x2000012390,0x10f0
.quad 0xf2c0,0x2000,0x100000f4d0,0x2010,0x100000f2c0,0x2020,0x200000f4d0,0x2030,0xf700,0x2040,0x100000f910,0x2050,0x100000f700,0x2060,0x200000f910,0x2070
.quad 0xfb40,0x2080,0x100000fd50,0x2090,0x100000fb40,0x20a0,0x200000fd50,0xc2000000000020b0,0xff80,0x20c0,0x1000010190,0x20d0,0x100000ff80,0x20e0,0x2000010190,0x20f0
.quad 0xf2c0,0x3000,0x100000f4d0,0x3010,0x100000f2c0,0x3020,0x200000f4d0,0x3030,0xf700,0x3040,0x100000f910,0x3050,0x100000f700,0x3060,0x200000f910,0x3070
.quad 0xfb40,0x3080,0x100000fd50,0x3090,0x100000fb40,0x30a0,0x200000fd50,0x30b0,0xff80,0x30c0,0x1000010190,0x30d0,0x100000ff80,0x30e0,0x2000010190,0x30f0
.quad 0xf72e0000f2ee,0,0xf74e0000f30e,0x8,0xf76e0000f32e,0x10,0xf78e0000f34e,0x18,0xf7ae0000f36e,0x20,0xf7ce0000f38e,0x28,0xf7ee0000f3ae,0x30,0xf6e00000f6e0,0x38
.quad 0xf72e0000f2ee,0x40,0xf74e0000f30e,0x48,0xf76e0000f32e,0x50,0xf78e0000f34e,0x58,0xf7ae0000f36e,0x60,0xf7ce0000f38e,0x68,0xf7ee0000f3ae,0x70,0xf6e00000f6e0,0x78
.quad 0x1192e000114ee,0x80,0x1194e0001150e,0x88,0x1196e0001152e,0x90,0x1198e0001154e,0x98,0x119ae0001156e,0xa0,0x119ce0001158e,0xa8,0x119ee000115ae,0xb0,0x118e0000118e0,0xb8
.quad 0x1192e000114ee,0xc0,0x1194e0001150e,0xc8,0x1196e0001152e,0xd0,0x1198e0001154e,0xd8,0x119ae0001156e,0xe0,0x119ce0001158e,0xe8,0x119ee000115ae,0xf0,0x118e0000118e0,0xf8
.quad 0xf72e0000f2ee,0x100,0xf74e0000f30e,0x108,0xf76e0000f32e,0x110,0xf78e0000f34e,0x118,0xf7ae0000f36e,0x120,0xf7ce0000f38e,0x128,0xf7ee0000f3ae,0x130,0xf6e00000f6e0,0x138
.quad 0xf72e0000f2ee,0x140,0xf74e0000f30e,0x148,0xf76e0000f32e,0x150,0xf78e0000f34e,0x158,0xf7ae0000f36e,0x160,0xf7ce0000f38e,0x168,0xf7ee0000f3ae,0x170,0xf6e00000f6e0,0x178
.quad 0xf72e0000f2ee,0x180,0xf74e0000f30e,0x188,0xf76e0000f32e,0x190,0xf78e0000f34e,0x198,0xf7ae0000f36e,0x1a0,0xf7ce0000f38e,0x1a8,0xf7ee0000f3ae,0x1b0,0xf6e00000f6e0,0x1b8
.quad 0xf72e0000f2ee,0x1c0,0xf74e0000f30e,0x1c8,0xf76e0000f32e,0x1d0,0xf78e0000f34e,0x1d8,0xf7ae0000f36e,0x1e0,0xf7ce0000f38e,0x1e8,0xf7ee0000f3ae,0x1f0,0xf6e00000f6e0,0x1f8
.quad 0xf2c0,0,0x100000f4d0,0x10,0x100000f2c0,0x20,0x200000f4d0,0x30,0xf700,0x40,0x100000f910,0x50,0x100000f700,0x60,0x200000f910,0x70
.quad 0xfb40,0x80,0x100000fd50,0x90,0x100000fb40,0xa0,0x200000fd50,0xc2000000000000b0,0xff80,0xc0,0x1000010190,0xd0,0x100000ff80,0xe0,0x2000010190,0xf0
.quad 0x114c0,0x1000,0x10000116d0,0x1010,0x10000114c0,0x1020,0x20000116d0,0x1030,0x11900,0x1040,0x1000011b10,0x1050,0x1000011900,0x1060,0x2000011b10,0x1070
.quad 0x11d40,0x1080,0x1000011f50,0x1090,0x1000011d40,0x10a0,0x2000011f50,0x10b0,0x12180,0x10c0,0x1000012390,0x10d0,0x1000012180,0x10e0,0x2000012390,0x10f0
.quad 0xea40,0x2000,0x100000ec50,0x2010,0x100000ea40,0x2020,0x200000ec50,0x2030,0xee80,0x2040,0x100000f090,0x2050,0x100000ee80,0x2060,0x200000f090,0x2070
.quad 0xf2c0,0x2080,0x100000f4d0,0x2090,0x100000f2c0,0x20a0,0x200000f4d0,0xc2000000000020b0,0xf700,0x20c0,0x100000f910,0x20d0,0x100000f700,0x20e0,0x200000f910,0x20f0
.quad 0xf2c0,0x3000,0x100000f4d0,0x3010,0x100000f2c0,0x3020,0x200000f4d0,0x3030,0xf700,0x3040,0x100000f910,0x3050,0x100000f700,0x3060,0x200000f910,0x3070
.quad 0xfb40,0x3080,0x100000fd50,0x3090,0x100000fb40,0x30a0,0x200000fd50,0x30b0,0xff80,0x30c0,0x1000010190,0x30d0,0x100000ff80,0x30e0,0x2000010190,0x30f0
.quad 0xf72e0000f2ee,0,0xf74e0000f30e,0x8,0xf76e0000f32e,0x10,0xf78e0000f34e,0x18,0xf7ae0000f36e,0x20,0xf7ce0000f38e,0x28,0xf7ee0000f3ae,0x30,0xf6e00000f6e0,0x38
.quad 0xf72e0000f2ee,0x40,0xf74e0000f30e,0x48,0xf76e0000f32e,0x50,0xf78e0000f34e,0x58,0xf7ae0000f36e,0x60,0xf7ce0000f38e,0x68,0xf7ee0000f3ae,0x70,0xf6e00000f6e0,0x78
.quad 0x1192e000114ee,0x80,0x1194e0001150e,0x88,0x1196e0001152e,0x90,0x1198e0001154e,0x98,0x119ae0001156e,0xa0,0x119ce0001158e,0xa8,0x119ee000115ae,0xb0,0x118e0000118e0,0xb8
.quad 0x1192e000114ee,0xc0,0x1194e0001150e,0xc8,0x1196e0001152e,0xd0,0x1198e0001154e,0xd8,0x119ae0001156e,0xe0,0x119ce0001158e,0xe8,0x119ee000115ae,0xf0,0x118e0000118e0,0xf8
.quad 0xeeae0000ea6e,0x100,0xeece0000ea8e,0x108,0xeeee0000eaae,0x110,0xef0e0000eace,0x118,0xef2e0000eaee,0x120,0xef4e0000eb0e,0x128,0xef6e0000eb2e,0x130,0xee600000ee60,0x138
.quad 0xeeae0000ea6e,0x140,0xeece0000ea8e,0x148,0xeeee0000eaae,0x150,0xef0e0000eace,0x158,0xef2e0000eaee,0x160,0xef4e0000eb0e,0x168,0xef6e0000eb2e,0x170,0xee600000ee60,0x178
.quad 0xf72e0000f2ee,0x180,0xf74e0000f30e,0x188,0xf76e0000f32e,0x190,0xf78e0000f34e,0x198,0xf7ae0000f36e,0x1a0,0xf7ce0000f38e,0x1a8,0xf7ee0000f3ae,0x1b0,0xf6e00000f6e0,0x1b8
.quad 0xf72e0000f2ee,0x1c0,0xf74e0000f30e,0x1c8,0xf76e0000f32e,0x1d0,0xf78e0000f34e,0x1d8,0xf7ae0000f36e,0x1e0,0xf7ce0000f38e,0x1e8,0xf7ee0000f3ae,0x1f0,0xf6e00000f6e0,0x1f8
.quad 0x8000280028002800,0x8000280080002800,0x964827fea8002800,0x9cb227ea9a4627f6,0x9a4627f628002800,0xa0a527a89e3e27d9,0x9cb227eaa8002800,0xa2d7273ba0a527a8,0x9e3e27d928002800,0xa47226a7a21f2764,0x9fc627c3a8002800,0xa55f25eda38b270e,0xa0a527a828002800,0xa62f2513a47226a7,0xa1642788a8002800,0xa6dd241da513262f
.quad 0xa21f276428002800,0xa764221fa5a825a8,0xa2d7273ba8002800,0xa7c31fc6a62f2513,0xa38b270e28002800,0xa7f61a46a6a72472,0xa41d26dda8002800,0xa7fe9648a70e238b,0xa47226a728002800,0xa7d99e3ea764221f,0xa4c4266da8002800,0xa788a164a7a820a5,0xa513262f28002800,0xa70ea38ba7d91e3e,0xa55f25eda8002800,0xa66da4c4a7f61a46
.quad 0xa5a825a828002800,0xa5a8a5a8a8000000,0xa5ed255fa8002800,0xa4c4a66da7f69a46,0xa62f251328002800,0xa38ba70ea7d99e3e,0xa66d24c4a8002800,0xa164a788a7a8a0a5,0xa6a7247228002800,0x9e3ea7d9a764a21f,0xa6dd241da8002800,0x9648a7fea70ea38b,0xa70e238b28002800,0x1a46a7f6a6a7a472,0xa73b22d7a8002800,0x1fc6a7c3a62fa513
.quad 0xa764221f28002800,0x221fa764a5a8a5a8,0xa7882164a8002800,0x241da6dda513a62f,0xa7a820a528002800,0x2513a62fa472a6a7,0xa7c31fc6a8002800,0x25eda55fa38ba70e,0xa7d91e3e28002800,0x26a7a472a21fa764,0xa7ea1cb2a8002800,0x273ba2d7a0a5a7a8,0xa7f61a4628002800,0x27a8a0a59e3ea7d9,0xa7fe1648a8002800,0x27ea9cb29a46a7f6
.quad 0x8000280080002800,0x8000280080002800,0x9fc627c39e3e27d9,0xa1642788a0a527a8,0xa38b270ea21f2764,0xa513262fa47226a7,0xa55f25eda47226a7,0xa6dd241da62f2513,0xa6a72472a5a825a8,0xa7d91e3ea764221f,0xa7882164a6a72472,0xa7ea9cb2a7f61a46,0xa7f61a46a764221f,0xa70ea38ba7d99e3e,0xa7ea9cb2a7d91e3e,0xa55fa5eda70ea38b
.quad 0xa764a21fa8000000,0xa21fa764a5a8a5a8,0xa66da4c4a7d99e3e,0x9648a7fea38ba70e,0xa513a62fa764a21f,0x20a5a7a89e3ea7d9,0xa2d7a73ba6a7a472,0x24c4a66d1a46a7f6,0x9e3ea7d9a5a8a5a8,0x26a7a472221fa764,0x1648a7fea472a6a7,0x27c39fc62513a62f,0x20a5a7a8a21fa764,0x27f61a4626a7a472,0x241da6dd9e3ea7d9,0x273b22d727a8a0a5
.quad 0x25a8a5a88000a800,0x25a825a828008000,0x26dda41d1e3ea7d9,0x22d7273b27a820a5,0x27a8a0a5221fa764,0x1a4627f626a72472,0x27fe96482472a6a7,0x9fc627c32513262f,0x27d91e3e25a8a5a8,0xa47226a7221f2764,0x273b22d726a7a472,0xa66d24c41a4627f6,0x262f25132764a21f,0xa7a820a59e3e27d9,0x24c4266d27d99e3e,0xa7fe9648a38b270e
.quad 0x221f276428008000,0xa764a21fa5a825a8,0x1cb227ea27d91e3e,0xa5eda55fa70e238b,0x9a4627f62764221f,0xa38ba70ea7d91e3e,0xa164278826a72472,0x9cb2a7eaa7f69a46,0xa47226a725a825a8,0x1e3ea7d9a764a21f,0xa5ed255f247226a7,0x241da6dda62fa513,0xa70e238b221f2764,0x262fa513a472a6a7,0xa7c31fc61e3e27d9,0x2788a164a0a5a7a8
.quad 0x8000280080002800,0x8000280080002800,0xa2d7273ba21f2764,0xa41d26dda38b270e,0xa62f2513a5a825a8,0xa70e238ba6a72472,0xa7c31fc6a764221f,0xa7fe9648a7f61a46,0xa7d99e3ea8000000,0xa6a7a472a764a21f,0xa66da4c4a764a21f,0xa2d7a73ba513a62f,0xa38ba70ea5a8a5a8,0x1a46a7f69e3ea7d9,0x9648a7fea21fa764,0x24c4a66d20a5a7a8
.quad 0x221fa7648000a800,0x2764a21f25a8a5a8,0x25eda55f221fa764,0x27ea1cb227a8a0a5,0x27a8a0a525a8a5a8,0x262f251327d91e3e,0x27ea1cb22764a21f,0x21642788262f2513,0x26a7247228008000,0x9e3e27d9221f2764,0x241d26dd2764221f,0xa55f25ed9a4627f6,0x1a4627f625a825a8,0xa7a820a5a47226a7,0xa1642788221f2764,0xa7c39fc6a70e238b
.quad 0xa5a825a800002800,0xa5a8a5a8a8000000,0xa7882164a21f2764,0x9fc6a7c3a70ea38b,0xa7f69a46a5a825a8,0x20a5a7a8a472a6a7,0xa6dda41da764221f,0x25eda55f9a46a7f6,0xa472a6a7a8000000,0x27d99e3e221fa764,0x9cb2a7eaa764a21f,0x27882164262fa513,0x20a5a7a8a5a8a5a8,0x2513262f27d99e3e,0x255fa5eda21fa764,0x1cb227ea27a820a5
.quad 0x2764a21f8000a800,0xa21f276425a825a8,0x27fe1648221fa764,0xa66d24c420a527a8,0x270e238b25a8a5a8,0xa7f61a469e3e27d9,0x24c4266d2764a21f,0xa73ba2d7a513262f,0x1e3e27d928008000,0xa472a6a7a764221f,0x9fc627c32764221f,0x9648a7fea7f69a46,0xa513262f25a825a8,0x238ba70ea6a7a472,0xa73b22d7221f2764,0x26dda41da38ba70e
.quad 0x8000280080002800,0x8000280080002800,0xa4c4266da47226a7,0xa55f25eda513262f,0xa7a820a5a764221f,0xa7f61a46a7d91e3e,0xa788a164a7d99e3e,0xa66da4c4a70ea38b,0xa472a6a7a5a8a5a8,0x9e3ea7d9a21fa764,0x1648a7fe9e3ea7d9,0x241da6dd20a5a7a8,0x2513a62f221fa764,0x27a8a0a526a7a472,0x27c39fc626a7a472,0x273b22d727f61a46
.quad 0x2764221f28008000,0x221f276425a825a8,0x241d26dd26a72472,0xa16427881a4627f6,0x9a4627f6221f2764,0xa70e238ba47226a7,0xa55f25ed9e3e27d9,0xa7c39fc6a7a820a5,0xa7d91e3ea5a825a8,0xa472a6a7a764a21f,0xa73ba2d7a7d91e3e,0x1cb2a7eaa38ba70e,0xa38ba70ea764a21f,0x262fa5131e3ea7d9,0x1cb2a7eaa472a6a7,0x27fe1648262fa513
.quad 0x25a8a5a88000a800,0x25a825a828008000,0x27ea9cb22472a6a7,0x164827fe262f2513,0x270e238b2764a21f,0xa513262f1e3e27d9,0x22d7273b27d91e3e,0xa7ea1cb2a38b270e,0x9e3e27d925a825a8,0xa6a7a472a764221f,0xa5ed255f1e3e27d9,0x9fc6a7c3a7a8a0a5,0xa7f61a46a21f2764,0x238ba70ea472a6a7,0xa6dda41da6a72472,0x2788a1641a46a7f6
.quad 0xa21fa764a8000000,0x2764221f25a8a5a8,0x1fc6a7c3a6a7a472,0x22d7273b27f69a46,0x262fa513a21fa764,0xa0a527a826a72472,0x27fe96481e3ea7d9,0xa6dd241d20a527a8,0x26a7247225a8a5a8,0xa7d99e3ea21f2764,0x2164278827d99e3e,0xa4c4a66da70e238b,0xa0a527a82764221f,0x1a46a7f6a7d99e3e,0xa66d24c4247226a7,0x25eda55fa513a62f
.quad 0x8000280080002800,0x8000280080002800,0xa5ed255fa5a825a8,0xa66d24c4a62f2513,0xa7f69a46a8000000,0xa7a8a0a5a7d99e3e,0xa4c4a66da5a8a5a8,0xa164a788a38ba70e,0x1e3ea7d98000a800,0x2472a6a7221fa764,0x26dda41d25a8a5a8,0x27fe964827a8a0a5,0x27a820a528008000,0x2513262f26a72472,0x22d7273b25a825a8,0x9fc627c31a4627f6
.quad 0xa21f276400002800,0xa764221fa5a825a8,0xa7882164a5a825a8,0xa6dda41da7f69a46,0xa70ea38ba8000000,0x9a46a7f6a472a6a7,0x9fc6a7c3a5a8a5a8,0x25eda55f20a5a7a8,0x2472a6a78000a800,0x27d91e3e2764a21f,0x27ea9cb225a8a5a8,0x22d7273b270e238b,0x262f251328008000,0xa38b270e1e3e27d9,0x164827fe25a825a8,0xa7ea1cb2a513262f
.quad 0xa5a825a800002800,0xa5a8a5a8a8000000,0xa7fe9648a5a825a8,0x1cb2a7eaa513a62f,0xa513a62fa8000000,0x270ea38b1e3ea7d9,0x1cb2a7eaa5a8a5a8,0x273b22d7270ea38b,0x26a7a4728000a800,0x1e3e27d92764221f,0x27c31fc625a8a5a8,0xa55f25ed20a527a8,0x238b270e28008000,0xa7f69a46a47226a7,0xa164278825a825a8,0xa41da6dda7f61a46
.quad 0xa764221f00002800,0x221fa764a5a8a5a8,0xa73ba2d7a5a825a8,0x27c39fc61a46a7f6,0xa0a5a7a8a8008000,0x262f251326a7a472,0x241da6dda5a8a5a8,0x964827fe27a820a5,0x27d99e3e8000a800,0xa6a72472221f2764,0x266d24c425a8a5a8,0xa788a164a38b270e,0x1a4627f628008000,0xa0a5a7a8a7d91e3e,0xa55f25ed25a825a8,0x24c4a66da62fa513
.quad 0x8000280080002800,0x8000280080002800,0xa6dd241da6a72472,0xa73b22d7a70e238b,0xa70ea38ba764a21f,0xa62fa513a6a7a472,0x9648a7fe9e3ea7d9,0x1fc6a7c31a46a7f6,0x26a7a47225a8a5a8,0x27d99e3e2764a21f,0x273b22d727d91e3e,0x24c4266d262f2513,0x1a4627f6221f2764,0xa38b270e9e3e27d9,0xa66d24c4a47226a7,0xa7fe9648a7a820a5
.quad 0xa764a21fa8000000,0xa21fa764a5a8a5a8,0x9cb2a7eaa472a6a7,0x255fa5ed20a5a7a8,0x262fa513221fa764,0x27a820a527d99e3e,0x2788216427d99e3e,0x1cb227ea2513262f,0x1e3e27d925a825a8,0xa6a72472a21f2764,0xa5ed255f9e3e27d9,0xa6dda41da7f61a46,0xa7a8a0a5a764221f,0x1a46a7f6a472a6a7,0x9fc6a7c3a6a7a472,0x2788a164238ba70e
.quad 0x25a8a5a88000a800,0x25a825a828008000,0x27c31fc626a7a472,0xa1642788238b270e,0x20a527a82764221f,0xa7f61a46a47226a7,0xa55f25ed1e3e27d9,0xa41da6dda7f69a46,0xa7d99e3ea5a825a8,0x2472a6a7a21fa764,0xa164a788a7d99e3e,0x27ea1cb22513a62f,0x2513a62fa21fa764,0x20a527a827d91e3e,0x27ea1cb22472a6a7,0xa5ed255f20a527a8
.quad 0x221f276428008000,0xa764a21fa5a825a8,0xa4c4266d247226a7,0x9648a7fea7a8a0a5,0xa7f69a46a21f2764,0x270ea38b9e3ea7d9,0xa2d7a73ba7d91e3e,0x266d24c4262fa513,0x2472a6a7a5a8a5a8,0x9e3e27d92764221f,0x27fe16481e3ea7d9,0xa7c31fc61a4627f6,0x238b270e2764a21f,0xa513a62fa6a72472,0xa41d26dd26a72472,0x22d7a73ba70ea38b
.quad 0x8000280080002800,0x8000280080002800,0xa7882164a764221f,0xa7c31fc6a7a820a5,0xa513a62fa5a8a5a8,0xa38ba70ea472a6a7,0x241da6dd221fa764,0x25eda55f2513a62f,0x27d91e3e28008000,0x26a724722764221f,0x1cb227ea221f2764,0xa16427889a4627f6,0xa70e238ba5a825a8,0xa7f69a46a7d91e3e,0xa5eda55fa764a21f,0x9cb2a7eaa38ba70e
.quad 0x221fa7648000a800,0x2764a21f25a8a5a8,0x27fe16482764a21f,0x24c4266d270e238b,0x20a527a825a825a8,0xa513262f9e3e27d9,0xa66d24c4a21f2764,0xa73ba2d7a7f61a46,0xa6a7a472a8000000,0x1e3ea7d9a21fa764,0x1fc6a7c3a21fa764,0x27fe9648262fa513,0x27f69a4625a8a5a8,0x20a527a826a72472,0x22d7273b2764221f,0xa6dd241da0a527a8
.quad 0xa5a825a800002800,0xa5a8a5a8a8008000,0xa73ba2d7a764221f,0x241da6dda0a5a7a8,0x1a46a7f6a5a8a5a8,0x27a820a526a7a472,0x27c39fc6221fa764,0x964827fe262f2513,0x247226a728008000,0xa7d91e3ea21f2764,0xa4c4266d221f2764,0xa2d7a73ba7f69a46,0xa7a8a0a5a5a825a8,0x262fa5139e3ea7d9,0x9648a7fea764a21f,0x266d24c4270ea38b
.quad 0x2764a21f8000a800,0xa21f276425a825a8,0x255f25ed2764a21f,0xa7ea9cb2a38b270e,0xa38b270e25a825a8,0x9a46a7f6a7d99e3e,0xa7ea9cb2a21f2764,0x2788a1649a46a7f6,0x9e3ea7d9a8008000,0x247226a72764a21f,0x26dda41da21fa764,0xa55f25ed2513262f,0x262f251325a8a5a8,0xa70ea38ba47226a7,0xa16427882764221f,0x1fc6a7c3a7a8a0a5
.quad 0x8000280080002800,0x8000280080002800,0xa7ea1cb2a7d91e3e,0xa7fe1648a7f61a46,0xa0a5a7a8a21fa764,0x9a46a7f69e3ea7d9,0x273ba2d726a7a472,0x27ea9cb227a8a0a5,0x247226a725a825a8,0x1e3e27d9221f2764,0xa5ed255fa47226a7,0xa7c31fc6a70e238b,0xa62fa513a764a21f,0xa0a5a7a8a472a6a7,0x241da6dd1e3ea7d9,0x2788a164262fa513
.quad 0x2764221f28008000,0x221f276425a825a8,0x9fc627c31e3e27d9,0xa73b22d7a513262f,0xa7f69a46a764221f,0xa38ba70ea6a7a472,0x9648a7fea472a6a7,0x26dda41d238ba70e,0x27d99e3e25a8a5a8,0x247226a72764221f,0x2164278826a72472,0xa66d24c4a0a527a8,0xa70e238ba21f2764,0xa513a62fa7d99e3e,0xa4c4a66da7d99e3e,0x25eda55f1a46a7f6
.quad 0x25a8a5a88000a800,0x25a825a828008000,0x266d24c427d99e3e,0xa55f25ed1a4627f6,0xa38b270e221f2764,0xa62fa513a7d91e3e,0xa788a164a6a72472,0x24c4a66da0a5a7a8,0x1e3ea7d9a5a8a5a8,0x26a724722764a21f,0x27fe16482472a6a7,0xa41d26dd238b270e,0x1a4627f62764221f,0xa70ea38ba6a72472,0xa7c31fc69e3e27d9,0x22d7a73ba513a62f
.quad 0xa21fa764a8008000,0x2764221f25a8a5a8,0x26dda41d9e3ea7d9,0xa1642788262f2513,0x2513262f2764a21f,0xa7a8a0a5a47226a7,0xa55f25ed247226a7,0x1fc6a7c3a70ea38b,0xa6a7a472a5a825a8,0x27d91e3e221fa764,0x22d7a73ba6a7a472,0x9cb227ea27a820a5,0x27a820a5221fa764,0xa7f69a469e3e27d9,0x9cb227ea27d91e3e,0x1648a7fea7f69a46
.quad 0x8000280080002800,0x8000280080002800,0xa7fe9648a8000000,0xa7ea9cb2a7f69a46,0x1a46a7f68000a800,0x20a5a7a81e3ea7d9,0x27ea1cb228008000,0x273b22d727a820a5,0x9e3e27d900002800,0xa47226a7a21f2764,0xa7c39fc6a8000000,0xa5eda55fa70ea38b,0x20a5a7a88000a800,0x262fa5132472a6a7,0x2788216428008000,0x241d26dd262f2513
.quad 0xa21f276400002800,0xa764221fa5a825a8,0xa73ba2d7a8000000,0x9fc6a7c3a513a62f,0x238ba70e8000a800,0x27f69a4626a7a472,0x26dd241d28008000,0x964827fe238b270e,0xa47226a700002800,0xa7d99e3ea764221f,0xa66da4c4a8008000,0x2164a788a0a5a7a8,0x2513a62f8000a800,0x270e238b27d99e3e,0x25ed255f28008000,0xa4c4266d1a4627f6
.quad 0xa5a825a800002800,0xa5a8a5a8a8008000,0xa55fa5eda8008000,0x266da4c41a46a7f6,0x262fa5138000a800,0x238b270e27d91e3e,0x24c4266d28008000,0xa7882164a0a527a8,0xa6a7247200002800,0x9e3ea7d9a764a21f,0xa41da6dda8008000,0x27fe9648238ba70e,0x270ea38b8000a800,0x9a4627f626a72472,0x22d7273b28008000,0xa7c39fc6a513262f
.quad 0xa764221f00002800,0x221fa764a5a8a5a8,0xa164a788a8008000,0x26dd241d262fa513,0x27a8a0a50000a800,0xa513262f247226a7,0x1fc627c328008000,0xa55fa5eda70e238b,0xa7d91e3e00002800,0x26a7a472a21fa764,0x9cb2a7eaa8008000,0x22d7273b27a8a0a5,0x27f69a468000a800,0xa7a820a51e3e27d9,0x164827fe28008000,0x9cb2a7eaa7f61a46
.quad 0x8000280080002800,0x8000280080002800,0xa7c39fc6a7d99e3e,0xa788a164a7a8a0a5,0x238ba70e221fa764,0x2513a62f2472a6a7,0x25ed255f26a72472,0x241d26dd2513262f,0xa6a72472a5a825a8,0xa7d91e3ea764221f,0xa164a788a472a6a7,0x1cb2a7ea9a46a7f6,0x27f69a462764a21f,0x270e238b27d91e3e,0x9cb227ea1e3e27d9,0xa5ed255fa38b270e
.quad 0xa764a21fa8000000,0xa21fa764a5a8a5a8,0x24c4a66d1e3ea7d9,0x27fe9648270ea38b,0x2513262f2764221f,0xa0a527a81e3e27d9,0xa73b22d7a47226a7,0xa66da4c4a7f69a46,0x9e3ea7d9a5a8a5a8,0x26a7a472221fa764,0x27fe164826a7a472,0x1fc627c3262f2513,0xa0a527a8221f2764,0xa7f69a46a6a72472,0xa6dda41da7d91e3e,0x22d7a73ba0a5a7a8
.quad 0x25a8a5a88000a800,0x25a825a828008000,0x241d26dd27d91e3e,0xa73b22d7a0a527a8,0xa7a820a5a21f2764,0x9a46a7f6a6a7a472,0x9648a7fea6a7a472,0x27c31fc6262fa513,0x27d91e3e25a8a5a8,0xa47226a7221f2764,0xa2d7273b247226a7,0xa4c4a66da7f61a46,0xa62fa513a764221f,0x27a8a0a51e3ea7d9,0x266da4c49e3ea7d9,0x964827fe270e238b
.quad 0x221f276428008000,0xa764a21fa5a825a8,0xa7ea1cb29e3e27d9,0x255fa5eda38ba70e,0x1a46a7f6a764a21f,0x238b270e27d99e3e,0x278821642472a6a7,0xa7ea1cb29a4627f6,0xa47226a725a825a8,0x1e3ea7d9a764a21f,0xa55fa5eda6a72472,0x26dd241d2513a62f,0x270ea38ba21fa764,0xa62f2513247226a7,0x1fc627c327d99e3e,0xa164a788a7a820a5
.quad 0x8000280080002800,0x8000280080002800,0xa73ba2d7a764a21f,0xa6dda41da70ea38b,0x262fa51325a8a5a8,0x270ea38b26a7a472,0x1fc627c3221f2764,0x964827fe1a4627f6,0xa7d99e3ea8000000,0xa6a7a472a764a21f,0x24c4a66d221fa764,0x273ba2d7262fa513,0x238b270e25a825a8,0x9a4627f61e3e27d9,0xa7fe1648a764221f,0xa66da4c4a7a8a0a5
.quad 0x221fa7648000a800,0x2764a21f25a8a5a8,0x255f25ed2764221f,0x9cb227ea20a527a8,0xa7a820a5a5a825a8,0xa62fa513a7d99e3e,0x1cb2a7eaa21fa764,0x2788a1642513a62f,0x26a7247228008000,0x9e3e27d9221f2764,0xa6dd241da21f2764,0xa5eda55fa7f69a46,0x9a46a7f6a5a8a5a8,0x27a8a0a52472a6a7,0x278821642764a21f,0x9fc627c3238b270e
.quad 0xa5a825a800002800,0xa5a8a5a8a8008000,0xa164a788a764a21f,0x27c39fc6238ba70e,0x27f61a4625a8a5a8,0xa0a527a8247226a7,0xa41d26dd221f2764,0xa55fa5eda7f61a46,0xa472a6a7a8008000,0x27d99e3e221fa764,0x27ea9cb2221fa764,0xa16427882513262f,0xa0a527a825a825a8,0xa513a62fa7d91e3e,0xa5eda55fa764221f,0x27ea9cb220a5a7a8
.quad 0x2764a21f8000a800,0xa21f276425a825a8,0x964827fe2764221f,0xa4c4a66da7a820a5,0xa70ea38ba5a825a8,0x27f69a461e3ea7d9,0x266da4c4a21fa764,0xa2d7273b262f2513,0x1e3e27d928008000,0xa472a6a7a764221f,0xa7c39fc6a21f2764,0x27fe96481a46a7f6,0x2513a62fa5a8a5a8,0xa38b270e26a72472,0x22d7273b2764a21f,0xa41da6dda70e238b
.quad 0x8000280080002800,0x8000280080002800,0xa66da4c4a6a7a472,0xa5eda55fa62fa513,0x27a8a0a52764a21f,0x27f69a4627d99e3e,0xa16427889e3e27d9,0xa4c4266da38b270e,0xa472a6a7a5a8a5a8,0x9e3ea7d9a21fa764,0x27fe164827d99e3e,0x26dd241d27a820a5,0xa513262fa21f2764,0xa7a820a5a6a72472,0x9fc6a7c3a472a6a7,0x22d7a73b1a46a7f6
.quad 0x2764221f28008000,0x221f276425a825a8,0xa6dd241da47226a7,0xa788a164a7f61a46,0x1a46a7f6a21fa764,0x270ea38b2472a6a7,0x25ed255f27d91e3e,0x9fc627c320a527a8,0xa7d91e3ea5a825a8,0xa472a6a7a764a21f,0x22d7a73b9e3ea7d9,0x27ea1cb2270ea38b,0x238b270e2764221f,0xa62f25139e3e27d9,0xa7ea9cb2a6a72472,0x1648a7fea513a62f
.quad 0x25a8a5a88000a800,0x25a825a828008000,0x1cb227ea26a72472,0xa7fe1648a513262f,0xa70ea38ba764221f,0x2513a62f9e3ea7d9,0x273ba2d71e3ea7d9,0x1cb227ea270e238b,0x9e3e27d925a825a8,0xa6a7a472a764221f,0xa55fa5eda7d91e3e,0x27c39fc620a5a7a8,0x27f69a46221fa764,0xa38b270e247226a7,0xa41d26dd247226a7,0xa164a788a7f69a46
.quad 0xa21fa764a8000000,0x2764221f25a8a5a8,0x27c31fc62472a6a7,0xa73b22d71a4627f6,0xa62f2513221f2764,0x20a5a7a8a6a7a472,0x9648a7fea7d99e3e,0x241d26dd27a8a0a5,0x26a7247225a8a5a8,0xa7d99e3ea21f2764,0xa78821641e3e27d9,0x266da4c4a38ba70e,0x20a5a7a8a764a21f,0x9a4627f627d91e3e,0x24c4266d26a7a472,0xa55fa5eda62f2513
.quad 0x8000280080002800,0x8000280080002800,0xa55fa5eda5a8a5a8,0xa4c4a66da513a62f,0x27f61a4628008000,0x27a820a527d91e3e,0xa66d24c4a5a825a8,0xa7882164a70e238b,0x1e3ea7d98000a800,0x2472a6a7221fa764,0x241d26dd25a825a8,0x164827fe20a527a8,0xa7a8a0a5a8000000,0xa513a62fa6a7a472,0x273ba2d725a8a5a8,0x27c31fc627f69a46
.quad 0xa21f276400002800,0xa764221fa5a825a8,0xa164a788a5a8a5a8,0x241da6dd1a46a7f6,0x270e238b28008000,0x1a4627f6247226a7,0xa7c31fc6a5a825a8,0xa55fa5eda7a8a0a5,0x2472a6a78000a800,0x27d91e3e2764a21f,0x1cb227ea25a825a8,0xa73b22d7a38b270e,0xa62fa513a8008000,0x238ba70e9e3ea7d9,0x27fe964825a8a5a8,0x1cb227ea262f2513
.quad 0xa5a825a800002800,0xa5a8a5a8a8008000,0x1648a7fea5a8a5a8,0x27ea1cb2262fa513,0x2513262f28008000,0xa70e238b9e3e27d9,0xa7ea9cb2a5a825a8,0x22d7a73ba38ba70e,0x26a7a4728000a800,0x1e3e27d92764221f,0x9fc627c325a825a8,0xa5eda55fa7a820a5,0xa38ba70ea8000000,0x27f61a462472a6a7,0x2788216425a8a5a8,0xa6dd241d1a4627f6
.quad 0xa764221f00002800,0x221fa764a5a8a5a8,0x22d7a73ba5a8a5a8,0x1fc627c327f61a46,0x20a527a828000000,0xa62fa513a6a72472,0xa6dda41da5a825a8,0x27fe164820a5a7a8,0x27d99e3e0000a800,0xa6a72472221f2764,0xa4c4266d25a825a8,0x2164a788a70ea38b,0x9a46a7f6a8000000,0x20a527a827d99e3e,0x25ed255f25a8a5a8,0xa66da4c4a513262f
.quad 0x8000280080002800,0x8000280080002800,0xa41da6dda472a6a7,0xa2d7a73ba38ba70e,0x270e238b2764221f,0x262f251326a72472,0xa7fe1648a7d91e3e,0xa7c39fc6a7f69a46,0x26a7a47225a8a5a8,0x27d99e3e2764a21f,0xa2d7273b9e3e27d9,0xa66d24c4a513262f,0x9a46a7f6a21fa764,0x238ba70e1e3ea7d9,0x24c4266d26a72472,0x964827fe20a527a8
.quad 0xa764a21fa8008000,0xa21fa764a5a8a5a8,0x27ea9cb226a7a472,0x25ed255f27a820a5,0xa62f2513a21f2764,0xa7a8a0a5a7d91e3e,0x2164a7889e3ea7d9,0x27ea9cb2262fa513,0x1e3e27d925a825a8,0xa6a72472a21f2764,0xa55fa5eda7d99e3e,0x241da6dd9a46a7f6,0x27a820a52764a21f,0x9a4627f6247226a7,0xa7c31fc6a47226a7,0xa164a788a70ea38b
.quad 0x25a8a5a80000a800,0x25a825a828008000,0x9fc627c3247226a7,0xa788a164a70e238b,0xa0a5a7a8a764a21f,0x27f69a462472a6a7,0x25ed255f27d99e3e,0xa6dd241d9a4627f6,0xa7d99e3ea5a825a8,0x2472a6a7a21fa764,0x2788a1641e3ea7d9,0x9cb227ea262f2513,0xa513262f221f2764,0xa0a5a7a8a7d99e3e,0x1cb2a7eaa6a7a472,0x255f25ed27a8a0a5
.quad 0x221f276428008000,0xa764a21fa5a825a8,0xa66da4c4a6a72472,0x27fe964820a5a7a8,0x27f61a46221fa764,0xa70e238b1e3e27d9,0xa73b22d71e3e27d9,0x24c4a66da513a62f,0x2472a6a7a5a8a5a8,0x9e3e27d92764221f,0x964827fe27d91e3e,0x9fc6a7c3a7f61a46,0xa38ba70ea764221f,0x2513262f26a7a472,0x26dd241d2472a6a7,0xa73ba2d7a38b270e
.quad 0x8000280080002800,0x8000280080002800,0xa164a788a21fa764,0x9fc6a7c3a0a5a7a8,0x2513262f25a825a8,0x238b270e247226a7,0xa6dda41da764a21f,0xa55fa5eda62fa513,0x27d91e3e28008000,0x26a724722764221f,0xa7ea1cb2a764221f,0xa788a164a7f69a46,0x270ea38b25a8a5a8,0x27f61a4627d99e3e,0xa55f25eda21f2764,0xa7ea1cb2a70e238b
.quad 0x221fa7648000a800,0x2764a21f25a8a5a8,0x964827fe221f2764,0xa66d24c4a38b270e,0xa0a5a7a8a5a8a5a8,0x2513a62f1e3ea7d9,0x24c4266d2764221f,0xa2d7273b1a4627f6,0xa6a7a472a8008000,0x1e3ea7d9a21fa764,0x27c31fc62764a21f,0x164827fe2513262f,0xa7f61a46a5a825a8,0xa0a5a7a8a6a7a472,0x273ba2d7221fa764,0x241d26dd27a820a5
.quad 0xa5a825a800002800,0xa5a8a5a8a8008000,0x22d7a73ba21fa764,0x26dd241d27a8a0a5,0x9a4627f625a825a8,0xa7a8a0a5a6a72472,0x9fc6a7c3a764a21f,0x27fe16482513a62f,0x247226a728008000,0xa7d91e3ea21f2764,0xa66da4c4a764221f,0x273ba2d71a46a7f6,0x27a820a525a8a5a8,0xa62f25131e3e27d9,0xa7fe1648a21f2764,0x24c4a66da38ba70e
.quad 0x2764a21f0000a800,0xa21f276425a825a8,0xa5ed255f221f2764,0x1cb2a7eaa70ea38b,0x238ba70ea5a8a5a8,0x1a4627f627d91e3e,0x9cb227ea2764221f,0xa164a788a7f61a46,0x9e3ea7d9a8000000,0x247226a72764a21f,0x241d26dd2764a21f,0xa5eda55fa62f2513,0xa62fa513a5a825a8,0x270e238b2472a6a7,0x27882164221fa764,0xa7c39fc6a0a527a8
.quad 0x8000280080002800,0x8000280080002800,0x9cb2a7ea9e3ea7d9,0x9648a7fe9a46a7f6,0x20a527a8221f2764,0x1a4627f61e3e27d9,0xa2d7a73ba472a6a7,0x9cb2a7eaa0a5a7a8,0x247226a725a825a8,0x1e3e27d9221f2764,0xa55fa5eda6a7a472,0x9fc6a7c3a38ba70e,0x262f25132764221f,0x20a527a8247226a7,0xa6dda41da7d99e3e,0xa164a788a513a62f
.quad 0x2764221f28008000,0x221f276425a825a8,0xa7c39fc6a7d91e3e,0xa2d7a73ba62fa513,0x27f61a462764a21f,0x238b270e26a72472,0xa7fe1648a6a72472,0xa41da6dda70ea38b,0x27d99e3e25a8a5a8,0x247226a72764221f,0xa7882164a47226a7,0xa4c4a66da7a8a0a5,0x270ea38b221fa764,0x2513262f27d91e3e,0xa66d24c49e3e27d9,0xa55fa5eda7f69a46
.quad 0x25a8a5a88000a800,0x25a825a828008000,0xa4c4266d1e3e27d9,0xa5eda55fa7f61a46,0x238ba70ea21fa764,0x262f251327d99e3e,0xa1642788247226a7,0xa66da4c4a7a820a5,0x1e3ea7d9a5a8a5a8,0x26a724722764a21f,0x964827fe26a72472,0xa6dda41da70e238b,0x9a46a7f6a764a21f,0x270e238b26a7a472,0x1fc627c327d91e3e,0xa73ba2d7a62f2513
.quad 0xa21fa764a8000000,0x2764221f25a8a5a8,0x241d26dd27d99e3e,0xa788a164a513262f,0xa513a62fa764221f,0x27a820a52472a6a7,0x25ed255f26a7a472,0xa7c39fc6a38b270e,0xa6a7a472a5a825a8,0x27d91e3e221fa764,0x273b22d72472a6a7,0xa7ea9cb2a0a527a8,0xa7a8a0a5a21f2764,0x27f61a461e3ea7d9,0x27ea1cb21e3ea7d9,0xa7fe96489a4627f6
.quad 0xa800000028002800,0x280080008000a800,0xa7fe9648a8002800,0x27ea1cb21a46a7f6,0xa7f69a4628002800,0x27a820a51e3ea7d9,0xa7ea9cb2a8002800,0x273b22d720a5a7a8,0xa7d99e3e28002800,0x26a72472221fa764,0xa7c39fc6a8002800,0x25ed255f238ba70e,0xa7a8a0a528002800,0x2513262f2472a6a7,0xa788a164a8002800,0x241d26dd2513a62f
.quad 0xa764a21f28002800,0x221f276425a8a5a8,0xa73ba2d7a8002800,0x1fc627c3262fa513,0xa70ea38b28002800,0x1a4627f626a7a472,0xa6dda41da8002800,0x964827fe270ea38b,0xa6a7a47228002800,0x9e3e27d92764a21f,0xa66da4c4a8002800,0xa164278827a8a0a5,0xa62fa51328002800,0xa38b270e27d99e3e,0xa5eda55fa8002800,0xa4c4266d27f69a46
.quad 0xa5a8a5a828002800,0xa5a825a828008000,0xa55fa5eda8002800,0xa66d24c427f61a46,0xa513a62f28002800,0xa70e238b27d91e3e,0xa4c4a66da8002800,0xa788216427a820a5,0xa472a6a728002800,0xa7d91e3e2764221f,0xa41da6dda8002800,0xa7fe1648270e238b,0xa38ba70e28002800,0xa7f69a4626a72472,0xa2d7a73ba8002800,0xa7c39fc6262f2513
.quad 0xa21fa76428002800,0xa764a21f25a825a8,0xa164a788a8002800,0xa6dda41d2513262f,0xa0a5a7a828002800,0xa62fa513247226a7,0x9fc6a7c3a8002800,0xa55fa5ed238b270e,0x9e3ea7d928002800,0xa472a6a7221f2764,0x9cb2a7eaa8002800,0xa2d7a73b20a527a8,0x9a46a7f628002800,0xa0a5a7a81e3e27d9,0x9648a7fea8002800,0x9cb2a7ea1a4627f6
.quad 0xa800000000002800,0x280080008000a800,0xa7c39fc69e3e27d9,0x2788216420a5a7a8,0xa70ea38ba21f2764,0x262f25132472a6a7,0xa5eda55fa47226a7,0x241d26dd262fa513,0xa472a6a7a5a825a8,0x1e3e27d92764a21f,0xa164a788a6a72472,0x9cb227ea27f69a46,0x9a46a7f6a764221f,0xa38b270e27d91e3e,0x1cb2a7eaa7d91e3e,0xa5ed255f270e238b
.quad 0x221fa764a8000000,0xa764221f25a825a8,0x24c4a66da7d99e3e,0xa7fe1648238b270e,0x262fa513a764a21f,0xa7a8a0a51e3e27d9,0x273ba2d7a6a7a472,0xa66da4c49a4627f6,0x27d99e3ea5a8a5a8,0xa472a6a7a21f2764,0x27fe1648a472a6a7,0x9fc6a7c3a513262f,0x27a820a5a21fa764,0x1a46a7f6a6a72472,0x26dd241d9e3ea7d9,0x22d7a73ba7a820a5
.quad 0x25a825a88000a800,0x25a8a5a8a8000000,0x241d26dd1e3ea7d9,0x273ba2d7a7a8a0a5,0x20a527a8221fa764,0x27f69a46a6a7a472,0x164827fe2472a6a7,0x27c31fc6a513a62f,0x9e3e27d925a8a5a8,0x26a72472a21fa764,0xa2d7273b26a7a472,0x24c4266d9a46a7f6,0xa513262f2764a21f,0x20a527a81e3ea7d9,0xa66d24c427d99e3e,0x964827fe238ba70e
.quad 0xa764221f28008000,0xa21f276425a8a5a8,0xa7ea1cb227d91e3e,0xa55f25ed270ea38b,0xa7f69a462764221f,0xa70e238b27d99e3e,0xa788a16426a72472,0xa7ea1cb227f61a46,0xa6a7a47225a825a8,0xa7d99e3e2764221f,0xa55fa5ed247226a7,0xa6dda41d262f2513,0xa38ba70e221f2764,0xa513a62f247226a7,0x9fc6a7c31e3e27d9,0xa164a78820a527a8
.quad 0xa800000000002800,0x280080008000a800,0xa73ba2d7a21f2764,0x26dd241d238ba70e,0xa513a62fa5a825a8,0x238b270e26a7a472,0x9fc6a7c3a764221f,0x964827fe27f69a46,0x1e3ea7d9a8000000,0xa47226a72764221f,0x24c4a66da764a21f,0xa73b22d72513262f,0x270ea38ba5a8a5a8,0xa7f69a461e3e27d9,0x27fe9648a21fa764,0xa66da4c4a0a527a8
.quad 0x2764221f8000a800,0xa21fa764a5a825a8,0x255f25ed221fa764,0x1cb2a7eaa7a820a5,0x20a527a825a8a5a8,0x2513a62fa7d99e3e,0x9cb227ea2764a21f,0x2788a164a62fa513,0xa47226a728008000,0x27d91e3ea21fa764,0xa6dd241d2764221f,0x25ed255f1a46a7f6,0xa7f61a4625a825a8,0x20a527a82472a6a7,0xa788a164221f2764,0x9fc627c3270ea38b
.quad 0xa5a8a5a800002800,0xa5a825a828008000,0xa164a788a21f2764,0xa7c31fc6270e238b,0x1a46a7f6a5a825a8,0xa7a8a0a5247226a7,0x241da6dda764221f,0xa55fa5ed1a4627f6,0x26a7a472a8008000,0x9e3ea7d9a21f2764,0x27ea9cb2a764a21f,0x2164a788a62f2513,0x27a820a5a5a8a5a8,0x262fa513a7d91e3e,0x25ed255fa21fa764,0x27ea9cb2a7a8a0a5
.quad 0x221f27648000a800,0x2764221fa5a8a5a8,0x964827fe221fa764,0x24c4266da0a5a7a8,0xa38b270e25a8a5a8,0x1a4627f61e3ea7d9,0xa66d24c42764a21f,0xa2d7273b2513a62f,0xa7d91e3e28008000,0xa6a724722764a21f,0xa7c39fc62764221f,0xa7fe164827f61a46,0xa62fa51325a825a8,0xa70ea38b26a72472,0xa2d7a73b221f2764,0xa41da6dd238b270e
.quad 0xa800800000002800,0x280080008000a800,0xa66da4c4a47226a7,0x25ed255f2513a62f,0xa0a5a7a8a764221f,0x1a4627f627d99e3e,0x2164a788a7d99e3e,0xa4c4266d270e238b,0x26a7a472a5a8a5a8,0xa7d91e3e221f2764,0x27fe16489e3ea7d9,0xa6dda41da0a527a8,0x262f2513221fa764,0xa0a5a7a8a6a72472,0x1fc627c326a7a472,0x22d7a73ba7f69a46
.quad 0xa21f276428008000,0x2764a21fa5a8a5a8,0xa6dd241d26a72472,0x278821649a46a7f6,0xa7f69a46221f2764,0x238b270e2472a6a7,0xa5eda55f9e3e27d9,0x9fc627c327a8a0a5,0x9e3ea7d9a5a825a8,0xa6a724722764221f,0x22d7a73ba7d91e3e,0xa7ea9cb2238b270e,0x270ea38ba764a21f,0xa513a62f9e3e27d9,0x27ea1cb2a472a6a7,0x1648a7fea62f2513
.quad 0x25a825a88000a800,0x25a8a5a8a8008000,0x1cb227ea2472a6a7,0x27fe9648a62fa513,0xa38b270e2764a21f,0x262f25139e3ea7d9,0xa73b22d727d91e3e,0x1cb227ea238ba70e,0xa7d99e3e25a825a8,0xa47226a72764a21f,0xa55fa5ed1e3e27d9,0xa7c31fc627a820a5,0x9a46a7f6a21f2764,0xa70ea38b247226a7,0x241da6dda6a72472,0xa164a7889a4627f6
.quad 0x2764a21fa8008000,0x221fa764a5a825a8,0x27c31fc6a6a7a472,0x273ba2d7a7f61a46,0x2513262fa21fa764,0x27a820a5a6a7a472,0x164827fe1e3ea7d9,0x241d26dda0a5a7a8,0xa47226a725a8a5a8,0x9e3e27d9221fa764,0xa788216427d99e3e,0xa66d24c4270ea38b,0xa7a8a0a52764221f,0xa7f69a4627d91e3e,0xa4c4a66d247226a7,0xa55fa5ed2513262f
.quad 0xa800800000002800,0x280080008000a800,0xa55fa5eda5a825a8,0x24c4266d262fa513,0x1a46a7f6a8008000,0xa0a527a827d91e3e,0x266da4c4a5a8a5a8,0xa7882164238b270e,0x27d91e3e8000a800,0xa6a7a472a21f2764,0x241d26dd25a8a5a8,0x9648a7fea7a820a5,0xa0a527a828008000,0x262fa513a6a7a472,0xa73b22d725a825a8,0x27c31fc69a46a7f6
.quad 0xa764a21f00002800,0x221f276425a8a5a8,0xa164a788a5a825a8,0xa41d26dd27f61a46,0x238ba70ea8008000,0xa7f61a46247226a7,0x27c39fc6a5a8a5a8,0xa55fa5eda0a527a8,0x26a724728000a800,0x1e3ea7d9a764221f,0x1cb227ea25a8a5a8,0x273ba2d7a70ea38b,0xa513262f28008000,0x270e238b9e3ea7d9,0xa7fe164825a825a8,0x1cb227ea2513a62f
.quad 0xa5a8a5a800002800,0xa5a825a828008000,0x1648a7fea5a825a8,0xa7ea9cb22513262f,0x262fa513a8008000,0xa38ba70e9e3e27d9,0x27ea1cb2a5a8a5a8,0x22d7a73ba70e238b,0x247226a70000a800,0x27d99e3ea764a21f,0x9fc627c325a8a5a8,0x25ed255fa0a5a7a8,0xa70e238b28008000,0x9a4627f62472a6a7,0xa788a16425a825a8,0xa6dd241d27f69a46
.quad 0xa21fa76400002800,0xa764a21f25a825a8,0x22d7a73ba5a825a8,0x9fc6a7c39a4627f6,0x27a8a0a5a8008000,0x2513a62fa6a72472,0x26dd241da5a8a5a8,0x27fe1648a7a8a0a5,0x1e3e27d98000a800,0x247226a7a21fa764,0xa4c4266d25a8a5a8,0xa1642788238ba70e,0xa7f61a4628008000,0xa7a820a527d99e3e,0xa5eda55f25a825a8,0xa66da4c4262f2513
.quad 0xa800800000002800,0x280080008000a800,0xa41da6dda6a72472,0x22d7273b270ea38b,0x238ba70ea764a21f,0xa513262f26a72472,0x27fe96489e3ea7d9,0xa7c39fc69a4627f6,0x247226a725a8a5a8,0x9e3ea7d9a764221f,0xa2d7273b27d91e3e,0x266da4c4a62fa513,0xa7f61a46221f2764,0x270e238b1e3ea7d9,0xa4c4a66da47226a7,0x964827fe27a8a0a5
.quad 0x221fa764a8008000,0xa764221f25a825a8,0x27ea9cb2a472a6a7,0xa5eda55fa0a527a8,0x2513262f221fa764,0x20a5a7a8a7d91e3e,0xa164278827d99e3e,0x27ea9cb2a513a62f,0xa7d91e3e25a825a8,0x247226a7221fa764,0xa55fa5ed9e3e27d9,0xa41d26dd27f69a46,0x20a5a7a8a764221f,0xa7f69a46247226a7,0x27c39fc6a6a7a472,0xa164a788a38b270e
.quad 0x25a825a88000a800,0x25a8a5a8a8000000,0x9fc627c326a7a472,0x27882164a38ba70e,0xa7a820a52764221f,0x1a4627f62472a6a7,0xa5eda55f1e3e27d9,0xa6dd241d27f61a46,0x1e3ea7d9a5a825a8,0xa6a7a472221f2764,0x2788a164a7d99e3e,0x1cb2a7eaa513262f,0x262f2513a21fa764,0x27a8a0a5a7d99e3e,0x9cb227ea2472a6a7,0x255f25eda0a5a7a8
.quad 0xa764221f28008000,0xa21f276425a8a5a8,0xa66da4c4247226a7,0xa7fe164827a820a5,0x1a46a7f6a21f2764,0xa38ba70e1e3e27d9,0x273ba2d7a7d91e3e,0x24c4a66da62f2513,0x26a72472a5a8a5a8,0x27d91e3ea764a21f,0x964827fe1e3ea7d9,0x1fc627c39a46a7f6,0xa70e238b2764a21f,0xa62f251326a7a472,0xa6dda41d26a72472,0xa73ba2d7270e238b
.quad 0xa800800000002800,0x280080000000a800,0xa164a788a764221f,0x1fc627c327a8a0a5,0x262fa513a5a8a5a8,0xa70e238b247226a7,0x26dd241d221fa764,0xa55fa5eda513262f,0x9e3e27d928008000,0x2472a6a7a764a21f,0xa7ea1cb2221f2764,0x278821641a46a7f6,0xa38ba70ea5a825a8,0x9a4627f627d99e3e,0x255fa5eda764a21f,0xa7ea1cb2238b270e
.quad 0x2764221f8000a800,0xa21fa764a5a825a8,0x964827fe2764a21f,0x266da4c4a70ea38b,0xa7a820a525a825a8,0x262f25131e3ea7d9,0xa4c4a66da21f2764,0xa2d7273b27f69a46,0x2472a6a7a8000000,0xa7d99e3e221f2764,0x27c31fc6a21fa764,0x9648a7fea62f2513,0x1a4627f625a8a5a8,0x27a8a0a5a6a7a472,0xa73b22d72764221f,0x241d26dd20a5a7a8
.quad 0xa5a8a5a800002800,0xa5a825a828008000,0x22d7a73ba764221f,0xa6dda41d20a527a8,0x27f61a46a5a8a5a8,0x20a5a7a8a6a72472,0x1fc627c3221fa764,0x27fe1648a62fa513,0xa6a7247228000000,0x1e3e27d9221fa764,0xa66da4c4221f2764,0xa73b22d727f61a46,0x20a5a7a8a5a825a8,0xa513a62f1e3e27d9,0x27fe9648a764a21f,0x24c4a66da70e238b
.quad 0x221f27640000a800,0x2764221fa5a8a5a8,0xa5ed255f2764a21f,0x9cb227ea238ba70e,0xa70ea38b25a825a8,0xa7f61a4627d91e3e,0x1cb2a7eaa21f2764,0xa164a7881a4627f6,0x27d99e3ea8000000,0x26a7a472a764221f,0x241d26dda21fa764,0x25ed255fa513a62f,0xa513262f25a8a5a8,0xa38b270e2472a6a7,0xa788a1642764221f,0xa7c39fc627a820a5
.quad 0xa800800000002800,0x280080008000a800,0x9cb2a7eaa7d91e3e,0x164827fe27f69a46,0x27a8a0a5a21fa764,0xa7f61a461e3e27d9,0x22d7273b26a7a472,0x9cb2a7eaa7a820a5,0xa6a7247225a825a8,0x27d99e3ea21fa764,0xa55fa5eda47226a7,0x1fc627c3270ea38b,0x2513a62fa764a21f,0xa7a820a5247226a7,0x26dd241d1e3ea7d9,0xa164a788a62f2513
.quad 0xa21f276428008000,0x2764a21fa5a8a5a8,0xa7c39fc61e3e27d9,0x22d7273b2513a62f,0x1a46a7f6a764221f,0xa70e238b26a72472,0x27fe9648a472a6a7,0xa41da6dda38b270e,0x1e3e27d925a8a5a8,0x26a7a472a764a21f,0xa788216426a72472,0x24c4266d20a5a7a8,0xa38ba70ea21f2764,0xa62f251327d91e3e,0x266da4c4a7d99e3e,0xa55fa5ed9a4627f6
.quad 0x25a825a80000a800,0x25a8a5a8a8000000,0xa4c4266d27d99e3e,0x25ed255f9a46a7f6,0xa70ea38b221f2764,0xa513262f27d99e3e,0x2164a788a6a72472,0xa66da4c420a527a8,0x27d91e3ea5a8a5a8,0x2472a6a7a764221f,0x964827fe2472a6a7,0x26dd241da38ba70e,0xa7f61a462764221f,0xa38b270e26a7a472,0x9fc6a7c39e3e27d9,0xa73ba2d72513262f
.quad 0x2764a21fa8000000,0x221fa764a5a825a8,0x241d26dd9e3ea7d9,0x27882164a62fa513,0xa62f25132764a21f,0xa0a527a82472a6a7,0xa5eda55f247226a7,0xa7c39fc6270e238b,0x2472a6a7a5a825a8,0x1e3ea7d9a21f2764,0x273b22d7a6a7a472,0x27ea1cb2a7a8a0a5,0xa0a527a8221fa764,0x9a4627f61e3ea7d9,0xa7ea9cb227d91e3e,0xa7fe964827f61a46
.quad 0xa800000000002800,0x280080000000a800,0x1648a7fea8000000,0x9cb227ea27f61a46,0x27f61a460000a800,0xa7a8a0a59e3e27d9,0x9cb227ea28008000,0x22d7a73ba7a8a0a5,0xa7d99e3e00002800,0x26a72472221fa764,0x1fc6a7c3a8000000,0xa55f25ed270e238b,0x27a820a58000a800,0xa513a62fa47226a7,0xa164278828008000,0x26dda41da62fa513
.quad 0xa764a21f00002800,0x221f276425a8a5a8,0x22d7a73ba8000000,0xa7c31fc62513262f,0x270e238b0000a800,0x9a46a7f6a6a72472,0xa41d26dd28008000,0x27fe1648a38ba70e,0xa6a7a47200002800,0x9e3e27d92764a21f,0x24c4a66da8000000,0xa788a16420a527a8,0x262f25138000a800,0x238ba70ea7d91e3e,0xa55f25ed28000000,0x266d24c49a46a7f6
.quad 0xa5a8a5a800002800,0xa5a825a828008000,0x25eda55fa8000000,0xa4c4a66d9a4627f6,0x2513262f0000a800,0x270ea38ba7d99e3e,0xa66d24c428008000,0x2164278820a5a7a8,0xa472a6a780002800,0xa7d91e3e2764221f,0x26dda41da8000000,0x9648a7fea38b270e,0x238b270e8000a800,0x27f61a46a6a7a472,0xa73b22d728000000,0x9fc627c32513a62f
.quad 0xa21fa76400002800,0xa764a21f25a825a8,0x2788a164a8000000,0x241da6dda62f2513,0x20a527a80000a800,0x262f2513a472a6a7,0xa7c31fc628008000,0xa5ed255f270ea38b,0x9e3ea7d900002800,0xa472a6a7221f2764,0x27ea9cb2a8000000,0x273ba2d7a7a820a5,0x1a4627f68000a800,0x20a527a89e3ea7d9,0xa7fe164828000000,0xa7ea1cb227f69a46
.quad 0xa800000000002800,0x280080008000a800,0x1fc6a7c3a7d99e3e,0xa164278827a820a5,0x270e238b221fa764,0xa62fa513a47226a7,0xa55f25ed26a72472,0x26dda41da513a62f,0xa472a6a7a5a825a8,0x1e3e27d92764a21f,0x2788a164a472a6a7,0xa7ea9cb21a4627f6,0x1a4627f62764a21f,0x238ba70ea7d99e3e,0xa7ea9cb21e3e27d9,0x255f25ed238ba70e
.quad 0x221fa764a8000000,0xa764221f25a825a8,0x266d24c41e3ea7d9,0x9648a7fea70e238b,0xa62f25132764221f,0x27a820a59e3ea7d9,0xa2d7a73ba47226a7,0xa4c4266d27f61a46,0x27d99e3ea5a8a5a8,0xa472a6a7a21f2764,0x964827fe26a7a472,0x27c39fc6a62fa513,0xa7a8a0a5221f2764,0x9a4627f626a7a472,0x241da6dda7d91e3e,0xa73ba2d720a527a8
.quad 0x25a825a88000a800,0x25a8a5a8a8000000,0xa6dd241d27d91e3e,0x22d7273b20a5a7a8,0xa0a5a7a8a21f2764,0xa7f61a4626a72472,0x27fe9648a6a7a472,0x1fc6a7c3a62f2513,0x9e3e27d925a8a5a8,0x26a72472a21fa764,0xa73ba2d7247226a7,0xa66d24c427f69a46,0x2513a62fa764221f,0xa0a5a7a89e3e27d9,0x24c4266d9e3ea7d9,0x27fe1648a70ea38b
.quad 0xa764221f28000000,0xa21f276425a8a5a8,0x9cb2a7ea9e3e27d9,0xa5eda55f238b270e,0x27f61a46a764a21f,0x270ea38ba7d91e3e,0xa16427882472a6a7,0x1cb227ea1a46a7f6,0xa6a7a47225a825a8,0xa7d99e3e2764221f,0x25eda55fa6a72472,0x241da6dda513262f,0x238b270ea21fa764,0x2513262fa472a6a7,0xa7c31fc627d99e3e,0xa788216427a8a0a5
.quad 0xa800000000002800,0x280080000000a800,0x22d7a73ba764a21f,0xa41d26dd270e238b,0x2513262f25a8a5a8,0xa38ba70ea6a72472,0xa7c31fc6221f2764,0x27fe16489a46a7f6,0x1e3ea7d9a8000000,0xa47226a72764221f,0x266d24c4221fa764,0xa2d7a73ba62f2513,0xa70e238b25a825a8,0x27f61a469e3ea7d9,0x9648a7fea764221f,0xa4c4266d27a820a5
.quad 0x2764221f0000a800,0xa21fa764a5a825a8,0xa5ed255f2764221f,0x27ea1cb2a0a5a7a8,0xa0a5a7a8a5a825a8,0xa513262f27d91e3e,0x27ea1cb2a21fa764,0xa164a788a513262f,0xa47226a728008000,0x27d91e3ea21fa764,0xa41da6dda21f2764,0xa55f25ed27f61a46,0x27f69a46a5a8a5a8,0xa0a5a7a8a47226a7,0xa16427882764a21f,0x27c31fc6a38ba70e
.quad 0xa5a8a5a800002800,0xa5a825a828000000,0x2788a164a764a21f,0x9fc6a7c3a38b270e,0x9a4627f625a8a5a8,0x27a820a5a472a6a7,0xa6dda41d221f2764,0xa5ed255f27f69a46,0x26a7a472a8008000,0x9e3ea7d9a21f2764,0x1cb227ea221fa764,0x27882164a513a62f,0xa7a8a0a525a825a8,0xa62f251327d99e3e,0x255fa5eda764221f,0x9cb2a7eaa0a527a8
.quad 0x221f27648000a800,0x2764221fa5a8a5a8,0xa7fe96482764221f,0xa66d24c427a8a0a5,0x238ba70ea5a825a8,0x9a46a7f69e3e27d9,0x24c4266da21fa764,0x273b22d7a62fa513,0xa7d91e3e28008000,0xa6a724722764a21f,0x1fc6a7c3a21f2764,0x9648a7fe9a4627f6,0x262f2513a5a8a5a8,0x270e238ba6a7a472,0xa73b22d72764a21f,0xa6dd241d270ea38b
.quad 0xa800000000002800,0x280000008000a800,0x24c4a66da6a7a472,0xa55f25ed262f2513,0x20a527a82764a21f,0x9a46a7f6a7d91e3e,0xa788a1649e3e27d9,0x266d24c4238ba70e,0x26a7a472a5a8a5a8,0xa7d91e3e221f2764,0x964827fe27d99e3e,0x241da6dda7a8a0a5,0xa62fa513a21f2764,0x20a527a826a7a472,0x27c39fc6a472a6a7,0xa73ba2d79a4627f6
.quad 0xa21f276428000000,0x2764a21fa5a8a5a8,0xa41da6dda47226a7,0xa164278827f69a46,0x27f61a46a21fa764,0xa38ba70ea47226a7,0xa55f25ed27d91e3e,0x27c31fc6a0a5a7a8,0x9e3ea7d9a5a825a8,0xa6a724722764221f,0x273b22d79e3ea7d9,0x1cb2a7eaa70e238b,0xa70e238b2764221f,0x2513262f1e3ea7d9,0x1cb2a7eaa6a72472,0xa7fe96482513262f
.quad 0x25a825a88000a800,0x25a8a5a8a8000000,0xa7ea1cb226a72472,0x164827fe2513a62f,0x238ba70ea764221f,0xa62fa5131e3e27d9,0x22d7273b1e3ea7d9,0x27ea9cb2a70ea38b,0xa7d99e3e25a825a8,0xa47226a72764a21f,0x25eda55fa7d91e3e,0x9fc6a7c3a0a527a8,0x1a4627f6221fa764,0x270e238ba472a6a7,0xa6dda41d247226a7,0xa788216427f61a46
.quad 0x2764a21fa8000000,0x221fa764a5a825a8,0x9fc627c32472a6a7,0x22d7273b9a46a7f6,0xa513a62f221f2764,0xa7a8a0a526a72472,0x27fe9648a7d99e3e,0x26dda41da7a820a5,0xa47226a725a8a5a8,0x9e3e27d9221fa764,0xa164a7881e3e27d9,0xa4c4a66d238b270e,0x27a820a5a764a21f,0x27f61a46a7d99e3e,0xa66d24c426a7a472,0xa5ed255f262fa513
.quad 0xa800000000002800,0x280080000000a800,0x25eda55fa5a8a5a8,0xa66d24c42513262f,0x9a4627f628000000,0x20a5a7a8a7d99e3e,0xa4c4a66da5a825a8,0x21642788270ea38b,0x27d91e3e8000a800,0xa6a7a472a21f2764,0xa6dd241d25a825a8,0x27fe9648a0a5a7a8,0x20a5a7a8a8000000,0xa62f251326a72472,0x22d7273b25a8a5a8,0x1fc6a7c3a7f61a46
.quad 0xa764a21f00002800,0x221f276425a8a5a8,0x2788a164a5a8a5a8,0xa6dda41d9a4627f6,0xa38b270e28000000,0x27f69a46a472a6a7,0x9fc6a7c3a5a825a8,0xa5ed255f27a820a5,0x26a724728000a800,0x1e3ea7d9a764221f,0xa7ea1cb225a825a8,0x22d7273b238ba70e,0x2513a62fa8000000,0xa70ea38b1e3e27d9,0x164827fe25a8a5a8,0x27ea9cb2a62fa513
.quad 0xa5a8a5a800002800,0xa5a825a828008000,0x27fe1648a5a8a5a8,0x1cb2a7eaa62f2513,0xa62f251328008000,0x238b270e1e3ea7d9,0x1cb2a7eaa5a825a8,0xa73ba2d7238b270e,0x247226a70000a800,0x27d99e3ea764a21f,0xa7c39fc625a825a8,0xa55f25ed27a8a0a5,0x270ea38ba8000000,0x1a46a7f6a47226a7,0xa164278825a8a5a8,0x241d26dd9a46a7f6
.quad 0xa21fa76480002800,0xa764a21f25a825a8,0x273b22d7a5a8a5a8,0x27c39fc6a7f69a46,0xa7a820a528008000,0xa513262f26a7a472,0x241da6dda5a825a8,0x1648a7fea0a527a8,0x1e3e27d98000a800,0x247226a7a21fa764,0xa66da4c425a825a8,0xa788a164270e238b,0x27f69a46a8000000,0x27a8a0a5a7d91e3e,0xa55f25ed25a8a5a8,0xa4c4266d2513a62f
.quad 0xa800000080002800,0x280000008000a800,0x26dda41da472a6a7,0xa73b22d7238b270e,0xa38b270e2764221f,0x2513a62fa6a7a472,0x9648a7fea7d91e3e,0x9fc627c327f61a46,0x247226a725a8a5a8,0x9e3ea7d9a764221f,0xa73ba2d79e3e27d9,0x24c4266d2513a62f,0x27f69a46a21fa764,0xa70ea38b9e3e27d9,0xa66d24c426a72472,0x27fe1648a0a5a7a8
.quad 0x221fa764a8000000,0xa764221f25a825a8,0x1cb227ea26a7a472,0x255fa5eda7a8a0a5,0xa513a62fa21f2764,0xa0a527a827d99e3e,0x278821649e3ea7d9,0x9cb2a7eaa62f2513,0xa7d91e3e25a825a8,0x247226a7221fa764,0x25eda55fa7d99e3e,0xa6dda41d1a4627f6,0xa0a527a82764a21f,0x27f61a46a472a6a7,0x9fc6a7c3a47226a7,0xa7882164270e238b
.quad 0x25a825a88000a800,0x25a8a5a8a8000000,0xa7c39fc6247226a7,0xa1642788270ea38b,0x27a8a0a5a764a21f,0x9a46a7f6a47226a7,0xa55f25ed27d99e3e,0x241d26dd1a46a7f6,0x1e3ea7d9a5a825a8,0xa6a7a472221f2764,0x216427881e3ea7d9,0x27ea1cb2a62fa513,0xa62fa513221f2764,0xa7a820a527d91e3e,0x27ea1cb2a6a7a472,0x25eda55fa7a820a5
.quad 0xa764221f28008000,0xa21f276425a8a5a8,0x24c4a66da6a72472,0x9648a7fea0a527a8,0x9a4627f6221fa764,0x238b270e9e3ea7d9,0xa2d7a73b1e3e27d9,0xa66da4c42513262f,0x26a72472a5a8a5a8,0x27d91e3ea764a21f,0xa7fe964827d91e3e,0xa7c31fc627f69a46,0x270ea38ba764221f,0x262fa513a6a72472,0xa41d26dd2472a6a7,0xa2d7273b238ba70e
.quad 0xa800000000002800,0x280080000000a800,0x2788a164a21fa764,0xa7c31fc620a527a8,0xa62f251325a825a8,0x270ea38ba472a6a7,0x241da6dda764a21f,0xa5ed255f262f2513,0x9e3e27d928000000,0x2472a6a7a764a21f,0x9cb2a7eaa764221f,0xa164278827f61a46,0x238b270e25a8a5a8,0x1a46a7f6a7d91e3e,0xa5eda55fa21f2764,0x1cb227ea270ea38b
.quad 0x2764221f8000a800,0xa21fa764a5a825a8,0xa7fe9648221f2764,0x24c4266d238ba70e,0x27a8a0a5a5a8a5a8,0xa62fa5139e3e27d9,0xa66d24c42764221f,0x273b22d79a46a7f6,0x2472a6a7a8000000,0xa7d99e3e221f2764,0x9fc627c32764a21f,0x27fe9648a513a62f,0x9a46a7f6a5a825a8,0xa7a820a526a72472,0x22d7273b221fa764,0x26dda41da7a8a0a5
.quad 0xa5a8a5a880002800,0xa5a825a828008000,0x273b22d7a21fa764,0x241da6dda7a820a5,0xa7f69a4625a825a8,0xa0a527a826a7a472,0x27c39fc6a764a21f,0x1648a7fea513262f,0xa6a7247228000000,0x1e3e27d9221fa764,0x24c4a66da764221f,0xa2d7a73b9a4627f6,0xa0a527a825a8a5a8,0x2513262f9e3ea7d9,0x9648a7fea21f2764,0xa66da4c4238b270e
.quad 0x221f27648000a800,0x2764221fa5a8a5a8,0xa55fa5ed221f2764,0xa7ea9cb2270e238b,0x270e238ba5a8a5a8,0x27f69a46a7d99e3e,0xa7ea9cb22764221f,0xa788216427f69a46,0x27d99e3ea8000000,0x26a7a472a764221f,0xa6dd241d2764a21f,0xa55f25ed262fa513,0x2513a62fa5a825a8,0x238ba70ea47226a7,0xa1642788221fa764,0x9fc627c320a5a7a8
.quad 0xa800000000002800,0x280000008000a800,0x27ea9cb29e3ea7d9,0xa7fe16481a4627f6,0xa7a820a5221f2764,0x27f69a469e3ea7d9,0x273ba2d7a472a6a7,0xa7ea1cb220a527a8,0xa6a7247225a825a8,0x27d99e3ea21fa764,0x25eda55fa6a7a472,0xa7c31fc6238b270e,0xa513262f2764221f,0x27a8a0a5a472a6a7,0x241da6dda7d99e3e,0xa78821642513262f
.quad 0xa21f276428008000,0x2764a21fa5a8a5a8,0x1fc6a7c3a7d91e3e,0xa73b22d7262f2513,0x9a4627f62764a21f,0x270ea38ba6a7a472,0x9648a7fea6a72472,0xa6dd241d270e238b,0x1e3e27d925a8a5a8,0x26a7a472a764a21f,0xa164a788a47226a7,0xa66d24c427a820a5,0x238b270e221fa764,0x262fa513a7d99e3e,0xa4c4a66d9e3e27d9,0xa5ed255f27f61a46
.quad 0x25a825a88000a800,0x25a8a5a8a8000000,0xa66da4c41e3e27d9,0xa55f25ed27f69a46,0x270e238ba21fa764,0x2513a62fa7d91e3e,0xa788a164247226a7,0xa4c4266d27a8a0a5,0x27d91e3ea5a8a5a8,0x2472a6a7a764221f,0xa7fe964826a72472,0xa41d26dd270ea38b,0x27f69a46a764a21f,0x238ba70ea6a72472,0xa7c31fc627d91e3e,0xa2d7273b262fa513
.quad 0x2764a21fa8008000,0x221fa764a5a825a8,0xa6dd241d27d99e3e,0xa16427882513a62f,0x262fa513a764221f,0x20a5a7a8a47226a7,0xa55f25ed26a7a472,0x9fc627c3238ba70e,0x2472a6a7a5a825a8,0x1e3ea7d9a21f2764,0xa2d7273b2472a6a7,0x9cb227ea20a5a7a8,0x20a5a7a8a21f2764,0x1a46a7f69e3e27d9,0x9cb227ea1e3ea7d9,0x964827fe1a46a7f6
.quad 0x8000a80028002800,0x8000a80000002800,0x1648a7fea8002800,0x1cb2a7ea9a4627f6,0x1a46a7f628002800,0x20a5a7a89e3e27d9,0x1cb2a7eaa8002800,0x22d7a73ba0a527a8,0x1e3ea7d928002800,0x2472a6a7a21f2764,0x1fc6a7c3a8002800,0x255fa5eda38b270e,0x20a5a7a828002800,0x262fa513a47226a7,0x2164a788a8002800,0x26dda41da513262f
.quad 0x221fa76428002800,0x2764a21fa5a825a8,0x22d7a73ba8002800,0x27c39fc6a62f2513,0x238ba70e28002800,0x27f69a46a6a72472,0x241da6dda8002800,0x27fe1648a70e238b,0x2472a6a728002800,0x27d91e3ea764221f,0x24c4a66da8002800,0x27882164a7a820a5,0x2513a62f28002800,0x270e238ba7d91e3e,0x255fa5eda8002800,0x266d24c4a7f61a46
.quad 0x25a8a5a828002800,0x25a825a8a8000000,0x25eda55fa8002800,0x24c4266da7f69a46,0x262fa51328002800,0x238b270ea7d99e3e,0x266da4c4a8002800,0x21642788a7a8a0a5,0x26a7a47228002800,0x1e3e27d9a764a21f,0x26dda41da8002800,0x164827fea70ea38b,0x270ea38b28002800,0x9a4627f6a6a7a472,0x273ba2d7a8002800,0x9fc627c3a62fa513
.quad 0x2764a21f28002800,0xa21f2764a5a8a5a8,0x2788a164a8002800,0xa41d26dda513a62f,0x27a8a0a528002800,0xa513262fa472a6a7,0x27c39fc6a8002800,0xa5ed255fa38ba70e,0x27d99e3e28002800,0xa6a72472a21fa764,0x27ea9cb2a8002800,0xa73b22d7a0a5a7a8,0x27f69a4628002800,0xa7a820a59e3ea7d9,0x27fe9648a8002800,0xa7ea1cb29a46a7f6
.quad 0x8000a80000002800,0x8000a80000002800,0x1fc6a7c39e3e27d9,0x2164a788a0a527a8,0x238ba70ea21f2764,0x2513a62fa47226a7,0x255fa5eda47226a7,0x26dda41da62f2513,0x26a7a472a5a825a8,0x27d99e3ea764221f,0x2788a164a6a72472,0x27ea1cb2a7f61a46,0x27f69a46a764221f,0x270e238ba7d99e3e,0x27ea1cb2a7d91e3e,0x255f25eda70ea38b
.quad 0x2764221fa8000000,0x221f2764a5a8a5a8,0x266d24c4a7d99e3e,0x164827fea38ba70e,0x2513262fa764a21f,0xa0a527a89e3ea7d9,0x22d7273ba6a7a472,0xa4c4266d1a46a7f6,0x1e3e27d9a5a8a5a8,0xa6a72472221fa764,0x964827fea472a6a7,0xa7c31fc62513a62f,0xa0a527a8a21fa764,0xa7f69a4626a7a472,0xa41d26dd9e3ea7d9,0xa73ba2d727a8a0a5
.quad 0xa5a825a88000a800,0xa5a8a5a828008000,0xa6dd241d1e3ea7d9,0xa2d7a73b27a820a5,0xa7a820a5221fa764,0x9a46a7f626a72472,0xa7fe16482472a6a7,0x1fc6a7c32513262f,0xa7d99e3e25a8a5a8,0x2472a6a7221f2764,0xa73ba2d726a7a472,0x266da4c41a4627f6,0xa62fa5132764a21f,0x27a8a0a59e3e27d9,0xa4c4a66d27d99e3e,0x27fe1648a38b270e
.quad 0xa21fa76428008000,0x2764221fa5a825a8,0x9cb2a7ea27d91e3e,0x25ed255fa70e238b,0x1a46a7f62764221f,0x238b270ea7d91e3e,0x2164a78826a72472,0x1cb227eaa7f69a46,0x2472a6a725a825a8,0x9e3e27d9a764a21f,0x25eda55f247226a7,0xa41d26dda62fa513,0x270ea38b221f2764,0xa62f2513a472a6a7,0x27c39fc61e3e27d9,0xa7882164a0a5a7a8
.quad 0x8000a80000002800,0x8000a80000002800,0x22d7a73ba21f2764,0x241da6dda38b270e,0x262fa513a5a825a8,0x270ea38ba6a72472,0x27c39fc6a764221f,0x27fe1648a7f61a46,0x27d91e3ea8008000,0x26a72472a764a21f,0x266d24c4a764a21f,0x22d7273ba513a62f,0x238b270ea5a8a5a8,0x9a4627f69e3ea7d9,0x164827fea21fa764,0xa4c4266d20a5a7a8
.quad 0xa21f27648000a800,0xa764221f25a8a5a8,0xa5ed255f221fa764,0xa7ea9cb227a8a0a5,0xa7a820a525a8a5a8,0xa62fa51327d91e3e,0xa7ea9cb22764a21f,0xa164a788262f2513,0xa6a7a47228008000,0x1e3ea7d9221f2764,0xa41da6dd2764221f,0x255fa5ed9a4627f6,0x9a46a7f625a825a8,0x27a8a0a5a47226a7,0x2164a788221f2764,0x27c31fc6a70e238b
.quad 0x25a8a5a800002800,0x25a825a8a8008000,0x2788a164a21f2764,0x1fc627c3a70ea38b,0x27f61a46a5a825a8,0xa0a527a8a472a6a7,0x26dd241da764221f,0xa5ed255f9a46a7f6,0x247226a7a8008000,0xa7d91e3e221fa764,0x1cb227eaa764a21f,0xa788a164262fa513,0xa0a527a8a5a8a5a8,0xa513a62f27d99e3e,0xa55f25eda21fa764,0x9cb2a7ea27a820a5
.quad 0xa764221f8000a800,0x221fa76425a825a8,0xa7fe9648221fa764,0x266da4c420a527a8,0xa70ea38b25a8a5a8,0x27f69a469e3e27d9,0xa4c4a66d2764a21f,0x273b22d7a513262f,0x9e3ea7d928008000,0x247226a7a764221f,0x1fc6a7c32764221f,0x164827fea7f69a46,0x2513a62f25a825a8,0xa38b270ea6a7a472,0x273ba2d7221f2764,0xa6dd241da38ba70e
.quad 0xa80000002800,0x8000a80000002800,0x24c4a66da47226a7,0x255fa5eda513262f,0x27a8a0a5a764221f,0x27f69a46a7d91e3e,0x27882164a7d99e3e,0x266d24c4a70ea38b,0x247226a7a5a8a5a8,0x1e3e27d9a21fa764,0x964827fe9e3ea7d9,0xa41d26dd20a5a7a8,0xa513262f221fa764,0xa7a820a526a7a472,0xa7c31fc626a7a472,0xa73ba2d727f61a46
.quad 0xa764a21f28008000,0xa21fa76425a825a8,0xa41da6dd26a72472,0x2164a7881a4627f6,0x1a46a7f6221f2764,0x270ea38ba47226a7,0x255fa5ed9e3e27d9,0x27c31fc6a7a820a5,0x27d99e3ea5a825a8,0x247226a7a764a21f,0x273b22d7a7d91e3e,0x9cb227eaa38ba70e,0x238b270ea764a21f,0xa62f25131e3ea7d9,0x9cb227eaa472a6a7,0xa7fe9648262fa513
.quad 0xa5a825a88000a800,0xa5a8a5a828008000,0xa7ea1cb22472a6a7,0x9648a7fe262f2513,0xa70ea38b2764a21f,0x2513a62f1e3e27d9,0xa2d7a73b27d91e3e,0x27ea9cb2a38b270e,0x1e3ea7d925a825a8,0x26a72472a764221f,0x25eda55f1e3e27d9,0x1fc627c3a7a8a0a5,0x27f69a46a21f2764,0xa38b270ea472a6a7,0x26dd241da6a72472,0xa78821641a46a7f6
.quad 0x221f2764a8000000,0xa764a21f25a8a5a8,0x9fc627c3a6a7a472,0xa2d7a73b27f69a46,0xa62f2513a21fa764,0x20a5a7a826a72472,0xa7fe16481e3ea7d9,0x26dda41d20a527a8,0xa6a7a47225a8a5a8,0x27d91e3ea21f2764,0xa164a78827d99e3e,0x24c4266da70e238b,0x20a5a7a82764221f,0x9a4627f6a7d99e3e,0x266da4c4247226a7,0xa5ed255fa513a62f
.quad 0xa80000002800,0x8000a80000002800,0x25eda55fa5a825a8,0x266da4c4a62f2513,0x27f61a46a8000000,0x27a820a5a7d99e3e,0x24c4266da5a8a5a8,0x21642788a38ba70e,0x9e3e27d90000a800,0xa47226a7221fa764,0xa6dd241d25a8a5a8,0xa7fe164827a8a0a5,0xa7a8a0a528008000,0xa513a62f26a72472,0xa2d7a73b25a825a8,0x1fc6a7c31a4627f6
.quad 0x221fa76400002800,0x2764a21fa5a825a8,0x2788a164a5a825a8,0x26dd241da7f69a46,0x270e238ba8000000,0x1a4627f6a472a6a7,0x1fc627c3a5a8a5a8,0xa5ed255f20a5a7a8,0xa47226a78000a800,0xa7d99e3e2764a21f,0xa7ea1cb225a8a5a8,0xa2d7a73b270e238b,0xa62fa51328008000,0x238ba70e1e3e27d9,0x9648a7fe25a825a8,0x27ea9cb2a513262f
.quad 0x25a8a5a800002800,0x25a825a8a8000000,0x27fe1648a5a825a8,0x9cb227eaa513a62f,0x2513262fa8000000,0xa70e238b1e3ea7d9,0x9cb227eaa5a8a5a8,0xa73ba2d7270ea38b,0xa6a724720000a800,0x9e3ea7d92764221f,0xa7c39fc625a8a5a8,0x255fa5ed20a527a8,0xa38ba70e28008000,0x27f61a46a47226a7,0x2164a78825a825a8,0x241d26dda7f61a46
.quad 0x2764a21f00002800,0xa21f2764a5a8a5a8,0x273b22d7a5a825a8,0xa7c31fc61a46a7f6,0x20a527a8a8000000,0xa62fa51326a7a472,0xa41d26dda5a8a5a8,0x1648a7fe27a820a5,0xa7d91e3e8000a800,0x26a7a472221f2764,0xa66da4c425a8a5a8,0x27882164a38b270e,0x9a46a7f628000000,0x20a527a8a7d91e3e,0x255fa5ed25a825a8,0xa4c4266da62fa513
.quad 0xa80000002800,0x8000a80000002800,0x26dda41da6a72472,0x273ba2d7a70e238b,0x270e238ba764a21f,0x262f2513a6a7a472,0x164827fe9e3ea7d9,0x9fc627c31a46a7f6,0xa6a7247225a8a5a8,0xa7d91e3e2764a21f,0xa73ba2d727d91e3e,0xa4c4a66d262f2513,0x9a46a7f6221f2764,0x238ba70e9e3e27d9,0x266da4c4a47226a7,0x27fe1648a7a820a5
.quad 0x2764221fa8000000,0x221f2764a5a8a5a8,0x1cb227eaa472a6a7,0xa55f25ed20a5a7a8,0xa62f2513221fa764,0xa7a8a0a527d99e3e,0xa788a16427d99e3e,0x9cb2a7ea2513262f,0x9e3ea7d925a825a8,0x26a7a472a21f2764,0x25eda55f9e3e27d9,0x26dd241da7f61a46,0x27a820a5a764221f,0x9a4627f6a472a6a7,0x1fc627c3a6a7a472,0xa7882164238ba70e
.quad 0xa5a825a80000a800,0xa5a8a5a828000000,0xa7c39fc626a7a472,0x2164a788238b270e,0xa0a5a7a82764221f,0x27f69a46a47226a7,0x255fa5ed1e3e27d9,0x241d26dda7f69a46,0x27d91e3ea5a825a8,0xa47226a7a21fa764,0x21642788a7d99e3e,0xa7ea9cb22513a62f,0xa513262fa21fa764,0xa0a5a7a827d91e3e,0xa7ea9cb22472a6a7,0x25eda55f20a527a8
.quad 0xa21fa76428008000,0x2764221fa5a825a8,0x24c4a66d247226a7,0x164827fea7a8a0a5,0x27f61a46a21f2764,0xa70e238b9e3ea7d9,0x22d7273ba7d91e3e,0xa66da4c4262fa513,0xa47226a7a5a8a5a8,0x1e3ea7d92764221f,0xa7fe96481e3ea7d9,0x27c39fc61a4627f6,0xa38ba70e2764a21f,0x2513262fa6a72472,0x241da6dd26a72472,0xa2d7273ba70ea38b
.quad 0xa80000002800,0x8000a80080002800,0x2788a164a764221f,0x27c39fc6a7a820a5,0x2513262fa5a8a5a8,0x238b270ea472a6a7,0xa41d26dd221fa764,0xa5ed255f2513a62f,0xa7d99e3e28000000,0xa6a7a4722764221f,0x9cb2a7ea221f2764,0x2164a7889a4627f6,0x270ea38ba5a825a8,0x27f61a46a7d91e3e,0x25ed255fa764a21f,0x1cb227eaa38ba70e
.quad 0xa21f27648000a800,0xa764221f25a8a5a8,0xa7fe96482764a21f,0xa4c4a66d270e238b,0xa0a5a7a825a825a8,0x2513a62f9e3e27d9,0x266da4c4a21f2764,0x273b22d7a7f61a46,0x26a72472a8000000,0x9e3e27d9a21fa764,0x9fc627c3a21fa764,0xa7fe1648262fa513,0xa7f61a4625a8a5a8,0xa0a5a7a826a72472,0xa2d7a73b2764221f,0x26dda41da0a527a8
.quad 0x25a8a5a800002800,0x25a825a8a8000000,0x273b22d7a764221f,0xa41d26dda0a5a7a8,0x9a4627f6a5a8a5a8,0xa7a8a0a526a7a472,0xa7c31fc6221fa764,0x1648a7fe262f2513,0xa472a6a728000000,0x27d99e3ea21f2764,0x24c4a66d221f2764,0x22d7273ba7f69a46,0x27a820a5a5a825a8,0xa62f25139e3ea7d9,0x164827fea764a21f,0xa66da4c4270ea38b
.quad 0xa764221f8000a800,0x221fa76425a825a8,0xa55fa5ed2764a21f,0x27ea1cb2a38b270e,0x238ba70e25a825a8,0x1a4627f6a7d99e3e,0x27ea1cb2a21f2764,0xa78821649a46a7f6,0x1e3e27d9a8000000,0xa472a6a72764a21f,0xa6dd241da21fa764,0x255fa5ed2513262f,0xa62fa51325a8a5a8,0x270e238ba47226a7,0x2164a7882764221f,0x9fc627c3a7a8a0a5
.quad 0xa80000002800,0x8000a80000002800,0x27ea9cb2a7d91e3e,0x27fe9648a7f61a46,0x20a527a8a21fa764,0x1a4627f69e3ea7d9,0xa73b22d726a7a472,0xa7ea1cb227a8a0a5,0xa472a6a725a825a8,0x9e3ea7d9221f2764,0x25eda55fa47226a7,0x27c39fc6a70e238b,0x262f2513a764a21f,0x20a527a8a472a6a7,0xa41d26dd1e3ea7d9,0xa7882164262fa513
.quad 0xa764a21f28000000,0xa21fa76425a825a8,0x1fc6a7c31e3e27d9,0x273ba2d7a513262f,0x27f61a46a764221f,0x238b270ea6a7a472,0x164827fea472a6a7,0xa6dd241d238ba70e,0xa7d91e3e25a8a5a8,0xa472a6a72764221f,0xa164a78826a72472,0x266da4c4a0a527a8,0x270ea38ba21f2764,0x2513262fa7d99e3e,0x24c4266da7d99e3e,0xa5ed255f1a46a7f6
.quad 0xa5a825a88000a800,0xa5a8a5a828008000,0xa66da4c427d99e3e,0x255fa5ed1a4627f6,0x238ba70e221f2764,0x262f2513a7d91e3e,0x27882164a6a72472,0xa4c4266da0a5a7a8,0x9e3e27d9a5a8a5a8,0xa6a7a4722764a21f,0xa7fe96482472a6a7,0x241da6dd238b270e,0x9a46a7f62764221f,0x270e238ba6a72472,0x27c39fc69e3e27d9,0xa2d7273ba513a62f
.quad 0x221f2764a8000000,0xa764a21f25a8a5a8,0xa6dd241d9e3ea7d9,0x2164a788262f2513,0xa513a62f2764a21f,0x27a820a5a47226a7,0x255fa5ed247226a7,0x9fc627c3a70ea38b,0x26a72472a5a825a8,0xa7d99e3e221fa764,0xa2d7273ba6a7a472,0x1cb2a7ea27a820a5,0xa7a8a0a5221fa764,0x27f61a469e3e27d9,0x1cb2a7ea27d91e3e,0x964827fea7f69a46
.quad 0x8000a80000002800,0x8000a80080002800,0x27fe1648a8000000,0x27ea1cb2a7f69a46,0x9a4627f68000a800,0xa0a527a81e3ea7d9,0xa7ea9cb228008000,0xa73ba2d727a820a5,0x1e3ea7d980002800,0x2472a6a7a21f2764,0x27c31fc6a8000000,0x25ed255fa70ea38b,0xa0a527a88000a800,0xa62f25132472a6a7,0xa788a16428000000,0xa41da6dd262f2513
.quad 0x221fa76400002800,0x2764a21fa5a825a8,0x273b22d7a8000000,0x1fc627c3a513a62f,0xa38b270e8000a800,0xa7f61a4626a7a472,0xa6dda41d28008000,0x1648a7fe238b270e,0x2472a6a700002800,0x27d91e3ea764221f,0x266d24c4a8000000,0xa1642788a0a5a7a8,0xa513262f8000a800,0xa70ea38b27d99e3e,0xa5eda55f28000000,0x24c4a66d1a4627f6
.quad 0x25a8a5a800002800,0x25a825a8a8000000,0x255f25eda8000000,0xa66d24c41a46a7f6,0xa62f25138000a800,0xa38ba70e27d91e3e,0xa4c4a66d28000000,0x2788a164a0a527a8,0x26a7a47280002800,0x1e3e27d9a764a21f,0x241d26dda8000000,0xa7fe1648238ba70e,0xa70e238b8000a800,0x1a46a7f626a72472,0xa2d7a73b28008000,0x27c31fc6a513262f
.quad 0x2764a21f00002800,0xa21f2764a5a8a5a8,0x21642788a8008000,0xa6dda41d262fa513,0xa7a820a58000a800,0x2513a62f247226a7,0x9fc6a7c328008000,0x255f25eda70e238b,0x27d99e3e00002800,0xa6a72472a21fa764,0x1cb227eaa8000000,0xa2d7a73b27a8a0a5,0xa7f61a460000a800,0x27a8a0a51e3e27d9,0x9648a7fe28008000,0x1cb227eaa7f61a46
.quad 0x8000a80000002800,0x8000a80000002800,0x27c31fc6a7d99e3e,0x27882164a7a8a0a5,0xa38b270e221fa764,0xa513262f2472a6a7,0xa5eda55f26a72472,0xa41da6dd2513262f,0x26a7a472a5a825a8,0x27d99e3ea764221f,0x21642788a472a6a7,0x9cb227ea9a46a7f6,0xa7f61a462764a21f,0xa70ea38b27d91e3e,0x1cb2a7ea1e3e27d9,0x25eda55fa38b270e
.quad 0x2764221fa8000000,0x221f2764a5a8a5a8,0xa4c4266d1e3ea7d9,0xa7fe1648270ea38b,0xa513a62f2764221f,0x20a5a7a81e3e27d9,0x273ba2d7a47226a7,0x266d24c4a7f69a46,0x1e3e27d9a5a8a5a8,0xa6a72472221fa764,0xa7fe964826a7a472,0x9fc6a7c3262f2513,0x20a5a7a8221f2764,0x27f61a46a6a72472,0x26dd241da7d91e3e,0xa2d7273ba0a5a7a8
.quad 0xa5a825a88000a800,0xa5a8a5a828008000,0xa41da6dd27d91e3e,0x273ba2d7a0a527a8,0x27a8a0a5a21f2764,0x1a4627f6a6a7a472,0x164827fea6a7a472,0xa7c39fc6262fa513,0xa7d99e3e25a8a5a8,0x2472a6a7221f2764,0x22d7a73b247226a7,0x24c4266da7f61a46,0x262f2513a764221f,0xa7a820a51e3ea7d9,0xa66d24c49e3ea7d9,0x1648a7fe270e238b
.quad 0xa21fa76428008000,0x2764221fa5a825a8,0x27ea9cb29e3e27d9,0xa55f25eda38ba70e,0x9a4627f6a764a21f,0xa38ba70e27d99e3e,0xa788a1642472a6a7,0x27ea9cb29a4627f6,0x2472a6a725a825a8,0x9e3e27d9a764a21f,0x255f25eda6a72472,0xa6dda41d2513a62f,0xa70e238ba21fa764,0x262fa513247226a7,0x9fc6a7c327d99e3e,0x21642788a7a820a5
.quad 0x8000a80000002800,0x8000a80080002800,0x273b22d7a764a21f,0x26dd241da70ea38b,0xa62f251325a8a5a8,0xa70e238b26a7a472,0x9fc6a7c3221f2764,0x1648a7fe1a4627f6,0x27d91e3ea8000000,0x26a72472a764a21f,0xa4c4266d221fa764,0xa73b22d7262fa513,0xa38ba70e25a825a8,0x1a46a7f61e3e27d9,0x27fe9648a764221f,0x266d24c4a7a8a0a5
.quad 0xa21f27648000a800,0xa764221f25a8a5a8,0xa55fa5ed2764221f,0x1cb2a7ea20a527a8,0x27a8a0a5a5a825a8,0x262f2513a7d99e3e,0x9cb227eaa21fa764,0xa78821642513a62f,0xa6a7a47228008000,0x1e3ea7d9221f2764,0x26dda41da21f2764,0x25ed255fa7f69a46,0x1a4627f6a5a8a5a8,0xa7a820a52472a6a7,0xa788a1642764a21f,0x1fc6a7c3238b270e
.quad 0x25a8a5a880002800,0x25a825a8a8008000,0x21642788a764a21f,0xa7c31fc6238ba70e,0xa7f69a4625a8a5a8,0x20a5a7a8247226a7,0x241da6dd221f2764,0x255f25eda7f61a46,0x247226a7a8008000,0xa7d91e3e221fa764,0xa7ea1cb2221fa764,0x2164a7882513262f,0x20a5a7a825a825a8,0x2513262fa7d91e3e,0x25ed255fa764221f,0xa7ea1cb220a5a7a8
.quad 0xa764221f8000a800,0x221fa76425a825a8,0x1648a7fe2764221f,0x24c4266da7a820a5,0x270e238ba5a825a8,0xa7f61a461e3ea7d9,0xa66d24c4a21fa764,0x22d7a73b262f2513,0x9e3ea7d928008000,0x247226a7a764221f,0x27c31fc6a21f2764,0xa7fe16481a46a7f6,0xa513262fa5a8a5a8,0x238ba70e26a72472,0xa2d7a73b2764a21f,0x241d26dda70e238b
.quad 0x8000a80000002800,0xa80000002800,0x266d24c4a6a7a472,0x25ed255fa62fa513,0xa7a820a52764a21f,0xa7f61a4627d99e3e,0x2164a7889e3e27d9,0x24c4a66da38b270e,0x247226a7a5a8a5a8,0x1e3e27d9a21fa764,0xa7fe964827d99e3e,0xa6dda41d27a820a5,0x2513a62fa21f2764,0x27a8a0a5a6a72472,0x1fc627c3a472a6a7,0xa2d7273b1a46a7f6
.quad 0xa764a21f28000000,0xa21fa76425a825a8,0x26dda41da47226a7,0x27882164a7f61a46,0x9a4627f6a21fa764,0xa70e238b2472a6a7,0xa5eda55f27d91e3e,0x1fc6a7c320a527a8,0x27d99e3ea5a825a8,0x247226a7a764a21f,0xa2d7273b9e3ea7d9,0xa7ea9cb2270ea38b,0xa38ba70e2764221f,0x262fa5139e3e27d9,0x27ea1cb2a6a72472,0x964827fea513a62f
.quad 0xa5a825a80000a800,0xa5a8a5a828000000,0x9cb2a7ea26a72472,0x27fe9648a513262f,0x270e238ba764221f,0xa513262f9e3ea7d9,0xa73b22d71e3ea7d9,0x9cb2a7ea270e238b,0x1e3ea7d925a825a8,0x26a72472a764221f,0x255f25eda7d91e3e,0xa7c31fc620a5a7a8,0xa7f61a46221fa764,0x238ba70e247226a7,0x241da6dd247226a7,0x21642788a7f69a46
.quad 0x221f2764a8000000,0xa764a21f25a8a5a8,0xa7c39fc62472a6a7,0x273ba2d71a4627f6,0x262fa513221f2764,0xa0a527a8a6a7a472,0x164827fea7d99e3e,0xa41da6dd27a8a0a5,0xa6a7a47225a8a5a8,0x27d91e3ea21f2764,0x2788a1641e3e27d9,0xa66d24c4a38ba70e,0xa0a527a8a764a21f,0x1a46a7f627d91e3e,0xa4c4a66d26a7a472,0x255f25eda62f2513
.quad 0x8000a80000002800,0x8000a80080002800,0x255f25eda5a8a5a8,0x24c4266da513a62f,0xa7f69a4628000000,0xa7a8a0a527d91e3e,0x266da4c4a5a825a8,0x2788a164a70e238b,0x9e3e27d90000a800,0xa47226a7221fa764,0xa41da6dd25a825a8,0x9648a7fe20a527a8,0x27a820a5a8008000,0x2513262fa6a7a472,0xa73b22d725a8a5a8,0xa7c39fc627f69a46
.quad 0x221fa76400002800,0x2764a21fa5a825a8,0x21642788a5a8a5a8,0xa41d26dd1a46a7f6,0xa70ea38b28008000,0x9a46a7f6247226a7,0x27c39fc6a5a825a8,0x255f25eda7a8a0a5,0xa47226a78000a800,0xa7d99e3e2764a21f,0x9cb2a7ea25a825a8,0x273ba2d7a38b270e,0x262f2513a8000000,0xa38b270e9e3ea7d9,0xa7fe164825a8a5a8,0x9cb2a7ea262f2513
.quad 0x25a8a5a800002800,0x25a825a8a8000000,0x964827fea5a8a5a8,0xa7ea9cb2262fa513,0xa513a62f28008000,0x270ea38b9e3e27d9,0x27ea1cb2a5a825a8,0xa2d7273ba38ba70e,0xa6a724720000a800,0x9e3ea7d92764221f,0x1fc6a7c325a825a8,0x25ed255fa7a820a5,0x238b270ea8000000,0xa7f69a462472a6a7,0xa788a16425a8a5a8,0x26dda41d1a4627f6
.quad 0x2764a21f00002800,0xa21f2764a5a8a5a8,0xa2d7273ba5a8a5a8,0x9fc6a7c327f61a46,0xa0a5a7a828000000,0x262f2513a6a72472,0x26dd241da5a825a8,0xa7fe964820a5a7a8,0xa7d91e3e8000a800,0x26a7a472221f2764,0x24c4a66d25a825a8,0xa1642788a70ea38b,0x1a4627f6a8008000,0xa0a5a7a827d99e3e,0xa5eda55f25a8a5a8,0x266d24c4a513262f
.quad 0x8000a80080002800,0xa80000002800,0x241d26dda472a6a7,0x22d7273ba38ba70e,0xa70ea38b2764221f,0xa62fa51326a72472,0x27fe9648a7d91e3e,0x27c31fc6a7f69a46,0xa6a7247225a8a5a8,0xa7d91e3e2764a21f,0x22d7a73b9e3e27d9,0x266da4c4a513262f,0x1a4627f6a21fa764,0xa38b270e1e3ea7d9,0xa4c4a66d26a72472,0x1648a7fe20a527a8
.quad 0x2764221fa8000000,0x221f2764a5a8a5a8,0xa7ea1cb226a7a472,0xa5eda55f27a820a5,0x262fa513a21f2764,0x27a820a5a7d91e3e,0xa16427889e3ea7d9,0xa7ea1cb2262fa513,0x9e3ea7d925a825a8,0x26a7a472a21f2764,0x255f25eda7d99e3e,0xa41d26dd9a46a7f6,0xa7a8a0a52764a21f,0x1a46a7f6247226a7,0x27c39fc6a47226a7,0x21642788a70ea38b
.quad 0xa5a825a88000a800,0xa5a8a5a828008000,0x1fc6a7c3247226a7,0x27882164a70e238b,0x20a527a8a764a21f,0xa7f61a462472a6a7,0xa5eda55f27d99e3e,0x26dda41d9a4627f6,0x27d91e3ea5a825a8,0xa47226a7a21fa764,0xa78821641e3ea7d9,0x1cb2a7ea262f2513,0x2513a62f221f2764,0x20a527a8a7d99e3e,0x9cb227eaa6a7a472,0xa55fa5ed27a8a0a5
.quad 0xa21fa76428008000,0x2764221fa5a825a8,0x266d24c4a6a72472,0xa7fe164820a5a7a8,0xa7f69a46221fa764,0x270ea38b1e3e27d9,0x273ba2d71e3e27d9,0xa4c4266da513a62f,0xa47226a7a5a8a5a8,0x1e3ea7d92764221f,0x1648a7fe27d91e3e,0x1fc627c3a7f61a46,0x238b270ea764221f,0xa513a62f26a7a472,0xa6dda41d2472a6a7,0x273b22d7a38b270e
.quad 0x8000a80000002800,0x8000a80080002800,0x21642788a21fa764,0x1fc627c3a0a5a7a8,0xa513a62f25a825a8,0xa38ba70e247226a7,0x26dd241da764a21f,0x255f25eda62fa513,0xa7d99e3e28000000,0xa6a7a4722764221f,0x27ea9cb2a764221f,0x27882164a7f69a46,0xa70e238b25a8a5a8,0xa7f69a4627d99e3e,0x255fa5eda21f2764,0x27ea9cb2a70e238b
.quad 0xa21f27640000a800,0xa764221f25a8a5a8,0x1648a7fe221f2764,0x266da4c4a38b270e,0x20a527a8a5a8a5a8,0xa513262f1e3ea7d9,0xa4c4a66d2764221f,0x22d7a73b1a4627f6,0x26a72472a8000000,0x9e3e27d9a21fa764,0xa7c39fc62764a21f,0x9648a7fe2513262f,0x27f69a46a5a825a8,0x20a527a8a6a7a472,0xa73b22d7221fa764,0xa41da6dd27a820a5
.quad 0x25a8a5a800002800,0x25a825a8a8000000,0xa2d7273ba21fa764,0xa6dda41d27a8a0a5,0x1a46a7f625a825a8,0x27a820a5a6a72472,0x1fc627c3a764a21f,0xa7fe96482513a62f,0xa472a6a728000000,0x27d99e3ea21f2764,0x266d24c4a764221f,0xa73b22d71a46a7f6,0xa7a8a0a525a8a5a8,0x262fa5131e3e27d9,0x27fe9648a21f2764,0xa4c4266da38ba70e
.quad 0xa764221f8000a800,0x221fa76425a825a8,0x25eda55f221f2764,0x9cb227eaa70ea38b,0xa38b270ea5a8a5a8,0x9a46a7f627d91e3e,0x1cb2a7ea2764221f,0x21642788a7f61a46,0x1e3e27d9a8000000,0xa472a6a72764a21f,0xa41da6dd2764a21f,0x25ed255fa62f2513,0x262f2513a5a825a8,0xa70ea38b2472a6a7,0xa788a164221fa764,0x27c31fc6a0a527a8
.quad 0x8000a80000002800,0xa80000002800,0x1cb227ea9e3ea7d9,0x164827fe9a46a7f6,0xa0a5a7a8221f2764,0x9a46a7f61e3e27d9,0x22d7273ba472a6a7,0x1cb227eaa0a5a7a8,0xa472a6a725a825a8,0x9e3ea7d9221f2764,0x255f25eda6a7a472,0x1fc627c3a38ba70e,0xa62fa5132764221f,0xa0a5a7a8247226a7,0x26dd241da7d99e3e,0x21642788a513a62f
.quad 0xa764a21f28008000,0xa21fa76425a825a8,0x27c31fc6a7d91e3e,0x22d7273ba62fa513,0xa7f69a462764a21f,0xa38ba70e26a72472,0x27fe9648a6a72472,0x241d26dda70ea38b,0xa7d91e3e25a8a5a8,0xa472a6a72764221f,0x2788a164a47226a7,0x24c4266da7a8a0a5,0xa70e238b221fa764,0xa513a62f27d91e3e,0x266da4c49e3e27d9,0x255f25eda7f69a46
.quad 0xa5a825a88000a800,0xa5a8a5a828008000,0x24c4a66d1e3e27d9,0x25ed255fa7f61a46,0xa38b270ea21fa764,0xa62fa51327d99e3e,0x2164a788247226a7,0x266d24c4a7a820a5,0x9e3e27d9a5a8a5a8,0xa6a7a4722764a21f,0x1648a7fe26a72472,0x26dd241da70e238b,0x1a4627f6a764a21f,0xa70ea38b26a7a472,0x9fc6a7c327d91e3e,0x273b22d7a62f2513
.quad 0x221f2764a8000000,0xa764a21f25a8a5a8,0xa41da6dd27d99e3e,0x27882164a513262f,0x2513262fa764221f,0xa7a8a0a52472a6a7,0xa5eda55f26a7a472,0x27c31fc6a38b270e,0x26a72472a5a825a8,0xa7d99e3e221fa764,0xa73ba2d72472a6a7,0x27ea1cb2a0a527a8,0x27a820a5a21f2764,0xa7f69a461e3ea7d9,0xa7ea9cb21e3ea7d9,0x27fe16489a4627f6
.quad 0x2800800028002800,0xa80000008000a800,0x27fe1648a8002800,0xa7ea9cb21a46a7f6,0x27f61a4628002800,0xa7a8a0a51e3ea7d9,0x27ea1cb2a8002800,0xa73ba2d720a5a7a8,0x27d91e3e28002800,0xa6a7a472221fa764,0x27c31fc6a8002800,0xa5eda55f238ba70e,0x27a820a528002800,0xa513a62f2472a6a7,0x27882164a8002800,0xa41da6dd2513a62f
.quad 0x2764221f28002800,0xa21fa76425a8a5a8,0x273b22d7a8002800,0x9fc6a7c3262fa513,0x270e238b28002800,0x9a46a7f626a7a472,0x26dd241da8002800,0x1648a7fe270ea38b,0x26a7247228002800,0x1e3ea7d92764a21f,0x266d24c4a8002800,0x2164a78827a8a0a5,0x262f251328002800,0x238ba70e27d99e3e,0x25ed255fa8002800,0x24c4a66d27f69a46
.quad 0x25a825a828002800,0x25a8a5a828008000,0x255f25eda8002800,0x266da4c427f61a46,0x2513262f28002800,0x270ea38b27d91e3e,0x24c4266da8002800,0x2788a16427a820a5,0x247226a728002800,0x27d99e3e2764221f,0x241d26dda8002800,0x27fe9648270e238b,0x238b270e28002800,0x27f61a4626a72472,0x22d7273ba8002800,0x27c31fc6262f2513
.quad 0x221f276428002800,0x2764221f25a825a8,0x21642788a8002800,0x26dd241d2513262f,0x20a527a828002800,0x262f2513247226a7,0x1fc627c3a8002800,0x255f25ed238b270e,0x1e3e27d928002800,0x247226a7221f2764,0x1cb227eaa8002800,0x22d7273b20a527a8,0x1a4627f628002800,0x20a527a81e3e27d9,0x164827fea8002800,0x1cb227ea1a4627f6
.quad 0x2800800000002800,0xa80080008000a800,0x27c31fc69e3e27d9,0xa788a16420a5a7a8,0x270e238ba21f2764,0xa62fa5132472a6a7,0x25ed255fa47226a7,0xa41da6dd262fa513,0x247226a7a5a825a8,0x9e3ea7d92764a21f,0x21642788a6a72472,0x1cb2a7ea27f69a46,0x1a4627f6a764221f,0x238ba70e27d91e3e,0x9cb227eaa7d91e3e,0x25eda55f270e238b
.quad 0xa21f2764a8008000,0x2764a21f25a825a8,0xa4c4266da7d99e3e,0x27fe9648238b270e,0xa62f2513a764a21f,0x27a820a51e3e27d9,0xa73b22d7a6a7a472,0x266d24c49a4627f6,0xa7d91e3ea5a8a5a8,0x247226a7a21f2764,0xa7fe9648a472a6a7,0x1fc627c3a513262f,0xa7a8a0a5a21fa764,0x9a4627f6a6a72472,0xa6dda41d9e3ea7d9,0xa2d7273ba7a820a5
.quad 0xa5a8a5a88000a800,0xa5a825a8a8008000,0xa41da6dd1e3ea7d9,0xa73b22d7a7a8a0a5,0xa0a5a7a8221fa764,0xa7f61a46a6a7a472,0x9648a7fe2472a6a7,0xa7c39fc6a513a62f,0x1e3ea7d925a8a5a8,0xa6a7a472a21fa764,0x22d7a73b26a7a472,0xa4c4a66d9a46a7f6,0x2513a62f2764a21f,0xa0a5a7a81e3ea7d9,0x266da4c427d99e3e,0x1648a7fe238ba70e
.quad 0x2764a21f28008000,0x221fa76425a8a5a8,0x27ea9cb227d91e3e,0x255fa5ed270ea38b,0x27f61a462764221f,0x270ea38b27d99e3e,0x2788216426a72472,0x27ea9cb227f61a46,0x26a7247225a825a8,0x27d91e3e2764221f,0x255f25ed247226a7,0x26dd241d262f2513,0x238b270e221f2764,0x2513262f247226a7,0x1fc627c31e3e27d9,0x2164278820a527a8
.quad 0x2800800000002800,0xa80000008000a800,0x273b22d7a21f2764,0xa6dda41d238ba70e,0x2513262fa5a825a8,0xa38ba70e26a7a472,0x1fc627c3a764221f,0x1648a7fe27f69a46,0x9e3e27d9a8008000,0x2472a6a72764221f,0xa4c4266da764a21f,0x273ba2d72513262f,0xa70e238ba5a8a5a8,0x27f61a461e3e27d9,0xa7fe1648a21fa764,0x266d24c4a0a527a8
.quad 0xa764a21f0000a800,0x221f2764a5a825a8,0xa55fa5ed221fa764,0x9cb227eaa7a820a5,0xa0a5a7a825a8a5a8,0xa513262fa7d99e3e,0x1cb2a7ea2764a21f,0xa7882164a62fa513,0x2472a6a728008000,0xa7d99e3ea21fa764,0x26dda41d2764221f,0xa5eda55f1a46a7f6,0x27f69a4625a825a8,0xa0a5a7a82472a6a7,0x27882164221f2764,0x1fc6a7c3270ea38b
.quad 0x25a825a800002800,0x25a8a5a828008000,0x21642788a21f2764,0x27c39fc6270e238b,0x9a4627f6a5a825a8,0x27a820a5247226a7,0xa41d26dda764221f,0x255f25ed1a4627f6,0xa6a72472a8008000,0x1e3e27d9a21f2764,0xa7ea1cb2a764a21f,0xa1642788a62f2513,0xa7a8a0a5a5a8a5a8,0xa62f2513a7d91e3e,0xa5eda55fa21fa764,0xa7ea1cb2a7a8a0a5
.quad 0xa21fa7648000a800,0xa764a21fa5a8a5a8,0x1648a7fe221fa764,0xa4c4a66da0a5a7a8,0x238ba70e25a8a5a8,0x9a46a7f61e3ea7d9,0x266da4c42764a21f,0x22d7a73b2513a62f,0x27d99e3e28008000,0x26a7a4722764a21f,0x27c31fc62764221f,0x27fe964827f61a46,0x262f251325a825a8,0x270e238b26a72472,0x22d7273b221f2764,0x241d26dd238b270e
.quad 0x2800800000002800,0xa80000000000a800,0x266d24c4a47226a7,0xa5eda55f2513a62f,0x20a527a8a764221f,0x9a46a7f627d99e3e,0xa1642788a7d99e3e,0x24c4a66d270e238b,0xa6a72472a5a8a5a8,0x27d99e3e221f2764,0xa7fe96489e3ea7d9,0x26dd241da0a527a8,0xa62fa513221fa764,0x20a527a8a6a72472,0x9fc6a7c326a7a472,0xa2d7273ba7f69a46
.quad 0x221fa76428000000,0xa764221fa5a8a5a8,0x26dda41d26a72472,0xa788a1649a46a7f6,0x27f61a46221f2764,0xa38ba70e2472a6a7,0x25ed255f9e3e27d9,0x1fc6a7c327a8a0a5,0x1e3e27d9a5a825a8,0x26a7a4722764221f,0xa2d7273ba7d91e3e,0x27ea1cb2238b270e,0xa70e238ba764a21f,0x2513262f9e3e27d9,0xa7ea9cb2a472a6a7,0x964827fea62f2513
.quad 0xa5a8a5a80000a800,0xa5a825a8a8000000,0x9cb2a7ea2472a6a7,0xa7fe1648a62fa513,0x238ba70e2764a21f,0xa62fa5139e3ea7d9,0x273ba2d727d91e3e,0x9cb2a7ea238ba70e,0x27d91e3e25a825a8,0x2472a6a72764a21f,0x255f25ed1e3e27d9,0x27c39fc627a820a5,0x1a4627f6a21f2764,0x270e238b247226a7,0xa41d26dda6a72472,0x216427889a4627f6
.quad 0xa764221fa8000000,0xa21f2764a5a825a8,0xa7c39fc6a6a7a472,0xa73b22d7a7f61a46,0xa513a62fa21fa764,0xa7a8a0a5a6a7a472,0x9648a7fe1e3ea7d9,0xa41da6dda0a5a7a8,0x2472a6a725a8a5a8,0x1e3ea7d9221fa764,0x2788a16427d99e3e,0x266da4c4270ea38b,0x27a820a52764221f,0x27f61a4627d91e3e,0x24c4266d247226a7,0x255f25ed2513262f
.quad 0x2800800000002800,0xa80000008000a800,0x255f25eda5a825a8,0xa4c4a66d262fa513,0x9a4627f6a8000000,0x20a5a7a827d91e3e,0xa66d24c4a5a8a5a8,0x2788a164238b270e,0xa7d99e3e0000a800,0x26a72472a21f2764,0xa41da6dd25a8a5a8,0x164827fea7a820a5,0x20a5a7a828008000,0xa62f2513a6a7a472,0x273ba2d725a825a8,0xa7c39fc69a46a7f6
.quad 0x2764221f80002800,0xa21fa76425a8a5a8,0x21642788a5a825a8,0x241da6dd27f61a46,0xa38b270ea8000000,0x27f69a46247226a7,0xa7c31fc6a5a8a5a8,0x255f25eda0a527a8,0xa6a7a4728000a800,0x9e3e27d9a764221f,0x9cb2a7ea25a8a5a8,0xa73b22d7a70ea38b,0x2513a62f28000000,0xa70ea38b9e3ea7d9,0x27fe964825a825a8,0x9cb2a7ea2513a62f
.quad 0x25a825a800002800,0x25a8a5a828000000,0x964827fea5a825a8,0x27ea1cb22513262f,0xa62f2513a8000000,0x238b270e9e3e27d9,0xa7ea9cb2a5a8a5a8,0xa2d7273ba70e238b,0xa472a6a70000a800,0xa7d91e3ea764a21f,0x1fc6a7c325a8a5a8,0xa5eda55fa0a5a7a8,0x270ea38b28008000,0x1a46a7f62472a6a7,0x2788216425a825a8,0x26dda41d27f69a46
.quad 0x221f276400002800,0x2764221f25a825a8,0xa2d7273ba5a825a8,0x1fc627c39a4627f6,0xa7a820a5a8000000,0xa513262fa6a72472,0xa6dda41da5a8a5a8,0xa7fe9648a7a8a0a5,0x9e3ea7d98000a800,0xa472a6a7a21fa764,0x24c4a66d25a8a5a8,0x2164a788238ba70e,0x27f69a4628000000,0x27a8a0a527d99e3e,0x25ed255f25a825a8,0x266d24c4262f2513
.quad 0x2800000000002800,0xa80000008000a800,0x241d26dda6a72472,0xa2d7a73b270ea38b,0xa38b270ea764a21f,0x2513a62f26a72472,0xa7fe16489e3ea7d9,0x27c31fc69a4627f6,0xa472a6a725a8a5a8,0x1e3e27d9a764221f,0x22d7a73b27d91e3e,0xa66d24c4a62fa513,0x27f69a46221f2764,0xa70ea38b1e3ea7d9,0x24c4266da47226a7,0x1648a7fe27a8a0a5
.quad 0xa21f2764a8008000,0x2764a21f25a825a8,0xa7ea1cb2a472a6a7,0x25ed255fa0a527a8,0xa513a62f221fa764,0xa0a527a8a7d91e3e,0x2164a78827d99e3e,0xa7ea1cb2a513a62f,0x27d99e3e25a825a8,0xa472a6a7221fa764,0x255f25ed9e3e27d9,0x241da6dd27f69a46,0xa0a527a8a764221f,0x27f61a46247226a7,0xa7c31fc6a6a7a472,0x21642788a38b270e
.quad 0xa5a8a5a88000a800,0xa5a825a8a8000000,0x1fc6a7c326a7a472,0xa788a164a38ba70e,0x27a8a0a52764221f,0x9a46a7f62472a6a7,0x25ed255f1e3e27d9,0x26dda41d27f61a46,0x9e3e27d9a5a825a8,0x26a72472221f2764,0xa7882164a7d99e3e,0x9cb227eaa513262f,0xa62fa513a21fa764,0xa7a820a5a7d99e3e,0x1cb2a7ea2472a6a7,0xa55fa5eda0a5a7a8
.quad 0x2764a21f28008000,0x221fa76425a8a5a8,0x266d24c4247226a7,0x27fe964827a820a5,0x9a4627f6a21f2764,0x238b270e1e3e27d9,0xa73b22d7a7d91e3e,0xa4c4266da62f2513,0xa6a7a472a5a8a5a8,0xa7d99e3ea764a21f,0x1648a7fe1e3ea7d9,0x9fc6a7c39a46a7f6,0x270ea38b2764a21f,0x262fa51326a7a472,0x26dd241d26a72472,0x273b22d7270e238b
.quad 0x2800800000002800,0xa80000008000a800,0x21642788a764221f,0x9fc6a7c327a8a0a5,0xa62f2513a5a8a5a8,0x270ea38b247226a7,0xa6dda41d221fa764,0x255f25eda513262f,0x1e3ea7d928008000,0xa47226a7a764a21f,0x27ea9cb2221f2764,0xa788a1641a46a7f6,0x238b270ea5a825a8,0x1a46a7f627d99e3e,0xa55f25eda764a21f,0x27ea9cb2238b270e
.quad 0xa764a21f0000a800,0x221f2764a5a825a8,0x1648a7fe2764a21f,0xa66d24c4a70ea38b,0x27a8a0a525a825a8,0xa62fa5131e3ea7d9,0x24c4266da21f2764,0x22d7a73b27f69a46,0xa47226a7a8000000,0x27d91e3e221f2764,0xa7c39fc6a21fa764,0x164827fea62f2513,0x9a46a7f625a8a5a8,0xa7a820a5a6a7a472,0x273ba2d72764221f,0xa41da6dd20a5a7a8
.quad 0x25a825a880002800,0x25a8a5a828008000,0xa2d7273ba764221f,0x26dd241d20a527a8,0xa7f69a46a5a8a5a8,0xa0a527a8a6a72472,0x9fc6a7c3221fa764,0xa7fe9648a62fa513,0x26a7a47228008000,0x9e3ea7d9221fa764,0x266d24c4221f2764,0x273ba2d727f61a46,0xa0a527a8a5a825a8,0x2513262f1e3e27d9,0xa7fe1648a764a21f,0xa4c4266da70e238b
.quad 0xa21fa7648000a800,0xa764a21fa5a8a5a8,0x25eda55f2764a21f,0x1cb2a7ea238ba70e,0x270e238b25a825a8,0x27f69a4627d91e3e,0x9cb227eaa21f2764,0x216427881a4627f6,0xa7d91e3ea8000000,0xa6a72472a764221f,0xa41da6dda21fa764,0xa5eda55fa513a62f,0x2513a62f25a8a5a8,0x238ba70e2472a6a7,0x278821642764221f,0x27c31fc627a820a5
.quad 0x2800800080002800,0xa80000008000a800,0x1cb227eaa7d91e3e,0x9648a7fe27f69a46,0xa7a820a5a21fa764,0x27f69a461e3e27d9,0xa2d7a73b26a7a472,0x1cb227eaa7a820a5,0x26a7a47225a825a8,0xa7d91e3ea21fa764,0x255f25eda47226a7,0x9fc6a7c3270ea38b,0xa513262fa764a21f,0x27a8a0a5247226a7,0xa6dda41d1e3ea7d9,0x21642788a62f2513
.quad 0x221fa76428000000,0xa764221fa5a8a5a8,0x27c31fc61e3e27d9,0xa2d7a73b2513a62f,0x9a4627f6a764221f,0x270ea38b26a72472,0xa7fe1648a472a6a7,0x241d26dda38b270e,0x9e3ea7d925a8a5a8,0xa6a72472a764a21f,0x2788a16426a72472,0xa4c4a66d20a5a7a8,0x238b270ea21f2764,0x262fa51327d91e3e,0xa66d24c4a7d99e3e,0x255f25ed9a4627f6
.quad 0xa5a8a5a88000a800,0xa5a825a8a8008000,0x24c4a66d27d99e3e,0xa5eda55f9a46a7f6,0x270e238b221f2764,0x2513a62f27d99e3e,0xa1642788a6a72472,0x266d24c420a527a8,0xa7d99e3ea5a8a5a8,0xa47226a7a764221f,0x1648a7fe2472a6a7,0xa6dda41da38ba70e,0x27f69a462764221f,0x238ba70e26a7a472,0x1fc627c39e3e27d9,0x273b22d72513262f
.quad 0xa764221fa8000000,0xa21f2764a5a825a8,0xa41da6dd9e3ea7d9,0xa788a164a62fa513,0x262fa5132764a21f,0x20a5a7a82472a6a7,0x25ed255f247226a7,0x27c31fc6270e238b,0xa47226a7a5a825a8,0x9e3e27d9a21f2764,0xa73ba2d7a6a7a472,0xa7ea9cb2a7a8a0a5,0x20a5a7a8221fa764,0x1a46a7f61e3ea7d9,0x27ea1cb227d91e3e,0x27fe164827f61a46
.quad 0x2800000000002800,0xa80080008000a800,0x964827fea8000000,0x1cb2a7ea27f61a46,0xa7f69a468000a800,0x27a820a59e3e27d9,0x1cb2a7ea28000000,0xa2d7273ba7a8a0a5,0x27d91e3e80002800,0xa6a7a472221fa764,0x9fc627c3a8000000,0x255fa5ed270e238b,0xa7a8a0a58000a800,0x2513262fa47226a7,0x2164a78828008000,0xa6dd241da62fa513
.quad 0x2764221f80002800,0xa21fa76425a8a5a8,0xa2d7273ba8008000,0x27c39fc62513262f,0xa70ea38b8000a800,0x1a4627f6a6a72472,0x241da6dd28008000,0xa7fe9648a38ba70e,0x26a7247200002800,0x1e3ea7d92764a21f,0xa4c4266da8000000,0x2788216420a527a8,0xa62fa5130000a800,0xa38b270ea7d91e3e,0x255fa5ed28008000,0xa66da4c49a46a7f6
.quad 0x25a825a800002800,0x25a8a5a828008000,0xa5ed255fa8000000,0x24c4266d9a4627f6,0xa513a62f8000a800,0xa70e238ba7d99e3e,0x266da4c428000000,0xa164a78820a5a7a8,0x247226a780002800,0x27d99e3e2764221f,0xa6dd241da8000000,0x164827fea38b270e,0xa38ba70e8000a800,0xa7f69a46a6a7a472,0x273ba2d728008000,0x1fc6a7c32513a62f
.quad 0x221f276400002800,0x2764221f25a825a8,0xa7882164a8008000,0xa41d26dda62f2513,0xa0a5a7a88000a800,0xa62fa513a472a6a7,0x27c39fc628008000,0x25eda55f270ea38b,0x1e3e27d900002800,0x247226a7221f2764,0xa7ea1cb2a8000000,0xa73b22d7a7a820a5,0x9a46a7f60000a800,0xa0a5a7a89e3ea7d9,0x27fe964828008000,0x27ea9cb227f69a46
.quad 0x2800800000002800,0xa80000008000a800,0x9fc627c3a7d99e3e,0x2164a78827a820a5,0xa70ea38b221fa764,0x262f2513a47226a7,0x255fa5ed26a72472,0xa6dd241da513a62f,0x247226a7a5a825a8,0x9e3ea7d92764a21f,0xa7882164a472a6a7,0x27ea1cb21a4627f6,0x9a46a7f62764a21f,0xa38b270ea7d99e3e,0x27ea1cb21e3e27d9,0xa55fa5ed238ba70e
.quad 0xa21f2764a8000000,0x2764a21f25a825a8,0xa66da4c41e3ea7d9,0x164827fea70e238b,0x262fa5132764221f,0xa7a8a0a59e3ea7d9,0x22d7273ba47226a7,0x24c4a66d27f61a46,0xa7d91e3ea5a8a5a8,0x247226a7a21f2764,0x1648a7fe26a7a472,0xa7c31fc6a62fa513,0x27a820a5221f2764,0x1a46a7f626a7a472,0xa41d26dda7d91e3e,0x273b22d720a527a8
.quad 0xa5a8a5a80000a800,0xa5a825a8a8000000,0x26dda41d27d91e3e,0xa2d7a73b20a5a7a8,0x20a527a8a21f2764,0x27f69a4626a72472,0xa7fe1648a6a7a472,0x9fc627c3a62f2513,0x1e3ea7d925a8a5a8,0xa6a7a472a21fa764,0x273b22d7247226a7,0x266da4c427f69a46,0xa513262fa764221f,0x20a527a89e3e27d9,0xa4c4a66d9e3ea7d9,0xa7fe9648a70ea38b
.quad 0x2764a21f28008000,0x221fa76425a8a5a8,0x1cb227ea9e3e27d9,0x25ed255f238b270e,0xa7f69a46a764a21f,0xa70e238ba7d91e3e,0x2164a7882472a6a7,0x9cb2a7ea1a46a7f6,0x26a7247225a825a8,0x27d91e3e2764221f,0xa5ed255fa6a72472,0xa41d26dda513262f,0xa38ba70ea21fa764,0xa513a62fa472a6a7,0x27c39fc627d99e3e,0x2788a16427a8a0a5
.quad 0x2800800000002800,0xa80000000000a800,0xa2d7273ba764a21f,0x241da6dd270e238b,0xa513a62f25a8a5a8,0x238b270ea6a72472,0x27c39fc6221f2764,0xa7fe96489a46a7f6,0x9e3e27d9a8008000,0x2472a6a72764221f,0xa66da4c4221fa764,0x22d7273ba62f2513,0x270ea38b25a825a8,0xa7f69a469e3ea7d9,0x164827fea764221f,0x24c4a66d27a820a5
.quad 0xa764a21f0000a800,0x221f2764a5a825a8,0x25eda55f2764221f,0xa7ea9cb2a0a5a7a8,0x20a527a8a5a825a8,0x2513a62f27d91e3e,0xa7ea9cb2a21fa764,0x21642788a513262f,0x2472a6a728008000,0xa7d99e3ea21fa764,0x241d26dda21f2764,0x255fa5ed27f61a46,0xa7f61a46a5a8a5a8,0x20a527a8a47226a7,0x2164a7882764a21f,0xa7c39fc6a38ba70e
.quad 0x25a825a800002800,0x25a8a5a828000000,0xa7882164a764a21f,0x1fc627c3a38b270e,0x1a46a7f625a8a5a8,0xa7a8a0a5a472a6a7,0x26dd241d221f2764,0x25eda55f27f69a46,0xa6a72472a8008000,0x1e3e27d9a21f2764,0x9cb2a7ea221fa764,0xa788a164a513a62f,0x27a820a525a825a8,0x262fa51327d99e3e,0xa55f25eda764221f,0x1cb227eaa0a527a8
.quad 0xa21fa7648000a800,0xa764a21fa5a8a5a8,0x27fe16482764221f,0x266da4c427a8a0a5,0xa38b270ea5a825a8,0x1a4627f69e3e27d9,0xa4c4a66da21fa764,0xa73ba2d7a62fa513,0x27d99e3e28008000,0x26a7a4722764a21f,0x9fc627c3a21f2764,0x164827fe9a4627f6,0xa62fa513a5a8a5a8,0xa70ea38ba6a7a472,0x273ba2d72764a21f,0x26dda41d270ea38b
.quad 0x2800800000002800,0xa80000008000a800,0xa4c4266da6a7a472,0x255fa5ed262f2513,0xa0a5a7a82764a21f,0x1a4627f6a7d91e3e,0x278821649e3e27d9,0xa66da4c4238ba70e,0xa6a72472a5a8a5a8,0x27d99e3e221f2764,0x1648a7fe27d99e3e,0xa41d26dda7a8a0a5,0x262f2513a21f2764,0xa0a5a7a826a7a472,0xa7c31fc6a472a6a7,0x273b22d79a4627f6
.quad 0x221fa76428000000,0xa764221fa5a8a5a8,0x241d26dda47226a7,0x2164a78827f69a46,0xa7f69a46a21fa764,0x238b270ea47226a7,0x255fa5ed27d91e3e,0xa7c39fc6a0a5a7a8,0x1e3e27d9a5a825a8,0x26a7a4722764221f,0xa73ba2d79e3ea7d9,0x9cb227eaa70e238b,0x270ea38b2764221f,0xa513a62f1e3ea7d9,0x9cb227eaa6a72472,0x27fe16482513262f
.quad 0xa5a8a5a88000a800,0xa5a825a8a8000000,0x27ea9cb226a72472,0x9648a7fe2513a62f,0xa38b270ea764221f,0x262f25131e3e27d9,0xa2d7a73b1e3ea7d9,0xa7ea1cb2a70ea38b,0x27d91e3e25a825a8,0x2472a6a72764a21f,0xa5ed255fa7d91e3e,0x1fc627c3a0a527a8,0x9a46a7f6221fa764,0xa70ea38ba472a6a7,0x26dd241d247226a7,0x2788a16427f61a46
.quad 0xa764221fa8000000,0xa21f2764a5a825a8,0x1fc6a7c32472a6a7,0xa2d7a73b9a46a7f6,0x2513262f221f2764,0x27a820a526a72472,0xa7fe1648a7d99e3e,0xa6dd241da7a820a5,0x2472a6a725a8a5a8,0x1e3ea7d9221fa764,0x216427881e3e27d9,0x24c4266d238b270e,0xa7a8a0a5a764a21f,0xa7f69a46a7d99e3e,0x266da4c426a7a472,0x25eda55f262fa513
.quad 0x2800000000002800,0xa80000008000a800,0xa5ed255fa5a8a5a8,0x266da4c42513262f,0x1a46a7f628008000,0xa0a527a8a7d99e3e,0x24c4266da5a825a8,0xa164a788270ea38b,0xa7d99e3e8000a800,0x26a72472a21f2764,0x26dda41d25a825a8,0xa7fe1648a0a5a7a8,0xa0a527a8a8000000,0x262fa51326a72472,0xa2d7a73b25a8a5a8,0x9fc627c3a7f61a46
.quad 0x2764221f80002800,0xa21fa76425a8a5a8,0xa7882164a5a8a5a8,0x26dd241d9a4627f6,0x238ba70e28008000,0xa7f61a46a472a6a7,0x1fc627c3a5a825a8,0x25eda55f27a820a5,0xa6a7a4728000a800,0x9e3e27d9a764221f,0x27ea9cb225a825a8,0xa2d7a73b238ba70e,0xa513262fa8008000,0x270e238b1e3e27d9,0x9648a7fe25a8a5a8,0xa7ea1cb2a62fa513
.quad 0x25a825a880002800,0x25a8a5a828008000,0xa7fe9648a5a8a5a8,0x9cb227eaa62f2513,0x262fa51328008000,0xa38ba70e1e3ea7d9,0x9cb227eaa5a825a8,0x273b22d7238b270e,0xa472a6a78000a800,0xa7d91e3ea764a21f,0x27c31fc625a825a8,0x255fa5ed27a8a0a5,0xa70e238ba8008000,0x9a4627f6a47226a7,0x2164a78825a8a5a8,0xa41da6dd9a46a7f6
.quad 0x221f276400002800,0x2764221f25a825a8,0xa73ba2d7a5a8a5a8,0xa7c31fc6a7f69a46,0x27a8a0a528008000,0x2513a62f26a7a472,0xa41d26dda5a825a8,0x964827fea0a527a8,0x9e3ea7d98000a800,0xa472a6a7a21fa764,0x266d24c425a825a8,0x27882164270e238b,0xa7f61a46a8008000,0xa7a820a5a7d91e3e,0x255fa5ed25a8a5a8,0x24c4a66d2513a62f
.quad 0x2800800000002800,0xa80000008000a800,0xa6dd241da472a6a7,0x273ba2d7238b270e,0x238ba70e2764221f,0xa513262fa6a7a472,0x164827fea7d91e3e,0x1fc6a7c327f61a46,0xa472a6a725a8a5a8,0x1e3e27d9a764221f,0x273b22d79e3e27d9,0xa4c4a66d2513a62f,0xa7f61a46a21fa764,0x270e238b9e3e27d9,0x266da4c426a72472,0xa7fe9648a0a5a7a8
.quad 0xa21f2764a8000000,0x2764a21f25a825a8,0x9cb2a7ea26a7a472,0xa55f25eda7a8a0a5,0x2513262fa21f2764,0x20a5a7a827d99e3e,0xa788a1649e3ea7d9,0x1cb227eaa62f2513,0x27d99e3e25a825a8,0xa472a6a7221fa764,0xa5ed255fa7d99e3e,0x26dd241d1a4627f6,0x20a5a7a82764a21f,0xa7f69a46a472a6a7,0x1fc627c3a47226a7,0x2788a164270e238b
.quad 0xa5a8a5a88000a800,0xa5a825a8a8008000,0x27c31fc6247226a7,0x2164a788270ea38b,0xa7a820a5a764a21f,0x1a4627f6a47226a7,0x255fa5ed27d99e3e,0xa41da6dd1a46a7f6,0x9e3e27d9a5a825a8,0x26a72472221f2764,0xa164a7881e3ea7d9,0xa7ea9cb2a62fa513,0x262f2513221f2764,0x27a8a0a527d91e3e,0xa7ea9cb2a6a7a472,0xa5ed255fa7a820a5
.quad 0x2764a21f28008000,0x221fa76425a8a5a8,0xa4c4266da6a72472,0x164827fea0a527a8,0x1a46a7f6221fa764,0xa38ba70e9e3ea7d9,0x22d7273b1e3e27d9,0x266d24c42513262f,0xa6a7a472a5a8a5a8,0xa7d99e3ea764a21f,0x27fe164827d91e3e,0x27c39fc627f69a46,0xa70e238ba764221f,0xa62f2513a6a72472,0x241da6dd2472a6a7,0x22d7a73b238ba70e
.quad 0x2800800080002800,0xa80080008000a800,0xa7882164a21fa764,0x27c39fc620a527a8,0x262fa51325a825a8,0xa70e238ba472a6a7,0xa41d26dda764a21f,0x25eda55f262f2513,0x1e3ea7d928000000,0xa47226a7a764a21f,0x1cb227eaa764221f,0x2164a78827f61a46,0xa38ba70e25a8a5a8,0x9a4627f6a7d91e3e,0x25ed255fa21f2764,0x9cb2a7ea270ea38b
.quad 0xa764a21f0000a800,0x221f2764a5a825a8,0x27fe1648221f2764,0xa4c4a66d238ba70e,0xa7a820a5a5a8a5a8,0x262f25139e3e27d9,0x266da4c42764221f,0xa73ba2d79a46a7f6,0xa47226a7a8000000,0x27d91e3e221f2764,0x1fc6a7c32764a21f,0xa7fe1648a513a62f,0x1a4627f6a5a825a8,0x27a8a0a526a72472,0xa2d7a73b221fa764,0xa6dd241da7a8a0a5
.quad 0x25a825a800002800,0x25a8a5a828008000,0xa73ba2d7a21fa764,0xa41d26dda7a820a5,0x27f61a4625a825a8,0x20a5a7a826a7a472,0xa7c31fc6a764a21f,0x964827fea513262f,0x26a7a47228008000,0x9e3ea7d9221fa764,0xa4c4266da764221f,0x22d7273b9a4627f6,0x20a5a7a825a8a5a8,0xa513a62f9e3ea7d9,0x164827fea21f2764,0x266d24c4238b270e
.quad 0xa21fa7648000a800,0xa764a21fa5a8a5a8,0x255f25ed221f2764,0x27ea1cb2270e238b,0xa70ea38ba5a8a5a8,0xa7f61a46a7d99e3e,0x27ea1cb22764221f,0x2788a16427f69a46,0xa7d91e3ea8000000,0xa6a72472a764221f,0x26dda41d2764a21f,0x255fa5ed262fa513,0xa513262fa5a825a8,0xa38b270ea47226a7,0x2164a788221fa764,0x1fc6a7c320a5a7a8
.quad 0x2800800000002800,0xa80080008000a800,0xa7ea1cb29e3ea7d9,0x27fe96481a4627f6,0x27a8a0a5221f2764,0xa7f61a469e3ea7d9,0xa73b22d7a472a6a7,0x27ea9cb220a527a8,0x26a7a47225a825a8,0xa7d91e3ea21fa764,0xa5ed255fa6a7a472,0x27c39fc6238b270e,0x2513a62f2764221f,0xa7a820a5a472a6a7,0xa41d26dda7d99e3e,0x2788a1642513262f
.quad 0x221fa76428000000,0xa764221fa5a8a5a8,0x9fc627c3a7d91e3e,0x273ba2d7262f2513,0x1a46a7f62764a21f,0xa70e238ba6a7a472,0x164827fea6a72472,0x26dda41d270e238b,0x9e3ea7d925a8a5a8,0xa6a72472a764a21f,0x21642788a47226a7,0x266da4c427a820a5,0xa38ba70e221fa764,0xa62f2513a7d99e3e,0x24c4266d9e3e27d9,0x25eda55f27f61a46
.quad 0xa5a8a5a80000a800,0xa5a825a8a8000000,0x266d24c41e3e27d9,0x255fa5ed27f69a46,0xa70ea38ba21fa764,0xa513262fa7d91e3e,0x27882164247226a7,0x24c4a66d27a8a0a5,0xa7d99e3ea5a8a5a8,0xa47226a7a764221f,0x27fe164826a72472,0x241da6dd270ea38b,0xa7f61a46a764a21f,0xa38b270ea6a72472,0x27c39fc627d91e3e,0x22d7a73b262fa513
.quad 0xa764221fa8000000,0xa21f2764a5a825a8,0x26dda41d27d99e3e,0x2164a7882513a62f,0xa62f2513a764221f,0xa0a527a8a47226a7,0x255fa5ed26a7a472,0x1fc6a7c3238ba70e,0xa47226a7a5a825a8,0x9e3e27d9a21f2764,0x22d7a73b2472a6a7,0x1cb2a7ea20a5a7a8,0xa0a527a8a21f2764,0x9a4627f69e3e27d9,0x1cb2a7ea1e3ea7d9,0x1648a7fe1a46a7f6
.quad 0x924827ffa8002800,0x98b527fa964827fe,0x98b527fa28002800,0x9f0327ce9cb227ea,0x9bd627f1a8002800,0xa1c227779fc627c3,0x9d7927e228002800,0xa3e326f6a1642788,0x9f0327cea8002800,0xa4ec264fa2d7273b,0xa04427b628002800,0xa5cb2584a41d26dd,0xa1052799a8002800,0xa68a249ba4c4266d,0xa1c2277728002800,0xa7252332a55f25ed
.quad 0xa27c2750a8002800,0xa7992105a5ed255f,0xa332272528002800,0xa7e21d79a66d24c4,0xa3e326f6a8002800,0xa7ff1248a6dd241d,0xa44826c228002800,0xa7f19bd6a73b22d7,0xa49b268aa8002800,0xa7b6a044a7882164,0xa4ec264f28002800,0xa750a27ca7c31fc6,0xa53a260fa8002800,0xa6c2a448a7ea1cb2,0xa58425cb28002800,0xa60fa53aa7fe1648
.quad 0xa5cb2584a8002800,0xa53aa60fa7fe9648,0xa60f253a28002800,0xa448a6c2a7ea9cb2,0xa64f24eca8002800,0xa27ca750a7c39fc6,0xa68a249b28002800,0xa044a7b6a788a164,0xa6c22448a8002800,0x9bd6a7f1a73ba2d7,0xa6f623e328002800,0x1248a7ffa6dda41d,0xa7252332a8002800,0x1d79a7e2a66da4c4,0xa750227c28002800,0x2105a799a5eda55f
.quad 0xa77721c2a8002800,0x2332a725a55fa5ed,0xa799210528002800,0x249ba68aa4c4a66d,0xa7b62044a8002800,0x2584a5cba41da6dd,0xa7ce1f0328002800,0x264fa4eca2d7a73b,0xa7e21d79a8002800,0x26f6a3e3a164a788,0xa7f11bd628002800,0x2777a1c29fc6a7c3,0xa7fa18b5a8002800,0x27ce9f039cb2a7ea,0xa7ff124828002800,0x27fa98b59648a7fe
.quad 0x9bd627f19a4627f6,0x9d7927e29cb227ea,0xa1c22777a0a527a8,0xa3e326f6a2d7273b,0xa49b268aa38b270e,0xa60f253aa55f25ed,0xa60f253aa513262f,0xa77721c2a6dd241d,0xa7252332a62f2513,0xa7ff1248a7c31fc6,0xa7ce1f03a70e238b,0xa799a105a7fe9648,0xa7ff9248a7a820a5,0xa64fa4eca788a164,0xa7b6a044a7f61a46,0xa448a6c2a66da4c4
.quad 0xa6f6a3e3a7f69a46,0x9f03a7cea4c4a66d,0xa5cba584a7a8a0a5,0x1bd6a7f1a164a788,0xa448a6c2a70ea38b,0x2332a7259648a7fe,0xa105a799a62fa513,0x25cba5841fc6a7c3,0x98b5a7faa513a62f,0x2750a27c241da6dd,0x1d79a7e2a38ba70e,0x27fa98b525eda55f,0x227ca750a0a5a7a8,0x27b62044273ba2d7,0x24eca64f9a46a7f6,0x268a249b27ea9cb2
.quad 0x264fa4ec1a46a7f6,0x249b268a27ea1cb2,0x2750a27c20a5a7a8,0x204427b6273b22d7,0x27e29d79238ba70e,0x98b527fa25ed255f,0x27fa18b52513a62f,0xa27c2750241d26dd,0x27992105262fa513,0xa58425cb1fc627c3,0x26c22448270ea38b,0xa7252332964827fe,0x258425cb27a8a0a5,0xa7f11bd6a1642788,0x23e326f627f69a46,0xa7ce9f03a4c4266d
.quad 0x204427b627f61a46,0xa6c2a448a66d24c4,0x124827ff27a820a5,0xa4eca64fa7882164,0x9f0327ce270e238b,0xa105a799a7fe1648,0xa3322725262f2513,0x1248a7ffa7c39fc6,0xa53a260f2513262f,0x21c2a777a6dda41d,0xa68a249b238b270e,0x253aa60fa55fa5ed,0xa77721c220a527a8,0x26f6a3e3a2d7a73b,0xa7f11bd61a4627f6,0x27e29d799cb2a7ea
.quad 0x9f0327ce9e3e27d9,0xa04427b69fc627c3,0xa4ec264fa47226a7,0xa5cb2584a55f25ed,0xa7252332a6a72472,0xa7ce1f03a7882164,0xa7ff1248a7d91e3e,0xa799a105a7ea9cb2,0xa750a27ca7d99e3e,0xa53aa60fa66da4c4,0xa53aa60fa6a7a472,0x9d79a7e2a2d7a73b,0xa044a7b6a472a6a7,0x21c2a7771648a7fe,0x1d79a7e29e3ea7d9,0x264fa4ec241da6dd
.quad 0x249ba68a1e3ea7d9,0x27f19bd626dda41d,0x26f6a3e32472a6a7,0x2750227c27fe9648,0x27fa98b526a7a472,0x249b268a273b22d7,0x277721c227d99e3e,0x18b527fa24c4266d,0x258425cb27d91e3e,0xa33227251cb227ea,0x2105279926a72472,0xa6c22448a1642788,0x9bd627f1247226a7,0xa7ff1248a5ed255f,0xa44826c21e3e27d9,0xa6f6a3e3a7c31fc6
.quad 0xa6c224489e3e27d9,0xa3e3a6f6a7c39fc6,0xa7f11bd6a47226a7,0x1248a7ffa5eda55f,0xa799a105a6a72472,0x2448a6c2a164a788,0xa5cba584a7d91e3e,0x2725a3321cb2a7ea,0xa1c2a777a7d99e3e,0x27fa18b524c4a66d,0x18b5a7faa6a7a472,0x268a249b273ba2d7,0x23e3a6f6a472a6a7,0x227c275027fe1648,0x268aa49b9e3ea7d9,0x9bd627f126dd241d
.quad 0x27e29d791e3ea7d9,0xa4ec264f241d26dd,0x27b620442472a6a7,0xa77721c2164827fe,0x260f253a26a7a472,0xa7e29d79a2d7273b,0x227c275027d99e3e,0xa60fa53aa66d24c4,0x924827ff27d91e3e,0xa105a799a7ea1cb2,0xa332272526a72472,0x1f03a7cea788a164,0xa64f24ec247226a7,0x2584a5cba55fa5ed,0xa7ce1f031e3e27d9,0x27b6a0449fc6a7c3
.quad 0xa1052799a0a527a8,0xa1c22777a1642788,0xa68a249ba62f2513,0xa7252332a6dd241d,0xa7ff9248a7f61a46,0xa7b6a044a7ea9cb2,0xa64fa4eca70ea38b,0xa448a6c2a55fa5ed,0xa044a7b6a38ba70e,0x1d79a7e29648a7fe,0x21c2a7771a46a7f6,0x264fa4ec24c4a66d,0x26c2a4482513a62f,0x27fa18b527c39fc6,0x27fa18b527a8a0a5,0x258425cb273b22d7
.quad 0x260f253a27a820a5,0x124827ff22d7273b,0x1f0327ce2513262f,0xa53a260f9fc627c3,0xa27c27501a4627f6,0xa7f11bd6a66d24c4,0xa6f623e3a38b270e,0xa68aa49ba7fe9648,0xa7f19bd6a70e238b,0x9f03a7cea5eda55f,0xa5cba584a7f69a46,0x23e3a6f69cb2a7ea,0x9d79a7e2a62fa513,0x2799a105241da6dd,0x2332a725a0a5a7a8,0x2750227c2788a164
.quad 0x2725a33220a5a7a8,0x227c275027882164,0x27e21d79262fa513,0xa1052799241d26dd,0x258425cb27f69a46,0xa6f623e39cb227ea,0x1bd627f1270e238b,0xa7ce9f03a5ed255f,0xa3e326f6238b270e,0xa49ba68aa7fe1648,0xa750227c9a4627f6,0x1bd6a7f1a66da4c4,0xa7ce9f03a513262f,0x260fa53a9fc6a7c3,0xa53aa60fa7a820a5,0x27ff124822d7a73b
.quad 0x98b5a7faa7a8a0a5,0x25cb2584273ba2d7,0x2448a6c2a513a62f,0x18b527fa27c31fc6,0x2777a1c29a46a7f6,0xa4ec264f24c4266d,0x27b62044238ba70e,0xa7e21d79964827fe,0x24ec264f270ea38b,0xa6c2a448a55f25ed,0x124827ff27f61a46,0xa044a7b6a7ea1cb2,0xa49b268a262f2513,0x2332a725a6dda41d,0xa799210520a527a8,0x2777a1c2a164a788
.quad 0xa27c2750a21f2764,0xa3322725a2d7273b,0xa7992105a764221f,0xa7e21d79a7c31fc6,0xa6f6a3e3a764a21f,0xa5cba584a66da4c4,0x9f03a7cea21fa764,0x1bd6a7f19648a7fe,0x249ba68a221fa764,0x26f6a3e325eda55f,0x27f19bd62764a21f,0x2750227c27ea1cb2,0x260f253a2764221f,0x1f0327ce241d26dd,0x124827ff221f2764,0xa53a260fa1642788
.quad 0xa5cb2584a21f2764,0xa7fa98b5a7882164,0xa7fa98b5a764221f,0xa448a6c2a6dda41d,0xa4eca64fa764a21f,0x21c2a7779cb2a7ea,0x1d79a7e2a21fa764,0x27b6a044255fa5ed,0x26c2a448221fa764,0x264f24ec27fe1648,0x27b620442764a21f,0x924827ff24c4266d,0x233227252764221f,0xa68a249b9fc627c3,0xa1c22777221f2764,0xa799a105a73b22d7
.quad 0xa77721c2a21f2764,0xa105a799a73ba2d7,0xa725a332a764221f,0x249ba68a9fc6a7c3,0xa044a7b6a764a21f,0x27ff924824c4a66d,0x2448a6c2a21fa764,0x24ec264f27fe9648,0x27e29d79221fa764,0xa04427b6255f25ed,0x264f24ec2764a21f,0xa77721c29cb227ea,0x18b527fa2764221f,0xa6c2a448a6dd241d,0xa58425cb221f2764,0x98b5a7faa788a164
.quad 0xa7ff9248a21f2764,0x260fa53aa164a788,0xa53aa60fa764221f,0x27ce1f03241da6dd,0x1bd6a7f1a764a21f,0x227c275027ea9cb2,0x268aa49ba21fa764,0xa3e326f625ed255f,0x27ce1f03221fa764,0xa7f11bd6964827fe,0x23e326f62764a21f,0xa584a5cba66d24c4,0xa10527992764221f,0x1d79a7e2a7c39fc6,0xa750227c221f2764,0x2725a332a2d7a73b
.quad 0xa3e326f6a38b270e,0xa44826c2a41d26dd,0xa7ff1248a7f61a46,0xa7f19bd6a7fe9648,0xa448a6c2a513a62f,0xa105a799a2d7a73b,0x2332a72520a5a7a8,0x25cba58424c4a66d,0x27fa98b527a8a0a5,0x277721c227ea1cb2,0x249b268a262f2513,0x18b527fa21642788,0xa27c27509a4627f6,0xa6f623e3a55f25ed,0xa7f11bd6a70e238b,0xa68aa49ba7c39fc6
.quad 0xa4eca64fa70ea38b,0x1d79a7e29fc6a7c3,0x21c2a7779a46a7f6,0x27b6a04425eda55f,0x27e29d79262fa513,0x253a260f27882164,0x253a260f27a820a5,0xa27c27501cb227ea,0xa105279920a527a8,0xa7ff1248a66d24c4,0xa7ce1f03a513262f,0xa332a725a73ba2d7,0xa584a5cba7f69a46,0x24eca64f9648a7fe,0x2044a7b6a38ba70e,0x27ce1f0326dda41d
.quad 0x27b6a044238ba70e,0x1f0327ce26dd241d,0x25cb258427f69a46,0xa64f24ec964827fe,0x9f0327ce2513262f,0xa725a332a73b22d7,0xa7992105a0a527a8,0x1248a7ffa66da4c4,0xa60fa53aa7a820a5,0x2750a27c1cb2a7ea,0x1d79a7e2a62fa513,0x260f253a2788a164,0x2777a1c21a46a7f6,0xa04427b625ed255f,0x264f24ec270ea38b,0xa7e21d799fc627c3
.quad 0x9bd627f1270e238b,0xa49ba68aa7c31fc6,0xa750227c1a4627f6,0x23e3a6f6a55fa5ed,0xa68aa49ba62f2513,0x27fa18b52164a788,0x18b5a7faa7a8a0a5,0x21c2277727ea9cb2,0x2725a332a0a5a7a8,0xa58425cb24c4266d,0x26c224482513a62f,0xa799a105a2d7273b,0x924827ff27f61a46,0x9bd6a7f1a7fe1648,0xa6f623e3238b270e,0x26c2a448a41da6dd
.quad 0xa49b268aa47226a7,0xa4ec264fa4c4266d,0xa7b6a044a7d99e3e,0xa750a27ca788a164,0x98b5a7fa9e3ea7d9,0x1d79a7e21648a7fe,0x2750a27c26a7a472,0x27fa98b527c39fc6,0x258425cb26a72472,0x21052799241d26dd,0xa33227259e3e27d9,0xa6c22448a55f25ed,0xa7f19bd6a7d91e3e,0xa5cba584a73ba2d7,0x9f03a7cea472a6a7,0x23e3a6f61cb2a7ea
.quad 0x26c2a4482472a6a7,0x27b6204427ea9cb2,0x264f24ec27d91e3e,0x924827ff22d7273b,0xa10527991e3e27d9,0xa7ce1f03a5ed255f,0xa7ff1248a6a72472,0xa332a725a6dda41d,0xa1c2a777a6a7a472,0x260fa53a1fc6a7c3,0x260fa53a1e3ea7d9,0x268a249b27fe9648,0x26f623e327d99e3e,0xa1c2277721642788,0x9d7927e2247226a7,0xa7f19bd6a66d24c4
.quad 0xa7e21d79a47226a7,0x9bd6a7f1a66da4c4,0xa3e3a6f6a7d99e3e,0x2777a1c22164a788,0x253aa60f9e3ea7d9,0x249b268a27fe1648,0x277721c226a7a472,0xa53a260f1fc627c3,0x924827ff26a72472,0xa725a332a6dd241d,0xa79921059e3e27d9,0x1f03a7cea5eda55f,0xa4eca64fa7d91e3e,0x27ff924822d7a73b,0x2448a6c2a472a6a7,0x204427b627ea1cb2
.quad 0x27ce1f032472a6a7,0xa6f623e31cb227ea,0x1bd627f127d91e3e,0xa584a5cba73b22d7,0xa72523321e3e27d9,0x2448a6c2a55fa5ed,0xa5cba584a6a72472,0x27992105241da6dd,0x227ca750a6a7a472,0x98b527fa27c31fc6,0x27fa18b51e3ea7d9,0xa7e21d79164827fe,0x204427b627d99e3e,0xa27ca750a7882164,0xa68a249b247226a7,0x264fa4eca4c4a66d
.quad 0xa53a260fa513262f,0xa58425cba55f25ed,0xa6c2a448a70ea38b,0xa60fa53aa66da4c4,0x227ca75020a5a7a8,0x24eca64f241da6dd,0x27b6204427f61a46,0x268a249b273b22d7,0x9bd627f11a4627f6,0xa44826c2a1642788,0xa7ff1248a7a820a5,0xa6f6a3e3a7c39fc6,0x9d79a7e2a38ba70e,0x2332a7251cb2a7ea,0x2799a105262fa513,0x2750227c27fe1648
.quad 0x23322725262f2513,0xa1c22777164827fe,0xa68a249ba38b270e,0xa799a105a7ea1cb2,0xa584a5cba7a8a0a5,0x2044a7b69fc6a7c3,0x24eca64f1a46a7f6,0x27ce1f032788a164,0x26f623e327f69a46,0x9d7927e222d7273b,0xa1c2277720a527a8,0xa7f19bd6a6dd241d,0xa7ce9f03a70e238b,0x18b5a7faa4c4a66d,0x18b5a7faa513a62f,0x27ff124825eda55f
.quad 0x27fa98b52513a62f,0x124827ff25ed255f,0x1f0327ce270e238b,0xa7fa18b5a4c4266d,0xa77721c2a0a527a8,0x9bd6a7f1a6dda41d,0xa3e3a6f6a7f69a46,0x27e29d7922d7a73b,0x264fa4ec9a46a7f6,0x1f0327ce27882164,0x25cb258427a8a0a5,0xa7b620449fc627c3,0xa49b268a238b270e,0xa105a799a7ea9cb2,0xa725a332a62f2513,0x2777a1c21648a7fe
.quad 0x2105a799a62fa513,0x227c275027fe9648,0x27e21d79238ba70e,0xa72523321cb227ea,0x924827ff27a820a5,0xa3e3a6f6a7c31fc6,0xa7f11bd69a4627f6,0x26c2a448a164a788,0xa044a7b6a7f61a46,0x249b268a273ba2d7,0x2750a27ca0a5a7a8,0xa64f24ec241d26dd,0x244826c2270ea38b,0xa53aa60fa66d24c4,0xa60f253a2513262f,0x25cba584a55fa5ed
.quad 0xa5cb2584a5a825a8,0xa60f253aa5ed255f,0xa53aa60fa5a8a5a8,0xa448a6c2a4c4a66d,0x264fa4ec25a8a5a8,0x2750a27c26dda41d,0x249b268a25a825a8,0x204427b622d7273b,0xa6c22448a5a825a8,0xa7f11bd6a7882164,0xa3e3a6f6a5a8a5a8,0x1248a7ff9fc6a7c3,0x2725a33225a8a5a8,0x27e21d7927ea9cb2,0x227c275025a825a8,0xa1052799164827fe
.quad 0xa77721c2a5a825a8,0xa725a332a7fe9648,0xa105a799a5a8a5a8,0x249ba68a1cb2a7ea,0x27b6a04425a8a5a8,0x25cb258427c31fc6,0x1f0327ce25a825a8,0xa64f24eca1642788,0xa7e21d79a5a825a8,0xa3e3a6f6a73ba2d7,0x9bd6a7f1a5a8a5a8,0x2777a1c2241da6dd,0x27fa98b525a8a5a8,0x1f0327ce266d24c4,0x124827ff25a825a8,0xa7fa18b5a55f25ed
.quad 0xa7ff9248a5a825a8,0x18b5a7faa55fa5ed,0x18b5a7faa5a8a5a8,0x27ce1f03266da4c4,0x27f11bd625a8a5a8,0xa1c22777241d26dd,0x9d7927e225a825a8,0xa6f6a3e3a73b22d7,0xa7ce9f03a5a825a8,0x24eca64fa164a788,0x2044a7b6a5a8a5a8,0x258425cb27c39fc6,0x2799210525a8a5a8,0xa68a249b1cb227ea,0xa1c2277725a825a8,0xa332a725a7fe1648
.quad 0xa750a27ca5a825a8,0x2799a1051648a7fe,0x2332a725a5a8a5a8,0x1d7927e227ea1cb2,0x26f623e325a8a5a8,0xa7ff12489fc627c3,0xa44826c225a825a8,0x1bd6a7f1a788a164,0xa68aa49ba5a825a8,0x27b6204422d7a73b,0x24eca64fa5a8a5a8,0xa27c275026dd241d,0x260f253a25a8a5a8,0xa6c2a448a4c4266d,0xa58425cb25a825a8,0x253aa60fa5eda55f
.quad 0xa64f24eca62f2513,0xa68a249ba66d24c4,0xa27ca750a38ba70e,0xa044a7b6a164a788,0x27e29d7927a8a0a5,0x27fa18b527fe9648,0x98b527fa1a4627f6,0xa27c27509fc627c3,0xa799a105a7f69a46,0xa5cba584a6dda41d,0x2448a6c220a5a7a8,0x2725a33225eda55f,0x258425cb270e238b,0x1bd627f122d7273b,0xa6f623e3a513262f,0xa7ce9f03a7ea1cb2
.quad 0xa044a7b6a513a62f,0x2448a6c21cb2a7ea,0x27ff9248270ea38b,0x24ec264f273b22d7,0x9f0327ce20a527a8,0xa7992105a55f25ed,0xa725a332a7f61a46,0x1248a7ffa41da6dd,0x253aa60f1a46a7f6,0x277721c227c39fc6,0x249b268a27a820a5,0xa53a260f964827fe,0xa77721c2a38b270e,0xa3e3a6f6a788a164,0x9bd6a7f1a62fa513,0x27e29d7924c4a66d
.quad 0x27f11bd6262fa513,0x9d7927e224c4266d,0xa1c22777238b270e,0xa6f6a3e3a7882164,0xa68aa49ba7a820a5,0x260fa53a9648a7fe,0x260fa53a9a46a7f6,0x21c2277727c31fc6,0x2332272527f61a46,0xa7ff1248a41d26dd,0xa7ce1f03a0a527a8,0x2105a799a55fa5ed,0x1248a7ffa70ea38b,0x264f24ec273ba2d7,0x27b620442513a62f,0xa6c224481cb227ea
.quad 0xa3e326f62513262f,0x9f03a7cea7ea9cb2,0xa5cba584a70e238b,0x27f11bd622d7a73b,0x26c2a448a0a5a7a8,0xa332272525ed255f,0x2105279927f69a46,0xa584a5cba6dd241d,0xa7fa18b59a4627f6,0x2750a27c9fc6a7c3,0x1d79a7e2a7a8a0a5,0x18b527fa27fe1648,0x2750227c238ba70e,0xa7b6a044a1642788,0xa4ec264f262f2513,0x249ba68aa66da4c4
.quad 0xa6c22448a6a72472,0xa6f623e3a6dd241d,0x9bd6a7f19e3ea7d9,0x1248a7ff9648a7fe,0x2799210527d91e3e,0x26c22448273b22d7,0xa58425cba47226a7,0xa7252332a66d24c4,0xa1c2a777a472a6a7,0x18b5a7fa9cb2a7ea,0x27fa18b527d99e3e,0x268a249b27882164,0xa3e326f69e3e27d9,0xa750227ca5ed255f,0xa49ba68aa6a7a472,0x1bd6a7f19fc6a7c3
.quad 0x27e29d7926a7a472,0x264f24ec27c31fc6,0xa04427b61e3e27d9,0xa77721c2a55f25ed,0xa60fa53aa7d99e3e,0x1d79a7e2a164a788,0x2750a27c2472a6a7,0x260f253a27ea1cb2,0x924827ff247226a7,0xa7992105a4c4266d,0xa725a332a7d91e3e,0x1f03a7cea2d7a73b,0x264fa4ec1e3ea7d9,0x25cb258427fe1648,0x1f0327ce26a72472,0xa7b62044a41d26dd
.quad 0xa7ce9f03a6a72472,0x2044a7b6a41da6dd,0x24eca64f9e3ea7d9,0x258425cb27fe9648,0x2332272527d91e3e,0xa7ce1f03a2d7273b,0xa7ff1248a47226a7,0x2105a799a4c4a66d,0x227ca750a472a6a7,0x253a260f27ea9cb2,0x253a260f27d99e3e,0xa7e21d79a1642788,0xa7b620449e3e27d9,0x21c2a777a55fa5ed,0x1d79a7e2a6a7a472,0x24ec264f27c39fc6
.quad 0x268a249b26a7a472,0xa7f11bd69fc627c3,0xa6f623e31e3e27d9,0x227ca750a5eda55f,0x98b5a7faa7d99e3e,0x249b268a2788a164,0x277721c22472a6a7,0xa7fa18b59cb227ea,0xa5cb2584247226a7,0x2332a725a66da4c4,0xa105a799a7d91e3e,0x244826c2273ba2d7,0x27f11bd61e3ea7d9,0xa7ff1248964827fe,0xa44826c226a72472,0x23e3a6f6a6dda41d
.quad 0xa7252332a70e238b,0xa750227ca73b22d7,0x1d79a7e21a46a7f6,0x2105a7991fc6a7c3,0x258425cb262f2513,0x23e326f624c4266d,0xa7f11bd6a7a820a5,0xa7ce9f03a7fe9648,0x23e3a6f620a5a7a8,0x268aa49b255fa5ed,0x227c27502513262f,0x9bd627f11cb227ea,0xa7ce9f03a7f61a46,0xa53aa60fa6dda41d,0x260fa53a238ba70e,0x27ff12482788a164
.quad 0x18b527fa238b270e,0xa58425cba1642788,0xa6c2a448a7f69a46,0x98b5a7faa41da6dd,0x2777a1c22513a62f,0x264f24ec27ea1cb2,0xa04427b620a527a8,0xa7e21d79a5ed255f,0xa4eca64fa7a8a0a5,0x2448a6c29648a7fe,0x27ff9248262fa513,0x204427b6266d24c4,0xa49b268a1a4627f6,0xa725a332a7c31fc6,0xa105a799a70ea38b,0x2777a1c222d7a73b
.quad 0x27992105270ea38b,0xa1c2277722d7273b,0xa68a249b9a4627f6,0xa332a725a7c39fc6,0x1248a7ffa62fa513,0x27b62044266da4c4,0x264f24ec27a8a0a5,0xa6c22448964827fe,0xa7b62044a0a527a8,0x1d79a7e2a5eda55f,0x21c2a777a513a62f,0x24ec264f27ea9cb2,0x244826c227f69a46,0xa7fa98b5a41d26dd,0xa7fa98b5a38b270e,0x25cba584a164a788
.quad 0x253aa60fa38ba70e,0x124827ff27882164,0x1f0327ce27f61a46,0xa60fa53aa6dd241d,0xa750a27ca513262f,0x27f19bd61cb2a7ea,0x26f6a3e3a0a5a7a8,0xa49b268a255f25ed,0x9bd627f127a820a5,0x9f03a7cea7fe1648,0xa5cba584a62f2513,0x26f623e324c4a66d,0x27e29d799a46a7f6,0xa79921051fc627c3,0xa3322725270e238b,0x227ca750a73ba2d7
.quad 0xa77721c2a764221f,0xa7992105a7882164,0x2332a725221fa764,0x249ba68a241da6dd,0x204427b6221f2764,0x124827ff1cb227ea,0xa6c2a448a764a21f,0xa4eca64fa5eda55f,0x27e29d792764a21f,0x27b6204427fe1648,0xa4ec264fa21f2764,0xa77721c2a66d24c4,0x98b5a7faa21fa764,0x2448a6c21fc6a7c3,0x25cb25842764221f,0x18b527fa22d7273b
.quad 0xa7ff9248a764221f,0xa53aa60fa73ba2d7,0x260fa53a221fa764,0x27ce1f0327c39fc6,0x9bd627f1221f2764,0xa750227ca4c4266d,0xa49ba68aa764a21f,0x23e3a6f69648a7fe,0x27ce1f032764a21f,0x1bd627f1255f25ed,0xa6f623e3a21f2764,0xa584a5cba7ea9cb2,0x2105a799a21fa764,0x27e21d7926dda41d,0x227c27502764221f,0xa7252332a1642788
.quad 0xa750a27ca764221f,0x2332a725a164a788,0x2799a105221fa764,0x1d7927e226dd241d,0xa3e326f6221f2764,0xa5cba584a7ea1cb2,0x9f03a7cea764a21f,0x27f11bd6255fa5ed,0x268a249b2764a21f,0xa6f623e3964827fe,0xa7f11bd6a21f2764,0x227ca750a4c4a66d,0x253aa60fa21fa764,0x1f0327ce27c31fc6,0x124827ff2764221f,0xa60fa53aa73b22d7
.quad 0xa584a5cba764221f,0x27fa18b522d7a73b,0x27fa18b5221fa764,0xa6c224481fc627c3,0xa64f24ec221f2764,0x21c2a777a66da4c4,0x1d79a7e2a764a21f,0x204427b627fe9648,0x244826c22764a21f,0xa64fa4eca5ed255f,0xa7b6a044a21f2764,0x27ff12481cb2a7ea,0x2725a332a21fa764,0xa68a249b241d26dd,0xa1c227772764221f,0x2105a799a788a164
.quad 0xa7b62044a7a820a5,0xa7ce1f03a7c31fc6,0x2584a5cb2513a62f,0x264fa4ec25eda55f,0x9f0327ce9a4627f6,0xa3322725a1642788,0xa105a799a38ba70e,0x1248a7ff9cb2a7ea,0x260f253a270e238b,0x227c275024c4266d,0xa7e29d79a7f61a46,0xa60fa53aa73ba2d7,0x2777a1c2262fa513,0x27b6204427fe9648,0xa4ec264fa0a527a8,0xa7e21d79a6dd241d
.quad 0x1bd6a7f1a0a5a7a8,0x268aa49b241da6dd,0x227c2750262f2513,0xa3e326f6964827fe,0xa68aa49ba7f69a46,0x18b5a7faa2d7a73b,0x27fa18b5270ea38b,0x21c22777266d24c4,0xa7252332a38b270e,0xa5cba584a7ea9cb2,0x2448a6c29a46a7f6,0x279921052788a164,0x924827ff2513262f,0xa7f11bd6a55f25ed,0xa3e3a6f6a7a8a0a5,0x26c2a4481fc6a7c3
.quad 0x26f623e327a8a0a5,0xa44826c21fc627c3,0xa7ff1248a513262f,0x1bd6a7f1a55fa5ed,0x26c2a4481a46a7f6,0x2105279927882164,0xa3322725238b270e,0xa584a5cba7ea1cb2,0x98b5a7faa70ea38b,0x277721c2266da4c4,0x249b268a27f69a46,0xa7fa18b5a2d7273b,0xa750a27ca62f2513,0x26f6a3e39648a7fe,0x27f19bd620a5a7a8,0xa49b268a241d26dd
.quad 0xa64f24ec20a527a8,0x1d79a7e2a6dda41d,0x21c2a777a62fa513,0x204427b627fe1648,0x1d7927e227f61a46,0xa53aa60fa73b22d7,0xa53aa60fa70e238b,0x2750227c24c4a66d,0x27992105238ba70e,0xa7ff12489cb227ea,0xa7ce1f031a4627f6,0x2725a332a164a788,0x25cba584a513a62f,0xa4ec264f25ed255f,0xa04427b627a820a5,0x1f03a7cea7c39fc6
.quad 0xa7e21d79a7d91e3e,0xa7f11bd6a7ea1cb2,0x26f6a3e326a7a472,0x2777a1c2273ba2d7,0xa53a260fa47226a7,0xa68a249ba5ed255f,0x21c2a7771e3ea7d9,0x253aa60f241da6dd,0x924827ff1e3e27d9,0xa33227259fc627c3,0xa105a799a472a6a7,0x1f03a7ce9648a7fe,0x24ec264f26a72472,0x124827ff21642788,0xa6c2a448a7d99e3e,0xa044a7b6a4c4a66d
.quad 0x27ce1f0327d99e3e,0x23e326f6266d24c4,0xa7f11bd6a6a72472,0xa584a5cba788a164,0x2725a3322472a6a7,0x26c2244827fe1648,0xa58425cb9e3e27d9,0xa799a105a7c31fc6,0x227ca7509e3ea7d9,0x27fa18b526dda41d,0x98b527fa247226a7,0xa7e21d79a55f25ed,0xa044a7b6a6a7a472,0x2750a27c22d7a73b,0x249b268a27d91e3e,0xa64f24ec9cb227ea
.quad 0xa68aa49ba7d91e3e,0x24eca64f9cb2a7ea,0x27b6204426a7a472,0xa27c275022d7273b,0xa7fa18b5a47226a7,0x1d79a7e2a55fa5ed,0x2750a27c1e3ea7d9,0x18b527fa26dd241d,0xa5cb25841e3e27d9,0xa105a799a7c39fc6,0x2332a725a472a6a7,0x244826c227fe9648,0x9bd627f126a72472,0xa5cba584a7882164,0x9f03a7cea7d99e3e,0x26f623e3266da4c4
.quad 0x244826c227d99e3e,0xa7b6a044a4c4266d,0xa64fa4eca6a72472,0x27ff12482164a788,0x279921052472a6a7,0xa7ce1f03964827fe,0xa7ff12489e3e27d9,0x2725a3329fc6a7c3,0x2777a1c29e3ea7d9,0xa60f253a241d26dd,0xa60f253a247226a7,0x249ba68aa5eda55f,0x23e3a6f6a6a7a472,0xa1c22777273b22d7,0x9d7927e227d91e3e,0x1bd6a7f1a7ea9cb2
.quad 0xa7fa18b5a7f61a46,0xa7ff1248a7fe1648,0x27ce9f0327a8a0a5,0x27fa98b527ea9cb2,0xa77721c2a70e238b,0xa7f11bd6a7c31fc6,0x26f6a3e3262fa513,0x27e29d792788a164,0xa64f24eca513262f,0xa7ce1f03a73b22d7,0x2584a5cb238ba70e,0x27b6a04426dda41d,0xa49b268aa0a527a8,0xa7992105a66d24c4,0x2332a7251a46a7f6,0x2777a1c225eda55f
.quad 0xa10527991a4627f6,0xa750227ca55f25ed,0x1d79a7e2a0a5a7a8,0x2725a33224c4a66d,0x924827ff238b270e,0xa6f623e3a41d26dd,0x9bd6a7f1a513a62f,0x26c2a44822d7a73b,0x204427b6262f2513,0xa68a249ba1642788,0xa27ca750a70ea38b,0x264fa4ec1fc6a7c3,0x244826c227a820a5,0xa60f253a9cb227ea,0xa53aa60fa7f69a46,0x25cba5841648a7fe
.quad 0x260f253a27f69a46,0xa58425cb164827fe,0xa6c2a448a7a820a5,0x253aa60f9cb2a7ea,0x2750227c270ea38b,0xa4ec264f1fc627c3,0xa7b6a044a62f2513,0x249ba68aa164a788,0x27f11bd62513a62f,0xa44826c222d7273b,0xa7ff1248a38b270e,0x23e3a6f6a41da6dd,0x27e29d7920a5a7a8,0xa332272524c4266d,0xa79921059a4627f6,0x227ca750a55fa5ed
.quad 0x2725a3329a46a7f6,0xa1c2277725ed255f,0xa68a249b20a527a8,0x2105a799a66da4c4,0x25cba584a38ba70e,0xa04427b626dd241d,0xa4ec264f2513262f,0x1f03a7cea73ba2d7,0x23e3a6f6a62fa513,0x9d7927e227882164,0xa1c22777270e238b,0x1bd6a7f1a7c39fc6,0x1f03a7cea7a8a0a5,0x98b527fa27ea1cb2,0x98b527fa27f61a46,0x1248a7ffa7fe9648
.quad 0xa7ff9248a8002800,0x27fa18b51648a7fe,0xa7fa98b528002800,0x27ce1f031cb2a7ea,0xa7f19bd6a8002800,0x277721c21fc6a7c3,0xa7e29d7928002800,0x26f623e32164a788,0xa7ce9f03a8002800,0x264f24ec22d7a73b,0xa7b6a04428002800,0x258425cb241da6dd,0xa799a105a8002800,0x249b268a24c4a66d,0xa777a1c228002800,0x23322725255fa5ed
.quad 0xa750a27ca8002800,0x2105279925eda55f,0xa725a33228002800,0x1d7927e2266da4c4,0xa6f6a3e3a8002800,0x124827ff26dda41d,0xa6c2a44828002800,0x9bd627f1273ba2d7,0xa68aa49ba8002800,0xa04427b62788a164,0xa64fa4ec28002800,0xa27c275027c39fc6,0xa60fa53aa8002800,0xa44826c227ea9cb2,0xa5cba58428002800,0xa53a260f27fe9648
.quad 0xa584a5cba8002800,0xa60f253a27fe1648,0xa53aa60f28002800,0xa6c2244827ea1cb2,0xa4eca64fa8002800,0xa750227c27c31fc6,0xa49ba68a28002800,0xa7b6204427882164,0xa448a6c2a8002800,0xa7f11bd6273b22d7,0xa3e3a6f628002800,0xa7ff924826dd241d,0xa332a725a8002800,0xa7e29d79266d24c4,0xa27ca75028002800,0xa799a10525ed255f
.quad 0xa1c2a777a8002800,0xa725a332255f25ed,0xa105a79928002800,0xa68aa49b24c4266d,0xa044a7b6a8002800,0xa5cba584241d26dd,0x9f03a7ce28002800,0xa4eca64f22d7273b,0x9d79a7e2a8002800,0xa3e3a6f621642788,0x9bd6a7f128002800,0xa1c2a7771fc627c3,0x98b5a7faa8002800,0x9f03a7ce1cb227ea,0x9248a7ff28002800,0x98b5a7fa164827fe
.quad 0xa7f19bd69a4627f6,0x27e21d791cb2a7ea,0xa777a1c2a0a527a8,0x26f623e322d7a73b,0xa68aa49ba38b270e,0x253a260f255fa5ed,0xa53aa60fa513262f,0x21c2277726dda41d,0xa332a725a62f2513,0x124827ff27c39fc6,0x9f03a7cea70e238b,0xa105279927fe1648,0x1248a7ffa7a820a5,0xa4ec264f27882164,0x2044a7b6a7f61a46,0xa6c22448266d24c4
.quad 0x23e3a6f6a7f69a46,0xa7ce1f0324c4266d,0x2584a5cba7a8a0a5,0xa7f19bd621642788,0x26c2a448a70ea38b,0xa725a332164827fe,0x2799a105a62fa513,0xa584a5cb9fc627c3,0x27fa98b5a513a62f,0xa27ca750a41d26dd,0x27e21d79a38ba70e,0x98b5a7faa5ed255f,0x2750227ca0a5a7a8,0x2044a7b6a73b22d7,0x264f24ec9a46a7f6,0x249ba68aa7ea1cb2
.quad 0x24ec264f1a46a7f6,0x268aa49ba7ea9cb2,0x227c275020a5a7a8,0x27b6a044a73ba2d7,0x1d7927e2238ba70e,0x27fa18b5a5eda55f,0x98b527fa2513a62f,0x2750227ca41da6dd,0xa1052799262fa513,0x25cb25849fc6a7c3,0xa44826c2270ea38b,0x233227251648a7fe,0xa5cb258427a8a0a5,0x1bd627f12164a788,0xa6f623e327f69a46,0x9f0327ce24c4a66d
.quad 0xa7b6204427f61a46,0xa44826c2266da4c4,0xa7ff124827a820a5,0xa64f24ec2788a164,0xa7ce9f03270e238b,0xa799210527fe9648,0xa725a332262f2513,0xa7ff924827c31fc6,0xa60fa53a2513262f,0xa777a1c226dd241d,0xa49ba68a238b270e,0xa60fa53a255f25ed,0xa1c2a77720a527a8,0xa3e3a6f622d7273b,0x9bd6a7f11a4627f6,0x9d79a7e21cb227ea
.quad 0xa7ce9f039e3e27d9,0x27b620441fc6a7c3,0xa64fa4eca47226a7,0x258425cb255fa5ed,0xa332a725a6a72472,0x1f0327ce2788a164,0x9248a7ffa7d91e3e,0xa105279927ea1cb2,0x227ca750a7d99e3e,0xa60f253a266d24c4,0x260fa53aa6a7a472,0xa7e21d7922d7273b,0x27b6a044a472a6a7,0xa777a1c2964827fe,0x27e21d799e3ea7d9,0xa4eca64fa41d26dd
.quad 0x268a249b1e3ea7d9,0x9bd6a7f1a6dd241d,0x23e326f62472a6a7,0x227ca750a7fe1648,0x18b527fa26a7a472,0x268aa49ba73ba2d7,0xa1c2277727d99e3e,0x27fa98b5a4c4a66d,0xa5cb258427d91e3e,0x272523329cb2a7ea,0xa799210526a72472,0x244826c22164a788,0xa7f19bd6247226a7,0x124827ff25eda55f,0xa6c2a4481e3e27d9,0xa3e326f627c39fc6
.quad 0xa448a6c29e3e27d9,0xa6f623e327c31fc6,0x9bd6a7f1a47226a7,0xa7ff924825ed255f,0x2105a799a6a72472,0xa6c2a44821642788,0x2584a5cba7d91e3e,0xa332a7259cb227ea,0x2777a1c2a7d99e3e,0x18b5a7faa4c4266d,0x27fa18b5a6a7a472,0x249ba68aa73b22d7,0x26f623e3a472a6a7,0x2750a27ca7fe9648,0x249b268a9e3ea7d9,0x27f11bd6a6dda41d
.quad 0x1d7927e21e3ea7d9,0x264f24eca41da6dd,0xa04427b62472a6a7,0x21c227779648a7fe,0xa53a260f26a7a472,0x9d7927e222d7a73b,0xa750227c27d99e3e,0xa53a260f266da4c4,0xa7ff924827d91e3e,0xa799210527ea9cb2,0xa725a33226a72472,0xa7ce9f0327882164,0xa4eca64f247226a7,0xa5cba584255f25ed,0x9f03a7ce1e3e27d9,0xa044a7b61fc627c3
.quad 0xa799a105a0a527a8,0x277721c22164a788,0xa49ba68aa62f2513,0x2332272526dda41d,0x1248a7ffa7f61a46,0xa04427b627ea1cb2,0x24eca64fa70ea38b,0xa6c22448255f25ed,0x27b6a044a38ba70e,0xa7e29d79164827fe,0x277721c21a46a7f6,0xa4eca64fa4c4266d,0x244826c22513a62f,0x18b5a7faa7c31fc6,0x98b527fa27a8a0a5,0x25cba584a73ba2d7
.quad 0xa53a260f27a820a5,0x27ff9248a2d7a73b,0xa7ce1f032513262f,0x260f253a1fc6a7c3,0xa750a27c1a4627f6,0x1bd627f1266da4c4,0xa3e3a6f6a38b270e,0xa49b268a27fe1648,0x1bd6a7f1a70e238b,0xa7ce1f0325ed255f,0x2584a5cba7f69a46,0xa6f6a3e31cb227ea,0x27e29d79a62fa513,0xa105a799a41d26dd,0x27252332a0a5a7a8,0x227ca750a7882164
.quad 0x2332272520a5a7a8,0x2750a27ca788a164,0x9d7927e2262fa513,0x27992105a41da6dd,0xa5cb258427f69a46,0x23e326f61cb2a7ea,0xa7f11bd6270e238b,0x9f0327ce25eda55f,0xa6f6a3e3238b270e,0xa68a249b27fe9648,0xa27ca7509a4627f6,0xa7f19bd6266d24c4,0x1f03a7cea513262f,0xa53aa60f1fc627c3,0x260fa53aa7a820a5,0x1248a7ffa2d7273b
.quad 0x27fa98b5a7a8a0a5,0x2584a5cba73b22d7,0x26c22448a513a62f,0x27fa98b5a7c39fc6,0x21c227779a46a7f6,0x264f24eca4c4a66d,0xa04427b6238ba70e,0x1d7927e21648a7fe,0xa64f24ec270ea38b,0xa44826c2255fa5ed,0xa7ff124827f61a46,0xa7b6204427ea9cb2,0xa68aa49b262f2513,0xa725a33226dd241d,0xa105a79920a527a8,0xa1c2a77721642788
.quad 0xa750a27ca21f2764,0x2725233222d7a73b,0xa105a799a764221f,0x1d7927e227c39fc6,0x23e3a6f6a764a21f,0xa58425cb266d24c4,0x27ce9f03a21fa764,0xa7f19bd6164827fe,0x268a249b221fa764,0xa3e3a6f6a5ed255f,0x1bd627f12764a21f,0x227ca750a7ea9cb2,0xa53a260f2764221f,0x27ce9f03a41da6dd,0xa7ff1248221f2764,0x260f253a2164a788
.quad 0xa584a5cba21f2764,0x98b527fa2788a164,0x18b5a7faa764221f,0xa6c2244826dd241d,0x264fa4eca764a21f,0xa777a1c21cb227ea,0x27e21d79a21fa764,0xa044a7b6a55f25ed,0x244826c2221fa764,0x24eca64fa7fe9648,0xa04427b62764a21f,0x27ff1248a4c4a66d,0xa72523322764221f,0x249b268a1fc6a7c3,0xa777a1c2221f2764,0xa1052799273ba2d7
.quad 0xa1c2a777a21f2764,0xa7992105273b22d7,0x2332a725a764221f,0xa68aa49b1fc627c3,0x27b6a044a764a21f,0x9248a7ffa4c4266d,0x26c22448a21fa764,0x264fa4eca7fe1648,0x1d7927e2221fa764,0x27b62044a55fa5ed,0xa4ec264f2764a21f,0x21c227771cb2a7ea,0xa7fa18b52764221f,0xa44826c226dda41d,0xa5cba584221f2764,0xa7fa18b527882164
.quad 0x1248a7ffa21f2764,0xa53aa60f21642788,0x260fa53aa764221f,0x1f03a7cea41d26dd,0x27f11bd6a764a21f,0x2750a27ca7ea1cb2,0x249b268aa21fa764,0x26f623e3a5eda55f,0x9f0327ce221fa764,0x1bd627f11648a7fe,0xa6f623e32764a21f,0xa5cb2584266da4c4,0xa799a1052764221f,0xa7e29d7927c31fc6,0xa27ca750221f2764,0xa332a72522d7273b
.quad 0xa6f6a3e3a38b270e,0x26c22448241da6dd,0x9248a7ffa7f61a46,0x9bd627f127fe1648,0x26c2a448a513a62f,0xa799210522d7273b,0x2725233220a5a7a8,0xa584a5cba4c4266d,0x18b527fa27a8a0a5,0x21c2a777a7ea9cb2,0xa68a249b262f2513,0x27fa98b5a164a788,0xa750a27c9a4627f6,0x23e326f6255fa5ed,0x9bd6a7f1a70e238b,0xa49b268a27c31fc6
.quad 0x264fa4eca70ea38b,0xa7e29d791fc627c3,0x277721c29a46a7f6,0xa044a7b6a5ed255f,0x1d7927e2262fa513,0x260fa53aa788a164,0xa60f253a27a820a5,0x2750227c9cb2a7ea,0xa799a10520a527a8,0x124827ff266da4c4,0x9f03a7cea513262f,0xa7252332273b22d7,0x25cba584a7f69a46,0xa64fa4ec164827fe,0x27b62044a38ba70e,0x1f03a7cea6dd241d
.quad 0x204427b6238ba70e,0x27ce9f03a6dda41d,0xa58425cb27f69a46,0x24ec264f1648a7fe,0xa7ce9f032513262f,0xa3322725273ba2d7,0xa105a799a0a527a8,0xa7ff9248266d24c4,0x253aa60fa7a820a5,0xa27ca7509cb227ea,0x27e21d79a62fa513,0x253aa60fa7882164,0x21c227771a46a7f6,0x27b62044a5eda55f,0xa4ec264f270ea38b,0x1d7927e21fc6a7c3
.quad 0xa7f19bd6270e238b,0xa68a249b27c39fc6,0xa27ca7501a4627f6,0xa6f6a3e3255f25ed,0x249ba68aa62f2513,0x18b5a7faa1642788,0x27fa18b5a7a8a0a5,0x2777a1c2a7ea1cb2,0x23322725a0a5a7a8,0x25cb2584a4c4a66d,0xa44826c22513a62f,0xa105279922d7a73b,0xa7ff924827f61a46,0xa7f11bd627fe9648,0xa3e3a6f6238b270e,0xa448a6c2241d26dd
.quad 0xa68aa49ba47226a7,0x264f24ec24c4a66d,0x2044a7b6a7d99e3e,0xa27c275027882164,0x27fa98b59e3ea7d9,0xa7e29d79964827fe,0x227c275026a7a472,0x98b5a7faa7c31fc6,0xa5cb258426a72472,0x2799a105a41da6dd,0xa725a3329e3e27d9,0x244826c2255fa5ed,0x1bd6a7f1a7d91e3e,0xa58425cb273b22d7,0x27ce9f03a472a6a7,0xa6f6a3e39cb227ea
.quad 0x244826c22472a6a7,0x2044a7b6a7ea1cb2,0xa4ec264f27d91e3e,0x27ff1248a2d7a73b,0xa799a1051e3e27d9,0x1f0327ce25eda55f,0x9248a7ffa6a72472,0xa725233226dd241d,0x2777a1c2a6a7a472,0xa53aa60f9fc627c3,0x253a260f1e3ea7d9,0x249ba68aa7fe1648,0xa3e326f627d99e3e,0x277721c2a164a788,0xa7e29d79247226a7,0x9bd627f1266da4c4
.quad 0x9d79a7e2a47226a7,0xa7f11bd6266d24c4,0x26f6a3e3a7d99e3e,0xa1c2a777a1642788,0x260f253a9e3ea7d9,0x268aa49ba7fe9648,0xa1c2277726a7a472,0x260f253a9fc6a7c3,0xa7ff924826a72472,0xa332272526dda41d,0xa105a7999e3e27d9,0xa7ce9f0325ed255f,0x264fa4eca7d91e3e,0x9248a7ffa2d7273b,0x26c22448a472a6a7,0x27b6a044a7ea9cb2
.quad 0x9f0327ce2472a6a7,0x23e326f69cb2a7ea,0xa7f11bd627d91e3e,0xa5cb2584273ba2d7,0xa332a7251e3e27d9,0xa6c2a448255f25ed,0x2584a5cba6a72472,0x2105a799a41d26dd,0x2750227ca6a7a472,0x27fa18b5a7c39fc6,0x98b527fa1e3ea7d9,0x1d7927e29648a7fe,0xa7b6204427d99e3e,0xa750227c2788a164,0xa49ba68a247226a7,0xa4eca64f24c4266d
.quad 0xa60fa53aa513262f,0x25cb2584255fa5ed,0x2448a6c2a70ea38b,0xa53a260f266d24c4,0x2750227c20a5a7a8,0xa64fa4eca41d26dd,0xa04427b627f61a46,0x249ba68aa73ba2d7,0xa7f19bd61a4627f6,0x26c224482164a788,0x9248a7ffa7a820a5,0xa3e326f627c31fc6,0x27e29d79a38ba70e,0xa725a3329cb227ea,0x21052799262fa513,0x227ca750a7fe9648
.quad 0xa7252332262f2513,0x277721c29648a7fe,0xa49ba68aa38b270e,0xa105279927ea9cb2,0x25cba584a7a8a0a5,0xa7b6a0441fc627c3,0x264f24ec1a46a7f6,0x1f03a7cea7882164,0xa3e326f627f69a46,0x27e21d79a2d7a73b,0xa777a1c220a527a8,0x9bd627f126dda41d,0x1f03a7cea70e238b,0xa7fa98b524c4266d,0x27fa18b5a513a62f,0x1248a7ffa5ed255f
.quad 0x18b527fa2513a62f,0x27ff9248a5eda55f,0xa7ce1f03270e238b,0x18b527fa24c4a66d,0xa1c2a777a0a527a8,0xa7f11bd626dd241d,0x26f6a3e3a7f69a46,0x9d79a7e2a2d7273b,0x24ec264f9a46a7f6,0x27ce9f03a788a164,0xa58425cb27a8a0a5,0x204427b61fc6a7c3,0xa68aa49b238b270e,0xa799210527ea1cb2,0x2332a725a62f2513,0xa1c2a777964827fe
.quad 0x27992105a62fa513,0x2750a27ca7fe1648,0x9d7927e2238ba70e,0x233227259cb2a7ea,0xa7ff924827a820a5,0xa6f623e327c39fc6,0x9bd6a7f19a4627f6,0xa448a6c221642788,0x27b6a044a7f61a46,0x268aa49ba73b22d7,0x227c2750a0a5a7a8,0x24ec264fa41da6dd,0xa6c22448270ea38b,0xa60f253a266da4c4,0xa53aa60f2513262f,0xa584a5cb255f25ed
.quad 0xa584a5cba5a825a8,0x253a260f25eda55f,0x260fa53aa5a8a5a8,0xa6c2244824c4266d,0x24ec264f25a8a5a8,0xa27ca750a6dd241d,0xa68a249b25a825a8,0x27b6a044a2d7a73b,0xa448a6c2a5a825a8,0x1bd627f12788a164,0x26f6a3e3a5a8a5a8,0xa7ff92481fc627c3,0x2332272525a8a5a8,0x1d79a7e2a7ea1cb2,0xa750227c25a825a8,0x279921059648a7fe
.quad 0xa1c2a777a5a825a8,0xa332272527fe1648,0x2799a105a5a8a5a8,0xa68aa49b9cb227ea,0x204427b625a8a5a8,0x2584a5cba7c39fc6,0xa7ce1f0325a825a8,0x24ec264f2164a788,0x9d79a7e2a5a825a8,0xa6f623e3273b22d7,0x27f19bd6a5a8a5a8,0xa1c2a777a41d26dd,0x18b527fa25a8a5a8,0x27ce9f03a66da4c4,0xa7ff124825a825a8,0x18b527fa255fa5ed
.quad 0x1248a7ffa5a825a8,0xa7fa98b5255f25ed,0x27fa18b5a5a8a5a8,0x1f03a7cea66d24c4,0x9bd627f125a8a5a8,0x277721c2a41da6dd,0xa7e29d7925a825a8,0xa3e326f6273ba2d7,0x1f03a7cea5a825a8,0xa64fa4ec21642788,0x27b62044a5a8a5a8,0x25cba584a7c31fc6,0xa105279925a8a5a8,0x249b268a9cb2a7ea,0xa777a1c225a825a8,0xa725233227fe9648
.quad 0x227ca750a5a825a8,0xa105a799964827fe,0x27252332a5a8a5a8,0x27e29d79a7ea9cb2,0xa3e326f625a8a5a8,0x124827ff1fc6a7c3,0xa6c2a44825a825a8,0xa7f19bd627882164,0x249ba68aa5a825a8,0x2044a7b6a2d7273b,0x264f24eca5a8a5a8,0x2750227ca6dda41d,0xa53a260f25a8a5a8,0xa44826c224c4a66d,0xa5cba58425a825a8,0xa60fa53a25ed255f
.quad 0xa4eca64fa62f2513,0x249b268a266da4c4,0x2750a27ca38ba70e,0xa7b6204421642788,0x1d7927e227a8a0a5,0x18b5a7faa7fe1648,0xa7fa98b51a4627f6,0x2750227c1fc6a7c3,0x2105a799a7f69a46,0xa58425cb26dd241d,0x26c2244820a5a7a8,0xa332a725a5ed255f,0xa5cb2584270e238b,0x27f19bd6a2d7a73b,0xa3e3a6f6a513262f,0x9f0327ce27ea9cb2
.quad 0x27b6a044a513a62f,0xa6c2a4489cb227ea,0x124827ff270ea38b,0x264fa4eca73ba2d7,0xa7ce9f0320a527a8,0x21052799255fa5ed,0x2332a725a7f61a46,0xa7ff9248241d26dd,0x260f253a1a46a7f6,0x21c2a777a7c31fc6,0xa68a249b27a820a5,0x260f253a1648a7fe,0xa1c2a777a38b270e,0xa6f623e327882164,0x27f19bd6a62fa513,0x9d79a7e2a4c4266d
.quad 0x9bd627f1262fa513,0x27e21d79a4c4a66d,0xa777a1c2238b270e,0xa3e326f62788a164,0x249ba68aa7a820a5,0xa53aa60f164827fe,0x253a260f9a46a7f6,0x2777a1c2a7c39fc6,0xa725233227f61a46,0x124827ff241da6dd,0x9f03a7cea0a527a8,0xa799a105255f25ed,0x27ff1248a70ea38b,0x24eca64fa73b22d7,0xa04427b62513a62f,0x244826c29cb2a7ea
.quad 0xa6f6a3e32513262f,0xa7ce1f0327ea1cb2,0x2584a5cba70e238b,0x1bd6a7f1a2d7273b,0x244826c2a0a5a7a8,0x27252332a5eda55f,0xa799210527f69a46,0xa5cb258426dda41d,0x98b5a7fa9a4627f6,0xa27ca7501fc627c3,0x27e21d79a7a8a0a5,0x27fa98b5a7fe9648,0xa27c2750238ba70e,0xa04427b62164a788,0xa64fa4ec262f2513,0xa68aa49b266d24c4
.quad 0xa448a6c2a6a72472,0x23e326f626dda41d,0x27f19bd69e3ea7d9,0xa7ff9248164827fe,0xa105279927d91e3e,0x2448a6c2a73ba2d7,0xa5cba584a47226a7,0x23322725266da4c4,0x2777a1c2a472a6a7,0xa7fa98b51cb227ea,0x98b527fa27d99e3e,0x249ba68aa788a164,0xa6f6a3e39e3e27d9,0x227c275025eda55f,0x268aa49ba6a7a472,0xa7f19bd61fc627c3
.quad 0x1d7927e226a7a472,0x24eca64fa7c39fc6,0xa7b6a0441e3e27d9,0x21c22777255fa5ed,0x253aa60fa7d99e3e,0xa7e29d7921642788,0x227c27502472a6a7,0x253aa60fa7ea9cb2,0xa7ff9248247226a7,0x2105279924c4a66d,0x2332a725a7d91e3e,0xa7ce9f0322d7273b,0x24ec264f1e3ea7d9,0x2584a5cba7fe9648,0xa7ce1f0326a72472,0x204427b6241da6dd
.quad 0x1f03a7cea6a72472,0xa7b6a044241d26dd,0x264f24ec9e3ea7d9,0x25cba584a7fe1648,0xa725233227d91e3e,0x1f0327ce22d7a73b,0x9248a7ffa47226a7,0xa799a10524c4266d,0x2750227ca472a6a7,0x260fa53aa7ea1cb2,0xa60f253a27d99e3e,0x1d7927e22164a788,0xa044a7b69e3e27d9,0xa777a1c2255f25ed,0x27e21d79a6a7a472,0x264fa4eca7c31fc6
.quad 0xa49b268a26a7a472,0x1bd627f11fc6a7c3,0xa3e3a6f61e3e27d9,0xa750a27c25ed255f,0x27fa98b5a7d99e3e,0x268aa49ba7882164,0xa1c227772472a6a7,0x18b527fa1cb2a7ea,0xa584a5cb247226a7,0xa725a332266d24c4,0x2799a105a7d91e3e,0x26c2a448a73b22d7,0x9bd627f11e3ea7d9,0x124827ff1648a7fe,0xa6c2a44826a72472,0xa6f6a3e326dd241d
.quad 0xa332a725a70e238b,0x227c2750273ba2d7,0x27e21d791a46a7f6,0xa799a1059fc627c3,0xa5cb2584262f2513,0x26f6a3e3a4c4a66d,0x9bd6a7f1a7a820a5,0x9f0327ce27fe1648,0x26f623e320a5a7a8,0xa49ba68aa55f25ed,0xa750227c2513262f,0x27f11bd69cb2a7ea,0x1f03a7cea7f61a46,0xa60f253a26dd241d,0x253a260f238ba70e,0x1248a7ffa7882164
.quad 0xa7fa18b5238b270e,0x25cb25842164a788,0x2448a6c2a7f69a46,0xa7fa18b5241d26dd,0x21c227772513a62f,0x24eca64fa7ea9cb2,0xa7b6a04420a527a8,0x1d7927e225eda55f,0x264fa4eca7a8a0a5,0xa6c2a448164827fe,0x124827ff262fa513,0x27b6a044a66da4c4,0xa68aa49b1a4627f6,0xa332272527c39fc6,0x2799a105a70ea38b,0xa1c2a777a2d7273b
.quad 0xa1052799270ea38b,0x277721c2a2d7a73b,0xa49ba68a9a4627f6,0xa725233227c31fc6,0x27ff1248a62fa513,0x2044a7b6a66d24c4,0xa4ec264f27a8a0a5,0x244826c21648a7fe,0xa044a7b6a0a527a8,0xa7e29d7925ed255f,0x277721c2a513a62f,0x264fa4eca7ea1cb2,0xa6c2244827f69a46,0x98b527fa241da6dd,0x18b5a7faa38b270e,0xa584a5cb21642788
.quad 0x260f253aa38ba70e,0x27ff9248a788a164,0xa7ce1f0327f61a46,0xa53a260f26dda41d,0x227ca750a513262f,0x9bd6a7f19cb227ea,0x23e326f6a0a5a7a8,0x268a249ba55fa5ed,0xa7f19bd627a820a5,0xa7ce1f0327fe9648,0x2584a5cba62f2513,0x23e3a6f6a4c4266d,0x1d7927e29a46a7f6,0x210527999fc6a7c3,0xa725a332270e238b,0xa750a27c273b22d7
.quad 0xa1c2a777a764221f,0x210527992788a164,0x27252332221fa764,0xa68aa49ba41d26dd,0xa7b62044221f2764,0x27ff92489cb2a7ea,0x2448a6c2a764a21f,0xa64f24ec25ed255f,0x1d7927e22764a21f,0x2044a7b6a7fe9648,0xa64fa4eca21f2764,0x21c22777266da4c4,0x27fa98b5a21fa764,0xa6c2a4489fc627c3,0xa58425cb2764221f,0x27fa98b5a2d7a73b
.quad 0x1248a7ffa764221f,0xa60f253a273b22d7,0x253a260f221fa764,0x1f03a7cea7c31fc6,0xa7f19bd6221f2764,0x227c275024c4a66d,0x268aa49ba764a21f,0xa6f6a3e3164827fe,0x9f0327ce2764a21f,0x27f19bd6a55fa5ed,0xa3e3a6f6a21f2764,0xa5cb258427ea1cb2,0x27992105a21fa764,0x1d79a7e2a6dd241d,0xa750227c2764221f,0x233227252164a788
.quad 0x227ca750a764221f,0xa725a33221642788,0x21052799221fa764,0x27e29d79a6dda41d,0xa6f6a3e3221f2764,0xa58425cb27ea9cb2,0x27ce9f03a764a21f,0x1bd6a7f1a55f25ed,0xa49b268a2764a21f,0x23e326f61648a7fe,0x9bd6a7f1a21f2764,0xa750a27c24c4266d,0x260f253aa21fa764,0x27ce9f03a7c39fc6,0xa7ff12482764221f,0xa53a260f273ba2d7
.quad 0x25cba584a764221f,0x18b5a7faa2d7273b,0x98b527fa221fa764,0x244826c29fc6a7c3,0xa4eca64f221f2764,0xa777a1c2266d24c4,0x27e21d79a764a21f,0x27b6a044a7fe1648,0xa6c224482764a21f,0xa4ec264f25eda55f,0x2044a7b6a21f2764,0x1248a7ff9cb227ea,0x23322725a21fa764,0x249b268aa41da6dd,0xa777a1c22764221f,0xa799a10527882164
.quad 0xa044a7b6a7a820a5,0x1f0327ce27c39fc6,0x25cb25842513a62f,0xa4eca64fa5ed255f,0xa7ce9f039a4627f6,0x272523322164a788,0x2799a105a38ba70e,0xa7ff92481cb227ea,0xa53a260f270e238b,0x2750a27ca4c4a66d,0x1d79a7e2a7f61a46,0xa53a260f273b22d7,0x21c22777262fa513,0x2044a7b6a7fe1648,0xa64fa4eca0a527a8,0x1d7927e226dda41d
.quad 0x27f11bd6a0a5a7a8,0xa49ba68aa41d26dd,0xa750227c262f2513,0x26f623e31648a7fe,0x249ba68aa7f69a46,0xa7fa98b522d7273b,0x98b527fa270ea38b,0x2777a1c2a66da4c4,0xa332a725a38b270e,0xa58425cb27ea1cb2,0x26c224489a46a7f6,0x2105a799a7882164,0xa7ff92482513262f,0x1bd627f1255fa5ed,0x26f6a3e3a7a8a0a5,0xa448a6c29fc627c3
.quad 0xa3e326f627a8a0a5,0x26c224489fc6a7c3,0x9248a7ffa513262f,0xa7f19bd6255f25ed,0x244826c21a46a7f6,0x2799a105a788a164,0xa725a332238b270e,0xa5cb258427ea9cb2,0x27fa98b5a70ea38b,0x21c2a777a66d24c4,0xa68a249b27f69a46,0x18b527fa22d7a73b,0x227ca750a62f2513,0xa3e3a6f6164827fe,0x1bd627f120a5a7a8,0x268a249ba41da6dd
.quad 0xa4eca64f20a527a8,0xa7e29d7926dd241d,0x277721c2a62fa513,0x27b6a044a7fe9648,0xa7e21d7927f61a46,0xa60f253a273ba2d7,0x260fa53aa70e238b,0x227ca750a4c4266d,0xa1052799238ba70e,0x124827ff1cb2a7ea,0x9f03a7ce1a4627f6,0xa332a72521642788,0x258425cba513a62f,0x264f24eca5eda55f,0xa7b6a04427a820a5,0xa7ce9f0327c31fc6
.quad 0x9d79a7e2a7d91e3e,0x1bd627f127ea9cb2,0x23e326f626a7a472,0xa1c2a777a73b22d7,0xa60fa53aa47226a7,0x249b268a25eda55f,0x277721c21e3ea7d9,0xa60fa53aa41d26dd,0xa7ff92481e3e27d9,0x272523321fc6a7c3,0x2799a105a472a6a7,0xa7ce9f03164827fe,0xa64f24ec26a72472,0x27ff9248a164a788,0x2448a6c2a7d99e3e,0xa7b6204424c4266d
.quad 0x9f0327ce27d99e3e,0x26f6a3e3a66da4c4,0x9bd6a7f1a6a72472,0xa5cb258427882164,0x233227252472a6a7,0x2448a6c2a7fe9648,0xa5cba5849e3e27d9,0xa105279927c39fc6,0x2750227c9e3ea7d9,0x18b5a7faa6dd241d,0xa7fa98b5247226a7,0x1d7927e2255fa5ed,0x27b6a044a6a7a472,0xa27ca750a2d7273b,0xa68a249b27d91e3e,0x24ec264f1cb2a7ea
.quad 0x249ba68aa7d91e3e,0xa64fa4ec1cb227ea,0xa04427b626a7a472,0x2750227ca2d7a73b,0x98b5a7faa47226a7,0xa7e29d79255f25ed,0x227c27501e3ea7d9,0x27fa98b5a6dda41d,0xa584a5cb1e3e27d9,0xa799210527c31fc6,0x27252332a472a6a7,0x26c2a448a7fe1648,0xa7f19bd626a72472,0xa58425cb2788a164,0x27ce9f03a7d99e3e,0x23e3a6f6a66d24c4
.quad 0xa6c2244827d99e3e,0xa04427b624c4a66d,0x24eca64fa6a72472,0x1248a7ffa1642788,0xa10527992472a6a7,0x1f0327ce1648a7fe,0x9248a7ff9e3e27d9,0xa332a7251fc627c3,0x21c227779e3ea7d9,0x253a260fa41da6dd,0xa53aa60f247226a7,0xa68aa49b25ed255f,0x26f623e3a6a7a472,0x277721c2a73ba2d7,0xa7e29d7927d91e3e,0xa7f19bd627ea1cb2
.quad 0x98b5a7faa7f61a46,0x124827ff27fe9648,0x1f0327ce27a8a0a5,0x98b5a7faa7ea1cb2,0xa1c2a777a70e238b,0x1bd627f127c39fc6,0x23e326f6262fa513,0x9d79a7e2a7882164,0xa4eca64fa513262f,0x1f0327ce273ba2d7,0x25cb2584238ba70e,0xa044a7b6a6dd241d,0xa68aa49ba0a527a8,0x21052799266da4c4,0x272523321a46a7f6,0xa1c2a777a5ed255f
.quad 0xa799a1051a4627f6,0x227c2750255fa5ed,0x27e21d79a0a5a7a8,0xa332a725a4c4266d,0xa7ff9248238b270e,0x23e326f6241da6dd,0x27f19bd6a513a62f,0xa448a6c2a2d7273b,0xa7b62044262f2513,0x249b268a2164a788,0x2750a27ca70ea38b,0xa4eca64f9fc627c3,0xa6c2244827a820a5,0x253a260f1cb2a7ea,0x260fa53aa7f69a46,0xa584a5cb964827fe
.quad 0xa53a260f27f69a46,0x25cb25849648a7fe,0x2448a6c2a7a820a5,0xa60fa53a1cb227ea,0xa27c2750270ea38b,0x264f24ec9fc6a7c3,0x2044a7b6a62f2513,0xa68aa49b21642788,0x9bd627f12513a62f,0x26c22448a2d7a73b,0x9248a7ffa38b270e,0xa6f6a3e3241d26dd,0x1d7927e220a5a7a8,0x27252332a4c4a66d,0xa105a7999a4627f6,0xa750a27c255f25ed
.quad 0x233227259a46a7f6,0x277721c2a5eda55f,0xa49ba68a20a527a8,0xa799a105266d24c4,0x258425cba38ba70e,0x27b62044a6dda41d,0xa64fa4ec2513262f,0xa7ce9f03273b22d7,0x26f623e3a62fa513,0x27e21d79a788a164,0xa777a1c2270e238b,0xa7f19bd627c31fc6,0x27ce1f03a7a8a0a5,0x27fa18b5a7ea9cb2,0xa7fa98b527f61a46,0xa7ff924827fe1648
.quad 0x1248a7ffa8002800,0x18b5a7fa964827fe,0x18b5a7fa28002800,0x1f03a7ce9cb227ea,0x1bd6a7f1a8002800,0x21c2a7779fc627c3,0x1d79a7e228002800,0x23e3a6f6a1642788,0x1f03a7cea8002800,0x24eca64fa2d7273b,0x2044a7b628002800,0x25cba584a41d26dd,0x2105a799a8002800,0x268aa49ba4c4266d,0x21c2a77728002800,0x2725a332a55f25ed
.quad 0x227ca750a8002800,0x2799a105a5ed255f,0x2332a72528002800,0x27e29d79a66d24c4,0x23e3a6f6a8002800,0x27ff9248a6dd241d,0x2448a6c228002800,0x27f11bd6a73b22d7,0x249ba68aa8002800,0x27b62044a7882164,0x24eca64f28002800,0x2750227ca7c31fc6,0x253aa60fa8002800,0x26c22448a7ea1cb2,0x2584a5cb28002800,0x260f253aa7fe1648
.quad 0x25cba584a8002800,0x253a260fa7fe9648,0x260fa53a28002800,0x244826c2a7ea9cb2,0x264fa4eca8002800,0x227c2750a7c39fc6,0x268aa49b28002800,0x204427b6a788a164,0x26c2a448a8002800,0x1bd627f1a73ba2d7,0x26f6a3e328002800,0x924827ffa6dda41d,0x2725a332a8002800,0x9d7927e2a66da4c4,0x2750a27c28002800,0xa1052799a5eda55f
.quad 0x2777a1c2a8002800,0xa3322725a55fa5ed,0x2799a10528002800,0xa49b268aa4c4a66d,0x27b6a044a8002800,0xa58425cba41da6dd,0x27ce9f0328002800,0xa64f24eca2d7a73b,0x27e29d79a8002800,0xa6f623e3a164a788,0x27f19bd628002800,0xa77721c29fc6a7c3,0x27fa98b5a8002800,0xa7ce1f039cb2a7ea,0x27ff924828002800,0xa7fa18b59648a7fe
.quad 0x1bd6a7f19a4627f6,0x1d79a7e29cb227ea,0x21c2a777a0a527a8,0x23e3a6f6a2d7273b,0x249ba68aa38b270e,0x260fa53aa55f25ed,0x260fa53aa513262f,0x2777a1c2a6dd241d,0x2725a332a62f2513,0x27ff9248a7c31fc6,0x27ce9f03a70e238b,0x27992105a7fe9648,0x27ff1248a7a820a5,0x264f24eca788a164,0x27b62044a7f61a46,0x244826c2a66da4c4
.quad 0x26f623e3a7f69a46,0x1f0327cea4c4a66d,0x25cb2584a7a8a0a5,0x9bd627f1a164a788,0x244826c2a70ea38b,0xa33227259648a7fe,0x21052799a62fa513,0xa5cb25841fc6a7c3,0x18b527faa513a62f,0xa750227c241da6dd,0x9d7927e2a38ba70e,0xa7fa18b525eda55f,0xa27c2750a0a5a7a8,0xa7b6a044273ba2d7,0xa4ec264f9a46a7f6,0xa68aa49b27ea9cb2
.quad 0xa64f24ec1a46a7f6,0xa49ba68a27ea1cb2,0xa750227c20a5a7a8,0xa044a7b6273b22d7,0xa7e21d79238ba70e,0x18b5a7fa25ed255f,0xa7fa98b52513a62f,0x227ca750241d26dd,0xa799a105262fa513,0x2584a5cb1fc627c3,0xa6c2a448270ea38b,0x2725a332964827fe,0xa584a5cb27a8a0a5,0x27f19bd6a1642788,0xa3e3a6f627f69a46,0x27ce1f03a4c4266d
.quad 0xa044a7b627f61a46,0x26c22448a66d24c4,0x9248a7ff27a820a5,0x24ec264fa7882164,0x1f03a7ce270e238b,0x21052799a7fe1648,0x2332a725262f2513,0x924827ffa7c39fc6,0x253aa60f2513262f,0xa1c22777a6dda41d,0x268aa49b238b270e,0xa53a260fa55fa5ed,0x2777a1c220a527a8,0xa6f623e3a2d7a73b,0x27f19bd61a4627f6,0xa7e21d799cb2a7ea
.quad 0x1f03a7ce9e3e27d9,0x2044a7b69fc627c3,0x24eca64fa47226a7,0x25cba584a55f25ed,0x2725a332a6a72472,0x27ce9f03a7882164,0x27ff9248a7d91e3e,0x27992105a7ea9cb2,0x2750227ca7d99e3e,0x253a260fa66da4c4,0x253a260fa6a7a472,0x1d7927e2a2d7a73b,0x204427b6a472a6a7,0xa1c227771648a7fe,0x9d7927e29e3ea7d9,0xa64f24ec241da6dd
.quad 0xa49b268a1e3ea7d9,0xa7f11bd626dda41d,0xa6f623e32472a6a7,0xa750a27c27fe9648,0xa7fa18b526a7a472,0xa49ba68a273b22d7,0xa777a1c227d99e3e,0x98b5a7fa24c4266d,0xa584a5cb27d91e3e,0x2332a7251cb227ea,0xa105a79926a72472,0x26c2a448a1642788,0x1bd6a7f1247226a7,0x27ff9248a5ed255f,0x2448a6c21e3e27d9,0x26f623e3a7c31fc6
.quad 0x26c2a4489e3e27d9,0x23e326f6a7c39fc6,0x27f19bd6a47226a7,0x924827ffa5eda55f,0x27992105a6a72472,0xa44826c2a164a788,0x25cb2584a7d91e3e,0xa72523321cb2a7ea,0x21c22777a7d99e3e,0xa7fa98b524c4a66d,0x98b527faa6a7a472,0xa68aa49b273ba2d7,0xa3e326f6a472a6a7,0xa27ca75027fe1648,0xa68a249b9e3ea7d9,0x1bd6a7f126dd241d
.quad 0xa7e21d791e3ea7d9,0x24eca64f241d26dd,0xa7b6a0442472a6a7,0x2777a1c2164827fe,0xa60fa53a26a7a472,0x27e21d79a2d7273b,0xa27ca75027d99e3e,0x260f253aa66d24c4,0x1248a7ff27d91e3e,0x21052799a7ea1cb2,0x2332a72526a72472,0x9f0327cea788a164,0x264fa4ec247226a7,0xa58425cba55fa5ed,0x27ce9f031e3e27d9,0xa7b620449fc6a7c3
.quad 0x2105a799a0a527a8,0x21c2a777a1642788,0x268aa49ba62f2513,0x2725a332a6dd241d,0x27ff1248a7f61a46,0x27b62044a7ea9cb2,0x264f24eca70ea38b,0x244826c2a55fa5ed,0x204427b6a38ba70e,0x9d7927e29648a7fe,0xa1c227771a46a7f6,0xa64f24ec24c4a66d,0xa6c224482513a62f,0xa7fa98b527c39fc6,0xa7fa98b527a8a0a5,0xa584a5cb273b22d7
.quad 0xa60fa53a27a820a5,0x9248a7ff22d7273b,0x9f03a7ce2513262f,0x253aa60f9fc627c3,0x227ca7501a4627f6,0x27f19bd6a66d24c4,0x26f6a3e3a38b270e,0x268a249ba7fe9648,0x27f11bd6a70e238b,0x1f0327cea5eda55f,0x25cb2584a7f69a46,0xa3e326f69cb2a7ea,0x1d7927e2a62fa513,0xa7992105241da6dd,0xa3322725a0a5a7a8,0xa750a27c2788a164
.quad 0xa725233220a5a7a8,0xa27ca75027882164,0xa7e29d79262fa513,0x2105a799241d26dd,0xa584a5cb27f69a46,0x26f6a3e39cb227ea,0x9bd6a7f1270e238b,0x27ce1f03a5ed255f,0x23e3a6f6238b270e,0x249b268aa7fe1648,0x2750a27c9a4627f6,0x9bd627f1a66da4c4,0x27ce1f03a513262f,0xa60f253a9fc6a7c3,0x253a260fa7a820a5,0xa7ff924822d7a73b
.quad 0x18b527faa7a8a0a5,0xa5cba584273ba2d7,0xa44826c2a513a62f,0x98b5a7fa27c31fc6,0xa77721c29a46a7f6,0x24eca64f24c4266d,0xa7b6a044238ba70e,0x27e29d79964827fe,0xa4eca64f270ea38b,0x26c22448a55f25ed,0x9248a7ff27f61a46,0x204427b6a7ea1cb2,0x249ba68a262f2513,0xa3322725a6dda41d,0x2799a10520a527a8,0xa77721c2a164a788
.quad 0x227ca750a21f2764,0x2332a725a2d7273b,0x2799a105a764221f,0x27e29d79a7c31fc6,0x26f623e3a764a21f,0x25cb2584a66da4c4,0x1f0327cea21fa764,0x9bd627f19648a7fe,0xa49b268a221fa764,0xa6f623e325eda55f,0xa7f11bd62764a21f,0xa750a27c27ea1cb2,0xa60fa53a2764221f,0x9f03a7ce241d26dd,0x9248a7ff221f2764,0x253aa60fa1642788
.quad 0x25cba584a21f2764,0x27fa18b5a7882164,0x27fa18b5a764221f,0x244826c2a6dda41d,0x24ec264fa764a21f,0xa1c227779cb2a7ea,0x9d7927e2a21fa764,0xa7b62044255fa5ed,0xa6c22448221fa764,0xa64fa4ec27fe1648,0xa7b6a0442764a21f,0x1248a7ff24c4266d,0xa332a7252764221f,0x268aa49b9fc627c3,0x21c2a777221f2764,0x27992105a73b22d7
.quad 0x2777a1c2a21f2764,0x21052799a73ba2d7,0x27252332a764221f,0xa49b268a9fc6a7c3,0x204427b6a764a21f,0xa7ff124824c4a66d,0xa44826c2a21fa764,0xa4eca64f27fe9648,0xa7e21d79221fa764,0x2044a7b6255f25ed,0xa64fa4ec2764a21f,0x2777a1c29cb227ea,0x98b5a7fa2764221f,0x26c22448a6dd241d,0x2584a5cb221f2764,0x18b527faa788a164
.quad 0x27ff1248a21f2764,0xa60f253aa164a788,0x253a260fa764221f,0xa7ce9f03241da6dd,0x9bd627f1a764a21f,0xa27ca75027ea9cb2,0xa68a249ba21fa764,0x23e3a6f625ed255f,0xa7ce9f03221fa764,0x27f19bd6964827fe,0xa3e3a6f62764a21f,0x258425cba66d24c4,0x2105a7992764221f,0x9d7927e2a7c39fc6,0x2750a27c221f2764,0xa7252332a2d7a73b
.quad 0x23e3a6f6a38b270e,0x2448a6c2a41d26dd,0x27ff9248a7f61a46,0x27f11bd6a7fe9648,0x244826c2a513a62f,0x21052799a2d7a73b,0xa332272520a5a7a8,0xa5cb258424c4a66d,0xa7fa18b527a8a0a5,0xa777a1c227ea1cb2,0xa49ba68a262f2513,0x98b5a7fa21642788,0x227ca7509a4627f6,0x26f6a3e3a55f25ed,0x27f19bd6a70e238b,0x268a249ba7c39fc6
.quad 0x24ec264fa70ea38b,0x9d7927e29fc6a7c3,0xa1c227779a46a7f6,0xa7b6204425eda55f,0xa7e21d79262fa513,0xa53aa60f27882164,0xa53aa60f27a820a5,0x227ca7501cb227ea,0x2105a79920a527a8,0x27ff9248a66d24c4,0x27ce9f03a513262f,0x23322725a73ba2d7,0x258425cba7f69a46,0xa4ec264f9648a7fe,0xa04427b6a38ba70e,0xa7ce9f0326dda41d
.quad 0xa7b62044238ba70e,0x9f03a7ce26dd241d,0xa5cba58427f69a46,0x264fa4ec964827fe,0x1f03a7ce2513262f,0x27252332a73b22d7,0x2799a105a0a527a8,0x924827ffa66da4c4,0x260f253aa7a820a5,0xa750227c1cb2a7ea,0x9d7927e2a62fa513,0xa60fa53a2788a164,0xa77721c21a46a7f6,0x2044a7b625ed255f,0xa64fa4ec270ea38b,0x27e29d799fc627c3
.quad 0x1bd6a7f1270e238b,0x249b268aa7c31fc6,0x2750a27c1a4627f6,0xa3e326f6a55fa5ed,0x268a249ba62f2513,0xa7fa98b52164a788,0x98b527faa7a8a0a5,0xa1c2a77727ea9cb2,0xa7252332a0a5a7a8,0x2584a5cb24c4266d,0xa6c2a4482513a62f,0x27992105a2d7273b,0x1248a7ff27f61a46,0x1bd627f1a7fe1648,0x26f6a3e3238b270e,0xa6c22448a41da6dd
.quad 0x249ba68aa47226a7,0x24eca64fa4c4266d,0x27b62044a7d99e3e,0x2750227ca788a164,0x18b527fa9e3ea7d9,0x9d7927e21648a7fe,0xa750227c26a7a472,0xa7fa18b527c39fc6,0xa584a5cb26a72472,0xa105a799241d26dd,0x2332a7259e3e27d9,0x26c2a448a55f25ed,0x27f11bd6a7d91e3e,0x25cb2584a73ba2d7,0x1f0327cea472a6a7,0xa3e326f61cb2a7ea
.quad 0xa6c224482472a6a7,0xa7b6a04427ea9cb2,0xa64fa4ec27d91e3e,0x1248a7ff22d7273b,0x2105a7991e3e27d9,0x27ce9f03a5ed255f,0x27ff9248a6a72472,0x23322725a6dda41d,0x21c22777a6a7a472,0xa60f253a1fc6a7c3,0xa60f253a1e3ea7d9,0xa68aa49b27fe9648,0xa6f6a3e327d99e3e,0x21c2a77721642788,0x1d79a7e2247226a7,0x27f11bd6a66d24c4
.quad 0x27e29d79a47226a7,0x1bd627f1a66da4c4,0x23e326f6a7d99e3e,0xa77721c22164a788,0xa53a260f9e3ea7d9,0xa49ba68a27fe1648,0xa777a1c226a7a472,0x253aa60f1fc627c3,0x1248a7ff26a72472,0x27252332a6dd241d,0x2799a1059e3e27d9,0x9f0327cea5eda55f,0x24ec264fa7d91e3e,0xa7ff124822d7a73b,0xa44826c2a472a6a7,0xa044a7b627ea1cb2
.quad 0xa7ce9f032472a6a7,0x26f6a3e31cb227ea,0x9bd6a7f127d91e3e,0x258425cba73b22d7,0x2725a3321e3e27d9,0xa44826c2a55fa5ed,0x25cb2584a6a72472,0xa799a105241da6dd,0xa27c2750a6a7a472,0x18b5a7fa27c31fc6,0xa7fa98b51e3ea7d9,0x27e29d79164827fe,0xa044a7b627d99e3e,0x227c2750a7882164,0x268aa49b247226a7,0xa64f24eca4c4a66d
.quad 0x253aa60fa513262f,0x2584a5cba55f25ed,0x26c22448a70ea38b,0x260f253aa66da4c4,0xa27c275020a5a7a8,0xa4ec264f241da6dd,0xa7b6a04427f61a46,0xa68aa49b273b22d7,0x1bd6a7f11a4627f6,0x2448a6c2a1642788,0x27ff9248a7a820a5,0x26f623e3a7c39fc6,0x1d7927e2a38ba70e,0xa33227251cb2a7ea,0xa7992105262fa513,0xa750a27c27fe1648
.quad 0xa332a725262f2513,0x21c2a777164827fe,0x268aa49ba38b270e,0x27992105a7ea1cb2,0x258425cba7a8a0a5,0xa04427b69fc6a7c3,0xa4ec264f1a46a7f6,0xa7ce9f032788a164,0xa6f6a3e327f69a46,0x1d79a7e222d7273b,0x21c2a77720a527a8,0x27f11bd6a6dd241d,0x27ce1f03a70e238b,0x98b527faa4c4a66d,0x98b527faa513a62f,0xa7ff924825eda55f
.quad 0xa7fa18b52513a62f,0x9248a7ff25ed255f,0x9f03a7ce270e238b,0x27fa98b5a4c4266d,0x2777a1c2a0a527a8,0x1bd627f1a6dda41d,0x23e326f6a7f69a46,0xa7e21d7922d7a73b,0xa64f24ec9a46a7f6,0x9f03a7ce27882164,0xa5cba58427a8a0a5,0x27b6a0449fc627c3,0x249ba68a238b270e,0x21052799a7ea9cb2,0x27252332a62f2513,0xa77721c21648a7fe
.quad 0xa1052799a62fa513,0xa27ca75027fe9648,0xa7e29d79238ba70e,0x2725a3321cb227ea,0x1248a7ff27a820a5,0x23e326f6a7c31fc6,0x27f19bd69a4627f6,0xa6c22448a164a788,0x204427b6a7f61a46,0xa49ba68a273ba2d7,0xa750227ca0a5a7a8,0x264fa4ec241d26dd,0xa448a6c2270ea38b,0x253a260fa66d24c4,0x260fa53a2513262f,0xa5cb2584a55fa5ed
.quad 0x25cba584a5a825a8,0x260fa53aa5ed255f,0x253a260fa5a8a5a8,0x244826c2a4c4a66d,0xa64f24ec25a8a5a8,0xa750227c26dda41d,0xa49ba68a25a825a8,0xa044a7b622d7273b,0x26c2a448a5a825a8,0x27f19bd6a7882164,0x23e326f6a5a8a5a8,0x924827ff9fc6a7c3,0xa725233225a8a5a8,0xa7e29d7927ea9cb2,0xa27ca75025a825a8,0x2105a799164827fe
.quad 0x2777a1c2a5a825a8,0x27252332a7fe9648,0x21052799a5a8a5a8,0xa49b268a1cb2a7ea,0xa7b6204425a8a5a8,0xa5cba58427c31fc6,0x9f03a7ce25a825a8,0x264fa4eca1642788,0x27e29d79a5a825a8,0x23e326f6a73ba2d7,0x1bd627f1a5a8a5a8,0xa77721c2241da6dd,0xa7fa18b525a8a5a8,0x9f03a7ce266d24c4,0x9248a7ff25a825a8,0x27fa98b5a55f25ed
.quad 0x27ff1248a5a825a8,0x98b527faa55fa5ed,0x98b527faa5a8a5a8,0xa7ce9f03266da4c4,0xa7f19bd625a8a5a8,0x21c2a777241d26dd,0x1d79a7e225a825a8,0x26f623e3a73b22d7,0x27ce1f03a5a825a8,0xa4ec264fa164a788,0xa04427b6a5a8a5a8,0xa584a5cb27c39fc6,0xa799a10525a8a5a8,0x268aa49b1cb227ea,0x21c2a77725a825a8,0x23322725a7fe1648
.quad 0x2750227ca5a825a8,0xa79921051648a7fe,0xa3322725a5a8a5a8,0x9d79a7e227ea1cb2,0xa6f6a3e325a8a5a8,0x27ff92489fc627c3,0x2448a6c225a825a8,0x9bd627f1a788a164,0x268a249ba5a825a8,0xa7b6a04422d7a73b,0xa4ec264fa5a8a5a8,0x227ca75026dd241d,0xa60fa53a25a8a5a8,0x26c22448a4c4266d,0x2584a5cb25a825a8,0xa53a260fa5eda55f
.quad 0x264fa4eca62f2513,0x268aa49ba66d24c4,0x227c2750a38ba70e,0x204427b6a164a788,0xa7e21d7927a8a0a5,0xa7fa98b527fe9648,0x18b5a7fa1a4627f6,0x227ca7509fc627c3,0x27992105a7f69a46,0x25cb2584a6dda41d,0xa44826c220a5a7a8,0xa725233225eda55f,0xa584a5cb270e238b,0x9bd6a7f122d7273b,0x26f6a3e3a513262f,0x27ce1f03a7ea1cb2
.quad 0x204427b6a513a62f,0xa44826c21cb2a7ea,0xa7ff1248270ea38b,0xa4eca64f273b22d7,0x1f03a7ce20a527a8,0x2799a105a55f25ed,0x27252332a7f61a46,0x924827ffa41da6dd,0xa53a260f1a46a7f6,0xa777a1c227c39fc6,0xa49ba68a27a820a5,0x253aa60f964827fe,0x2777a1c2a38b270e,0x23e326f6a788a164,0x1bd627f1a62fa513,0xa7e21d7924c4a66d
.quad 0xa7f19bd6262fa513,0x1d79a7e224c4266d,0x21c2a777238b270e,0x26f623e3a7882164,0x268a249ba7a820a5,0xa60f253a9648a7fe,0xa60f253a9a46a7f6,0xa1c2a77727c31fc6,0xa332a72527f61a46,0x27ff9248a41d26dd,0x27ce9f03a0a527a8,0xa1052799a55fa5ed,0x924827ffa70ea38b,0xa64fa4ec273ba2d7,0xa7b6a0442513a62f,0x26c2a4481cb227ea
.quad 0x23e3a6f62513262f,0x1f0327cea7ea9cb2,0x25cb2584a70e238b,0xa7f19bd622d7a73b,0xa6c22448a0a5a7a8,0x2332a72525ed255f,0xa105a79927f69a46,0x258425cba6dd241d,0x27fa98b59a4627f6,0xa750227c9fc6a7c3,0x9d7927e2a7a8a0a5,0x98b5a7fa27fe1648,0xa750a27c238ba70e,0x27b62044a1642788,0x24eca64f262f2513,0xa49b268aa66da4c4
.quad 0x26c2a448a6a72472,0x26f6a3e3a6dd241d,0x1bd627f19e3ea7d9,0x924827ff9648a7fe,0xa799a10527d91e3e,0xa6c2a448273b22d7,0x2584a5cba47226a7,0x2725a332a66d24c4,0x21c22777a472a6a7,0x98b527fa9cb2a7ea,0xa7fa98b527d99e3e,0xa68aa49b27882164,0x23e3a6f69e3e27d9,0x2750a27ca5ed255f,0x249b268aa6a7a472,0x9bd627f19fc6a7c3
.quad 0xa7e21d7926a7a472,0xa64fa4ec27c31fc6,0x2044a7b61e3e27d9,0x2777a1c2a55f25ed,0x260f253aa7d99e3e,0x9d7927e2a164a788,0xa750227c2472a6a7,0xa60fa53a27ea1cb2,0x1248a7ff247226a7,0x2799a105a4c4266d,0x27252332a7d91e3e,0x9f0327cea2d7a73b,0xa64f24ec1e3ea7d9,0xa5cba58427fe1648,0x9f03a7ce26a72472,0x27b6a044a41d26dd
.quad 0x27ce1f03a6a72472,0xa04427b6a41da6dd,0xa4ec264f9e3ea7d9,0xa584a5cb27fe9648,0xa332a72527d91e3e,0x27ce9f03a2d7273b,0x27ff9248a47226a7,0xa1052799a4c4a66d,0xa27c2750a472a6a7,0xa53aa60f27ea9cb2,0xa53aa60f27d99e3e,0x27e29d79a1642788,0x27b6a0449e3e27d9,0xa1c22777a55fa5ed,0x9d7927e2a6a7a472,0xa4eca64f27c39fc6
.quad 0xa68aa49b26a7a472,0x27f19bd69fc627c3,0x26f6a3e31e3e27d9,0xa27c2750a5eda55f,0x18b527faa7d99e3e,0xa49ba68a2788a164,0xa777a1c22472a6a7,0x27fa98b59cb227ea,0x25cba584247226a7,0xa3322725a66da4c4,0x21052799a7d91e3e,0xa448a6c2273ba2d7,0xa7f19bd61e3ea7d9,0x27ff9248964827fe,0x2448a6c226a72472,0xa3e326f6a6dda41d
.quad 0x2725a332a70e238b,0x2750a27ca73b22d7,0x9d7927e21a46a7f6,0xa10527991fc6a7c3,0xa584a5cb262f2513,0xa3e3a6f624c4266d,0x27f19bd6a7a820a5,0x27ce1f03a7fe9648,0xa3e326f620a5a7a8,0xa68a249b255fa5ed,0xa27ca7502513262f,0x1bd6a7f11cb227ea,0x27ce1f03a7f61a46,0x253a260fa6dda41d,0xa60f253a238ba70e,0xa7ff92482788a164
.quad 0x98b5a7fa238b270e,0x2584a5cba1642788,0x26c22448a7f69a46,0x18b527faa41da6dd,0xa77721c22513a62f,0xa64fa4ec27ea1cb2,0x2044a7b620a527a8,0x27e29d79a5ed255f,0x24ec264fa7a8a0a5,0xa44826c29648a7fe,0xa7ff1248262fa513,0xa044a7b6266d24c4,0x249ba68a1a4627f6,0x27252332a7c31fc6,0x21052799a70ea38b,0xa77721c222d7a73b
.quad 0xa799a105270ea38b,0x21c2a77722d7273b,0x268aa49b9a4627f6,0x23322725a7c39fc6,0x924827ffa62fa513,0xa7b6a044266da4c4,0xa64fa4ec27a8a0a5,0x26c2a448964827fe,0x27b6a044a0a527a8,0x9d7927e2a5eda55f,0xa1c22777a513a62f,0xa4eca64f27ea9cb2,0xa448a6c227f69a46,0x27fa18b5a41d26dd,0x27fa18b5a38b270e,0xa5cb2584a164a788
.quad 0xa53a260fa38ba70e,0x9248a7ff27882164,0x9f03a7ce27f61a46,0x260f253aa6dd241d,0x2750227ca513262f,0xa7f11bd61cb2a7ea,0xa6f623e3a0a5a7a8,0x249ba68a255f25ed,0x1bd6a7f127a820a5,0x1f0327cea7fe1648,0x25cb2584a62f2513,0xa6f6a3e324c4a66d,0xa7e21d799a46a7f6,0x2799a1051fc627c3,0x2332a725270e238b,0xa27c2750a73ba2d7
.quad 0x2777a1c2a764221f,0x2799a105a7882164,0xa3322725221fa764,0xa49b268a241da6dd,0xa044a7b6221f2764,0x9248a7ff1cb227ea,0x26c22448a764a21f,0x24ec264fa5eda55f,0xa7e21d792764a21f,0xa7b6a04427fe1648,0x24eca64fa21f2764,0x2777a1c2a66d24c4,0x18b527faa21fa764,0xa44826c21fc6a7c3,0xa5cba5842764221f,0x98b5a7fa22d7273b
.quad 0x27ff1248a764221f,0x253a260fa73ba2d7,0xa60f253a221fa764,0xa7ce9f0327c39fc6,0x1bd6a7f1221f2764,0x2750a27ca4c4266d,0x249b268aa764a21f,0xa3e326f69648a7fe,0xa7ce9f032764a21f,0x9bd6a7f1255f25ed,0x26f6a3e3a21f2764,0x258425cba7ea9cb2,0xa1052799a21fa764,0xa7e29d7926dda41d,0xa27ca7502764221f,0x2725a332a1642788
.quad 0x2750227ca764221f,0xa3322725a164a788,0xa7992105221fa764,0x9d79a7e226dd241d,0x23e3a6f6221f2764,0x25cb2584a7ea1cb2,0x1f0327cea764a21f,0xa7f19bd6255fa5ed,0xa68aa49b2764a21f,0x26f6a3e3964827fe,0x27f19bd6a21f2764,0xa27c2750a4c4a66d,0xa53a260fa21fa764,0x9f03a7ce27c31fc6,0x9248a7ff2764221f,0x260f253aa73b22d7
.quad 0x258425cba764221f,0xa7fa98b522d7a73b,0xa7fa98b5221fa764,0x26c2a4481fc627c3,0x264fa4ec221f2764,0xa1c22777a66da4c4,0x9d7927e2a764a21f,0xa044a7b627fe9648,0xa448a6c22764a21f,0x264f24eca5ed255f,0x27b62044a21f2764,0xa7ff92481cb2a7ea,0xa7252332a21fa764,0x268aa49b241d26dd,0x21c2a7772764221f,0xa1052799a788a164
.quad 0x27b6a044a7a820a5,0x27ce9f03a7c31fc6,0xa58425cb2513a62f,0xa64f24ec25eda55f,0x1f03a7ce9a4627f6,0x2332a725a1642788,0x21052799a38ba70e,0x924827ff9cb2a7ea,0xa60fa53a270e238b,0xa27ca75024c4266d,0x27e21d79a7f61a46,0x260f253aa73ba2d7,0xa77721c2262fa513,0xa7b6a04427fe9648,0x24eca64fa0a527a8,0x27e29d79a6dd241d
.quad 0x9bd627f1a0a5a7a8,0xa68a249b241da6dd,0xa27ca750262f2513,0x23e3a6f6964827fe,0x268a249ba7f69a46,0x98b527faa2d7a73b,0xa7fa98b5270ea38b,0xa1c2a777266d24c4,0x2725a332a38b270e,0x25cb2584a7ea9cb2,0xa44826c29a46a7f6,0xa799a1052788a164,0x1248a7ff2513262f,0x27f19bd6a55f25ed,0x23e326f6a7a8a0a5,0xa6c224481fc6a7c3
.quad 0xa6f6a3e327a8a0a5,0x2448a6c21fc627c3,0x27ff9248a513262f,0x9bd627f1a55fa5ed,0xa6c224481a46a7f6,0xa105a79927882164,0x2332a725238b270e,0x258425cba7ea1cb2,0x18b527faa70ea38b,0xa777a1c2266da4c4,0xa49ba68a27f69a46,0x27fa98b5a2d7273b,0x2750227ca62f2513,0xa6f623e39648a7fe,0xa7f11bd620a5a7a8,0x249ba68a241d26dd
.quad 0x264fa4ec20a527a8,0x9d7927e2a6dda41d,0xa1c22777a62fa513,0xa044a7b627fe1648,0x9d79a7e227f61a46,0x253a260fa73b22d7,0x253a260fa70e238b,0xa750a27c24c4a66d,0xa799a105238ba70e,0x27ff92489cb227ea,0x27ce9f031a4627f6,0xa7252332a164a788,0xa5cb2584a513a62f,0x24eca64f25ed255f,0x2044a7b627a820a5,0x9f0327cea7c39fc6
.quad 0x27e29d79a7d91e3e,0x27f19bd6a7ea1cb2,0xa6f623e326a7a472,0xa77721c2273ba2d7,0x253aa60fa47226a7,0x268aa49ba5ed255f,0xa1c227771e3ea7d9,0xa53a260f241da6dd,0x1248a7ff1e3e27d9,0x2332a7259fc627c3,0x21052799a472a6a7,0x9f0327ce9648a7fe,0xa4eca64f26a72472,0x9248a7ff21642788,0x26c22448a7d99e3e,0x204427b6a4c4a66d
.quad 0xa7ce9f0327d99e3e,0xa3e3a6f6266d24c4,0x27f19bd6a6a72472,0x258425cba788a164,0xa72523322472a6a7,0xa6c2a44827fe1648,0x2584a5cb9e3e27d9,0x27992105a7c31fc6,0xa27c27509e3ea7d9,0xa7fa98b526dda41d,0x18b5a7fa247226a7,0x27e29d79a55f25ed,0x204427b6a6a7a472,0xa750227c22d7a73b,0xa49ba68a27d91e3e,0x264fa4ec9cb227ea
.quad 0x268a249ba7d91e3e,0xa4ec264f9cb2a7ea,0xa7b6a04426a7a472,0x227ca75022d7273b,0x27fa98b5a47226a7,0x9d7927e2a55fa5ed,0xa750227c1e3ea7d9,0x98b5a7fa26dd241d,0x25cba5841e3e27d9,0x21052799a7c39fc6,0xa3322725a472a6a7,0xa448a6c227fe9648,0x1bd6a7f126a72472,0x25cb2584a7882164,0x1f0327cea7d99e3e,0xa6f6a3e3266da4c4
.quad 0xa448a6c227d99e3e,0x27b62044a4c4266d,0x264f24eca6a72472,0xa7ff92482164a788,0xa799a1052472a6a7,0x27ce9f03964827fe,0x27ff92489e3e27d9,0xa72523329fc6a7c3,0xa77721c29e3ea7d9,0x260fa53a241d26dd,0x260fa53a247226a7,0xa49b268aa5eda55f,0xa3e326f6a6a7a472,0x21c2a777273b22d7,0x1d79a7e227d91e3e,0x9bd627f1a7ea9cb2
.quad 0x27fa98b5a7f61a46,0x27ff9248a7fe1648,0xa7ce1f0327a8a0a5,0xa7fa18b527ea9cb2,0x2777a1c2a70e238b,0x27f19bd6a7c31fc6,0xa6f623e3262fa513,0xa7e21d792788a164,0x264fa4eca513262f,0x27ce9f03a73b22d7,0xa58425cb238ba70e,0xa7b6204426dda41d,0x249ba68aa0a527a8,0x2799a105a66d24c4,0xa33227251a46a7f6,0xa77721c225eda55f
.quad 0x2105a7991a4627f6,0x2750a27ca55f25ed,0x9d7927e2a0a5a7a8,0xa725233224c4a66d,0x1248a7ff238b270e,0x26f6a3e3a41d26dd,0x1bd627f1a513a62f,0xa6c2244822d7a73b,0xa044a7b6262f2513,0x268aa49ba1642788,0x227c2750a70ea38b,0xa64f24ec1fc6a7c3,0xa448a6c227a820a5,0x260fa53a9cb227ea,0x253a260fa7f69a46,0xa5cb25841648a7fe
.quad 0xa60fa53a27f69a46,0x2584a5cb164827fe,0x26c22448a7a820a5,0xa53a260f9cb2a7ea,0xa750a27c270ea38b,0x24eca64f1fc627c3,0x27b62044a62f2513,0xa49b268aa164a788,0xa7f19bd62513a62f,0x2448a6c222d7273b,0x27ff9248a38b270e,0xa3e326f6a41da6dd,0xa7e21d7920a5a7a8,0x2332a72524c4266d,0x2799a1059a4627f6,0xa27c2750a55fa5ed
.quad 0xa72523329a46a7f6,0x21c2a77725ed255f,0x268aa49b20a527a8,0xa1052799a66da4c4,0xa5cb2584a38ba70e,0x2044a7b626dd241d,0x24eca64f2513262f,0x9f0327cea73ba2d7,0xa3e326f6a62fa513,0x1d79a7e227882164,0x21c2a777270e238b,0x9bd627f1a7c39fc6,0x9f0327cea7a8a0a5,0x18b5a7fa27ea1cb2,0x18b5a7fa27f61a46,0x924827ffa7fe9648
.quad 0x27ff1248a8002800,0xa7fa98b51648a7fe,0x27fa18b528002800,0xa7ce9f031cb2a7ea,0x27f11bd6a8002800,0xa777a1c21fc6a7c3,0x27e21d7928002800,0xa6f6a3e32164a788,0x27ce1f03a8002800,0xa64fa4ec22d7a73b,0x27b6204428002800,0xa584a5cb241da6dd,0x27992105a8002800,0xa49ba68a24c4a66d,0x277721c228002800,0xa332a725255fa5ed
.quad 0x2750227ca8002800,0xa105a79925eda55f,0x2725233228002800,0x9d79a7e2266da4c4,0x26f623e3a8002800,0x9248a7ff26dda41d,0x26c2244828002800,0x1bd6a7f1273ba2d7,0x268a249ba8002800,0x2044a7b62788a164,0x264f24ec28002800,0x227ca75027c39fc6,0x260f253aa8002800,0x2448a6c227ea9cb2,0x25cb258428002800,0x253aa60f27fe9648
.quad 0x258425cba8002800,0x260fa53a27fe1648,0x253a260f28002800,0x26c2a44827ea1cb2,0x24ec264fa8002800,0x2750a27c27c31fc6,0x249b268a28002800,0x27b6a04427882164,0x244826c2a8002800,0x27f19bd6273b22d7,0x23e326f628002800,0x27ff124826dd241d,0x23322725a8002800,0x27e21d79266d24c4,0x227c275028002800,0x2799210525ed255f
.quad 0x21c22777a8002800,0x27252332255f25ed,0x2105279928002800,0x268a249b24c4266d,0x204427b6a8002800,0x25cb2584241d26dd,0x1f0327ce28002800,0x24ec264f22d7273b,0x1d7927e2a8002800,0x23e326f621642788,0x1bd627f128002800,0x21c227771fc627c3,0x18b527faa8002800,0x1f0327ce1cb227ea,0x124827ff28002800,0x18b527fa164827fe
.quad 0x27f11bd69a4627f6,0xa7e29d791cb2a7ea,0x277721c2a0a527a8,0xa6f6a3e322d7a73b,0x268a249ba38b270e,0xa53aa60f255fa5ed,0x253a260fa513262f,0xa1c2a77726dda41d,0x23322725a62f2513,0x9248a7ff27c39fc6,0x1f0327cea70e238b,0x2105a79927fe1648,0x924827ffa7a820a5,0x24eca64f27882164,0xa04427b6a7f61a46,0x26c2a448266d24c4
.quad 0xa3e326f6a7f69a46,0x27ce9f0324c4266d,0xa58425cba7a8a0a5,0x27f11bd621642788,0xa6c22448a70ea38b,0x27252332164827fe,0xa7992105a62fa513,0x258425cb9fc627c3,0xa7fa18b5a513a62f,0x227c2750a41d26dd,0xa7e29d79a38ba70e,0x18b527faa5ed255f,0xa750a27ca0a5a7a8,0xa04427b6a73b22d7,0xa64fa4ec9a46a7f6,0xa49b268aa7ea1cb2
.quad 0xa4eca64f1a46a7f6,0xa68a249ba7ea9cb2,0xa27ca75020a5a7a8,0xa7b62044a73ba2d7,0x9d79a7e2238ba70e,0xa7fa98b5a5eda55f,0x18b5a7fa2513a62f,0xa750a27ca41da6dd,0x2105a799262fa513,0xa5cba5849fc6a7c3,0x2448a6c2270ea38b,0xa332a7251648a7fe,0x25cba58427a8a0a5,0x9bd6a7f12164a788,0x26f6a3e327f69a46,0x1f03a7ce24c4a66d
.quad 0x27b6a04427f61a46,0x2448a6c2266da4c4,0x27ff924827a820a5,0x264fa4ec2788a164,0x27ce1f03270e238b,0x2799a10527fe9648,0x27252332262f2513,0x27ff124827c31fc6,0x260f253a2513262f,0x277721c226dd241d,0x249b268a238b270e,0x260f253a255f25ed,0x21c2277720a527a8,0x23e326f622d7273b,0x1bd627f11a4627f6,0x1d7927e21cb227ea
.quad 0x27ce1f039e3e27d9,0xa7b6a0441fc6a7c3,0x264f24eca47226a7,0xa584a5cb255fa5ed,0x23322725a6a72472,0x9f03a7ce2788a164,0x124827ffa7d91e3e,0x2105a79927ea1cb2,0xa27c2750a7d99e3e,0x260fa53a266d24c4,0xa60f253aa6a7a472,0x27e29d7922d7273b,0xa7b62044a472a6a7,0x277721c2964827fe,0xa7e29d799e3ea7d9,0x24ec264fa41d26dd
.quad 0xa68aa49b1e3ea7d9,0x1bd627f1a6dd241d,0xa3e3a6f62472a6a7,0xa27c2750a7fe1648,0x98b5a7fa26a7a472,0xa68a249ba73ba2d7,0x21c2a77727d99e3e,0xa7fa18b5a4c4a66d,0x25cba58427d91e3e,0xa725a3329cb2a7ea,0x2799a10526a72472,0xa448a6c22164a788,0x27f11bd6247226a7,0x9248a7ff25eda55f,0x26c224481e3e27d9,0x23e3a6f627c39fc6
.quad 0x244826c29e3e27d9,0x26f6a3e327c31fc6,0x1bd627f1a47226a7,0x27ff124825ed255f,0xa1052799a6a72472,0x26c2244821642788,0xa58425cba7d91e3e,0x233227259cb227ea,0xa77721c2a7d99e3e,0x98b527faa4c4266d,0xa7fa98b5a6a7a472,0xa49b268aa73b22d7,0xa6f6a3e3a472a6a7,0xa750227ca7fe9648,0xa49ba68a9e3ea7d9,0xa7f19bd6a6dda41d
.quad 0x9d79a7e21e3ea7d9,0xa64fa4eca41da6dd,0x2044a7b62472a6a7,0xa1c2a7779648a7fe,0x253aa60f26a7a472,0x1d79a7e222d7a73b,0x2750a27c27d99e3e,0x253aa60f266da4c4,0x27ff124827d91e3e,0x2799a10527ea9cb2,0x2725233226a72472,0x27ce1f0327882164,0x24ec264f247226a7,0x25cb2584255f25ed,0x1f0327ce1e3e27d9,0x204427b61fc627c3
.quad 0x27992105a0a527a8,0xa777a1c22164a788,0x249b268aa62f2513,0xa332a72526dda41d,0x924827ffa7f61a46,0x2044a7b627ea1cb2,0xa4ec264fa70ea38b,0x26c2a448255f25ed,0xa7b62044a38ba70e,0x27e21d79164827fe,0xa777a1c21a46a7f6,0x24ec264fa4c4266d,0xa448a6c22513a62f,0x98b527faa7c31fc6,0x18b5a7fa27a8a0a5,0xa5cb2584a73ba2d7
.quad 0x253aa60f27a820a5,0xa7ff1248a2d7a73b,0x27ce9f032513262f,0xa60fa53a1fc6a7c3,0x2750227c1a4627f6,0x9bd6a7f1266da4c4,0x23e326f6a38b270e,0x249ba68a27fe1648,0x9bd627f1a70e238b,0x27ce9f0325ed255f,0xa58425cba7f69a46,0x26f623e31cb227ea,0xa7e21d79a62fa513,0x21052799a41d26dd,0xa725a332a0a5a7a8,0xa27c2750a7882164
.quad 0xa332a72520a5a7a8,0xa750227ca788a164,0x1d79a7e2262fa513,0xa799a105a41da6dd,0x25cba58427f69a46,0xa3e3a6f61cb2a7ea,0x27f19bd6270e238b,0x1f03a7ce25eda55f,0x26f623e3238b270e,0x268aa49b27fe9648,0x227c27509a4627f6,0x27f11bd6266d24c4,0x9f0327cea513262f,0x253a260f1fc627c3,0xa60f253aa7a820a5,0x924827ffa2d7273b
.quad 0xa7fa18b5a7a8a0a5,0xa58425cba73b22d7,0xa6c2a448a513a62f,0xa7fa18b5a7c39fc6,0xa1c2a7779a46a7f6,0xa64fa4eca4c4a66d,0x2044a7b6238ba70e,0x9d79a7e21648a7fe,0x264fa4ec270ea38b,0x2448a6c2255fa5ed,0x27ff924827f61a46,0x27b6a04427ea9cb2,0x268a249b262f2513,0x2725233226dd241d,0x2105279920a527a8,0x21c2277721642788
.quad 0x2750227ca21f2764,0xa725a33222d7a73b,0x21052799a764221f,0x9d79a7e227c39fc6,0xa3e326f6a764a21f,0x2584a5cb266d24c4,0xa7ce1f03a21fa764,0x27f11bd6164827fe,0xa68aa49b221fa764,0x23e326f6a5ed255f,0x9bd6a7f12764a21f,0xa27c2750a7ea9cb2,0x253aa60f2764221f,0xa7ce1f03a41da6dd,0x27ff9248221f2764,0xa60fa53a2164a788
.quad 0x258425cba21f2764,0x18b5a7fa2788a164,0x98b527faa764221f,0x26c2a44826dd241d,0xa64f24eca764a21f,0x277721c21cb227ea,0xa7e29d79a21fa764,0x204427b6a55f25ed,0xa448a6c2221fa764,0xa4ec264fa7fe9648,0x2044a7b62764a21f,0xa7ff9248a4c4a66d,0x2725a3322764221f,0xa49ba68a1fc6a7c3,0x277721c2221f2764,0x2105a799273ba2d7
.quad 0x21c22777a21f2764,0x2799a105273b22d7,0xa3322725a764221f,0x268a249b1fc627c3,0xa7b62044a764a21f,0x124827ffa4c4266d,0xa6c2a448a21fa764,0xa64f24eca7fe1648,0x9d79a7e2221fa764,0xa7b6a044a55fa5ed,0x24eca64f2764a21f,0xa1c2a7771cb2a7ea,0x27fa98b52764221f,0x2448a6c226dda41d,0x25cb2584221f2764,0x27fa98b527882164
.quad 0x924827ffa21f2764,0x253a260f21642788,0xa60f253aa764221f,0x9f0327cea41d26dd,0xa7f19bd6a764a21f,0xa750227ca7ea1cb2,0xa49ba68aa21fa764,0xa6f6a3e3a5eda55f,0x1f03a7ce221fa764,0x9bd6a7f11648a7fe,0x26f6a3e32764a21f,0x25cba584266da4c4,0x279921052764221f,0x27e21d7927c31fc6,0x227c2750221f2764,0x2332272522d7273b
.quad 0x26f623e3a38b270e,0xa6c2a448241da6dd,0x124827ffa7f61a46,0x1bd6a7f127fe1648,0xa6c22448a513a62f,0x2799a10522d7273b,0xa725a33220a5a7a8,0x258425cba4c4266d,0x98b5a7fa27a8a0a5,0xa1c22777a7ea9cb2,0x268aa49b262f2513,0xa7fa18b5a164a788,0x2750227c9a4627f6,0xa3e3a6f6255fa5ed,0x1bd627f1a70e238b,0x249ba68a27c31fc6
.quad 0xa64f24eca70ea38b,0x27e21d791fc627c3,0xa777a1c29a46a7f6,0x204427b6a5ed255f,0x9d79a7e2262fa513,0xa60f253aa788a164,0x260fa53a27a820a5,0xa750a27c9cb2a7ea,0x2799210520a527a8,0x9248a7ff266da4c4,0x1f0327cea513262f,0x2725a332273b22d7,0xa5cb2584a7f69a46,0x264f24ec164827fe,0xa7b6a044a38ba70e,0x9f0327cea6dd241d
.quad 0xa044a7b6238ba70e,0xa7ce1f03a6dda41d,0x2584a5cb27f69a46,0xa4eca64f1648a7fe,0x27ce1f032513262f,0x2332a725273ba2d7,0x21052799a0a527a8,0x27ff1248266d24c4,0xa53a260fa7a820a5,0x227c27509cb227ea,0xa7e29d79a62fa513,0xa53a260fa7882164,0xa1c2a7771a46a7f6,0xa7b6a044a5eda55f,0x24eca64f270ea38b,0x9d79a7e21fc6a7c3
.quad 0x27f11bd6270e238b,0x268aa49b27c39fc6,0x227c27501a4627f6,0x26f623e3255f25ed,0xa49b268aa62f2513,0x98b527faa1642788,0xa7fa98b5a7a8a0a5,0xa77721c2a7ea1cb2,0xa332a725a0a5a7a8,0xa5cba584a4c4a66d,0x2448a6c22513a62f,0x2105a79922d7a73b,0x27ff124827f61a46,0x27f19bd627fe9648,0x23e326f6238b270e,0x244826c2241d26dd
.quad 0x268a249ba47226a7,0xa64fa4ec24c4a66d,0xa04427b6a7d99e3e,0x227ca75027882164,0xa7fa18b59e3ea7d9,0x27e21d79964827fe,0xa27ca75026a7a472,0x18b527faa7c31fc6,0x25cba58426a72472,0xa7992105a41da6dd,0x272523329e3e27d9,0xa448a6c2255fa5ed,0x9bd627f1a7d91e3e,0x2584a5cb273b22d7,0xa7ce1f03a472a6a7,0x26f623e39cb227ea
.quad 0xa448a6c22472a6a7,0xa04427b6a7ea1cb2,0x24eca64f27d91e3e,0xa7ff9248a2d7a73b,0x279921051e3e27d9,0x9f03a7ce25eda55f,0x124827ffa6a72472,0x2725a33226dd241d,0xa77721c2a6a7a472,0x253a260f9fc627c3,0xa53aa60f1e3ea7d9,0xa49b268aa7fe1648,0x23e3a6f627d99e3e,0xa777a1c2a164a788,0x27e21d79247226a7,0x1bd6a7f1266da4c4
.quad 0x1d7927e2a47226a7,0x27f19bd6266d24c4,0xa6f623e3a7d99e3e,0x21c22777a1642788,0xa60fa53a9e3ea7d9,0xa68a249ba7fe9648,0x21c2a77726a7a472,0xa60fa53a9fc6a7c3,0x27ff124826a72472,0x2332a72526dda41d,0x210527999e3e27d9,0x27ce1f0325ed255f,0xa64f24eca7d91e3e,0x124827ffa2d7273b,0xa6c2a448a472a6a7,0xa7b62044a7ea9cb2
.quad 0x1f03a7ce2472a6a7,0xa3e3a6f69cb2a7ea,0x27f19bd627d91e3e,0x25cba584273ba2d7,0x233227251e3e27d9,0x26c22448255f25ed,0xa58425cba6a72472,0xa1052799a41d26dd,0xa750a27ca6a7a472,0xa7fa98b5a7c39fc6,0x18b5a7fa1e3ea7d9,0x9d79a7e29648a7fe,0x27b6a04427d99e3e,0x2750a27c2788a164,0x249b268a247226a7,0x24ec264f24c4266d
.quad 0x260f253aa513262f,0xa5cba584255fa5ed,0xa44826c2a70ea38b,0x253aa60f266d24c4,0xa750a27c20a5a7a8,0x264f24eca41d26dd,0x2044a7b627f61a46,0xa49b268aa73ba2d7,0x27f11bd61a4627f6,0xa6c2a4482164a788,0x124827ffa7a820a5,0x23e3a6f627c31fc6,0xa7e21d79a38ba70e,0x272523329cb227ea,0xa105a799262fa513,0xa27c2750a7fe9648
.quad 0x2725a332262f2513,0xa777a1c29648a7fe,0x249b268aa38b270e,0x2105a79927ea9cb2,0xa5cb2584a7a8a0a5,0x27b620441fc627c3,0xa64fa4ec1a46a7f6,0x9f0327cea7882164,0x23e3a6f627f69a46,0xa7e29d79a2d7a73b,0x277721c220a527a8,0x1bd6a7f126dda41d,0x9f0327cea70e238b,0x27fa18b524c4266d,0xa7fa98b5a513a62f,0x924827ffa5ed255f
.quad 0x98b5a7fa2513a62f,0xa7ff1248a5eda55f,0x27ce9f03270e238b,0x98b5a7fa24c4a66d,0x21c22777a0a527a8,0x27f19bd626dd241d,0xa6f623e3a7f69a46,0x1d7927e2a2d7273b,0xa4eca64f9a46a7f6,0xa7ce1f03a788a164,0x2584a5cb27a8a0a5,0xa044a7b61fc6a7c3,0x268a249b238b270e,0x2799a10527ea1cb2,0xa3322725a62f2513,0x21c22777964827fe
.quad 0xa799a105a62fa513,0xa750227ca7fe1648,0x1d79a7e2238ba70e,0xa332a7259cb2a7ea,0x27ff124827a820a5,0x26f6a3e327c39fc6,0x1bd627f19a4627f6,0x244826c221642788,0xa7b62044a7f61a46,0xa68a249ba73b22d7,0xa27ca750a0a5a7a8,0xa4eca64fa41da6dd,0x26c2a448270ea38b,0x260fa53a266da4c4,0x253a260f2513262f,0x258425cb255f25ed
.quad 0x258425cba5a825a8,0xa53aa60f25eda55f,0xa60f253aa5a8a5a8,0x26c2a44824c4266d,0xa4eca64f25a8a5a8,0x227c2750a6dd241d,0x268aa49b25a825a8,0xa7b62044a2d7a73b,0x244826c2a5a825a8,0x9bd6a7f12788a164,0xa6f623e3a5a8a5a8,0x27ff12481fc627c3,0xa332a72525a8a5a8,0x9d7927e2a7ea1cb2,0x2750a27c25a825a8,0xa799a1059648a7fe
.quad 0x21c22777a5a825a8,0x2332a72527fe1648,0xa7992105a5a8a5a8,0x268a249b9cb227ea,0xa044a7b625a8a5a8,0xa58425cba7c39fc6,0x27ce9f0325a825a8,0xa4eca64f2164a788,0x1d7927e2a5a825a8,0x26f6a3e3273b22d7,0xa7f11bd6a5a8a5a8,0x21c22777a41d26dd,0x98b5a7fa25a8a5a8,0xa7ce1f03a66da4c4,0x27ff924825a825a8,0x98b5a7fa255fa5ed
.quad 0x924827ffa5a825a8,0x27fa18b5255f25ed,0xa7fa98b5a5a8a5a8,0x9f0327cea66d24c4,0x1bd6a7f125a8a5a8,0xa777a1c2a41da6dd,0x27e21d7925a825a8,0x23e3a6f6273ba2d7,0x9f0327cea5a825a8,0x264f24ec21642788,0xa7b6a044a5a8a5a8,0xa5cb2584a7c31fc6,0x2105a79925a8a5a8,0xa49ba68a9cb2a7ea,0x277721c225a825a8,0x2725a33227fe9648
.quad 0xa27c2750a5a825a8,0x21052799964827fe,0xa725a332a5a8a5a8,0xa7e21d79a7ea9cb2,0x23e3a6f625a8a5a8,0x9248a7ff1fc6a7c3,0x26c2244825a825a8,0x27f11bd627882164,0xa49b268aa5a825a8,0xa04427b6a2d7273b,0xa64fa4eca5a8a5a8,0xa750a27ca6dda41d,0x253aa60f25a8a5a8,0x2448a6c224c4a66d,0x25cb258425a825a8,0x260f253a25ed255f
.quad 0x24ec264fa62f2513,0xa49ba68a266da4c4,0xa750227ca38ba70e,0x27b6a04421642788,0x9d79a7e227a8a0a5,0x98b527faa7fe1648,0x27fa18b51a4627f6,0xa750a27c1fc6a7c3,0xa1052799a7f69a46,0x2584a5cb26dd241d,0xa6c2a44820a5a7a8,0x23322725a5ed255f,0x25cba584270e238b,0xa7f11bd6a2d7a73b,0x23e326f6a513262f,0x1f03a7ce27ea9cb2
.quad 0xa7b62044a513a62f,0x26c224489cb227ea,0x9248a7ff270ea38b,0xa64f24eca73ba2d7,0x27ce1f0320a527a8,0xa105a799255fa5ed,0xa3322725a7f61a46,0x27ff1248241d26dd,0xa60fa53a1a46a7f6,0xa1c22777a7c31fc6,0x268aa49b27a820a5,0xa60fa53a1648a7fe,0x21c22777a38b270e,0x26f6a3e327882164,0xa7f11bd6a62fa513,0x1d7927e2a4c4266d
.quad 0x1bd6a7f1262fa513,0xa7e29d79a4c4a66d,0x277721c2238b270e,0x23e3a6f62788a164,0xa49b268aa7a820a5,0x253a260f164827fe,0xa53aa60f9a46a7f6,0xa77721c2a7c39fc6,0x2725a33227f61a46,0x9248a7ff241da6dd,0x1f0327cea0a527a8,0x27992105255f25ed,0xa7ff9248a70ea38b,0xa4ec264fa73b22d7,0x2044a7b62513a62f,0xa448a6c29cb2a7ea
.quad 0x26f623e32513262f,0x27ce9f0327ea1cb2,0xa58425cba70e238b,0x9bd627f1a2d7273b,0xa448a6c2a0a5a7a8,0xa725a332a5eda55f,0x2799a10527f69a46,0x25cba58426dda41d,0x18b527fa9a4627f6,0x227c27501fc627c3,0xa7e29d79a7a8a0a5,0xa7fa18b5a7fe9648,0x227ca750238ba70e,0x2044a7b62164a788,0x264f24ec262f2513,0x268a249b266d24c4
.quad 0x244826c2a6a72472,0xa3e3a6f626dda41d,0xa7f11bd69e3ea7d9,0x27ff1248164827fe,0x2105a79927d91e3e,0xa44826c2a73ba2d7,0x25cb2584a47226a7,0xa332a725266da4c4,0xa77721c2a472a6a7,0x27fa18b51cb227ea,0x18b5a7fa27d99e3e,0xa49b268aa788a164,0x26f623e39e3e27d9,0xa27ca75025eda55f,0xa68a249ba6a7a472,0x27f11bd61fc627c3
.quad 0x9d79a7e226a7a472,0xa4ec264fa7c39fc6,0x27b620441e3e27d9,0xa1c2a777255fa5ed,0xa53a260fa7d99e3e,0x27e21d7921642788,0xa27ca7502472a6a7,0xa53a260fa7ea9cb2,0x27ff1248247226a7,0xa105a79924c4a66d,0xa3322725a7d91e3e,0x27ce1f0322d7273b,0xa4eca64f1e3ea7d9,0xa58425cba7fe9648,0x27ce9f0326a72472,0xa044a7b6241da6dd
.quad 0x9f0327cea6a72472,0x27b62044241d26dd,0xa64fa4ec9e3ea7d9,0xa5cb2584a7fe1648,0x2725a33227d91e3e,0x9f03a7ce22d7a73b,0x124827ffa47226a7,0x2799210524c4266d,0xa750a27ca472a6a7,0xa60f253aa7ea1cb2,0x260fa53a27d99e3e,0x9d79a7e22164a788,0x204427b69e3e27d9,0x277721c2255f25ed,0xa7e29d79a6a7a472,0xa64f24eca7c31fc6
.quad 0x249ba68a26a7a472,0x9bd6a7f11fc6a7c3,0x23e326f61e3e27d9,0x2750227c25ed255f,0xa7fa18b5a7d99e3e,0xa68a249ba7882164,0x21c2a7772472a6a7,0x98b5a7fa1cb2a7ea,0x258425cb247226a7,0x27252332266d24c4,0xa7992105a7d91e3e,0xa6c22448a73b22d7,0x1bd6a7f11e3ea7d9,0x9248a7ff1648a7fe,0x26c2244826a72472,0x26f623e326dd241d
.quad 0x23322725a70e238b,0xa27ca750273ba2d7,0xa7e29d791a46a7f6,0x279921059fc627c3,0x25cba584262f2513,0xa6f623e3a4c4a66d,0x1bd627f1a7a820a5,0x1f03a7ce27fe1648,0xa6f6a3e320a5a7a8,0x249b268aa55f25ed,0x2750a27c2513262f,0xa7f19bd69cb2a7ea,0x9f0327cea7f61a46,0x260fa53a26dd241d,0xa53aa60f238ba70e,0x924827ffa7882164
.quad 0x27fa98b5238b270e,0xa5cba5842164a788,0xa44826c2a7f69a46,0x27fa98b5241d26dd,0xa1c2a7772513a62f,0xa4ec264fa7ea9cb2,0x27b6204420a527a8,0x9d79a7e225eda55f,0xa64f24eca7a8a0a5,0x26c22448164827fe,0x9248a7ff262fa513,0xa7b62044a66da4c4,0x268a249b1a4627f6,0x2332a72527c39fc6,0xa7992105a70ea38b,0x21c22777a2d7273b
.quad 0x2105a799270ea38b,0xa777a1c2a2d7a73b,0x249b268a9a4627f6,0x2725a33227c31fc6,0xa7ff9248a62fa513,0xa04427b6a66d24c4,0x24eca64f27a8a0a5,0xa448a6c21648a7fe,0x204427b6a0a527a8,0x27e21d7925ed255f,0xa777a1c2a513a62f,0xa64f24eca7ea1cb2,0x26c2a44827f69a46,0x18b5a7fa241da6dd,0x98b527faa38b270e,0x258425cb21642788
.quad 0xa60fa53aa38ba70e,0xa7ff1248a788a164,0x27ce9f0327f61a46,0x253aa60f26dda41d,0xa27c2750a513262f,0x1bd627f19cb227ea,0xa3e3a6f6a0a5a7a8,0xa68aa49ba55fa5ed,0x27f11bd627a820a5,0x27ce9f0327fe9648,0xa58425cba62f2513,0xa3e326f6a4c4266d,0x9d79a7e29a46a7f6,0xa105a7999fc6a7c3,0x27252332270e238b,0x2750227c273b22d7
.quad 0x21c22777a764221f,0xa105a7992788a164,0xa725a332221fa764,0x268a249ba41d26dd,0x27b6a044221f2764,0xa7ff12489cb2a7ea,0xa44826c2a764a21f,0x264fa4ec25ed255f,0x9d79a7e22764a21f,0xa04427b6a7fe9648,0x264f24eca21f2764,0xa1c2a777266da4c4,0xa7fa18b5a21fa764,0x26c224489fc627c3,0x2584a5cb2764221f,0xa7fa18b5a2d7a73b
.quad 0x924827ffa764221f,0x260fa53a273b22d7,0xa53aa60f221fa764,0x9f0327cea7c31fc6,0x27f11bd6221f2764,0xa27ca75024c4a66d,0xa68a249ba764a21f,0x26f623e3164827fe,0x1f03a7ce2764a21f,0xa7f11bd6a55fa5ed,0x23e326f6a21f2764,0x25cba58427ea1cb2,0xa799a105a21fa764,0x9d7927e2a6dd241d,0x2750a27c2764221f,0xa332a7252164a788
.quad 0xa27c2750a764221f,0x2725233221642788,0xa105a799221fa764,0xa7e21d79a6dda41d,0x26f623e3221f2764,0x2584a5cb27ea9cb2,0xa7ce1f03a764a21f,0x9bd627f1a55f25ed,0x249ba68a2764a21f,0xa3e3a6f61648a7fe,0x1bd627f1a21f2764,0x2750227c24c4266d,0xa60fa53aa21fa764,0xa7ce1f03a7c39fc6,0x27ff92482764221f,0x253aa60f273ba2d7
.quad 0xa5cb2584a764221f,0x98b527faa2d7273b,0x18b5a7fa221fa764,0xa448a6c29fc6a7c3,0x24ec264f221f2764,0x277721c2266d24c4,0xa7e29d79a764a21f,0xa7b62044a7fe1648,0x26c2a4482764a21f,0x24eca64f25eda55f,0xa04427b6a21f2764,0x924827ff9cb227ea,0xa332a725a21fa764,0xa49ba68aa41da6dd,0x277721c22764221f,0x2799210527882164
.quad 0x204427b6a7a820a5,0x9f03a7ce27c39fc6,0xa5cba5842513a62f,0x24ec264fa5ed255f,0x27ce1f039a4627f6,0xa725a3322164a788,0xa7992105a38ba70e,0x27ff12481cb227ea,0x253aa60f270e238b,0xa750227ca4c4a66d,0x9d7927e2a7f61a46,0x253aa60f273b22d7,0xa1c2a777262fa513,0xa04427b6a7fe1648,0x264f24eca0a527a8,0x9d79a7e226dda41d
.quad 0xa7f19bd6a0a5a7a8,0x249b268aa41d26dd,0x2750a27c262f2513,0xa6f6a3e31648a7fe,0xa49b268aa7f69a46,0x27fa18b522d7273b,0x18b5a7fa270ea38b,0xa77721c2a66da4c4,0x23322725a38b270e,0x2584a5cb27ea1cb2,0xa6c2a4489a46a7f6,0xa1052799a7882164,0x27ff12482513262f,0x9bd6a7f1255fa5ed,0xa6f623e3a7a8a0a5,0x244826c29fc627c3
.quad 0x23e3a6f627a8a0a5,0xa6c2a4489fc6a7c3,0x124827ffa513262f,0x27f11bd6255f25ed,0xa448a6c21a46a7f6,0xa7992105a788a164,0x27252332238b270e,0x25cba58427ea9cb2,0xa7fa18b5a70ea38b,0xa1c22777a66d24c4,0x268aa49b27f69a46,0x98b5a7fa22d7a73b,0xa27c2750a62f2513,0x23e326f6164827fe,0x9bd6a7f120a5a7a8,0xa68aa49ba41da6dd
.quad 0x24ec264f20a527a8,0x27e21d7926dd241d,0xa777a1c2a62fa513,0xa7b62044a7fe9648,0x27e29d7927f61a46,0x260fa53a273ba2d7,0xa60f253aa70e238b,0xa27c2750a4c4266d,0x2105a799238ba70e,0x9248a7ff1cb2a7ea,0x1f0327ce1a4627f6,0x2332272521642788,0xa584a5cba513a62f,0xa64fa4eca5eda55f,0x27b6204427a820a5,0x27ce1f0327c31fc6
.quad 0x1d7927e2a7d91e3e,0x9bd6a7f127ea9cb2,0xa3e3a6f626a7a472,0x21c22777a73b22d7,0x260f253aa47226a7,0xa49ba68a25eda55f,0xa777a1c21e3ea7d9,0x260f253aa41d26dd,0x27ff12481e3e27d9,0xa725a3321fc6a7c3,0xa7992105a472a6a7,0x27ce1f03164827fe,0x264fa4ec26a72472,0xa7ff1248a164a788,0xa44826c2a7d99e3e,0x27b6a04424c4266d
.quad 0x1f03a7ce27d99e3e,0xa6f623e3a66da4c4,0x1bd627f1a6a72472,0x25cba58427882164,0xa332a7252472a6a7,0xa44826c2a7fe9648,0x25cb25849e3e27d9,0x2105a79927c39fc6,0xa750a27c9e3ea7d9,0x98b527faa6dd241d,0x27fa18b5247226a7,0x9d79a7e2255fa5ed,0xa7b62044a6a7a472,0x227c2750a2d7273b,0x268aa49b27d91e3e,0xa4eca64f1cb2a7ea
.quad 0xa49b268aa7d91e3e,0x264f24ec1cb227ea,0x2044a7b626a7a472,0xa750a27ca2d7a73b,0x18b527faa47226a7,0x27e21d79255f25ed,0xa27ca7501e3ea7d9,0xa7fa18b5a6dda41d,0x258425cb1e3e27d9,0x2799a10527c31fc6,0xa725a332a472a6a7,0xa6c22448a7fe1648,0x27f11bd626a72472,0x2584a5cb2788a164,0xa7ce1f03a7d99e3e,0xa3e326f6a66d24c4
.quad 0x26c2a44827d99e3e,0x2044a7b624c4a66d,0xa4ec264fa6a72472,0x924827ffa1642788,0x2105a7992472a6a7,0x9f03a7ce1648a7fe,0x124827ff9e3e27d9,0x233227251fc627c3,0xa1c2a7779e3ea7d9,0xa53aa60fa41da6dd,0x253a260f247226a7,0x268a249b25ed255f,0xa6f6a3e3a6a7a472,0xa777a1c2a73ba2d7,0x27e21d7927d91e3e,0x27f11bd627ea1cb2
.quad 0x18b527faa7f61a46,0x9248a7ff27fe9648,0x9f03a7ce27a8a0a5,0x18b527faa7ea1cb2,0x21c22777a70e238b,0x9bd6a7f127c39fc6,0xa3e3a6f6262fa513,0x1d7927e2a7882164,0x24ec264fa513262f,0x9f03a7ce273ba2d7,0xa5cba584238ba70e,0x204427b6a6dd241d,0x268a249ba0a527a8,0xa105a799266da4c4,0xa725a3321a46a7f6,0x21c22777a5ed255f
.quad 0x279921051a4627f6,0xa27ca750255fa5ed,0xa7e29d79a0a5a7a8,0x23322725a4c4266d,0x27ff1248238b270e,0xa3e3a6f6241da6dd,0xa7f11bd6a513a62f,0x244826c2a2d7273b,0x27b6a044262f2513,0xa49ba68a2164a788,0xa750227ca70ea38b,0x24ec264f9fc627c3,0x26c2a44827a820a5,0xa53aa60f1cb2a7ea,0xa60f253aa7f69a46,0x258425cb964827fe
.quad 0x253aa60f27f69a46,0xa5cba5849648a7fe,0xa44826c2a7a820a5,0x260f253a1cb227ea,0x227ca750270ea38b,0xa64fa4ec9fc6a7c3,0xa04427b6a62f2513,0x268a249b21642788,0x1bd6a7f12513a62f,0xa6c2a448a2d7a73b,0x124827ffa38b270e,0x26f623e3241d26dd,0x9d79a7e220a5a7a8,0xa725a332a4c4a66d,0x210527999a4627f6,0x2750227c255f25ed
.quad 0xa332a7259a46a7f6,0xa777a1c2a5eda55f,0x249b268a20a527a8,0x27992105266d24c4,0xa584a5cba38ba70e,0xa7b6a044a6dda41d,0x264f24ec2513262f,0x27ce1f03273b22d7,0xa6f6a3e3a62fa513,0xa7e29d79a788a164,0x277721c2270e238b,0x27f11bd627c31fc6,0xa7ce9f03a7a8a0a5,0xa7fa98b5a7ea9cb2,0x27fa18b527f61a46,0x27ff124827fe1648
.quad 0x3400340034003400,0x3400340034003400,0,0,0x35a8000034003400,0xb5a83400b400,0,0,0x3400b40034003400,0xb4003400b400b400,0,0,0xb5a834003400,0x35a80000b4003400,0,0
.quad 0xb400b40034003400,0xb400b40034003400,0,0,0xb5a8800034003400,0x800035a83400b400,0,0,0xb400340034003400,0x3400b400b400b400,0,0,0x800035a834003400,0xb5a88000b4003400,0,0
.quad 0,0,0x3400340034003400,0x3400340034003400,0,0,0x353ab054353a3054,0xb054b53a3054b53a,0,0,0xb5a835a80000,0x800035a8b5a88000,0,0,0xb53ab054353ab054,0x3054b53a3054353a
.quad 0,0,0xb40034003400b400,0xb40034003400b400,0,0,0x3054353a3054b53a,0x353ab054b53ab054,0,0,0x35a800000000b5a8,0xb5a88000800035a8,0,0,0x3054b53ab054b53a,0x353a3054353ab054
.quad 0x34003400,0,0,0,0xb400b400,0,0,0,0x34003400,0,0,0,0xb400b400,0,0,0
.quad 0x34003400,0,0,0,0xb400b400,0,0,0,0x34003400,0,0,0,0xb400b400,0,0,0
.quad 0,0,0,0,0,0,0,0,0,0,0,0,0,0,0,0
.quad 0,0,0,0,0,0,0,0,0,0,0,0,0,0,0,0
.quad 0x3400340034003400,0x3400340034003400,0xb4003400b4003400,0xb4003400b4003400,0x35a89471340333fa,0x9471b5a833fab403,0x147135a8b3fa3403,0x35a89471340333fa,0x33f3b406340633f3,0xb3f33406b406b3f3,0x340633f3b3f33406,0xb406b3f333f3b406,0x9aaab5a8340933ed,0x35a89aaab3ed3409,0x35a89aaab3ed3409,0x1aaa35a8b409b3ed
.quad 0xb40cb3e7340c33e7,0xb40cb3e7340c33e7,0x33e7b40cb3e7340c,0x33e7b40cb3e7340c,0xb5a81d8e341033e0,0x1d8e35a833e0b410,0x9d8eb5a8b3e03410,0xb5a81d8e341033e0,0xb3da3413341333da,0x33dab413b413b3da,0xb413b3dab3da3413,0x341333da33dab413,0x1fc635a8341633d4,0xb5a81fc6b3d43416,0xb5a81fc6b3d43416,0x9fc6b5a8b416b3d4
.quad 0x3400340034003400,0x3400340034003400,0xb4003400b4003400,0xb4003400b4003400,0xb5a81471b403b3fa,0x147135a8b3fa3403,0x9471b5a833fab403,0xb5a81471b403b3fa,0x33f3b406340633f3,0xb3f33406b406b3f3,0x340633f3b3f33406,0xb406b3f333f3b406,0x1aaa35a8b409b3ed,0xb5a81aaa33edb409,0xb5a81aaa33edb409,0x9aaab5a8340933ed
.quad 0xb40cb3e7340c33e7,0xb40cb3e7340c33e7,0x33e7b40cb3e7340c,0x33e7b40cb3e7340c,0x35a89d8eb410b3e0,0x9d8eb5a8b3e03410,0x1d8e35a833e0b410,0x35a89d8eb410b3e0,0xb3da3413341333da,0x33dab413b413b3da,0xb413b3dab3da3413,0x341333da33dab413,0x9fc6b5a8b416b3d4,0x35a89fc633d4b416,0x35a89fc633d4b416,0x1fc635a8341633d4
.quad 0,0,0,0,0,0,0,0,0,0,0,0,0,0,0,0
.quad 0,0,0,0,0,0,0,0,0,0,0,0,0,0,0,0
.quad 0,0,0,0,0,0,0,0,0,0,0,0,0,0,0,0
.quad 0,0,0,0,0,0,0,0,0,0,0,0,0,0,0,0
.quad 0x3400340034003400,0x3400340034003400,0xb4003400b4003400,0xb4003400b4003400,0x35a89871340633f3,0x9871b5a833f3b406,0x187135a8b3f33406,0x35a89871340633f3,0x33e7b40c340c33e7,0xb3e7340cb40cb3e7,0x340c33e7b3e7340c,0xb40cb3e733e7b40c,0x9eaab5a8341333da,0x35a89eaab3da3413,0x35a89eaab3da3413,0x1eaa35a8b413b3da
.quad 0xb419b3cd341933cd,0xb419b3cd341933cd,0x33cdb419b3cd3419,0x33cdb419b3cd3419,0xb5a7218d341f33c0,0x218d35a733c0b41f,0xa18db5a7b3c0341f,0xb5a7218d341f33c0,0xb3b33425342533b3,0x33b3b425b425b3b3,0xb425b3b3b3b33425,0x342533b333b3b425,0x23c635a7342b33a6,0xb5a723c6b3a6342b,0xb5a723c6b3a6342b,0xa3c6b5a7b42bb3a6
.quad 0x3400340034003400,0x3400340034003400,0xb4003400b4003400,0xb4003400b4003400,0xb5a81871b406b3f3,0x187135a8b3f33406,0x9871b5a833f3b406,0xb5a81871b406b3f3,0x33e7b40c340c33e7,0xb3e7340cb40cb3e7,0x340c33e7b3e7340c,0xb40cb3e733e7b40c,0x1eaa35a8b413b3da,0xb5a81eaa33dab413,0xb5a81eaa33dab413,0x9eaab5a8341333da
.quad 0xb419b3cd341933cd,0xb419b3cd341933cd,0x33cdb419b3cd3419,0x33cdb419b3cd3419,0x35a7a18db41fb3c0,0xa18db5a7b3c0341f,0x218d35a733c0b41f,0x35a7a18db41fb3c0,0xb3b33425342533b3,0x33b3b425b425b3b3,0xb425b3b3b3b33425,0x342533b333b3b425,0xa3c6b5a7b42bb3a6,0x35a7a3c633a6b42b,0x35a7a3c633a6b42b,0x23c635a7342b33a6
.quad 0,0,0,0,0,0,0,0,0,0,0,0,0,0,0,0
.quad 0,0,0,0,0,0,0,0,0,0,0,0,0,0,0,0
.quad 0,0,0,0,0,0,0,0,0,0,0,0,0,0,0,0
.quad 0,0,0,0,0,0,0,0,0,0,0,0,0,0,0,0
.quad 0x3400340034003400,0x3400340034003400,0xb4003400b4003400,0xb4003400b4003400,0x35a89aaa340933ed,0x9aaab5a833edb409,0x1aaa35a8b3ed3409,0x35a89aaa340933ed,0x33dab413341333da,0xb3da3413b413b3da,0x341333dab3da3413,0xb413b3da33dab413,0xa0ffb5a8341c33c7,0x35a8a0ffb3c7341c,0x35a8a0ffb3c7341c,0x20ff35a8b41cb3c7
.quad 0xb425b3b3342533b3,0xb425b3b3342533b3,0x33b3b425b3b33425,0x33b3b425b3b33425,0xb5a7242a342e33a0,0x242a35a733a0b42e,0xa42ab5a7b3a0342e,0xb5a7242a342e33a0,0xb38c34373437338c,0x338cb437b437b38c,0xb437b38cb38c3437,0x3437338c338cb437,0x25d435a534403378,0xb5a525d4b3783440,0xb5a525d4b3783440,0xa5d4b5a5b440b378
.quad 0x3400340034003400,0x3400340034003400,0xb4003400b4003400,0xb4003400b4003400,0xb5a81aaab409b3ed,0x1aaa35a8b3ed3409,0x9aaab5a833edb409,0xb5a81aaab409b3ed,0x33dab413341333da,0xb3da3413b413b3da,0x341333dab3da3413,0xb413b3da33dab413,0x20ff35a8b41cb3c7,0xb5a820ff33c7b41c,0xb5a820ff33c7b41c,0xa0ffb5a8341c33c7
.quad 0xb425b3b3342533b3,0xb425b3b3342533b3,0x33b3b425b3b33425,0x33b3b425b3b33425,0x35a7a42ab42eb3a0,0xa42ab5a7b3a0342e,0x242a35a733a0b42e,0x35a7a42ab42eb3a0,0xb38c34373437338c,0x338cb437b437b38c,0xb437b38cb38c3437,0x3437338c338cb437,0xa5d4b5a5b440b378,0x35a5a5d43378b440,0x35a5a5d43378b440,0x25d435a534403378
.quad 0,0,0,0,0,0,0,0,0,0,0,0,0,0,0,0
.quad 0,0,0,0,0,0,0,0,0,0,0,0,0,0,0,0
.quad 0,0,0,0,0,0,0,0,0,0,0,0,0,0,0,0
.quad 0,0,0,0,0,0,0,0,0,0,0,0,0,0,0,0
.quad 0x3400340034003400,0x3400340034003400,0xb4003400b4003400,0xb4003400b4003400,0x35a89c71340c33e7,0x9c71b5a833e7b40c,0x1c7135a8b3e7340c,0x35a89c71340c33e7,0x33cdb419341933cd,0xb3cd3419b419b3cd,0x341933cdb3cd3419,0xb419b3cd33cdb419,0xa2aab5a7342533b3,0x35a7a2aab3b33425,0x35a7a2aab3b33425,0x22aa35a7b425b3b3
.quad 0xb431b39934313399,0xb431b39934313399,0x3399b431b3993431,0x3399b431b3993431,0xb5a5258d343d337f,0x258d35a5337fb43d,0xa58db5a5b37f343d,0xb5a5258d343d337f,0xb364344934493364,0x3364b449b449b364,0xb449b364b3643449,0x344933643364b449,0x27c435a334543349,0xb5a327c4b3493454,0xb5a327c4b3493454,0xa7c4b5a3b454b349
.quad 0x3400340034003400,0x3400340034003400,0xb4003400b4003400,0xb4003400b4003400,0xb5a81c71b40cb3e7,0x1c7135a8b3e7340c,0x9c71b5a833e7b40c,0xb5a81c71b40cb3e7,0x33cdb419341933cd,0xb3cd3419b419b3cd,0x341933cdb3cd3419,0xb419b3cd33cdb419,0x22aa35a7b425b3b3,0xb5a722aa33b3b425,0xb5a722aa33b3b425,0xa2aab5a7342533b3
.quad 0xb431b39934313399,0xb431b39934313399,0x3399b431b3993431,0x3399b431b3993431,0x35a5a58db43db37f,0xa58db5a5b37f343d,0x258d35a5337fb43d,0x35a5a58db43db37f,0xb364344934493364,0x3364b449b449b364,0xb449b364b3643449,0x344933643364b449,0xa7c4b5a3b454b349,0x35a3a7c43349b454,0x35a3a7c43349b454,0x27c435a334543349
.quad 0,0,0,0,0,0,0,0,0,0,0,0,0,0,0,0
.quad 0,0,0,0,0,0,0,0,0,0,0,0,0,0,0,0
.quad 0,0,0,0,0,0,0,0,0,0,0,0,0,0,0,0
.quad 0,0,0,0,0,0,0,0,0,0,0,0,0,0,0,0
.quad 0x3400340034003400,0x3400340034003400,0xb4003400b4003400,0xb4003400b4003400,0x35a89d8e341033e0,0x9d8eb5a833e0b410,0x1d8e35a8b3e03410,0x35a89d8e341033e0,0x33c0b41f341f33c0,0xb3c0341fb41fb3c0,0x341f33c0b3c0341f,0xb41fb3c033c0b41f,0xa42ab5a7342e33a0,0x35a7a42ab3a0342e,0x35a7a42ab3a0342e,0x242a35a7b42eb3a0
.quad 0xb43db37f343d337f,0xb43db37f343d337f,0x337fb43db37f343d,0x337fb43db37f343d,0xb5a426ef344b335d,0x26ef35a4335db44b,0xa6efb5a4b35d344b,0xb5a426ef344b335d,0xb33b345a345a333b,0x333bb45ab45ab33b,0xb45ab33bb33b345a,0x345a333b333bb45a,0x28da35a034683319,0xb5a028dab3193468,0xb5a028dab3193468,0xa8dab5a0b468b319
.quad 0x3400340034003400,0x3400340034003400,0xb4003400b4003400,0xb4003400b4003400,0xb5a81d8eb410b3e0,0x1d8e35a8b3e03410,0x9d8eb5a833e0b410,0xb5a81d8eb410b3e0,0x33c0b41f341f33c0,0xb3c0341fb41fb3c0,0x341f33c0b3c0341f,0xb41fb3c033c0b41f,0x242a35a7b42eb3a0,0xb5a7242a33a0b42e,0xb5a7242a33a0b42e,0xa42ab5a7342e33a0
.quad 0xb43db37f343d337f,0xb43db37f343d337f,0x337fb43db37f343d,0x337fb43db37f343d,0x35a4a6efb44bb35d,0xa6efb5a4b35d344b,0x26ef35a4335db44b,0x35a4a6efb44bb35d,0xb33b345a345a333b,0x333bb45ab45ab33b,0xb45ab33bb33b345a,0x345a333b333bb45a,0xa8dab5a0b468b319,0x35a0a8da3319b468,0x35a0a8da3319b468,0x28da35a034683319
.quad 0,0,0,0,0,0,0,0,0,0,0,0,0,0,0,0
.quad 0,0,0,0,0,0,0,0,0,0,0,0,0,0,0,0
.quad 0,0,0,0,0,0,0,0,0,0,0,0,0,0,0,0
.quad 0,0,0,0,0,0,0,0,0,0,0,0,0,0,0,0
.quad 0x3400340034003400,0x3400340034003400,0xb4003400b4003400,0xb4003400b4003400,0x35a89eaa341333da,0x9eaab5a833dab413,0x1eaa35a8b3da3413,0x35a89eaa341333da,0x33b3b425342533b3,0xb3b33425b425b3b3,0x342533b3b3b33425,0xb425b3b333b3b425,0xa4ffb5a63437338c,0x35a6a4ffb38c3437,0x35a6a4ffb38c3437,0x24ff35a6b437b38c
.quad 0xb449b36434493364,0xb449b36434493364,0x3364b449b3643449,0x3364b449b3643449,0xb5a22829345a333b,0x282935a2333bb45a,0xa829b5a2b33b345a,0xb5a22829345a333b,0xb312346b346b3312,0x3312b46bb46bb312,0xb46bb312b312346b,0x346b33123312b46b,0x29d1359c347b32e8,0xb59c29d1b2e8347b,0xb59c29d1b2e8347b,0xa9d1b59cb47bb2e8
.quad 0x3400340034003400,0x3400340034003400,0xb4003400b4003400,0xb4003400b4003400,0xb5a81eaab413b3da,0x1eaa35a8b3da3413,0x9eaab5a833dab413,0xb5a81eaab413b3da,0x33b3b425342533b3,0xb3b33425b425b3b3,0x342533b3b3b33425,0xb425b3b333b3b425,0x24ff35a6b437b38c,0xb5a624ff338cb437,0xb5a624ff338cb437,0xa4ffb5a63437338c
.quad 0xb449b36434493364,0xb449b36434493364,0x3364b449b3643449,0x3364b449b3643449,0x35a2a829b45ab33b,0xa829b5a2b33b345a,0x282935a2333bb45a,0x35a2a829b45ab33b,0xb312346b346b3312,0x3312b46bb46bb312,0xb46bb312b312346b,0x346b33123312b46b,0xa9d1b59cb47bb2e8,0x359ca9d132e8b47b,0x359ca9d132e8b47b,0x29d1359c347b32e8
.quad 0,0,0,0,0,0,0,0,0,0,0,0,0,0,0,0
.quad 0,0,0,0,0,0,0,0,0,0,0,0,0,0,0,0
.quad 0,0,0,0,0,0,0,0,0,0,0,0,0,0,0,0
.quad 0,0,0,0,0,0,0,0,0,0,0,0,0,0,0,0
.quad 0x3400340034003400,0x3400340034003400,0xb4003400b4003400,0xb4003400b4003400,0x35a89fc6341633d4,0x9fc6b5a833d4b416,0x1fc635a8b3d43416,0x35a89fc6341633d4,0x33a6b42b342b33a6,0xb3a6342bb42bb3a6,0x342b33a6b3a6342b,0xb42bb3a633a6b42b,0xa5d4b5a534403378,0x35a5a5d4b3783440,0x35a5a5d4b3783440,0x25d435a5b440b378
.quad 0xb454b34934543349,0xb454b34934543349,0x3349b454b3493454,0x3349b454b3493454,0xb5a028da34683319,0x28da35a03319b468,0xa8dab5a0b3193468,0xb5a028da34683319,0xb2e8347b347b32e8,0x32e8b47bb47bb2e8,0xb47bb2e8b2e8347b,0x347b32e832e8b47b,0x2ac73598348e32b6,0xb5982ac7b2b6348e,0xb5982ac7b2b6348e,0xaac7b598b48eb2b6
.quad 0x3400340034003400,0x3400340034003400,0xb4003400b4003400,0xb4003400b4003400,0xb5a81fc6b416b3d4,0x1fc635a8b3d43416,0x9fc6b5a833d4b416,0xb5a81fc6b416b3d4,0x33a6b42b342b33a6,0xb3a6342bb42bb3a6,0x342b33a6b3a6342b,0xb42bb3a633a6b42b,0x25d435a5b440b378,0xb5a525d43378b440,0xb5a525d43378b440,0xa5d4b5a534403378
.quad 0xb454b34934543349,0xb454b34934543349,0x3349b454b3493454,0x3349b454b3493454,0x35a0a8dab468b319,0xa8dab5a0b3193468,0x28da35a03319b468,0x35a0a8dab468b319,0xb2e8347b347b32e8,0x32e8b47bb47bb2e8,0xb47bb2e8b2e8347b,0x347b32e832e8b47b,0xaac7b598b48eb2b6,0x3598aac732b6b48e,0x3598aac732b6b48e,0x2ac73598348e32b6
.quad 0,0,0,0,0,0,0,0,0,0,0,0,0,0,0,0
.quad 0,0,0,0,0,0,0,0,0,0,0,0,0,0,0,0
.quad 0,0,0,0,0,0,0,0,0,0,0,0,0,0,0,0
.quad 0,0,0,0,0,0,0,0,0,0,0,0,0,0,0,0
.quad 0x3400340034003400,0x3400340034003400,0xb4003400b4003400,0xb4003400b4003400,0x35a8a071341933cd,0xa071b5a833cdb419,0x207135a8b3cd3419,0x35a8a071341933cd,0x3399b43134313399,0xb3993431b431b399,0x34313399b3993431,0xb431b3993399b431,0xa6a9b5a434493364,0x35a4a6a9b3643449,0x35a4a6a9b3643449,0x26a935a4b449b364
.quad 0xb45fb32d345f332d,0xb45fb32d345f332d,0x332db45fb32d345f,0x332db45fb32d345f,0xb59d298a347632f6,0x298a359d32f6b476,0xa98ab59db2f63476,0xb59d298a347632f6,0xb2bd348b348b32bd,0x32bdb48bb48bb2bd,0xb48bb2bdb2bd348b,0x348b32bd32bdb48b,0x2bbd359334a03284,0xb5932bbdb28434a0,0xb5932bbdb28434a0,0xabbdb593b4a0b284
.quad 0x3400340034003400,0x3400340034003400,0xb4003400b4003400,0xb4003400b4003400,0xb5a82071b419b3cd,0x207135a8b3cd3419,0xa071b5a833cdb419,0xb5a82071b419b3cd,0x3399b43134313399,0xb3993431b431b399,0x34313399b3993431,0xb431b3993399b431,0x26a935a4b449b364,0xb5a426a93364b449,0xb5a426a93364b449,0xa6a9b5a434493364
.quad 0xb45fb32d345f332d,0xb45fb32d345f332d,0x332db45fb32d345f,0x332db45fb32d345f,0x359da98ab476b2f6,0xa98ab59db2f63476,0x298a359d32f6b476,0x359da98ab476b2f6,0xb2bd348b348b32bd,0x32bdb48bb48bb2bd,0xb48bb2bdb2bd348b,0x348b32bd32bdb48b,0xabbdb593b4a0b284,0x3593abbd3284b4a0,0x3593abbd3284b4a0,0x2bbd359334a03284
.quad 0,0,0,0,0,0,0,0,0,0,0,0,0,0,0,0
.quad 0,0,0,0,0,0,0,0,0,0,0,0,0,0,0,0
.quad 0,0,0,0,0,0,0,0,0,0,0,0,0,0,0,0
.quad 0,0,0,0,0,0,0,0,0,0,0,0,0,0,0,0
.quad 0x3400340034003400,0x3400340034003400,0xb4003400b4003400,0xb4003400b4003400,0x35a8a0ff341c33c7,0xa0ffb5a833c7b41c,0x20ff35a8b3c7341c,0x35a8a0ff341c33c7,0x338cb4373437338c,0xb38c3437b437b38c,0x3437338cb38c3437,0xb437b38c338cb437,0xa77db5a334513350,0x35a3a77db3503451,0x35a3a77db3503451,0x277d35a3b451b350
.quad 0xb46bb312346b3312,0xb46bb312346b3312,0x3312b46bb312346b,0x3312b46bb312346b,0xb59a2a3a348332d3,0x2a3a359a32d3b483,0xaa3ab59ab2d33483,0xb59a2a3a348332d3,0xb292349b349b3292,0x3292b49bb49bb292,0xb49bb292b292349b,0x349b32923292b49b,0x2c59358d34b23250,0xb58d2c59b25034b2,0xb58d2c59b25034b2,0xac59b58db4b2b250
.quad 0x3400340034003400,0x3400340034003400,0xb4003400b4003400,0xb4003400b4003400,0xb5a820ffb41cb3c7,0x20ff35a8b3c7341c,0xa0ffb5a833c7b41c,0xb5a820ffb41cb3c7,0x338cb4373437338c,0xb38c3437b437b38c,0x3437338cb38c3437,0xb437b38c338cb437,0x277d35a3b451b350,0xb5a3277d3350b451,0xb5a3277d3350b451,0xa77db5a334513350
.quad 0xb46bb312346b3312,0xb46bb312346b3312,0x3312b46bb312346b,0x3312b46bb312346b,0x359aaa3ab483b2d3,0xaa3ab59ab2d33483,0x2a3a359a32d3b483,0x359aaa3ab483b2d3,0xb292349b349b3292,0x3292b49bb49bb292,0xb49bb292b292349b,0x349b32923292b49b,0xac59b58db4b2b250,0x358dac593250b4b2,0x358dac593250b4b2,0x2c59358d34b23250
.quad 0,0,0,0,0,0,0,0,0,0,0,0,0,0,0,0
.quad 0,0,0,0,0,0,0,0,0,0,0,0,0,0,0,0
.quad 0,0,0,0,0,0,0,0,0,0,0,0,0,0,0,0
.quad 0,0,0,0,0,0,0,0,0,0,0,0,0,0,0,0
.quad 0x3400340034003400,0x3400340034003400,0xb4003400b4003400,0xb4003400b4003400,0x35a7a18d341f33c0,0xa18db5a733c0b41f,0x218d35a7b3c0341f,0x35a7a18d341f33c0,0x337fb43d343d337f,0xb37f343db43db37f,0x343d337fb37f343d,0xb43db37f337fb43d,0xa829b5a2345a333b,0x35a2a829b33b345a,0x35a2a829b33b345a,0x282935a2b45ab33b
.quad 0xb476b2f6347632f6,0xb476b2f6347632f6,0x32f6b476b2f63476,0x32f6b476b2f63476,0xb5972aea349032af,0x2aea359732afb490,0xaaeab597b2af3490,0xb5972aea349032af,0xb26734aa34aa3267,0x3267b4aab4aab267,0xb4aab267b26734aa,0x34aa32673267b4aa,0x2cd2358734c3321d,0xb5872cd2b21d34c3,0xb5872cd2b21d34c3,0xacd2b587b4c3b21d
.quad 0x3400340034003400,0x3400340034003400,0xb4003400b4003400,0xb4003400b4003400,0xb5a7218db41fb3c0,0x218d35a7b3c0341f,0xa18db5a733c0b41f,0xb5a7218db41fb3c0,0x337fb43d343d337f,0xb37f343db43db37f,0x343d337fb37f343d,0xb43db37f337fb43d,0x282935a2b45ab33b,0xb5a22829333bb45a,0xb5a22829333bb45a,0xa829b5a2345a333b
.quad 0xb476b2f6347632f6,0xb476b2f6347632f6,0x32f6b476b2f63476,0x32f6b476b2f63476,0x3597aaeab490b2af,0xaaeab597b2af3490,0x2aea359732afb490,0x3597aaeab490b2af,0xb26734aa34aa3267,0x3267b4aab4aab267,0xb4aab267b26734aa,0x34aa32673267b4aa,0xacd2b587b4c3b21d,0x3587acd2321db4c3,0x3587acd2321db4c3,0x2cd2358734c3321d
.quad 0,0,0,0,0,0,0,0,0,0,0,0,0,0,0,0
.quad 0,0,0,0,0,0,0,0,0,0,0,0,0,0,0,0
.quad 0,0,0,0,0,0,0,0,0,0,0,0,0,0,0,0
.quad 0,0,0,0,0,0,0,0,0,0,0,0,0,0,0,0
.quad 0x3400340034003400,0x3400340034003400,0xb4003400b4003400,0xb4003400b4003400,0x35a7a21c342233ba,0xa21cb5a733bab422,0x221c35a7b3ba3422,0x35a7a21c342233ba,0x3371b44334433371,0xb3713443b443b371,0x34433371b3713443,0xb443b3713371b443,0xa893b5a134623327,0x35a1a893b3273462,0x35a1a893b3273462,0x289335a1b462b327
.quad 0xb480b2da348032da,0xb480b2da348032da,0x32dab480b2da3480,0x32dab480b2da3480,0xb5942b9a349d328b,0x2b9a3594328bb49d,0xab9ab594b28b349d,0xb5942b9a349d328b,0xb23a34b934b9323a,0x323ab4b9b4b9b23a,0xb4b9b23ab23a34b9,0x34b9323a323ab4b9,0x2d4c358034d331e8,0xb5802d4cb1e834d3,0xb5802d4cb1e834d3,0xad4cb580b4d3b1e8
.quad 0x3400340034003400,0x3400340034003400,0xb4003400b4003400,0xb4003400b4003400,0xb5a7221cb422b3ba,0x221c35a7b3ba3422,0xa21cb5a733bab422,0xb5a7221cb422b3ba,0x3371b44334433371,0xb3713443b443b371,0x34433371b3713443,0xb443b3713371b443,0x289335a1b462b327,0xb5a128933327b462,0xb5a128933327b462,0xa893b5a134623327
.quad 0xb480b2da348032da,0xb480b2da348032da,0x32dab480b2da3480,0x32dab480b2da3480,0x3594ab9ab49db28b,0xab9ab594b28b349d,0x2b9a3594328bb49d,0x3594ab9ab49db28b,0xb23a34b934b9323a,0x323ab4b9b4b9b23a,0xb4b9b23ab23a34b9,0x34b9323a323ab4b9,0xad4cb580b4d3b1e8,0x3580ad4c31e8b4d3,0x3580ad4c31e8b4d3,0x2d4c358034d331e8
.quad 0,0,0,0,0,0,0,0,0,0,0,0,0,0,0,0
.quad 0,0,0,0,0,0,0,0,0,0,0,0,0,0,0,0
.quad 0,0,0,0,0,0,0,0,0,0,0,0,0,0,0,0
.quad 0,0,0,0,0,0,0,0,0,0,0,0,0,0,0,0
.quad 0x3400340034003400,0x3400340034003400,0xb4003400b4003400,0xb4003400b4003400,0x35a7a2aa342533b3,0xa2aab5a733b3b425,0x22aa35a7b3b33425,0x35a7a2aa342533b3,0x3364b44934493364,0xb3643449b449b364,0x34493364b3643449,0xb449b3643364b449,0xa8fdb59f346b3312,0x359fa8fdb312346b,0x359fa8fdb312346b,0x28fd359fb46bb312
.quad 0xb48bb2bd348b32bd,0xb48bb2bd348b32bd,0x32bdb48bb2bd348b,0x32bdb48bb2bd348b,0xb5902c2434aa3267,0x2c2435903267b4aa,0xac24b590b26734aa,0xb5902c2434aa3267,0xb20e34c734c7320e,0x320eb4c7b4c7b20e,0xb4c7b20eb20e34c7,0x34c7320e320eb4c7,0x2dc4357834e331b2,0xb5782dc4b1b234e3,0xb5782dc4b1b234e3,0xadc4b578b4e3b1b2
.quad 0x3400340034003400,0x3400340034003400,0xb4003400b4003400,0xb4003400b4003400,0xb5a722aab425b3b3,0x22aa35a7b3b33425,0xa2aab5a733b3b425,0xb5a722aab425b3b3,0x3364b44934493364,0xb3643449b449b364,0x34493364b3643449,0xb449b3643364b449,0x28fd359fb46bb312,0xb59f28fd3312b46b,0xb59f28fd3312b46b,0xa8fdb59f346b3312
.quad 0xb48bb2bd348b32bd,0xb48bb2bd348b32bd,0x32bdb48bb2bd348b,0x32bdb48bb2bd348b,0x3590ac24b4aab267,0xac24b590b26734aa,0x2c2435903267b4aa,0x3590ac24b4aab267,0xb20e34c734c7320e,0x320eb4c7b4c7b20e,0xb4c7b20eb20e34c7,0x34c7320e320eb4c7,0xadc4b578b4e3b1b2,0x3578adc431b2b4e3,0x3578adc431b2b4e3,0x2dc4357834e331b2
.quad 0,0,0,0,0,0,0,0,0,0,0,0,0,0,0,0
.quad 0,0,0,0,0,0,0,0,0,0,0,0,0,0,0,0
.quad 0,0,0,0,0,0,0,0,0,0,0,0,0,0,0,0
.quad 0,0,0,0,0,0,0,0,0,0,0,0,0,0,0,0
.quad 0x3400340034003400,0x3400340034003400,0xb4003400b4003400,0xb4003400b4003400,0x35a7a338342833ad,0xa338b5a733adb428,0x233835a7b3ad3428,0x35a7a338342833ad,0x3356b44e344e3356,0xb356344eb44eb356,0x344e3356b356344e,0xb44eb3563356b44e,0xa967b59e347332fd,0x359ea967b2fd3473,0x359ea967b2fd3473,0x2967359eb473b2fd
.quad 0xb496b2a1349632a1,0xb496b2a1349632a1,0x32a1b496b2a13496,0x32a1b496b2a13496,0xb58b2c7c34b73242,0x2c7c358b3242b4b7,0xac7cb58bb24234b7,0xb58b2c7c34b73242,0xb1e034d634d631e0,0x31e0b4d6b4d6b1e0,0xb4d6b1e0b1e034d6,0x34d631e031e0b4d6,0x2e3c357034f3317c,0xb5702e3cb17c34f3,0xb5702e3cb17c34f3,0xae3cb570b4f3b17c
.quad 0x3400340034003400,0x3400340034003400,0xb4003400b4003400,0xb4003400b4003400,0xb5a72338b428b3ad,0x233835a7b3ad3428,0xa338b5a733adb428,0xb5a72338b428b3ad,0x3356b44e344e3356,0xb356344eb44eb356,0x344e3356b356344e,0xb44eb3563356b44e,0x2967359eb473b2fd,0xb59e296732fdb473,0xb59e296732fdb473,0xa967b59e347332fd
.quad 0xb496b2a1349632a1,0xb496b2a1349632a1,0x32a1b496b2a13496,0x32a1b496b2a13496,0x358bac7cb4b7b242,0xac7cb58bb24234b7,0x2c7c358b3242b4b7,0x358bac7cb4b7b242,0xb1e034d634d631e0,0x31e0b4d6b4d6b1e0,0xb4d6b1e0b1e034d6,0x34d631e031e0b4d6,0xae3cb570b4f3b17c,0x3570ae3c317cb4f3,0x3570ae3c317cb4f3,0x2e3c357034f3317c
.quad 0,0,0,0,0,0,0,0,0,0,0,0,0,0,0,0
.quad 0,0,0,0,0,0,0,0,0,0,0,0,0,0,0,0
.quad 0,0,0,0,0,0,0,0,0,0,0,0,0,0,0,0
.quad 0,0,0,0,0,0,0,0,0,0,0,0,0,0,0,0
.quad 0x3400340034003400,0x3400340034003400,0xb4003400b4003400,0xb4003400b4003400,0x35a7a3c6342b33a6,0xa3c6b5a733a6b42b,0x23c635a7b3a6342b,0x35a7a3c6342b33a6,0x3349b45434543349,0xb3493454b454b349,0x34543349b3493454,0xb454b3493349b454,0xa9d1b59c347b32e8,0x359ca9d1b2e8347b,0x359ca9d1b2e8347b,0x29d1359cb47bb2e8
.quad 0xb4a0b28434a03284,0xb4a0b28434a03284,0x3284b4a0b28434a0,0x3284b4a0b28434a0,0xb5872cd234c3321d,0x2cd23587321db4c3,0xacd2b587b21d34c3,0xb5872cd234c3321d,0xb1b234e334e331b2,0x31b2b4e3b4e3b1b2,0xb4e3b1b2b1b234e3,0x34e331b231b2b4e3,0x2eb3356735013146,0xb5672eb3b1463501,0xb5672eb3b1463501,0xaeb3b567b501b146
.quad 0x3400340034003400,0x3400340034003400,0xb4003400b4003400,0xb4003400b4003400,0xb5a723c6b42bb3a6,0x23c635a7b3a6342b,0xa3c6b5a733a6b42b,0xb5a723c6b42bb3a6,0x3349b45434543349,0xb3493454b454b349,0x34543349b3493454,0xb454b3493349b454,0x29d1359cb47bb2e8,0xb59c29d132e8b47b,0xb59c29d132e8b47b,0xa9d1b59c347b32e8
.quad 0xb4a0b28434a03284,0xb4a0b28434a03284,0x3284b4a0b28434a0,0x3284b4a0b28434a0,0x3587acd2b4c3b21d,0xacd2b587b21d34c3,0x2cd23587321db4c3,0x3587acd2b4c3b21d,0xb1b234e334e331b2,0x31b2b4e3b4e3b1b2,0xb4e3b1b2b1b234e3,0x34e331b231b2b4e3,0xaeb3b567b501b146,0x3567aeb33146b501,0x3567aeb33146b501,0x2eb3356735013146
.quad 0,0,0,0,0,0,0,0,0,0,0,0,0,0,0,0
.quad 0,0,0,0,0,0,0,0,0,0,0,0,0,0,0,0
.quad 0,0,0,0,0,0,0,0,0,0,0,0,0,0,0,0
.quad 0,0,0,0,0,0,0,0,0,0,0,0,0,0,0,0
.quad 0x3400340034003400,0x3400340034003400,0xb4003400b4003400,0xb4003400b4003400,0x35a7a42a342e33a0,0xa42ab5a733a0b42e,0x242a35a7b3a0342e,0x35a7a42a342e33a0,0x333bb45a345a333b,0xb33b345ab45ab33b,0x345a333bb33b345a,0xb45ab33b333bb45a,0xaa3ab59a348332d3,0x359aaa3ab2d33483,0x359aaa3ab2d33483,0x2a3a359ab483b2d3
.quad 0xb4aab26734aa3267,0xb4aab26734aa3267,0x3267b4aab26734aa,0x3267b4aab26734aa,0xb5822d2934cf31f7,0x2d29358231f7b4cf,0xad29b582b1f734cf,0xb5822d2934cf31f7,0xb18434f034f03184,0x3184b4f0b4f0b184,0xb4f0b184b18434f0,0x34f031843184b4f0,0x2f2a355e3510310e,0xb55e2f2ab10e3510,0xb55e2f2ab10e3510,0xaf2ab55eb510b10e
.quad 0x3400340034003400,0x3400340034003400,0xb4003400b4003400,0xb4003400b4003400,0xb5a7242ab42eb3a0,0x242a35a7b3a0342e,0xa42ab5a733a0b42e,0xb5a7242ab42eb3a0,0x333bb45a345a333b,0xb33b345ab45ab33b,0x345a333bb33b345a,0xb45ab33b333bb45a,0x2a3a359ab483b2d3,0xb59a2a3a32d3b483,0xb59a2a3a32d3b483,0xaa3ab59a348332d3
.quad 0xb4aab26734aa3267,0xb4aab26734aa3267,0x3267b4aab26734aa,0x3267b4aab26734aa,0x3582ad29b4cfb1f7,0xad29b582b1f734cf,0x2d29358231f7b4cf,0x3582ad29b4cfb1f7,0xb18434f034f03184,0x3184b4f0b4f0b184,0xb4f0b184b18434f0,0x34f031843184b4f0,0xaf2ab55eb510b10e,0x355eaf2a310eb510,0x355eaf2a310eb510,0x2f2a355e3510310e
.quad 0,0,0,0,0,0,0,0,0,0,0,0,0,0,0,0
.quad 0,0,0,0,0,0,0,0,0,0,0,0,0,0,0,0
.quad 0,0,0,0,0,0,0,0,0,0,0,0,0,0,0,0
.quad 0,0,0,0,0,0,0,0,0,0,0,0,0,0,0,0
.quad 0x3400340034003400,0x3400340034003400,0xb4003400b4003400,0xb4003400b4003400,0x35a6a47134313399,0xa471b5a63399b431,0x247135a6b3993431,0x35a6a47134313399,0x332db45f345f332d,0xb32d345fb45fb32d,0x345f332db32d345f,0xb45fb32d332db45f,0xaaa4b598348b32bd,0x3598aaa4b2bd348b,0x3598aaa4b2bd348b,0x2aa43598b48bb2bd
.quad 0xb4b4b24934b43249,0xb4b4b24934b43249,0x3249b4b4b24934b4,0x3249b4b4b24934b4,0xb57d2d7f34da31d1,0x2d7f357d31d1b4da,0xad7fb57db1d134da,0xb57d2d7f34da31d1,0xb15534fd34fd3155,0x3155b4fdb4fdb155,0xb4fdb155b15534fd,0x34fd31553155b4fd,0x2f9f3554351d30d6,0xb5542f9fb0d6351d,0xb5542f9fb0d6351d,0xaf9fb554b51db0d6
.quad 0x3400340034003400,0x3400340034003400,0xb4003400b4003400,0xb4003400b4003400,0xb5a62471b431b399,0x247135a6b3993431,0xa471b5a63399b431,0xb5a62471b431b399,0x332db45f345f332d,0xb32d345fb45fb32d,0x345f332db32d345f,0xb45fb32d332db45f,0x2aa43598b48bb2bd,0xb5982aa432bdb48b,0xb5982aa432bdb48b,0xaaa4b598348b32bd
.quad 0xb4b4b24934b43249,0xb4b4b24934b43249,0x3249b4b4b24934b4,0x3249b4b4b24934b4,0x357dad7fb4dab1d1,0xad7fb57db1d134da,0x2d7f357d31d1b4da,0x357dad7fb4dab1d1,0xb15534fd34fd3155,0x3155b4fdb4fdb155,0xb4fdb155b15534fd,0x34fd31553155b4fd,0xaf9fb554b51db0d6,0x3554af9f30d6b51d,0x3554af9f30d6b51d,0x2f9f3554351d30d6
.quad 0,0,0,0,0,0,0,0,0,0,0,0,0,0,0,0
.quad 0,0,0,0,0,0,0,0,0,0,0,0,0,0,0,0
.quad 0,0,0,0,0,0,0,0,0,0,0,0,0,0,0,0
.quad 0,0,0,0,0,0,0,0,0,0,0,0,0,0,0,0
.quad 0x3400340034003400,0x3400340034003400,0xb4003400b4003400,0xb4003400b4003400,0x35a6a4b834343392,0xa4b8b5a63392b434,0x24b835a6b3923434,0x35a6a4b834343392,0x3320b46534653320,0xb3203465b465b320,0x34653320b3203465,0xb465b3203320b465,0xab0db596349332a8,0x3596ab0db2a83493,0x3596ab0db2a83493,0x2b0d3596b493b2a8
.quad 0xb4beb22b34be322b,0xb4beb22b34be322b,0x322bb4beb22b34be,0x322bb4beb22b34be,0xb5772dd634e531ab,0x2dd6357731abb4e5,0xadd6b577b1ab34e5,0xb5772dd634e531ab,0xb126350a350a3126,0x3126b50ab50ab126,0xb50ab126b126350a,0x350a31263126b50a,0x300a3549352a309e,0xb549300ab09e352a,0xb549300ab09e352a,0xb00ab549b52ab09e
.quad 0x3400340034003400,0x3400340034003400,0xb4003400b4003400,0xb4003400b4003400,0xb5a624b8b434b392,0x24b835a6b3923434,0xa4b8b5a63392b434,0xb5a624b8b434b392,0x3320b46534653320,0xb3203465b465b320,0x34653320b3203465,0xb465b3203320b465,0x2b0d3596b493b2a8,0xb5962b0d32a8b493,0xb5962b0d32a8b493,0xab0db596349332a8
.quad 0xb4beb22b34be322b,0xb4beb22b34be322b,0x322bb4beb22b34be,0x322bb4beb22b34be,0x3577add6b4e5b1ab,0xadd6b577b1ab34e5,0x2dd6357731abb4e5,0x3577add6b4e5b1ab,0xb126350a350a3126,0x3126b50ab50ab126,0xb50ab126b126350a,0x350a31263126b50a,0xb00ab549b52ab09e,0x3549b00a309eb52a,0x3549b00a309eb52a,0x300a3549352a309e
.quad 0,0,0,0,0,0,0,0,0,0,0,0,0,0,0,0
.quad 0,0,0,0,0,0,0,0,0,0,0,0,0,0,0,0
.quad 0,0,0,0,0,0,0,0,0,0,0,0,0,0,0,0
.quad 0,0,0,0,0,0,0,0,0,0,0,0,0,0,0,0
.quad 0x3400340034003400,0x3400340034003400,0xb4003400b4003400,0xb4003400b4003400,0x35a6a4ff3437338c,0xa4ffb5a6338cb437,0x24ff35a6b38c3437,0x35a6a4ff3437338c,0x3312b46b346b3312,0xb312346bb46bb312,0x346b3312b312346b,0xb46bb3123312b46b,0xab77b594349b3292,0x3594ab77b292349b,0x3594ab77b292349b,0x2b773594b49bb292
.quad 0xb4c7b20e34c7320e,0xb4c7b20e34c7320e,0x320eb4c7b20e34c7,0x320eb4c7b20e34c7,0xb5712e2b34f03184,0x2e2b35713184b4f0,0xae2bb571b18434f0,0xb5712e2b34f03184,0xb0f63515351530f6,0x30f6b515b515b0f6,0xb515b0f6b0f63515,0x351530f630f6b515,0x3044353d35363065,0xb53d3044b0653536,0xb53d3044b0653536,0xb044b53db536b065
.quad 0x3400340034003400,0x3400340034003400,0xb4003400b4003400,0xb4003400b4003400,0xb5a624ffb437b38c,0x24ff35a6b38c3437,0xa4ffb5a6338cb437,0xb5a624ffb437b38c,0x3312b46b346b3312,0xb312346bb46bb312,0x346b3312b312346b,0xb46bb3123312b46b,0x2b773594b49bb292,0xb5942b773292b49b,0xb5942b773292b49b,0xab77b594349b3292
.quad 0xb4c7b20e34c7320e,0xb4c7b20e34c7320e,0x320eb4c7b20e34c7,0x320eb4c7b20e34c7,0x3571ae2bb4f0b184,0xae2bb571b18434f0,0x2e2b35713184b4f0,0x3571ae2bb4f0b184,0xb0f63515351530f6,0x30f6b515b515b0f6,0xb515b0f6b0f63515,0x351530f630f6b515,0xb044b53db536b065,0x353db0443065b536,0x353db0443065b536,0x3044353d35363065
.quad 0,0,0,0,0,0,0,0,0,0,0,0,0,0,0,0
.quad 0,0,0,0,0,0,0,0,0,0,0,0,0,0,0,0
.quad 0,0,0,0,0,0,0,0,0,0,0,0,0,0,0,0
.quad 0,0,0,0,0,0,0,0,0,0,0,0,0,0,0,0
.quad 0x3400340034003400,0x3400340034003400,0xb4003400b4003400,0xb4003400b4003400,0x35a6a546343a3385,0xa546b5a63385b43a,0x254635a6b385343a,0x35a6a546343a3385,0x3304b47034703304,0xb3043470b470b304,0x34703304b3043470,0xb470b3043304b470,0xabe0b59234a3327c,0x3592abe0b27c34a3,0x3592abe0b27c34a3,0x2be03592b4a3b27c
.quad 0xb4d1b1ef34d131ef,0xb4d1b1ef34d131ef,0x31efb4d1b1ef34d1,0x31efb4d1b1ef34d1,0xb56b2e8034fb315d,0x2e80356b315db4fb,0xae80b56bb15d34fb,0xb56b2e8034fb315d,0xb0c63521352130c6,0x30c6b521b521b0c6,0xb521b0c6b0c63521,0x352130c630c6b521,0x307d35313542302b,0xb531307db02b3542,0xb531307db02b3542,0xb07db531b542b02b
.quad 0x3400340034003400,0x3400340034003400,0xb4003400b4003400,0xb4003400b4003400,0xb5a62546b43ab385,0x254635a6b385343a,0xa546b5a63385b43a,0xb5a62546b43ab385,0x3304b47034703304,0xb3043470b470b304,0x34703304b3043470,0xb470b3043304b470,0x2be03592b4a3b27c,0xb5922be0327cb4a3,0xb5922be0327cb4a3,0xabe0b59234a3327c
.quad 0xb4d1b1ef34d131ef,0xb4d1b1ef34d131ef,0x31efb4d1b1ef34d1,0x31efb4d1b1ef34d1,0x356bae80b4fbb15d,0xae80b56bb15d34fb,0x2e80356b315db4fb,0x356bae80b4fbb15d,0xb0c63521352130c6,0x30c6b521b521b0c6,0xb521b0c6b0c63521,0x352130c630c6b521,0xb07db531b542b02b,0x3531b07d302bb542,0x3531b07d302bb542,0x307d35313542302b
.quad 0,0,0,0,0,0,0,0,0,0,0,0,0,0,0,0
.quad 0,0,0,0,0,0,0,0,0,0,0,0,0,0,0,0
.quad 0,0,0,0,0,0,0,0,0,0,0,0,0,0,0,0
.quad 0,0,0,0,0,0,0,0,0,0,0,0,0,0,0,0
.quad 0x3400340034003400,0x3400340034003400,0xb4003400b4003400,0xb4003400b4003400,0x35a5a58d343d337f,0xa58db5a5337fb43d,0x258d35a5b37f343d,0x35a5a58d343d337f,0x32f6b476347632f6,0xb2f63476b476b2f6,0x347632f6b2f63476,0xb476b2f632f6b476,0xac24b59034aa3267,0x3590ac24b26734aa,0x3590ac24b26734aa,0x2c243590b4aab267
.quad 0xb4dab1d134da31d1,0xb4dab1d134da31d1,0x31d1b4dab1d134da,0x31d1b4dab1d134da,0xb5652ed535053136,0x2ed535653136b505,0xaed5b565b1363505,0xb5652ed535053136,0xb096352c352c3096,0x3096b52cb52cb096,0xb52cb096b096352c,0x352c30963096b52c,0x30b63525354d2fe2,0xb52530b6afe2354d,0xb52530b6afe2354d,0xb0b6b525b54dafe2
.quad 0x3400340034003400,0x3400340034003400,0xb4003400b4003400,0xb4003400b4003400,0xb5a5258db43db37f,0x258d35a5b37f343d,0xa58db5a5337fb43d,0xb5a5258db43db37f,0x32f6b476347632f6,0xb2f63476b476b2f6,0x347632f6b2f63476,0xb476b2f632f6b476,0x2c243590b4aab267,0xb5902c243267b4aa,0xb5902c243267b4aa,0xac24b59034aa3267
.quad 0xb4dab1d134da31d1,0xb4dab1d134da31d1,0x31d1b4dab1d134da,0x31d1b4dab1d134da,0x3565aed5b505b136,0xaed5b565b1363505,0x2ed535653136b505,0x3565aed5b505b136,0xb096352c352c3096,0x3096b52cb52cb096,0xb52cb096b096352c,0x352c30963096b52c,0xb0b6b525b54dafe2,0x3525b0b62fe2b54d,0x3525b0b62fe2b54d,0x30b63525354d2fe2
.quad 0,0,0,0,0,0,0,0,0,0,0,0,0,0,0,0
.quad 0,0,0,0,0,0,0,0,0,0,0,0,0,0,0,0
.quad 0,0,0,0,0,0,0,0,0,0,0,0,0,0,0,0
.quad 0,0,0,0,0,0,0,0,0,0,0,0,0,0,0,0
.quad 0x3400340034003400,0x3400340034003400,0xb4003400b4003400,0xb4003400b4003400,0x35a5a5d434403378,0xa5d4b5a53378b440,0x25d435a5b3783440,0x35a5a5d434403378,0x32e8b47b347b32e8,0xb2e8347bb47bb2e8,0x347b32e8b2e8347b,0xb47bb2e832e8b47b,0xac59b58d34b23250,0x358dac59b25034b2,0x358dac59b25034b2,0x2c59358db4b2b250
.quad 0xb4e3b1b234e331b2,0xb4e3b1b234e331b2,0x31b2b4e3b1b234e3,0x31b2b4e3b1b234e3,0xb55e2f2a3510310e,0x2f2a355e310eb510,0xaf2ab55eb10e3510,0xb55e2f2a3510310e,0xb065353635363065,0x3065b536b536b065,0xb536b065b0653536,0x353630653065b536,0x30ee351735582f6d,0xb51730eeaf6d3558,0xb51730eeaf6d3558,0xb0eeb517b558af6d
.quad 0x3400340034003400,0x3400340034003400,0xb4003400b4003400,0xb4003400b4003400,0xb5a525d4b440b378,0x25d435a5b3783440,0xa5d4b5a53378b440,0xb5a525d4b440b378,0x32e8b47b347b32e8,0xb2e8347bb47bb2e8,0x347b32e8b2e8347b,0xb47bb2e832e8b47b,0x2c59358db4b2b250,0xb58d2c593250b4b2,0xb58d2c593250b4b2,0xac59b58d34b23250
.quad 0xb4e3b1b234e331b2,0xb4e3b1b234e331b2,0x31b2b4e3b1b234e3,0x31b2b4e3b1b234e3,0x355eaf2ab510b10e,0xaf2ab55eb10e3510,0x2f2a355e310eb510,0x355eaf2ab510b10e,0xb065353635363065,0x3065b536b536b065,0xb536b065b0653536,0x353630653065b536,0xb0eeb517b558af6d,0x3517b0ee2f6db558,0x3517b0ee2f6db558,0x30ee351735582f6d
.quad 0,0,0,0,0,0,0,0,0,0,0,0,0,0,0,0
.quad 0,0,0,0,0,0,0,0,0,0,0,0,0,0,0,0
.quad 0,0,0,0,0,0,0,0,0,0,0,0,0,0,0,0
.quad 0,0,0,0,0,0,0,0,0,0,0,0,0,0,0,0
.quad 0x3400340034003400,0x3400340034003400,0xb4003400b4003400,0xb4003400b4003400,0x35a5a61b34433371,0xa61bb5a53371b443,0x261b35a5b3713443,0x35a5a61b34433371,0x32dab480348032da,0xb2da3480b480b2da,0x348032dab2da3480,0xb480b2da32dab480,0xac8db58b34b9323a,0x358bac8db23a34b9,0x358bac8db23a34b9,0x2c8d358bb4b9b23a
.quad 0xb4ecb19434ec3194,0xb4ecb19434ec3194,0x3194b4ecb19434ec,0x3194b4ecb19434ec,0xb5562f7e351930e6,0x2f7e355630e6b519,0xaf7eb556b0e63519,0xb5562f7e351930e6,0xb033354135413033,0x3033b541b541b033,0xb541b033b0333541,0x354130333033b541,0x3126350a35622ef7,0xb50a3126aef73562,0xb50a3126aef73562,0xb126b50ab562aef7
.quad 0x3400340034003400,0x3400340034003400,0xb4003400b4003400,0xb4003400b4003400,0xb5a5261bb443b371,0x261b35a5b3713443,0xa61bb5a53371b443,0xb5a5261bb443b371,0x32dab480348032da,0xb2da3480b480b2da,0x348032dab2da3480,0xb480b2da32dab480,0x2c8d358bb4b9b23a,0xb58b2c8d323ab4b9,0xb58b2c8d323ab4b9,0xac8db58b34b9323a
.quad 0xb4ecb19434ec3194,0xb4ecb19434ec3194,0x3194b4ecb19434ec,0x3194b4ecb19434ec,0x3556af7eb519b0e6,0xaf7eb556b0e63519,0x2f7e355630e6b519,0x3556af7eb519b0e6,0xb033354135413033,0x3033b541b541b033,0xb541b033b0333541,0x354130333033b541,0xb126b50ab562aef7,0x350ab1262ef7b562,0x350ab1262ef7b562,0x3126350a35622ef7
.quad 0,0,0,0,0,0,0,0,0,0,0,0,0,0,0,0
.quad 0,0,0,0,0,0,0,0,0,0,0,0,0,0,0,0
.quad 0,0,0,0,0,0,0,0,0,0,0,0,0,0,0,0
.quad 0,0,0,0,0,0,0,0,0,0,0,0,0,0,0,0
.quad 0x3400340034003400,0x3400340034003400,0xb4003400b4003400,0xb4003400b4003400,0x35a5a6623446336b,0xa662b5a5336bb446,0x266235a5b36b3446,0x35a5a6623446336b,0x32ccb486348632cc,0xb2cc3486b486b2cc,0x348632ccb2cc3486,0xb486b2cc32ccb486,0xacc1b58834c03224,0x3588acc1b22434c0,0x3588acc1b22434c0,0x2cc13588b4c0b224
.quad 0xb4f5b17534f53175,0xb4f5b17534f53175,0x3175b4f5b17534f5,0x3175b4f5b17534f5,0xb54f2fd2352330be,0x2fd2354f30beb523,0xafd2b54fb0be3523,0xb54f2fd2352330be,0xb002354a354a3002,0x3002b54ab54ab002,0xb54ab002b002354a,0x354a30023002b54a,0x315d34fb356b2e80,0xb4fb315dae80356b,0xb4fb315dae80356b,0xb15db4fbb56bae80
.quad 0x3400340034003400,0x3400340034003400,0xb4003400b4003400,0xb4003400b4003400,0xb5a52662b446b36b,0x266235a5b36b3446,0xa662b5a5336bb446,0xb5a52662b446b36b,0x32ccb486348632cc,0xb2cc3486b486b2cc,0x348632ccb2cc3486,0xb486b2cc32ccb486,0x2cc13588b4c0b224,0xb5882cc13224b4c0,0xb5882cc13224b4c0,0xacc1b58834c03224
.quad 0xb4f5b17534f53175,0xb4f5b17534f53175,0x3175b4f5b17534f5,0x3175b4f5b17534f5,0x354fafd2b523b0be,0xafd2b54fb0be3523,0x2fd2354f30beb523,0x354fafd2b523b0be,0xb002354a354a3002,0x3002b54ab54ab002,0xb54ab002b002354a,0x354a30023002b54a,0xb15db4fbb56bae80,0x34fbb15d2e80b56b,0x34fbb15d2e80b56b,0x315d34fb356b2e80
.quad 0,0,0,0,0,0,0,0,0,0,0,0,0,0,0,0
.quad 0,0,0,0,0,0,0,0,0,0,0,0,0,0,0,0
.quad 0,0,0,0,0,0,0,0,0,0,0,0,0,0,0,0
.quad 0,0,0,0,0,0,0,0,0,0,0,0,0,0,0,0
.quad 0x3400340034003400,0x3400340034003400,0xb4003400b4003400,0xb4003400b4003400,0x35a4a6a934493364,0xa6a9b5a43364b449,0x26a935a4b3643449,0x35a4a6a934493364,0x32bdb48b348b32bd,0xb2bd348bb48bb2bd,0x348b32bdb2bd348b,0xb48bb2bd32bdb48b,0xacf5b58534c7320e,0x3585acf5b20e34c7,0x3585acf5b20e34c7,0x2cf53585b4c7b20e
.quad 0xb4fdb15534fd3155,0xb4fdb15534fd3155,0x3155b4fdb15534fd,0x3155b4fdb15534fd,0xb5473012352c3096,0x301235473096b52c,0xb012b547b096352c,0xb5473012352c3096,0xaf9f355435542f9f,0x2f9fb554b554af9f,0xb554af9faf9f3554,0x35542f9f2f9fb554,0x319434ec35742e09,0xb4ec3194ae093574,0xb4ec3194ae093574,0xb194b4ecb574ae09
.quad 0x3400340034003400,0x3400340034003400,0xb4003400b4003400,0xb4003400b4003400,0xb5a426a9b449b364,0x26a935a4b3643449,0xa6a9b5a43364b449,0xb5a426a9b449b364,0x32bdb48b348b32bd,0xb2bd348bb48bb2bd,0x348b32bdb2bd348b,0xb48bb2bd32bdb48b,0x2cf53585b4c7b20e,0xb5852cf5320eb4c7,0xb5852cf5320eb4c7,0xacf5b58534c7320e
.quad 0xb4fdb15534fd3155,0xb4fdb15534fd3155,0x3155b4fdb15534fd,0x3155b4fdb15534fd,0x3547b012b52cb096,0xb012b547b096352c,0x301235473096b52c,0x3547b012b52cb096,0xaf9f355435542f9f,0x2f9fb554b554af9f,0xb554af9faf9f3554,0x35542f9f2f9fb554,0xb194b4ecb574ae09,0x34ecb1942e09b574,0x34ecb1942e09b574,0x319434ec35742e09
.quad 0,0,0,0,0,0,0,0,0,0,0,0,0,0,0,0
.quad 0,0,0,0,0,0,0,0,0,0,0,0,0,0,0,0
.quad 0,0,0,0,0,0,0,0,0,0,0,0,0,0,0,0
.quad 0,0,0,0,0,0,0,0,0,0,0,0,0,0,0,0
.quad 0x3400340034003400,0x3400340034003400,0xb4003400b4003400,0xb4003400b4003400,0x35a4a6ef344b335d,0xa6efb5a4335db44b,0x26ef35a4b35d344b,0x35a4a6ef344b335d,0x32afb490349032af,0xb2af3490b490b2af,0x349032afb2af3490,0xb490b2af32afb490,0xad29b58234cf31f7,0x3582ad29b1f734cf,0x3582ad29b1f734cf,0x2d293582b4cfb1f7
.quad 0xb505b13635053136,0xb505b13635053136,0x3136b505b1363505,0x3136b505b1363505,0xb53f303c3535306d,0x303c353f306db535,0xb03cb53fb06d3535,0xb53f303c3535306d,0xaf3b355c355c2f3b,0x2f3bb55cb55caf3b,0xb55caf3baf3b355c,0x355c2f3b2f3bb55c,0x31c934dc357c2d91,0xb4dc31c9ad91357c,0xb4dc31c9ad91357c,0xb1c9b4dcb57cad91
.quad 0x3400340034003400,0x3400340034003400,0xb4003400b4003400,0xb4003400b4003400,0xb5a426efb44bb35d,0x26ef35a4b35d344b,0xa6efb5a4335db44b,0xb5a426efb44bb35d,0x32afb490349032af,0xb2af3490b490b2af,0x349032afb2af3490,0xb490b2af32afb490,0x2d293582b4cfb1f7,0xb5822d2931f7b4cf,0xb5822d2931f7b4cf,0xad29b58234cf31f7
.quad 0xb505b13635053136,0xb505b13635053136,0x3136b505b1363505,0x3136b505b1363505,0x353fb03cb535b06d,0xb03cb53fb06d3535,0x303c353f306db535,0x353fb03cb535b06d,0xaf3b355c355c2f3b,0x2f3bb55cb55caf3b,0xb55caf3baf3b355c,0x355c2f3b2f3bb55c,0xb1c9b4dcb57cad91,0x34dcb1c92d91b57c,0x34dcb1c92d91b57c,0x31c934dc357c2d91
.quad 0,0,0,0,0,0,0,0,0,0,0,0,0,0,0,0
.quad 0,0,0,0,0,0,0,0,0,0,0,0,0,0,0,0
.quad 0,0,0,0,0,0,0,0,0,0,0,0,0,0,0,0
.quad 0,0,0,0,0,0,0,0,0,0,0,0,0,0,0,0
.quad 0x3400340034003400,0x3400340034003400,0xb4003400b4003400,0xb4003400b4003400,0x35a4a736344e3356,0xa736b5a43356b44e,0x273635a4b356344e,0x35a4a736344e3356,0x32a1b496349632a1,0xb2a13496b496b2a1,0x349632a1b2a13496,0xb496b2a132a1b496,0xad5db57f34d631e0,0x357fad5db1e034d6,0x357fad5db1e034d6,0x2d5d357fb4d6b1e0
.quad 0xb50eb116350e3116,0xb50eb116350e3116,0x3116b50eb116350e,0x3116b50eb116350e,0xb5363065353d3044,0x306535363044b53d,0xb065b536b044353d,0xb5363065353d3044,0xaed5356535652ed5,0x2ed5b565b565aed5,0xb565aed5aed53565,0x35652ed52ed5b565,0x31fe34cc35832d18,0xb4cc31fead183583,0xb4cc31fead183583,0xb1feb4ccb583ad18
.quad 0x3400340034003400,0x3400340034003400,0xb4003400b4003400,0xb4003400b4003400,0xb5a42736b44eb356,0x273635a4b356344e,0xa736b5a43356b44e,0xb5a42736b44eb356,0x32a1b496349632a1,0xb2a13496b496b2a1,0x349632a1b2a13496,0xb496b2a132a1b496,0x2d5d357fb4d6b1e0,0xb57f2d5d31e0b4d6,0xb57f2d5d31e0b4d6,0xad5db57f34d631e0
.quad 0xb50eb116350e3116,0xb50eb116350e3116,0x3116b50eb116350e,0x3116b50eb116350e,0x3536b065b53db044,0xb065b536b044353d,0x306535363044b53d,0x3536b065b53db044,0xaed5356535652ed5,0x2ed5b565b565aed5,0xb565aed5aed53565,0x35652ed52ed5b565,0xb1feb4ccb583ad18,0x34ccb1fe2d18b583,0x34ccb1fe2d18b583,0x31fe34cc35832d18
.quad 0,0,0,0,0,0,0,0,0,0,0,0,0,0,0,0
.quad 0,0,0,0,0,0,0,0,0,0,0,0,0,0,0,0
.quad 0,0,0,0,0,0,0,0,0,0,0,0,0,0,0,0
.quad 0,0,0,0,0,0,0,0,0,0,0,0,0,0,0,0
.quad 0x3400340034003400,0x3400340034003400,0xb4003400b4003400,0xb4003400b4003400,0x35a3a77d34513350,0xa77db5a33350b451,0x277d35a3b3503451,0x35a3a77d34513350,0x3292b49b349b3292,0xb292349bb49bb292,0x349b3292b292349b,0xb49bb2923292b49b,0xad91b57c34dc31c9,0x357cad91b1c934dc,0x357cad91b1c934dc,0x2d91357cb4dcb1c9
.quad 0xb515b0f6351530f6,0xb515b0f6351530f6,0x30f6b515b0f63515,0x30f6b515b0f63515,0xb52e308e3546301b,0x308e352e301bb546,0xb08eb52eb01b3546,0xb52e308e3546301b,0xae6f356c356c2e6f,0x2e6fb56cb56cae6f,0xb56cae6fae6f356c,0x356c2e6f2e6fb56c,0x323334bb358a2c9e,0xb4bb3233ac9e358a,0xb4bb3233ac9e358a,0xb233b4bbb58aac9e
.quad 0x3400340034003400,0x3400340034003400,0xb4003400b4003400,0xb4003400b4003400,0xb5a3277db451b350,0x277d35a3b3503451,0xa77db5a33350b451,0xb5a3277db451b350,0x3292b49b349b3292,0xb292349bb49bb292,0x349b3292b292349b,0xb49bb2923292b49b,0x2d91357cb4dcb1c9,0xb57c2d9131c9b4dc,0xb57c2d9131c9b4dc,0xad91b57c34dc31c9
.quad 0xb515b0f6351530f6,0xb515b0f6351530f6,0x30f6b515b0f63515,0x30f6b515b0f63515,0x352eb08eb546b01b,0xb08eb52eb01b3546,0x308e352e301bb546,0x352eb08eb546b01b,0xae6f356c356c2e6f,0x2e6fb56cb56cae6f,0xb56cae6fae6f356c,0x356c2e6f2e6fb56c,0xb233b4bbb58aac9e,0x34bbb2332c9eb58a,0x34bbb2332c9eb58a,0x323334bb358a2c9e
.quad 0,0,0,0,0,0,0,0,0,0,0,0,0,0,0,0
.quad 0,0,0,0,0,0,0,0,0,0,0,0,0,0,0,0
.quad 0,0,0,0,0,0,0,0,0,0,0,0,0,0,0,0
.quad 0,0,0,0,0,0,0,0,0,0,0,0,0,0,0,0
.quad 0x3400340034003400,0x3400340034003400,0xb4003400b4003400,0xb4003400b4003400,0x35a3a7c434543349,0xa7c4b5a33349b454,0x27c435a3b3493454,0x35a3a7c434543349,0x3284b4a034a03284,0xb28434a0b4a0b284,0x34a03284b28434a0,0xb4a0b2843284b4a0,0xadc4b57834e331b2,0x3578adc4b1b234e3,0x3578adc4b1b234e3,0x2dc43578b4e3b1b2
.quad 0xb51db0d6351d30d6,0xb51db0d6351d30d6,0x30d6b51db0d6351d,0x30d6b51db0d6351d,0xb52530b6354d2fe2,0x30b635252fe2b54d,0xb0b6b525afe2354d,0xb52530b6354d2fe2,0xae09357435742e09,0x2e09b574b574ae09,0xb574ae09ae093574,0x35742e092e09b574,0x326734aa35902c24,0xb4aa3267ac243590,0xb4aa3267ac243590,0xb267b4aab590ac24
.quad 0x3400340034003400,0x3400340034003400,0xb4003400b4003400,0xb4003400b4003400,0xb5a327c4b454b349,0x27c435a3b3493454,0xa7c4b5a33349b454,0xb5a327c4b454b349,0x3284b4a034a03284,0xb28434a0b4a0b284,0x34a03284b28434a0,0xb4a0b2843284b4a0,0x2dc43578b4e3b1b2,0xb5782dc431b2b4e3,0xb5782dc431b2b4e3,0xadc4b57834e331b2
.quad 0xb51db0d6351d30d6,0xb51db0d6351d30d6,0x30d6b51db0d6351d,0x30d6b51db0d6351d,0x3525b0b6b54dafe2,0xb0b6b525afe2354d,0x30b635252fe2b54d,0x3525b0b6b54dafe2,0xae09357435742e09,0x2e09b574b574ae09,0xb574ae09ae093574,0x35742e092e09b574,0xb267b4aab590ac24,0x34aab2672c24b590,0x34aab2672c24b590,0x326734aa35902c24
.quad 0,0,0,0,0,0,0,0,0,0,0,0,0,0,0,0
.quad 0,0,0,0,0,0,0,0,0,0,0,0,0,0,0,0
.quad 0,0,0,0,0,0,0,0,0,0,0,0,0,0,0,0
.quad 0,0,0,0,0,0,0,0,0,0,0,0,0,0,0,0
.quad 0x3400340034003400,0x3400340034003400,0xb4003400b4003400,0xb4003400b4003400,0x35a2a80534573342,0xa805b5a23342b457,0x280535a2b3423457,0x35a2a80534573342,0x3275b4a534a53275,0xb27534a5b4a5b275,0x34a53275b27534a5,0xb4a5b2753275b4a5,0xadf8b57534ea319b,0x3575adf8b19b34ea,0x3575adf8b19b34ea,0x2df83575b4eab19b
.quad 0xb525b0b6352530b6,0xb525b0b6352530b6,0x30b6b525b0b63525,0x30b6b525b0b63525,0xb51b30de35552f8f,0x30de351b2f8fb555,0xb0deb51baf8f3555,0xb51b30de35552f8f,0xada2357b357b2da2,0x2da2b57bb57bada2,0xb57bada2ada2357b,0x357b2da22da2b57b,0x3299349835952b53,0xb4983299ab533595,0xb4983299ab533595,0xb299b498b595ab53
.quad 0x3400340034003400,0x3400340034003400,0xb4003400b4003400,0xb4003400b4003400,0xb5a22805b457b342,0x280535a2b3423457,0xa805b5a23342b457,0xb5a22805b457b342,0x3275b4a534a53275,0xb27534a5b4a5b275,0x34a53275b27534a5,0xb4a5b2753275b4a5,0x2df83575b4eab19b,0xb5752df8319bb4ea,0xb5752df8319bb4ea,0xadf8b57534ea319b
.quad 0xb525b0b6352530b6,0xb525b0b6352530b6,0x30b6b525b0b63525,0x30b6b525b0b63525,0x351bb0deb555af8f,0xb0deb51baf8f3555,0x30de351b2f8fb555,0x351bb0deb555af8f,0xada2357b357b2da2,0x2da2b57bb57bada2,0xb57bada2ada2357b,0x357b2da22da2b57b,0xb299b498b595ab53,0x3498b2992b53b595,0x3498b2992b53b595,0x3299349835952b53
.quad 0,0,0,0,0,0,0,0,0,0,0,0,0,0,0,0
.quad 0,0,0,0,0,0,0,0,0,0,0,0,0,0,0,0
.quad 0,0,0,0,0,0,0,0,0,0,0,0,0,0,0,0
.quad 0,0,0,0,0,0,0,0,0,0,0,0,0,0,0,0
.quad 0x3400340034003400,0x3400340034003400,0xb4003400b4003400,0xb4003400b4003400,0x35a2a829345a333b,0xa829b5a2333bb45a,0x282935a2b33b345a,0x35a2a829345a333b,0x3267b4aa34aa3267,0xb26734aab4aab267,0x34aa3267b26734aa,0xb4aab2673267b4aa,0xae2bb57134f03184,0x3571ae2bb18434f0,0x3571ae2bb18434f0,0x2e2b3571b4f0b184
.quad 0xb52cb096352c3096,0xb52cb096352c3096,0x3096b52cb096352c,0x3096b52cb096352c,0xb5113106355c2f3b,0x310635112f3bb55c,0xb106b511af3b355c,0xb5113106355c2f3b,0xad3a358135812d3a,0x2d3ab581b581ad3a,0xb581ad3aad3a3581,0x35812d3a2d3ab581,0x32cc3486359a2a5e,0xb48632ccaa5e359a,0xb48632ccaa5e359a,0xb2ccb486b59aaa5e
.quad 0x3400340034003400,0x3400340034003400,0xb4003400b4003400,0xb4003400b4003400,0xb5a22829b45ab33b,0x282935a2b33b345a,0xa829b5a2333bb45a,0xb5a22829b45ab33b,0x3267b4aa34aa3267,0xb26734aab4aab267,0x34aa3267b26734aa,0xb4aab2673267b4aa,0x2e2b3571b4f0b184,0xb5712e2b3184b4f0,0xb5712e2b3184b4f0,0xae2bb57134f03184
.quad 0xb52cb096352c3096,0xb52cb096352c3096,0x3096b52cb096352c,0x3096b52cb096352c,0x3511b106b55caf3b,0xb106b511af3b355c,0x310635112f3bb55c,0x3511b106b55caf3b,0xad3a358135812d3a,0x2d3ab581b581ad3a,0xb581ad3aad3a3581,0x35812d3a2d3ab581,0xb2ccb486b59aaa5e,0x3486b2cc2a5eb59a,0x3486b2cc2a5eb59a,0x32cc3486359a2a5e
.quad 0,0,0,0,0,0,0,0,0,0,0,0,0,0,0,0
.quad 0,0,0,0,0,0,0,0,0,0,0,0,0,0,0,0
.quad 0,0,0,0,0,0,0,0,0,0,0,0,0,0,0,0
.quad 0,0,0,0,0,0,0,0,0,0,0,0,0,0,0,0
.quad 0x3400340034003400,0x3400340034003400,0xb4003400b4003400,0xb4003400b4003400,0x35a2a84c345d3334,0xa84cb5a23334b45d,0x284c35a2b334345d,0x35a2a84c345d3334,0x3258b4af34af3258,0xb25834afb4afb258,0x34af3258b25834af,0xb4afb2583258b4af,0xae5eb56e34f7316d,0x356eae5eb16d34f7,0x356eae5eb16d34f7,0x2e5e356eb4f7b16d
.quad 0xb533b07535333075,0xb533b07535333075,0x3075b533b0753533,0x3075b533b0753533,0xb507312e35632ee6,0x312e35072ee6b563,0xb12eb507aee63563,0xb507312e35632ee6,0xacd2358735872cd2,0x2cd2b587b587acd2,0xb587acd2acd23587,0x35872cd22cd2b587,0x32fd3473359e2967,0xb47332fda967359e,0xb47332fda967359e,0xb2fdb473b59ea967
.quad 0x3400340034003400,0x3400340034003400,0xb4003400b4003400,0xb4003400b4003400,0xb5a2284cb45db334,0x284c35a2b334345d,0xa84cb5a23334b45d,0xb5a2284cb45db334,0x3258b4af34af3258,0xb25834afb4afb258,0x34af3258b25834af,0xb4afb2583258b4af,0x2e5e356eb4f7b16d,0xb56e2e5e316db4f7,0xb56e2e5e316db4f7,0xae5eb56e34f7316d
.quad 0xb533b07535333075,0xb533b07535333075,0x3075b533b0753533,0x3075b533b0753533,0x3507b12eb563aee6,0xb12eb507aee63563,0x312e35072ee6b563,0x3507b12eb563aee6,0xacd2358735872cd2,0x2cd2b587b587acd2,0xb587acd2acd23587,0x35872cd22cd2b587,0xb2fdb473b59ea967,0x3473b2fd2967b59e,0x3473b2fd2967b59e,0x32fd3473359e2967
.quad 0,0,0,0,0,0,0,0,0,0,0,0,0,0,0,0
.quad 0,0,0,0,0,0,0,0,0,0,0,0,0,0,0,0
.quad 0,0,0,0,0,0,0,0,0,0,0,0,0,0,0,0
.quad 0,0,0,0,0,0,0,0,0,0,0,0,0,0,0,0
.quad 0x3400340034003400,0x3400340034003400,0xb4003400b4003400,0xb4003400b4003400,0x35a1a870345f332d,0xa870b5a1332db45f,0x287035a1b32d345f,0x35a1a870345f332d,0x3249b4b434b43249,0xb24934b4b4b4b249,0x34b43249b24934b4,0xb4b4b2493249b4b4,0xae92b56a34fd3155,0x356aae92b15534fd,0x356aae92b15534fd,0x2e92356ab4fdb155
.quad 0xb53ab054353a3054,0xb53ab054353a3054,0x3054b53ab054353a,0x3054b53ab054353a,0xb4fd3155356a2e92,0x315534fd2e92b56a,0xb155b4fdae92356a,0xb4fd3155356a2e92,0xac6a358c358c2c6a,0x2c6ab58cb58cac6a,0xb58cac6aac6a358c,0x358c2c6a2c6ab58c,0x332d345f35a12870,0xb45f332da87035a1,0xb45f332da87035a1,0xb32db45fb5a1a870
.quad 0x3400340034003400,0x3400340034003400,0xb4003400b4003400,0xb4003400b4003400,0xb5a12870b45fb32d,0x287035a1b32d345f,0xa870b5a1332db45f,0xb5a12870b45fb32d,0x3249b4b434b43249,0xb24934b4b4b4b249,0x34b43249b24934b4,0xb4b4b2493249b4b4,0x2e92356ab4fdb155,0xb56a2e923155b4fd,0xb56a2e923155b4fd,0xae92b56a34fd3155
.quad 0xb53ab054353a3054,0xb53ab054353a3054,0x3054b53ab054353a,0x3054b53ab054353a,0x34fdb155b56aae92,0xb155b4fdae92356a,0x315534fd2e92b56a,0x34fdb155b56aae92,0xac6a358c358c2c6a,0x2c6ab58cb58cac6a,0xb58cac6aac6a358c,0x358c2c6a2c6ab58c,0xb32db45fb5a1a870,0x345fb32d2870b5a1,0x345fb32d2870b5a1,0x332d345f35a12870
.quad 0,0,0,0,0,0,0,0,0,0,0,0,0,0,0,0
.quad 0,0,0,0,0,0,0,0,0,0,0,0,0,0,0,0
.quad 0,0,0,0,0,0,0,0,0,0,0,0,0,0,0,0
.quad 0,0,0,0,0,0,0,0,0,0,0,0,0,0,0,0
.quad 0x3400340034003400,0x3400340034003400,0xb4003400b4003400,0xb4003400b4003400,0x35a1a89334623327,0xa893b5a13327b462,0x289335a1b3273462,0x35a1a89334623327,0x323ab4b934b9323a,0xb23a34b9b4b9b23a,0x34b9323ab23a34b9,0xb4b9b23a323ab4b9,0xaec4b5663503313e,0x3566aec4b13e3503,0x3566aec4b13e3503,0x2ec43566b503b13e
.quad 0xb541b03335413033,0xb541b03335413033,0x3033b541b0333541,0x3033b541b0333541,0xb4f3317c35702e3c,0x317c34f32e3cb570,0xb17cb4f3ae3c3570,0xb4f3317c35702e3c,0xac01359135912c01,0x2c01b591b591ac01,0xb591ac01ac013591,0x35912c012c01b591,0x335d344b35a426ef,0xb44b335da6ef35a4,0xb44b335da6ef35a4,0xb35db44bb5a4a6ef
.quad 0x3400340034003400,0x3400340034003400,0xb4003400b4003400,0xb4003400b4003400,0xb5a12893b462b327,0x289335a1b3273462,0xa893b5a13327b462,0xb5a12893b462b327,0x323ab4b934b9323a,0xb23a34b9b4b9b23a,0x34b9323ab23a34b9,0xb4b9b23a323ab4b9,0x2ec43566b503b13e,0xb5662ec4313eb503,0xb5662ec4313eb503,0xaec4b5663503313e
.quad 0xb541b03335413033,0xb541b03335413033,0x3033b541b0333541,0x3033b541b0333541,0x34f3b17cb570ae3c,0xb17cb4f3ae3c3570,0x317c34f32e3cb570,0x34f3b17cb570ae3c,0xac01359135912c01,0x2c01b591b591ac01,0xb591ac01ac013591,0x35912c012c01b591,0xb35db44bb5a4a6ef,0x344bb35d26efb5a4,0x344bb35d26efb5a4,0x335d344b35a426ef
.quad 0,0,0,0,0,0,0,0,0,0,0,0,0,0,0,0
.quad 0,0,0,0,0,0,0,0,0,0,0,0,0,0,0,0
.quad 0,0,0,0,0,0,0,0,0,0,0,0,0,0,0,0
.quad 0,0,0,0,0,0,0,0,0,0,0,0,0,0,0,0
.quad 0x3400340034003400,0x3400340034003400,0xb4003400b4003400,0xb4003400b4003400,0x35a0a8b634653320,0xa8b6b5a03320b465,0x28b635a0b3203465,0x35a0a8b634653320,0x322bb4be34be322b,0xb22b34beb4beb22b,0x34be322bb22b34be,0xb4beb22b322bb4be,0xaef7b562350a3126,0x3562aef7b126350a,0x3562aef7b126350a,0x2ef73562b50ab126
.quad 0xb547b01235473012,0xb547b01235473012,0x3012b547b0123547,0x3012b547b0123547,0xb4e831a335762de7,0x31a334e82de7b576,0xb1a3b4e8ade73576,0xb4e831a335762de7,0xab30359635962b30,0x2b30b596b596ab30,0xb596ab30ab303596,0x35962b302b30b596,0x338c343735a624ff,0xb437338ca4ff35a6,0xb437338ca4ff35a6,0xb38cb437b5a6a4ff
.quad 0x3400340034003400,0x3400340034003400,0xb4003400b4003400,0xb4003400b4003400,0xb5a028b6b465b320,0x28b635a0b3203465,0xa8b6b5a03320b465,0xb5a028b6b465b320,0x322bb4be34be322b,0xb22b34beb4beb22b,0x34be322bb22b34be,0xb4beb22b322bb4be,0x2ef73562b50ab126,0xb5622ef73126b50a,0xb5622ef73126b50a,0xaef7b562350a3126
.quad 0xb547b01235473012,0xb547b01235473012,0x3012b547b0123547,0x3012b547b0123547,0x34e8b1a3b576ade7,0xb1a3b4e8ade73576,0x31a334e82de7b576,0x34e8b1a3b576ade7,0xab30359635962b30,0x2b30b596b596ab30,0xb596ab30ab303596,0x35962b302b30b596,0xb38cb437b5a6a4ff,0x3437b38c24ffb5a6,0x3437b38c24ffb5a6,0x338c343735a624ff
.quad 0,0,0,0,0,0,0,0,0,0,0,0,0,0,0,0
.quad 0,0,0,0,0,0,0,0,0,0,0,0,0,0,0,0
.quad 0,0,0,0,0,0,0,0,0,0,0,0,0,0,0,0
.quad 0,0,0,0,0,0,0,0,0,0,0,0,0,0,0,0
.quad 0x3400340034003400,0x3400340034003400,0xb4003400b4003400,0xb4003400b4003400,0x35a0a8da34683319,0xa8dab5a03319b468,0x28da35a0b3193468,0x35a0a8da34683319,0x321db4c334c3321d,0xb21d34c3b4c3b21d,0x34c3321db21d34c3,0xb4c3b21d321db4c3,0xaf2ab55e3510310e,0x355eaf2ab10e3510,0x355eaf2ab10e3510,0x2f2a355eb510b10e
.quad 0xb54dafe2354d2fe2,0xb54dafe2354d2fe2,0x2fe2b54dafe2354d,0x2fe2b54dafe2354d,0xb4dc31c9357c2d91,0x31c934dc2d91b57c,0xb1c9b4dcad91357c,0xb4dc31c9357c2d91,0xaa5e359a359a2a5e,0x2a5eb59ab59aaa5e,0xb59aaa5eaa5e359a,0x359a2a5e2a5eb59a,0x33ba342235a7221c,0xb42233baa21c35a7,0xb42233baa21c35a7,0xb3bab422b5a7a21c
.quad 0x3400340034003400,0x3400340034003400,0xb4003400b4003400,0xb4003400b4003400,0xb5a028dab468b319,0x28da35a0b3193468,0xa8dab5a03319b468,0xb5a028dab468b319,0x321db4c334c3321d,0xb21d34c3b4c3b21d,0x34c3321db21d34c3,0xb4c3b21d321db4c3,0x2f2a355eb510b10e,0xb55e2f2a310eb510,0xb55e2f2a310eb510,0xaf2ab55e3510310e
.quad 0xb54dafe2354d2fe2,0xb54dafe2354d2fe2,0x2fe2b54dafe2354d,0x2fe2b54dafe2354d,0x34dcb1c9b57cad91,0xb1c9b4dcad91357c,0x31c934dc2d91b57c,0x34dcb1c9b57cad91,0xaa5e359a359a2a5e,0x2a5eb59ab59aaa5e,0xb59aaa5eaa5e359a,0x359a2a5e2a5eb59a,0xb3bab422b5a7a21c,0x3422b3ba221cb5a7,0x3422b3ba221cb5a7,0x33ba342235a7221c
.quad 0,0,0,0,0,0,0,0,0,0,0,0,0,0,0,0
.quad 0,0,0,0,0,0,0,0,0,0,0,0,0,0,0,0
.quad 0,0,0,0,0,0,0,0,0,0,0,0,0,0,0,0
.quad 0,0,0,0,0,0,0,0,0,0,0,0,0,0,0,0
.quad 0x3400340034003400,0x3400340034003400,0xb4003400b4003400,0xb4003400b4003400,0x359fa8fd346b3312,0xa8fdb59f3312b46b,0x28fd359fb312346b,0x359fa8fd346b3312,0x320eb4c734c7320e,0xb20e34c7b4c7b20e,0x34c7320eb20e34c7,0xb4c7b20e320eb4c7,0xaf5cb559351530f6,0x3559af5cb0f63515,0x3559af5cb0f63515,0x2f5c3559b515b0f6
.quad 0xb554af9f35542f9f,0xb554af9f35542f9f,0x2f9fb554af9f3554,0x2f9fb554af9f3554,0xb4d131ef35812d3a,0x31ef34d12d3ab581,0xb1efb4d1ad3a3581,0xb4d131ef35812d3a,0xa98a359d359d298a,0x298ab59db59da98a,0xb59da98aa98a359d,0x359d298a298ab59d,0x33e7340c35a81c71,0xb40c33e79c7135a8,0xb40c33e79c7135a8,0xb3e7b40cb5a89c71
.quad 0x3400340034003400,0x3400340034003400,0xb4003400b4003400,0xb4003400b4003400,0xb59f28fdb46bb312,0x28fd359fb312346b,0xa8fdb59f3312b46b,0xb59f28fdb46bb312,0x320eb4c734c7320e,0xb20e34c7b4c7b20e,0x34c7320eb20e34c7,0xb4c7b20e320eb4c7,0x2f5c3559b515b0f6,0xb5592f5c30f6b515,0xb5592f5c30f6b515,0xaf5cb559351530f6
.quad 0xb554af9f35542f9f,0xb554af9f35542f9f,0x2f9fb554af9f3554,0x2f9fb554af9f3554,0x34d1b1efb581ad3a,0xb1efb4d1ad3a3581,0x31ef34d12d3ab581,0x34d1b1efb581ad3a,0xa98a359d359d298a,0x298ab59db59da98a,0xb59da98aa98a359d,0x359d298a298ab59d,0xb3e7b40cb5a89c71,0x340cb3e71c71b5a8,0x340cb3e71c71b5a8,0x33e7340c35a81c71
.quad 0,0,0,0,0,0,0,0,0,0,0,0,0,0,0,0
.quad 0,0,0,0,0,0,0,0,0,0,0,0,0,0,0,0
.quad 0,0,0,0,0,0,0,0,0,0,0,0,0,0,0,0
.quad 0,0,0,0,0,0,0,0,0,0,0,0,0,0,0,0
.quad 0x3400340034003400,0x3400340034003400,0xb4003400b4003400,0xb4003400b4003400,0x359fa920346d330b,0xa920b59f330bb46d,0x2920359fb30b346d,0x359fa920346d330b,0x31feb4cc34cc31fe,0xb1fe34ccb4ccb1fe,0x34cc31feb1fe34cc,0xb4ccb1fe31feb4cc,0xaf8fb555351b30de,0x3555af8fb0de351b,0x3555af8fb0de351b,0x2f8f3555b51bb0de
.quad 0xb559af5c35592f5c,0xb559af5c35592f5c,0x2f5cb559af5c3559,0x2f5cb559af5c3559,0xb4c5321535862ce4,0x321534c52ce4b586,0xb215b4c5ace43586,0xb4c5321535862ce4,0xa8b635a035a028b6,0x28b6b5a0b5a0a8b6,0xb5a0a8b6a8b635a0,0x35a028b628b6b5a0,0x340933ed35a89aaa,0xb3ed34091aaa35a8,0xb3ed34091aaa35a8,0xb409b3edb5a81aaa
.quad 0x3400340034003400,0x3400340034003400,0xb4003400b4003400,0xb4003400b4003400,0xb59f2920b46db30b,0x2920359fb30b346d,0xa920b59f330bb46d,0xb59f2920b46db30b,0x31feb4cc34cc31fe,0xb1fe34ccb4ccb1fe,0x34cc31feb1fe34cc,0xb4ccb1fe31feb4cc,0x2f8f3555b51bb0de,0xb5552f8f30deb51b,0xb5552f8f30deb51b,0xaf8fb555351b30de
.quad 0xb559af5c35592f5c,0xb559af5c35592f5c,0x2f5cb559af5c3559,0x2f5cb559af5c3559,0x34c5b215b586ace4,0xb215b4c5ace43586,0x321534c52ce4b586,0x34c5b215b586ace4,0xa8b635a035a028b6,0x28b6b5a0b5a0a8b6,0xb5a0a8b6a8b635a0,0x35a028b628b6b5a0,0xb409b3edb5a81aaa,0x33edb4099aaab5a8,0x33edb4099aaab5a8,0x340933ed35a89aaa
.quad 0,0,0,0,0,0,0,0,0,0,0,0,0,0,0,0
.quad 0,0,0,0,0,0,0,0,0,0,0,0,0,0,0,0
.quad 0,0,0,0,0,0,0,0,0,0,0,0,0,0,0,0
.quad 0,0,0,0,0,0,0,0,0,0,0,0,0,0,0,0
.quad 0x3400340034003400,0x3400340034003400,0xb4003400b4003400,0xb4003400b4003400,0x359ea94434703304,0xa944b59e3304b470,0x2944359eb3043470,0x359ea94434703304,0x31efb4d134d131ef,0xb1ef34d1b4d1b1ef,0x34d131efb1ef34d1,0xb4d1b1ef31efb4d1,0xafc1b550352130c6,0x3550afc1b0c63521,0x3550afc1b0c63521,0x2fc13550b521b0c6
.quad 0xb55faf19355f2f19,0xb55faf19355f2f19,0x2f19b55faf19355f,0x2f19b55faf19355f,0xb4b9323a358b2c8d,0x323a34b92c8db58b,0xb23ab4b9ac8d358b,0xb4b9323a358b2c8d,0xa7c435a335a327c4,0x27c4b5a3b5a3a7c4,0xb5a3a7c4a7c435a3,0x35a327c427c4b5a3,0x341f33c035a7a18d,0xb3c0341f218d35a7,0xb3c0341f218d35a7,0xb41fb3c0b5a7218d
.quad 0x3400340034003400,0x3400340034003400,0xb4003400b4003400,0xb4003400b4003400,0xb59e2944b470b304,0x2944359eb3043470,0xa944b59e3304b470,0xb59e2944b470b304,0x31efb4d134d131ef,0xb1ef34d1b4d1b1ef,0x34d131efb1ef34d1,0xb4d1b1ef31efb4d1,0x2fc13550b521b0c6,0xb5502fc130c6b521,0xb5502fc130c6b521,0xafc1b550352130c6
.quad 0xb55faf19355f2f19,0xb55faf19355f2f19,0x2f19b55faf19355f,0x2f19b55faf19355f,0x34b9b23ab58bac8d,0xb23ab4b9ac8d358b,0x323a34b92c8db58b,0x34b9b23ab58bac8d,0xa7c435a335a327c4,0x27c4b5a3b5a3a7c4,0xb5a3a7c4a7c435a3,0x35a327c427c4b5a3,0xb41fb3c0b5a7218d,0x33c0b41fa18db5a7,0x33c0b41fa18db5a7,0x341f33c035a7a18d
.quad 0,0,0,0,0,0,0,0,0,0,0,0,0,0,0,0
.quad 0,0,0,0,0,0,0,0,0,0,0,0,0,0,0,0
.quad 0,0,0,0,0,0,0,0,0,0,0,0,0,0,0,0
.quad 0,0,0,0,0,0,0,0,0,0,0,0,0,0,0,0
.quad 0x3400340034003400,0x3400340034003400,0xb4003400b4003400,0xb4003400b4003400,0x359ea967347332fd,0xa967b59e32fdb473,0x2967359eb2fd3473,0x359ea967347332fd,0x31e0b4d634d631e0,0xb1e034d6b4d6b1e0,0x34d631e0b1e034d6,0xb4d6b1e031e0b4d6,0xaff3b54c352630ae,0x354caff3b0ae3526,0x354caff3b0ae3526,0x2ff3354cb526b0ae
.quad 0xb565aed535652ed5,0xb565aed535652ed5,0x2ed5b565aed53565,0x2ed5b565aed53565,0xb4ad325f358f2c36,0x325f34ad2c36b58f,0xb25fb4adac36358f,0xb4ad325f358f2c36,0xa61b35a535a5261b,0x261bb5a5b5a5a61b,0xb5a5a61ba61b35a5,0x35a5261b261bb5a5,0x3434339235a6a4b8,0xb392343424b835a6,0xb392343424b835a6,0xb434b392b5a624b8
.quad 0x3400340034003400,0x3400340034003400,0xb4003400b4003400,0xb4003400b4003400,0xb59e2967b473b2fd,0x2967359eb2fd3473,0xa967b59e32fdb473,0xb59e2967b473b2fd,0x31e0b4d634d631e0,0xb1e034d6b4d6b1e0,0x34d631e0b1e034d6,0xb4d6b1e031e0b4d6,0x2ff3354cb526b0ae,0xb54c2ff330aeb526,0xb54c2ff330aeb526,0xaff3b54c352630ae
.quad 0xb565aed535652ed5,0xb565aed535652ed5,0x2ed5b565aed53565,0x2ed5b565aed53565,0x34adb25fb58fac36,0xb25fb4adac36358f,0x325f34ad2c36b58f,0x34adb25fb58fac36,0xa61b35a535a5261b,0x261bb5a5b5a5a61b,0xb5a5a61ba61b35a5,0x35a5261b261bb5a5,0xb434b392b5a624b8,0x3392b434a4b8b5a6,0x3392b434a4b8b5a6,0x3434339235a6a4b8
.quad 0,0,0,0,0,0,0,0,0,0,0,0,0,0,0,0
.quad 0,0,0,0,0,0,0,0,0,0,0,0,0,0,0,0
.quad 0,0,0,0,0,0,0,0,0,0,0,0,0,0,0,0
.quad 0,0,0,0,0,0,0,0,0,0,0,0,0,0,0,0
.quad 0x3400340034003400,0x3400340034003400,0xb4003400b4003400,0xb4003400b4003400,0x359da98a347632f6,0xa98ab59d32f6b476,0x298a359db2f63476,0x359da98a347632f6,0x31d1b4da34da31d1,0xb1d134dab4dab1d1,0x34da31d1b1d134da,0xb4dab1d131d1b4da,0xb012b547352c3096,0x3547b012b096352c,0x3547b012b096352c,0x30123547b52cb096
.quad 0xb56aae92356a2e92,0xb56aae92356a2e92,0x2e92b56aae92356a,0x2e92b56aae92356a,0xb4a0328435932bbd,0x328434a02bbdb593,0xb284b4a0abbd3593,0xb4a0328435932bbd,0xa47135a635a62471,0x2471b5a6b5a6a471,0xb5a6a471a47135a6,0x35a624712471b5a6,0x3449336435a4a6a9,0xb364344926a935a4,0xb364344926a935a4,0xb449b364b5a426a9
.quad 0x3400340034003400,0x3400340034003400,0xb4003400b4003400,0xb4003400b4003400,0xb59d298ab476b2f6,0x298a359db2f63476,0xa98ab59d32f6b476,0xb59d298ab476b2f6,0x31d1b4da34da31d1,0xb1d134dab4dab1d1,0x34da31d1b1d134da,0xb4dab1d131d1b4da,0x30123547b52cb096,0xb54730123096b52c,0xb54730123096b52c,0xb012b547352c3096
.quad 0xb56aae92356a2e92,0xb56aae92356a2e92,0x2e92b56aae92356a,0x2e92b56aae92356a,0x34a0b284b593abbd,0xb284b4a0abbd3593,0x328434a02bbdb593,0x34a0b284b593abbd,0xa47135a635a62471,0x2471b5a6b5a6a471,0xb5a6a471a47135a6,0x35a624712471b5a6,0xb449b364b5a426a9,0x3364b449a6a9b5a4,0x3364b449a6a9b5a4,0x3449336435a4a6a9
.quad 0,0,0,0,0,0,0,0,0,0,0,0,0,0,0,0
.quad 0,0,0,0,0,0,0,0,0,0,0,0,0,0,0,0
.quad 0,0,0,0,0,0,0,0,0,0,0,0,0,0,0,0
.quad 0,0,0,0,0,0,0,0,0,0,0,0,0,0,0,0
.quad 0x3400340034003400,0x3400340034003400,0xb4003400b4003400,0xb4003400b4003400,0x359da9ad347832ef,0xa9adb59d32efb478,0x29ad359db2ef3478,0x359da9ad347832ef,0x31c2b4df34df31c2,0xb1c234dfb4dfb1c2,0x34df31c2b1c234df,0xb4dfb1c231c2b4df,0xb02bb5423531307d,0x3542b02bb07d3531,0x3542b02bb07d3531,0x302b3542b531b07d
.quad 0xb56fae4d356f2e4d,0xb56fae4d356f2e4d,0x2e4db56fae4d356f,0x2e4db56fae4d356f,0xb49332a835962b0d,0x32a834932b0db596,0xb2a8b493ab0d3596,0xb49332a835962b0d,0xa18d35a735a7218d,0x218db5a7b5a7a18d,0xb5a7a18da18d35a7,0x35a7218d218db5a7,0x345d333435a2a84c,0xb334345d284c35a2,0xb334345d284c35a2,0xb45db334b5a2284c
.quad 0x3400340034003400,0x3400340034003400,0xb4003400b4003400,0xb4003400b4003400,0xb59d29adb478b2ef,0x29ad359db2ef3478,0xa9adb59d32efb478,0xb59d29adb478b2ef,0x31c2b4df34df31c2,0xb1c234dfb4dfb1c2,0x34df31c2b1c234df,0xb4dfb1c231c2b4df,0x302b3542b531b07d,0xb542302b307db531,0xb542302b307db531,0xb02bb5423531307d
.quad 0xb56fae4d356f2e4d,0xb56fae4d356f2e4d,0x2e4db56fae4d356f,0x2e4db56fae4d356f,0x3493b2a8b596ab0d,0xb2a8b493ab0d3596,0x32a834932b0db596,0x3493b2a8b596ab0d,0xa18d35a735a7218d,0x218db5a7b5a7a18d,0xb5a7a18da18d35a7,0x35a7218d218db5a7,0xb45db334b5a2284c,0x3334b45da84cb5a2,0x3334b45da84cb5a2,0x345d333435a2a84c
.quad 0,0,0,0,0,0,0,0,0,0,0,0,0,0,0,0
.quad 0,0,0,0,0,0,0,0,0,0,0,0,0,0,0,0
.quad 0,0,0,0,0,0,0,0,0,0,0,0,0,0,0,0
.quad 0,0,0,0,0,0,0,0,0,0,0,0,0,0,0,0
.quad 0x3400340034003400,0x3400340034003400,0xb4003400b4003400,0xb4003400b4003400,0x359ca9d1347b32e8,0xa9d1b59c32e8b47b,0x29d1359cb2e8347b,0x359ca9d1347b32e8,0x31b2b4e334e331b2,0xb1b234e3b4e3b1b2,0x34e331b2b1b234e3,0xb4e3b1b231b2b4e3,0xb044b53d35363065,0x353db044b0653536,0x353db044b0653536,0x3044353db536b065
.quad 0xb574ae0935742e09,0xb574ae0935742e09,0x2e09b574ae093574,0x2e09b574ae093574,0xb48632cc359a2a5e,0x32cc34862a5eb59a,0xb2ccb486aa5e359a,0xb48632cc359a2a5e,0x9c7135a835a81c71,0x1c71b5a8b5a89c71,0xb5a89c719c7135a8,0x35a81c711c71b5a8,0x34703304359ea944,0xb30434702944359e,0xb30434702944359e,0xb470b304b59e2944
.quad 0x3400340034003400,0x3400340034003400,0xb4003400b4003400,0xb4003400b4003400,0xb59c29d1b47bb2e8,0x29d1359cb2e8347b,0xa9d1b59c32e8b47b,0xb59c29d1b47bb2e8,0x31b2b4e334e331b2,0xb1b234e3b4e3b1b2,0x34e331b2b1b234e3,0xb4e3b1b231b2b4e3,0x3044353db536b065,0xb53d30443065b536,0xb53d30443065b536,0xb044b53d35363065
.quad 0xb574ae0935742e09,0xb574ae0935742e09,0x2e09b574ae093574,0x2e09b574ae093574,0x3486b2ccb59aaa5e,0xb2ccb486aa5e359a,0x32cc34862a5eb59a,0x3486b2ccb59aaa5e,0x9c7135a835a81c71,0x1c71b5a8b5a89c71,0xb5a89c719c7135a8,0x35a81c711c71b5a8,0xb470b304b59e2944,0x3304b470a944b59e,0x3304b470a944b59e,0x34703304359ea944
.quad 0,0,0,0,0,0,0,0,0,0,0,0,0,0,0,0
.quad 0,0,0,0,0,0,0,0,0,0,0,0,0,0,0,0
.quad 0,0,0,0,0,0,0,0,0,0,0,0,0,0,0,0
.quad 0,0,0,0,0,0,0,0,0,0,0,0,0,0,0,0
.quad 0x3400340034003400,0x3400340034003400,0xb4003400b4003400,0xb4003400b4003400,0x359ca9f4347e32e1,0xa9f4b59c32e1b47e,0x29f4359cb2e1347e,0x359ca9f4347e32e1,0x31a3b4e834e831a3,0xb1a334e8b4e8b1a3,0x34e831a3b1a334e8,0xb4e8b1a331a3b4e8,0xb05db538353c304c,0x3538b05db04c353c,0x3538b05db04c353c,0x305d3538b53cb04c
.quad 0xb578adc435782dc4,0xb578adc435782dc4,0x2dc4b578adc43578,0x2dc4b578adc43578,0xb47832ef359d29ad,0x32ef347829adb59d,0xb2efb478a9ad359d,0xb47832ef359d29ad,0x187135a835a89871,0x9871b5a8b5a81871,0xb5a81871187135a8,0x35a898719871b5a8,0x348332d3359aaa3a,0xb2d334832a3a359a,0xb2d334832a3a359a,0xb483b2d3b59a2a3a
.quad 0x3400340034003400,0x3400340034003400,0xb4003400b4003400,0xb4003400b4003400,0xb59c29f4b47eb2e1,0x29f4359cb2e1347e,0xa9f4b59c32e1b47e,0xb59c29f4b47eb2e1,0x31a3b4e834e831a3,0xb1a334e8b4e8b1a3,0x34e831a3b1a334e8,0xb4e8b1a331a3b4e8,0x305d3538b53cb04c,0xb538305d304cb53c,0xb538305d304cb53c,0xb05db538353c304c
.quad 0xb578adc435782dc4,0xb578adc435782dc4,0x2dc4b578adc43578,0x2dc4b578adc43578,0x3478b2efb59da9ad,0xb2efb478a9ad359d,0x32ef347829adb59d,0x3478b2efb59da9ad,0x187135a835a89871,0x9871b5a8b5a81871,0xb5a81871187135a8,0x35a898719871b5a8,0xb483b2d3b59a2a3a,0x32d3b483aa3ab59a,0x32d3b483aa3ab59a,0x348332d3359aaa3a
.quad 0,0,0,0,0,0,0,0,0,0,0,0,0,0,0,0
.quad 0,0,0,0,0,0,0,0,0,0,0,0,0,0,0,0
.quad 0,0,0,0,0,0,0,0,0,0,0,0,0,0,0,0
.quad 0,0,0,0,0,0,0,0,0,0,0,0,0,0,0,0
.quad 0x3400340034003400,0x3400340034003400,0xb4003400b4003400,0xb4003400b4003400,0x359baa17348032da,0xaa17b59b32dab480,0x2a17359bb2da3480,0x359baa17348032da,0x3194b4ec34ec3194,0xb19434ecb4ecb194,0x34ec3194b19434ec,0xb4ecb1943194b4ec,0xb075b53335413033,0x3533b075b0333541,0x3533b075b0333541,0x30753533b541b033
.quad 0xb57dad7f357d2d7f,0xb57dad7f357d2d7f,0x2d7fb57dad7f357d,0x2d7fb57dad7f357d,0xb46b3312359f28fd,0x3312346b28fdb59f,0xb312b46ba8fd359f,0xb46b3312359f28fd,0x207135a835a8a071,0xa071b5a8b5a82071,0xb5a82071207135a8,0x35a8a071a071b5a8,0x349632a13596ab30,0xb2a134962b303596,0xb2a134962b303596,0xb496b2a1b5962b30
.quad 0x3400340034003400,0x3400340034003400,0xb4003400b4003400,0xb4003400b4003400,0xb59b2a17b480b2da,0x2a17359bb2da3480,0xaa17b59b32dab480,0xb59b2a17b480b2da,0x3194b4ec34ec3194,0xb19434ecb4ecb194,0x34ec3194b19434ec,0xb4ecb1943194b4ec,0x30753533b541b033,0xb53330753033b541,0xb53330753033b541,0xb075b53335413033
.quad 0xb57dad7f357d2d7f,0xb57dad7f357d2d7f,0x2d7fb57dad7f357d,0x2d7fb57dad7f357d,0x346bb312b59fa8fd,0xb312b46ba8fd359f,0x3312346b28fdb59f,0x346bb312b59fa8fd,0x207135a835a8a071,0xa071b5a8b5a82071,0xb5a82071207135a8,0x35a8a071a071b5a8,0xb496b2a1b5962b30,0x32a1b496ab30b596,0x32a1b496ab30b596,0x349632a13596ab30
.quad 0,0,0,0,0,0,0,0,0,0,0,0,0,0,0,0
.quad 0,0,0,0,0,0,0,0,0,0,0,0,0,0,0,0
.quad 0,0,0,0,0,0,0,0,0,0,0,0,0,0,0,0
.quad 0,0,0,0,0,0,0,0,0,0,0,0,0,0,0,0
.quad 0x3400340034003400,0x3400340034003400,0xb4003400b4003400,0xb4003400b4003400,0x359aaa3a348332d3,0xaa3ab59a32d3b483,0x2a3a359ab2d33483,0x359aaa3a348332d3,0x3184b4f034f03184,0xb18434f0b4f0b184,0x34f03184b18434f0,0xb4f0b1843184b4f0,0xb08eb52e3546301b,0x352eb08eb01b3546,0x352eb08eb01b3546,0x308e352eb546b01b
.quad 0xb581ad3a35812d3a,0xb581ad3a35812d3a,0x2d3ab581ad3a3581,0x2d3ab581ad3a3581,0xb45d333435a2284c,0x3334345d284cb5a2,0xb334b45da84c35a2,0xb45d333435a2284c,0x23c635a735a7a3c6,0xa3c6b5a7b5a723c6,0xb5a723c623c635a7,0x35a7a3c6a3c6b5a7,0x34a8326e3590ac13,0xb26e34a82c133590,0xb26e34a82c133590,0xb4a8b26eb5902c13
.quad 0x3400340034003400,0x3400340034003400,0xb4003400b4003400,0xb4003400b4003400,0xb59a2a3ab483b2d3,0x2a3a359ab2d33483,0xaa3ab59a32d3b483,0xb59a2a3ab483b2d3,0x3184b4f034f03184,0xb18434f0b4f0b184,0x34f03184b18434f0,0xb4f0b1843184b4f0,0x308e352eb546b01b,0xb52e308e301bb546,0xb52e308e301bb546,0xb08eb52e3546301b
.quad 0xb581ad3a35812d3a,0xb581ad3a35812d3a,0x2d3ab581ad3a3581,0x2d3ab581ad3a3581,0x345db334b5a2a84c,0xb334b45da84c35a2,0x3334345d284cb5a2,0x345db334b5a2a84c,0x23c635a735a7a3c6,0xa3c6b5a7b5a723c6,0xb5a723c623c635a7,0x35a7a3c6a3c6b5a7,0xb4a8b26eb5902c13,0x326eb4a8ac13b590,0x326eb4a8ac13b590,0x34a8326e3590ac13
.quad 0,0,0,0,0,0,0,0,0,0,0,0,0,0,0,0
.quad 0,0,0,0,0,0,0,0,0,0,0,0,0,0,0,0
.quad 0,0,0,0,0,0,0,0,0,0,0,0,0,0,0,0
.quad 0,0,0,0,0,0,0,0,0,0,0,0,0,0,0,0
.quad 0x3400340034003400,0x3400340034003400,0xb4003400b4003400,0xb4003400b4003400,0x359aaa5e348632cc,0xaa5eb59a32ccb486,0x2a5e359ab2cc3486,0x359aaa5e348632cc,0x3175b4f534f53175,0xb17534f5b4f5b175,0x34f53175b17534f5,0xb4f5b1753175b4f5,0xb0a6b528354a3002,0x3528b0a6b002354a,0x3528b0a6b002354a,0x30a63528b54ab002
.quad 0xb585acf535852cf5,0xb585acf535852cf5,0x2cf5b585acf53585,0x2cf5b585acf53585,0xb44e335635a42736,0x3356344e2736b5a4,0xb356b44ea73635a4,0xb44e335635a42736,0x258d35a535a5a58d,0xa58db5a5b5a5258d,0xb5a5258d258d35a5,0x35a5a58da58db5a5,0x34b9323a358bac8d,0xb23a34b92c8d358b,0xb23a34b92c8d358b,0xb4b9b23ab58b2c8d
.quad 0x3400340034003400,0x3400340034003400,0xb4003400b4003400,0xb4003400b4003400,0xb59a2a5eb486b2cc,0x2a5e359ab2cc3486,0xaa5eb59a32ccb486,0xb59a2a5eb486b2cc,0x3175b4f534f53175,0xb17534f5b4f5b175,0x34f53175b17534f5,0xb4f5b1753175b4f5,0x30a63528b54ab002,0xb52830a63002b54a,0xb52830a63002b54a,0xb0a6b528354a3002
.quad 0xb585acf535852cf5,0xb585acf535852cf5,0x2cf5b585acf53585,0x2cf5b585acf53585,0x344eb356b5a4a736,0xb356b44ea73635a4,0x3356344e2736b5a4,0x344eb356b5a4a736,0x258d35a535a5a58d,0xa58db5a5b5a5258d,0xb5a5258d258d35a5,0x35a5a58da58db5a5,0xb4b9b23ab58b2c8d,0x323ab4b9ac8db58b,0x323ab4b9ac8db58b,0x34b9323a358bac8d
.quad 0,0,0,0,0,0,0,0,0,0,0,0,0,0,0,0
.quad 0,0,0,0,0,0,0,0,0,0,0,0,0,0,0,0
.quad 0,0,0,0,0,0,0,0,0,0,0,0,0,0,0,0
.quad 0,0,0,0,0,0,0,0,0,0,0,0,0,0,0,0
.quad 0x3400340034003400,0x3400340034003400,0xb4003400b4003400,0xb4003400b4003400,0x3599aa81348932c4,0xaa81b59932c4b489,0x2a813599b2c43489,0x3599aa81348932c4,0x3165b4f934f93165,0xb16534f9b4f9b165,0x34f93165b16534f9,0xb4f9b1653165b4f9,0xb0beb523354f2fd2,0x3523b0beafd2354f,0x3523b0beafd2354f,0x30be3523b54fafd2
.quad 0xb589acb035892cb0,0xb589acb035892cb0,0x2cb0b589acb03589,0x2cb0b589acb03589,0xb440337835a525d4,0x3378344025d4b5a5,0xb378b440a5d435a5,0xb440337835a525d4,0x273635a435a4a736,0xa736b5a4b5a42736,0xb5a42736273635a4,0x35a4a736a736b5a4,0x34ca32063584ad07,0xb20634ca2d073584,0xb20634ca2d073584,0xb4cab206b5842d07
.quad 0x3400340034003400,0x3400340034003400,0xb4003400b4003400,0xb4003400b4003400,0xb5992a81b489b2c4,0x2a813599b2c43489,0xaa81b59932c4b489,0xb5992a81b489b2c4,0x3165b4f934f93165,0xb16534f9b4f9b165,0x34f93165b16534f9,0xb4f9b1653165b4f9,0x30be3523b54fafd2,0xb52330be2fd2b54f,0xb52330be2fd2b54f,0xb0beb523354f2fd2
.quad 0xb589acb035892cb0,0xb589acb035892cb0,0x2cb0b589acb03589,0x2cb0b589acb03589,0x3440b378b5a5a5d4,0xb378b440a5d435a5,0x3378344025d4b5a5,0x3440b378b5a5a5d4,0x273635a435a4a736,0xa736b5a4b5a42736,0xb5a42736273635a4,0x35a4a736a736b5a4,0xb4cab206b5842d07,0x3206b4caad07b584,0x3206b4caad07b584,0x34ca32063584ad07
.quad 0,0,0,0,0,0,0,0,0,0,0,0,0,0,0,0
.quad 0,0,0,0,0,0,0,0,0,0,0,0,0,0,0,0
.quad 0,0,0,0,0,0,0,0,0,0,0,0,0,0,0,0
.quad 0,0,0,0,0,0,0,0,0,0,0,0,0,0,0,0
.quad 0x3400340034003400,0x3400340034003400,0xb4003400b4003400,0xb4003400b4003400,0x3598aaa4348b32bd,0xaaa4b59832bdb48b,0x2aa43598b2bd348b,0x3598aaa4348b32bd,0x3155b4fd34fd3155,0xb15534fdb4fdb155,0x34fd3155b15534fd,0xb4fdb1553155b4fd,0xb0d6b51d35542f9f,0x351db0d6af9f3554,0x351db0d6af9f3554,0x30d6351db554af9f
.quad 0xb58cac6a358c2c6a,0xb58cac6a358c2c6a,0x2c6ab58cac6a358c,0x2c6ab58cac6a358c,0xb431339935a62471,0x339934312471b5a6,0xb399b431a47135a6,0xb431339935a62471,0x287035a135a1a870,0xa870b5a1b5a12870,0xb5a12870287035a1,0x35a1a870a870b5a1,0x34da31d1357dad7f,0xb1d134da2d7f357d,0xb1d134da2d7f357d,0xb4dab1d1b57d2d7f
.quad 0x3400340034003400,0x3400340034003400,0xb4003400b4003400,0xb4003400b4003400,0xb5982aa4b48bb2bd,0x2aa43598b2bd348b,0xaaa4b59832bdb48b,0xb5982aa4b48bb2bd,0x3155b4fd34fd3155,0xb15534fdb4fdb155,0x34fd3155b15534fd,0xb4fdb1553155b4fd,0x30d6351db554af9f,0xb51d30d62f9fb554,0xb51d30d62f9fb554,0xb0d6b51d35542f9f
.quad 0xb58cac6a358c2c6a,0xb58cac6a358c2c6a,0x2c6ab58cac6a358c,0x2c6ab58cac6a358c,0x3431b399b5a6a471,0xb399b431a47135a6,0x339934312471b5a6,0x3431b399b5a6a471,0x287035a135a1a870,0xa870b5a1b5a12870,0xb5a12870287035a1,0x35a1a870a870b5a1,0xb4dab1d1b57d2d7f,0x31d1b4daad7fb57d,0x31d1b4daad7fb57d,0x34da31d1357dad7f
.quad 0,0,0,0,0,0,0,0,0,0,0,0,0,0,0,0
.quad 0,0,0,0,0,0,0,0,0,0,0,0,0,0,0,0
.quad 0,0,0,0,0,0,0,0,0,0,0,0,0,0,0,0
.quad 0,0,0,0,0,0,0,0,0,0,0,0,0,0,0,0
.quad 0x3400340034003400,0x3400340034003400,0xb4003400b4003400,0xb4003400b4003400,0x3598aac7348e32b6,0xaac7b59832b6b48e,0x2ac73598b2b6348e,0x3598aac7348e32b6,0x3146b50135013146,0xb1463501b501b146,0x35013146b1463501,0xb501b1463146b501,0xb0eeb51735582f6d,0x3517b0eeaf6d3558,0x3517b0eeaf6d3558,0x30ee3517b558af6d
.quad 0xb590ac2435902c24,0xb590ac2435902c24,0x2c24b590ac243590,0x2c24b590ac243590,0xb42233ba35a7221c,0x33ba3422221cb5a7,0xb3bab422a21c35a7,0xb42233ba35a7221c,0x2944359e359ea944,0xa944b59eb59e2944,0xb59e29442944359e,0x359ea944a944b59e,0x34ea319b3575adf8,0xb19b34ea2df83575,0xb19b34ea2df83575,0xb4eab19bb5752df8
.quad 0x3400340034003400,0x3400340034003400,0xb4003400b4003400,0xb4003400b4003400,0xb5982ac7b48eb2b6,0x2ac73598b2b6348e,0xaac7b59832b6b48e,0xb5982ac7b48eb2b6,0x3146b50135013146,0xb1463501b501b146,0x35013146b1463501,0xb501b1463146b501,0x30ee3517b558af6d,0xb51730ee2f6db558,0xb51730ee2f6db558,0xb0eeb51735582f6d
.quad 0xb590ac2435902c24,0xb590ac2435902c24,0x2c24b590ac243590,0x2c24b590ac243590,0x3422b3bab5a7a21c,0xb3bab422a21c35a7,0x33ba3422221cb5a7,0x3422b3bab5a7a21c,0x2944359e359ea944,0xa944b59eb59e2944,0xb59e29442944359e,0x359ea944a944b59e,0xb4eab19bb5752df8,0x319bb4eaadf8b575,0x319bb4eaadf8b575,0x34ea319b3575adf8
.quad 0,0,0,0,0,0,0,0,0,0,0,0,0,0,0,0
.quad 0,0,0,0,0,0,0,0,0,0,0,0,0,0,0,0
.quad 0,0,0,0,0,0,0,0,0,0,0,0,0,0,0,0
.quad 0,0,0,0,0,0,0,0,0,0,0,0,0,0,0,0
.quad 0x3400340034003400,0x3400340034003400,0xb4003400b4003400,0xb4003400b4003400,0x3597aaea349032af,0xaaeab59732afb490,0x2aea3597b2af3490,0x3597aaea349032af,0x3136b50535053136,0xb1363505b505b136,0x35053136b1363505,0xb505b1363136b505,0xb106b511355c2f3b,0x3511b106af3b355c,0x3511b106af3b355c,0x31063511b55caf3b
.quad 0xb593abbd35932bbd,0xb593abbd35932bbd,0x2bbdb593abbd3593,0x2bbdb593abbd3593,0xb41333da35a81eaa,0x33da34131eaab5a8,0xb3dab4139eaa35a8,0xb41333da35a81eaa,0x2a17359b359baa17,0xaa17b59bb59b2a17,0xb59b2a172a17359b,0x359baa17aa17b59b,0x34f93165356cae6f,0xb16534f92e6f356c,0xb16534f92e6f356c,0xb4f9b165b56c2e6f
.quad 0x3400340034003400,0x3400340034003400,0xb4003400b4003400,0xb4003400b4003400,0xb5972aeab490b2af,0x2aea3597b2af3490,0xaaeab59732afb490,0xb5972aeab490b2af,0x3136b50535053136,0xb1363505b505b136,0x35053136b1363505,0xb505b1363136b505,0x31063511b55caf3b,0xb51131062f3bb55c,0xb51131062f3bb55c,0xb106b511355c2f3b
.quad 0xb593abbd35932bbd,0xb593abbd35932bbd,0x2bbdb593abbd3593,0x2bbdb593abbd3593,0x3413b3dab5a89eaa,0xb3dab4139eaa35a8,0x33da34131eaab5a8,0x3413b3dab5a89eaa,0x2a17359b359baa17,0xaa17b59bb59b2a17,0xb59b2a172a17359b,0x359baa17aa17b59b,0xb4f9b165b56c2e6f,0x3165b4f9ae6fb56c,0x3165b4f9ae6fb56c,0x34f93165356cae6f
.quad 0,0,0,0,0,0,0,0,0,0,0,0,0,0,0,0
.quad 0,0,0,0,0,0,0,0,0,0,0,0,0,0,0,0
.quad 0,0,0,0,0,0,0,0,0,0,0,0,0,0,0,0
.quad 0,0,0,0,0,0,0,0,0,0,0,0,0,0,0,0
.quad 0x3400340034003400,0x3400340034003400,0xb4003400b4003400,0xb4003400b4003400,0x3596ab0d349332a8,0xab0db59632a8b493,0x2b0d3596b2a83493,0x3596ab0d349332a8,0x3126b50a350a3126,0xb126350ab50ab126,0x350a3126b126350a,0xb50ab1263126b50a,0xb11eb50c35602f08,0x350cb11eaf083560,0x350cb11eaf083560,0x311e350cb560af08
.quad 0xb596ab3035962b30,0xb596ab3035962b30,0x2b30b596ab303596,0x2b30b596ab303596,0xb40333fa35a81471,0x33fa34031471b5a8,0xb3fab403947135a8,0xb40333fa35a81471,0x2aea35973597aaea,0xaaeab597b5972aea,0xb5972aea2aea3597,0x3597aaeaaaeab597,0x3507312e3563aee6,0xb12e35072ee63563,0xb12e35072ee63563,0xb507b12eb5632ee6
.quad 0x3400340034003400,0x3400340034003400,0xb4003400b4003400,0xb4003400b4003400,0xb5962b0db493b2a8,0x2b0d3596b2a83493,0xab0db59632a8b493,0xb5962b0db493b2a8,0x3126b50a350a3126,0xb126350ab50ab126,0x350a3126b126350a,0xb50ab1263126b50a,0x311e350cb560af08,0xb50c311e2f08b560,0xb50c311e2f08b560,0xb11eb50c35602f08
.quad 0xb596ab3035962b30,0xb596ab3035962b30,0x2b30b596ab303596,0x2b30b596ab303596,0x3403b3fab5a89471,0xb3fab403947135a8,0x33fa34031471b5a8,0x3403b3fab5a89471,0x2aea35973597aaea,0xaaeab597b5972aea,0xb5972aea2aea3597,0x3597aaeaaaeab597,0xb507b12eb5632ee6,0x312eb507aee6b563,0x312eb507aee6b563,0x3507312e3563aee6
.quad 0,0,0,0,0,0,0,0,0,0,0,0,0,0,0,0
.quad 0,0,0,0,0,0,0,0,0,0,0,0,0,0,0,0
.quad 0,0,0,0,0,0,0,0,0,0,0,0,0,0,0,0
.quad 0,0,0,0,0,0,0,0,0,0,0,0,0,0,0,0
.quad 0x3400340034003400,0x3400340034003400,0xb4003400b4003400,0xb4003400b4003400,0x3596ab30349632a1,0xab30b59632a1b496,0x2b303596b2a13496,0x3596ab30349632a1,0x3116b50e350e3116,0xb116350eb50eb116,0x350e3116b116350e,0xb50eb1163116b50e,0xb136b50535652ed5,0x3505b136aed53565,0x3505b136aed53565,0x31363505b565aed5
.quad 0xb598aaa435982aa4,0xb598aaa435982aa4,0x2aa4b598aaa43598,0x2aa4b598aaa43598,0xb3e7340c35a89c71,0x340c33e79c71b5a8,0xb40cb3e71c7135a8,0xb3e7340c35a89c71,0x2bbd35933593abbd,0xabbdb593b5932bbd,0xb5932bbd2bbd3593,0x3593abbdabbdb593,0x351530f63559af5c,0xb0f635152f5c3559,0xb0f635152f5c3559,0xb515b0f6b5592f5c
.quad 0x3400340034003400,0x3400340034003400,0xb4003400b4003400,0xb4003400b4003400,0xb5962b30b496b2a1,0x2b303596b2a13496,0xab30b59632a1b496,0xb5962b30b496b2a1,0x3116b50e350e3116,0xb116350eb50eb116,0x350e3116b116350e,0xb50eb1163116b50e,0x31363505b565aed5,0xb50531362ed5b565,0xb50531362ed5b565,0xb136b50535652ed5
.quad 0xb598aaa435982aa4,0xb598aaa435982aa4,0x2aa4b598aaa43598,0x2aa4b598aaa43598,0x33e7b40cb5a81c71,0xb40cb3e71c7135a8,0x340c33e79c71b5a8,0x33e7b40cb5a81c71,0x2bbd35933593abbd,0xabbdb593b5932bbd,0xb5932bbd2bbd3593,0x3593abbdabbdb593,0xb515b0f6b5592f5c,0x30f6b515af5cb559,0x30f6b515af5cb559,0x351530f63559af5c
.quad 0,0,0,0,0,0,0,0,0,0,0,0,0,0,0,0
.quad 0,0,0,0,0,0,0,0,0,0,0,0,0,0,0,0
.quad 0,0,0,0,0,0,0,0,0,0,0,0,0,0,0,0
.quad 0,0,0,0,0,0,0,0,0,0,0,0,0,0,0,0
.quad 0x3400340034003400,0x3400340034003400,0xb4003400b4003400,0xb4003400b4003400,0x3595ab5334983299,0xab53b5953299b498,0x2b533595b2993498,0x3595ab5334983299,0x3106b51135113106,0xb1063511b511b106,0x35113106b1063511,0xb511b1063106b511,0xb14db4ff35692ea3,0x34ffb14daea33569,0x34ffb14daea33569,0x314d34ffb569aea3
.quad 0xb59baa17359b2a17,0xb59baa17359b2a17,0x2a17b59baa17359b,0x2a17b59baa17359b,0xb3c7341c35a8a0ff,0x341c33c7a0ffb5a8,0xb41cb3c720ff35a8,0xb3c7341c35a8a0ff,0x2c47358e358eac47,0xac47b58eb58e2c47,0xb58e2c472c47358e,0x358eac47ac47b58e,0x352330be354fafd2,0xb0be35232fd2354f,0xb0be35232fd2354f,0xb523b0beb54f2fd2
.quad 0x3400340034003400,0x3400340034003400,0xb4003400b4003400,0xb4003400b4003400,0xb5952b53b498b299,0x2b533595b2993498,0xab53b5953299b498,0xb5952b53b498b299,0x3106b51135113106,0xb1063511b511b106,0x35113106b1063511,0xb511b1063106b511,0x314d34ffb569aea3,0xb4ff314d2ea3b569,0xb4ff314d2ea3b569,0xb14db4ff35692ea3
.quad 0xb59baa17359b2a17,0xb59baa17359b2a17,0x2a17b59baa17359b,0x2a17b59baa17359b,0x33c7b41cb5a820ff,0xb41cb3c720ff35a8,0x341c33c7a0ffb5a8,0x33c7b41cb5a820ff,0x2c47358e358eac47,0xac47b58eb58e2c47,0xb58e2c472c47358e,0x358eac47ac47b58e,0xb523b0beb54f2fd2,0x30beb523afd2b54f,0x30beb523afd2b54f,0x352330be354fafd2
.quad 0,0,0,0,0,0,0,0,0,0,0,0,0,0,0,0
.quad 0,0,0,0,0,0,0,0,0,0,0,0,0,0,0,0
.quad 0,0,0,0,0,0,0,0,0,0,0,0,0,0,0,0
.quad 0,0,0,0,0,0,0,0,0,0,0,0,0,0,0,0
.quad 0x3400340034003400,0x3400340034003400,0xb4003400b4003400,0xb4003400b4003400,0x3594ab77349b3292,0xab77b5943292b49b,0x2b773594b292349b,0x3594ab77349b3292,0x30f6b515351530f6,0xb0f63515b515b0f6,0x351530f6b0f63515,0xb515b0f630f6b515,0xb165b4f9356c2e6f,0x34f9b165ae6f356c,0x34f9b165ae6f356c,0x316534f9b56cae6f
.quad 0xb59da98a359d298a,0xb59da98a359d298a,0x298ab59da98a359d,0x298ab59da98a359d,0xb3a6342b35a7a3c6,0x342b33a6a3c6b5a7,0xb42bb3a623c635a7,0xb3a6342b35a7a3c6,0x2cb035893589acb0,0xacb0b589b5892cb0,0xb5892cb02cb03589,0x3589acb0acb0b589,0x352f30853544b023,0xb085352f30233544,0xb085352f30233544,0xb52fb085b5443023
.quad 0x3400340034003400,0x3400340034003400,0xb4003400b4003400,0xb4003400b4003400,0xb5942b77b49bb292,0x2b773594b292349b,0xab77b5943292b49b,0xb5942b77b49bb292,0x30f6b515351530f6,0xb0f63515b515b0f6,0x351530f6b0f63515,0xb515b0f630f6b515,0x316534f9b56cae6f,0xb4f931652e6fb56c,0xb4f931652e6fb56c,0xb165b4f9356c2e6f
.quad 0xb59da98a359d298a,0xb59da98a359d298a,0x298ab59da98a359d,0x298ab59da98a359d,0x33a6b42bb5a723c6,0xb42bb3a623c635a7,0x342b33a6a3c6b5a7,0x33a6b42bb5a723c6,0x2cb035893589acb0,0xacb0b589b5892cb0,0xb5892cb02cb03589,0x3589acb0acb0b589,0xb52fb085b5443023,0x3085b52fb023b544,0x3085b52fb023b544,0x352f30853544b023
.quad 0,0,0,0,0,0,0,0,0,0,0,0,0,0,0,0
.quad 0,0,0,0,0,0,0,0,0,0,0,0,0,0,0,0
.quad 0,0,0,0,0,0,0,0,0,0,0,0,0,0,0,0
.quad 0,0,0,0,0,0,0,0,0,0,0,0,0,0,0,0
.quad 0x3400340034003400,0x3400340034003400,0xb4003400b4003400,0xb4003400b4003400,0x3594ab9a349d328b,0xab9ab594328bb49d,0x2b9a3594b28b349d,0x3594ab9a349d328b,0x30e6b519351930e6,0xb0e63519b519b0e6,0x351930e6b0e63519,0xb519b0e630e6b519,0xb17cb4f335702e3c,0x34f3b17cae3c3570,0x34f3b17cae3c3570,0x317c34f3b570ae3c
.quad 0xb59fa8fd359f28fd,0xb59fa8fd359f28fd,0x28fdb59fa8fd359f,0x28fdb59fa8fd359f,0xb385343a35a6a546,0x343a3385a546b5a6,0xb43ab385254635a6,0xb385343a35a6a546,0x2d1835833583ad18,0xad18b583b5832d18,0xb5832d182d183583,0x3583ad18ad18b583,0x353c304c3538b05d,0xb04c353c305d3538,0xb04c353c305d3538,0xb53cb04cb538305d
.quad 0x3400340034003400,0x3400340034003400,0xb4003400b4003400,0xb4003400b4003400,0xb5942b9ab49db28b,0x2b9a3594b28b349d,0xab9ab594328bb49d,0xb5942b9ab49db28b,0x30e6b519351930e6,0xb0e63519b519b0e6,0x351930e6b0e63519,0xb519b0e630e6b519,0x317c34f3b570ae3c,0xb4f3317c2e3cb570,0xb4f3317c2e3cb570,0xb17cb4f335702e3c
.quad 0xb59fa8fd359f28fd,0xb59fa8fd359f28fd,0x28fdb59fa8fd359f,0x28fdb59fa8fd359f,0x3385b43ab5a62546,0xb43ab385254635a6,0x343a3385a546b5a6,0x3385b43ab5a62546,0x2d1835833583ad18,0xad18b583b5832d18,0xb5832d182d183583,0x3583ad18ad18b583,0xb53cb04cb538305d,0x304cb53cb05db538,0x304cb53cb05db538,0x353c304c3538b05d
.quad 0,0,0,0,0,0,0,0,0,0,0,0,0,0,0,0
.quad 0,0,0,0,0,0,0,0,0,0,0,0,0,0,0,0
.quad 0,0,0,0,0,0,0,0,0,0,0,0,0,0,0,0
.quad 0,0,0,0,0,0,0,0,0,0,0,0,0,0,0,0
.quad 0x3400340034003400,0x3400340034003400,0xb4003400b4003400,0xb4003400b4003400,0x3593abbd34a03284,0xabbdb5933284b4a0,0x2bbd3593b28434a0,0x3593abbd34a03284,0x30d6b51d351d30d6,0xb0d6351db51db0d6,0x351d30d6b0d6351d,0xb51db0d630d6b51d,0xb194b4ec35742e09,0x34ecb194ae093574,0x34ecb194ae093574,0x319434ecb574ae09
.quad 0xb5a1a87035a12870,0xb5a1a87035a12870,0x2870b5a1a87035a1,0x2870b5a1a87035a1,0xb364344935a4a6a9,0x34493364a6a9b5a4,0xb449b36426a935a4,0xb364344935a4a6a9,0x2d7f357d357dad7f,0xad7fb57db57d2d7f,0xb57d2d7f2d7f357d,0x357dad7fad7fb57d,0x35473012352cb096,0xb01235473096352c,0xb01235473096352c,0xb547b012b52c3096
.quad 0x3400340034003400,0x3400340034003400,0xb4003400b4003400,0xb4003400b4003400,0xb5932bbdb4a0b284,0x2bbd3593b28434a0,0xabbdb5933284b4a0,0xb5932bbdb4a0b284,0x30d6b51d351d30d6,0xb0d6351db51db0d6,0x351d30d6b0d6351d,0xb51db0d630d6b51d,0x319434ecb574ae09,0xb4ec31942e09b574,0xb4ec31942e09b574,0xb194b4ec35742e09
.quad 0xb5a1a87035a12870,0xb5a1a87035a12870,0x2870b5a1a87035a1,0x2870b5a1a87035a1,0x3364b449b5a426a9,0xb449b36426a935a4,0x34493364a6a9b5a4,0x3364b449b5a426a9,0x2d7f357d357dad7f,0xad7fb57db57d2d7f,0xb57d2d7f2d7f357d,0x357dad7fad7fb57d,0xb547b012b52c3096,0x3012b547b096b52c,0x3012b547b096b52c,0x35473012352cb096
.quad 0,0,0,0,0,0,0,0,0,0,0,0,0,0,0,0
.quad 0,0,0,0,0,0,0,0,0,0,0,0,0,0,0,0
.quad 0,0,0,0,0,0,0,0,0,0,0,0,0,0,0,0
.quad 0,0,0,0,0,0,0,0,0,0,0,0,0,0,0,0
.quad 0x3400340034003400,0x3400340034003400,0xb4003400b4003400,0xb4003400b4003400,0x3592abe034a3327c,0xabe0b592327cb4a3,0x2be03592b27c34a3,0x3592abe034a3327c,0x30c6b521352130c6,0xb0c63521b521b0c6,0x352130c6b0c63521,0xb521b0c630c6b521,0xb1abb4e535772dd6,0x34e5b1abadd63577,0x34e5b1abadd63577,0x31ab34e5b577add6
.quad 0xb5a3a7c435a327c4,0xb5a3a7c435a327c4,0x27c4b5a3a7c435a3,0x27c4b5a3a7c435a3,0xb342345735a2a805,0x34573342a805b5a2,0xb457b342280535a2,0xb342345735a2a805,0x2de735763576ade7,0xade7b576b5762de7,0xb5762de72de73576,0x3576ade7ade7b576,0x35522fb0351fb0ce,0xafb0355230ce351f,0xafb0355230ce351f,0xb552afb0b51f30ce
.quad 0x3400340034003400,0x3400340034003400,0xb4003400b4003400,0xb4003400b4003400,0xb5922be0b4a3b27c,0x2be03592b27c34a3,0xabe0b592327cb4a3,0xb5922be0b4a3b27c,0x30c6b521352130c6,0xb0c63521b521b0c6,0x352130c6b0c63521,0xb521b0c630c6b521,0x31ab34e5b577add6,0xb4e531ab2dd6b577,0xb4e531ab2dd6b577,0xb1abb4e535772dd6
.quad 0xb5a3a7c435a327c4,0xb5a3a7c435a327c4,0x27c4b5a3a7c435a3,0x27c4b5a3a7c435a3,0x3342b457b5a22805,0xb457b342280535a2,0x34573342a805b5a2,0x3342b457b5a22805,0x2de735763576ade7,0xade7b576b5762de7,0xb5762de72de73576,0x3576ade7ade7b576,0xb552afb0b51f30ce,0x2fb0b552b0ceb51f,0x2fb0b552b0ceb51f,0x35522fb0351fb0ce
.quad 0,0,0,0,0,0,0,0,0,0,0,0,0,0,0,0
.quad 0,0,0,0,0,0,0,0,0,0,0,0,0,0,0,0
.quad 0,0,0,0,0,0,0,0,0,0,0,0,0,0,0,0
.quad 0,0,0,0,0,0,0,0,0,0,0,0,0,0,0,0
.quad 0x3400340034003400,0x3400340034003400,0xb4003400b4003400,0xb4003400b4003400,0x3591ac0134a53275,0xac01b5913275b4a5,0x2c013591b27534a5,0x3591ac0134a53275,0x30b6b525352530b6,0xb0b63525b525b0b6,0x352530b6b0b63525,0xb525b0b630b6b525,0xb1c2b4df357b2da2,0x34dfb1c2ada2357b,0x34dfb1c2ada2357b,0x31c234dfb57bada2
.quad 0xb5a4a6a935a426a9,0xb5a4a6a935a426a9,0x26a9b5a4a6a935a4,0x26a9b5a4a6a935a4,0xb320346535a0a8b6,0x34653320a8b6b5a0,0xb465b32028b635a0,0xb320346535a0a8b6,0x2e4d356f356fae4d,0xae4db56fb56f2e4d,0xb56f2e4d2e4d356f,0x356fae4dae4db56f,0x355c2f3b3511b106,0xaf3b355c31063511,0xaf3b355c31063511,0xb55caf3bb5113106
.quad 0x3400340034003400,0x3400340034003400,0xb4003400b4003400,0xb4003400b4003400,0xb5912c01b4a5b275,0x2c013591b27534a5,0xac01b5913275b4a5,0xb5912c01b4a5b275,0x30b6b525352530b6,0xb0b63525b525b0b6,0x352530b6b0b63525,0xb525b0b630b6b525,0x31c234dfb57bada2,0xb4df31c22da2b57b,0xb4df31c22da2b57b,0xb1c2b4df357b2da2
.quad 0xb5a4a6a935a426a9,0xb5a4a6a935a426a9,0x26a9b5a4a6a935a4,0x26a9b5a4a6a935a4,0x3320b465b5a028b6,0xb465b32028b635a0,0x34653320a8b6b5a0,0x3320b465b5a028b6,0x2e4d356f356fae4d,0xae4db56fb56f2e4d,0xb56f2e4d2e4d356f,0x356fae4dae4db56f,0xb55caf3bb5113106,0x2f3bb55cb106b511,0x2f3bb55cb106b511,0x355c2f3b3511b106
.quad 0,0,0,0,0,0,0,0,0,0,0,0,0,0,0,0
.quad 0,0,0,0,0,0,0,0,0,0,0,0,0,0,0,0
.quad 0,0,0,0,0,0,0,0,0,0,0,0,0,0,0,0
.quad 0,0,0,0,0,0,0,0,0,0,0,0,0,0,0,0
.quad 0x3400340034003400,0x3400340034003400,0xb4003400b4003400,0xb4003400b4003400,0x3590ac1334a8326e,0xac13b590326eb4a8,0x2c133590b26e34a8,0x3590ac1334a8326e,0x30a6b528352830a6,0xb0a63528b528b0a6,0x352830a6b0a63528,0xb528b0a630a6b528,0xb1d9b4d8357e2d6e,0x34d8b1d9ad6e357e,0x34d8b1d9ad6e357e,0x31d934d8b57ead6e
.quad 0xb5a5a58d35a5258d,0xb5a5a58d35a5258d,0x258db5a5a58d35a5,0x258db5a5a58d35a5,0xb2fd3473359ea967,0x347332fda967b59e,0xb473b2fd2967359e,0xb2fd3473359ea967,0x2eb335673567aeb3,0xaeb3b567b5672eb3,0xb5672eb32eb33567,0x3567aeb3aeb3b567,0x35662ec43503b13e,0xaec43566313e3503,0xaec43566313e3503,0xb566aec4b503313e
.quad 0x3400340034003400,0x3400340034003400,0xb4003400b4003400,0xb4003400b4003400,0xb5902c13b4a8b26e,0x2c133590b26e34a8,0xac13b590326eb4a8,0xb5902c13b4a8b26e,0x30a6b528352830a6,0xb0a63528b528b0a6,0x352830a6b0a63528,0xb528b0a630a6b528,0x31d934d8b57ead6e,0xb4d831d92d6eb57e,0xb4d831d92d6eb57e,0xb1d9b4d8357e2d6e
.quad 0xb5a5a58d35a5258d,0xb5a5a58d35a5258d,0x258db5a5a58d35a5,0x258db5a5a58d35a5,0x32fdb473b59e2967,0xb473b2fd2967359e,0x347332fda967b59e,0x32fdb473b59e2967,0x2eb335673567aeb3,0xaeb3b567b5672eb3,0xb5672eb32eb33567,0x3567aeb3aeb3b567,0xb566aec4b503313e,0x2ec4b566b13eb503,0x2ec4b566b13eb503,0x35662ec43503b13e
.quad 0,0,0,0,0,0,0,0,0,0,0,0,0,0,0,0
.quad 0,0,0,0,0,0,0,0,0,0,0,0,0,0,0,0
.quad 0,0,0,0,0,0,0,0,0,0,0,0,0,0,0,0
.quad 0,0,0,0,0,0,0,0,0,0,0,0,0,0,0,0
.quad 0x3400340034003400,0x3400340034003400,0xb4003400b4003400,0xb4003400b4003400,0x3590ac2434aa3267,0xac24b5903267b4aa,0x2c243590b26734aa,0x3590ac2434aa3267,0x3096b52c352c3096,0xb096352cb52cb096,0x352c3096b096352c,0xb52cb0963096b52c,0xb1efb4d135812d3a,0x34d1b1efad3a3581,0x34d1b1efad3a3581,0x31ef34d1b581ad3a
.quad 0xb5a6a47135a62471,0xb5a6a47135a62471,0x2471b5a6a47135a6,0x2471b5a6a47135a6,0xb2da3480359baa17,0x348032daaa17b59b,0xb480b2da2a17359b,0xb2da3480359baa17,0x2f19355f355faf19,0xaf19b55fb55f2f19,0xb55f2f192f19355f,0x355faf19af19b55f,0x356f2e4d34f5b175,0xae4d356f317534f5,0xae4d356f317534f5,0xb56fae4db4f53175
.quad 0x3400340034003400,0x3400340034003400,0xb4003400b4003400,0xb4003400b4003400,0xb5902c24b4aab267,0x2c243590b26734aa,0xac24b5903267b4aa,0xb5902c24b4aab267,0x3096b52c352c3096,0xb096352cb52cb096,0x352c3096b096352c,0xb52cb0963096b52c,0x31ef34d1b581ad3a,0xb4d131ef2d3ab581,0xb4d131ef2d3ab581,0xb1efb4d135812d3a
.quad 0xb5a6a47135a62471,0xb5a6a47135a62471,0x2471b5a6a47135a6,0x2471b5a6a47135a6,0x32dab480b59b2a17,0xb480b2da2a17359b,0x348032daaa17b59b,0x32dab480b59b2a17,0x2f19355f355faf19,0xaf19b55fb55f2f19,0xb55f2f192f19355f,0x355faf19af19b55f,0xb56fae4db4f53175,0x2e4db56fb175b4f5,0x2e4db56fb175b4f5,0x356f2e4d34f5b175
.quad 0,0,0,0,0,0,0,0,0,0,0,0,0,0,0,0
.quad 0,0,0,0,0,0,0,0,0,0,0,0,0,0,0,0
.quad 0,0,0,0,0,0,0,0,0,0,0,0,0,0,0,0
.quad 0,0,0,0,0,0,0,0,0,0,0,0,0,0,0,0
.quad 0x3400340034003400,0x3400340034003400,0xb4003400b4003400,0xb4003400b4003400,0x358fac3634ad325f,0xac36b58f325fb4ad,0x2c36358fb25f34ad,0x358fac3634ad325f,0x3085b52f352f3085,0xb085352fb52fb085,0x352f3085b085352f,0xb52fb0853085b52f,0xb206b4ca35842d07,0x34cab206ad073584,0x34cab206ad073584,0x320634cab584ad07
.quad 0xb5a7a2aa35a722aa,0xb5a7a2aa35a722aa,0x22aab5a7a2aa35a7,0x22aab5a7a2aa35a7,0xb2b6348e3598aac7,0x348e32b6aac7b598,0xb48eb2b62ac73598,0xb2b6348e3598aac7,0x2f7e35563556af7e,0xaf7eb556b5562f7e,0xb5562f7e2f7e3556,0x3556af7eaf7eb556,0x35772dd634e5b1ab,0xadd6357731ab34e5,0xadd6357731ab34e5,0xb577add6b4e531ab
.quad 0x3400340034003400,0x3400340034003400,0xb4003400b4003400,0xb4003400b4003400,0xb58f2c36b4adb25f,0x2c36358fb25f34ad,0xac36b58f325fb4ad,0xb58f2c36b4adb25f,0x3085b52f352f3085,0xb085352fb52fb085,0x352f3085b085352f,0xb52fb0853085b52f,0x320634cab584ad07,0xb4ca32062d07b584,0xb4ca32062d07b584,0xb206b4ca35842d07
.quad 0xb5a7a2aa35a722aa,0xb5a7a2aa35a722aa,0x22aab5a7a2aa35a7,0x22aab5a7a2aa35a7,0x32b6b48eb5982ac7,0xb48eb2b62ac73598,0x348e32b6aac7b598,0x32b6b48eb5982ac7,0x2f7e35563556af7e,0xaf7eb556b5562f7e,0xb5562f7e2f7e3556,0x3556af7eaf7eb556,0xb577add6b4e531ab,0x2dd6b577b1abb4e5,0x2dd6b577b1abb4e5,0x35772dd634e5b1ab
.quad 0,0,0,0,0,0,0,0,0,0,0,0,0,0,0,0
.quad 0,0,0,0,0,0,0,0,0,0,0,0,0,0,0,0
.quad 0,0,0,0,0,0,0,0,0,0,0,0,0,0,0,0
.quad 0,0,0,0,0,0,0,0,0,0,0,0,0,0,0,0
.quad 0x3400340034003400,0x3400340034003400,0xb4003400b4003400,0xb4003400b4003400,0x358eac4734af3258,0xac47b58e3258b4af,0x2c47358eb25834af,0x358eac4734af3258,0x3075b53335333075,0xb0753533b533b075,0x35333075b0753533,0xb533b0753075b533,0xb21db4c335872cd2,0x34c3b21dacd23587,0x34c3b21dacd23587,0x321d34c3b587acd2
.quad 0xb5a8a07135a82071,0xb5a8a07135a82071,0x2071b5a8a07135a8,0x2071b5a8a07135a8,0xb292349b3594ab77,0x349b3292ab77b594,0xb49bb2922b773594,0xb292349b3594ab77,0x2fe2354d354dafe2,0xafe2b54db54d2fe2,0xb54d2fe22fe2354d,0x354dafe2afe2b54d,0x357f2d5d34d6b1e0,0xad5d357f31e034d6,0xad5d357f31e034d6,0xb57fad5db4d631e0
.quad 0x3400340034003400,0x3400340034003400,0xb4003400b4003400,0xb4003400b4003400,0xb58e2c47b4afb258,0x2c47358eb25834af,0xac47b58e3258b4af,0xb58e2c47b4afb258,0x3075b53335333075,0xb0753533b533b075,0x35333075b0753533,0xb533b0753075b533,0x321d34c3b587acd2,0xb4c3321d2cd2b587,0xb4c3321d2cd2b587,0xb21db4c335872cd2
.quad 0xb5a8a07135a82071,0xb5a8a07135a82071,0x2071b5a8a07135a8,0x2071b5a8a07135a8,0x3292b49bb5942b77,0xb49bb2922b773594,0x349b3292ab77b594,0x3292b49bb5942b77,0x2fe2354d354dafe2,0xafe2b54db54d2fe2,0xb54d2fe22fe2354d,0x354dafe2afe2b54d,0xb57fad5db4d631e0,0x2d5db57fb1e0b4d6,0x2d5db57fb1e0b4d6,0x357f2d5d34d6b1e0
.quad 0,0,0,0,0,0,0,0,0,0,0,0,0,0,0,0
.quad 0,0,0,0,0,0,0,0,0,0,0,0,0,0,0,0
.quad 0,0,0,0,0,0,0,0,0,0,0,0,0,0,0,0
.quad 0,0,0,0,0,0,0,0,0,0,0,0,0,0,0,0
.quad 0x3400340034003400,0x3400340034003400,0xb4003400b4003400,0xb4003400b4003400,0x358dac5934b23250,0xac59b58d3250b4b2,0x2c59358db25034b2,0x358dac5934b23250,0x3065b53635363065,0xb0653536b536b065,0x35363065b0653536,0xb536b0653065b536,0xb233b4bb358a2c9e,0x34bbb233ac9e358a,0x34bbb233ac9e358a,0x323334bbb58aac9e
.quad 0xb5a89c7135a81c71,0xb5a89c7135a81c71,0x1c71b5a89c7135a8,0x1c71b5a89c7135a8,0xb26e34a83590ac13,0x34a8326eac13b590,0xb4a8b26e2c133590,0xb26e34a83590ac13,0x302335443544b023,0xb023b544b5443023,0xb544302330233544,0x3544b023b023b544,0x35862ce434c5b215,0xace43586321534c5,0xace43586321534c5,0xb586ace4b4c53215
.quad 0x3400340034003400,0x3400340034003400,0xb4003400b4003400,0xb4003400b4003400,0xb58d2c59b4b2b250,0x2c59358db25034b2,0xac59b58d3250b4b2,0xb58d2c59b4b2b250,0x3065b53635363065,0xb0653536b536b065,0x35363065b0653536,0xb536b0653065b536,0x323334bbb58aac9e,0xb4bb32332c9eb58a,0xb4bb32332c9eb58a,0xb233b4bb358a2c9e
.quad 0xb5a89c7135a81c71,0xb5a89c7135a81c71,0x1c71b5a89c7135a8,0x1c71b5a89c7135a8,0x326eb4a8b5902c13,0xb4a8b26e2c133590,0x34a8326eac13b590,0x326eb4a8b5902c13,0x302335443544b023,0xb023b544b5443023,0xb544302330233544,0x3544b023b023b544,0xb586ace4b4c53215,0x2ce4b586b215b4c5,0x2ce4b586b215b4c5,0x35862ce434c5b215
.quad 0,0,0,0,0,0,0,0,0,0,0,0,0,0,0,0
.quad 0,0,0,0,0,0,0,0,0,0,0,0,0,0,0,0
.quad 0,0,0,0,0,0,0,0,0,0,0,0,0,0,0,0
.quad 0,0,0,0,0,0,0,0,0,0,0,0,0,0,0,0
.quad 0x3400340034003400,0x3400340034003400,0xb4003400b4003400,0xb4003400b4003400,0x358cac6a34b43249,0xac6ab58c3249b4b4,0x2c6a358cb24934b4,0x358cac6a34b43249,0x3054b53a353a3054,0xb054353ab53ab054,0x353a3054b054353a,0xb53ab0543054b53a,0xb249b4b4358c2c6a,0x34b4b249ac6a358c,0x34b4b249ac6a358c,0x324934b4b58cac6a
.quad 0xb5a8800035a80000,0xb5a8800035a80000,0xb5a8000035a8,0xb5a8800035a8,0xb24934b4358cac6a,0x34b43249ac6ab58c,0xb4b4b2492c6a358c,0xb24934b4358cac6a,0x3054353a353ab054,0xb054b53ab53a3054,0xb53a30543054353a,0x353ab054b054b53a,0x358c2c6a34b4b249,0xac6a358c324934b4,0xac6a358c324934b4,0xb58cac6ab4b43249
.quad 0x3400340034003400,0x3400340034003400,0xb4003400b4003400,0xb4003400b4003400,0xb58c2c6ab4b4b249,0x2c6a358cb24934b4,0xac6ab58c3249b4b4,0xb58c2c6ab4b4b249,0x3054b53a353a3054,0xb054353ab53ab054,0x353a3054b054353a,0xb53ab0543054b53a,0x324934b4b58cac6a,0xb4b432492c6ab58c,0xb4b432492c6ab58c,0xb249b4b4358c2c6a
.quad 0xb5a8800035a80000,0xb5a8800035a88000,0xb5a8800035a8,0xb5a8800035a8,0x3249b4b4b58c2c6a,0xb4b4b2492c6a358c,0x34b43249ac6ab58c,0x3249b4b4b58c2c6a,0x3054353a353ab054,0xb054b53ab53a3054,0xb53a30543054353a,0x353ab054b054b53a,0xb58cac6ab4b43249,0x2c6ab58cb249b4b4,0x2c6ab58cb249b4b4,0x358c2c6a34b4b249
.quad 0,0,0,0,0,0,0,0,0,0,0,0,0,0,0,0
.quad 0,0,0,0,0,0,0,0,0,0,0,0,0,0,0,0
.quad 0,0,0,0,0,0,0,0,0,0,0,0,0,0,0,0
.quad 0,0,0,0,0,0,0,0,0,0,0,0,0,0,0,0
.quad 0x3400340034003400,0x3400340034003400,0xb4003400b4003400,0xb4003400b4003400,0x358bac7c34b73242,0xac7cb58b3242b4b7,0x2c7c358bb24234b7,0x358bac7c34b73242,0x3044b53d353d3044,0xb044353db53db044,0x353d3044b044353d,0xb53db0443044b53d,0xb25fb4ad358f2c36,0x34adb25fac36358f,0x34adb25fac36358f,0x325f34adb58fac36
.quad 0xb5a81c7135a89c71,0xb5a81c7135a89c71,0x9c71b5a81c7135a8,0x9c71b5a81c7135a8,0xb22434c03588acc1,0x34c03224acc1b588,0xb4c0b2242cc13588,0xb22434c03588acc1,0x3085352f352fb085,0xb085b52fb52f3085,0xb52f30853085352f,0x352fb085b085b52f,0x35922be034a3b27c,0xabe03592327c34a3,0xabe03592327c34a3,0xb592abe0b4a3327c
.quad 0x3400340034003400,0x3400340034003400,0xb4003400b4003400,0xb4003400b4003400,0xb58b2c7cb4b7b242,0x2c7c358bb24234b7,0xac7cb58b3242b4b7,0xb58b2c7cb4b7b242,0x3044b53d353d3044,0xb044353db53db044,0x353d3044b044353d,0xb53db0443044b53d,0x325f34adb58fac36,0xb4ad325f2c36b58f,0xb4ad325f2c36b58f,0xb25fb4ad358f2c36
.quad 0xb5a81c7135a89c71,0xb5a81c7135a89c71,0x9c71b5a81c7135a8,0x9c71b5a81c7135a8,0x3224b4c0b5882cc1,0xb4c0b2242cc13588,0x34c03224acc1b588,0x3224b4c0b5882cc1,0x3085352f352fb085,0xb085b52fb52f3085,0xb52f30853085352f,0x352fb085b085b52f,0xb592abe0b4a3327c,0x2be0b592b27cb4a3,0x2be0b592b27cb4a3,0x35922be034a3b27c
.quad 0,0,0,0,0,0,0,0,0,0,0,0,0,0,0,0
.quad 0,0,0,0,0,0,0,0,0,0,0,0,0,0,0,0
.quad 0,0,0,0,0,0,0,0,0,0,0,0,0,0,0,0
.quad 0,0,0,0,0,0,0,0,0,0,0,0,0,0,0,0
.quad 0x3400340034003400,0x3400340034003400,0xb4003400b4003400,0xb4003400b4003400,0x358bac8d34b9323a,0xac8db58b323ab4b9,0x2c8d358bb23a34b9,0x358bac8d34b9323a,0x3033b54135413033,0xb0333541b541b033,0x35413033b0333541,0xb541b0333033b541,0xb275b4a535912c01,0x34a5b275ac013591,0x34a5b275ac013591,0x327534a5b591ac01
.quad 0xb5a8207135a8a071,0xb5a8207135a8a071,0xa071b5a8207135a8,0xa071b5a8207135a8,0xb1fe34cc3583ad18,0x34cc31fead18b583,0xb4ccb1fe2d183583,0xb1fe34cc3583ad18,0x30b635253525b0b6,0xb0b6b525b52530b6,0xb52530b630b63525,0x3525b0b6b0b6b525,0x35972aea3490b2af,0xaaea359732af3490,0xaaea359732af3490,0xb597aaeab49032af
.quad 0x3400340034003400,0x3400340034003400,0xb4003400b4003400,0xb4003400b4003400,0xb58b2c8db4b9b23a,0x2c8d358bb23a34b9,0xac8db58b323ab4b9,0xb58b2c8db4b9b23a,0x3033b54135413033,0xb0333541b541b033,0x35413033b0333541,0xb541b0333033b541,0x327534a5b591ac01,0xb4a532752c01b591,0xb4a532752c01b591,0xb275b4a535912c01
.quad 0xb5a8207135a8a071,0xb5a8207135a8a071,0xa071b5a8207135a8,0xa071b5a8207135a8,0x31feb4ccb5832d18,0xb4ccb1fe2d183583,0x34cc31fead18b583,0x31feb4ccb5832d18,0x30b635253525b0b6,0xb0b6b525b52530b6,0xb52530b630b63525,0x3525b0b6b0b6b525,0xb597aaeab49032af,0x2aeab597b2afb490,0x2aeab597b2afb490,0x35972aea3490b2af
.quad 0,0,0,0,0,0,0,0,0,0,0,0,0,0,0,0
.quad 0,0,0,0,0,0,0,0,0,0,0,0,0,0,0,0
.quad 0,0,0,0,0,0,0,0,0,0,0,0,0,0,0,0
.quad 0,0,0,0,0,0,0,0,0,0,0,0,0,0,0,0
.quad 0x3400340034003400,0x3400340034003400,0xb4003400b4003400,0xb4003400b4003400,0x358aac9e34bb3233,0xac9eb58a3233b4bb,0x2c9e358ab23334bb,0x358aac9e34bb3233,0x3023b54435443023,0xb0233544b544b023,0x35443023b0233544,0xb544b0233023b544,0xb28bb49d35942b9a,0x349db28bab9a3594,0x349db28bab9a3594,0x328b349db594ab9a
.quad 0xb5a722aa35a7a2aa,0xb5a722aa35a7a2aa,0xa2aab5a722aa35a7,0xa2aab5a722aa35a7,0xb1d934d8357ead6e,0x34d831d9ad6eb57e,0xb4d8b1d92d6e357e,0xb1d934d8357ead6e,0x30e635193519b0e6,0xb0e6b519b51930e6,0xb51930e630e63519,0x3519b0e6b0e6b519,0x359c29f4347eb2e1,0xa9f4359c32e1347e,0xa9f4359c32e1347e,0xb59ca9f4b47e32e1
.quad 0x3400340034003400,0x3400340034003400,0xb4003400b4003400,0xb4003400b4003400,0xb58a2c9eb4bbb233,0x2c9e358ab23334bb,0xac9eb58a3233b4bb,0xb58a2c9eb4bbb233,0x3023b54435443023,0xb0233544b544b023,0x35443023b0233544,0xb544b0233023b544,0x328b349db594ab9a,0xb49d328b2b9ab594,0xb49d328b2b9ab594,0xb28bb49d35942b9a
.quad 0xb5a722aa35a7a2aa,0xb5a722aa35a7a2aa,0xa2aab5a722aa35a7,0xa2aab5a722aa35a7,0x31d9b4d8b57e2d6e,0xb4d8b1d92d6e357e,0x34d831d9ad6eb57e,0x31d9b4d8b57e2d6e,0x30e635193519b0e6,0xb0e6b519b51930e6,0xb51930e630e63519,0x3519b0e6b0e6b519,0xb59ca9f4b47e32e1,0x29f4b59cb2e1b47e,0x29f4b59cb2e1b47e,0x359c29f4347eb2e1
.quad 0,0,0,0,0,0,0,0,0,0,0,0,0,0,0,0
.quad 0,0,0,0,0,0,0,0,0,0,0,0,0,0,0,0
.quad 0,0,0,0,0,0,0,0,0,0,0,0,0,0,0,0
.quad 0,0,0,0,0,0,0,0,0,0,0,0,0,0,0,0
.quad 0x3400340034003400,0x3400340034003400,0xb4003400b4003400,0xb4003400b4003400,0x3589acb034be322b,0xacb0b589322bb4be,0x2cb03589b22b34be,0x3589acb034be322b,0x3012b54735473012,0xb0123547b547b012,0x35473012b0123547,0xb547b0123012b547,0xb2a1b49635962b30,0x3496b2a1ab303596,0x3496b2a1ab303596,0x32a13496b596ab30
.quad 0xb5a6247135a6a471,0xb5a6247135a6a471,0xa471b5a6247135a6,0xa471b5a6247135a6,0xb1b234e33578adc4,0x34e331b2adc4b578,0xb4e3b1b22dc43578,0xb1b234e33578adc4,0x3116350e350eb116,0xb116b50eb50e3116,0xb50e31163116350e,0x350eb116b116b50e,0x359f28fd346bb312,0xa8fd359f3312346b,0xa8fd359f3312346b,0xb59fa8fdb46b3312
.quad 0x3400340034003400,0x3400340034003400,0xb4003400b4003400,0xb4003400b4003400,0xb5892cb0b4beb22b,0x2cb03589b22b34be,0xacb0b589322bb4be,0xb5892cb0b4beb22b,0x3012b54735473012,0xb0123547b547b012,0x35473012b0123547,0xb547b0123012b547,0x32a13496b596ab30,0xb49632a12b30b596,0xb49632a12b30b596,0xb2a1b49635962b30
.quad 0xb5a6247135a6a471,0xb5a6247135a6a471,0xa471b5a6247135a6,0xa471b5a6247135a6,0x31b2b4e3b5782dc4,0xb4e3b1b22dc43578,0x34e331b2adc4b578,0x31b2b4e3b5782dc4,0x3116350e350eb116,0xb116b50eb50e3116,0xb50e31163116350e,0x350eb116b116b50e,0xb59fa8fdb46b3312,0x28fdb59fb312b46b,0x28fdb59fb312b46b,0x359f28fd346bb312
.quad 0,0,0,0,0,0,0,0,0,0,0,0,0,0,0,0
.quad 0,0,0,0,0,0,0,0,0,0,0,0,0,0,0,0
.quad 0,0,0,0,0,0,0,0,0,0,0,0,0,0,0,0
.quad 0,0,0,0,0,0,0,0,0,0,0,0,0,0,0,0
.quad 0x3400340034003400,0x3400340034003400,0xb4003400b4003400,0xb4003400b4003400,0x3588acc134c03224,0xacc1b5883224b4c0,0x2cc13588b22434c0,0x3588acc134c03224,0x3002b54a354a3002,0xb002354ab54ab002,0x354a3002b002354a,0xb54ab0023002b54a,0xb2b6b48e35982ac7,0x348eb2b6aac73598,0x348eb2b6aac73598,0x32b6348eb598aac7
.quad 0xb5a5258d35a5a58d,0xb5a5258d35a5a58d,0xa58db5a5258d35a5,0xa58db5a5258d35a5,0xb18c34ee3573ae1a,0x34ee318cae1ab573,0xb4eeb18c2e1a3573,0xb18c34ee3573ae1a,0x314635013501b146,0xb146b501b5013146,0xb501314631463501,0x3501b146b146b501,0x35a228053457b342,0xa80535a233423457,0xa80535a233423457,0xb5a2a805b4573342
.quad 0x3400340034003400,0x3400340034003400,0xb4003400b4003400,0xb4003400b4003400,0xb5882cc1b4c0b224,0x2cc13588b22434c0,0xacc1b5883224b4c0,0xb5882cc1b4c0b224,0x3002b54a354a3002,0xb002354ab54ab002,0x354a3002b002354a,0xb54ab0023002b54a,0x32b6348eb598aac7,0xb48e32b62ac7b598,0xb48e32b62ac7b598,0xb2b6b48e35982ac7
.quad 0xb5a5258d35a5a58d,0xb5a5258d35a5a58d,0xa58db5a5258d35a5,0xa58db5a5258d35a5,0x318cb4eeb5732e1a,0xb4eeb18c2e1a3573,0x34ee318cae1ab573,0x318cb4eeb5732e1a,0x314635013501b146,0xb146b501b5013146,0xb501314631463501,0x3501b146b146b501,0xb5a2a805b4573342,0x2805b5a2b342b457,0x2805b5a2b342b457,0x35a228053457b342
.quad 0,0,0,0,0,0,0,0,0,0,0,0,0,0,0,0
.quad 0,0,0,0,0,0,0,0,0,0,0,0,0,0,0,0
.quad 0,0,0,0,0,0,0,0,0,0,0,0,0,0,0,0
.quad 0,0,0,0,0,0,0,0,0,0,0,0,0,0,0,0
.quad 0x3400340034003400,0x3400340034003400,0xb4003400b4003400,0xb4003400b4003400,0x3587acd234c3321d,0xacd2b587321db4c3,0x2cd23587b21d34c3,0x3587acd234c3321d,0x2fe2b54d354d2fe2,0xafe2354db54dafe2,0x354d2fe2afe2354d,0xb54dafe22fe2b54d,0xb2ccb486359a2a5e,0x3486b2ccaa5e359a,0x3486b2ccaa5e359a,0x32cc3486b59aaa5e
.quad 0xb5a426a935a4a6a9,0xb5a426a935a4a6a9,0xa6a9b5a426a935a4,0xa6a9b5a426a935a4,0xb16534f9356cae6f,0x34f93165ae6fb56c,0xb4f9b1652e6f356c,0xb16534f9356cae6f,0x317534f534f5b175,0xb175b4f5b4f53175,0xb4f53175317534f5,0x34f5b175b175b4f5,0x35a5261b3443b371,0xa61b35a533713443,0xa61b35a533713443,0xb5a5a61bb4433371
.quad 0x3400340034003400,0x3400340034003400,0xb4003400b4003400,0xb4003400b4003400,0xb5872cd2b4c3b21d,0x2cd23587b21d34c3,0xacd2b587321db4c3,0xb5872cd2b4c3b21d,0x2fe2b54d354d2fe2,0xafe2354db54dafe2,0x354d2fe2afe2354d,0xb54dafe22fe2b54d,0x32cc3486b59aaa5e,0xb48632cc2a5eb59a,0xb48632cc2a5eb59a,0xb2ccb486359a2a5e
.quad 0xb5a426a935a4a6a9,0xb5a426a935a4a6a9,0xa6a9b5a426a935a4,0xa6a9b5a426a935a4,0x3165b4f9b56c2e6f,0xb4f9b1652e6f356c,0x34f93165ae6fb56c,0x3165b4f9b56c2e6f,0x317534f534f5b175,0xb175b4f5b4f53175,0xb4f53175317534f5,0x34f5b175b175b4f5,0xb5a5a61bb4433371,0x261bb5a5b371b443,0x261bb5a5b371b443,0x35a5261b3443b371
.quad 0,0,0,0,0,0,0,0,0,0,0,0,0,0,0,0
.quad 0,0,0,0,0,0,0,0,0,0,0,0,0,0,0,0
.quad 0,0,0,0,0,0,0,0,0,0,0,0,0,0,0,0
.quad 0,0,0,0,0,0,0,0,0,0,0,0,0,0,0,0
.quad 0x3400340034003400,0x3400340034003400,0xb4003400b4003400,0xb4003400b4003400,0x3586ace434c53215,0xace4b5863215b4c5,0x2ce43586b21534c5,0x3586ace434c53215,0x2fc1b55035502fc1,0xafc13550b550afc1,0x35502fc1afc13550,0xb550afc12fc1b550,0xb2e1b47e359c29f4,0x347eb2e1a9f4359c,0x347eb2e1a9f4359c,0x32e1347eb59ca9f4
.quad 0xb5a327c435a3a7c4,0xb5a327c435a3a7c4,0xa7c4b5a327c435a3,0xa7c4b5a327c435a3,0xb13e35033566aec4,0x3503313eaec4b566,0xb503b13e2ec43566,0xb13e35033566aec4,0x31a334e834e8b1a3,0xb1a3b4e8b4e831a3,0xb4e831a331a334e8,0x34e8b1a3b1a3b4e8,0x35a7242a342eb3a0,0xa42a35a733a0342e,0xa42a35a733a0342e,0xb5a7a42ab42e33a0
.quad 0x3400340034003400,0x3400340034003400,0xb4003400b4003400,0xb4003400b4003400,0xb5862ce4b4c5b215,0x2ce43586b21534c5,0xace4b5863215b4c5,0xb5862ce4b4c5b215,0x2fc1b55035502fc1,0xafc13550b550afc1,0x35502fc1afc13550,0xb550afc12fc1b550,0x32e1347eb59ca9f4,0xb47e32e129f4b59c,0xb47e32e129f4b59c,0xb2e1b47e359c29f4
.quad 0xb5a327c435a3a7c4,0xb5a327c435a3a7c4,0xa7c4b5a327c435a3,0xa7c4b5a327c435a3,0x313eb503b5662ec4,0xb503b13e2ec43566,0x3503313eaec4b566,0x313eb503b5662ec4,0x31a334e834e8b1a3,0xb1a3b4e8b4e831a3,0xb4e831a331a334e8,0x34e8b1a3b1a3b4e8,0xb5a7a42ab42e33a0,0x242ab5a7b3a0b42e,0x242ab5a7b3a0b42e,0x35a7242a342eb3a0
.quad 0,0,0,0,0,0,0,0,0,0,0,0,0,0,0,0
.quad 0,0,0,0,0,0,0,0,0,0,0,0,0,0,0,0
.quad 0,0,0,0,0,0,0,0,0,0,0,0,0,0,0,0
.quad 0,0,0,0,0,0,0,0,0,0,0,0,0,0,0,0
.quad 0x3400340034003400,0x3400340034003400,0xb4003400b4003400,0xb4003400b4003400,0x3585acf534c7320e,0xacf5b585320eb4c7,0x2cf53585b20e34c7,0x3585acf534c7320e,0x2f9fb55435542f9f,0xaf9f3554b554af9f,0x35542f9faf9f3554,0xb554af9f2f9fb554,0xb2f6b476359d298a,0x3476b2f6a98a359d,0x3476b2f6a98a359d,0x32f63476b59da98a
.quad 0xb5a1287035a1a870,0xb5a1287035a1a870,0xa870b5a1287035a1,0xa870b5a1287035a1,0xb116350e355faf19,0x350e3116af19b55f,0xb50eb1162f19355f,0xb116350e355faf19,0x31d134da34dab1d1,0xb1d1b4dab4da31d1,0xb4da31d131d134da,0x34dab1d1b1d1b4da,0x35a820713419b3cd,0xa07135a833cd3419,0xa07135a833cd3419,0xb5a8a071b41933cd
.quad 0x3400340034003400,0x3400340034003400,0xb4003400b4003400,0xb4003400b4003400,0xb5852cf5b4c7b20e,0x2cf53585b20e34c7,0xacf5b585320eb4c7,0xb5852cf5b4c7b20e,0x2f9fb55435542f9f,0xaf9f3554b554af9f,0x35542f9faf9f3554,0xb554af9f2f9fb554,0x32f63476b59da98a,0xb47632f6298ab59d,0xb47632f6298ab59d,0xb2f6b476359d298a
.quad 0xb5a1287035a1a870,0xb5a1287035a1a870,0xa870b5a1287035a1,0xa870b5a1287035a1,0x3116b50eb55f2f19,0xb50eb1162f19355f,0x350e3116af19b55f,0x3116b50eb55f2f19,0x31d134da34dab1d1,0xb1d1b4dab4da31d1,0xb4da31d131d134da,0x34dab1d1b1d1b4da,0xb5a8a071b41933cd,0x2071b5a8b3cdb419,0x2071b5a8b3cdb419,0x35a820713419b3cd
.quad 0,0,0,0,0,0,0,0,0,0,0,0,0,0,0,0
.quad 0,0,0,0,0,0,0,0,0,0,0,0,0,0,0,0
.quad 0,0,0,0,0,0,0,0,0,0,0,0,0,0,0,0
.quad 0,0,0,0,0,0,0,0,0,0,0,0,0,0,0,0
.quad 0x3400340034003400,0x3400340034003400,0xb4003400b4003400,0xb4003400b4003400,0x3584ad0734ca3206,0xad07b5843206b4ca,0x2d073584b20634ca,0x3584ad0734ca3206,0x2f7eb55635562f7e,0xaf7e3556b556af7e,0x35562f7eaf7e3556,0xb556af7e2f7eb556,0xb30bb46d359f2920,0x346db30ba920359f,0x346db30ba920359f,0x330b346db59fa920
.quad 0xb59f28fd359fa8fd,0xb59f28fd359fa8fd,0xa8fdb59f28fd359f,0xa8fdb59f28fd359f,0xb0ee35173558af6d,0x351730eeaf6db558,0xb517b0ee2f6d3558,0xb0ee35173558af6d,0x31fe34cc34ccb1fe,0xb1feb4ccb4cc31fe,0xb4cc31fe31fe34cc,0x34ccb1feb1feb4cc,0x35a814713403b3fa,0x947135a833fa3403,0x947135a833fa3403,0xb5a89471b40333fa
.quad 0x3400340034003400,0x3400340034003400,0xb4003400b4003400,0xb4003400b4003400,0xb5842d07b4cab206,0x2d073584b20634ca,0xad07b5843206b4ca,0xb5842d07b4cab206,0x2f7eb55635562f7e,0xaf7e3556b556af7e,0x35562f7eaf7e3556,0xb556af7e2f7eb556,0x330b346db59fa920,0xb46d330b2920b59f,0xb46d330b2920b59f,0xb30bb46d359f2920
.quad 0xb59f28fd359fa8fd,0xb59f28fd359fa8fd,0xa8fdb59f28fd359f,0xa8fdb59f28fd359f,0x30eeb517b5582f6d,0xb517b0ee2f6d3558,0x351730eeaf6db558,0x30eeb517b5582f6d,0x31fe34cc34ccb1fe,0xb1feb4ccb4cc31fe,0xb4cc31fe31fe34cc,0x34ccb1feb1feb4cc,0xb5a89471b40333fa,0x1471b5a8b3fab403,0x1471b5a8b3fab403,0x35a814713403b3fa
.quad 0,0,0,0,0,0,0,0,0,0,0,0,0,0,0,0
.quad 0,0,0,0,0,0,0,0,0,0,0,0,0,0,0,0
.quad 0,0,0,0,0,0,0,0,0,0,0,0,0,0,0,0
.quad 0,0,0,0,0,0,0,0,0,0,0,0,0,0,0,0
.quad 0x3400340034003400,0x3400340034003400,0xb4003400b4003400,0xb4003400b4003400,0x3583ad1834cc31fe,0xad18b58331feb4cc,0x2d183583b1fe34cc,0x3583ad1834cc31fe,0x2f5cb55935592f5c,0xaf5c3559b559af5c,0x35592f5caf5c3559,0xb559af5c2f5cb559,0xb320b46535a028b6,0x3465b320a8b635a0,0x3465b320a8b635a0,0x33203465b5a0a8b6
.quad 0xb59d298a359da98a,0xb59d298a359da98a,0xa98ab59d298a359d,0xa98ab59d298a359d,0xb0c635213550afc1,0x352130c6afc1b550,0xb521b0c62fc13550,0xb0c635213550afc1,0x322b34be34beb22b,0xb22bb4beb4be322b,0xb4be322b322b34be,0x34beb22bb22bb4be,0x35a89eaa33dab413,0x1eaa35a8341333da,0x1eaa35a8341333da,0xb5a81eaab3da3413
.quad 0x3400340034003400,0x3400340034003400,0xb4003400b4003400,0xb4003400b4003400,0xb5832d18b4ccb1fe,0x2d183583b1fe34cc,0xad18b58331feb4cc,0xb5832d18b4ccb1fe,0x2f5cb55935592f5c,0xaf5c3559b559af5c,0x35592f5caf5c3559,0xb559af5c2f5cb559,0x33203465b5a0a8b6,0xb465332028b6b5a0,0xb465332028b6b5a0,0xb320b46535a028b6
.quad 0xb59d298a359da98a,0xb59d298a359da98a,0xa98ab59d298a359d,0xa98ab59d298a359d,0x30c6b521b5502fc1,0xb521b0c62fc13550,0x352130c6afc1b550,0x30c6b521b5502fc1,0x322b34be34beb22b,0xb22bb4beb4be322b,0xb4be322b322b34be,0x34beb22bb22bb4be,0xb5a81eaab3da3413,0x9eaab5a8b413b3da,0x9eaab5a8b413b3da,0x35a89eaa33dab413
.quad 0,0,0,0,0,0,0,0,0,0,0,0,0,0,0,0
.quad 0,0,0,0,0,0,0,0,0,0,0,0,0,0,0,0
.quad 0,0,0,0,0,0,0,0,0,0,0,0,0,0,0,0
.quad 0,0,0,0,0,0,0,0,0,0,0,0,0,0,0,0
.quad 0x3400340034003400,0x3400340034003400,0xb4003400b4003400,0xb4003400b4003400,0x3582ad2934cf31f7,0xad29b58231f7b4cf,0x2d293582b1f734cf,0x3582ad2934cf31f7,0x2f3bb55c355c2f3b,0xaf3b355cb55caf3b,0x355c2f3baf3b355c,0xb55caf3b2f3bb55c,0xb334b45d35a2284c,0x345db334a84c35a2,0x345db334a84c35a2,0x3334345db5a2a84c
.quad 0xb59b2a17359baa17,0xb59b2a17359baa17,0xaa17b59b2a17359b,0xaa17b59b2a17359b,0xb09e352a3549b00a,0x352a309eb00ab549,0xb52ab09e300a3549,0xb09e352a3549b00a,0x325834af34afb258,0xb258b4afb4af3258,0xb4af3258325834af,0x34afb258b258b4af,0x35a7a33833adb428,0x233835a7342833ad,0x233835a7342833ad,0xb5a72338b3ad3428
.quad 0x3400340034003400,0x3400340034003400,0xb4003400b4003400,0xb4003400b4003400,0xb5822d29b4cfb1f7,0x2d293582b1f734cf,0xad29b58231f7b4cf,0xb5822d29b4cfb1f7,0x2f3bb55c355c2f3b,0xaf3b355cb55caf3b,0x355c2f3baf3b355c,0xb55caf3b2f3bb55c,0x3334345db5a2a84c,0xb45d3334284cb5a2,0xb45d3334284cb5a2,0xb334b45d35a2284c
.quad 0xb59b2a17359baa17,0xb59b2a17359baa17,0xaa17b59b2a17359b,0xaa17b59b2a17359b,0x309eb52ab549300a,0xb52ab09e300a3549,0x352a309eb00ab549,0x309eb52ab549300a,0x325834af34afb258,0xb258b4afb4af3258,0xb4af3258325834af,0x34afb258b258b4af,0xb5a72338b3ad3428,0xa338b5a7b428b3ad,0xa338b5a7b428b3ad,0x35a7a33833adb428
.quad 0,0,0,0,0,0,0,0,0,0,0,0,0,0,0,0
.quad 0,0,0,0,0,0,0,0,0,0,0,0,0,0,0,0
.quad 0,0,0,0,0,0,0,0,0,0,0,0,0,0,0,0
.quad 0,0,0,0,0,0,0,0,0,0,0,0,0,0,0,0
.quad 0x3400340034003400,0x3400340034003400,0xb4003400b4003400,0xb4003400b4003400,0x3581ad3a34d131ef,0xad3ab58131efb4d1,0x2d3a3581b1ef34d1,0x3581ad3a34d131ef,0x2f19b55f355f2f19,0xaf19355fb55faf19,0x355f2f19af19355f,0xb55faf192f19b55f,0xb349b45435a327c4,0x3454b349a7c435a3,0x3454b349a7c435a3,0x33493454b5a3a7c4
.quad 0xb5982aa43598aaa4,0xb5982aa43598aaa4,0xaaa4b5982aa43598,0xaaa4b5982aa43598,0xb07535333541b033,0x35333075b033b541,0xb533b07530333541,0xb07535333541b033,0x328434a034a0b284,0xb284b4a0b4a03284,0xb4a03284328434a0,0x34a0b284b284b4a0,0x35a5a58d337fb43d,0x258d35a5343d337f,0x258d35a5343d337f,0xb5a5258db37f343d
.quad 0x3400340034003400,0x3400340034003400,0xb4003400b4003400,0xb4003400b4003400,0xb5812d3ab4d1b1ef,0x2d3a3581b1ef34d1,0xad3ab58131efb4d1,0xb5812d3ab4d1b1ef,0x2f19b55f355f2f19,0xaf19355fb55faf19,0x355f2f19af19355f,0xb55faf192f19b55f,0x33493454b5a3a7c4,0xb454334927c4b5a3,0xb454334927c4b5a3,0xb349b45435a327c4
.quad 0xb5982aa43598aaa4,0xb5982aa43598aaa4,0xaaa4b5982aa43598,0xaaa4b5982aa43598,0x3075b533b5413033,0xb533b07530333541,0x35333075b033b541,0x3075b533b5413033,0x328434a034a0b284,0xb284b4a0b4a03284,0xb4a03284328434a0,0x34a0b284b284b4a0,0xb5a5258db37f343d,0xa58db5a5b43db37f,0xa58db5a5b43db37f,0x35a5a58d337fb43d
.quad 0,0,0,0,0,0,0,0,0,0,0,0,0,0,0,0
.quad 0,0,0,0,0,0,0,0,0,0,0,0,0,0,0,0
.quad 0,0,0,0,0,0,0,0,0,0,0,0,0,0,0,0
.quad 0,0,0,0,0,0,0,0,0,0,0,0,0,0,0,0
.quad 0x3400340034003400,0x3400340034003400,0xb4003400b4003400,0xb4003400b4003400,0x3580ad4c34d331e8,0xad4cb58031e8b4d3,0x2d4c3580b1e834d3,0x3580ad4c34d331e8,0x2ef7b56235622ef7,0xaef73562b562aef7,0x35622ef7aef73562,0xb562aef72ef7b562,0xb35db44b35a426ef,0x344bb35da6ef35a4,0x344bb35da6ef35a4,0x335d344bb5a4a6ef
.quad 0xb5962b303596ab30,0xb5962b303596ab30,0xab30b5962b303596,0xab30b5962b303596,0xb04c353c3538b05d,0x353c304cb05db538,0xb53cb04c305d3538,0xb04c353c3538b05d,0x32af34903490b2af,0xb2afb490b49032af,0xb49032af32af3490,0x3490b2afb2afb490,0x35a3a77d3350b451,0x277d35a334513350,0x277d35a334513350,0xb5a3277db3503451
.quad 0x3400340034003400,0x3400340034003400,0xb4003400b4003400,0xb4003400b4003400,0xb5802d4cb4d3b1e8,0x2d4c3580b1e834d3,0xad4cb58031e8b4d3,0xb5802d4cb4d3b1e8,0x2ef7b56235622ef7,0xaef73562b562aef7,0x35622ef7aef73562,0xb562aef72ef7b562,0x335d344bb5a4a6ef,0xb44b335d26efb5a4,0xb44b335d26efb5a4,0xb35db44b35a426ef
.quad 0xb5962b303596ab30,0xb5962b303596ab30,0xab30b5962b303596,0xab30b5962b303596,0x304cb53cb538305d,0xb53cb04c305d3538,0x353c304cb05db538,0x304cb53cb538305d,0x32af34903490b2af,0xb2afb490b49032af,0xb49032af32af3490,0x3490b2afb2afb490,0xb5a3277db3503451,0xa77db5a3b451b350,0xa77db5a3b451b350,0x35a3a77d3350b451
.quad 0,0,0,0,0,0,0,0,0,0,0,0,0,0,0,0
.quad 0,0,0,0,0,0,0,0,0,0,0,0,0,0,0,0
.quad 0,0,0,0,0,0,0,0,0,0,0,0,0,0,0,0
.quad 0,0,0,0,0,0,0,0,0,0,0,0,0,0,0,0
.quad 0x3400340034003400,0x3400340034003400,0xb4003400b4003400,0xb4003400b4003400,0x357fad5d34d631e0,0xad5db57f31e0b4d6,0x2d5d357fb1e034d6,0x357fad5d34d631e0,0x2ed5b56535652ed5,0xaed53565b565aed5,0x35652ed5aed53565,0xb565aed52ed5b565,0xb371b44335a5261b,0x3443b371a61b35a5,0x3443b371a61b35a5,0x33713443b5a5a61b
.quad 0xb5932bbd3593abbd,0xb5932bbd3593abbd,0xabbdb5932bbd3593,0xabbdb5932bbd3593,0xb0233544352fb085,0x35443023b085b52f,0xb544b0233085352f,0xb0233544352fb085,0x32da34803480b2da,0xb2dab480b48032da,0xb48032da32da3480,0x3480b2dab2dab480,0x35a0a8b63320b465,0x28b635a034653320,0x28b635a034653320,0xb5a028b6b3203465
.quad 0x3400340034003400,0x3400340034003400,0xb4003400b4003400,0xb4003400b4003400,0xb57f2d5db4d6b1e0,0x2d5d357fb1e034d6,0xad5db57f31e0b4d6,0xb57f2d5db4d6b1e0,0x2ed5b56535652ed5,0xaed53565b565aed5,0x35652ed5aed53565,0xb565aed52ed5b565,0x33713443b5a5a61b,0xb4433371261bb5a5,0xb4433371261bb5a5,0xb371b44335a5261b
.quad 0xb5932bbd3593abbd,0xb5932bbd3593abbd,0xabbdb5932bbd3593,0xabbdb5932bbd3593,0x3023b544b52f3085,0xb544b0233085352f,0x35443023b085b52f,0x3023b544b52f3085,0x32da34803480b2da,0xb2dab480b48032da,0xb48032da32da3480,0x3480b2dab2dab480,0xb5a028b6b3203465,0xa8b6b5a0b465b320,0xa8b6b5a0b465b320,0x35a0a8b63320b465
.quad 0,0,0,0,0,0,0,0,0,0,0,0,0,0,0,0
.quad 0,0,0,0,0,0,0,0,0,0,0,0,0,0,0,0
.quad 0,0,0,0,0,0,0,0,0,0,0,0,0,0,0,0
.quad 0,0,0,0,0,0,0,0,0,0,0,0,0,0,0,0
.quad 0x3400340034003400,0x3400340034003400,0xb4003400b4003400,0xb4003400b4003400,0x357ead6e34d831d9,0xad6eb57e31d9b4d8,0x2d6e357eb1d934d8,0x357ead6e34d831d9,0x2eb3b56735672eb3,0xaeb33567b567aeb3,0x35672eb3aeb33567,0xb567aeb32eb3b567,0xb385b43a35a62546,0x343ab385a54635a6,0x343ab385a54635a6,0x3385343ab5a6a546
.quad 0xb5902c243590ac24,0xb5902c243590ac24,0xac24b5902c243590,0xac24b5902c243590,0xaff3354c3526b0ae,0x354c2ff3b0aeb526,0xb54caff330ae3526,0xaff3354c3526b0ae,0x330434703470b304,0xb304b470b4703304,0xb470330433043470,0x3470b304b304b470,0x359da9ad32efb478,0x29ad359d347832ef,0x29ad359d347832ef,0xb59d29adb2ef3478
.quad 0x3400340034003400,0x3400340034003400,0xb4003400b4003400,0xb4003400b4003400,0xb57e2d6eb4d8b1d9,0x2d6e357eb1d934d8,0xad6eb57e31d9b4d8,0xb57e2d6eb4d8b1d9,0x2eb3b56735672eb3,0xaeb33567b567aeb3,0x35672eb3aeb33567,0xb567aeb32eb3b567,0x3385343ab5a6a546,0xb43a33852546b5a6,0xb43a33852546b5a6,0xb385b43a35a62546
.quad 0xb5902c243590ac24,0xb5902c243590ac24,0xac24b5902c243590,0xac24b5902c243590,0x2ff3b54cb52630ae,0xb54caff330ae3526,0x354c2ff3b0aeb526,0x2ff3b54cb52630ae,0x330434703470b304,0xb304b470b4703304,0xb470330433043470,0x3470b304b304b470,0xb59d29adb2ef3478,0xa9adb59db478b2ef,0xa9adb59db478b2ef,0x359da9ad32efb478
.quad 0,0,0,0,0,0,0,0,0,0,0,0,0,0,0,0
.quad 0,0,0,0,0,0,0,0,0,0,0,0,0,0,0,0
.quad 0,0,0,0,0,0,0,0,0,0,0,0,0,0,0,0
.quad 0,0,0,0,0,0,0,0,0,0,0,0,0,0,0,0
.quad 0x3400340034003400,0x3400340034003400,0xb4003400b4003400,0xb4003400b4003400,0x357dad7f34da31d1,0xad7fb57d31d1b4da,0x2d7f357db1d134da,0x357dad7f34da31d1,0x2e92b56a356a2e92,0xae92356ab56aae92,0x356a2e92ae92356a,0xb56aae922e92b56a,0xb399b43135a62471,0x3431b399a47135a6,0x3431b399a47135a6,0x33993431b5a6a471
.quad 0xb58c2c6a358cac6a,0xb58c2c6a358cac6a,0xac6ab58c2c6a358c,0xac6ab58c2c6a358c,0xaf9f3554351db0d6,0x35542f9fb0d6b51d,0xb554af9f30d6351d,0xaf9f3554351db0d6,0x332d345f345fb32d,0xb32db45fb45f332d,0xb45f332d332d345f,0x345fb32db32db45f,0x3598aaa432bdb48b,0x2aa43598348b32bd,0x2aa43598348b32bd,0xb5982aa4b2bd348b
.quad 0x3400340034003400,0x3400340034003400,0xb4003400b4003400,0xb4003400b4003400,0xb57d2d7fb4dab1d1,0x2d7f357db1d134da,0xad7fb57d31d1b4da,0xb57d2d7fb4dab1d1,0x2e92b56a356a2e92,0xae92356ab56aae92,0x356a2e92ae92356a,0xb56aae922e92b56a,0x33993431b5a6a471,0xb43133992471b5a6,0xb43133992471b5a6,0xb399b43135a62471
.quad 0xb58c2c6a358cac6a,0xb58c2c6a358cac6a,0xac6ab58c2c6a358c,0xac6ab58c2c6a358c,0x2f9fb554b51d30d6,0xb554af9f30d6351d,0x35542f9fb0d6b51d,0x2f9fb554b51d30d6,0x332d345f345fb32d,0xb32db45fb45f332d,0xb45f332d332d345f,0x345fb32db32db45f,0xb5982aa4b2bd348b,0xaaa4b598b48bb2bd,0xaaa4b598b48bb2bd,0x3598aaa432bdb48b
.quad 0,0,0,0,0,0,0,0,0,0,0,0,0,0,0,0
.quad 0,0,0,0,0,0,0,0,0,0,0,0,0,0,0,0
.quad 0,0,0,0,0,0,0,0,0,0,0,0,0,0,0,0
.quad 0,0,0,0,0,0,0,0,0,0,0,0,0,0,0,0
.quad 0x3400340034003400,0x3400340034003400,0xb4003400b4003400,0xb4003400b4003400,0x357cad9134dc31c9,0xad91b57c31c9b4dc,0x2d91357cb1c934dc,0x357cad9134dc31c9,0x2e6fb56c356c2e6f,0xae6f356cb56cae6f,0x356c2e6fae6f356c,0xb56cae6f2e6fb56c,0xb3adb42835a72338,0x3428b3ada33835a7,0x3428b3ada33835a7,0x33ad3428b5a7a338
.quad 0xb5892cb03589acb0,0xb5892cb03589acb0,0xacb0b5892cb03589,0xacb0b5892cb03589,0xaf4c355b3513b0fe,0x355b2f4cb0feb513,0xb55baf4c30fe3513,0xaf4c355b3513b0fe,0x3356344e344eb356,0xb356b44eb44e3356,0xb44e33563356344e,0x344eb356b356b44e,0x3594ab9a328bb49d,0x2b9a3594349d328b,0x2b9a3594349d328b,0xb5942b9ab28b349d
.quad 0x3400340034003400,0x3400340034003400,0xb4003400b4003400,0xb4003400b4003400,0xb57c2d91b4dcb1c9,0x2d91357cb1c934dc,0xad91b57c31c9b4dc,0xb57c2d91b4dcb1c9,0x2e6fb56c356c2e6f,0xae6f356cb56cae6f,0x356c2e6fae6f356c,0xb56cae6f2e6fb56c,0x33ad3428b5a7a338,0xb42833ad2338b5a7,0xb42833ad2338b5a7,0xb3adb42835a72338
.quad 0xb5892cb03589acb0,0xb5892cb03589acb0,0xacb0b5892cb03589,0xacb0b5892cb03589,0x2f4cb55bb51330fe,0xb55baf4c30fe3513,0x355b2f4cb0feb513,0x2f4cb55bb51330fe,0x3356344e344eb356,0xb356b44eb44e3356,0xb44e33563356344e,0x344eb356b356b44e,0xb5942b9ab28b349d,0xab9ab594b49db28b,0xab9ab594b49db28b,0x3594ab9a328bb49d
.quad 0,0,0,0,0,0,0,0,0,0,0,0,0,0,0,0
.quad 0,0,0,0,0,0,0,0,0,0,0,0,0,0,0,0
.quad 0,0,0,0,0,0,0,0,0,0,0,0,0,0,0,0
.quad 0,0,0,0,0,0,0,0,0,0,0,0,0,0,0,0
.quad 0x3400340034003400,0x3400340034003400,0xb4003400b4003400,0xb4003400b4003400,0x357bada234df31c2,0xada2b57b31c2b4df,0x2da2357bb1c234df,0x357bada234df31c2,0x2e4db56f356f2e4d,0xae4d356fb56fae4d,0x356f2e4dae4d356f,0xb56fae4d2e4db56f,0xb3c0b41f35a7218d,0x341fb3c0a18d35a7,0x341fb3c0a18d35a7,0x33c0341fb5a7a18d
.quad 0xb5852cf53585acf5,0xb5852cf53585acf5,0xacf5b5852cf53585,0xacf5b5852cf53585,0xaef73562350ab126,0x35622ef7b126b50a,0xb562aef73126350a,0xaef73562350ab126,0x337f343d343db37f,0xb37fb43db43d337f,0xb43d337f337f343d,0x343db37fb37fb43d,0x358eac473258b4af,0x2c47358e34af3258,0x2c47358e34af3258,0xb58e2c47b25834af
.quad 0x3400340034003400,0x3400340034003400,0xb4003400b4003400,0xb4003400b4003400,0xb57b2da2b4dfb1c2,0x2da2357bb1c234df,0xada2b57b31c2b4df,0xb57b2da2b4dfb1c2,0x2e4db56f356f2e4d,0xae4d356fb56fae4d,0x356f2e4dae4d356f,0xb56fae4d2e4db56f,0x33c0341fb5a7a18d,0xb41f33c0218db5a7,0xb41f33c0218db5a7,0xb3c0b41f35a7218d
.quad 0xb5852cf53585acf5,0xb5852cf53585acf5,0xacf5b5852cf53585,0xacf5b5852cf53585,0x2ef7b562b50a3126,0xb562aef73126350a,0x35622ef7b126b50a,0x2ef7b562b50a3126,0x337f343d343db37f,0xb37fb43db43d337f,0xb43d337f337f343d,0x343db37fb37fb43d,0xb58e2c47b25834af,0xac47b58eb4afb258,0xac47b58eb4afb258,0x358eac473258b4af
.quad 0,0,0,0,0,0,0,0,0,0,0,0,0,0,0,0
.quad 0,0,0,0,0,0,0,0,0,0,0,0,0,0,0,0
.quad 0,0,0,0,0,0,0,0,0,0,0,0,0,0,0,0
.quad 0,0,0,0,0,0,0,0,0,0,0,0,0,0,0,0
.quad 0x3400340034003400,0x3400340034003400,0xb4003400b4003400,0xb4003400b4003400,0x3579adb334e131ba,0xadb3b57931bab4e1,0x2db33579b1ba34e1,0x3579adb334e131ba,0x2e2bb57135712e2b,0xae2b3571b571ae2b,0x35712e2bae2b3571,0xb571ae2b2e2bb571,0xb3d4b41635a81fc6,0x3416b3d49fc635a8,0x3416b3d49fc635a8,0x33d43416b5a89fc6
.quad 0xb5812d3a3581ad3a,0xb5812d3a3581ad3a,0xad3ab5812d3a3581,0xad3ab5812d3a3581,0xaea3356934ffb14d,0x35692ea3b14db4ff,0xb569aea3314d34ff,0xaea3356934ffb14d,0x33a6342b342bb3a6,0xb3a6b42bb42b33a6,0xb42b33a633a6342b,0x342bb3a6b3a6b42b,0x3588acc13224b4c0,0x2cc1358834c03224,0x2cc1358834c03224,0xb5882cc1b22434c0
.quad 0x3400340034003400,0x3400340034003400,0xb4003400b4003400,0xb4003400b4003400,0xb5792db3b4e1b1ba,0x2db33579b1ba34e1,0xadb3b57931bab4e1,0xb5792db3b4e1b1ba,0x2e2bb57135712e2b,0xae2b3571b571ae2b,0x35712e2bae2b3571,0xb571ae2b2e2bb571,0x33d43416b5a89fc6,0xb41633d41fc6b5a8,0xb41633d41fc6b5a8,0xb3d4b41635a81fc6
.quad 0xb5812d3a3581ad3a,0xb5812d3a3581ad3a,0xad3ab5812d3a3581,0xad3ab5812d3a3581,0x2ea3b569b4ff314d,0xb569aea3314d34ff,0x35692ea3b14db4ff,0x2ea3b569b4ff314d,0x33a6342b342bb3a6,0xb3a6b42bb42b33a6,0xb42b33a633a6342b,0x342bb3a6b3a6b42b,0xb5882cc1b22434c0,0xacc1b588b4c0b224,0xacc1b588b4c0b224,0x3588acc13224b4c0
.quad 0,0,0,0,0,0,0,0,0,0,0,0,0,0,0,0
.quad 0,0,0,0,0,0,0,0,0,0,0,0,0,0,0,0
.quad 0,0,0,0,0,0,0,0,0,0,0,0,0,0,0,0
.quad 0,0,0,0,0,0,0,0,0,0,0,0,0,0,0,0
.quad 0x3400340034003400,0x3400340034003400,0xb4003400b4003400,0xb4003400b4003400,0x3578adc434e331b2,0xadc4b57831b2b4e3,0x2dc43578b1b234e3,0x3578adc434e331b2,0x2e09b57435742e09,0xae093574b574ae09,0x35742e09ae093574,0xb574ae092e09b574,0xb3e7b40c35a81c71,0x340cb3e79c7135a8,0x340cb3e79c7135a8,0x33e7340cb5a89c71
.quad 0xb57d2d7f357dad7f,0xb57d2d7f357dad7f,0xad7fb57d2d7f357d,0xad7fb57d2d7f357d,0xae4d356f34f5b175,0x356f2e4db175b4f5,0xb56fae4d317534f5,0xae4d356f34f5b175,0x33cd34193419b3cd,0xb3cdb419b41933cd,0xb41933cd33cd3419,0x3419b3cdb3cdb419,0x3581ad3a31efb4d1,0x2d3a358134d131ef,0x2d3a358134d131ef,0xb5812d3ab1ef34d1
.quad 0x3400340034003400,0x3400340034003400,0xb4003400b4003400,0xb4003400b4003400,0xb5782dc4b4e3b1b2,0x2dc43578b1b234e3,0xadc4b57831b2b4e3,0xb5782dc4b4e3b1b2,0x2e09b57435742e09,0xae093574b574ae09,0x35742e09ae093574,0xb574ae092e09b574,0x33e7340cb5a89c71,0xb40c33e71c71b5a8,0xb40c33e71c71b5a8,0xb3e7b40c35a81c71
.quad 0xb57d2d7f357dad7f,0xb57d2d7f357dad7f,0xad7fb57d2d7f357d,0xad7fb57d2d7f357d,0x2e4db56fb4f53175,0xb56fae4d317534f5,0x356f2e4db175b4f5,0x2e4db56fb4f53175,0x33cd34193419b3cd,0xb3cdb419b41933cd,0xb41933cd33cd3419,0x3419b3cdb3cdb419,0xb5812d3ab1ef34d1,0xad3ab581b4d1b1ef,0xad3ab581b4d1b1ef,0x3581ad3a31efb4d1
.quad 0,0,0,0,0,0,0,0,0,0,0,0,0,0,0,0
.quad 0,0,0,0,0,0,0,0,0,0,0,0,0,0,0,0
.quad 0,0,0,0,0,0,0,0,0,0,0,0,0,0,0,0
.quad 0,0,0,0,0,0,0,0,0,0,0,0,0,0,0,0
.quad 0x3400340034003400,0x3400340034003400,0xb4003400b4003400,0xb4003400b4003400,0x3577add634e531ab,0xadd6b57731abb4e5,0x2dd63577b1ab34e5,0x3577add634e531ab,0x2de7b57635762de7,0xade73576b576ade7,0x35762de7ade73576,0xb576ade72de7b576,0xb3fab40335a81471,0x3403b3fa947135a8,0x3403b3fa947135a8,0x33fa3403b5a89471
.quad 0xb5782dc43578adc4,0xb5782dc43578adc4,0xadc4b5782dc43578,0xadc4b5782dc43578,0xadf8357534eab19b,0x35752df8b19bb4ea,0xb575adf8319b34ea,0xadf8357534eab19b,0x33f334063406b3f3,0xb3f3b406b40633f3,0xb40633f333f33406,0x3406b3f3b3f3b406,0x3579adb331bab4e1,0x2db3357934e131ba,0x2db3357934e131ba,0xb5792db3b1ba34e1
.quad 0x3400340034003400,0x3400340034003400,0xb4003400b4003400,0xb4003400b4003400,0xb5772dd6b4e5b1ab,0x2dd63577b1ab34e5,0xadd6b57731abb4e5,0xb5772dd6b4e5b1ab,0x2de7b57635762de7,0xade73576b576ade7,0x35762de7ade73576,0xb576ade72de7b576,0x33fa3403b5a89471,0xb40333fa1471b5a8,0xb40333fa1471b5a8,0xb3fab40335a81471
.quad 0xb5782dc43578adc4,0xb5782dc43578adc4,0xadc4b5782dc43578,0xadc4b5782dc43578,0x2df8b575b4ea319b,0xb575adf8319b34ea,0x35752df8b19bb4ea,0x2df8b575b4ea319b,0x33f334063406b3f3,0xb3f3b406b40633f3,0xb40633f333f33406,0x3406b3f3b3f3b406,0xb5792db3b1ba34e1,0xadb3b579b4e1b1ba,0xadb3b579b4e1b1ba,0x3579adb331bab4e1
.quad 0,0,0,0,0,0,0,0,0,0,0,0,0,0,0,0
.quad 0,0,0,0,0,0,0,0,0,0,0,0,0,0,0,0
.quad 0,0,0,0,0,0,0,0,0,0,0,0,0,0,0,0
.quad 0,0,0,0,0,0,0,0,0,0,0,0,0,0,0,0
.quad 0x3400340034003400,0x3400340034003400,0xb4003400b4003400,0xb4003400b4003400,0x3576ade734e831a3,0xade7b57631a3b4e8,0x2de73576b1a334e8,0x3576ade734e831a3,0x2dc4b57835782dc4,0xadc43578b578adc4,0x35782dc4adc43578,0xb578adc42dc4b578,0xb406b3f335a89871,0x33f3b406187135a8,0x33f3b406187135a8,0x340633f3b5a81871
.quad 0xb5742e093574ae09,0xb5742e093574ae09,0xae09b5742e093574,0xae09b5742e093574,0xada2357b34dfb1c2,0x357b2da2b1c2b4df,0xb57bada231c234df,0xada2357b34dfb1c2,0x340c33e733e7b40c,0xb40cb3e7b3e7340c,0xb3e7340c340c33e7,0x33e7b40cb40cb3e7,0x3571ae2b3184b4f0,0x2e2b357134f03184,0x2e2b357134f03184,0xb5712e2bb18434f0
.quad 0x3400340034003400,0x3400340034003400,0xb4003400b4003400,0xb4003400b4003400,0xb5762de7b4e8b1a3,0x2de73576b1a334e8,0xade7b57631a3b4e8,0xb5762de7b4e8b1a3,0x2dc4b57835782dc4,0xadc43578b578adc4,0x35782dc4adc43578,0xb578adc42dc4b578,0x340633f3b5a81871,0xb3f334069871b5a8,0xb3f334069871b5a8,0xb406b3f335a89871
.quad 0xb5742e093574ae09,0xb5742e093574ae09,0xae09b5742e093574,0xae09b5742e093574,0x2da2b57bb4df31c2,0xb57bada231c234df,0x357b2da2b1c2b4df,0x2da2b57bb4df31c2,0x340c33e733e7b40c,0xb40cb3e7b3e7340c,0xb3e7340c340c33e7,0x33e7b40cb40cb3e7,0xb5712e2bb18434f0,0xae2bb571b4f0b184,0xae2bb571b4f0b184,0x3571ae2b3184b4f0
.quad 0,0,0,0,0,0,0,0,0,0,0,0,0,0,0,0
.quad 0,0,0,0,0,0,0,0,0,0,0,0,0,0,0,0
.quad 0,0,0,0,0,0,0,0,0,0,0,0,0,0,0,0
.quad 0,0,0,0,0,0,0,0,0,0,0,0,0,0,0,0
.quad 0x3400340034003400,0x3400340034003400,0xb4003400b4003400,0xb4003400b4003400,0x3575adf834ea319b,0xadf8b575319bb4ea,0x2df83575b19b34ea,0x3575adf834ea319b,0x2da2b57b357b2da2,0xada2357bb57bada2,0x357b2da2ada2357b,0xb57bada22da2b57b,0xb410b3e035a89d8e,0x33e0b4101d8e35a8,0x33e0b4101d8e35a8,0x341033e0b5a81d8e
.quad 0xb56f2e4d356fae4d,0xb56f2e4d356fae4d,0xae4db56f2e4d356f,0xae4db56f2e4d356f,0xad4c358034d3b1e8,0x35802d4cb1e8b4d3,0xb580ad4c31e834d3,0xad4c358034d3b1e8,0x341f33c033c0b41f,0xb41fb3c0b3c0341f,0xb3c0341f341f33c0,0x33c0b41fb41fb3c0,0x3569aea3314db4ff,0x2ea3356934ff314d,0x2ea3356934ff314d,0xb5692ea3b14d34ff
.quad 0x3400340034003400,0x3400340034003400,0xb4003400b4003400,0xb4003400b4003400,0xb5752df8b4eab19b,0x2df83575b19b34ea,0xadf8b575319bb4ea,0xb5752df8b4eab19b,0x2da2b57b357b2da2,0xada2357bb57bada2,0x357b2da2ada2357b,0xb57bada22da2b57b,0x341033e0b5a81d8e,0xb3e034109d8eb5a8,0xb3e034109d8eb5a8,0xb410b3e035a89d8e
.quad 0xb56f2e4d356fae4d,0xb56f2e4d356fae4d,0xae4db56f2e4d356f,0xae4db56f2e4d356f,0x2d4cb580b4d331e8,0xb580ad4c31e834d3,0x35802d4cb1e8b4d3,0x2d4cb580b4d331e8,0x341f33c033c0b41f,0xb41fb3c0b3c0341f,0xb3c0341f341f33c0,0x33c0b41fb41fb3c0,0xb5692ea3b14d34ff,0xaea3b569b4ffb14d,0xaea3b569b4ffb14d,0x3569aea3314db4ff
.quad 0,0,0,0,0,0,0,0,0,0,0,0,0,0,0,0
.quad 0,0,0,0,0,0,0,0,0,0,0,0,0,0,0,0
.quad 0,0,0,0,0,0,0,0,0,0,0,0,0,0,0,0
.quad 0,0,0,0,0,0,0,0,0,0,0,0,0,0,0,0
.quad 0x3400340034003400,0x3400340034003400,0xb4003400b4003400,0xb4003400b4003400,0x3574ae0934ec3194,0xae09b5743194b4ec,0x2e093574b19434ec,0x3574ae0934ec3194,0x2d7fb57d357d2d7f,0xad7f357db57dad7f,0x357d2d7fad7f357d,0xb57dad7f2d7fb57d,0xb419b3cd35a8a071,0x33cdb419207135a8,0x33cdb419207135a8,0x341933cdb5a82071
.quad 0xb56a2e92356aae92,0xb56a2e92356aae92,0xae92b56a2e92356a,0xae92b56a2e92356a,0xacf5358534c7b20e,0x35852cf5b20eb4c7,0xb585acf5320e34c7,0xacf5358534c7b20e,0x343133993399b431,0xb431b399b3993431,0xb399343134313399,0x3399b431b431b399,0x355faf193116b50e,0x2f19355f350e3116,0x2f19355f350e3116,0xb55f2f19b116350e
.quad 0x3400340034003400,0x3400340034003400,0xb4003400b4003400,0xb4003400b4003400,0xb5742e09b4ecb194,0x2e093574b19434ec,0xae09b5743194b4ec,0xb5742e09b4ecb194,0x2d7fb57d357d2d7f,0xad7f357db57dad7f,0x357d2d7fad7f357d,0xb57dad7f2d7fb57d,0x341933cdb5a82071,0xb3cd3419a071b5a8,0xb3cd3419a071b5a8,0xb419b3cd35a8a071
.quad 0xb56a2e92356aae92,0xb56a2e92356aae92,0xae92b56a2e92356a,0xae92b56a2e92356a,0x2cf5b585b4c7320e,0xb585acf5320e34c7,0x35852cf5b20eb4c7,0x2cf5b585b4c7320e,0x343133993399b431,0xb431b399b3993431,0xb399343134313399,0x3399b431b431b399,0xb55f2f19b116350e,0xaf19b55fb50eb116,0xaf19b55fb50eb116,0x355faf193116b50e
.quad 0,0,0,0,0,0,0,0,0,0,0,0,0,0,0,0
.quad 0,0,0,0,0,0,0,0,0,0,0,0,0,0,0,0
.quad 0,0,0,0,0,0,0,0,0,0,0,0,0,0,0,0
.quad 0,0,0,0,0,0,0,0,0,0,0,0,0,0,0,0
.quad 0x3400340034003400,0x3400340034003400,0xb4003400b4003400,0xb4003400b4003400,0x3573ae1a34ee318c,0xae1ab573318cb4ee,0x2e1a3573b18c34ee,0x3573ae1a34ee318c,0x2d5db57f357f2d5d,0xad5d357fb57fad5d,0x357f2d5dad5d357f,0xb57fad5d2d5db57f,0xb422b3ba35a7a21c,0x33bab422221c35a7,0x33bab422221c35a7,0x342233bab5a7221c
.quad 0xb5652ed53565aed5,0xb5652ed53565aed5,0xaed5b5652ed53565,0xaed5b5652ed53565,0xac9e358a34bbb233,0x358a2c9eb233b4bb,0xb58aac9e323334bb,0xac9e358a34bbb233,0x344333713371b443,0xb443b371b3713443,0xb371344334433371,0x3371b443b443b371,0x3555af8f30deb51b,0x2f8f3555351b30de,0x2f8f3555351b30de,0xb5552f8fb0de351b
.quad 0x3400340034003400,0x3400340034003400,0xb4003400b4003400,0xb4003400b4003400,0xb5732e1ab4eeb18c,0x2e1a3573b18c34ee,0xae1ab573318cb4ee,0xb5732e1ab4eeb18c,0x2d5db57f357f2d5d,0xad5d357fb57fad5d,0x357f2d5dad5d357f,0xb57fad5d2d5db57f,0x342233bab5a7221c,0xb3ba3422a21cb5a7,0xb3ba3422a21cb5a7,0xb422b3ba35a7a21c
.quad 0xb5652ed53565aed5,0xb5652ed53565aed5,0xaed5b5652ed53565,0xaed5b5652ed53565,0x2c9eb58ab4bb3233,0xb58aac9e323334bb,0x358a2c9eb233b4bb,0x2c9eb58ab4bb3233,0x344333713371b443,0xb443b371b3713443,0xb371344334433371,0x3371b443b443b371,0xb5552f8fb0de351b,0xaf8fb555b51bb0de,0xaf8fb555b51bb0de,0x3555af8f30deb51b
.quad 0,0,0,0,0,0,0,0,0,0,0,0,0,0,0,0
.quad 0,0,0,0,0,0,0,0,0,0,0,0,0,0,0,0
.quad 0,0,0,0,0,0,0,0,0,0,0,0,0,0,0,0
.quad 0,0,0,0,0,0,0,0,0,0,0,0,0,0,0,0
.quad 0x3400340034003400,0x3400340034003400,0xb4003400b4003400,0xb4003400b4003400,0x3571ae2b34f03184,0xae2bb5713184b4f0,0x2e2b3571b18434f0,0x3571ae2b34f03184,0x2d3ab58135812d3a,0xad3a3581b581ad3a,0x35812d3aad3a3581,0xb581ad3a2d3ab581,0xb42bb3a635a7a3c6,0x33a6b42b23c635a7,0x33a6b42b23c635a7,0x342b33a6b5a723c6
.quad 0xb55f2f19355faf19,0xb55f2f19355faf19,0xaf19b55f2f19355f,0xaf19b55f2f19355f,0xac47358e34afb258,0x358e2c47b258b4af,0xb58eac47325834af,0xac47358e34afb258,0x345433493349b454,0xb454b349b3493454,0xb349345434543349,0x3349b454b454b349,0x354ab00230a6b528,0x3002354a352830a6,0x3002354a352830a6,0xb54a3002b0a63528
.quad 0x3400340034003400,0x3400340034003400,0xb4003400b4003400,0xb4003400b4003400,0xb5712e2bb4f0b184,0x2e2b3571b18434f0,0xae2bb5713184b4f0,0xb5712e2bb4f0b184,0x2d3ab58135812d3a,0xad3a3581b581ad3a,0x35812d3aad3a3581,0xb581ad3a2d3ab581,0x342b33a6b5a723c6,0xb3a6342ba3c6b5a7,0xb3a6342ba3c6b5a7,0xb42bb3a635a7a3c6
.quad 0xb55f2f19355faf19,0xb55f2f19355faf19,0xaf19b55f2f19355f,0xaf19b55f2f19355f,0x2c47b58eb4af3258,0xb58eac47325834af,0x358e2c47b258b4af,0x2c47b58eb4af3258,0x345433493349b454,0xb454b349b3493454,0xb349345434543349,0x3349b454b454b349,0xb54a3002b0a63528,0xb002b54ab528b0a6,0xb002b54ab528b0a6,0x354ab00230a6b528
.quad 0,0,0,0,0,0,0,0,0,0,0,0,0,0,0,0
.quad 0,0,0,0,0,0,0,0,0,0,0,0,0,0,0,0
.quad 0,0,0,0,0,0,0,0,0,0,0,0,0,0,0,0
.quad 0,0,0,0,0,0,0,0,0,0,0,0,0,0,0,0
.quad 0x3400340034003400,0x3400340034003400,0xb4003400b4003400,0xb4003400b4003400,0x3570ae3c34f3317c,0xae3cb570317cb4f3,0x2e3c3570b17c34f3,0x3570ae3c34f3317c,0x2d18b58335832d18,0xad183583b583ad18,0x35832d18ad183583,0xb583ad182d18b583,0xb434b39235a6a4b8,0x3392b43424b835a6,0x3392b43424b835a6,0x34343392b5a624b8
.quad 0xb5592f5c3559af5c,0xb5592f5c3559af5c,0xaf5cb5592f5c3559,0xaf5cb5592f5c3559,0xabe0359234a3b27c,0x35922be0b27cb4a3,0xb592abe0327c34a3,0xabe0359234a3b27c,0x346533203320b465,0xb465b320b3203465,0xb320346534653320,0x3320b465b465b320,0x353fb03c306db535,0x303c353f3535306d,0x303c353f3535306d,0xb53f303cb06d3535
.quad 0x3400340034003400,0x3400340034003400,0xb4003400b4003400,0xb4003400b4003400,0xb5702e3cb4f3b17c,0x2e3c3570b17c34f3,0xae3cb570317cb4f3,0xb5702e3cb4f3b17c,0x2d18b58335832d18,0xad183583b583ad18,0x35832d18ad183583,0xb583ad182d18b583,0x34343392b5a624b8,0xb3923434a4b8b5a6,0xb3923434a4b8b5a6,0xb434b39235a6a4b8
.quad 0xb5592f5c3559af5c,0xb5592f5c3559af5c,0xaf5cb5592f5c3559,0xaf5cb5592f5c3559,0x2be0b592b4a3327c,0xb592abe0327c34a3,0x35922be0b27cb4a3,0x2be0b592b4a3327c,0x346533203320b465,0xb465b320b3203465,0xb320346534653320,0x3320b465b465b320,0xb53f303cb06d3535,0xb03cb53fb535b06d,0xb03cb53fb535b06d,0x353fb03c306db535
.quad 0,0,0,0,0,0,0,0,0,0,0,0,0,0,0,0
.quad 0,0,0,0,0,0,0,0,0,0,0,0,0,0,0,0
.quad 0,0,0,0,0,0,0,0,0,0,0,0,0,0,0,0
.quad 0,0,0,0,0,0,0,0,0,0,0,0,0,0,0,0
.quad 0x3400340034003400,0x3400340034003400,0xb4003400b4003400,0xb4003400b4003400,0x356fae4d34f53175,0xae4db56f3175b4f5,0x2e4d356fb17534f5,0x356fae4d34f53175,0x2cf5b58535852cf5,0xacf53585b585acf5,0x35852cf5acf53585,0xb585acf52cf5b585,0xb43db37f35a5a58d,0x337fb43d258d35a5,0x337fb43d258d35a5,0x343d337fb5a5258d
.quad 0xb5542f9f3554af9f,0xb5542f9f3554af9f,0xaf9fb5542f9f3554,0xaf9fb5542f9f3554,0xab3035963496b2a1,0x35962b30b2a1b496,0xb596ab3032a13496,0xab3035963496b2a1,0x347632f632f6b476,0xb476b2f6b2f63476,0xb2f63476347632f6,0x32f6b476b476b2f6,0x3533b0753033b541,0x3075353335413033,0x3075353335413033,0xb5333075b0333541
.quad 0x3400340034003400,0x3400340034003400,0xb4003400b4003400,0xb4003400b4003400,0xb56f2e4db4f5b175,0x2e4d356fb17534f5,0xae4db56f3175b4f5,0xb56f2e4db4f5b175,0x2cf5b58535852cf5,0xacf53585b585acf5,0x35852cf5acf53585,0xb585acf52cf5b585,0x343d337fb5a5258d,0xb37f343da58db5a5,0xb37f343da58db5a5,0xb43db37f35a5a58d
.quad 0xb5542f9f3554af9f,0xb5542f9f3554af9f,0xaf9fb5542f9f3554,0xaf9fb5542f9f3554,0x2b30b596b49632a1,0xb596ab3032a13496,0x35962b30b2a1b496,0x2b30b596b49632a1,0x347632f632f6b476,0xb476b2f6b2f63476,0xb2f63476347632f6,0x32f6b476b476b2f6,0xb5333075b0333541,0xb075b533b541b033,0xb075b533b541b033,0x3533b0753033b541
.quad 0,0,0,0,0,0,0,0,0,0,0,0,0,0,0,0
.quad 0,0,0,0,0,0,0,0,0,0,0,0,0,0,0,0
.quad 0,0,0,0,0,0,0,0,0,0,0,0,0,0,0,0
.quad 0,0,0,0,0,0,0,0,0,0,0,0,0,0,0,0
.quad 0x3400340034003400,0x3400340034003400,0xb4003400b4003400,0xb4003400b4003400,0x356eae5e34f7316d,0xae5eb56e316db4f7,0x2e5e356eb16d34f7,0x356eae5e34f7316d,0x2cd2b58735872cd2,0xacd23587b587acd2,0x35872cd2acd23587,0xb587acd22cd2b587,0xb446b36b35a5a662,0x336bb446266235a5,0x336bb446266235a5,0x3446336bb5a52662
.quad 0xb54d2fe2354dafe2,0xb54d2fe2354dafe2,0xafe2b54d2fe2354d,0xafe2b54d2fe2354d,0xaa8135993489b2c4,0x35992a81b2c4b489,0xb599aa8132c43489,0xaa8135993489b2c4,0x348632cc32ccb486,0xb486b2ccb2cc3486,0xb2cc3486348632cc,0x32ccb486b486b2cc,0x3526b0ae2ff3b54c,0x30ae3526354c2ff3,0x30ae3526354c2ff3,0xb52630aeaff3354c
.quad 0x3400340034003400,0x3400340034003400,0xb4003400b4003400,0xb4003400b4003400,0xb56e2e5eb4f7b16d,0x2e5e356eb16d34f7,0xae5eb56e316db4f7,0xb56e2e5eb4f7b16d,0x2cd2b58735872cd2,0xacd23587b587acd2,0x35872cd2acd23587,0xb587acd22cd2b587,0x3446336bb5a52662,0xb36b3446a662b5a5,0xb36b3446a662b5a5,0xb446b36b35a5a662
.quad 0xb54d2fe2354dafe2,0xb54d2fe2354dafe2,0xafe2b54d2fe2354d,0xafe2b54d2fe2354d,0x2a81b599b48932c4,0xb599aa8132c43489,0x35992a81b2c4b489,0x2a81b599b48932c4,0x348632cc32ccb486,0xb486b2ccb2cc3486,0xb2cc3486348632cc,0x32ccb486b486b2cc,0xb52630aeaff3354c,0xb0aeb526b54caff3,0xb0aeb526b54caff3,0x3526b0ae2ff3b54c
.quad 0,0,0,0,0,0,0,0,0,0,0,0,0,0,0,0
.quad 0,0,0,0,0,0,0,0,0,0,0,0,0,0,0,0
.quad 0,0,0,0,0,0,0,0,0,0,0,0,0,0,0,0
.quad 0,0,0,0,0,0,0,0,0,0,0,0,0,0,0,0
.quad 0x3400340034003400,0x3400340034003400,0xb4003400b4003400,0xb4003400b4003400,0x356cae6f34f93165,0xae6fb56c3165b4f9,0x2e6f356cb16534f9,0x356cae6f34f93165,0x2cb0b58935892cb0,0xacb03589b589acb0,0x35892cb0acb03589,0xb589acb02cb0b589,0xb44eb35635a4a736,0x3356b44e273635a4,0x3356b44e273635a4,0x344e3356b5a42736
.quad 0xb54730123547b012,0xb54730123547b012,0xb012b54730123547,0xb012b54730123547,0xa9d1359c347bb2e8,0x359c29d1b2e8b47b,0xb59ca9d132e8347b,0xa9d1359c347bb2e8,0x349632a132a1b496,0xb496b2a1b2a13496,0xb2a13496349632a1,0x32a1b496b496b2a1,0x3519b0e62f7eb556,0x30e6351935562f7e,0x30e6351935562f7e,0xb51930e6af7e3556
.quad 0x3400340034003400,0x3400340034003400,0xb4003400b4003400,0xb4003400b4003400,0xb56c2e6fb4f9b165,0x2e6f356cb16534f9,0xae6fb56c3165b4f9,0xb56c2e6fb4f9b165,0x2cb0b58935892cb0,0xacb03589b589acb0,0x35892cb0acb03589,0xb589acb02cb0b589,0x344e3356b5a42736,0xb356344ea736b5a4,0xb356344ea736b5a4,0xb44eb35635a4a736
.quad 0xb54730123547b012,0xb54730123547b012,0xb012b54730123547,0xb012b54730123547,0x29d1b59cb47b32e8,0xb59ca9d132e8347b,0x359c29d1b2e8b47b,0x29d1b59cb47b32e8,0x349632a132a1b496,0xb496b2a1b2a13496,0xb2a13496349632a1,0x32a1b496b496b2a1,0xb51930e6af7e3556,0xb0e6b519b556af7e,0xb0e6b519b556af7e,0x3519b0e62f7eb556
.quad 0,0,0,0,0,0,0,0,0,0,0,0,0,0,0,0
.quad 0,0,0,0,0,0,0,0,0,0,0,0,0,0,0,0
.quad 0,0,0,0,0,0,0,0,0,0,0,0,0,0,0,0
.quad 0,0,0,0,0,0,0,0,0,0,0,0,0,0,0,0
.quad 0x3400340034003400,0x3400340034003400,0xb4003400b4003400,0xb4003400b4003400,0x356bae8034fb315d,0xae80b56b315db4fb,0x2e80356bb15d34fb,0x356bae8034fb315d,0x2c8db58b358b2c8d,0xac8d358bb58bac8d,0x358b2c8dac8d358b,0xb58bac8d2c8db58b,0xb457b34235a2a805,0x3342b457280535a2,0x3342b457280535a2,0x34573342b5a22805
.quad 0xb54130333541b033,0xb54130333541b033,0xb033b54130333541,0xb033b54130333541,0xa920359f346db30b,0x359f2920b30bb46d,0xb59fa920330b346d,0xa920359f346db30b,0x34a532753275b4a5,0xb4a5b275b27534a5,0xb27534a534a53275,0x3275b4a5b4a5b275,0x350cb11e2f08b560,0x311e350c35602f08,0x311e350c35602f08,0xb50c311eaf083560
.quad 0x3400340034003400,0x3400340034003400,0xb4003400b4003400,0xb4003400b4003400,0xb56b2e80b4fbb15d,0x2e80356bb15d34fb,0xae80b56b315db4fb,0xb56b2e80b4fbb15d,0x2c8db58b358b2c8d,0xac8d358bb58bac8d,0x358b2c8dac8d358b,0xb58bac8d2c8db58b,0x34573342b5a22805,0xb3423457a805b5a2,0xb3423457a805b5a2,0xb457b34235a2a805
.quad 0xb54130333541b033,0xb54130333541b033,0xb033b54130333541,0xb033b54130333541,0x2920b59fb46d330b,0xb59fa920330b346d,0x359f2920b30bb46d,0x2920b59fb46d330b,0x34a532753275b4a5,0xb4a5b275b27534a5,0xb27534a534a53275,0x3275b4a5b4a5b275,0xb50c311eaf083560,0xb11eb50cb560af08,0xb11eb50cb560af08,0x350cb11e2f08b560
.quad 0,0,0,0,0,0,0,0,0,0,0,0,0,0,0,0
.quad 0,0,0,0,0,0,0,0,0,0,0,0,0,0,0,0
.quad 0,0,0,0,0,0,0,0,0,0,0,0,0,0,0,0
.quad 0,0,0,0,0,0,0,0,0,0,0,0,0,0,0,0
.quad 0x3400340034003400,0x3400340034003400,0xb4003400b4003400,0xb4003400b4003400,0x356aae9234fd3155,0xae92b56a3155b4fd,0x2e92356ab15534fd,0x356aae9234fd3155,0x2c6ab58c358c2c6a,0xac6a358cb58cac6a,0x358c2c6aac6a358c,0xb58cac6a2c6ab58c,0xb45fb32d35a1a870,0x332db45f287035a1,0x332db45f287035a1,0x345f332db5a12870
.quad 0xb53a3054353ab054,0xb53a3054353ab054,0xb054b53a3054353a,0xb054b53a3054353a,0xa87035a1345fb32d,0x35a12870b32db45f,0xb5a1a870332d345f,0xa87035a1345fb32d,0x34b432493249b4b4,0xb4b4b249b24934b4,0xb24934b434b43249,0x3249b4b4b4b4b249,0x34fdb1552e92b56a,0x315534fd356a2e92,0x315534fd356a2e92,0xb4fd3155ae92356a
.quad 0x3400340034003400,0x3400340034003400,0xb4003400b4003400,0xb4003400b4003400,0xb56a2e92b4fdb155,0x2e92356ab15534fd,0xae92b56a3155b4fd,0xb56a2e92b4fdb155,0x2c6ab58c358c2c6a,0xac6a358cb58cac6a,0x358c2c6aac6a358c,0xb58cac6a2c6ab58c,0x345f332db5a12870,0xb32d345fa870b5a1,0xb32d345fa870b5a1,0xb45fb32d35a1a870
.quad 0xb53a3054353ab054,0xb53a3054353ab054,0xb054b53a3054353a,0xb054b53a3054353a,0x2870b5a1b45f332d,0xb5a1a870332d345f,0x35a12870b32db45f,0x2870b5a1b45f332d,0x34b432493249b4b4,0xb4b4b249b24934b4,0xb24934b434b43249,0x3249b4b4b4b4b249,0xb4fd3155ae92356a,0xb155b4fdb56aae92,0xb155b4fdb56aae92,0x34fdb1552e92b56a
.quad 0,0,0,0,0,0,0,0,0,0,0,0,0,0,0,0
.quad 0,0,0,0,0,0,0,0,0,0,0,0,0,0,0,0
.quad 0,0,0,0,0,0,0,0,0,0,0,0,0,0,0,0
.quad 0,0,0,0,0,0,0,0,0,0,0,0,0,0,0,0
.quad 0x3400340034003400,0x3400340034003400,0xb4003400b4003400,0xb4003400b4003400,0x3569aea334ff314d,0xaea3b569314db4ff,0x2ea33569b14d34ff,0x3569aea334ff314d,0x2c47b58e358e2c47,0xac47358eb58eac47,0x358e2c47ac47358e,0xb58eac472c47b58e,0xb468b31935a0a8da,0x3319b46828da35a0,0x3319b46828da35a0,0x34683319b5a028da
.quad 0xb53330753533b075,0xb53330753533b075,0xb075b53330753533,0xb075b53330753533,0xa77d35a33451b350,0x35a3277db350b451,0xb5a3a77d33503451,0xa77d35a33451b350,0x34c3321d321db4c3,0xb4c3b21db21d34c3,0xb21d34c334c3321d,0x321db4c3b4c3b21d,0x34eeb18c2e1ab573,0x318c34ee35732e1a,0x318c34ee35732e1a,0xb4ee318cae1a3573
.quad 0x3400340034003400,0x3400340034003400,0xb4003400b4003400,0xb4003400b4003400,0xb5692ea3b4ffb14d,0x2ea33569b14d34ff,0xaea3b569314db4ff,0xb5692ea3b4ffb14d,0x2c47b58e358e2c47,0xac47358eb58eac47,0x358e2c47ac47358e,0xb58eac472c47b58e,0x34683319b5a028da,0xb3193468a8dab5a0,0xb3193468a8dab5a0,0xb468b31935a0a8da
.quad 0xb53330753533b075,0xb53330753533b075,0xb075b53330753533,0xb075b53330753533,0x277db5a3b4513350,0xb5a3a77d33503451,0x35a3277db350b451,0x277db5a3b4513350,0x34c3321d321db4c3,0xb4c3b21db21d34c3,0xb21d34c334c3321d,0x321db4c3b4c3b21d,0xb4ee318cae1a3573,0xb18cb4eeb573ae1a,0xb18cb4eeb573ae1a,0x34eeb18c2e1ab573
.quad 0,0,0,0,0,0,0,0,0,0,0,0,0,0,0,0
.quad 0,0,0,0,0,0,0,0,0,0,0,0,0,0,0,0
.quad 0,0,0,0,0,0,0,0,0,0,0,0,0,0,0,0
.quad 0,0,0,0,0,0,0,0,0,0,0,0,0,0,0,0
.quad 0x3400340034003400,0x3400340034003400,0xb4003400b4003400,0xb4003400b4003400,0x3567aeb335013146,0xaeb3b5673146b501,0x2eb33567b1463501,0x3567aeb335013146,0x2c24b59035902c24,0xac243590b590ac24,0x35902c24ac243590,0xb590ac242c24b590,0xb470b304359ea944,0x3304b4702944359e,0x3304b4702944359e,0x34703304b59e2944
.quad 0xb52c3096352cb096,0xb52c3096352cb096,0xb096b52c3096352c,0xb096b52c3096352c,0xa61b35a53443b371,0x35a5261bb371b443,0xb5a5a61b33713443,0xa61b35a53443b371,0x34d131ef31efb4d1,0xb4d1b1efb1ef34d1,0xb1ef34d134d131ef,0x31efb4d1b4d1b1ef,0x34dfb1c22da2b57b,0x31c234df357b2da2,0x31c234df357b2da2,0xb4df31c2ada2357b
.quad 0x3400340034003400,0x3400340034003400,0xb4003400b4003400,0xb4003400b4003400,0xb5672eb3b501b146,0x2eb33567b1463501,0xaeb3b5673146b501,0xb5672eb3b501b146,0x2c24b59035902c24,0xac243590b590ac24,0x35902c24ac243590,0xb590ac242c24b590,0x34703304b59e2944,0xb3043470a944b59e,0xb3043470a944b59e,0xb470b304359ea944
.quad 0xb52c3096352cb096,0xb52c3096352cb096,0xb096b52c3096352c,0xb096b52c3096352c,0x261bb5a5b4433371,0xb5a5a61b33713443,0x35a5261bb371b443,0x261bb5a5b4433371,0x34d131ef31efb4d1,0xb4d1b1efb1ef34d1,0xb1ef34d134d131ef,0x31efb4d1b4d1b1ef,0xb4df31c2ada2357b,0xb1c2b4dfb57bada2,0xb1c2b4dfb57bada2,0x34dfb1c22da2b57b
.quad 0,0,0,0,0,0,0,0,0,0,0,0,0,0,0,0
.quad 0,0,0,0,0,0,0,0,0,0,0,0,0,0,0,0
.quad 0,0,0,0,0,0,0,0,0,0,0,0,0,0,0,0
.quad 0,0,0,0,0,0,0,0,0,0,0,0,0,0,0,0
.quad 0x3400340034003400,0x3400340034003400,0xb4003400b4003400,0xb4003400b4003400,0x3566aec43503313e,0xaec4b566313eb503,0x2ec43566b13e3503,0x3566aec43503313e,0x2c01b59135912c01,0xac013591b591ac01,0x35912c01ac013591,0xb591ac012c01b591,0xb478b2ef359da9ad,0x32efb47829ad359d,0x32efb47829ad359d,0x347832efb59d29ad
.quad 0xb52530b63525b0b6,0xb52530b63525b0b6,0xb0b6b52530b63525,0xb0b6b52530b63525,0xa4b835a63434b392,0x35a624b8b392b434,0xb5a6a4b833923434,0xa4b835a63434b392,0x34df31c231c2b4df,0xb4dfb1c2b1c234df,0xb1c234df34df31c2,0x31c2b4dfb4dfb1c2,0x34cfb1f72d29b582,0x31f734cf35822d29,0x31f734cf35822d29,0xb4cf31f7ad293582
.quad 0x3400340034003400,0x3400340034003400,0xb4003400b4003400,0xb4003400b4003400,0xb5662ec4b503b13e,0x2ec43566b13e3503,0xaec4b566313eb503,0xb5662ec4b503b13e,0x2c01b59135912c01,0xac013591b591ac01,0x35912c01ac013591,0xb591ac012c01b591,0x347832efb59d29ad,0xb2ef3478a9adb59d,0xb2ef3478a9adb59d,0xb478b2ef359da9ad
.quad 0xb52530b63525b0b6,0xb52530b63525b0b6,0xb0b6b52530b63525,0xb0b6b52530b63525,0x24b8b5a6b4343392,0xb5a6a4b833923434,0x35a624b8b392b434,0x24b8b5a6b4343392,0x34df31c231c2b4df,0xb4dfb1c2b1c234df,0xb1c234df34df31c2,0x31c2b4dfb4dfb1c2,0xb4cf31f7ad293582,0xb1f7b4cfb582ad29,0xb1f7b4cfb582ad29,0x34cfb1f72d29b582
.quad 0,0,0,0,0,0,0,0,0,0,0,0,0,0,0,0
.quad 0,0,0,0,0,0,0,0,0,0,0,0,0,0,0,0
.quad 0,0,0,0,0,0,0,0,0,0,0,0,0,0,0,0
.quad 0,0,0,0,0,0,0,0,0,0,0,0,0,0,0,0
.quad 0x3400340034003400,0x3400340034003400,0xb4003400b4003400,0xb4003400b4003400,0x3565aed535053136,0xaed5b5653136b505,0x2ed53565b1363505,0x3565aed535053136,0x2bbdb59335932bbd,0xabbd3593b593abbd,0x35932bbdabbd3593,0xb593abbd2bbdb593,0xb480b2da359baa17,0x32dab4802a17359b,0x32dab4802a17359b,0x348032dab59b2a17
.quad 0xb51d30d6351db0d6,0xb51d30d6351db0d6,0xb0d6b51d30d6351d,0xb0d6b51d30d6351d,0xa2aa35a73425b3b3,0x35a722aab3b3b425,0xb5a7a2aa33b33425,0xa2aa35a73425b3b3,0x34ec31943194b4ec,0xb4ecb194b19434ec,0xb19434ec34ec3194,0x3194b4ecb4ecb194,0x34beb22b2cb0b589,0x322b34be35892cb0,0x322b34be35892cb0,0xb4be322bacb03589
.quad 0x3400340034003400,0x3400340034003400,0xb4003400b4003400,0xb4003400b4003400,0xb5652ed5b505b136,0x2ed53565b1363505,0xaed5b5653136b505,0xb5652ed5b505b136,0x2bbdb59335932bbd,0xabbd3593b593abbd,0x35932bbdabbd3593,0xb593abbd2bbdb593,0x348032dab59b2a17,0xb2da3480aa17b59b,0xb2da3480aa17b59b,0xb480b2da359baa17
.quad 0xb51d30d6351db0d6,0xb51d30d6351db0d6,0xb0d6b51d30d6351d,0xb0d6b51d30d6351d,0x22aab5a7b42533b3,0xb5a7a2aa33b33425,0x35a722aab3b3b425,0x22aab5a7b42533b3,0x34ec31943194b4ec,0xb4ecb194b19434ec,0xb19434ec34ec3194,0x3194b4ecb4ecb194,0xb4be322bacb03589,0xb22bb4beb589acb0,0xb22bb4beb589acb0,0x34beb22b2cb0b589
.quad 0,0,0,0,0,0,0,0,0,0,0,0,0,0,0,0
.quad 0,0,0,0,0,0,0,0,0,0,0,0,0,0,0,0
.quad 0,0,0,0,0,0,0,0,0,0,0,0,0,0,0,0
.quad 0,0,0,0,0,0,0,0,0,0,0,0,0,0,0,0
.quad 0x3400340034003400,0x3400340034003400,0xb4003400b4003400,0xb4003400b4003400,0x3563aee63507312e,0xaee6b563312eb507,0x2ee63563b12e3507,0x3563aee63507312e,0x2b77b59435942b77,0xab773594b594ab77,0x35942b77ab773594,0xb594ab772b77b594,0xb489b2c43599aa81,0x32c4b4892a813599,0x32c4b4892a813599,0x348932c4b5992a81
.quad 0xb51530f63515b0f6,0xb51530f63515b0f6,0xb0f6b51530f63515,0xb0f6b51530f63515,0x9fc635a83416b3d4,0x35a81fc6b3d4b416,0xb5a89fc633d43416,0x9fc635a83416b3d4,0x34f931653165b4f9,0xb4f9b165b16534f9,0xb16534f934f93165,0x3165b4f9b4f9b165,0x34adb25f2c36b58f,0x325f34ad358f2c36,0x325f34ad358f2c36,0xb4ad325fac36358f
.quad 0x3400340034003400,0x3400340034003400,0xb4003400b4003400,0xb4003400b4003400,0xb5632ee6b507b12e,0x2ee63563b12e3507,0xaee6b563312eb507,0xb5632ee6b507b12e,0x2b77b59435942b77,0xab773594b594ab77,0x35942b77ab773594,0xb594ab772b77b594,0x348932c4b5992a81,0xb2c43489aa81b599,0xb2c43489aa81b599,0xb489b2c43599aa81
.quad 0xb51530f63515b0f6,0xb51530f63515b0f6,0xb0f6b51530f63515,0xb0f6b51530f63515,0x1fc6b5a8b41633d4,0xb5a89fc633d43416,0x35a81fc6b3d4b416,0x1fc6b5a8b41633d4,0x34f931653165b4f9,0xb4f9b165b16534f9,0xb16534f934f93165,0x3165b4f9b4f9b165,0xb4ad325fac36358f,0xb25fb4adb58fac36,0xb25fb4adb58fac36,0x34adb25f2c36b58f
.quad 0,0,0,0,0,0,0,0,0,0,0,0,0,0,0,0
.quad 0,0,0,0,0,0,0,0,0,0,0,0,0,0,0,0
.quad 0,0,0,0,0,0,0,0,0,0,0,0,0,0,0,0
.quad 0,0,0,0,0,0,0,0,0,0,0,0,0,0,0,0
.quad 0x3400340034003400,0x3400340034003400,0xb4003400b4003400,0xb4003400b4003400,0x3562aef7350a3126,0xaef7b5623126b50a,0x2ef73562b126350a,0x3562aef7350a3126,0x2b30b59635962b30,0xab303596b596ab30,0x35962b30ab303596,0xb596ab302b30b596,0xb490b2af3597aaea,0x32afb4902aea3597,0x32afb4902aea3597,0x349032afb5972aea
.quad 0xb50e3116350eb116,0xb50e3116350eb116,0xb116b50e3116350e,0xb116b50e3116350e,0x987135a83406b3f3,0x35a81871b3f3b406,0xb5a8987133f33406,0x987135a83406b3f3,0x350531363136b505,0xb505b136b1363505,0xb136350535053136,0x3136b505b505b136,0x349bb2922b77b594,0x3292349b35942b77,0x3292349b35942b77,0xb49b3292ab773594
.quad 0x3400340034003400,0x3400340034003400,0xb4003400b4003400,0xb4003400b4003400,0xb5622ef7b50ab126,0x2ef73562b126350a,0xaef7b5623126b50a,0xb5622ef7b50ab126,0x2b30b59635962b30,0xab303596b596ab30,0x35962b30ab303596,0xb596ab302b30b596,0x349032afb5972aea,0xb2af3490aaeab597,0xb2af3490aaeab597,0xb490b2af3597aaea
.quad 0xb50e3116350eb116,0xb50e3116350eb116,0xb116b50e3116350e,0xb116b50e3116350e,0x1871b5a8b40633f3,0xb5a8987133f33406,0x35a81871b3f3b406,0x1871b5a8b40633f3,0x350531363136b505,0xb505b136b1363505,0xb136350535053136,0x3136b505b505b136,0xb49b3292ab773594,0xb292b49bb594ab77,0xb292b49bb594ab77,0x349bb2922b77b594
.quad 0,0,0,0,0,0,0,0,0,0,0,0,0,0,0,0
.quad 0,0,0,0,0,0,0,0,0,0,0,0,0,0,0,0
.quad 0,0,0,0,0,0,0,0,0,0,0,0,0,0,0,0
.quad 0,0,0,0,0,0,0,0,0,0,0,0,0,0,0,0
.quad 0x3400340034003400,0x3400340034003400,0xb4003400b4003400,0xb4003400b4003400,0x3560af08350c311e,0xaf08b560311eb50c,0x2f083560b11e350c,0x3560af08350c311e,0x2aeab59735972aea,0xaaea3597b597aaea,0x35972aeaaaea3597,0xb597aaea2aeab597,0xb498b2993595ab53,0x3299b4982b533595,0x3299b4982b533595,0x34983299b5952b53
.quad 0xb50531363505b136,0xb50531363505b136,0xb136b50531363505,0xb136b50531363505,0x1aaa35a833edb409,0x35a89aaab409b3ed,0xb5a81aaa340933ed,0x1aaa35a833edb409,0x351131063106b511,0xb511b106b1063511,0xb106351135113106,0x3106b511b511b106,0x3489b2c42a81b599,0x32c4348935992a81,0x32c4348935992a81,0xb48932c4aa813599
.quad 0x3400340034003400,0x3400340034003400,0xb4003400b4003400,0xb4003400b4003400,0xb5602f08b50cb11e,0x2f083560b11e350c,0xaf08b560311eb50c,0xb5602f08b50cb11e,0x2aeab59735972aea,0xaaea3597b597aaea,0x35972aeaaaea3597,0xb597aaea2aeab597,0x34983299b5952b53,0xb2993498ab53b595,0xb2993498ab53b595,0xb498b2993595ab53
.quad 0xb50531363505b136,0xb50531363505b136,0xb136b50531363505,0xb136b50531363505,0x9aaab5a8b3ed3409,0xb5a81aaa340933ed,0x35a89aaab409b3ed,0x9aaab5a8b3ed3409,0x351131063106b511,0xb511b106b1063511,0xb106351135113106,0x3106b511b511b106,0xb48932c4aa813599,0xb2c4b489b599aa81,0xb2c4b489b599aa81,0x3489b2c42a81b599
.quad 0,0,0,0,0,0,0,0,0,0,0,0,0,0,0,0
.quad 0,0,0,0,0,0,0,0,0,0,0,0,0,0,0,0
.quad 0,0,0,0,0,0,0,0,0,0,0,0,0,0,0,0
.quad 0,0,0,0,0,0,0,0,0,0,0,0,0,0,0,0
.quad 0x3400340034003400,0x3400340034003400,0xb4003400b4003400,0xb4003400b4003400,0x355faf19350e3116,0xaf19b55f3116b50e,0x2f19355fb116350e,0x355faf19350e3116,0x2aa4b59835982aa4,0xaaa43598b598aaa4,0x35982aa4aaa43598,0xb598aaa42aa4b598,0xb4a0b2843593abbd,0x3284b4a02bbd3593,0x3284b4a02bbd3593,0x34a03284b5932bbd
.quad 0xb4fd315534fdb155,0xb4fd315534fdb155,0xb155b4fd315534fd,0xb155b4fd315534fd,0x207135a833cdb419,0x35a8a071b419b3cd,0xb5a82071341933cd,0x207135a833cdb419,0x351d30d630d6b51d,0xb51db0d6b0d6351d,0xb0d6351d351d30d6,0x30d6b51db51db0d6,0x3476b2f6298ab59d,0x32f63476359d298a,0x32f63476359d298a,0xb47632f6a98a359d
.quad 0x3400340034003400,0x3400340034003400,0xb4003400b4003400,0xb4003400b4003400,0xb55f2f19b50eb116,0x2f19355fb116350e,0xaf19b55f3116b50e,0xb55f2f19b50eb116,0x2aa4b59835982aa4,0xaaa43598b598aaa4,0x35982aa4aaa43598,0xb598aaa42aa4b598,0x34a03284b5932bbd,0xb28434a0abbdb593,0xb28434a0abbdb593,0xb4a0b2843593abbd
.quad 0xb4fd315534fdb155,0xb4fd315534fdb155,0xb155b4fd315534fd,0xb155b4fd315534fd,0xa071b5a8b3cd3419,0xb5a82071341933cd,0x35a8a071b419b3cd,0xa071b5a8b3cd3419,0x351d30d630d6b51d,0xb51db0d6b0d6351d,0xb0d6351d351d30d6,0x30d6b51db51db0d6,0xb47632f6a98a359d,0xb2f6b476b59da98a,0xb2f6b476b59da98a,0x3476b2f6298ab59d
.quad 0,0,0,0,0,0,0,0,0,0,0,0,0,0,0,0
.quad 0,0,0,0,0,0,0,0,0,0,0,0,0,0,0,0
.quad 0,0,0,0,0,0,0,0,0,0,0,0,0,0,0,0
.quad 0,0,0,0,0,0,0,0,0,0,0,0,0,0,0,0
.quad 0x3400340034003400,0x3400340034003400,0xb4003400b4003400,0xb4003400b4003400,0x355eaf2a3510310e,0xaf2ab55e310eb510,0x2f2a355eb10e3510,0x355eaf2a3510310e,0x2a5eb59a359a2a5e,0xaa5e359ab59aaa5e,0x359a2a5eaa5e359a,0xb59aaa5e2a5eb59a,0xb4a8b26e3590ac13,0x326eb4a82c133590,0x326eb4a82c133590,0x34a8326eb5902c13
.quad 0xb4f5317534f5b175,0xb4f5317534f5b175,0xb175b4f5317534f5,0xb175b4f5317534f5,0x233835a733adb428,0x35a7a338b428b3ad,0xb5a72338342833ad,0x233835a733adb428,0x352830a630a6b528,0xb528b0a6b0a63528,0xb0a63528352830a6,0x30a6b528b528b0a6,0x3462b3272893b5a1,0x3327346235a12893,0x3327346235a12893,0xb4623327a89335a1
.quad 0x3400340034003400,0x3400340034003400,0xb4003400b4003400,0xb4003400b4003400,0xb55e2f2ab510b10e,0x2f2a355eb10e3510,0xaf2ab55e310eb510,0xb55e2f2ab510b10e,0x2a5eb59a359a2a5e,0xaa5e359ab59aaa5e,0x359a2a5eaa5e359a,0xb59aaa5e2a5eb59a,0x34a8326eb5902c13,0xb26e34a8ac13b590,0xb26e34a8ac13b590,0xb4a8b26e3590ac13
.quad 0xb4f5317534f5b175,0xb4f5317534f5b175,0xb175b4f5317534f5,0xb175b4f5317534f5,0xa338b5a7b3ad3428,0xb5a72338342833ad,0x35a7a338b428b3ad,0xa338b5a7b3ad3428,0x352830a630a6b528,0xb528b0a6b0a63528,0xb0a63528352830a6,0x30a6b528b528b0a6,0xb4623327a89335a1,0xb327b462b5a1a893,0xb327b462b5a1a893,0x3462b3272893b5a1
.quad 0,0,0,0,0,0,0,0,0,0,0,0,0,0,0,0
.quad 0,0,0,0,0,0,0,0,0,0,0,0,0,0,0,0
.quad 0,0,0,0,0,0,0,0,0,0,0,0,0,0,0,0
.quad 0,0,0,0,0,0,0,0,0,0,0,0,0,0,0,0
.quad 0x3400340034003400,0x3400340034003400,0xb4003400b4003400,0xb4003400b4003400,0x355caf3b35113106,0xaf3bb55c3106b511,0x2f3b355cb1063511,0x355caf3b35113106,0x2a17b59b359b2a17,0xaa17359bb59baa17,0x359b2a17aa17359b,0xb59baa172a17b59b,0xb4afb258358eac47,0x3258b4af2c47358e,0x3258b4af2c47358e,0x34af3258b58e2c47
.quad 0xb4ec319434ecb194,0xb4ec319434ecb194,0xb194b4ec319434ec,0xb194b4ec319434ec,0x24ff35a6338cb437,0x35a6a4ffb437b38c,0xb5a624ff3437338c,0x24ff35a6338cb437,0x353330753075b533,0xb533b075b0753533,0xb075353335333075,0x3075b533b533b075,0x344eb3562736b5a4,0x3356344e35a42736,0x3356344e35a42736,0xb44e3356a73635a4
.quad 0x3400340034003400,0x3400340034003400,0xb4003400b4003400,0xb4003400b4003400,0xb55c2f3bb511b106,0x2f3b355cb1063511,0xaf3bb55c3106b511,0xb55c2f3bb511b106,0x2a17b59b359b2a17,0xaa17359bb59baa17,0x359b2a17aa17359b,0xb59baa172a17b59b,0x34af3258b58e2c47,0xb25834afac47b58e,0xb25834afac47b58e,0xb4afb258358eac47
.quad 0xb4ec319434ecb194,0xb4ec319434ecb194,0xb194b4ec319434ec,0xb194b4ec319434ec,0xa4ffb5a6b38c3437,0xb5a624ff3437338c,0x35a6a4ffb437b38c,0xa4ffb5a6b38c3437,0x353330753075b533,0xb533b075b0753533,0xb075353335333075,0x3075b533b533b075,0xb44e3356a73635a4,0xb356b44eb5a4a736,0xb356b44eb5a4a736,0x344eb3562736b5a4
.quad 0,0,0,0,0,0,0,0,0,0,0,0,0,0,0,0
.quad 0,0,0,0,0,0,0,0,0,0,0,0,0,0,0,0
.quad 0,0,0,0,0,0,0,0,0,0,0,0,0,0,0,0
.quad 0,0,0,0,0,0,0,0,0,0,0,0,0,0,0,0
.quad 0x3400340034003400,0x3400340034003400,0xb4003400b4003400,0xb4003400b4003400,0x355baf4c351330fe,0xaf4cb55b30feb513,0x2f4c355bb0fe3513,0x355baf4c351330fe,0x29d1b59c359c29d1,0xa9d1359cb59ca9d1,0x359c29d1a9d1359c,0xb59ca9d129d1b59c,0xb4b7b242358bac7c,0x3242b4b72c7c358b,0x3242b4b72c7c358b,0x34b73242b58b2c7c
.quad 0xb4e331b234e3b1b2,0xb4e331b234e3b1b2,0xb1b2b4e331b234e3,0xb1b2b4e331b234e3,0x266235a5336bb446,0x35a5a662b446b36b,0xb5a526623446336b,0x266235a5336bb446,0x353d30443044b53d,0xb53db044b044353d,0xb044353d353d3044,0x3044b53db53db044,0x343ab3852546b5a6,0x3385343a35a62546,0x3385343a35a62546,0xb43a3385a54635a6
.quad 0x3400340034003400,0x3400340034003400,0xb4003400b4003400,0xb4003400b4003400,0xb55b2f4cb513b0fe,0x2f4c355bb0fe3513,0xaf4cb55b30feb513,0xb55b2f4cb513b0fe,0x29d1b59c359c29d1,0xa9d1359cb59ca9d1,0x359c29d1a9d1359c,0xb59ca9d129d1b59c,0x34b73242b58b2c7c,0xb24234b7ac7cb58b,0xb24234b7ac7cb58b,0xb4b7b242358bac7c
.quad 0xb4e331b234e3b1b2,0xb4e331b234e3b1b2,0xb1b2b4e331b234e3,0xb1b2b4e331b234e3,0xa662b5a5b36b3446,0xb5a526623446336b,0x35a5a662b446b36b,0xa662b5a5b36b3446,0x353d30443044b53d,0xb53db044b044353d,0xb044353d353d3044,0x3044b53db53db044,0xb43a3385a54635a6,0xb385b43ab5a6a546,0xb385b43ab5a6a546,0x343ab3852546b5a6
.quad 0,0,0,0,0,0,0,0,0,0,0,0,0,0,0,0
.quad 0,0,0,0,0,0,0,0,0,0,0,0,0,0,0,0
.quad 0,0,0,0,0,0,0,0,0,0,0,0,0,0,0,0
.quad 0,0,0,0,0,0,0,0,0,0,0,0,0,0,0,0
.quad 0x3400340034003400,0x3400340034003400,0xb4003400b4003400,0xb4003400b4003400,0x3559af5c351530f6,0xaf5cb55930f6b515,0x2f5c3559b0f63515,0x3559af5c351530f6,0x298ab59d359d298a,0xa98a359db59da98a,0x359d298aa98a359d,0xb59da98a298ab59d,0xb4beb22b3589acb0,0x322bb4be2cb03589,0x322bb4be2cb03589,0x34be322bb5892cb0
.quad 0xb4da31d134dab1d1,0xb4da31d134dab1d1,0xb1d1b4da31d134da,0xb1d1b4da31d134da,0x27c435a33349b454,0x35a3a7c4b454b349,0xb5a327c434543349,0x27c435a33349b454,0x354730123012b547,0xb547b012b0123547,0xb012354735473012,0x3012b547b547b012,0x3425b3b322aab5a7,0x33b3342535a722aa,0x33b3342535a722aa,0xb42533b3a2aa35a7
.quad 0x3400340034003400,0x3400340034003400,0xb4003400b4003400,0xb4003400b4003400,0xb5592f5cb515b0f6,0x2f5c3559b0f63515,0xaf5cb55930f6b515,0xb5592f5cb515b0f6,0x298ab59d359d298a,0xa98a359db59da98a,0x359d298aa98a359d,0xb59da98a298ab59d,0x34be322bb5892cb0,0xb22b34beacb0b589,0xb22b34beacb0b589,0xb4beb22b3589acb0
.quad 0xb4da31d134dab1d1,0xb4da31d134dab1d1,0xb1d1b4da31d134da,0xb1d1b4da31d134da,0xa7c4b5a3b3493454,0xb5a327c434543349,0x35a3a7c4b454b349,0xa7c4b5a3b3493454,0x354730123012b547,0xb547b012b0123547,0xb012354735473012,0x3012b547b547b012,0xb42533b3a2aa35a7,0xb3b3b425b5a7a2aa,0xb3b3b425b5a7a2aa,0x3425b3b322aab5a7
.quad 0,0,0,0,0,0,0,0,0,0,0,0,0,0,0,0
.quad 0,0,0,0,0,0,0,0,0,0,0,0,0,0,0,0
.quad 0,0,0,0,0,0,0,0,0,0,0,0,0,0,0,0
.quad 0,0,0,0,0,0,0,0,0,0,0,0,0,0,0,0
.quad 0x3400340034003400,0x3400340034003400,0xb4003400b4003400,0xb4003400b4003400,0x3558af6d351730ee,0xaf6db55830eeb517,0x2f6d3558b0ee3517,0x3558af6d351730ee,0x2944b59e359e2944,0xa944359eb59ea944,0x359e2944a944359e,0xb59ea9442944b59e,0xb4c5b2153586ace4,0x3215b4c52ce43586,0x3215b4c52ce43586,0x34c53215b5862ce4
.quad 0xb4d131ef34d1b1ef,0xb4d131ef34d1b1ef,0xb1efb4d131ef34d1,0xb1efb4d131ef34d1,0x289335a13327b462,0x35a1a893b462b327,0xb5a1289334623327,0x289335a13327b462,0x35502fc12fc1b550,0xb550afc1afc13550,0xafc1355035502fc1,0x2fc1b550b550afc1,0x3410b3e01d8eb5a8,0x33e0341035a81d8e,0x33e0341035a81d8e,0xb41033e09d8e35a8
.quad 0x3400340034003400,0x3400340034003400,0xb4003400b4003400,0xb4003400b4003400,0xb5582f6db517b0ee,0x2f6d3558b0ee3517,0xaf6db55830eeb517,0xb5582f6db517b0ee,0x2944b59e359e2944,0xa944359eb59ea944,0x359e2944a944359e,0xb59ea9442944b59e,0x34c53215b5862ce4,0xb21534c5ace4b586,0xb21534c5ace4b586,0xb4c5b2153586ace4
.quad 0xb4d131ef34d1b1ef,0xb4d131ef34d1b1ef,0xb1efb4d131ef34d1,0xb1efb4d131ef34d1,0xa893b5a1b3273462,0xb5a1289334623327,0x35a1a893b462b327,0xa893b5a1b3273462,0x35502fc12fc1b550,0xb550afc1afc13550,0xafc1355035502fc1,0x2fc1b550b550afc1,0xb41033e09d8e35a8,0xb3e0b410b5a89d8e,0xb3e0b410b5a89d8e,0x3410b3e01d8eb5a8
.quad 0,0,0,0,0,0,0,0,0,0,0,0,0,0,0,0
.quad 0,0,0,0,0,0,0,0,0,0,0,0,0,0,0,0
.quad 0,0,0,0,0,0,0,0,0,0,0,0,0,0,0,0
.quad 0,0,0,0,0,0,0,0,0,0,0,0,0,0,0,0
.quad 0x3400340034003400,0x3400340034003400,0xb4003400b4003400,0xb4003400b4003400,0x3556af7e351930e6,0xaf7eb55630e6b519,0x2f7e3556b0e63519,0x3556af7e351930e6,0x28fdb59f359f28fd,0xa8fd359fb59fa8fd,0x359f28fda8fd359f,0xb59fa8fd28fdb59f,0xb4ccb1fe3583ad18,0x31feb4cc2d183583,0x31feb4cc2d183583,0x34cc31feb5832d18
.quad 0xb4c7320e34c7b20e,0xb4c7320e34c7b20e,0xb20eb4c7320e34c7,0xb20eb4c7320e34c7,0x2944359e3304b470,0x359ea944b470b304,0xb59e294434703304,0x2944359e3304b470,0x35592f5c2f5cb559,0xb559af5caf5c3559,0xaf5c355935592f5c,0x2f5cb559b559af5c,0x33f3b4069871b5a8,0x340633f335a89871,0x340633f335a89871,0xb3f33406187135a8
.quad 0x3400340034003400,0x3400340034003400,0xb4003400b4003400,0xb4003400b4003400,0xb5562f7eb519b0e6,0x2f7e3556b0e63519,0xaf7eb55630e6b519,0xb5562f7eb519b0e6,0x28fdb59f359f28fd,0xa8fd359fb59fa8fd,0x359f28fda8fd359f,0xb59fa8fd28fdb59f,0x34cc31feb5832d18,0xb1fe34ccad18b583,0xb1fe34ccad18b583,0xb4ccb1fe3583ad18
.quad 0xb4c7320e34c7b20e,0xb4c7320e34c7b20e,0xb20eb4c7320e34c7,0xb20eb4c7320e34c7,0xa944b59eb3043470,0xb59e294434703304,0x359ea944b470b304,0xa944b59eb3043470,0x35592f5c2f5cb559,0xb559af5caf5c3559,0xaf5c355935592f5c,0x2f5cb559b559af5c,0xb3f33406187135a8,0xb406b3f3b5a81871,0xb406b3f3b5a81871,0x33f3b4069871b5a8
.quad 0,0,0,0,0,0,0,0,0,0,0,0,0,0,0,0
.quad 0,0,0,0,0,0,0,0,0,0,0,0,0,0,0,0
.quad 0,0,0,0,0,0,0,0,0,0,0,0,0,0,0,0
.quad 0,0,0,0,0,0,0,0,0,0,0,0,0,0,0,0
.quad 0x3400340034003400,0x3400340034003400,0xb4003400b4003400,0xb4003400b4003400,0x3555af8f351b30de,0xaf8fb55530deb51b,0x2f8f3555b0de351b,0x3555af8f351b30de,0x28b6b5a035a028b6,0xa8b635a0b5a0a8b6,0x35a028b6a8b635a0,0xb5a0a8b628b6b5a0,0xb4d3b1e83580ad4c,0x31e8b4d32d4c3580,0x31e8b4d32d4c3580,0x34d331e8b5802d4c
.quad 0xb4be322b34beb22b,0xb4be322b34beb22b,0xb22bb4be322b34be,0xb22bb4be322b34be,0x29f4359c32e1b47e,0x359ca9f4b47eb2e1,0xb59c29f4347e32e1,0x29f4359c32e1b47e,0x35622ef72ef7b562,0xb562aef7aef73562,0xaef7356235622ef7,0x2ef7b562b562aef7,0x33c7b41ca0ffb5a8,0x341c33c735a8a0ff,0x341c33c735a8a0ff,0xb3c7341c20ff35a8
.quad 0x3400340034003400,0x3400340034003400,0xb4003400b4003400,0xb4003400b4003400,0xb5552f8fb51bb0de,0x2f8f3555b0de351b,0xaf8fb55530deb51b,0xb5552f8fb51bb0de,0x28b6b5a035a028b6,0xa8b635a0b5a0a8b6,0x35a028b6a8b635a0,0xb5a0a8b628b6b5a0,0x34d331e8b5802d4c,0xb1e834d3ad4cb580,0xb1e834d3ad4cb580,0xb4d3b1e83580ad4c
.quad 0xb4be322b34beb22b,0xb4be322b34beb22b,0xb22bb4be322b34be,0xb22bb4be322b34be,0xa9f4b59cb2e1347e,0xb59c29f4347e32e1,0x359ca9f4b47eb2e1,0xa9f4b59cb2e1347e,0x35622ef72ef7b562,0xb562aef7aef73562,0xaef7356235622ef7,0x2ef7b562b562aef7,0xb3c7341c20ff35a8,0xb41cb3c7b5a820ff,0xb41cb3c7b5a820ff,0x33c7b41ca0ffb5a8
.quad 0,0,0,0,0,0,0,0,0,0,0,0,0,0,0,0
.quad 0,0,0,0,0,0,0,0,0,0,0,0,0,0,0,0
.quad 0,0,0,0,0,0,0,0,0,0,0,0,0,0,0,0
.quad 0,0,0,0,0,0,0,0,0,0,0,0,0,0,0,0
.quad 0x3400340034003400,0x3400340034003400,0xb4003400b4003400,0xb4003400b4003400,0x3554af9f351d30d6,0xaf9fb55430d6b51d,0x2f9f3554b0d6351d,0x3554af9f351d30d6,0x2870b5a135a12870,0xa87035a1b5a1a870,0x35a12870a87035a1,0xb5a1a8702870b5a1,0xb4dab1d1357dad7f,0x31d1b4da2d7f357d,0x31d1b4da2d7f357d,0x34da31d1b57d2d7f
.quad 0xb4b4324934b4b249,0xb4b4324934b4b249,0xb249b4b4324934b4,0xb249b4b4324934b4,0x2aa4359832bdb48b,0x3598aaa4b48bb2bd,0xb5982aa4348b32bd,0x2aa4359832bdb48b,0x356a2e922e92b56a,0xb56aae92ae92356a,0xae92356a356a2e92,0x2e92b56ab56aae92,0x3399b431a471b5a6,0x3431339935a6a471,0x3431339935a6a471,0xb3993431247135a6
.quad 0x3400340034003400,0x3400340034003400,0xb4003400b4003400,0xb4003400b4003400,0xb5542f9fb51db0d6,0x2f9f3554b0d6351d,0xaf9fb55430d6b51d,0xb5542f9fb51db0d6,0x2870b5a135a12870,0xa87035a1b5a1a870,0x35a12870a87035a1,0xb5a1a8702870b5a1,0x34da31d1b57d2d7f,0xb1d134daad7fb57d,0xb1d134daad7fb57d,0xb4dab1d1357dad7f
.quad 0xb4b4324934b4b249,0xb4b4324934b4b249,0xb249b4b4324934b4,0xb249b4b4324934b4,0xaaa4b598b2bd348b,0xb5982aa4348b32bd,0x3598aaa4b48bb2bd,0xaaa4b598b2bd348b,0x356a2e922e92b56a,0xb56aae92ae92356a,0xae92356a356a2e92,0x2e92b56ab56aae92,0xb3993431247135a6,0xb431b399b5a62471,0xb431b399b5a62471,0x3399b431a471b5a6
.quad 0,0,0,0,0,0,0,0,0,0,0,0,0,0,0,0
.quad 0,0,0,0,0,0,0,0,0,0,0,0,0,0,0,0
.quad 0,0,0,0,0,0,0,0,0,0,0,0,0,0,0,0
.quad 0,0,0,0,0,0,0,0,0,0,0,0,0,0,0,0
.quad 0x3400340034003400,0x3400340034003400,0xb4003400b4003400,0xb4003400b4003400,0x3552afb0351f30ce,0xafb0b55230ceb51f,0x2fb03552b0ce351f,0x3552afb0351f30ce,0x2829b5a235a22829,0xa82935a2b5a2a829,0x35a22829a82935a2,0xb5a2a8292829b5a2,0xb4e1b1ba3579adb3,0x31bab4e12db33579,0x31bab4e12db33579,0x34e131bab5792db3
.quad 0xb4aa326734aab267,0xb4aa326734aab267,0xb267b4aa326734aa,0xb267b4aa326734aa,0x2b5335953299b498,0x3595ab53b498b299,0xb5952b5334983299,0x2b5335953299b498,0x35712e2b2e2bb571,0xb571ae2bae2b3571,0xae2b357135712e2b,0x2e2bb571b571ae2b,0x336bb446a662b5a5,0x3446336b35a5a662,0x3446336b35a5a662,0xb36b3446266235a5
.quad 0x3400340034003400,0x3400340034003400,0xb4003400b4003400,0xb4003400b4003400,0xb5522fb0b51fb0ce,0x2fb03552b0ce351f,0xafb0b55230ceb51f,0xb5522fb0b51fb0ce,0x2829b5a235a22829,0xa82935a2b5a2a829,0x35a22829a82935a2,0xb5a2a8292829b5a2,0x34e131bab5792db3,0xb1ba34e1adb3b579,0xb1ba34e1adb3b579,0xb4e1b1ba3579adb3
.quad 0xb4aa326734aab267,0xb4aa326734aab267,0xb267b4aa326734aa,0xb267b4aa326734aa,0xab53b595b2993498,0xb5952b5334983299,0x3595ab53b498b299,0xab53b595b2993498,0x35712e2b2e2bb571,0xb571ae2bae2b3571,0xae2b357135712e2b,0x2e2bb571b571ae2b,0xb36b3446266235a5,0xb446b36bb5a52662,0xb446b36bb5a52662,0x336bb446a662b5a5
.quad 0,0,0,0,0,0,0,0,0,0,0,0,0,0,0,0
.quad 0,0,0,0,0,0,0,0,0,0,0,0,0,0,0,0
.quad 0,0,0,0,0,0,0,0,0,0,0,0,0,0,0,0
.quad 0,0,0,0,0,0,0,0,0,0,0,0,0,0,0,0
.quad 0x3400340034003400,0x3400340034003400,0xb4003400b4003400,0xb4003400b4003400,0x3550afc1352130c6,0xafc1b55030c6b521,0x2fc13550b0c63521,0x3550afc1352130c6,0x27c4b5a335a327c4,0xa7c435a3b5a3a7c4,0x35a327c4a7c435a3,0xb5a3a7c427c4b5a3,0xb4e8b1a33576ade7,0x31a3b4e82de73576,0x31a3b4e82de73576,0x34e831a3b5762de7
.quad 0xb4a0328434a0b284,0xb4a0328434a0b284,0xb284b4a0328434a0,0xb284b4a0328434a0,0x2c0135913275b4a5,0x3591ac01b4a5b275,0xb5912c0134a53275,0x2c0135913275b4a5,0x35782dc42dc4b578,0xb578adc4adc43578,0xadc4357835782dc4,0x2dc4b578b578adc4,0x333bb45aa829b5a2,0x345a333b35a2a829,0x345a333b35a2a829,0xb33b345a282935a2
.quad 0x3400340034003400,0x3400340034003400,0xb4003400b4003400,0xb4003400b4003400,0xb5502fc1b521b0c6,0x2fc13550b0c63521,0xafc1b55030c6b521,0xb5502fc1b521b0c6,0x27c4b5a335a327c4,0xa7c435a3b5a3a7c4,0x35a327c4a7c435a3,0xb5a3a7c427c4b5a3,0x34e831a3b5762de7,0xb1a334e8ade7b576,0xb1a334e8ade7b576,0xb4e8b1a33576ade7
.quad 0xb4a0328434a0b284,0xb4a0328434a0b284,0xb284b4a0328434a0,0xb284b4a0328434a0,0xac01b591b27534a5,0xb5912c0134a53275,0x3591ac01b4a5b275,0xac01b591b27534a5,0x35782dc42dc4b578,0xb578adc4adc43578,0xadc4357835782dc4,0x2dc4b578b578adc4,0xb33b345a282935a2,0xb45ab33bb5a22829,0xb45ab33bb5a22829,0x333bb45aa829b5a2
.quad 0,0,0,0,0,0,0,0,0,0,0,0,0,0,0,0
.quad 0,0,0,0,0,0,0,0,0,0,0,0,0,0,0,0
.quad 0,0,0,0,0,0,0,0,0,0,0,0,0,0,0,0
.quad 0,0,0,0,0,0,0,0,0,0,0,0,0,0,0,0
.quad 0x3400340034003400,0x3400340034003400,0xb4003400b4003400,0xb4003400b4003400,0x354fafd2352330be,0xafd2b54f30beb523,0x2fd2354fb0be3523,0x354fafd2352330be,0x2736b5a435a42736,0xa73635a4b5a4a736,0x35a42736a73635a4,0xb5a4a7362736b5a4,0xb4eeb18c3573ae1a,0x318cb4ee2e1a3573,0x318cb4ee2e1a3573,0x34ee318cb5732e1a
.quad 0xb49632a13496b2a1,0xb49632a13496b2a1,0xb2a1b49632a13496,0xb2a1b49632a13496,0x2c59358d3250b4b2,0x358dac59b4b2b250,0xb58d2c5934b23250,0x2c59358d3250b4b2,0x357f2d5d2d5db57f,0xb57fad5dad5d357f,0xad5d357f357f2d5d,0x2d5db57fb57fad5d,0x330bb46da920b59f,0x346d330b359fa920,0x346d330b359fa920,0xb30b346d2920359f
.quad 0x3400340034003400,0x3400340034003400,0xb4003400b4003400,0xb4003400b4003400,0xb54f2fd2b523b0be,0x2fd2354fb0be3523,0xafd2b54f30beb523,0xb54f2fd2b523b0be,0x2736b5a435a42736,0xa73635a4b5a4a736,0x35a42736a73635a4,0xb5a4a7362736b5a4,0x34ee318cb5732e1a,0xb18c34eeae1ab573,0xb18c34eeae1ab573,0xb4eeb18c3573ae1a
.quad 0xb49632a13496b2a1,0xb49632a13496b2a1,0xb2a1b49632a13496,0xb2a1b49632a13496,0xac59b58db25034b2,0xb58d2c5934b23250,0x358dac59b4b2b250,0xac59b58db25034b2,0x357f2d5d2d5db57f,0xb57fad5dad5d357f,0xad5d357f357f2d5d,0x2d5db57fb57fad5d,0xb30b346d2920359f,0xb46db30bb59f2920,0xb46db30bb59f2920,0x330bb46da920b59f
.quad 0,0,0,0,0,0,0,0,0,0,0,0,0,0,0,0
.quad 0,0,0,0,0,0,0,0,0,0,0,0,0,0,0,0
.quad 0,0,0,0,0,0,0,0,0,0,0,0,0,0,0,0
.quad 0,0,0,0,0,0,0,0,0,0,0,0,0,0,0,0
.quad 0x3400340034003400,0x3400340034003400,0xb4003400b4003400,0xb4003400b4003400,0x354dafe2352530b6,0xafe2b54d30b6b525,0x2fe2354db0b63525,0x354dafe2352530b6,0x26a9b5a435a426a9,0xa6a935a4b5a4a6a9,0x35a426a9a6a935a4,0xb5a4a6a926a9b5a4,0xb4f5b175356fae4d,0x3175b4f52e4d356f,0x3175b4f52e4d356f,0x34f53175b56f2e4d
.quad 0xb48b32bd348bb2bd,0xb48b32bd348bb2bd,0xb2bdb48b32bd348b,0xb2bdb48b32bd348b,0x2cb03589322bb4be,0x3589acb0b4beb22b,0xb5892cb034be322b,0x2cb03589322bb4be,0x35852cf52cf5b585,0xb585acf5acf53585,0xacf5358535852cf5,0x2cf5b585b585acf5,0x32dab480aa17b59b,0x348032da359baa17,0x348032da359baa17,0xb2da34802a17359b
.quad 0x3400340034003400,0x3400340034003400,0xb4003400b4003400,0xb4003400b4003400,0xb54d2fe2b525b0b6,0x2fe2354db0b63525,0xafe2b54d30b6b525,0xb54d2fe2b525b0b6,0x26a9b5a435a426a9,0xa6a935a4b5a4a6a9,0x35a426a9a6a935a4,0xb5a4a6a926a9b5a4,0x34f53175b56f2e4d,0xb17534f5ae4db56f,0xb17534f5ae4db56f,0xb4f5b175356fae4d
.quad 0xb48b32bd348bb2bd,0xb48b32bd348bb2bd,0xb2bdb48b32bd348b,0xb2bdb48b32bd348b,0xacb0b589b22b34be,0xb5892cb034be322b,0x3589acb0b4beb22b,0xacb0b589b22b34be,0x35852cf52cf5b585,0xb585acf5acf53585,0xacf5358535852cf5,0x2cf5b585b585acf5,0xb2da34802a17359b,0xb480b2dab59b2a17,0xb480b2dab59b2a17,0x32dab480aa17b59b
.quad 0,0,0,0,0,0,0,0,0,0,0,0,0,0,0,0
.quad 0,0,0,0,0,0,0,0,0,0,0,0,0,0,0,0
.quad 0,0,0,0,0,0,0,0,0,0,0,0,0,0,0,0
.quad 0,0,0,0,0,0,0,0,0,0,0,0,0,0,0,0
.quad 0x3400340034003400,0x3400340034003400,0xb4003400b4003400,0xb4003400b4003400,0x354caff3352630ae,0xaff3b54c30aeb526,0x2ff3354cb0ae3526,0x354caff3352630ae,0x261bb5a535a5261b,0xa61b35a5b5a5a61b,0x35a5261ba61b35a5,0xb5a5a61b261bb5a5,0xb4fbb15d356bae80,0x315db4fb2e80356b,0x315db4fb2e80356b,0x34fb315db56b2e80
.quad 0xb48032da3480b2da,0xb48032da3480b2da,0xb2dab48032da3480,0xb2dab48032da3480,0x2d0735843206b4ca,0x3584ad07b4cab206,0xb5842d0734ca3206,0x2d0735843206b4ca,0x358b2c8d2c8db58b,0xb58bac8dac8d358b,0xac8d358b358b2c8d,0x2c8db58bb58bac8d,0x32a8b493ab0db596,0x349332a83596ab0d,0x349332a83596ab0d,0xb2a834932b0d3596
.quad 0x3400340034003400,0x3400340034003400,0xb4003400b4003400,0xb4003400b4003400,0xb54c2ff3b526b0ae,0x2ff3354cb0ae3526,0xaff3b54c30aeb526,0xb54c2ff3b526b0ae,0x261bb5a535a5261b,0xa61b35a5b5a5a61b,0x35a5261ba61b35a5,0xb5a5a61b261bb5a5,0x34fb315db56b2e80,0xb15d34fbae80b56b,0xb15d34fbae80b56b,0xb4fbb15d356bae80
.quad 0xb48032da3480b2da,0xb48032da3480b2da,0xb2dab48032da3480,0xb2dab48032da3480,0xad07b584b20634ca,0xb5842d0734ca3206,0x3584ad07b4cab206,0xad07b584b20634ca,0x358b2c8d2c8db58b,0xb58bac8dac8d358b,0xac8d358b358b2c8d,0x2c8db58bb58bac8d,0xb2a834932b0d3596,0xb493b2a8b5962b0d,0xb493b2a8b5962b0d,0x32a8b493ab0db596
.quad 0,0,0,0,0,0,0,0,0,0,0,0,0,0,0,0
.quad 0,0,0,0,0,0,0,0,0,0,0,0,0,0,0,0
.quad 0,0,0,0,0,0,0,0,0,0,0,0,0,0,0,0
.quad 0,0,0,0,0,0,0,0,0,0,0,0,0,0,0,0
.quad 0x3400340034003400,0x3400340034003400,0xb4003400b4003400,0xb4003400b4003400,0x354ab002352830a6,0xb002b54a30a6b528,0x3002354ab0a63528,0x354ab002352830a6,0x258db5a535a5258d,0xa58d35a5b5a5a58d,0x35a5258da58d35a5,0xb5a5a58d258db5a5,0xb501b1463567aeb3,0x3146b5012eb33567,0x3146b5012eb33567,0x35013146b5672eb3
.quad 0xb47632f63476b2f6,0xb47632f63476b2f6,0xb2f6b47632f63476,0xb2f6b47632f63476,0x2d5d357f31e0b4d6,0x357fad5db4d6b1e0,0xb57f2d5d34d631e0,0x2d5d357f31e0b4d6,0x35902c242c24b590,0xb590ac24ac243590,0xac24359035902c24,0x2c24b590b590ac24,0x3275b4a5ac01b591,0x34a532753591ac01,0x34a532753591ac01,0xb27534a52c013591
.quad 0x3400340034003400,0x3400340034003400,0xb4003400b4003400,0xb4003400b4003400,0xb54a3002b528b0a6,0x3002354ab0a63528,0xb002b54a30a6b528,0xb54a3002b528b0a6,0x258db5a535a5258d,0xa58d35a5b5a5a58d,0x35a5258da58d35a5,0xb5a5a58d258db5a5,0x35013146b5672eb3,0xb1463501aeb3b567,0xb1463501aeb3b567,0xb501b1463567aeb3
.quad 0xb47632f63476b2f6,0xb47632f63476b2f6,0xb2f6b47632f63476,0xb2f6b47632f63476,0xad5db57fb1e034d6,0xb57f2d5d34d631e0,0x357fad5db4d6b1e0,0xad5db57fb1e034d6,0x35902c242c24b590,0xb590ac24ac243590,0xac24359035902c24,0x2c24b590b590ac24,0xb27534a52c013591,0xb4a5b275b5912c01,0xb4a5b275b5912c01,0x3275b4a5ac01b591
.quad 0,0,0,0,0,0,0,0,0,0,0,0,0,0,0,0
.quad 0,0,0,0,0,0,0,0,0,0,0,0,0,0,0,0
.quad 0,0,0,0,0,0,0,0,0,0,0,0,0,0,0,0
.quad 0,0,0,0,0,0,0,0,0,0,0,0,0,0,0,0
.quad 0x3400340034003400,0x3400340034003400,0xb4003400b4003400,0xb4003400b4003400,0x3549b00a352a309e,0xb00ab549309eb52a,0x300a3549b09e352a,0x3549b00a352a309e,0x24ffb5a635a624ff,0xa4ff35a6b5a6a4ff,0x35a624ffa4ff35a6,0xb5a6a4ff24ffb5a6,0xb507b12e3563aee6,0x312eb5072ee63563,0x312eb5072ee63563,0x3507312eb5632ee6
.quad 0xb46b3312346bb312,0xb46b3312346bb312,0xb312b46b3312346b,0xb312b46b3312346b,0x2db3357931bab4e1,0x3579adb3b4e1b1ba,0xb5792db334e131ba,0x2db3357931bab4e1,0x35942b772b77b594,0xb594ab77ab773594,0xab77359435942b77,0x2b77b594b594ab77,0x3242b4b7ac7cb58b,0x34b73242358bac7c,0x34b73242358bac7c,0xb24234b72c7c358b
.quad 0x3400340034003400,0x3400340034003400,0xb4003400b4003400,0xb4003400b4003400,0xb549300ab52ab09e,0x300a3549b09e352a,0xb00ab549309eb52a,0xb549300ab52ab09e,0x24ffb5a635a624ff,0xa4ff35a6b5a6a4ff,0x35a624ffa4ff35a6,0xb5a6a4ff24ffb5a6,0x3507312eb5632ee6,0xb12e3507aee6b563,0xb12e3507aee6b563,0xb507b12e3563aee6
.quad 0xb46b3312346bb312,0xb46b3312346bb312,0xb312b46b3312346b,0xb312b46b3312346b,0xadb3b579b1ba34e1,0xb5792db334e131ba,0x3579adb3b4e1b1ba,0xadb3b579b1ba34e1,0x35942b772b77b594,0xb594ab77ab773594,0xab77359435942b77,0x2b77b594b594ab77,0xb24234b72c7c358b,0xb4b7b242b58b2c7c,0xb4b7b242b58b2c7c,0x3242b4b7ac7cb58b
.quad 0,0,0,0,0,0,0,0,0,0,0,0,0,0,0,0
.quad 0,0,0,0,0,0,0,0,0,0,0,0,0,0,0,0
.quad 0,0,0,0,0,0,0,0,0,0,0,0,0,0,0,0
.quad 0,0,0,0,0,0,0,0,0,0,0,0,0,0,0,0
.quad 0x3400340034003400,0x3400340034003400,0xb4003400b4003400,0xb4003400b4003400,0x3547b012352c3096,0xb012b5473096b52c,0x30123547b096352c,0x3547b012352c3096,0x2471b5a635a62471,0xa47135a6b5a6a471,0x35a62471a47135a6,0xb5a6a4712471b5a6,0xb50eb116355faf19,0x3116b50e2f19355f,0x3116b50e2f19355f,0x350e3116b55f2f19
.quad 0xb45f332d345fb32d,0xb45f332d345fb32d,0xb32db45f332d345f,0xb32db45f332d345f,0x2e0935743194b4ec,0x3574ae09b4ecb194,0xb5742e0934ec3194,0x2e0935743194b4ec,0x35982aa42aa4b598,0xb598aaa4aaa43598,0xaaa4359835982aa4,0x2aa4b598b598aaa4,0x320eb4c7acf5b585,0x34c7320e3585acf5,0x34c7320e3585acf5,0xb20e34c72cf53585
.quad 0x3400340034003400,0x3400340034003400,0xb4003400b4003400,0xb4003400b4003400,0xb5473012b52cb096,0x30123547b096352c,0xb012b5473096b52c,0xb5473012b52cb096,0x2471b5a635a62471,0xa47135a6b5a6a471,0x35a62471a47135a6,0xb5a6a4712471b5a6,0x350e3116b55f2f19,0xb116350eaf19b55f,0xb116350eaf19b55f,0xb50eb116355faf19
.quad 0xb45f332d345fb32d,0xb45f332d345fb32d,0xb32db45f332d345f,0xb32db45f332d345f,0xae09b574b19434ec,0xb5742e0934ec3194,0x3574ae09b4ecb194,0xae09b574b19434ec,0x35982aa42aa4b598,0xb598aaa4aaa43598,0xaaa4359835982aa4,0x2aa4b598b598aaa4,0xb20e34c72cf53585,0xb4c7b20eb5852cf5,0xb4c7b20eb5852cf5,0x320eb4c7acf5b585
.quad 0,0,0,0,0,0,0,0,0,0,0,0,0,0,0,0
.quad 0,0,0,0,0,0,0,0,0,0,0,0,0,0,0,0
.quad 0,0,0,0,0,0,0,0,0,0,0,0,0,0,0,0
.quad 0,0,0,0,0,0,0,0,0,0,0,0,0,0,0,0
.quad 0x3400340034003400,0x3400340034003400,0xb4003400b4003400,0xb4003400b4003400,0x3546b01b352e308e,0xb01bb546308eb52e,0x301b3546b08e352e,0x3546b01b352e308e,0x23c6b5a735a723c6,0xa3c635a7b5a7a3c6,0x35a723c6a3c635a7,0xb5a7a3c623c6b5a7,0xb513b0fe355baf4c,0x30feb5132f4c355b,0x30feb5132f4c355b,0x351330feb55b2f4c
.quad 0xb45433493454b349,0xb45433493454b349,0xb349b45433493454,0xb349b45433493454,0x2e5e356e316db4f7,0x356eae5eb4f7b16d,0xb56e2e5e34f7316d,0x2e5e356e316db4f7,0x359c29d129d1b59c,0xb59ca9d1a9d1359c,0xa9d1359c359c29d1,0x29d1b59cb59ca9d1,0x31d9b4d8ad6eb57e,0x34d831d9357ead6e,0x34d831d9357ead6e,0xb1d934d82d6e357e
.quad 0x3400340034003400,0x3400340034003400,0xb4003400b4003400,0xb4003400b4003400,0xb546301bb52eb08e,0x301b3546b08e352e,0xb01bb546308eb52e,0xb546301bb52eb08e,0x23c6b5a735a723c6,0xa3c635a7b5a7a3c6,0x35a723c6a3c635a7,0xb5a7a3c623c6b5a7,0x351330feb55b2f4c,0xb0fe3513af4cb55b,0xb0fe3513af4cb55b,0xb513b0fe355baf4c
.quad 0xb45433493454b349,0xb45433493454b349,0xb349b45433493454,0xb349b45433493454,0xae5eb56eb16d34f7,0xb56e2e5e34f7316d,0x356eae5eb4f7b16d,0xae5eb56eb16d34f7,0x359c29d129d1b59c,0xb59ca9d1a9d1359c,0xa9d1359c359c29d1,0x29d1b59cb59ca9d1,0xb1d934d82d6e357e,0xb4d8b1d9b57e2d6e,0xb4d8b1d9b57e2d6e,0x31d9b4d8ad6eb57e
.quad 0,0,0,0,0,0,0,0,0,0,0,0,0,0,0,0
.quad 0,0,0,0,0,0,0,0,0,0,0,0,0,0,0,0
.quad 0,0,0,0,0,0,0,0,0,0,0,0,0,0,0,0
.quad 0,0,0,0,0,0,0,0,0,0,0,0,0,0,0,0
.quad 0x3400340034003400,0x3400340034003400,0xb4003400b4003400,0xb4003400b4003400,0x3544b023352f3085,0xb023b5443085b52f,0x30233544b085352f,0x3544b023352f3085,0x22aab5a735a722aa,0xa2aa35a7b5a7a2aa,0x35a722aaa2aa35a7,0xb5a7a2aa22aab5a7,0xb519b0e63556af7e,0x30e6b5192f7e3556,0x30e6b5192f7e3556,0x351930e6b5562f7e
.quad 0xb44933643449b364,0xb44933643449b364,0xb364b44933643449,0xb364b44933643449,0x2eb335673146b501,0x3567aeb3b501b146,0xb5672eb335013146,0x2eb335673146b501,0x359f28fd28fdb59f,0xb59fa8fda8fd359f,0xa8fd359f359f28fd,0x28fdb59fb59fa8fd,0x31a3b4e8ade7b576,0x34e831a33576ade7,0x34e831a33576ade7,0xb1a334e82de73576
.quad 0x3400340034003400,0x3400340034003400,0xb4003400b4003400,0xb4003400b4003400,0xb5443023b52fb085,0x30233544b085352f,0xb023b5443085b52f,0xb5443023b52fb085,0x22aab5a735a722aa,0xa2aa35a7b5a7a2aa,0x35a722aaa2aa35a7,0xb5a7a2aa22aab5a7,0x351930e6b5562f7e,0xb0e63519af7eb556,0xb0e63519af7eb556,0xb519b0e63556af7e
.quad 0xb44933643449b364,0xb44933643449b364,0xb364b44933643449,0xb364b44933643449,0xaeb3b567b1463501,0xb5672eb335013146,0x3567aeb3b501b146,0xaeb3b567b1463501,0x359f28fd28fdb59f,0xb59fa8fda8fd359f,0xa8fd359f359f28fd,0x28fdb59fb59fa8fd,0xb1a334e82de73576,0xb4e8b1a3b5762de7,0xb4e8b1a3b5762de7,0x31a3b4e8ade7b576
.quad 0,0,0,0,0,0,0,0,0,0,0,0,0,0,0,0
.quad 0,0,0,0,0,0,0,0,0,0,0,0,0,0,0,0
.quad 0,0,0,0,0,0,0,0,0,0,0,0,0,0,0,0
.quad 0,0,0,0,0,0,0,0,0,0,0,0,0,0,0,0
.quad 0x3400340034003400,0x3400340034003400,0xb4003400b4003400,0xb4003400b4003400,0x3542b02b3531307d,0xb02bb542307db531,0x302b3542b07d3531,0x3542b02b3531307d,0x218db5a735a7218d,0xa18d35a7b5a7a18d,0x35a7218da18d35a7,0xb5a7a18d218db5a7,0xb51fb0ce3552afb0,0x30ceb51f2fb03552,0x30ceb51f2fb03552,0x351f30ceb5522fb0
.quad 0xb43d337f343db37f,0xb43d337f343db37f,0xb37fb43d337f343d,0xb37fb43d337f343d,0x2f083560311eb50c,0x3560af08b50cb11e,0xb5602f08350c311e,0x2f083560311eb50c,0x35a228292829b5a2,0xb5a2a829a82935a2,0xa82935a235a22829,0x2829b5a2b5a2a829,0x316db4f7ae5eb56e,0x34f7316d356eae5e,0x34f7316d356eae5e,0xb16d34f72e5e356e
.quad 0x3400340034003400,0x3400340034003400,0xb4003400b4003400,0xb4003400b4003400,0xb542302bb531b07d,0x302b3542b07d3531,0xb02bb542307db531,0xb542302bb531b07d,0x218db5a735a7218d,0xa18d35a7b5a7a18d,0x35a7218da18d35a7,0xb5a7a18d218db5a7,0x351f30ceb5522fb0,0xb0ce351fafb0b552,0xb0ce351fafb0b552,0xb51fb0ce3552afb0
.quad 0xb43d337f343db37f,0xb43d337f343db37f,0xb37fb43d337f343d,0xb37fb43d337f343d,0xaf08b560b11e350c,0xb5602f08350c311e,0x3560af08b50cb11e,0xaf08b560b11e350c,0x35a228292829b5a2,0xb5a2a829a82935a2,0xa82935a235a22829,0x2829b5a2b5a2a829,0xb16d34f72e5e356e,0xb4f7b16db56e2e5e,0xb4f7b16db56e2e5e,0x316db4f7ae5eb56e
.quad 0,0,0,0,0,0,0,0,0,0,0,0,0,0,0,0
.quad 0,0,0,0,0,0,0,0,0,0,0,0,0,0,0,0
.quad 0,0,0,0,0,0,0,0,0,0,0,0,0,0,0,0
.quad 0,0,0,0,0,0,0,0,0,0,0,0,0,0,0,0
.quad 0x3400340034003400,0x3400340034003400,0xb4003400b4003400,0xb4003400b4003400,0x3541b03335333075,0xb033b5413075b533,0x30333541b0753533,0x3541b03335333075,0x2071b5a835a82071,0xa07135a8b5a8a071,0x35a82071a07135a8,0xb5a8a0712071b5a8,0xb525b0b6354dafe2,0x30b6b5252fe2354d,0x30b6b5252fe2354d,0x352530b6b54d2fe2
.quad 0xb43133993431b399,0xb43133993431b399,0xb399b43133993431,0xb399b43133993431,0x2f5c355930f6b515,0x3559af5cb515b0f6,0xb5592f5c351530f6,0x2f5c355930f6b515,0x35a426a926a9b5a4,0xb5a4a6a9a6a935a4,0xa6a935a435a426a9,0x26a9b5a4b5a4a6a9,0x3136b505aed5b565,0x350531363565aed5,0x350531363565aed5,0xb13635052ed53565
.quad 0x3400340034003400,0x3400340034003400,0xb4003400b4003400,0xb4003400b4003400,0xb5413033b533b075,0x30333541b0753533,0xb033b5413075b533,0xb5413033b533b075,0x2071b5a835a82071,0xa07135a8b5a8a071,0x35a82071a07135a8,0xb5a8a0712071b5a8,0x352530b6b54d2fe2,0xb0b63525afe2b54d,0xb0b63525afe2b54d,0xb525b0b6354dafe2
.quad 0xb43133993431b399,0xb43133993431b399,0xb399b43133993431,0xb399b43133993431,0xaf5cb559b0f63515,0xb5592f5c351530f6,0x3559af5cb515b0f6,0xaf5cb559b0f63515,0x35a426a926a9b5a4,0xb5a4a6a9a6a935a4,0xa6a935a435a426a9,0x26a9b5a4b5a4a6a9,0xb13635052ed53565,0xb505b136b5652ed5,0xb505b136b5652ed5,0x3136b505aed5b565
.quad 0,0,0,0,0,0,0,0,0,0,0,0,0,0,0,0
.quad 0,0,0,0,0,0,0,0,0,0,0,0,0,0,0,0
.quad 0,0,0,0,0,0,0,0,0,0,0,0,0,0,0,0
.quad 0,0,0,0,0,0,0,0,0,0,0,0,0,0,0,0
.quad 0x3400340034003400,0x3400340034003400,0xb4003400b4003400,0xb4003400b4003400,0x353fb03c3535306d,0xb03cb53f306db535,0x303c353fb06d3535,0x353fb03c3535306d,0x1eaab5a835a81eaa,0x9eaa35a8b5a89eaa,0x35a81eaa9eaa35a8,0xb5a89eaa1eaab5a8,0xb52ab09e3549b00a,0x309eb52a300a3549,0x309eb52a300a3549,0x352a309eb549300a
.quad 0xb42533b33425b3b3,0xb42533b33425b3b3,0xb3b3b42533b33425,0xb3b3b42533b33425,0x2fb0355230ceb51f,0x3552afb0b51fb0ce,0xb5522fb0351f30ce,0x2fb0355230ceb51f,0x35a624ff24ffb5a6,0xb5a6a4ffa4ff35a6,0xa4ff35a635a624ff,0x24ffb5a6b5a6a4ff,0x30feb513af4cb55b,0x351330fe355baf4c,0x351330fe355baf4c,0xb0fe35132f4c355b
.quad 0x3400340034003400,0x3400340034003400,0xb4003400b4003400,0xb4003400b4003400,0xb53f303cb535b06d,0x303c353fb06d3535,0xb03cb53f306db535,0xb53f303cb535b06d,0x1eaab5a835a81eaa,0x9eaa35a8b5a89eaa,0x35a81eaa9eaa35a8,0xb5a89eaa1eaab5a8,0x352a309eb549300a,0xb09e352ab00ab549,0xb09e352ab00ab549,0xb52ab09e3549b00a
.quad 0xb42533b33425b3b3,0xb42533b33425b3b3,0xb3b3b42533b33425,0xb3b3b42533b33425,0xafb0b552b0ce351f,0xb5522fb0351f30ce,0x3552afb0b51fb0ce,0xafb0b552b0ce351f,0x35a624ff24ffb5a6,0xb5a6a4ffa4ff35a6,0xa4ff35a635a624ff,0x24ffb5a6b5a6a4ff,0xb0fe35132f4c355b,0xb513b0feb55b2f4c,0xb513b0feb55b2f4c,0x30feb513af4cb55b
.quad 0,0,0,0,0,0,0,0,0,0,0,0,0,0,0,0
.quad 0,0,0,0,0,0,0,0,0,0,0,0,0,0,0,0
.quad 0,0,0,0,0,0,0,0,0,0,0,0,0,0,0,0
.quad 0,0,0,0,0,0,0,0,0,0,0,0,0,0,0,0
.quad 0x3400340034003400,0x3400340034003400,0xb4003400b4003400,0xb4003400b4003400,0x353db04435363065,0xb044b53d3065b536,0x3044353db0653536,0x353db04435363065,0x1c71b5a835a81c71,0x9c7135a8b5a89c71,0x35a81c719c7135a8,0xb5a89c711c71b5a8,0xb52fb0853544b023,0x3085b52f30233544,0x3085b52f30233544,0x352f3085b5443023
.quad 0xb41933cd3419b3cd,0xb41933cd3419b3cd,0xb3cdb41933cd3419,0xb3cdb41933cd3419,0x3002354a30a6b528,0x354ab002b528b0a6,0xb54a3002352830a6,0x3002354a30a6b528,0x35a722aa22aab5a7,0xb5a7a2aaa2aa35a7,0xa2aa35a735a722aa,0x22aab5a7b5a7a2aa,0x30c6b521afc1b550,0x352130c63550afc1,0x352130c63550afc1,0xb0c635212fc13550
.quad 0x3400340034003400,0x3400340034003400,0xb4003400b4003400,0xb4003400b4003400,0xb53d3044b536b065,0x3044353db0653536,0xb044b53d3065b536,0xb53d3044b536b065,0x1c71b5a835a81c71,0x9c7135a8b5a89c71,0x35a81c719c7135a8,0xb5a89c711c71b5a8,0x352f3085b5443023,0xb085352fb023b544,0xb085352fb023b544,0xb52fb0853544b023
.quad 0xb41933cd3419b3cd,0xb41933cd3419b3cd,0xb3cdb41933cd3419,0xb3cdb41933cd3419,0xb002b54ab0a63528,0xb54a3002352830a6,0x354ab002b528b0a6,0xb002b54ab0a63528,0x35a722aa22aab5a7,0xb5a7a2aaa2aa35a7,0xa2aa35a735a722aa,0x22aab5a7b5a7a2aa,0xb0c635212fc13550,0xb521b0c6b5502fc1,0xb521b0c6b5502fc1,0x30c6b521afc1b550
.quad 0,0,0,0,0,0,0,0,0,0,0,0,0,0,0,0
.quad 0,0,0,0,0,0,0,0,0,0,0,0,0,0,0,0
.quad 0,0,0,0,0,0,0,0,0,0,0,0,0,0,0,0
.quad 0,0,0,0,0,0,0,0,0,0,0,0,0,0,0,0
.quad 0x3400340034003400,0x3400340034003400,0xb4003400b4003400,0xb4003400b4003400,0x353cb04c3538305d,0xb04cb53c305db538,0x304c353cb05d3538,0x353cb04c3538305d,0x1871b5a835a81871,0x987135a8b5a89871,0x35a81871987135a8,0xb5a898711871b5a8,0xb535b06d353fb03c,0x306db535303c353f,0x306db535303c353f,0x3535306db53f303c
.quad 0xb40c33e7340cb3e7,0xb40c33e7340cb3e7,0xb3e7b40c33e7340c,0xb3e7b40c33e7340c,0x302b3542307db531,0x3542b02bb531b07d,0xb542302b3531307d,0x302b3542307db531,0x35a81eaa1eaab5a8,0xb5a89eaa9eaa35a8,0x9eaa35a835a81eaa,0x1eaab5a8b5a89eaa,0x308eb52eb01bb546,0x352e308e3546b01b,0x352e308e3546b01b,0xb08e352e301b3546
.quad 0x3400340034003400,0x3400340034003400,0xb4003400b4003400,0xb4003400b4003400,0xb53c304cb538b05d,0x304c353cb05d3538,0xb04cb53c305db538,0xb53c304cb538b05d,0x1871b5a835a81871,0x987135a8b5a89871,0x35a81871987135a8,0xb5a898711871b5a8,0x3535306db53f303c,0xb06d3535b03cb53f,0xb06d3535b03cb53f,0xb535b06d353fb03c
.quad 0xb40c33e7340cb3e7,0xb40c33e7340cb3e7,0xb3e7b40c33e7340c,0xb3e7b40c33e7340c,0xb02bb542b07d3531,0xb542302b3531307d,0x3542b02bb531b07d,0xb02bb542b07d3531,0x35a81eaa1eaab5a8,0xb5a89eaa9eaa35a8,0x9eaa35a835a81eaa,0x1eaab5a8b5a89eaa,0xb08e352e301b3546,0xb52eb08eb546301b,0xb52eb08eb546301b,0x308eb52eb01bb546
.quad 0,0,0,0,0,0,0,0,0,0,0,0,0,0,0,0
.quad 0,0,0,0,0,0,0,0,0,0,0,0,0,0,0,0
.quad 0,0,0,0,0,0,0,0,0,0,0,0,0,0,0,0
.quad 0,0,0,0,0,0,0,0,0,0,0,0,0,0,0,0
```

```asm
; @launch grid=(256,1,1) block=(512,1,1) lds=159552
.amdgcn_target "amdgcn-amd-amdhsa--gfx950"
.text
.globl parallel_sum__spectral_fnet__moe_arch_mod__prompt_kernel
.p2align 8
.type parallel_sum__spectral_fnet__moe_arch_mod__prompt_kernel,@function
parallel_sum__spectral_fnet__moe_arch_mod__prompt_kernel:
  s_load_dwordx2 s[4:5], s[0:1], 0
  s_load_dwordx2 s[8:9], s[0:1], 96
  s_load_dwordx2 s[12:13], s[0:1], 80
  s_getpc_b64 s[26:27]
L_pc:
  s_add_u32 s16, s26, L_tab@rel32@lo+4
  s_addc_u32 s17, s27, L_tab@rel32@hi+12
  v_lshrrev_b32 v3, 6, v0
  v_and_b32 v1, 63, v0
  s_mov_b32 s7, 0x20000
  v_readfirstlane_b32 s3, v3
  s_mov_b32 s11, 0x20000
  s_mov_b32 s19, 0x20000
  s_mov_b32 s23, 0x20000
  v_lshlrev_b32 v2, 4, v1
  s_mov_b32 s18, 85888
  s_cmp_ge_u32 s2, 128
  s_cbranch_scc1 L_ffn0
  s_load_dwordx2 s[20:21], s[0:1], 48
  s_mov_b32 s47, s2
  s_and_b32 s30, s2, 7
  s_sub_u32 s31, 16, s30
  s_cmp_eq_u32 s30, 0
  s_cselect_b32 s31, 8, s31
  s_bitcmp1_b32 s2, 3
  s_cselect_b32 s30, s31, s30
  s_and_b32 s2, s2, 0x70
  s_or_b32 s2, s2, s30
  s_mov_b32 s18, 217088
  s_lshl_b32 s30, s3, 8
  v_and_b32 v16, 15, v1
  v_lshrrev_b32 v17, 4, v1
  v_cmp_eq_u32 vcc, 4, v16
  v_mov_b32 v64, 0x3f803f80
  v_lshl_add_u32 v18, v17, 4, s30
  s_add_u32 s30, s30, s2
  s_cmp_eq_u32 s2, 0
  s_cselect_b32 s32, 896, 0
  v_cndmask_b32_e64 v32, 0, v64, vcc
  s_cmp_ge_u32 s3, 4
  s_cselect_b32 s32, s32, 0
  s_sub_u32 s30, s30, s32
  s_sub_u32 s31, 2048, s30
  s_cmp_eq_u32 s30, 0
  s_cselect_b32 s31, 1024, s31
  s_lshl_b32 s32, s30, 11
  s_lshl_b32 s33, s31, 11
  s_mul_i32 s34, s3, 4128
  s_mov_b32 s6, 0x400000
  s_mov_b32 s22, 2048
  s_lshl_b32 s38, s3, 9
  s_add_u32 m0, s38, 35328
  s_mov_b32 exec_hi, 0
  buffer_load_dwordx4 v2, s[16:19], s38 offen lds
  s_mov_b32 exec_hi, -1
  s_lshl_b32 s46, s3, 11
  s_add_u32 s39, s46, 39424
  s_add_u32 s46, s46, 4096
  s_cmp_eq_u32 s2, 0
  s_cselect_b32 s37, 2048, 0
  s_add_u32 s37, s37, s46
  s_cmp_eq_u32 s3, 6
  s_cselect_b32 s46, s37, s46
  s_lshl_b32 s37, s2, 10
  s_add_u32 s37, s37, 86016
  s_cmp_eq_u32 s3, 7
  s_cselect_b32 s46, s37, s46
  s_mov_b32 m0, s39
  s_nop 0
  buffer_load_dwordx4 v2, s[16:19], s46 offen lds
  buffer_load_dwordx4 v2, s[16:19], s46 offen offset:1024 lds
  v_mov_b32 v33, v32
  v_mov_b32 v34, v32
  v_mov_b32 v35, v32
  v_mov_b32 v36, v32
  v_mov_b32 v37, v32
  v_mov_b32 v38, v32
  v_mov_b32 v39, v32
  v_mov_b32 v40, v32
  v_mov_b32 v41, v32
  v_mov_b32 v42, v32
  v_mov_b32 v43, v32
  v_mov_b32 v44, v32
  v_mov_b32 v45, v32
  v_mov_b32 v46, v32
  v_mov_b32 v47, v32
  s_mov_b32 m0, s34
  s_waitcnt lgkmcnt(0)
  s_mov_b32 exec_lo, 0x01010101
  s_mov_b32 exec_hi, 0x01010101
  buffer_load_dwordx4 v[32:35], v18, s[20:23], 0 offen offset:0
  buffer_load_dwordx4 v[36:39], v18, s[20:23], 0 offen offset:64
  buffer_load_dwordx4 v[40:43], v18, s[20:23], 0 offen offset:128
  buffer_load_dwordx4 v[44:47], v18, s[20:23], 0 offen offset:192
  s_mov_b64 exec, -1
  buffer_load_dwordx4 v2, s[4:7], s32 offen lds
  buffer_load_dwordx4 v2, s[4:7], s32 offen offset:1024 lds
  s_add_u32 m0, m0, 2064
  s_load_dword s24, s[8:9], 0
  buffer_load_dwordx4 v2, s[4:7], s33 offen lds
  buffer_load_dwordx4 v2, s[4:7], s33 offen offset:1024 lds
  s_branch L_fft1
L_ffn0:
  s_cmp_ge_u32 s2, 256
  s_cbranch_scc1 L_end
  s_sub_u32 s30, s2, 128
  s_lshr_b32 s31, s30, 3
  s_lshl_b32 s31, s31, 13
  s_sub_u32 s32, s31, 16384
  s_cselect_b32 s31, s31, s32
  s_cselect_b64 s[16:17], s[26:27], s[16:17]
  s_cselect_b32 s32, L_end-L_pc, s18
  v_and_b32 v4, 0x1f8, v0
  v_lshl_add_u32 v4, v4, 4, s31
  v_min_u32 v4, s32, v4
  global_load_dword v57, v4, s[16:17]
  s_load_dwordx2 s[38:39], s[0:1], 48
  v_and_b32 v58, 0x7f0, v0
  v_lshlrev_b32 v58, 2, v58
  s_load_dwordx4 s[16:19], s[0:1], 56
  s_load_dwordx2 s[40:41], s[0:1], 72
  s_lshr_b32 s31, s30, 4
  s_and_b32 s32, s30, 15
  s_lshl_b32 s33, s32, 3
  s_add_u32 s33, s33, s3
  s_mul_i32 s33, s33, 57344
  s_mul_i32 s34, s31, 896
  s_add_u32 s33, s33, s34
  s_and_b32 s34, s3, 3
  s_mul_i32 s34, s34, 3712
  s_lshr_b32 s35, s3, 2
  s_mul_i32 s35, s35, 29696
  s_add_u32 m0, s34, s35
  s_mov_b32 s22, 7340032
  s_mov_b32 exec_hi, 0x00ffffff
  s_waitcnt lgkmcnt(0)
  s_mov_b64 s[20:21], s[18:19]
  s_mov_b32 s18, 7340032
  s_mov_b32 s19, 0x20000
  s_load_dword s24, s[8:9], 0
  s_cmp_lt_u32 s30, 8
  s_cbranch_scc0 L_npr
  global_load_dword v59, v58, s[38:39]
L_npr:
  s_waitcnt vmcnt(0)
  buffer_load_dwordx4 v2, s[16:19], s33 offen nt lds
  s_add_u32 m0, m0, 59392
  s_nop 0
  buffer_load_dwordx4 v2, s[20:23], s33 offen nt lds
  s_sub_u32 m0, m0, 58464
  s_add_u32 s33, s33, 7168
  buffer_load_dwordx4 v2, s[16:19], s33 offen nt lds
  s_add_u32 m0, m0, 59392
  s_nop 0
  buffer_load_dwordx4 v2, s[20:23], s33 offen nt lds
  s_sub_u32 m0, m0, 58464
  s_add_u32 s33, s33, 7168
  buffer_load_dwordx4 v2, s[16:19], s33 offen nt lds
  s_add_u32 m0, m0, 59392
  s_nop 0
  buffer_load_dwordx4 v2, s[20:23], s33 offen nt lds
  s_sub_u32 m0, m0, 58464
  s_add_u32 s33, s33, 7168
  buffer_load_dwordx4 v2, s[16:19], s33 offen nt lds
  s_add_u32 m0, m0, 59392
  s_nop 0
  buffer_load_dwordx4 v2, s[20:23], s33 offen nt lds
  s_sub_u32 m0, m0, 47328
  s_add_u32 s33, s33, 7168
  buffer_load_dwordx4 v2, s[16:19], s33 offen nt lds
  s_add_u32 m0, m0, 59392
  s_nop 0
  buffer_load_dwordx4 v2, s[20:23], s33 offen nt lds
  s_sub_u32 m0, m0, 58464
  s_add_u32 s33, s33, 7168
  buffer_load_dwordx4 v2, s[16:19], s33 offen nt lds
  s_add_u32 m0, m0, 59392
  s_nop 0
  buffer_load_dwordx4 v2, s[20:23], s33 offen nt lds
  s_sub_u32 m0, m0, 58464
  s_add_u32 s33, s33, 7168
  buffer_load_dwordx4 v2, s[16:19], s33 offen nt lds
  s_add_u32 m0, m0, 59392
  s_nop 0
  buffer_load_dwordx4 v2, s[20:23], s33 offen nt lds
  s_sub_u32 m0, m0, 58464
  s_add_u32 s33, s33, 7168
  buffer_load_dwordx4 v2, s[16:19], s33 offen nt lds
  s_add_u32 m0, m0, 59392
  s_nop 0
  buffer_load_dwordx4 v2, s[20:23], s33 offen nt lds
  s_mov_b32 exec_hi, -1
  s_branch L_ffn1
L_fft1:
  s_bfe_u32 s41, s2, 0x10003
  s_load_dwordx2 s[30:31], s[0:1], 72
  s_min_u32 s36, s47, 111
  s_lshl_b32 s36, s36, 16
  s_lshr_b32 s37, s3, 1
  s_lshl_b32 s37, s37, 14
  s_add_u32 s36, s36, s37
  s_and_b32 s37, s3, 1
  s_lshl_b32 s37, s37, 12
  s_add_u32 s36, s36, s37
  v_and_b32 v19, 1, v17
  v_and_b32 v20, 2, v17
  v_lshl_add_u32 v3, v16, 7, s36
  v_lshl_add_u32 v3, v19, 11, v3
  v_lshl_add_u32 v3, v20, 12, v3
  s_and_b32 s40, s2, 7
  s_lshr_b32 s42, s2, 4
  s_and_b32 s43, s2, 15
  v_lshrrev_b32 v19, 3, v0
  v_and_b32 v20, 7, v0
  v_lshl_add_u32 v19, v19, 4, s43
  s_lshl_b32 s44, s42, 7
  v_lshl_add_u32 v20, v20, 4, s44
  v_lshl_add_u32 v172, v19, 11, v20
  v_sub_u32 v19, 1024, v19
  v_sub_u32 v20, 2032, v20
  v_add_u32 v174, 0x200000, v172
  v_lshl_add_u32 v175, v19, 11, v20
  v_add_u32 v173, 0x200000, v175
  v_and_b32 v173, 0x3fffff, v173
  v_mul_u32_u24 v5, 2064, v16
  v_add_u32 v5, v5, v18
  s_mov_b32 s36, 55808
  v_lshl_add_u32 v8, v1, 5, s36
  v_lshrrev_b32 v19, 3, v1
  v_add_u32 v19, s3, v19
  v_and_b32 v20, 7, v19
  v_lshl_add_u32 v6, v20, 2, v8
  v_lshlrev_b32 v21, 1, v17
  v_sub_u32 v19, v19, v21
  v_add_u32 v19, 6, v19
  v_and_b32 v19, 7, v19
  v_lshlrev_b32 v19, 2, v19
  v_lshl_add_u32 v20, v16, 5, v19
  v_add_u32 v20, 57344, v20
  v_add_u32 v21, 2048, v6
  s_mov_b32 s36, 0x00f0000f
  s_mov_b32 s37, 0xf0000f00
  v_cndmask_b32_e64 v7, v21, v20, s[36:37]
  v_bfe_u32 v20, v1, 2, 2
  v_and_b32 v21, 3, v1
  v_lshrrev_b32 v22, 5, v1
  v_lshl_add_u32 v22, v22, 3, v20
  v_and_b32 v23, 1, v17
  v_lshlrev_b32 v22, 6, v22
  v_lshl_add_u32 v22, v23, 5, v22
  v_lshl_add_u32 v22, v21, 3, v22
  v_add_u32 v4, s34, v22
  v_mov_b32 v65, v64
  v_mov_b32 v66, v64
  v_mov_b32 v67, v64
  v_mov_b32 v11, 0xfffcfffc
  s_mov_b32 s10, 8388608
  s_mov_b32 s14, 0x400000
  s_mov_b32 s15, 0x20000
  s_lshl_b32 s34, s3, 1
  s_add_u32 s35, s34, 17
  s_add_u32 s34, s34, 16
  s_mov_b32 s48, 0x22222222
  s_mov_b32 s49, 0x22222222
  s_mov_b32 s50, 0x44444444
  s_mov_b32 s51, 0x44444444
  s_mov_b32 s52, 0x88888888
  s_mov_b32 s53, 0x88888888
  v_lshrrev_b32 v20, 1, v16
  v_lshlrev_b32 v20, 8, v20
  s_cmp_eq_u32 s2, 0
  s_cselect_b32 s36, 896, 0
  s_cselect_b32 s55, 0x10000, 0
  s_mov_b32 s54, 0xffff0000
  v_bfe_u32 v21, v1, 3, 1
  v_mul_u32_u24 v21, s36, v21
  v_add_u32 v20, s2, v20
  v_sub_u32 v20, v20, v21
  v_sub_u32 v21, 0x800, v20
  v_cmp_eq_u32 vcc, 0, v20
  v_mov_b32 v22, 0x400
  s_mov_b32 s36, 0xaaaaaaaa
  s_mov_b32 s37, s36
  v_cndmask_b32_e64 v21, v21, v22, vcc
  v_cndmask_b32_e64 v20, v20, v21, s[36:37]
  v_sub_u32 v9, 0xffff, v20
  v_and_b32 v21, 15, v20
  v_and_b32 v20, 0x7f0, v20
  v_lshl_add_u32 v10, v21, 12, v20
  v_mov_b32 v21, 0x800
  s_nop 1
  v_mov_b32_dpp v10, v21 quad_perm:[0,1,2,3] row_mask:0xd bank_mask:0xf
  s_waitcnt vmcnt(0)
  v_mfma_f32_16x16x32_bf16 v[76:79], v[32:35], v[64:67], 0
  v_mfma_f32_16x16x32_bf16 v[76:79], v[36:39], v[64:67], v[76:79]
  v_mfma_f32_16x16x32_bf16 v[76:79], v[40:43], v[64:67], v[76:79]
  v_mfma_f32_16x16x32_bf16 v[76:79], v[44:47], v[64:67], v[76:79]
  s_waitcnt lgkmcnt(0)
  s_barrier
  ds_read_b128 v[48:51], v5 offset:0
  ds_read_b128 v[52:55], v5 offset:64
  ds_read_b128 v[56:59], v5 offset:128
  ds_read_b128 v[60:63], v5 offset:192
  ds_read_b64_tr_b16 v[132:133], v4 offset:0
  ds_read_b64_tr_b16 v[134:135], v4 offset:256
  ds_read_b64_tr_b16 v[136:137], v4 offset:1024
  ds_read_b64_tr_b16 v[138:139], v4 offset:1280
  ds_read_b128 v[112:115], v2 offset:35328
  ds_read_b128 v[116:119], v2 offset:36352
  s_add_u32 s24, s24, 1
  s_and_b32 s29, s24, 0xff
  s_waitcnt lgkmcnt(9)
  v_mfma_f32_16x16x32_bf16 v[72:75], v[48:51], v[48:51], 0
  v_mfma_f32_16x16x32_bf16 v[68:71], v[32:35], v[48:51], 0
  s_waitcnt lgkmcnt(8)
  v_mfma_f32_16x16x32_bf16 v[72:75], v[52:55], v[52:55], v[72:75]
  v_mfma_f32_16x16x32_bf16 v[68:71], v[36:39], v[52:55], v[68:71]
  s_waitcnt lgkmcnt(7)
  v_mfma_f32_16x16x32_bf16 v[72:75], v[56:59], v[56:59], v[72:75]
  v_mfma_f32_16x16x32_bf16 v[68:71], v[40:43], v[56:59], v[68:71]
  s_waitcnt lgkmcnt(6)
  v_mfma_f32_16x16x32_bf16 v[72:75], v[60:63], v[60:63], v[72:75]
  v_mfma_f32_16x16x32_bf16 v[68:71], v[44:47], v[60:63], v[68:71]
  ds_read_b128 v[120:123], v2 offset:37376
  ds_read_b128 v[124:127], v2 offset:38400
  ds_read_b64_tr_b16 v[140:141], v4 offset:2064
  ds_read_b64_tr_b16 v[142:143], v4 offset:2320
  ds_read_b64_tr_b16 v[144:145], v4 offset:3088
  ds_read_b64_tr_b16 v[146:147], v4 offset:3344
  s_nop 0
  v_cndmask_b32_e64 v72, v72, v73, s[48:49]
  v_cndmask_b32_e64 v74, v74, v75, s[52:53]
  v_mov_b32_dpp v68, v76 quad_perm:[0,1,2,3] row_mask:0x4 bank_mask:0xf
  s_or_b64 s[50:51], s[50:51], s[52:53]
  ds_write_b32 v6, v68
  v_cndmask_b32_e64 v72, v72, v74, s[50:51]
  ds_write_b32 v7, v72
  s_waitcnt lgkmcnt(8)
  v_mfma_f32_32x32x16_bf16 v[176:191], v[132:135], v[112:115], 0
  v_mfma_f32_32x32x16_bf16 v[176:191], v[136:139], v[116:119], v[176:191]
  s_waitcnt lgkmcnt(0)
  s_barrier
  ds_read_b128 v[28:31], v8
  ds_read_b128 v[68:71], v8 offset:16
  ds_read_b128 v[20:23], v2 offset:51712
  ds_read_b128 v[12:15], v2 offset:47616
  ds_read_b128 v[80:83], v2 offset:39424
  ds_read_b128 v[84:87], v2 offset:40448
  ds_read_b128 v[88:91], v2 offset:41472
  ds_read_b128 v[92:95], v2 offset:42496
  ds_read_b128 v[96:99], v2 offset:43520
  ds_read_b128 v[100:103], v2 offset:44544
  ds_read_b128 v[104:107], v2 offset:45568
  ds_read_b128 v[108:111], v2 offset:46592
  ds_read_b128 v[128:131], v2 offset:53760
  ds_read_b128 v[24:27], v2 offset:52736
  s_cmp_eq_u32 s3, 7
  s_cbranch_scc1 L_cw
  v_mfma_f32_32x32x16_bf16 v[192:207], v[132:135], v[120:123], 0
  s_waitcnt lgkmcnt(12)
  v_pk_add_f32 v[28:29], v[28:29], v[30:31]
  v_pk_add_f32 v[68:69], v[68:69], v[70:71]
  v_pk_add_f32 v[28:29], v[28:29], v[68:69]
  v_add_f32 v68, v28, v29
  v_add_f32 v31, v28, v29
  s_nop 1
  v_permlane32_swap_b32 v68, v31
  v_mfma_f32_32x32x16_bf16 v[192:207], v[136:139], v[124:127], v[192:207]
  v_mov_b32 v69, v31
  v_mul_f32 v29, 0x3a800000, v68
  v_mul_f32 v31, 0x3a800000, v31
  v_fma_f32 v31, -v29, v29, v31
  v_max_f32 v31, 0, v31
  v_mfma_f32_32x32x16_bf16 v[208:223], v[140:143], v[112:115], 0
  v_cvt_pk_bf16_f32 v31, v31, v31
  v_and_b32 v31, 0xffff0000, v31
  v_add_f32 v31, 0x3727c5ac, v31
  v_cvt_pk_bf16_f32 v31, v31, v31
  v_and_b32 v31, 0xffff0000, v31
  v_sqrt_f32 v31, v31
  v_mfma_f32_32x32x16_bf16 v[208:223], v[144:147], v[116:119], v[208:223]
  v_mov_b32 v18, s24
  v_cvt_pk_bf16_f32 v19, v29, v31
  v_and_b32 v16, 0xffff0000, v19
  v_rcp_f32 v16, v16
  v_lshlrev_b32 v17, 16, v19
  v_mfma_f32_32x32x16_bf16 v[224:239], v[140:143], v[120:123], 0
  v_mul_f32 v17, v17, v16
  v_readlane_b32 s56, v16, s34
  v_readlane_b32 s57, v16, s35
  v_readlane_b32 s58, v17, s34
  v_readlane_b32 s59, v17, s35
  v_mfma_f32_32x32x16_bf16 v[224:239], v[144:147], v[124:127], v[224:239]
L_nocand:
  s_lshl_b32 s63, s41, 15
  s_lshl_b32 s38, s3, 13
  s_add_u32 m0, s38, 79552
  s_add_u32 s63, s63, s38
  s_add_u32 s63, s63, 20480
  s_mov_b32 s60, s57
  s_mov_b32 s61, s59
  s_or_b32 s62, s2, s3
  s_cselect_b32 s57, s57, 0
  s_cselect_b32 s59, s59, 0
  s_mul_i32 s36, s3, 2176
  s_lshl_b32 s37, s3, 5
  s_waitcnt lgkmcnt(10)
  v_add_u32 v21, s37, v21
  v_add_u32 v12, s36, v12
  v_add_u32 v13, s36, v13
  v_add_u32 v14, s36, v14
  v_add_u32 v15, s36, v15
  v_and_b32 v21, 0xff, v21
  v_add_u32 v20, v20, v21
L_job:
  v_mul_f32 v18, s58, v23
  v_mul_f32 v19, s59, v23
  v_add_f32 v16, v18, v19
  v_sub_f32 v17, v18, v19
  v_pk_fma_f32 v[156:157], v[176:177], s[56:57], v[16:17] op_sel:[0,0,0] op_sel_hi:[1,0,0]
  v_pk_fma_f32 v[158:159], v[192:193], s[56:57], v[16:17] op_sel:[0,0,1] op_sel_hi:[1,0,1]
  v_pk_fma_f32 v[156:157], v[224:225], s[56:57], v[156:157] op_sel:[0,1,0] op_sel_hi:[1,1,1]
  v_pk_fma_f32 v[158:159], v[208:209], s[56:57], v[158:159] op_sel:[0,1,0] op_sel_hi:[1,1,1] neg_lo:[1,0,0] neg_hi:[1,0,0]
  s_waitcnt lgkmcnt(2)
  v_cvt_pk_f16_f32 v160, v156, v157
  v_cvt_pk_f16_f32 v161, v158, v159
  v_pk_mul_f16 v162, v160, v80
  v_pk_mul_f16 v163, v161, v80
  v_pk_fma_f16 v132, v161, v82, v162
  v_pk_fma_f16 v134, v160, v82, v163 neg_lo:[1,0,0] neg_hi:[1,0,0]
  v_pk_fma_f32 v[164:165], v[178:179], s[56:57], v[16:17] op_sel:[0,0,0] op_sel_hi:[1,0,0]
  v_pk_fma_f32 v[166:167], v[194:195], s[56:57], v[16:17] op_sel:[0,0,1] op_sel_hi:[1,0,1]
  v_pk_fma_f32 v[164:165], v[226:227], s[56:57], v[164:165] op_sel:[0,1,0] op_sel_hi:[1,1,1]
  v_pk_fma_f32 v[166:167], v[210:211], s[56:57], v[166:167] op_sel:[0,1,0] op_sel_hi:[1,1,1] neg_lo:[1,0,0] neg_hi:[1,0,0]
  v_cvt_pk_f16_f32 v168, v164, v165
  v_cvt_pk_f16_f32 v169, v166, v167
  v_pk_mul_f16 v170, v168, v81
  v_pk_mul_f16 v171, v169, v81
  v_pk_fma_f16 v133, v169, v83, v170
  v_pk_fma_f16 v135, v168, v83, v171 neg_lo:[1,0,0] neg_hi:[1,0,0]
  v_pk_fma_f32 v[156:157], v[180:181], s[56:57], v[16:17] op_sel:[0,0,0] op_sel_hi:[1,0,0]
  v_pk_fma_f32 v[158:159], v[196:197], s[56:57], v[16:17] op_sel:[0,0,1] op_sel_hi:[1,0,1]
  v_pk_fma_f32 v[156:157], v[228:229], s[56:57], v[156:157] op_sel:[0,1,0] op_sel_hi:[1,1,1]
  v_pk_fma_f32 v[158:159], v[212:213], s[56:57], v[158:159] op_sel:[0,1,0] op_sel_hi:[1,1,1] neg_lo:[1,0,0] neg_hi:[1,0,0]
  s_nop 1
  v_mfma_f32_32x32x16_f16 v[112:127], v[132:135], v[96:99], 0
  v_cvt_pk_f16_f32 v160, v156, v157
  v_cvt_pk_f16_f32 v161, v158, v159
  v_pk_mul_f16 v162, v160, v84
  v_pk_mul_f16 v163, v161, v84
  v_pk_fma_f16 v136, v161, v86, v162
  v_pk_fma_f16 v138, v160, v86, v163 neg_lo:[1,0,0] neg_hi:[1,0,0]
  v_pk_fma_f32 v[164:165], v[182:183], s[56:57], v[16:17] op_sel:[0,0,0] op_sel_hi:[1,0,0]
  v_pk_fma_f32 v[166:167], v[198:199], s[56:57], v[16:17] op_sel:[0,0,1] op_sel_hi:[1,0,1]
  v_pk_fma_f32 v[164:165], v[230:231], s[56:57], v[164:165] op_sel:[0,1,0] op_sel_hi:[1,1,1]
  v_pk_fma_f32 v[166:167], v[214:215], s[56:57], v[166:167] op_sel:[0,1,0] op_sel_hi:[1,1,1] neg_lo:[1,0,0] neg_hi:[1,0,0]
  v_cvt_pk_f16_f32 v168, v164, v165
  v_cvt_pk_f16_f32 v169, v166, v167
  v_pk_mul_f16 v170, v168, v85
  v_pk_mul_f16 v171, v169, v85
  v_pk_fma_f16 v137, v169, v87, v170
  v_pk_fma_f16 v139, v168, v87, v171 neg_lo:[1,0,0] neg_hi:[1,0,0]
  v_pk_fma_f32 v[156:157], v[184:185], s[56:57], v[16:17] op_sel:[0,0,0] op_sel_hi:[1,0,0]
  v_pk_fma_f32 v[158:159], v[200:201], s[56:57], v[16:17] op_sel:[0,0,1] op_sel_hi:[1,0,1]
  v_pk_fma_f32 v[156:157], v[232:233], s[56:57], v[156:157] op_sel:[0,1,0] op_sel_hi:[1,1,1]
  v_pk_fma_f32 v[158:159], v[216:217], s[56:57], v[158:159] op_sel:[0,1,0] op_sel_hi:[1,1,1] neg_lo:[1,0,0] neg_hi:[1,0,0]
  s_nop 1
  v_mfma_f32_32x32x16_f16 v[112:127], v[136:139], v[100:103], v[112:127]
  s_cmp_ge_u32 s3, 4
  s_cbranch_scc1 L_yb0
  buffer_load_dwordx4 v2, s[16:19], s63 offen offset:0 lds
  buffer_load_dwordx4 v2, s[16:19], s63 offen offset:1024 lds
L_yb0:
  v_cvt_pk_f16_f32 v160, v156, v157
  v_cvt_pk_f16_f32 v161, v158, v159
  v_pk_mul_f16 v162, v160, v88
  v_pk_mul_f16 v163, v161, v88
  v_pk_fma_f16 v140, v161, v90, v162
  v_pk_fma_f16 v142, v160, v90, v163 neg_lo:[1,0,0] neg_hi:[1,0,0]
  v_pk_fma_f32 v[164:165], v[186:187], s[56:57], v[16:17] op_sel:[0,0,0] op_sel_hi:[1,0,0]
  v_pk_fma_f32 v[166:167], v[202:203], s[56:57], v[16:17] op_sel:[0,0,1] op_sel_hi:[1,0,1]
  v_pk_fma_f32 v[164:165], v[234:235], s[56:57], v[164:165] op_sel:[0,1,0] op_sel_hi:[1,1,1]
  v_pk_fma_f32 v[166:167], v[218:219], s[56:57], v[166:167] op_sel:[0,1,0] op_sel_hi:[1,1,1] neg_lo:[1,0,0] neg_hi:[1,0,0]
  s_cmp_ge_u32 s3, 4
  s_cbranch_scc1 L_yb1
  buffer_load_dwordx4 v2, s[16:19], s63 offen offset:2048 lds
  buffer_load_dwordx4 v2, s[16:19], s63 offen offset:3072 lds
L_yb1:
  v_cvt_pk_f16_f32 v168, v164, v165
  v_cvt_pk_f16_f32 v169, v166, v167
  v_pk_mul_f16 v170, v168, v89
  v_pk_mul_f16 v171, v169, v89
  v_pk_fma_f16 v141, v169, v91, v170
  v_pk_fma_f16 v143, v168, v91, v171 neg_lo:[1,0,0] neg_hi:[1,0,0]
  v_pk_fma_f32 v[156:157], v[188:189], s[56:57], v[16:17] op_sel:[0,0,0] op_sel_hi:[1,0,0]
  v_pk_fma_f32 v[158:159], v[204:205], s[56:57], v[16:17] op_sel:[0,0,1] op_sel_hi:[1,0,1]
  v_pk_fma_f32 v[156:157], v[236:237], s[56:57], v[156:157] op_sel:[0,1,0] op_sel_hi:[1,1,1]
  v_pk_fma_f32 v[158:159], v[220:221], s[56:57], v[158:159] op_sel:[0,1,0] op_sel_hi:[1,1,1] neg_lo:[1,0,0] neg_hi:[1,0,0]
  s_nop 1
  v_mfma_f32_32x32x16_f16 v[112:127], v[140:143], v[104:107], v[112:127]
  s_cmp_ge_u32 s3, 4
  s_cbranch_scc1 L_yb2
  s_add_u32 m0, m0, 4096
  s_add_u32 s63, s63, 4096
  buffer_load_dwordx4 v2, s[16:19], s63 offen offset:0 lds
  buffer_load_dwordx4 v2, s[16:19], s63 offen offset:1024 lds
L_yb2:
  v_cvt_pk_f16_f32 v160, v156, v157
  v_cvt_pk_f16_f32 v161, v158, v159
  v_pk_mul_f16 v162, v160, v92
  v_pk_mul_f16 v163, v161, v92
  v_pk_fma_f16 v144, v161, v94, v162
  v_pk_fma_f16 v146, v160, v94, v163 neg_lo:[1,0,0] neg_hi:[1,0,0]
  v_pk_fma_f32 v[164:165], v[190:191], s[56:57], v[16:17] op_sel:[0,0,0] op_sel_hi:[1,0,0]
  v_pk_fma_f32 v[166:167], v[206:207], s[56:57], v[16:17] op_sel:[0,0,1] op_sel_hi:[1,0,1]
  v_pk_fma_f32 v[164:165], v[238:239], s[56:57], v[164:165] op_sel:[0,1,0] op_sel_hi:[1,1,1]
  v_pk_fma_f32 v[166:167], v[222:223], s[56:57], v[166:167] op_sel:[0,1,0] op_sel_hi:[1,1,1] neg_lo:[1,0,0] neg_hi:[1,0,0]
  s_cmp_ge_u32 s3, 4
  s_cbranch_scc1 L_yb3
  buffer_load_dwordx4 v2, s[16:19], s63 offen offset:2048 lds
  buffer_load_dwordx4 v2, s[16:19], s63 offen offset:3072 lds
  s_sub_u32 m0, m0, 4096
  s_sub_u32 s63, s63, 4096
L_yb3:
  v_cvt_pk_f16_f32 v168, v164, v165
  v_cvt_pk_f16_f32 v169, v166, v167
  v_pk_mul_f16 v170, v168, v93
  v_pk_mul_f16 v171, v169, v93
  v_pk_fma_f16 v145, v169, v95, v170
  v_pk_fma_f16 v147, v168, v95, v171 neg_lo:[1,0,0] neg_hi:[1,0,0]
  s_nop 1
  v_mfma_f32_32x32x16_f16 v[112:127], v[144:147], v[108:111], v[112:127]
  s_and_b32 s37, s24, 0x3333
  s_and_b32 s38, s24, 0xcccc
  s_lshl_b32 s38, s38, 14
  s_or_b32 s37, s37, s38
  s_and_b32 s25, s37, 0x30003
  s_lshr_b32 s38, s37, 4
  s_and_b32 s26, s38, 0x30003
  s_lshr_b32 s38, s37, 8
  s_and_b32 s27, s38, 0x30003
  s_lshr_b32 s38, s37, 12
  s_and_b32 s28, s38, 0x30003
  s_nop 0
  v_cvt_pk_f16_f32 v148, v112, v113
  v_cvt_pk_f16_f32 v149, v114, v115
  v_cvt_pk_f16_f32 v150, v116, v117
  v_cvt_pk_f16_f32 v151, v118, v119
  ds_write_b128 v12, v[148:151]
  v_cvt_pk_f16_f32 v152, v120, v121
  v_cvt_pk_f16_f32 v153, v122, v123
  v_cvt_pk_f16_f32 v154, v124, v125
  v_cvt_pk_f16_f32 v155, v126, v127
  ds_write_b128 v13, v[152:155]
  ds_write_b16_d16_hi v14, v151
  ds_write_b16_d16_hi v15, v155
  s_cmp_lg_u32 s62, 0
  s_cbranch_scc0 L_job2
L_jobx:
  s_lshl_b32 s37, s2, 14
  s_lshl_b32 s38, s3, 8
  s_add_u32 s37, s37, s38
  s_add_u32 s37, s37, 1048576
  s_waitcnt lgkmcnt(0)
  s_barrier
  ds_read_b64_tr_b16 v[132:133], v20 offset:0
  ds_read_b64_tr_b16 v[134:135], v20 offset:4352
  ds_read_b64_tr_b16 v[136:137], v20 offset:8
  ds_read_b64_tr_b16 v[138:139], v20 offset:4360
  ds_read_b64_tr_b16 v[140:141], v20 offset:256
  ds_read_b64_tr_b16 v[142:143], v20 offset:4608
  ds_read_b64_tr_b16 v[144:145], v20 offset:264
  ds_read_b64_tr_b16 v[146:147], v20 offset:4616
  s_cmp_lg_u32 s3, 6
  s_cbranch_scc1 L_noext0
  ds_read_u16 v176, v24 offset:0
  ds_read_u16 v180, v25 offset:0
  ds_read_u16 v177, v24 offset:2176
  ds_read_u16 v181, v25 offset:2176
  ds_read_u16 v178, v24 offset:4352
  ds_read_u16 v182, v25 offset:4352
  ds_read_u16 v179, v24 offset:6528
  ds_read_u16 v183, v25 offset:6528
  s_lshl_b32 s38, s2, 9
  s_add_u32 s38, s38, 65536
  s_add_u32 s39, s38, 64
  v_mov_b32 v193, s24
  v_mov_b32 v195, s24
  s_waitcnt lgkmcnt(0)
  v_lshl_or_b32 v176, v180, 16, v176
  v_lshl_or_b32 v177, v181, 16, v177
  v_lshl_or_b32 v178, v182, 16, v178
  v_lshl_or_b32 v179, v183, 16, v179
  s_nop 1
  v_mfma_f32_16x16x32_f16 v[188:191], v[128:131], v[176:179], 0
L_noext0:
  s_waitcnt lgkmcnt(6)
  v_mfma_f32_16x16x32_f16 v[156:159], v[128:131], v[132:135], 0
  s_waitcnt lgkmcnt(4)
  v_mfma_f32_16x16x32_f16 v[160:163], v[128:131], v[136:139], 0
  s_waitcnt lgkmcnt(2)
  v_mfma_f32_16x16x32_f16 v[164:167], v[128:131], v[140:143], 0
  s_waitcnt lgkmcnt(0)
  v_mfma_f32_16x16x32_f16 v[168:171], v[128:131], v[144:147], 0
  s_cmp_lg_u32 s3, 6
  s_cbranch_scc1 L_noext
  v_cvt_pk_f16_f32 v192, v188, v189
  v_cvt_pk_f16_f32 v194, v190, v191
  s_mov_b32 exec_lo, 0xff00ff
  s_mov_b32 exec_hi, 0xff00ff
  buffer_store_dwordx2 v[192:193], v26, s[8:11], s38 offen sc1
  buffer_store_dwordx2 v[194:195], v26, s[8:11], s39 offen sc1
  s_mov_b64 exec, -1
L_noext:
  s_nop 1
  v_cvt_pk_f16_f32 v148, v156, v160
  s_nop 2
  v_cvt_pk_f16_f32 v149, v164, v168
  v_cvt_pk_f16_f32 v150, v157, v161
  v_cvt_pk_f16_f32 v151, v165, v169
  v_add_u32 v148, 0x20002, v148
  v_add_u32 v149, 0x20002, v149
  v_add_u32 v150, 0x20002, v150
  v_add_u32 v151, 0x20002, v151
  v_and_or_b32 v148, v148, v11, s25
  v_and_or_b32 v149, v149, v11, s26
  v_and_or_b32 v150, v150, v11, s27
  v_and_or_b32 v151, v151, v11, s28
  buffer_store_dwordx4 v[148:151], v22, s[8:11], s37 offen offset:0 sc1
  v_cvt_pk_f16_f32 v152, v158, v162
  v_cvt_pk_f16_f32 v153, v166, v170
  v_cvt_pk_f16_f32 v154, v159, v163
  v_cvt_pk_f16_f32 v155, v167, v171
  v_add_u32 v152, 0x20002, v152
  v_add_u32 v153, 0x20002, v153
  v_add_u32 v154, 0x20002, v154
  v_add_u32 v155, 0x20002, v155
  v_and_or_b32 v152, v152, v11, s25
  v_and_or_b32 v153, v153, v11, s26
  v_and_or_b32 v154, v154, v11, s27
  v_and_or_b32 v155, v155, v11, s28
  buffer_store_dwordx4 v[152:155], v22, s[8:11], s37 offen offset:2048 sc1
  s_barrier
  s_cmp_eq_u32 s3, 5
  s_cbranch_scc1 L_y01
  s_cmp_lg_u32 s3, 7
  s_cbranch_scc1 L_y03
  s_and_b32 s45, s2, 7
  s_lshl_b32 s45, s45, 11
  s_add_u32 s45, s45, 131072
  buffer_load_dwordx4 v[164:167], v2, s[8:11], s45 offen sc1
  buffer_load_dwordx4 v[168:171], v2, s[8:11], s45 offen offset:1024 sc1
  s_branch L_y03
L_y01:
  s_sub_u32 s45, 16, s43
  s_and_b32 s45, s45, 15
  s_cselect_b32 s37, 0, 16
  s_lshl_b32 s45, s45, 12
  s_lshl_b32 s44, s43, 12
  s_add_u32 s45, s45, s37
  s_add_u32 s44, s44, 196608
  s_add_u32 s45, s45, 196608
  buffer_load_dwordx3 v[112:114], v2, s[8:11], s44 offen offset:0 sc1
  buffer_load_dwordx3 v[116:118], v2, s[8:11], s44 offen offset:1024 sc1
  buffer_load_dwordx3 v[120:122], v2, s[8:11], s45 offen offset:0 sc1
  buffer_load_dwordx3 v[124:126], v2, s[8:11], s45 offen offset:1024 sc1
L_y03:
  s_mov_b32 exec_lo, 0
  global_load_dword v27, v3, s[30:31]
  s_mov_b64 exec, -1
  buffer_load_dwordx4 v[240:243], v172, s[4:7], 0 offen
  buffer_load_dwordx4 v[244:247], v173, s[4:7], 0 offen
  buffer_load_dwordx4 v[248:251], v174, s[4:7], 0 offen
  buffer_load_dwordx4 v[252:255], v175, s[4:7], 0 offen
  ds_read_b128 v[4:7], v2 offset:48640
  ds_read_b128 v[8:11], v2 offset:49664
  ds_read_b64 v[230:231], v2 offset:50696
  v_and_b32 v228, 0x1f8, v0
  v_sub_u32 v229, 57336, v228
  v_add_u32 v228, 55808, v228
  s_and_b32 s52, s3, 3
  s_lshl_b32 s36, s52, 13
  s_add_u32 s36, s36, 79552
  v_add_u32 v236, s36, v2
  s_lshl_b32 s48, s40, 11
  s_lshl_b32 s49, s42, 8
  s_add_u32 s48, s48, s49
  s_add_u32 s48, s48, 1048576
  s_lshl_b32 s36, s3, 16
  s_sub_u32 s49, s48, s36
  s_add_u32 s48, s48, s36
  s_add_u32 s32, s48, 524288
  s_add_u32 s33, s49, 999424
  s_add_u32 s49, s49, 1523712
  s_cmp_eq_u32 s41, 0
  s_mov_b32 s50, 0xbc00bc00
  s_cmov_b32 s50, 0x3c003c00
  s_lshr_b32 s51, s3, 2
  s_cmp_eq_u32 s3, 0
  s_cselect_b32 s38, 0xffff, 0
  s_mov_b32 s39, 0
  v_mov_b32 v232, s25
  v_mov_b32 v233, s26
  v_mov_b32 v234, s27
  v_mov_b32 v235, s28
  v_mov_b32 v25, 0x40000000
  s_lshl_b32 s36, s3, 10
  s_lshl_b32 s37, s51, 6
  s_waitcnt lgkmcnt(0)
  v_add_u32 v24, 0x100000, v5
  v_add_u32 v6, s36, v6
  v_cndmask_b32_e64 v24, v24, v5, s[38:39]
  v_xor_b32 v7, s37, v7
  s_mul_i32 s36, s52, 4608
  s_lshl_b32 s37, s51, 5
  v_add_u32 v11, s36, v11
  s_add_u32 s36, s36, s37
  s_mul_i32 s37, s3, 1152
  v_add_u32 v9, s36, v9
  v_add_u32 v10, s37, v10
  s_cmp_lg_u32 s3, 5
  s_cbranch_scc1 L_y02
  s_mov_b32 s63, 0
  s_waitcnt vmcnt(5)
  s_branch P_1_c
P_1:
  buffer_load_dwordx3 v[112:114], v2, s[8:11], s44 offen offset:0 sc1
  buffer_load_dwordx3 v[116:118], v2, s[8:11], s44 offen offset:1024 sc1
  buffer_load_dwordx3 v[120:122], v2, s[8:11], s45 offen offset:0 sc1
  buffer_load_dwordx3 v[124:126], v2, s[8:11], s45 offen offset:1024 sc1
  s_waitcnt vmcnt(0)
P_1_c:
  v_cmp_ne_u32 vcc, s24, v114
  v_cmp_ne_u32 s[38:39], s24, v118
  s_or_b64 vcc, vcc, s[38:39]
  v_cmp_ne_u32 s[38:39], s24, v122
  s_or_b64 vcc, vcc, s[38:39]
  v_cmp_ne_u32 s[38:39], s24, v126
  s_or_b64 vcc, vcc, s[38:39]
  s_cbranch_vccz P_1_x
  s_add_u32 s63, s63, 1
  s_cmp_lt_u32 s63, 65536
  s_cbranch_scc1 P_1
P_1_x:
  v_lshlrev_b32 v16, 3, v1
  v_add_f32 v112, 1.0, v112
  ds_write_b64 v16, v[112:113] offset:55808
  v_add_f32 v116, 1.0, v116
  ds_write_b64 v16, v[116:117] offset:56320
  v_add_f32 v120, 1.0, v120
  ds_write_b64 v16, v[120:121] offset:56832
  v_add_f32 v124, 1.0, v124
  ds_write_b64 v16, v[124:125] offset:57344
L_y02:
  s_cmp_lg_u32 s3, 7
  s_cbranch_scc1 L_y1
  s_mov_b32 s63, 0
  s_waitcnt vmcnt(5)
  s_branch P_2_c
P_2:
  buffer_load_dwordx4 v[164:167], v2, s[8:11], s45 offen sc1
  buffer_load_dwordx4 v[168:171], v2, s[8:11], s45 offen offset:1024 sc1
  s_waitcnt vmcnt(0)
P_2_c:
  v_cmp_ne_u32 vcc, s24, v166
  v_cmp_ne_u32 s[38:39], s24, v170
  s_or_b64 vcc, vcc, s[38:39]
  s_cbranch_vccz P_2_x
  s_add_u32 s63, s63, 1
  s_cmp_lt_u32 s63, 65536
  s_cbranch_scc1 P_2
P_2_x:
  v_max_u32 v166, v164, v168
  v_min_u32 v170, v164, v168
  v_max3_u32 v167, v170, v165, v169
  s_nop 0
  v_min_u32_dpp v170, v166, v166 row_ror:8 row_mask:0xf bank_mask:0xf
  v_max_u32_dpp v167, v167, v167 row_ror:8 row_mask:0xf bank_mask:0xf
  v_max_u32_dpp v166, v166, v166 row_ror:8 row_mask:0xf bank_mask:0xf
  v_max_u32 v167, v167, v170
  s_nop 0
  v_min_u32_dpp v170, v166, v166 row_ror:4 row_mask:0xf bank_mask:0xf
  v_max_u32_dpp v167, v167, v167 row_ror:4 row_mask:0xf bank_mask:0xf
  v_max_u32_dpp v166, v166, v166 row_ror:4 row_mask:0xf bank_mask:0xf
  v_max_u32 v167, v167, v170
  s_nop 0
  v_min_u32_dpp v170, v166, v166 row_ror:2 row_mask:0xf bank_mask:0xf
  v_max_u32_dpp v167, v167, v167 row_ror:2 row_mask:0xf bank_mask:0xf
  v_max_u32_dpp v166, v166, v166 row_ror:2 row_mask:0xf bank_mask:0xf
  v_max_u32 v167, v167, v170
  s_nop 0
  v_min_u32_dpp v170, v166, v166 row_ror:1 row_mask:0xf bank_mask:0xf
  v_max_u32_dpp v167, v167, v167 row_ror:1 row_mask:0xf bank_mask:0xf
  v_max_u32_dpp v166, v166, v166 row_ror:1 row_mask:0xf bank_mask:0xf
  v_max_u32 v167, v167, v170
  s_nop 0
  v_min_u32_dpp v170, v166, v166 row_bcast:15 row_mask:0xa bank_mask:0xf
  v_max_u32_dpp v167, v167, v167 row_bcast:15 row_mask:0xa bank_mask:0xf
  v_max_u32_dpp v166, v166, v166 row_bcast:15 row_mask:0xa bank_mask:0xf
  v_max_u32 v167, v167, v170
  s_nop 0
  v_min_u32_dpp v170, v166, v166 row_bcast:31 row_mask:0xc bank_mask:0xf
  v_max_u32_dpp v167, v167, v167 row_bcast:31 row_mask:0xc bank_mask:0xf
  v_max_u32_dpp v166, v166, v166 row_bcast:31 row_mask:0xc bank_mask:0xf
  v_max_u32 v167, v167, v170
  v_readlane_b32 s46, v166, 63
  v_readlane_b32 s47, v167, 63
  s_nop 0
  v_mov_b32 v16, s46
  v_mov_b32 v17, s47
  v_mov_b32 v18, 0
  ds_write_b64 v18, v[16:17] offset:59904
L_y1:
  s_lshl_b32 s37, s40, 6
  s_lshl_b32 s38, s42, 3
  s_add_u32 s37, s37, s38
  s_add_u32 s45, s37, 65536
  v_mov_b32 v18, 0
  s_waitcnt vmcnt(7) lgkmcnt(0)
  s_barrier
  s_cmp_lg_u32 s3, 6
  s_cbranch_scc1 L_y0
  buffer_load_dwordx2 v[164:165], v230, s[8:11], s45 offen sc1
  buffer_load_dwordx2 v[166:167], v231, s[8:11], s45 offen sc1
L_y0:
  buffer_load_dwordx4 v[96:99], v4, s[8:11], s48 offen sc1
  buffer_load_dwordx4 v[100:103], v24, s[8:11], s33 offen sc1
  buffer_load_dwordx4 v[104:107], v4, s[8:11], s32 offen sc1
  buffer_load_dwordx4 v[108:111], v5, s[8:11], s49 offen sc1
  ds_read_b64 v[16:17], v18 offset:59904
  ds_read2_b64 v[112:115], v228 offset1:64
  ds_read2_b64 v[116:119], v229 offset1:64
  ds_read_b128 v[32:35], v236 offset:0
  ds_read_b128 v[36:39], v236 offset:1024
  ds_read_b128 v[40:43], v236 offset:2048
  ds_read_b128 v[44:47], v236 offset:3072
  ds_read_b128 v[48:51], v236 offset:4096
  ds_read_b128 v[52:55], v236 offset:5120
  ds_read_b128 v[56:59], v236 offset:6144
  ds_read_b128 v[60:63], v236 offset:7168
  s_waitcnt lgkmcnt(10)
  v_readfirstlane_b32 s46, v16
  v_readfirstlane_b32 s47, v17
  s_and_b32 s46, s46, 0xffff
  s_and_b32 s47, s47, 0xffff
  s_sub_u32 s46, 0xffff, s46
  s_sub_u32 s47, 0xffff, s47
  v_lshrrev_b32 v16, 11, v172
  v_cmp_eq_u32 s[52:53], s46, v16
  v_cmp_eq_u32 vcc, s47, v16
  s_or_b64 s[52:53], s[52:53], vcc
  v_cndmask_b32_e64 v20, v172, v25, s[52:53]
  v_lshrrev_b32 v16, 11, v173
  v_cmp_eq_u32 s[54:55], s46, v16
  v_cmp_eq_u32 vcc, s47, v16
  s_or_b64 s[54:55], s[54:55], vcc
  v_cndmask_b32_e64 v21, v173, v25, s[54:55]
  v_lshrrev_b32 v16, 11, v174
  v_cmp_eq_u32 s[56:57], s46, v16
  v_cmp_eq_u32 vcc, s47, v16
  s_or_b64 s[56:57], s[56:57], vcc
  v_cndmask_b32_e64 v22, v174, v25, s[56:57]
  v_lshrrev_b32 v16, 11, v175
  v_cmp_eq_u32 s[58:59], s46, v16
  v_cmp_eq_u32 vcc, s47, v16
  s_or_b64 s[58:59], s[58:59], vcc
  v_cndmask_b32_e64 v23, v175, v25, s[58:59]
  s_waitcnt vmcnt(4)
  v_lshlrev_b32 v64, 16, v240
  v_and_b32 v65, 0xffff0000, v240
  s_waitcnt lgkmcnt(9)
  v_pk_fma_f32 v[64:65], v[64:65], v[112:113], v[112:113] op_sel:[0,0,1] op_sel_hi:[1,0,1] neg_lo:[0,0,1] neg_hi:[0,0,1]
  v_lshlrev_b32 v66, 16, v241
  v_and_b32 v67, 0xffff0000, v241
  v_pk_fma_f32 v[66:67], v[66:67], v[112:113], v[112:113] op_sel:[0,0,1] op_sel_hi:[1,0,1] neg_lo:[0,0,1] neg_hi:[0,0,1]
  v_lshlrev_b32 v68, 16, v242
  v_and_b32 v69, 0xffff0000, v242
  v_pk_fma_f32 v[68:69], v[68:69], v[112:113], v[112:113] op_sel:[0,0,1] op_sel_hi:[1,0,1] neg_lo:[0,0,1] neg_hi:[0,0,1]
  v_lshlrev_b32 v70, 16, v243
  v_and_b32 v71, 0xffff0000, v243
  v_pk_fma_f32 v[70:71], v[70:71], v[112:113], v[112:113] op_sel:[0,0,1] op_sel_hi:[1,0,1] neg_lo:[0,0,1] neg_hi:[0,0,1]
  v_lshlrev_b32 v80, 16, v248
  v_and_b32 v81, 0xffff0000, v248
  v_pk_fma_f32 v[80:81], v[80:81], v[114:115], v[114:115] op_sel:[0,0,1] op_sel_hi:[1,0,1] neg_lo:[0,0,1] neg_hi:[0,0,1]
  v_lshlrev_b32 v82, 16, v249
  v_and_b32 v83, 0xffff0000, v249
  v_pk_fma_f32 v[82:83], v[82:83], v[114:115], v[114:115] op_sel:[0,0,1] op_sel_hi:[1,0,1] neg_lo:[0,0,1] neg_hi:[0,0,1]
  v_lshlrev_b32 v84, 16, v250
  v_and_b32 v85, 0xffff0000, v250
  v_pk_fma_f32 v[84:85], v[84:85], v[114:115], v[114:115] op_sel:[0,0,1] op_sel_hi:[1,0,1] neg_lo:[0,0,1] neg_hi:[0,0,1]
  v_lshlrev_b32 v86, 16, v251
  v_and_b32 v87, 0xffff0000, v251
  v_pk_fma_f32 v[86:87], v[86:87], v[114:115], v[114:115] op_sel:[0,0,1] op_sel_hi:[1,0,1] neg_lo:[0,0,1] neg_hi:[0,0,1]
  v_lshlrev_b32 v88, 16, v252
  v_and_b32 v89, 0xffff0000, v252
  s_waitcnt lgkmcnt(8)
  v_pk_fma_f32 v[88:89], v[88:89], v[116:117], v[116:117] op_sel:[0,0,1] op_sel_hi:[1,0,1] neg_lo:[0,0,1] neg_hi:[0,0,1]
  v_lshlrev_b32 v90, 16, v253
  v_and_b32 v91, 0xffff0000, v253
  v_pk_fma_f32 v[90:91], v[90:91], v[116:117], v[116:117] op_sel:[0,0,1] op_sel_hi:[1,0,1] neg_lo:[0,0,1] neg_hi:[0,0,1]
  v_lshlrev_b32 v92, 16, v254
  v_and_b32 v93, 0xffff0000, v254
  v_pk_fma_f32 v[92:93], v[92:93], v[116:117], v[116:117] op_sel:[0,0,1] op_sel_hi:[1,0,1] neg_lo:[0,0,1] neg_hi:[0,0,1]
  v_lshlrev_b32 v94, 16, v255
  v_and_b32 v95, 0xffff0000, v255
  v_pk_fma_f32 v[94:95], v[94:95], v[116:117], v[116:117] op_sel:[0,0,1] op_sel_hi:[1,0,1] neg_lo:[0,0,1] neg_hi:[0,0,1]
  v_lshlrev_b32 v72, 16, v244
  v_and_b32 v73, 0xffff0000, v244
  v_pk_fma_f32 v[72:73], v[72:73], v[118:119], v[118:119] op_sel:[0,0,1] op_sel_hi:[1,0,1] neg_lo:[0,0,1] neg_hi:[0,0,1]
  v_lshlrev_b32 v74, 16, v245
  v_and_b32 v75, 0xffff0000, v245
  v_pk_fma_f32 v[74:75], v[74:75], v[118:119], v[118:119] op_sel:[0,0,1] op_sel_hi:[1,0,1] neg_lo:[0,0,1] neg_hi:[0,0,1]
  v_lshlrev_b32 v76, 16, v246
  v_and_b32 v77, 0xffff0000, v246
  v_pk_fma_f32 v[76:77], v[76:77], v[118:119], v[118:119] op_sel:[0,0,1] op_sel_hi:[1,0,1] neg_lo:[0,0,1] neg_hi:[0,0,1]
  v_lshlrev_b32 v78, 16, v247
  v_and_b32 v79, 0xffff0000, v247
  v_pk_fma_f32 v[78:79], v[78:79], v[118:119], v[118:119] op_sel:[0,0,1] op_sel_hi:[1,0,1] neg_lo:[0,0,1] neg_hi:[0,0,1]
  s_cmp_lg_u32 s3, 6
  s_cbranch_scc1 L_y2
  s_mov_b32 s63, 0
  s_waitcnt vmcnt(4)
  s_branch P_3_c
P_3:
  buffer_load_dwordx2 v[164:165], v230, s[8:11], s45 offen sc1
  buffer_load_dwordx2 v[166:167], v231, s[8:11], s45 offen sc1
  s_waitcnt vmcnt(0)
P_3_c:
  v_cmp_ne_u32 vcc, s24, v165
  v_cmp_ne_u32 s[38:39], s24, v167
  s_or_b64 vcc, vcc, s[38:39]
  s_cbranch_vccz P_3_x
  s_add_u32 s63, s63, 1
  s_cmp_lt_u32 s63, 65536
  s_cbranch_scc1 P_3
P_3_x:
  s_cmp_eq_u32 s41, 0
  s_mov_b32 s38, 0x07060100
  s_cmov_b32 s38, 0x05040100
  v_lshrrev_b32 v17, 16, v164
  v_perm_b32 v16, v166, v164, s38
  s_mov_b64 exec, 1
  v_mov_b32 v164, v16
  v_mov_b32 v166, v17
  s_mov_b64 exec, -1
  v_lshrrev_b32 v18, 7, v230
  v_pk_fma_f16 v164, v166, s50, v164 neg_hi:[0,1,0]
  ds_write_b32 v18, v164 offset:16384
L_y2:
  s_mov_b32 s63, 0
  s_waitcnt vmcnt(0)
  s_branch P_4_c
P_4:
  buffer_load_dwordx4 v[96:99], v4, s[8:11], s48 offen sc1
  buffer_load_dwordx4 v[100:103], v24, s[8:11], s33 offen sc1
  buffer_load_dwordx4 v[104:107], v4, s[8:11], s32 offen sc1
  buffer_load_dwordx4 v[108:111], v5, s[8:11], s49 offen sc1
  s_waitcnt vmcnt(0)
P_4_c:
  v_xor_b32 v96, v232, v96
  v_xor_b32 v97, v233, v97
  v_xor_b32 v98, v234, v98
  v_xor_b32 v99, v235, v99
  v_xor_b32 v100, v232, v100
  v_xor_b32 v101, v233, v101
  v_xor_b32 v102, v234, v102
  v_xor_b32 v103, v235, v103
  v_xor_b32 v104, v232, v104
  v_xor_b32 v105, v233, v105
  v_xor_b32 v106, v234, v106
  v_xor_b32 v107, v235, v107
  v_xor_b32 v108, v232, v108
  v_xor_b32 v109, v233, v109
  v_xor_b32 v110, v234, v110
  v_xor_b32 v111, v235, v111
  v_or3_b32 v16, v96, v97, v98
  v_or3_b32 v16, v16, v99, v100
  v_or3_b32 v16, v16, v101, v102
  v_or3_b32 v16, v16, v103, v104
  v_or3_b32 v16, v16, v105, v106
  v_or3_b32 v16, v16, v107, v108
  v_or3_b32 v16, v16, v109, v110
  v_or_b32 v16, v16, v111
  v_and_b32 v16, 0x30003, v16
  v_cmp_ne_u32 vcc, 0, v16
  s_cbranch_vccz P_4_x
  s_add_u32 s63, s63, 1
  s_cmp_lt_u32 s63, 65536
  s_cbranch_scc1 P_4
P_4_x:
  s_cmp_lg_u32 s3, 0
  s_cbranch_scc1 L_y3
  s_cmp_eq_u32 s41, 0
  s_cselect_b64 s[38:39], 0, -1
  s_mov_b64 exec, 0xffff
  v_cndmask_b32_e64 v16, v100, v102, s[38:39]
  v_cndmask_b32_e64 v17, v101, v103, s[38:39]
  v_mov_b32 v100, v98
  v_mov_b32 v101, v99
  v_mov_b32 v98, v16
  v_mov_b32 v99, v17
  v_mov_b32 v102, 0
  v_mov_b32 v103, 0
  s_mov_b64 exec, -1
L_y3:
  v_pk_fma_f16 v96, v100, s50, v96
  v_pk_fma_f16 v97, v101, s50, v97
  v_pk_fma_f16 v98, v102, s50, v98 neg_lo:[0,1,0] neg_hi:[0,1,0]
  v_pk_fma_f16 v99, v103, s50, v99 neg_lo:[0,1,0] neg_hi:[0,1,0]
  ds_write_b128 v6, v[96:99] offset:0
  v_pk_fma_f16 v104, v108, s50, v104
  v_pk_fma_f16 v105, v109, s50, v105
  v_pk_fma_f16 v106, v110, s50, v106 neg_lo:[0,1,0] neg_hi:[0,1,0]
  v_pk_fma_f16 v107, v111, s50, v107 neg_lo:[0,1,0] neg_hi:[0,1,0]
  ds_write_b128 v6, v[104:107] offset:8192
  v_mov_b32 v18, 0
  s_waitcnt lgkmcnt(0)
  s_barrier
  s_cmp_lg_u32 s51, 0
  s_cbranch_scc1 L_y4
  ds_read_b64_tr_b16 v[132:133], v7 offset:0
  ds_read_b64_tr_b16 v[134:135], v7 offset:512
  ds_read_b64_tr_b16 v[136:137], v7 offset:2048
  ds_read_b64_tr_b16 v[138:139], v7 offset:2560
  ds_read_b64_tr_b16 v[140:141], v7 offset:4096
  ds_read_b64_tr_b16 v[142:143], v7 offset:4608
  ds_read_b64_tr_b16 v[144:145], v7 offset:6144
  ds_read_b64_tr_b16 v[146:147], v7 offset:6656
  ds_read_b64_tr_b16 v[148:149], v7 offset:8192
  ds_read_b64_tr_b16 v[150:151], v7 offset:8704
  ds_read_b64_tr_b16 v[152:153], v7 offset:10240
  ds_read_b64_tr_b16 v[154:155], v7 offset:10752
  ds_read_b64_tr_b16 v[156:157], v7 offset:12288
  ds_read_b64_tr_b16 v[158:159], v7 offset:12800
  s_waitcnt lgkmcnt(12)
  v_mfma_f32_32x32x16_f16 v[208:223], v[132:135], v[32:35], 0
  ds_read_b64_tr_b16 v[160:161], v7 offset:14336
  ds_read_b64_tr_b16 v[162:163], v7 offset:14848
  s_waitcnt lgkmcnt(12)
  v_mfma_f32_32x32x16_f16 v[208:223], v[136:139], v[36:39], v[208:223]
  s_waitcnt lgkmcnt(10)
  v_mfma_f32_32x32x16_f16 v[208:223], v[140:143], v[40:43], v[208:223]
  s_waitcnt lgkmcnt(8)
  v_mfma_f32_32x32x16_f16 v[208:223], v[144:147], v[44:47], v[208:223]
  s_waitcnt lgkmcnt(6)
  v_mfma_f32_32x32x16_f16 v[208:223], v[148:151], v[48:51], v[208:223]
  s_waitcnt lgkmcnt(4)
  v_mfma_f32_32x32x16_f16 v[208:223], v[152:155], v[52:55], v[208:223]
  s_waitcnt lgkmcnt(2)
  v_mfma_f32_32x32x16_f16 v[208:223], v[156:159], v[56:59], v[208:223]
  s_waitcnt lgkmcnt(0)
  v_mfma_f32_32x32x16_f16 v[208:223], v[160:163], v[60:63], v[208:223]
  s_nop 11
  v_cvt_pk_f16_f32 v112, v221, v208
  v_cvt_pk_f16_f32 v113, v212, v216
  v_cvt_pk_f16_f32 v114, v220, v209
  v_cvt_pk_f16_f32 v115, v213, v217
  ds_write_b128 v9, v[112:115] offset:16896
  v_cvt_pk_f16_f32 v116, v210, v214
  v_cvt_pk_f16_f32 v117, v218, v222
  v_cvt_pk_f16_f32 v118, v211, v215
  v_cvt_pk_f16_f32 v119, v219, v223
  ds_write_b128 v9, v[116:119] offset:16912
  s_branch L_y5
L_y4:
  ds_read_b64_tr_b16 v[132:133], v7 offset:0
  ds_read_b64_tr_b16 v[134:135], v7 offset:512
  ds_read_b128 v[176:179], v8 offset:16384
  ds_read_b64_tr_b16 v[136:137], v7 offset:2048
  ds_read_b64_tr_b16 v[138:139], v7 offset:2560
  ds_read_b128 v[180:183], v8 offset:16416
  ds_read_b64_tr_b16 v[140:141], v7 offset:4096
  ds_read_b64_tr_b16 v[142:143], v7 offset:4608
  ds_read_b128 v[184:187], v8 offset:16448
  ds_read_b64_tr_b16 v[144:145], v7 offset:6144
  ds_read_b64_tr_b16 v[146:147], v7 offset:6656
  ds_read_b128 v[188:191], v8 offset:16480
  s_waitcnt lgkmcnt(10)
  v_mfma_f32_32x32x16_f16 v[208:223], v[132:135], v[32:35], 0
  ds_read_b64_tr_b16 v[148:149], v7 offset:8192
  ds_read_b64_tr_b16 v[150:151], v7 offset:8704
  ds_read_b128 v[192:195], v8 offset:16512
  s_waitcnt lgkmcnt(10)
  v_mfma_f32_32x32x16_f16 v[208:223], v[136:139], v[36:39], v[208:223]
  ds_read_b64_tr_b16 v[152:153], v7 offset:10240
  ds_read_b64_tr_b16 v[154:155], v7 offset:10752
  ds_read_b128 v[196:199], v8 offset:16544
  v_pk_mul_f16 v224, v32, v176
  v_pk_mul_f16 v225, v33, v177
  v_pk_mul_f16 v226, v34, v178
  v_pk_mul_f16 v227, v35, v179
  s_waitcnt lgkmcnt(10)
  v_mfma_f32_32x32x16_f16 v[208:223], v[140:143], v[40:43], v[208:223]
  ds_read_b64_tr_b16 v[156:157], v7 offset:12288
  ds_read_b64_tr_b16 v[158:159], v7 offset:12800
  ds_read_b128 v[200:203], v8 offset:16576
  v_pk_fma_f16 v224, v36, v180, v224
  v_pk_fma_f16 v225, v37, v181, v225
  v_pk_fma_f16 v226, v38, v182, v226
  v_pk_fma_f16 v227, v39, v183, v227
  s_waitcnt lgkmcnt(10)
  v_mfma_f32_32x32x16_f16 v[208:223], v[144:147], v[44:47], v[208:223]
  ds_read_b64_tr_b16 v[160:161], v7 offset:14336
  ds_read_b64_tr_b16 v[162:163], v7 offset:14848
  ds_read_b128 v[204:207], v8 offset:16608
  v_pk_fma_f16 v224, v40, v184, v224
  v_pk_fma_f16 v225, v41, v185, v225
  v_pk_fma_f16 v226, v42, v186, v226
  v_pk_fma_f16 v227, v43, v187, v227
  s_waitcnt lgkmcnt(10)
  v_mfma_f32_32x32x16_f16 v[208:223], v[148:151], v[48:51], v[208:223]
  v_pk_fma_f16 v224, v44, v188, v224
  v_pk_fma_f16 v225, v45, v189, v225
  v_pk_fma_f16 v226, v46, v190, v226
  v_pk_fma_f16 v227, v47, v191, v227
  s_waitcnt lgkmcnt(7)
  v_mfma_f32_32x32x16_f16 v[208:223], v[152:155], v[52:55], v[208:223]
  v_pk_fma_f16 v224, v48, v192, v224
  v_pk_fma_f16 v225, v49, v193, v225
  v_pk_fma_f16 v226, v50, v194, v226
  v_pk_fma_f16 v227, v51, v195, v227
  s_waitcnt lgkmcnt(4)
  v_mfma_f32_32x32x16_f16 v[208:223], v[156:159], v[56:59], v[208:223]
  v_pk_fma_f16 v224, v52, v196, v224
  v_pk_fma_f16 v225, v53, v197, v225
  v_pk_fma_f16 v226, v54, v198, v226
  v_pk_fma_f16 v227, v55, v199, v227
  s_waitcnt lgkmcnt(1)
  v_mfma_f32_32x32x16_f16 v[208:223], v[160:163], v[60:63], v[208:223]
  v_pk_fma_f16 v224, v56, v200, v224
  v_pk_fma_f16 v225, v57, v201, v225
  v_pk_fma_f16 v226, v58, v202, v226
  v_pk_fma_f16 v227, v59, v203, v227
  s_waitcnt lgkmcnt(0)
  v_pk_fma_f16 v224, v60, v204, v224
  v_pk_fma_f16 v225, v61, v205, v225
  v_pk_fma_f16 v226, v62, v206, v226
  v_pk_fma_f16 v227, v63, v207, v227
  s_mov_b32 s37, 0x3c003c00
  v_pk_add_f16 v224, v224, v225
  v_pk_add_f16 v226, v226, v227
  v_dot2c_f32_f16 v18, s37, v224
  v_dot2c_f32_f16 v18, s37, v226
  s_nop 2
  v_mov_b32 v19, v18
  s_nop 1
  v_permlane32_swap_b32 v18, v19
  v_add_f32 v18, v18, v19
  v_cvt_f16_f32 v18, v18
  ds_write_b16 v11, v18 offset:16896
  v_cvt_pk_f16_f32 v112, v221, v223
  v_cvt_pk_f16_f32 v113, v219, v215
  v_cvt_pk_f16_f32 v114, v211, v222
  v_cvt_pk_f16_f32 v115, v218, v214
  ds_write_b128 v9, v[112:115] offset:16896
  v_cvt_pk_f16_f32 v116, v210, v217
  v_cvt_pk_f16_f32 v117, v213, v209
  v_cvt_pk_f16_f32 v118, v220, v216
  v_cvt_pk_f16_f32 v119, v212, v208
  ds_write_b128 v9, v[116:119] offset:16912
L_y5:
  s_mov_b32 s37, 0x42800000
  s_or_b64 s[60:61], s[52:53], s[54:55]
  s_or_b64 s[38:39], s[56:57], s[58:59]
  s_waitcnt lgkmcnt(0)
  s_barrier
  ds_read_b128 v[96:99], v10 offset:16896
  ds_read_u16 v100, v10 offset:16912
  ds_read_b128 v[104:107], v10 offset:26112
  ds_read_u16 v108, v10 offset:26128
  s_or_b64 s[60:61], s[60:61], s[38:39]
  s_cbranch_scc1 L_sel
  s_waitcnt lgkmcnt(3)
  v_fma_mix_f32 v64, v96, s37, v64 op_sel:[0,0,0] op_sel_hi:[1,0,0]
  v_fma_mix_f32 v65, v96, s37, v65 op_sel:[1,0,0] op_sel_hi:[1,0,0]
  v_fma_mix_f32 v66, v97, s37, v66 op_sel:[0,0,0] op_sel_hi:[1,0,0]
  v_fma_mix_f32 v67, v97, s37, v67 op_sel:[1,0,0] op_sel_hi:[1,0,0]
  v_fma_mix_f32 v68, v98, s37, v68 op_sel:[0,0,0] op_sel_hi:[1,0,0]
  v_fma_mix_f32 v69, v98, s37, v69 op_sel:[1,0,0] op_sel_hi:[1,0,0]
  v_fma_mix_f32 v70, v99, s37, v70 op_sel:[0,0,0] op_sel_hi:[1,0,0]
  v_fma_mix_f32 v71, v99, s37, v71 op_sel:[1,0,0] op_sel_hi:[1,0,0]
  v_cvt_pk_bf16_f32 v132, v64, v65
  v_cvt_pk_bf16_f32 v133, v66, v67
  v_cvt_pk_bf16_f32 v134, v68, v69
  v_cvt_pk_bf16_f32 v135, v70, v71
  buffer_store_dwordx4 v[132:135], v20, s[12:15], 0 offen sc0 sc1
  s_waitcnt lgkmcnt(2)
  v_fma_mix_f32 v72, v100, s37, v72 op_sel:[0,0,0] op_sel_hi:[1,0,0]
  v_fma_mix_f32 v73, v99, s37, v73 op_sel:[1,0,0] op_sel_hi:[1,0,0]
  v_fma_mix_f32 v74, v99, s37, v74 op_sel:[0,0,0] op_sel_hi:[1,0,0]
  v_fma_mix_f32 v75, v98, s37, v75 op_sel:[1,0,0] op_sel_hi:[1,0,0]
  v_fma_mix_f32 v76, v98, s37, v76 op_sel:[0,0,0] op_sel_hi:[1,0,0]
  v_fma_mix_f32 v77, v97, s37, v77 op_sel:[1,0,0] op_sel_hi:[1,0,0]
  v_fma_mix_f32 v78, v97, s37, v78 op_sel:[0,0,0] op_sel_hi:[1,0,0]
  v_fma_mix_f32 v79, v96, s37, v79 op_sel:[1,0,0] op_sel_hi:[1,0,0]
  v_cvt_pk_bf16_f32 v136, v72, v73
  v_cvt_pk_bf16_f32 v137, v74, v75
  v_cvt_pk_bf16_f32 v138, v76, v77
  v_cvt_pk_bf16_f32 v139, v78, v79
  buffer_store_dwordx4 v[136:139], v21, s[12:15], 0 offen sc0 sc1
  s_waitcnt lgkmcnt(1)
  v_fma_mix_f32 v80, v104, s37, v80 op_sel:[0,0,0] op_sel_hi:[1,0,0]
  v_fma_mix_f32 v81, v104, s37, v81 op_sel:[1,0,0] op_sel_hi:[1,0,0]
  v_fma_mix_f32 v82, v105, s37, v82 op_sel:[0,0,0] op_sel_hi:[1,0,0]
  v_fma_mix_f32 v83, v105, s37, v83 op_sel:[1,0,0] op_sel_hi:[1,0,0]
  v_fma_mix_f32 v84, v106, s37, v84 op_sel:[0,0,0] op_sel_hi:[1,0,0]
  v_fma_mix_f32 v85, v106, s37, v85 op_sel:[1,0,0] op_sel_hi:[1,0,0]
  v_fma_mix_f32 v86, v107, s37, v86 op_sel:[0,0,0] op_sel_hi:[1,0,0]
  v_fma_mix_f32 v87, v107, s37, v87 op_sel:[1,0,0] op_sel_hi:[1,0,0]
  v_cvt_pk_bf16_f32 v140, v80, v81
  v_cvt_pk_bf16_f32 v141, v82, v83
  v_cvt_pk_bf16_f32 v142, v84, v85
  v_cvt_pk_bf16_f32 v143, v86, v87
  buffer_store_dwordx4 v[140:143], v22, s[12:15], 0 offen sc0 sc1
  s_waitcnt lgkmcnt(0)
  v_fma_mix_f32 v88, v108, s37, v88 op_sel:[0,0,0] op_sel_hi:[1,0,0]
  v_fma_mix_f32 v89, v107, s37, v89 op_sel:[1,0,0] op_sel_hi:[1,0,0]
  v_fma_mix_f32 v90, v107, s37, v90 op_sel:[0,0,0] op_sel_hi:[1,0,0]
  v_fma_mix_f32 v91, v106, s37, v91 op_sel:[1,0,0] op_sel_hi:[1,0,0]
  v_fma_mix_f32 v92, v106, s37, v92 op_sel:[0,0,0] op_sel_hi:[1,0,0]
  v_fma_mix_f32 v93, v105, s37, v93 op_sel:[1,0,0] op_sel_hi:[1,0,0]
  v_fma_mix_f32 v94, v105, s37, v94 op_sel:[0,0,0] op_sel_hi:[1,0,0]
  v_fma_mix_f32 v95, v104, s37, v95 op_sel:[1,0,0] op_sel_hi:[1,0,0]
  v_cvt_pk_bf16_f32 v144, v88, v89
  v_cvt_pk_bf16_f32 v145, v90, v91
  v_cvt_pk_bf16_f32 v146, v92, v93
  v_cvt_pk_bf16_f32 v147, v94, v95
  buffer_store_dwordx4 v[144:147], v23, s[12:15], 0 offen sc0 sc1
  s_branch L_fin
L_sel:
  s_waitcnt lgkmcnt(3)
  v_fma_mix_f32 v64, v96, s37, v64 op_sel:[0,0,0] op_sel_hi:[1,0,0]
  v_fma_mix_f32 v65, v96, s37, v65 op_sel:[1,0,0] op_sel_hi:[1,0,0]
  v_fma_mix_f32 v66, v97, s37, v66 op_sel:[0,0,0] op_sel_hi:[1,0,0]
  v_fma_mix_f32 v67, v97, s37, v67 op_sel:[1,0,0] op_sel_hi:[1,0,0]
  v_fma_mix_f32 v68, v98, s37, v68 op_sel:[0,0,0] op_sel_hi:[1,0,0]
  v_fma_mix_f32 v69, v98, s37, v69 op_sel:[1,0,0] op_sel_hi:[1,0,0]
  v_fma_mix_f32 v70, v99, s37, v70 op_sel:[0,0,0] op_sel_hi:[1,0,0]
  v_fma_mix_f32 v71, v99, s37, v71 op_sel:[1,0,0] op_sel_hi:[1,0,0]
  s_cmp_eq_u64 s[52:53], 0
  s_cbranch_scc1 L_selx0
  s_mov_b64 exec, s[52:53]
  v_lshrrev_b32 v16, 11, v172
  v_and_b32 v17, 2047, v172
  v_cmp_eq_u32 vcc, s47, v16
  v_lshlrev_b32 v17, 1, v17
  v_add_u32 v16, 4096, v17
  v_mov_b32 v18, 0xffffff00
  v_cndmask_b32_e64 v16, v17, v16, vcc
  s_mov_b32 s38, 4096
  v_and_or_b32 v176, v64, v18, s29
  v_and_or_b32 v177, v65, v18, s29
  v_and_or_b32 v178, v66, v18, s29
  v_and_or_b32 v179, v67, v18, s29
  v_and_or_b32 v180, v68, v18, s29
  v_and_or_b32 v181, v69, v18, s29
  v_and_or_b32 v182, v70, v18, s29
  v_and_or_b32 v183, v71, v18, s29
  buffer_store_dwordx4 v[176:179], v16, s[8:11], s38 offen sc1
  buffer_store_dwordx4 v[180:183], v16, s[8:11], s38 offen offset:16 sc1
  s_mov_b64 exec, -1
L_selx0:
  v_cvt_pk_bf16_f32 v132, v64, v65
  v_cvt_pk_bf16_f32 v133, v66, v67
  v_cvt_pk_bf16_f32 v134, v68, v69
  v_cvt_pk_bf16_f32 v135, v70, v71
  buffer_store_dwordx4 v[132:135], v20, s[12:15], 0 offen sc0 sc1
  s_waitcnt lgkmcnt(2)
  v_fma_mix_f32 v72, v100, s37, v72 op_sel:[0,0,0] op_sel_hi:[1,0,0]
  v_fma_mix_f32 v73, v99, s37, v73 op_sel:[1,0,0] op_sel_hi:[1,0,0]
  v_fma_mix_f32 v74, v99, s37, v74 op_sel:[0,0,0] op_sel_hi:[1,0,0]
  v_fma_mix_f32 v75, v98, s37, v75 op_sel:[1,0,0] op_sel_hi:[1,0,0]
  v_fma_mix_f32 v76, v98, s37, v76 op_sel:[0,0,0] op_sel_hi:[1,0,0]
  v_fma_mix_f32 v77, v97, s37, v77 op_sel:[1,0,0] op_sel_hi:[1,0,0]
  v_fma_mix_f32 v78, v97, s37, v78 op_sel:[0,0,0] op_sel_hi:[1,0,0]
  v_fma_mix_f32 v79, v96, s37, v79 op_sel:[1,0,0] op_sel_hi:[1,0,0]
  s_cmp_eq_u64 s[54:55], 0
  s_cbranch_scc1 L_selx1
  s_mov_b64 exec, s[54:55]
  v_lshrrev_b32 v16, 11, v173
  v_and_b32 v17, 2047, v173
  v_cmp_eq_u32 vcc, s47, v16
  v_lshlrev_b32 v17, 1, v17
  v_add_u32 v16, 4096, v17
  v_mov_b32 v18, 0xffffff00
  v_cndmask_b32_e64 v16, v17, v16, vcc
  s_mov_b32 s38, 4096
  v_and_or_b32 v176, v72, v18, s29
  v_and_or_b32 v177, v73, v18, s29
  v_and_or_b32 v178, v74, v18, s29
  v_and_or_b32 v179, v75, v18, s29
  v_and_or_b32 v180, v76, v18, s29
  v_and_or_b32 v181, v77, v18, s29
  v_and_or_b32 v182, v78, v18, s29
  v_and_or_b32 v183, v79, v18, s29
  buffer_store_dwordx4 v[176:179], v16, s[8:11], s38 offen sc1
  buffer_store_dwordx4 v[180:183], v16, s[8:11], s38 offen offset:16 sc1
  s_mov_b64 exec, -1
L_selx1:
  v_cvt_pk_bf16_f32 v136, v72, v73
  v_cvt_pk_bf16_f32 v137, v74, v75
  v_cvt_pk_bf16_f32 v138, v76, v77
  v_cvt_pk_bf16_f32 v139, v78, v79
  buffer_store_dwordx4 v[136:139], v21, s[12:15], 0 offen sc0 sc1
  s_waitcnt lgkmcnt(1)
  v_fma_mix_f32 v80, v104, s37, v80 op_sel:[0,0,0] op_sel_hi:[1,0,0]
  v_fma_mix_f32 v81, v104, s37, v81 op_sel:[1,0,0] op_sel_hi:[1,0,0]
  v_fma_mix_f32 v82, v105, s37, v82 op_sel:[0,0,0] op_sel_hi:[1,0,0]
  v_fma_mix_f32 v83, v105, s37, v83 op_sel:[1,0,0] op_sel_hi:[1,0,0]
  v_fma_mix_f32 v84, v106, s37, v84 op_sel:[0,0,0] op_sel_hi:[1,0,0]
  v_fma_mix_f32 v85, v106, s37, v85 op_sel:[1,0,0] op_sel_hi:[1,0,0]
  v_fma_mix_f32 v86, v107, s37, v86 op_sel:[0,0,0] op_sel_hi:[1,0,0]
  v_fma_mix_f32 v87, v107, s37, v87 op_sel:[1,0,0] op_sel_hi:[1,0,0]
  s_cmp_eq_u64 s[56:57], 0
  s_cbranch_scc1 L_selx2
  s_mov_b64 exec, s[56:57]
  v_lshrrev_b32 v16, 11, v174
  v_and_b32 v17, 2047, v174
  v_cmp_eq_u32 vcc, s47, v16
  v_lshlrev_b32 v17, 1, v17
  v_add_u32 v16, 4096, v17
  v_mov_b32 v18, 0xffffff00
  v_cndmask_b32_e64 v16, v17, v16, vcc
  s_mov_b32 s38, 4096
  v_and_or_b32 v176, v80, v18, s29
  v_and_or_b32 v177, v81, v18, s29
  v_and_or_b32 v178, v82, v18, s29
  v_and_or_b32 v179, v83, v18, s29
  v_and_or_b32 v180, v84, v18, s29
  v_and_or_b32 v181, v85, v18, s29
  v_and_or_b32 v182, v86, v18, s29
  v_and_or_b32 v183, v87, v18, s29
  buffer_store_dwordx4 v[176:179], v16, s[8:11], s38 offen sc1
  buffer_store_dwordx4 v[180:183], v16, s[8:11], s38 offen offset:16 sc1
  s_mov_b64 exec, -1
L_selx2:
  v_cvt_pk_bf16_f32 v140, v80, v81
  v_cvt_pk_bf16_f32 v141, v82, v83
  v_cvt_pk_bf16_f32 v142, v84, v85
  v_cvt_pk_bf16_f32 v143, v86, v87
  buffer_store_dwordx4 v[140:143], v22, s[12:15], 0 offen sc0 sc1
  s_waitcnt lgkmcnt(0)
  v_fma_mix_f32 v88, v108, s37, v88 op_sel:[0,0,0] op_sel_hi:[1,0,0]
  v_fma_mix_f32 v89, v107, s37, v89 op_sel:[1,0,0] op_sel_hi:[1,0,0]
  v_fma_mix_f32 v90, v107, s37, v90 op_sel:[0,0,0] op_sel_hi:[1,0,0]
  v_fma_mix_f32 v91, v106, s37, v91 op_sel:[1,0,0] op_sel_hi:[1,0,0]
  v_fma_mix_f32 v92, v106, s37, v92 op_sel:[0,0,0] op_sel_hi:[1,0,0]
  v_fma_mix_f32 v93, v105, s37, v93 op_sel:[1,0,0] op_sel_hi:[1,0,0]
  v_fma_mix_f32 v94, v105, s37, v94 op_sel:[0,0,0] op_sel_hi:[1,0,0]
  v_fma_mix_f32 v95, v104, s37, v95 op_sel:[1,0,0] op_sel_hi:[1,0,0]
  s_cmp_eq_u64 s[58:59], 0
  s_cbranch_scc1 L_selx3
  s_mov_b64 exec, s[58:59]
  v_lshrrev_b32 v16, 11, v175
  v_and_b32 v17, 2047, v175
  v_cmp_eq_u32 vcc, s47, v16
  v_lshlrev_b32 v17, 1, v17
  v_add_u32 v16, 4096, v17
  v_mov_b32 v18, 0xffffff00
  v_cndmask_b32_e64 v16, v17, v16, vcc
  s_mov_b32 s38, 4096
  v_and_or_b32 v176, v88, v18, s29
  v_and_or_b32 v177, v89, v18, s29
  v_and_or_b32 v178, v90, v18, s29
  v_and_or_b32 v179, v91, v18, s29
  v_and_or_b32 v180, v92, v18, s29
  v_and_or_b32 v181, v93, v18, s29
  v_and_or_b32 v182, v94, v18, s29
  v_and_or_b32 v183, v95, v18, s29
  buffer_store_dwordx4 v[176:179], v16, s[8:11], s38 offen sc1
  buffer_store_dwordx4 v[180:183], v16, s[8:11], s38 offen offset:16 sc1
  s_mov_b64 exec, -1
L_selx3:
  v_cvt_pk_bf16_f32 v144, v88, v89
  v_cvt_pk_bf16_f32 v145, v90, v91
  v_cvt_pk_bf16_f32 v146, v92, v93
  v_cvt_pk_bf16_f32 v147, v94, v95
  buffer_store_dwordx4 v[144:147], v23, s[12:15], 0 offen sc0 sc1
  s_branch L_fin
L_job2:
  s_mov_b32 s62, 1
  s_mov_b32 s56, 0
  s_mov_b32 s58, 0
  s_mov_b32 s57, s60
  s_mov_b32 s59, s61
  v_subrev_u32 v12, 2176, v12
  v_subrev_u32 v13, 2176, v13
  v_subrev_u32 v14, 2176, v14
  v_subrev_u32 v15, 2176, v15
  s_branch L_job
L_cw:
  s_setprio 2
  s_waitcnt lgkmcnt(12)
  v_pk_add_f32 v[28:29], v[28:29], v[30:31]
  v_pk_add_f32 v[68:69], v[68:69], v[70:71]
  v_pk_add_f32 v[28:29], v[28:29], v[68:69]
  v_add_f32 v68, v28, v29
  v_add_f32 v31, v28, v29
  s_nop 1
  v_permlane32_swap_b32 v68, v31
  v_mov_b32 v69, v31
  v_mul_f32 v29, 0x3a800000, v68
  v_mul_f32 v31, 0x3a800000, v31
  v_fma_f32 v31, -v29, v29, v31
  v_max_f32 v31, 0, v31
  v_cvt_pk_bf16_f32 v31, v31, v31
  v_and_b32 v31, 0xffff0000, v31
  v_add_f32 v31, 0x3727c5ac, v31
  v_cvt_pk_bf16_f32 v31, v31, v31
  v_and_b32 v31, 0xffff0000, v31
  v_sqrt_f32 v31, v31
  v_mov_b32 v18, s24
  v_cvt_pk_bf16_f32 v19, v29, v31
  v_and_b32 v16, 0xffff0000, v19
  v_rcp_f32 v16, v16
  v_lshlrev_b32 v17, 16, v19
  v_mul_f32 v17, v17, v16
  v_readlane_b32 s56, v16, s34
  v_readlane_b32 s57, v16, s35
  v_readlane_b32 s58, v17, s34
  v_readlane_b32 s59, v17, s35
  v_permlane16_swap_b32 v28, v68
  v_permlane16_swap_b32 v30, v69
  v_lshlrev_b32 v29, 16, v19
  v_fma_f32 v28, -v29, v30, v28
  v_mul_f32 v28, v28, v16
  v_cvt_pk_bf16_f32 v28, v28, v28
  s_lshl_b32 s37, s2, 4
  v_ashrrev_i32 v29, 31, v28
  s_add_u32 s37, s37, 98304
  v_or_b32 v29, 0x80000000, v29
  v_xor_b32 v28, v28, v29
  v_and_b32 v28, 0xffff0000, v28
  v_or_b32 v28, v28, v9
  v_mov_b32 v30, v18
  v_lshlrev_b32 v9, 11, v1
  v_min_u32_dpp v29, v28, v28 row_ror:8 row_mask:0xf bank_mask:0xf
  v_max_u32_dpp v28, v28, v28 row_ror:8 row_mask:0xf bank_mask:0xf
  s_nop 1
  v_min_u32_dpp v31, v28, v28 row_ror:4 row_mask:0xf bank_mask:0xf
  v_max_u32_dpp v29, v29, v29 row_ror:4 row_mask:0xf bank_mask:0xf
  v_max_u32_dpp v28, v28, v28 row_ror:4 row_mask:0xf bank_mask:0xf
  v_max_u32 v29, v29, v31
  s_nop 0
  v_min_u32_dpp v31, v28, v28 row_ror:2 row_mask:0xf bank_mask:0xf
  v_max_u32_dpp v29, v29, v29 row_ror:2 row_mask:0xf bank_mask:0xf
  v_max_u32_dpp v28, v28, v28 row_ror:2 row_mask:0xf bank_mask:0xf
  v_max_u32 v29, v29, v31
  s_nop 0
  v_min_u32_dpp v31, v28, v28 row_ror:1 row_mask:0xf bank_mask:0xf
  v_max_u32_dpp v29, v29, v29 row_ror:1 row_mask:0xf bank_mask:0xf
  v_max_u32_dpp v28, v28, v28 row_ror:1 row_mask:0xf bank_mask:0xf
  v_max_u32 v29, v29, v31
  s_mov_b64 exec, 0xff0000
  buffer_store_dwordx4 v[28:31], v9, s[8:11], s37 offen sc1
  s_mov_b64 exec, s[54:55]
  s_mov_b32 s37, 196608
  buffer_store_dwordx4 v[16:19], v10, s[8:11], s37 offen sc1
  s_mov_b64 exec, -1
  s_setprio 0
  v_mfma_f32_32x32x16_bf16 v[192:207], v[132:135], v[120:123], 0
  v_mfma_f32_32x32x16_bf16 v[192:207], v[136:139], v[124:127], v[192:207]
  v_mfma_f32_32x32x16_bf16 v[208:223], v[140:143], v[112:115], 0
  v_mfma_f32_32x32x16_bf16 v[208:223], v[144:147], v[116:119], v[208:223]
  v_mfma_f32_32x32x16_bf16 v[224:239], v[140:143], v[120:123], 0
  v_mfma_f32_32x32x16_bf16 v[224:239], v[144:147], v[124:127], v[224:239]
  s_branch L_nocand
L_ffn1:
  s_mov_b32 s6, 0x400000
  s_mov_b32 s10, 8388608
  s_mov_b32 s14, 0x400000
  s_mov_b32 s15, 0x20000
  s_mov_b32 s42, 7340032
  s_mov_b32 s43, 0x20000
  s_lshl_b32 s44, s30, 16
  v_mov_b32 v9, 0xffffff00
  v_bfe_u32 v16, v1, 2, 4
  v_and_b32 v17, 3, v1
  v_mul_u32_u24 v18, 2080, v16
  s_lshl_b32 s38, s3, 8
  v_lshl_add_u32 v11, v17, 3, s38
  v_add_u32 v11, v11, v18
  v_add_u32 v3, 118784, v11
  s_mul_i32 s37, s30, 4682
  s_lshr_b32 s37, s37, 16
  s_mul_i32 s38, s37, 14
  s_sub_u32 s38, s30, s38
  s_mul_i32 s37, s37, 114688
  s_lshl_b32 s38, s38, 9
  s_add_u32 s37, s37, s38
  s_add_u32 s48, s37, 3145728
  v_lshrrev_b32 v18, 5, v0
  v_and_b32 v19, 31, v0
  v_mul_u32_u24 v18, 7168, v18
  v_lshl_add_u32 v48, v19, 4, v18
  s_mov_b32 s36, 152384
  v_lshl_add_u32 v49, v0, 3, s36
  v_lshl_add_u32 v50, v1, 3, s36
  v_lshl_add_u32 v51, v0, 1, s36
  v_and_b32 v18, 1, v1
  v_and_b32 v19, 48, v1
  v_lshl_add_u32 v20, v18, 6, v19
  s_lshl_b32 s38, s3, 7
  s_add_u32 s38, s38, s36
  v_add_u32 v52, s38, v20
  s_lshl_b32 s38, s30, 13
  s_lshl_b32 s39, s3, 10
  s_add_u32 s38, s38, s39
  s_add_u32 s49, s38, 4194304
  v_lshrrev_b32 v20, 3, v0
  v_and_b32 v21, 7, v0
  v_lshlrev_b32 v20, 13, v20
  v_lshl_add_u32 v53, v21, 4, v20
  s_and_b32 s52, s30, 63
  s_lshl_b32 s50, s52, 7
  s_add_u32 s50, s50, 4194304
  s_add_u32 s51, s50, 524288
  s_mov_b32 s53, 4096
  v_lshl_add_u32 v54, v0, 2, s36
  v_lshl_add_u32 v55, v1, 2, s36
  s_and_b32 s45, s2, 7
  s_lshl_b32 s45, s45, 11
  s_add_u32 s45, s45, 131072
  s_waitcnt lgkmcnt(0)
  s_add_u32 s24, s24, 1
  s_and_b32 s29, s24, 0xff
  v_mov_b32 v10, s29
  v_mov_b32 v8, 0x40000000
  v_mov_b32 v7, 0
  s_not_b32 s36, s24
  v_mov_b32 v60, s36
  v_mov_b32 v61, s36
  v_mov_b32 v62, s36
  v_mov_b32 v63, s36
  s_cmp_lg_u32 s3, 7
  s_cbranch_scc1 L_f1
  s_waitcnt vmcnt(2)
  buffer_load_dwordx4 v[32:35], v2, s[8:11], s45 offen sc1
  buffer_load_dwordx4 v[36:39], v2, s[8:11], s45 offen offset:1024 sc1
  buffer_store_dwordx4 v[60:63], v2, s[8:11], s49 offen sc1
  s_and_b32 s36, s52, 62
  s_lshl_b32 s36, s36, 6
  s_add_u32 s36, s36, s53
  buffer_load_dword v59, off, s[8:11], s36 sc1
  s_add_u32 s36, s36, 4096
  buffer_load_dword v59, off, s[8:11], s36 sc1
  s_waitcnt vmcnt(5)
  s_barrier
  s_mov_b32 s63, 0
  s_waitcnt vmcnt(3)
  s_branch P_5_c
P_5:
  buffer_load_dwordx4 v[32:35], v2, s[8:11], s45 offen sc1
  buffer_load_dwordx4 v[36:39], v2, s[8:11], s45 offen offset:1024 sc1
  s_waitcnt vmcnt(0)
P_5_c:
  v_cmp_ne_u32 vcc, s24, v34
  v_cmp_ne_u32 s[38:39], s24, v38
  s_or_b64 vcc, vcc, s[38:39]
  s_cbranch_vccz P_5_x
  s_add_u32 s63, s63, 1
  s_cmp_lt_u32 s63, 65536
  s_cbranch_scc1 P_5
P_5_x:
  v_max_u32 v34, v32, v36
  v_min_u32 v38, v32, v36
  v_max3_u32 v35, v38, v33, v37
  s_nop 0
  v_min_u32_dpp v38, v34, v34 row_ror:8 row_mask:0xf bank_mask:0xf
  v_max_u32_dpp v35, v35, v35 row_ror:8 row_mask:0xf bank_mask:0xf
  v_max_u32_dpp v34, v34, v34 row_ror:8 row_mask:0xf bank_mask:0xf
  v_max_u32 v35, v35, v38
  s_nop 0
  v_min_u32_dpp v38, v34, v34 row_ror:4 row_mask:0xf bank_mask:0xf
  v_max_u32_dpp v35, v35, v35 row_ror:4 row_mask:0xf bank_mask:0xf
  v_max_u32_dpp v34, v34, v34 row_ror:4 row_mask:0xf bank_mask:0xf
  v_max_u32 v35, v35, v38
  s_nop 0
  v_min_u32_dpp v38, v34, v34 row_ror:2 row_mask:0xf bank_mask:0xf
  v_max_u32_dpp v35, v35, v35 row_ror:2 row_mask:0xf bank_mask:0xf
  v_max_u32_dpp v34, v34, v34 row_ror:2 row_mask:0xf bank_mask:0xf
  v_max_u32 v35, v35, v38
  s_nop 0
  v_min_u32_dpp v38, v34, v34 row_ror:1 row_mask:0xf bank_mask:0xf
  v_max_u32_dpp v35, v35, v35 row_ror:1 row_mask:0xf bank_mask:0xf
  v_max_u32_dpp v34, v34, v34 row_ror:1 row_mask:0xf bank_mask:0xf
  v_max_u32 v35, v35, v38
  s_nop 0
  v_min_u32_dpp v38, v34, v34 row_bcast:15 row_mask:0xa bank_mask:0xf
  v_max_u32_dpp v35, v35, v35 row_bcast:15 row_mask:0xa bank_mask:0xf
  v_max_u32_dpp v34, v34, v34 row_bcast:15 row_mask:0xa bank_mask:0xf
  v_max_u32 v35, v35, v38
  s_nop 0
  v_min_u32_dpp v38, v34, v34 row_bcast:31 row_mask:0xc bank_mask:0xf
  v_max_u32_dpp v35, v35, v35 row_bcast:31 row_mask:0xc bank_mask:0xf
  v_max_u32_dpp v34, v34, v34 row_bcast:31 row_mask:0xc bank_mask:0xf
  v_max_u32 v35, v35, v38
  v_readlane_b32 s46, v34, 63
  v_readlane_b32 s47, v35, 63
  s_and_b32 s36, s46, 0xffff
  s_sub_u32 s36, 0xffff, s36
  s_and_b32 s37, s47, 0xffff
  s_sub_u32 s37, 0xffff, s37
  s_lshl_b32 s38, s36, 11
  s_lshl_b32 s39, s37, 11
  s_lshl_b32 s33, s32, 7
  s_add_u32 s38, s38, s33
  s_add_u32 s39, s39, s33
  s_mov_b32 m0, 152064
  s_mov_b64 exec, 0xff
  buffer_load_dwordx4 v2, s[4:7], s38 offen lds
  s_mov_b32 m0, 152192
  s_and_b32 s33, s36, 15
  buffer_load_dwordx4 v2, s[4:7], s39 offen lds
  s_lshl_b32 s33, s33, 12
  s_and_b32 s36, s36, 0x7f0
  s_add_u32 s36, s36, s33
  s_add_u32 s36, s36, 196608
  s_and_b32 s33, s37, 15
  s_lshl_b32 s33, s33, 12
  s_and_b32 s37, s37, 0x7f0
  s_add_u32 s37, s37, s33
  s_add_u32 s37, s37, 196608
  s_mov_b64 exec, 1
  buffer_load_dwordx3 v[40:42], off, s[8:11], s36 sc1
  buffer_load_dwordx3 v[44:46], off, s[8:11], s37 sc1
  s_mov_b64 exec, -1
  s_cmp_ge_u32 s30, 112
  s_cbranch_scc1 L_f0
  s_mov_b32 m0, 118784
  s_mov_b32 s33, s44
  buffer_load_dwordx4 v2, s[40:43], s33 offen lds
  buffer_load_dwordx4 v2, s[40:43], s33 offen offset:1024 lds
  s_add_u32 m0, m0, 2080
  s_add_u32 s33, s33, 2048
  buffer_load_dwordx4 v2, s[40:43], s33 offen lds
  buffer_load_dwordx4 v2, s[40:43], s33 offen offset:1024 lds
  s_add_u32 m0, m0, 2080
  s_add_u32 s33, s33, 2048
  buffer_load_dwordx4 v2, s[40:43], s33 offen lds
  buffer_load_dwordx4 v2, s[40:43], s33 offen offset:1024 lds
  s_add_u32 m0, m0, 2080
  s_add_u32 s33, s33, 2048
  buffer_load_dwordx4 v2, s[40:43], s33 offen lds
  buffer_load_dwordx4 v2, s[40:43], s33 offen offset:1024 lds
  s_add_u32 m0, m0, 2080
  s_add_u32 s33, s33, 10240
  buffer_load_dwordx4 v2, s[40:43], s33 offen lds
  buffer_load_dwordx4 v2, s[40:43], s33 offen offset:1024 lds
  s_add_u32 m0, m0, 2080
  s_add_u32 s33, s33, 2048
  buffer_load_dwordx4 v2, s[40:43], s33 offen lds
  buffer_load_dwordx4 v2, s[40:43], s33 offen offset:1024 lds
  s_add_u32 m0, m0, 2080
  s_add_u32 s33, s33, 2048
  buffer_load_dwordx4 v2, s[40:43], s33 offen lds
  buffer_load_dwordx4 v2, s[40:43], s33 offen offset:1024 lds
  s_add_u32 m0, m0, 2080
  s_add_u32 s33, s33, 2048
  buffer_load_dwordx4 v2, s[40:43], s33 offen lds
  buffer_load_dwordx4 v2, s[40:43], s33 offen offset:1024 lds
  s_add_u32 m0, m0, 2080
  s_add_u32 s33, s33, 10240
  buffer_load_dwordx4 v2, s[40:43], s33 offen lds
  buffer_load_dwordx4 v2, s[40:43], s33 offen offset:1024 lds
  s_add_u32 m0, m0, 2080
  s_add_u32 s33, s33, 2048
  buffer_load_dwordx4 v2, s[40:43], s33 offen lds
  buffer_load_dwordx4 v2, s[40:43], s33 offen offset:1024 lds
  s_add_u32 m0, m0, 2080
  s_add_u32 s33, s33, 2048
  buffer_load_dwordx4 v2, s[40:43], s33 offen lds
  buffer_load_dwordx4 v2, s[40:43], s33 offen offset:1024 lds
  s_add_u32 m0, m0, 2080
  s_add_u32 s33, s33, 2048
  buffer_load_dwordx4 v2, s[40:43], s33 offen lds
  buffer_load_dwordx4 v2, s[40:43], s33 offen offset:1024 lds
  s_add_u32 m0, m0, 2080
  s_add_u32 s33, s33, 10240
  buffer_load_dwordx4 v2, s[40:43], s33 offen lds
  buffer_load_dwordx4 v2, s[40:43], s33 offen offset:1024 lds
  s_add_u32 m0, m0, 2080
  s_add_u32 s33, s33, 2048
  buffer_load_dwordx4 v2, s[40:43], s33 offen lds
  buffer_load_dwordx4 v2, s[40:43], s33 offen offset:1024 lds
  s_add_u32 m0, m0, 2080
  s_add_u32 s33, s33, 2048
  buffer_load_dwordx4 v2, s[40:43], s33 offen lds
  buffer_load_dwordx4 v2, s[40:43], s33 offen offset:1024 lds
  s_add_u32 m0, m0, 2080
  s_add_u32 s33, s33, 2048
  buffer_load_dwordx4 v2, s[40:43], s33 offen lds
  buffer_load_dwordx4 v2, s[40:43], s33 offen offset:1024 lds
  s_waitcnt vmcnt(32)
L_f0:
  s_mov_b64 exec, 1
  s_cmp_lt_u32 s30, 112
  s_cbranch_scc1 Q_6
  s_waitcnt vmcnt(0)
Q_6:
  s_mov_b32 s62, 0
  s_waitcnt vmcnt(63)
  s_branch P_7_c
P_7:
  buffer_load_dwordx3 v[40:42], off, s[8:11], s36 sc1
  buffer_load_dwordx3 v[44:46], off, s[8:11], s37 sc1
  s_waitcnt vmcnt(0)
P_7_c:
  v_cmp_ne_u32 vcc, s24, v42
  v_cmp_ne_u32 s[38:39], s24, v46
  s_or_b64 vcc, vcc, s[38:39]
  s_cbranch_vccz P_7_x
  s_add_u32 s62, s62, 1
  s_cmp_lt_u32 s62, 65536
  s_cbranch_scc1 P_7
P_7_x:
  v_mov_b32 v42, v41
  v_mov_b32 v41, v44
  v_mov_b32 v43, v45
  v_mov_b32 v44, 152320
  ds_write_b128 v44, v[40:43]
  s_waitcnt lgkmcnt(0)
  s_mov_b64 exec, -1
  s_barrier
  v_lshrrev_b32 v18, 5, v1
  v_mov_b32 v19, s47
  v_mov_b32 v20, s46
  s_nop 1
  v_mov_b32_dpp v19, v20 quad_perm:[0,1,2,3] row_mask:0x3 bank_mask:0xf
  s_lshr_b32 s38, s52, 1
  s_lshl_b32 s38, s38, 5
  s_and_b32 s39, s52, 1
  s_lshl_b32 s39, s39, 3
  s_add_u32 s38, s38, s39
  v_and_b32 v16, 16, v1
  v_add3_u32 v17, v21, v16, s38
  v_lshlrev_b32 v16, 12, v18
  v_lshl_add_u32 v7, v17, 2, v16
  v_ashrrev_i32 v16, 31, v19
  v_not_b32 v16, v16
  v_or_b32 v16, 0x80000000, v16
  v_xor_b32 v16, v16, v19
  v_and_b32 v16, 0xffff0000, v16
  v_mul_f32 v16, 0xbfb8aa3b, v16
  v_exp_f32 v16, v16
  v_and_b32 v19, 0xffff, v19
  v_add_f32 v16, 1.0, v16
  v_rcp_f32 v16, v16
  v_sub_u32 v19, 0xffff, v19
  v_lshlrev_b32 v19, 11, v19
  v_lshl_add_u32 v8, v17, 1, v19
  v_cvt_pk_bf16_f32 v16, v16, v16
  v_and_b32 v6, 0xffff0000, v16
  s_branch L_f2
L_f1:
  v_mul_u32_u24 v16, 928, v16
  s_lshl_b32 s36, s3, 7
  v_lshl_add_u32 v17, v17, 3, s36
  v_add_u32 v4, v16, v17
  v_add_u32 v5, 59392, v4
  v_lshl_add_u32 v6, v18, 7, v19
  v_add_u32 v6, 152064, v6
  v_mov_b32 v56, 152320
  s_mul_i32 s36, s30, 7168
  s_lshl_b32 s37, s3, 10
  s_add_u32 s36, s36, s37
  s_add_u32 s36, s36, 3145728
  buffer_store_dwordx4 v[60:63], v2, s[8:11], s36 offen sc1
  buffer_store_dwordx4 v[60:63], v2, s[8:11], s49 offen sc1
  v_mov_b32 v12, 0x3f803f80
  v_mov_b32 v13, 0x3f803f80
  v_mov_b32 v14, 0x3f803f80
  v_mov_b32 v15, 0x3f803f80
  s_waitcnt vmcnt(2)
  s_barrier
  ds_read_b64_tr_b16 v[64:65], v4 offset:0
  ds_read_b64_tr_b16 v[66:67], v4 offset:14848
  ds_read_b64_tr_b16 v[68:69], v4 offset:29696
  ds_read_b64_tr_b16 v[70:71], v4 offset:44544
  ds_read_b64_tr_b16 v[72:73], v5 offset:0
  ds_read_b64_tr_b16 v[74:75], v5 offset:14848
  ds_read_b64_tr_b16 v[76:77], v5 offset:29696
  ds_read_b64_tr_b16 v[78:79], v5 offset:44544
  ds_read_b64_tr_b16 v[80:81], v4 offset:32
  ds_read_b64_tr_b16 v[82:83], v4 offset:14880
  ds_read_b64_tr_b16 v[84:85], v4 offset:29728
  ds_read_b64_tr_b16 v[86:87], v4 offset:44576
  ds_read_b64_tr_b16 v[88:89], v5 offset:32
  ds_read_b64_tr_b16 v[90:91], v5 offset:14880
  ds_read_b64_tr_b16 v[92:93], v5 offset:29728
  ds_read_b64_tr_b16 v[94:95], v5 offset:44576
  ds_read_b64_tr_b16 v[96:97], v4 offset:64
  ds_read_b64_tr_b16 v[98:99], v4 offset:14912
  ds_read_b64_tr_b16 v[100:101], v4 offset:29760
  ds_read_b64_tr_b16 v[102:103], v4 offset:44608
  ds_read_b64_tr_b16 v[104:105], v5 offset:64
  ds_read_b64_tr_b16 v[106:107], v5 offset:14912
  ds_read_b64_tr_b16 v[108:109], v5 offset:29760
  ds_read_b64_tr_b16 v[110:111], v5 offset:44608
  ds_read_b64_tr_b16 v[112:113], v4 offset:96
  ds_read_b64_tr_b16 v[114:115], v4 offset:14944
  ds_read_b64_tr_b16 v[116:117], v4 offset:29792
  ds_read_b64_tr_b16 v[118:119], v4 offset:44640
  ds_read_b64_tr_b16 v[120:121], v5 offset:96
  ds_read_b64_tr_b16 v[122:123], v5 offset:14944
  ds_read_b64_tr_b16 v[124:125], v5 offset:29792
  ds_read_b64_tr_b16 v[126:127], v5 offset:44640
  s_waitcnt lgkmcnt(0)
  v_mfma_f32_16x16x32_bf16 v[128:131], v[12:15], v[64:67], 0
  v_mfma_f32_16x16x32_bf16 v[128:131], v[12:15], v[68:71], v[128:131]
  v_mfma_f32_16x16x32_bf16 v[132:135], v[12:15], v[72:75], 0
  v_mfma_f32_16x16x32_bf16 v[132:135], v[12:15], v[76:79], v[132:135]
  v_mfma_f32_16x16x32_bf16 v[136:139], v[12:15], v[80:83], 0
  v_mfma_f32_16x16x32_bf16 v[136:139], v[12:15], v[84:87], v[136:139]
  v_mfma_f32_16x16x32_bf16 v[140:143], v[12:15], v[88:91], 0
  v_mfma_f32_16x16x32_bf16 v[140:143], v[12:15], v[92:95], v[140:143]
  v_mfma_f32_16x16x32_bf16 v[144:147], v[12:15], v[96:99], 0
  v_mfma_f32_16x16x32_bf16 v[144:147], v[12:15], v[100:103], v[144:147]
  v_mfma_f32_16x16x32_bf16 v[148:151], v[12:15], v[104:107], 0
  v_mfma_f32_16x16x32_bf16 v[148:151], v[12:15], v[108:111], v[148:151]
  v_mfma_f32_16x16x32_bf16 v[152:155], v[12:15], v[112:115], 0
  v_mfma_f32_16x16x32_bf16 v[152:155], v[12:15], v[116:119], v[152:155]
  v_mfma_f32_16x16x32_bf16 v[156:159], v[12:15], v[120:123], 0
  v_mfma_f32_16x16x32_bf16 v[156:159], v[12:15], v[124:127], v[156:159]
  v_mov_b32 v16, v128
  s_nop 1
  v_mov_b32_dpp v16, v136 quad_perm:[0,1,2,3] row_mask:0x2 bank_mask:0xf
  s_nop 1
  v_mov_b32_dpp v16, v144 quad_perm:[0,1,2,3] row_mask:0x4 bank_mask:0xf
  s_nop 1
  v_mov_b32_dpp v16, v152 quad_perm:[0,1,2,3] row_mask:0x8 bank_mask:0xf
  v_mov_b32 v17, v132
  s_nop 1
  v_mov_b32_dpp v17, v140 quad_perm:[0,1,2,3] row_mask:0x2 bank_mask:0xf
  s_nop 1
  v_mov_b32_dpp v17, v148 quad_perm:[0,1,2,3] row_mask:0x4 bank_mask:0xf
  s_nop 1
  v_mov_b32_dpp v17, v156 quad_perm:[0,1,2,3] row_mask:0x8 bank_mask:0xf
  s_barrier
  ds_read_b128 v[20:23], v6
  ds_read_b128 v[24:27], v6 offset:64
  ds_read_b128 v[28:31], v56
  s_waitcnt lgkmcnt(2)
  v_mfma_f32_16x16x32_bf16 v[160:163], v[20:23], v[64:67], 0
  v_mfma_f32_16x16x32_bf16 v[164:167], v[20:23], v[72:75], 0
  v_mfma_f32_16x16x32_bf16 v[168:171], v[20:23], v[80:83], 0
  v_mfma_f32_16x16x32_bf16 v[172:175], v[20:23], v[88:91], 0
  v_mfma_f32_16x16x32_bf16 v[176:179], v[20:23], v[96:99], 0
  v_mfma_f32_16x16x32_bf16 v[180:183], v[20:23], v[104:107], 0
  v_mfma_f32_16x16x32_bf16 v[184:187], v[20:23], v[112:115], 0
  v_mfma_f32_16x16x32_bf16 v[188:191], v[20:23], v[120:123], 0
  s_waitcnt lgkmcnt(0)
  v_mfma_f32_16x16x32_bf16 v[160:163], v[24:27], v[68:71], v[160:163]
  v_pk_mul_f32 v[32:33], v[30:31], v[16:17] op_sel:[0,0] op_sel_hi:[1,0] neg_lo:[1,0] neg_hi:[1,0]
  s_nop 1
  v_mfma_f32_16x16x32_bf16 v[164:167], v[24:27], v[76:79], v[164:167]
  v_mul_f32 v34, -v30, v17
  v_mul_f32 v35, -v31, v17
  v_mfma_f32_16x16x32_bf16 v[168:171], v[24:27], v[84:87], v[168:171]
  v_mfma_f32_16x16x32_bf16 v[172:175], v[24:27], v[92:95], v[172:175]
  v_mfma_f32_16x16x32_bf16 v[176:179], v[24:27], v[100:103], v[176:179]
  v_mfma_f32_16x16x32_bf16 v[180:183], v[24:27], v[108:111], v[180:183]
  v_mfma_f32_16x16x32_bf16 v[184:187], v[24:27], v[116:119], v[184:187]
  v_mfma_f32_16x16x32_bf16 v[188:191], v[24:27], v[124:127], v[188:191]
  v_mov_b32 v40, v160
  s_nop 1
  v_mov_b32_dpp v40, v168 quad_perm:[0,1,2,3] row_mask:0x2 bank_mask:0xf
  s_nop 1
  v_mov_b32_dpp v40, v176 quad_perm:[0,1,2,3] row_mask:0x4 bank_mask:0xf
  s_nop 1
  v_mov_b32_dpp v40, v184 quad_perm:[0,1,2,3] row_mask:0x8 bank_mask:0xf
  v_mov_b32 v41, v161
  s_nop 1
  v_mov_b32_dpp v41, v169 quad_perm:[0,1,2,3] row_mask:0x2 bank_mask:0xf
  s_nop 1
  v_mov_b32_dpp v41, v177 quad_perm:[0,1,2,3] row_mask:0x4 bank_mask:0xf
  s_nop 1
  v_mov_b32_dpp v41, v185 quad_perm:[0,1,2,3] row_mask:0x8 bank_mask:0xf
  v_mov_b32 v42, v164
  s_nop 1
  v_mov_b32_dpp v42, v172 quad_perm:[0,1,2,3] row_mask:0x2 bank_mask:0xf
  s_nop 1
  v_mov_b32_dpp v42, v180 quad_perm:[0,1,2,3] row_mask:0x4 bank_mask:0xf
  s_nop 1
  v_mov_b32_dpp v42, v188 quad_perm:[0,1,2,3] row_mask:0x8 bank_mask:0xf
  v_mov_b32 v43, v165
  s_nop 1
  v_mov_b32_dpp v43, v173 quad_perm:[0,1,2,3] row_mask:0x2 bank_mask:0xf
  s_nop 1
  v_mov_b32_dpp v43, v181 quad_perm:[0,1,2,3] row_mask:0x4 bank_mask:0xf
  s_nop 1
  v_mov_b32_dpp v43, v189 quad_perm:[0,1,2,3] row_mask:0x8 bank_mask:0xf
  v_pk_fma_f32 v[40:41], v[40:41], v[28:29], v[32:33]
  v_pk_fma_f32 v[42:43], v[42:43], v[28:29], v[34:35]
  v_and_or_b32 v40, v40, v9, v10
  v_and_or_b32 v41, v41, v9, v10
  v_and_or_b32 v42, v42, v9, v10
  v_and_or_b32 v43, v43, v9, v10
  buffer_store_dwordx4 v[40:43], v2, s[8:11], s36 offen sc1
L_f2:
  s_cmp_ge_u32 s30, 112
  s_cbranch_scc1 L_red
  s_lshr_b32 s36, s3, 1
  s_lshl_b32 s36, s36, 3
  s_and_b32 s37, s3, 1
  s_lshl_b32 s37, s37, 1
  s_add_u32 s36, s36, s37
  s_add_u32 s36, s36, 4
  s_lshl_b32 s36, s36, 11
  s_add_u32 s33, s44, s36
  s_mul_i32 s36, s3, 4160
  s_add_u32 m0, s36, 0
  s_barrier
  buffer_load_dwordx4 v2, s[40:43], s33 offen lds
  buffer_load_dwordx4 v2, s[40:43], s33 offen offset:1024 lds
  s_add_u32 m0, m0, 2080
  s_add_u32 s33, s33, 2048
  buffer_load_dwordx4 v2, s[40:43], s33 offen lds
  buffer_load_dwordx4 v2, s[40:43], s33 offen offset:1024 lds
  s_mov_b32 s61, 0
P_8:
  buffer_load_dwordx4 v[24:27], v48, s[8:11], s48 offen sc1
  s_waitcnt vmcnt(0)
P_8_c:
  v_xor_b32 v24, v10, v24
  v_xor_b32 v25, v10, v25
  v_xor_b32 v26, v10, v26
  v_xor_b32 v27, v10, v27
  v_or3_b32 v16, v24, v25, v26
  v_or_b32 v16, v16, v27
  v_and_b32 v16, 0xff, v16
  v_cmp_ne_u32 vcc, 0, v16
  s_cbranch_vccz P_8_x
  s_add_u32 s61, s61, 1
  s_cmp_lt_u32 s61, 65536
  s_cbranch_scc1 P_8
P_8_x:
  v_permlane32_swap_b32 v24, v25
  v_permlane32_swap_b32 v26, v27
  v_add_f32 v24, v24, v25
  v_add_f32 v25, v26, v27
  ds_write_b64 v49, v[24:25] offset:0
  s_waitcnt vmcnt(0) lgkmcnt(0)
  s_barrier
  ds_read_b64 v[32:33], v50 offset:0
  ds_read_b64 v[34:35], v50 offset:512
  ds_read_b64 v[36:37], v50 offset:1024
  ds_read_b64 v[38:39], v50 offset:1536
  ds_read_b64 v[40:41], v50 offset:2048
  ds_read_b64 v[42:43], v50 offset:2560
  ds_read_b64 v[44:45], v50 offset:3072
  ds_read_b64 v[46:47], v50 offset:3584
  ds_read_b64_tr_b16 v[224:225], v3 offset:0
  ds_read_b64_tr_b16 v[226:227], v11 offset:0
  ds_read_b64_tr_b16 v[228:229], v3 offset:32
  ds_read_b64_tr_b16 v[230:231], v11 offset:32
  ds_read_b64_tr_b16 v[232:233], v3 offset:64
  ds_read_b64_tr_b16 v[234:235], v11 offset:64
  s_waitcnt lgkmcnt(12)
  v_pk_add_f32 v[32:33], v[32:33], v[34:35]
  s_waitcnt lgkmcnt(10)
  v_pk_add_f32 v[36:37], v[36:37], v[38:39]
  s_waitcnt lgkmcnt(8)
  v_pk_add_f32 v[40:41], v[40:41], v[42:43]
  s_waitcnt lgkmcnt(6)
  v_pk_add_f32 v[44:45], v[44:45], v[46:47]
  v_pk_add_f32 v[32:33], v[32:33], v[36:37]
  v_pk_add_f32 v[40:41], v[40:41], v[44:45]
  ds_read_b64_tr_b16 v[236:237], v3 offset:96
  ds_read_b64_tr_b16 v[238:239], v11 offset:96
  ds_read_b64_tr_b16 v[240:241], v3 offset:128
  ds_read_b64_tr_b16 v[242:243], v11 offset:128
  ds_read_b64_tr_b16 v[244:245], v3 offset:160
  ds_read_b64_tr_b16 v[246:247], v11 offset:160
  ds_read_b64_tr_b16 v[248:249], v3 offset:192
  v_pk_add_f32 v[32:33], v[32:33], v[40:41]
  v_cvt_pk_bf16_f32 v33, v32, v33
  v_lshlrev_b32 v32, 16, v33
  v_mul_f32 v34, 0xbfb8aa3b, v32
  v_exp_f32 v34, v34
  v_and_b32 v33, 0xffff0000, v33
  v_add_f32 v34, 1.0, v34
  v_rcp_f32 v34, v34
  s_waitcnt lgkmcnt(6)
  ds_read_b64_tr_b16 v[250:251], v11 offset:192
  ds_read_b64_tr_b16 v[252:253], v3 offset:224
  ds_read_b64_tr_b16 v[254:255], v11 offset:224
  v_mul_f32 v32, v32, v34
  v_cvt_pk_bf16_f32 v32, v32, v32
  v_and_b32 v32, 0xffff0000, v32
  v_mul_f32 v32, v32, v33
  v_cvt_pk_bf16_f32 v32, v32, v32
  ds_write_b16 v51, v32 offset:4096
  ds_read_b128 v[36:39], v52 offset:4096
  s_waitcnt lgkmcnt(0)
  v_mfma_f32_16x16x32_bf16 v[64:67], v[36:39], v[224:227], 0
  v_mfma_f32_16x16x32_bf16 v[68:71], v[36:39], v[228:231], 0
  v_mfma_f32_16x16x32_bf16 v[72:75], v[36:39], v[232:235], 0
  v_mfma_f32_16x16x32_bf16 v[76:79], v[36:39], v[236:239], 0
  v_mfma_f32_16x16x32_bf16 v[80:83], v[36:39], v[240:243], 0
  v_mfma_f32_16x16x32_bf16 v[84:87], v[36:39], v[244:247], 0
  v_mfma_f32_16x16x32_bf16 v[88:91], v[36:39], v[248:251], 0
  v_mfma_f32_16x16x32_bf16 v[92:95], v[36:39], v[252:255], 0
  s_nop 0
  v_mov_b32 v40, v64
  s_nop 1
  v_mov_b32_dpp v40, v72 quad_perm:[0,1,2,3] row_mask:0x2 bank_mask:0xf
  s_nop 1
  v_mov_b32_dpp v40, v80 quad_perm:[0,1,2,3] row_mask:0x4 bank_mask:0xf
  s_nop 1
  v_mov_b32_dpp v40, v88 quad_perm:[0,1,2,3] row_mask:0x8 bank_mask:0xf
  v_mov_b32 v41, v65
  s_nop 1
  v_mov_b32_dpp v41, v73 quad_perm:[0,1,2,3] row_mask:0x2 bank_mask:0xf
  s_nop 1
  v_mov_b32_dpp v41, v81 quad_perm:[0,1,2,3] row_mask:0x4 bank_mask:0xf
  s_nop 1
  v_mov_b32_dpp v41, v89 quad_perm:[0,1,2,3] row_mask:0x8 bank_mask:0xf
  v_mov_b32 v42, v68
  s_nop 1
  v_mov_b32_dpp v42, v76 quad_perm:[0,1,2,3] row_mask:0x2 bank_mask:0xf
  s_nop 1
  v_mov_b32_dpp v42, v84 quad_perm:[0,1,2,3] row_mask:0x4 bank_mask:0xf
  s_nop 1
  v_mov_b32_dpp v42, v92 quad_perm:[0,1,2,3] row_mask:0x8 bank_mask:0xf
  v_mov_b32 v43, v69
  s_nop 1
  v_mov_b32_dpp v43, v77 quad_perm:[0,1,2,3] row_mask:0x2 bank_mask:0xf
  s_nop 1
  v_mov_b32_dpp v43, v85 quad_perm:[0,1,2,3] row_mask:0x4 bank_mask:0xf
  s_nop 1
  v_mov_b32_dpp v43, v93 quad_perm:[0,1,2,3] row_mask:0x8 bank_mask:0xf
  v_and_or_b32 v40, v40, v9, v10
  v_and_or_b32 v41, v41, v9, v10
  v_and_or_b32 v42, v42, v9, v10
  v_and_or_b32 v43, v43, v9, v10
  buffer_store_dwordx4 v[40:43], v2, s[8:11], s49 offen sc1
L_red:
  s_sub_u32 s36, s30, 64
  s_cmp_ge_u32 s36, 64
  s_cbranch_scc1 L_fin
  s_cmp_ge_u32 s3, 6
  s_cbranch_scc1 L_r2
  s_mov_b32 s60, 0
P_9:
  buffer_load_dwordx4 v[20:23], v53, s[8:11], s50 offen sc1
  buffer_load_dwordx4 v[24:27], v53, s[8:11], s51 offen sc1
  s_waitcnt vmcnt(0)
P_9_c:
  v_xor_b32 v20, v10, v20
  v_xor_b32 v21, v10, v21
  v_xor_b32 v22, v10, v22
  v_xor_b32 v23, v10, v23
  v_xor_b32 v24, v10, v24
  v_xor_b32 v25, v10, v25
  v_xor_b32 v26, v10, v26
  v_xor_b32 v27, v10, v27
  v_or3_b32 v16, v20, v21, v22
  v_or3_b32 v16, v16, v23, v24
  v_or3_b32 v16, v16, v25, v26
  v_or_b32 v16, v16, v27
  v_and_b32 v16, 0xff, v16
  v_cmp_ne_u32 vcc, 0, v16
  s_cbranch_vccz P_9_x
  s_add_u32 s60, s60, 1
  s_cmp_lt_u32 s60, 65536
  s_cbranch_scc1 P_9
P_9_x:
  v_pk_add_f32 v[20:21], v[20:21], v[24:25]
  v_pk_add_f32 v[22:23], v[22:23], v[26:27]
  s_branch L_r3
L_r2:
  s_cmp_eq_u32 s3, 7
  s_cbranch_scc1 L_r4
  s_mov_b32 s60, 0
P_10:
  buffer_load_dwordx4 v[20:23], v53, s[8:11], s50 offen sc1
  s_waitcnt vmcnt(0)
P_10_c:
  v_xor_b32 v20, v10, v20
  v_xor_b32 v21, v10, v21
  v_xor_b32 v22, v10, v22
  v_xor_b32 v23, v10, v23
  v_or3_b32 v16, v20, v21, v22
  v_or_b32 v16, v16, v23
  v_and_b32 v16, 0xff, v16
  v_cmp_ne_u32 vcc, 0, v16
  s_cbranch_vccz P_10_x
  s_add_u32 s60, s60, 1
  s_cmp_lt_u32 s60, 65536
  s_cbranch_scc1 P_10
P_10_x:
  s_branch L_r3
L_r4:
  s_mov_b32 s60, 0
P_11:
  buffer_load_dwordx4 v[20:23], v53, s[8:11], s50 offen sc1
  buffer_load_dword v24, v7, s[8:11], s53 offen sc1
  s_waitcnt vmcnt(0)
P_11_c:
  v_xor_b32 v20, v10, v20
  v_xor_b32 v21, v10, v21
  v_xor_b32 v22, v10, v22
  v_xor_b32 v23, v10, v23
  v_xor_b32 v24, v10, v24
  v_or3_b32 v16, v20, v21, v22
  v_or3_b32 v16, v16, v23, v24
  v_and_b32 v16, 0xff, v16
  v_cmp_ne_u32 vcc, 0, v16
  s_cbranch_vccz P_11_x
  s_add_u32 s60, s60, 1
  s_cmp_lt_u32 s60, 65536
  s_cbranch_scc1 P_11
P_11_x:
L_r3:
  v_permlane32_swap_b32 v20, v21
  v_permlane32_swap_b32 v22, v23
  v_add_f32 v20, v20, v21
  v_add_f32 v22, v22, v23
  s_nop 1
  v_permlane16_swap_b32 v20, v22
  v_add_f32 v20, v20, v22
  s_nop 1
  v_add_f32_dpp v20, v20, v20 row_ror:8 row_mask:0xf bank_mask:0xf
  ds_write_b32 v54, v20 offset:5120
  s_waitcnt lgkmcnt(0)
  s_barrier
  s_cmp_lg_u32 s3, 7
  s_cbranch_scc1 L_fin
  ds_read_b32 v32, v55 offset:5120
  ds_read_b32 v33, v55 offset:5376
  ds_read_b32 v34, v55 offset:5632
  ds_read_b32 v35, v55 offset:5888
  ds_read_b32 v36, v55 offset:6144
  ds_read_b32 v37, v55 offset:6400
  ds_read_b32 v38, v55 offset:6656
  ds_read_b32 v39, v55 offset:6912
  s_waitcnt lgkmcnt(4)
  v_pk_add_f32 v[32:33], v[32:33], v[34:35]
  s_waitcnt lgkmcnt(0)
  v_pk_add_f32 v[36:37], v[36:37], v[38:39]
  v_pk_add_f32 v[32:33], v[32:33], v[36:37]
  v_add_f32 v20, v32, v33
  v_cvt_pk_bf16_f32 v20, v20, v20
  v_and_b32 v20, 0xffff0000, v20
  v_mul_f32 v20, v20, v6
  v_cvt_pk_bf16_f32 v20, v20, v20
  v_and_b32 v20, 0xffff0000, v20
  v_add_f32 v20, v20, v24
  v_cvt_pk_bf16_f32 v20, v20, v20
  s_mov_b32 exec_lo, 0xff00ff
  s_mov_b32 exec_hi, 0xff00ff
  buffer_store_short v20, v8, s[12:15], 0 offen sc1
  s_cmp_lg_u32 s52, 0
  s_cbranch_scc1 L_fin
  v_mov_b32 v16, s24
  s_mov_b64 exec, 1
  buffer_store_dword v16, off, s[8:11], 0 sc1
L_fin:
L_end:
  s_endpgm
.section .rodata,"a"
.p2align 6
.amdhsa_kernel parallel_sum__spectral_fnet__moe_arch_mod__prompt_kernel
  .amdhsa_next_free_vgpr 256
  .amdhsa_next_free_sgpr 102
  .amdhsa_accum_offset 256
  .amdhsa_group_segment_fixed_size 0
  .amdhsa_kernarg_size 104
  .amdhsa_user_sgpr_count 2
  .amdhsa_user_sgpr_kernarg_segment_ptr 1
  .amdhsa_system_sgpr_workgroup_id_x 1
.end_amdhsa_kernel
.p2align 8
L_tab:
.quad 0x3fb23fa73f973f80,0x3f973fa73fb23fb5,0x3fa73fb53fa73f80,0xbf0b25003f0b3f80,0x3f493fa73fb23f80,0xbfb2bfa7bf492500,0x25003f803fb53f80,0xa5c0bf80bfb5bf80,0xbf80bf803f803f80,0xbf80bf803f803f80,0xbe8dbfa73f493f80,0x3f49bfa7be8d3fb5,0x3f0bbfb53f0b3f80,0x3fa7a708bfa73f80,0x3f97bfa73e8d3f80,0xbe8d3fa7bf9726f0
.quad 0xbf493f0b3fb23f80,0x3fb23f0bbf49bfb5,0xbfa725003fa73f80,0x3f0b3fb53f0bbf80,0xbfb2bf0b3f973f80,0xbf973f0b3fb2a5c0,0x3f803f803f803f80,0x3f803f803f803f80,0x3fb5bf8025003f80,0xbfb53f80a708bf80,0x3f97bf0bbe8d3f80,0xbe8dbf0b3f97bfb5,0x3f0ba5c0bf0b3f80,0x3fa7bfb53fa7bf80,0xbe8d3f0bbf493f80,0x3f49bf0b3e8da708
.quad 0x3e8d3f0b3f493f80,0xbf49bf0bbe8d2500,0xbf0b25003f0b3f80,0xbfa7bfb5bfa7bf80,0xbf97bf0b3e8d3f80,0x3e8dbf0bbf97bfb5,0xbfb5bf8025003f80,0x3fb53f80a580bf80,0x3f80bf80bf803f80,0x3f80bf80bf803f80,0x3fb2bf0bbf973f80,0x3f973f0bbfb225c0,0x3fa7a580bfa73f80,0xbf0b3fb5bf0bbf80,0x3f493f0bbfb23f80,0xbfb23f0b3f49bfb5
.quad 0xbf97bfa7be8d3f80,0x3e8d3fa73f97a580,0xbf0bbfb5bf0b3f80,0xbfa725c03fa73f80,0x3e8dbfa7bf493f80,0xbf49bfa73e8d3fb5,0xbf803f80bf803f80,0xbf803f80bf803f80,0x25c03f80bfb53f80,0x25c0bf803fb5bf80,0xbf493fa7bfb23f80,0x3fb2bfa73f492660,0xbfa73fb5bfa73f80,0x3f0b25c0bf0b3f80,0xbfb23fa7bf973f80,0xbf973fa7bfb23fb5
.quad 0x3e8d3f0b3f493f80,0xbf49bf0bbe8d2500,0xbfa7bfb5bfa7bf80,0x3f0ba5c0bf0bbf80,0x3f973f0bbe8dbf80,0xbe8d3f0b3f973fb5,0x26f03f803fb53f80,0xa708bf80bfb5bf80,0xbf80bf803f803f80,0xbf80bf803f803f80,0x3fb2bf0bbf973f80,0x3f973f0bbfb22728,0xbf0b3fb5bf0bbf80,0xbfa727483fa7bf80,0xbf49bf0b3fb2bf80,0x3fb2bf0bbf493fb5
.quad 0xbf97bfa7be8d3f80,0x3e8d3fa73f97a708,0x3fa7a708bfa7bf80,0xbf0bbfb5bf0b3f80,0xbe8d3fa73f49bf80,0x3f493fa7be8dbfb5,0x3f803f803f803f80,0x3f803f803f803f80,0x3fb5bf8027283f80,0xbfb53f802718bf80,0xbf493fa7bfb23f80,0x3fb2bfa73f49a758,0xbf0b27483f0bbf80,0xbfa73fb5bfa73f80,0x3fb2bfa73f97bf80,0x3f97bfa73fb2bfb5
.quad 0xbfb2bfa7bf97bf80,0xbf97bfa7bfb2bfb5,0x3f0ba580bf0bbf80,0x3fa73fb53fa73f80,0x3f493fa73fb23f80,0xbfb2bfa7bf4925c0,0xbfb5bf8025c03f80,0x3fb53f802660bf80,0x3f80bf80bf803f80,0x3f80bf80bf803f80,0x3e8d3fa7bf49bf80,0xbf493fa73e8dbfb5,0xbfa7a5003fa7bf80,0x3f0bbfb53f0b3f80,0x3f97bfa73e8d3f80,0xbe8d3fa7bf972500
.quad 0x3f49bf0bbfb2bf80,0xbfb2bf0b3f493fb5,0x3f0b3fb53f0bbf80,0x3fa725c0bfa7bf80,0xbfb2bf0b3f973f80,0xbf973f0b3fb225c0,0xbf803f80bf803f80,0xbf803f80bf803f80,0x27bc3f80bfb53f80,0xa842bf803fb5bf80,0xbf973f0b3e8dbf80,0x3e8d3f0bbf973fb5,0x3fa7bfb53fa7bf80,0xbf0b27d43f0bbf80,0xbe8d3f0bbf493f80,0x3f49bf0b3e8da660
.quad 0xbfb2bfa7bf97bf80,0xbf97bfa7bfb2bfb5,0x3fa73fb53fa73f80,0xbf0b26f03f0b3f80,0xbf49bfa7bfb2bf80,0x3fb23fa73f49a708,0x27183f803fb53f80,0xa728bf80bfb5bf80,0xbf80bf803f803f80,0xbf80bf803f803f80,0x3e8d3fa7bf49bf80,0xbf493fa73e8dbfb5,0x3f0bbfb53f0b3f80,0x3fa7a81cbfa73f80,0xbf973fa7be8dbf80,0x3e8dbfa73f9726d0
.quad 0x3f49bf0bbfb2bf80,0xbfb2bf0b3f493fb5,0xbfa727283fa73f80,0x3f0b3fb53f0bbf80,0x3fb23f0bbf97bf80,0x3f97bf0bbfb22748,0x3f803f803f803f80,0x3f803f803f803f80,0x3fb5bf80a7ec3f80,0xbfb53f802690bf80,0xbf973f0b3e8dbf80,0x3e8d3f0bbf973fb5,0x3f0b2690bf0b3f80,0x3fa7bfb53fa7bf80,0x3e8dbf0b3f49bf80,0xbf493f0bbe8d27a4
.quad 0xbe8dbf0bbf49bf80,0x3f493f0b3e8da580,0xbf0b25c03f0b3f80,0xbfa7bfb5bfa7bf80,0x3f973f0bbe8dbf80,0xbe8d3f0b3f973fb5,0xbfb5bf80a6203f80,0x3fb53f8025c0bf80,0x3f80bf80bf803f80,0x3f80bf80bf803f80,0xbfb23f0b3f97bf80,0xbf97bf0b3fb2a660,0x3fa7a660bfa73f80,0xbf0b3fb5bf0bbf80,0xbf49bf0b3fb2bf80,0x3fb2bf0bbf493fb5
.quad 0x3f973fa73e8dbf80,0xbe8dbfa7bf97a500,0xbf0bbfb5bf0b3f80,0xbfa727bc3fa73f80,0xbe8d3fa73f49bf80,0x3f493fa7be8dbfb5,0xbf803f80bf803f80,0xbf803f80bf803f80,0x27e43f80bfb53f80,0xa6f0bf803fb5bf80,0x3f49bfa73fb2bf80,0xbfb23fa7bf4927ec,0xbfa73fb5bfa73f80,0x3f0ba85abf0b3f80,0x3fb2bfa73f97bf80,0x3f97bfa73fb2bfb5
.quad 0xbe8dbf0bbf49bf80,0x3f493f0b3e8da5c0,0xbfa7bfb5bfa7bf80,0x3f0ba708bf0bbf80,0xbf97bf0b3e8d3f80,0x3e8dbf0bbf97bfb5,0x27283f803fb53f80,0xa738bf80bfb5bf80,0xbf80bf803f803f80,0xbf80bf803f803f80,0xbfb23f0b3f97bf80,0xbf97bf0b3fb22690,0xbf0b3fb5bf0bbf80,0xbfa727a43fa7bf80,0x3f493f0bbfb23f80,0xbfb23f0b3f49bfb5
.quad 0x3f973fa73e8dbf80,0xbe8dbfa7bf972748,0x3fa72718bfa7bf80,0xbf0bbfb5bf0b3f80,0x3e8dbfa7bf493f80,0xbf49bfa73e8d3fb5,0x3f803f803f803f80,0x3f803f803f803f80,0x3fb5bf8027a43f80,0xbfb53f80a836bf80,0x3f49bfa73fb2bf80,0xbfb23fa7bf4927bc,0xbf0ba8873f0bbf80,0xbfa73fb5bfa73f80,0xbfb23fa7bf973f80,0xbf973fa7bfb23fb5
.quad 0x3fb23fa73f973f80,0x3f973fa73fb23fb5,0x3f0b2660bf0bbf80,0x3fa73fb53fa73f80,0xbf49bfa7bfb2bf80,0x3fb23fa73f4925c0,0xbfb5bf80a5003f80,0x3fb53f800000bf80,0x3f80bf80bf803f80,0x3f80bf80bf803f80,0xbe8dbfa73f493f80,0x3f49bfa7be8d3fb5,0xbfa7a7783fa7bf80,0x3f0bbfb53f0b3f80,0xbf973fa7be8dbf80,0x3e8dbfa73f97a718
.quad 0xbf493f0b3fb23f80,0x3fb23f0bbf49bfb5,0x3f0b3fb53f0bbf80,0x3fa7a842bfa7bf80,0x3fb23f0bbf97bf80,0x3f97bf0bbfb227d4,0xbf803f80bf803f80,0xbf803f80bf803f80,0x28023f80bfb53f80,0xa866bf803fb5bf80,0x3f97bf0bbe8d3f80,0xbe8dbf0b3f97bfb5,0x3fa7bfb53fa7bf80,0xbf0b28a53f0bbf80,0x3e8dbf0b3f49bf80,0xbf493f0bbe8da6f0
.quad 0x3e8d3f0b3f493f80,0xbf49bf0bbe8d2500,0xbf0b25003f0b3f80,0xbfa7bfb5bfa7bf80,0xbf97bf0b3e8d3f80,0x3e8dbf0bbf97bfb5,0xbfb5bf8025003f80,0x3fb53f80a580bf80,0x3f80bf80bf803f80,0x3f80bf80bf803f80,0x3fb2bf0bbf973f80,0x3f973f0bbfb225c0,0x3fa7a580bfa73f80,0xbf0b3fb5bf0bbf80,0x3f493f0bbfb23f80,0xbfb23f0b3f49bfb5
.quad 0xbf97bfa7be8d3f80,0x3e8d3fa73f97a580,0xbf0bbfb5bf0b3f80,0xbfa725c03fa73f80,0x3e8dbfa7bf493f80,0xbf49bfa73e8d3fb5,0x3f803f803f803f80,0x3f803f803f803f80,0x25c03f80bfb53f80,0x25c0bf803fb5bf80,0xbf493fa7bfb23f80,0x3fb2bfa73f492660,0xbfa73fb5bfa73f80,0x3f0b25c0bf0b3f80,0xbfb23fa7bf973f80,0xbf973fa7bfb23fb5
.quad 0x3fb23fa73f973f80,0x3f973fa73fb23fb5,0x3fa73fb53fa73f80,0xbf0b25003f0b3f80,0x3f493fa73fb23f80,0xbfb2bfa7bf492500,0x25003f803fb53f80,0xa5c0bf80bfb5bf80,0xbf80bf803f803f80,0xbf80bf803f803f80,0xbe8dbfa73f493f80,0x3f49bfa7be8d3fb5,0x3f0bbfb53f0b3f80,0x3fa7a708bfa73f80,0x3f97bfa73e8d3f80,0xbe8d3fa7bf9726f0
.quad 0xbf493f0b3fb23f80,0x3fb23f0bbf49bfb5,0xbfa725003fa73f80,0x3f0b3fb53f0bbf80,0xbfb2bf0b3f973f80,0xbf973f0b3fb2a5c0,0xbf803f80bf803f80,0xbf803f80bf803f80,0x3fb5bf8025003f80,0xbfb53f80a708bf80,0x3f97bf0bbe8d3f80,0xbe8dbf0b3f97bfb5,0x3f0ba5c0bf0b3f80,0x3fa7bfb53fa7bf80,0xbe8d3f0bbf493f80,0x3f49bf0b3e8da708
.quad 0xbfb2bfa7bf97bf80,0xbf97bfa7bfb2bfb5,0x3f0ba580bf0bbf80,0x3fa73fb53fa73f80,0x3f493fa73fb23f80,0xbfb2bfa7bf4925c0,0xbfb5bf8025c03f80,0x3fb53f802660bf80,0x3f80bf80bf803f80,0x3f80bf80bf803f80,0x3e8d3fa7bf49bf80,0xbf493fa73e8dbfb5,0xbfa7a5003fa7bf80,0x3f0bbfb53f0b3f80,0x3f97bfa73e8d3f80,0xbe8d3fa7bf972500
.quad 0x3f49bf0bbfb2bf80,0xbfb2bf0b3f493fb5,0x3f0b3fb53f0bbf80,0x3fa725c0bfa7bf80,0xbfb2bf0b3f973f80,0xbf973f0b3fb225c0,0x3f803f803f803f80,0x3f803f803f803f80,0x27bc3f80bfb53f80,0xa842bf803fb5bf80,0xbf973f0b3e8dbf80,0x3e8d3f0bbf973fb5,0x3fa7bfb53fa7bf80,0xbf0b27d43f0bbf80,0xbe8d3f0bbf493f80,0x3f49bf0b3e8da660
.quad 0x3e8d3f0b3f493f80,0xbf49bf0bbe8d2500,0xbfa7bfb5bfa7bf80,0x3f0ba5c0bf0bbf80,0x3f973f0bbe8dbf80,0xbe8d3f0b3f973fb5,0x26f03f803fb53f80,0xa708bf80bfb5bf80,0xbf80bf803f803f80,0xbf80bf803f803f80,0x3fb2bf0bbf973f80,0x3f973f0bbfb22728,0xbf0b3fb5bf0bbf80,0xbfa727483fa7bf80,0xbf49bf0b3fb2bf80,0x3fb2bf0bbf493fb5
.quad 0xbf97bfa7be8d3f80,0x3e8d3fa73f97a708,0x3fa7a708bfa7bf80,0xbf0bbfb5bf0b3f80,0xbe8d3fa73f49bf80,0x3f493fa7be8dbfb5,0xbf803f80bf803f80,0xbf803f80bf803f80,0x3fb5bf8027283f80,0xbfb53f802718bf80,0xbf493fa7bfb23f80,0x3fb2bfa73f49a758,0xbf0b27483f0bbf80,0xbfa73fb5bfa73f80,0x3fb2bfa73f97bf80,0x3f97bfa73fb2bfb5
.quad 0xbe8dbf0bbf49bf80,0x3f493f0b3e8da580,0xbf0b25c03f0b3f80,0xbfa7bfb5bfa7bf80,0x3f973f0bbe8dbf80,0xbe8d3f0b3f973fb5,0xbfb5bf80a6203f80,0x3fb53f8025c0bf80,0x3f80bf80bf803f80,0x3f80bf80bf803f80,0xbfb23f0b3f97bf80,0xbf97bf0b3fb2a660,0x3fa7a660bfa73f80,0xbf0b3fb5bf0bbf80,0xbf49bf0b3fb2bf80,0x3fb2bf0bbf493fb5
.quad 0x3f973fa73e8dbf80,0xbe8dbfa7bf97a500,0xbf0bbfb5bf0b3f80,0xbfa727bc3fa73f80,0xbe8d3fa73f49bf80,0x3f493fa7be8dbfb5,0x3f803f803f803f80,0x3f803f803f803f80,0x27e43f80bfb53f80,0xa6f0bf803fb5bf80,0x3f49bfa73fb2bf80,0xbfb23fa7bf4927ec,0xbfa73fb5bfa73f80,0x3f0ba85abf0b3f80,0x3fb2bfa73f97bf80,0x3f97bfa73fb2bfb5
.quad 0xbfb2bfa7bf97bf80,0xbf97bfa7bfb2bfb5,0x3fa73fb53fa73f80,0xbf0b26f03f0b3f80,0xbf49bfa7bfb2bf80,0x3fb23fa73f49a708,0x27183f803fb53f80,0xa728bf80bfb5bf80,0xbf80bf803f803f80,0xbf80bf803f803f80,0x3e8d3fa7bf49bf80,0xbf493fa73e8dbfb5,0x3f0bbfb53f0b3f80,0x3fa7a81cbfa73f80,0xbf973fa7be8dbf80,0x3e8dbfa73f9726d0
.quad 0x3f49bf0bbfb2bf80,0xbfb2bf0b3f493fb5,0xbfa727283fa73f80,0x3f0b3fb53f0bbf80,0x3fb23f0bbf97bf80,0x3f97bf0bbfb22748,0xbf803f80bf803f80,0xbf803f80bf803f80,0x3fb5bf80a7ec3f80,0xbfb53f802690bf80,0xbf973f0b3e8dbf80,0x3e8d3f0bbf973fb5,0x3f0b2690bf0b3f80,0x3fa7bfb53fa7bf80,0x3e8dbf0b3f49bf80,0xbf493f0bbe8d27a4
.quad 0x3fb23fa73f973f80,0x3f973fa73fb23fb5,0x3f0b2660bf0bbf80,0x3fa73fb53fa73f80,0xbf49bfa7bfb2bf80,0x3fb23fa73f4925c0,0xbfb5bf80a5003f80,0x3fb53f800000bf80,0x3f80bf80bf803f80,0x3f80bf80bf803f80,0xbe8dbfa73f493f80,0x3f49bfa7be8d3fb5,0xbfa7a7783fa7bf80,0x3f0bbfb53f0b3f80,0xbf973fa7be8dbf80,0x3e8dbfa73f97a718
.quad 0xbf493f0b3fb23f80,0x3fb23f0bbf49bfb5,0x3f0b3fb53f0bbf80,0x3fa7a842bfa7bf80,0x3fb23f0bbf97bf80,0x3f97bf0bbfb227d4,0x3f803f803f803f80,0x3f803f803f803f80,0x28023f80bfb53f80,0xa866bf803fb5bf80,0x3f97bf0bbe8d3f80,0xbe8dbf0b3f97bfb5,0x3fa7bfb53fa7bf80,0xbf0b28a53f0bbf80,0x3e8dbf0b3f49bf80,0xbf493f0bbe8da6f0
.quad 0xbe8dbf0bbf49bf80,0x3f493f0b3e8da5c0,0xbfa7bfb5bfa7bf80,0x3f0ba708bf0bbf80,0xbf97bf0b3e8d3f80,0x3e8dbf0bbf97bfb5,0x27283f803fb53f80,0xa738bf80bfb5bf80,0xbf80bf803f803f80,0xbf80bf803f803f80,0xbfb23f0b3f97bf80,0xbf97bf0b3fb22690,0xbf0b3fb5bf0bbf80,0xbfa727a43fa7bf80,0x3f493f0bbfb23f80,0xbfb23f0b3f49bfb5
.quad 0x3f973fa73e8dbf80,0xbe8dbfa7bf972748,0x3fa72718bfa7bf80,0xbf0bbfb5bf0b3f80,0x3e8dbfa7bf493f80,0xbf49bfa73e8d3fb5,0xbf803f80bf803f80,0xbf803f80bf803f80,0x3fb5bf8027a43f80,0xbfb53f80a836bf80,0x3f49bfa73fb2bf80,0xbfb23fa7bf4927bc,0xbf0ba8873f0bbf80,0xbfa73fb5bfa73f80,0xbfb23fa7bf973f80,0xbf973fa7bfb23fb5
.quad 0x3c003c003c003c00,0x24b622481e480000,0x3bff3bff3c003c00,0x28b6264822480000,0x3bfd3bff3c003c00,0x2b1128b624b60000,0x3bfa3bfe3bff3c00,0x2cb52a4826480000,0x3bea3bf63bfe3c00,0x30b22e462a480000,0x3be43bf43bfd3c00,0x31472f0e2b110000,0x3bdd3bf13bfc3c00,0x31db2fd62bd90000,0x3bd63bed3bfb3c00,0x326f304e2c510000
.quad 0x3bf73bfc3bff3c00,0x2de22bd927da0000,0x3bf43bfa3bff3c00,0x2f0e2cb528b60000,0x3bef3bf83bfe3c00,0x301d2d7e297f0000,0x3c003c003c003c00,0,0x3bce3bea3bfa3c00,0x330330b22cb50000,0x3bc63be63bf93c00,0x339631152d1a0000,0x3bbc3be23bf83c00,0x341431792d7e0000,0x3bb23bdd3bf73c00,0x345d31db2de20000
.quad 0x3c003c003c003c00,0xa4b6a2489e488000,0x3bff3bff3c003c00,0xa8b6a648a2488000,0x3bfd3bff3c003c00,0xab11a8b6a4b68000,0x3bfa3bfe3bff3c00,0xacb5aa48a6488000,0x3bea3bf63bfe3c00,0xb0b2ae46aa488000,0x3be43bf43bfd3c00,0xb147af0eab118000,0x3bdd3bf13bfc3c00,0xb1dbafd6abd98000,0x3bd63bed3bfb3c00,0xb26fb04eac518000
.quad 0x3bf73bfc3bff3c00,0xade2abd9a7da8000,0x3bf43bfa3bff3c00,0xaf0eacb5a8b68000,0x3bef3bf83bfe3c00,0xb01dad7ea97f8000,0x3ba83bd93bf63c00,0xb4a5b23eae468000,0x3bce3bea3bfa3c00,0xb303b0b2acb58000,0x3bc63be63bf93c00,0xb396b115ad1a8000,0x3bbc3be23bf83c00,0xb414b179ad7e8000,0x3bb23bdd3bf73c00,0xb45db1dbade28000
.quad 0x3bfe3bff3bff3bff,0x297f28b627da2648,0x3bf83bfa3bfc3bfe,0x2d7e2cb52bd92a48,0x3bef3bf43bf73bfa,0x301d2f0e2de22cb5,0x3be23bea3bf13bf6,0x317930b22fd62e46,0x3b883ba83bc33bd9,0x356434a533c6323e,0x3b693b913bb23bce,0x36083534345d3303,0x3b463b773ba03bc3,0x36aa35c234d533c6,0x3b203b5a3b8c3bb6,0x3748364e354c3444
.quad 0x3bd13bdd3be83bf1,0x32d231db30e42fd6,0x3bbc3bce3bdd3bea,0x3414330331db30b2,0x3ba43bbc3bd13be2,0x34bd341432d23179,0x3c003c003c003c00,0,0x3af63b3b3b773ba8,0x37e336d735c234a5,0x3ac93b1a3b5f3b99,0x383d375e36373505,0x3a993af63b463b88,0x388737e336aa3564,0x3a653ad03b2b3b77,0x38ce3832371b35c2
.quad 0x3bfe3bff3bff3bff,0xa97fa8b6a7daa648,0x3bf83bfa3bfc3bfe,0xad7eacb5abd9aa48,0x3bef3bf43bf73bfa,0xb01daf0eade2acb5,0x3be23bea3bf13bf6,0xb179b0b2afd6ae46,0x3b883ba83bc33bd9,0xb564b4a5b3c6b23e,0x3b693b913bb23bce,0xb608b534b45db303,0x3b463b773ba03bc3,0xb6aab5c2b4d5b3c6,0x3b203b5a3b8c3bb6,0xb748b64eb54cb444
.quad 0x3bd13bdd3be83bf1,0xb2d2b1dbb0e4afd6,0x3bbc3bce3bdd3bea,0xb414b303b1dbb0b2,0x3ba43bbc3bd13be2,0xb4bdb414b2d2b179,0x3a2f3aa73b0e3b64,0xb913b872b78bb61f,0x3af63b3b3b773ba8,0xb7e3b6d7b5c2b4a5,0x3ac93b1a3b5f3b99,0xb83db75eb637b505,0x3a993af63b463b88,0xb887b7e3b6aab564,0x3a653ad03b2b3b77,0xb8ceb832b71bb5c2
.quad 0x3bfb3bfc3bfd3bfe,0x2c512bd92b112a48,0x3bed3bf13bf43bf6,0x304e2fd62f0e2e46,0x3bd63bdd3be43bea,0x326f31db314730b2,0x3bb63bc33bce3bd9,0x344433c63303323e,0x3add3b0e3b3b3b64,0x381d378b36d7361f,0x3a923ad03b083b3b,0x3891383237a136d7,0x3a3f3a8a3ad03b0e,0x3900389b3832378b,0x39e53a3f3a923add,0x396939003891381d
.quad 0x3b8c3ba03bb23bc3,0x354c34d5345d33c6,0x3b5a3b773b913ba8,0x364e35c2353434a5,0x3b203b463b693b88,0x374836aa36083564,0x3c003c003c003c00,0,0x398439ed3a4f3aa7,0x39cb395f38ec3872,0x391d39963a073a6d,0x3a2739ba394338c4,0x38b0393a39ba3a2f,0x3a7c3a0f39963913,0x383d38d8396939ed,0x3ac93a5e39e5395f
.quad 0x3bfb3bfc3bfd3bfe,0xac51abd9ab11aa48,0x3bed3bf13bf43bf6,0xb04eafd6af0eae46,0x3bd63bdd3be43bea,0xb26fb1dbb147b0b2,0x3bb63bc33bce3bd9,0xb444b3c6b303b23e,0x3add3b0e3b3b3b64,0xb81db78bb6d7b61f,0x3a923ad03b083b3b,0xb891b832b7a1b6d7,0x3a3f3a8a3ad03b0e,0xb900b89bb832b78b,0x39e53a3f3a923add,0xb969b900b891b81d
.quad 0x3b8c3ba03bb23bc3,0xb54cb4d5b45db3c6,0x3b5a3b773b913ba8,0xb64eb5c2b534b4a5,0x3b203b463b693b88,0xb748b6aab608b564,0x378b3872391339a8,0xbb0ebaa7ba2fb9a8,0x398439ed3a4f3aa7,0xb9cbb95fb8ecb872,0x391d39963a073a6d,0xba27b9bab943b8c4,0x38b0393a39ba3a2f,0xba7cba0fb996b913,0x383d38d8396939ed,0xbac9ba5eb9e5b95f
.quad 0x3bf73bf83bf93bfa,0x2de22d7e2d1a2cb5,0x3bdd3be23be63bea,0x31db3179311530b2,0x3bb23bbc3bc63bce,0x345d341433963303,0x3b773b883b993ba8,0x35c23564350534a5,0x39ed3a2f3a6d3aa7,0x395f391338c43872,0x396939ba3a073a4f,0x39e53996394338ec,0x38d8393a399639ed,0x3a5e3a0f39ba395f,0x383d38b0391d3984,0x3ac93a7c3a2739cb
.quad 0x3b2b3b463b5f3b77,0x371b36aa363735c2,0x3ad03af63b1a3b3b,0x383237e3375e36d7,0x3a653a993ac93af6,0x38ce3887383d37e3,0x3c003c003c003c00,0,0x3732381d389b3913,0x3b253add3a8a3a2f,0x35da37053812389b,0x3b723b303ae33a8a,0x347535c23705381d,0x3baf3b773b303add,0x320d347535da3732,0x3bdb3baf3b723b25
.quad 0x3bf73bf83bf93bfa,0xade2ad7ead1aacb5,0x3bdd3be23be63bea,0xb1dbb179b115b0b2,0x3bb23bbc3bc63bce,0xb45db414b396b303,0x3b773b883b993ba8,0xb5c2b564b505b4a5,0x39ed3a2f3a6d3aa7,0xb95fb913b8c4b872,0x396939ba3a073a4f,0xb9e5b996b943b8ec,0x38d8393a399639ed,0xba5eba0fb9bab95f,0x383d38b0391d3984,0xbac9ba7cba27b9cb
.quad 0x3b2b3b463b5f3b77,0xb71bb6aab637b5c2,0x3ad03af63b1a3b3b,0xb832b7e3b75eb6d7,0x3a653a993ac93af6,0xb8ceb887b83db7e3,0x2e46323e34a5361f,0xbbf6bbd9bba8bb64,0x3732381d389b3913,0xbb25baddba8aba2f,0x35da37053812389b,0xbb72bb30bae3ba8a,0x347535c23705381d,0xbbafbb77bb30badd,0x320d347535da3732,0xbbdbbbafbb72bb25
.quad 0x3bf23bf43bf53bf6,0x2f722f0e2eaa2e46,0x3bc93bce3bd43bd9,0x3365330332a1323e,0x3b843b913b9d3ba8,0x357c353434ed34a5,0x3b253b3b3b503b64,0x373236d7367c361f,0x38c43913395f39a8,0x3a6d3a2f39ed39a8,0x37f9385d38ba3913,0x3af03ab53a743a2f,0x364e373238073872,0x3b5a3b253ae93aa7,0x348d35933693378b,0x3bab3b803b4b3b0e
.quad 0x3aae3ad03af03b0e,0x3867383237f9378b,0x3a1f3a4f3a7c3aa7,0x392738ec38b03872,0x397b39ba39f63a2f,0x39d4399639563913,0x3c003c003c003c00,0,0x317933c63505361f,0x3be23bc33b993b64,0x2b11304e32d234a5,0x3bfd3bed3bd13ba8,0xabd926482f0e323e,0x3bfc3bff3bf43bd9,0xb1aaad7e1e482e46,0x3be03bf83c003bf6
.quad 0x3bf23bf43bf53bf6,0xaf72af0eaeaaae46,0x3bc93bce3bd43bd9,0xb365b303b2a1b23e,0x3b843b913b9d3ba8,0xb57cb534b4edb4a5,0x3b253b3b3b503b64,0xb732b6d7b67cb61f,0x38c43913395f39a8,0xba6dba2fb9edb9a8,0x37f9385d38ba3913,0xbaf0bab5ba74ba2f,0x364e373238073872,0xbb5abb25bae9baa7,0x348d35933693378b,0xbbabbb80bb4bbb0e
.quad 0x3aae3ad03af03b0e,0xb867b832b7f9b78b,0x3a1f3a4f3a7c3aa7,0xb927b8ecb8b0b872,0x397b39ba39f63a2f,0xb9d4b996b956b913,0xb4a5b23eae460000,0xbba8bbd9bbf6bc00,0x317933c63505361f,0xbbe2bbc3bb99bb64,0x2b11304e32d234a5,0xbbfdbbedbbd1bba8,0xabd926482f0e323e,0xbbfcbbffbbf4bbd9,0xb1aaad7e1e482e46,0xbbe0bbf8bc00bbf6
.quad 0x3bec3bed3bef3bf1,0x3080304e301d2fd6,0x3baf3bb63bbc3bc3,0x34753444341433c6,0x3b4b3b5a3b693b77,0x3693364e360835c2,0x3ac23add3af63b0e,0x3848381d37e3378b,0x36d7378b381d3872,0x3b3b3b0e3add3aa7,0x34bd359336653732,0x3ba43b803b553b25,0x3115330334753564,0x3be63bce3baf3b88,0x24b62d7e30e43303,0x3c003bf83be83bce
.quad 0x3a173a3f3a653a8a,0x3930390038ce389b,0x394d398439ba39ed,0x39fe39cb3996395f,0x386738b038f6393a,0x3aae3a7c3a473a0f,0x3c003c003c003c00,0,0xafd6aa4826482e46,0x3bf13bfe3bff3bf6,0xb42cb1dbaeaaa648,0x3bb93bdd3bf53bff,0xb64eb505b365b0b2,0x3b5a3b993bc93bea,0xb828b705b5abb444,0x3ad63b303b7b3bb6
.quad 0x3bec3bed3bef3bf1,0xb080b04eb01dafd6,0x3baf3bb63bbc3bc3,0xb475b444b414b3c6,0x3b4b3b5a3b693b77,0xb693b64eb608b5c2,0x3ac23add3af63b0e,0xb848b81db7e3b78b,0x36d7378b381d3872,0xbb3bbb0ebaddbaa7,0x34bd359336653732,0xbba4bb80bb55bb25,0x3115330334753564,0xbbe6bbcebbafbb88,0x24b62d7e30e43303,0xbc00bbf8bbe8bbce
.quad 0x3a173a3f3a653a8a,0xb930b900b8ceb89b,0x394d398439ba39ed,0xb9feb9cbb996b95f,0x386738b038f6393a,0xbaaeba7cba47ba0f,0xb913b872b78bb61f,0xba2fbaa7bb0ebb64,0xafd6aa4826482e46,0xbbf1bbfebbffbbf6,0xb42cb1dbaeaaa648,0xbbb9bbddbbf5bbff,0xb64eb505b365b0b2,0xbb5abb99bbc9bbea,0xb828b705b5abb444,0xbad6bb30bb7bbbb6
.quad 0x3be43be63be83bea,0x3147311530e430b2,0x3b913b993ba03ba8,0x3534350534d534a5,0x3b083b1a3b2b3b3b,0x37a1375e371b36d7,0x3a4f3a6d3a8a3aa7,0x38ec38c4389b3872,0x33c634a53564361f,0x3bc33ba83b883b64,0x2d1a304e320d33c6,0x3bf93bed3bdb3bc3,0xad7ea64828b62e46,0x3bf83bff3bff3bf6,0xb3f7b1dbaf72aa48,0x3bc03bdd3bf23bfe
.quad 0x3969399639c339ed,0x39e539ba398d395f,0x385d389b38d83913,0x3ab53a8a3a5e3a2f,0x3665370537a1381d,0x3b553b303b083add,0x3c003c003c003c00,0,0xb67cb564b444b23e,0x3b503b883bb63bd9,0xb867b7b7b693b564,0x3aae3b023b4b3b88,0xb972b8ecb85db78b,0x39dc3a4f3ab53b0e,0xba56b9dcb956b8c4,0x38e2397239f63a6d
.quad 0x3be43be63be83bea,0xb147b115b0e4b0b2,0x3b913b993ba03ba8,0xb534b505b4d5b4a5,0x3b083b1a3b2b3b3b,0xb7a1b75eb71bb6d7,0x3a4f3a6d3a8a3aa7,0xb8ecb8c4b89bb872,0x33c634a53564361f,0xbbc3bba8bb88bb64,0x2d1a304e320d33c6,0xbbf9bbedbbdbbbc3,0xad7ea64828b62e46,0xbbf8bbffbbffbbf6,0xb3f7b1dbaf72aa48,0xbbc0bbddbbf2bbfe
.quad 0x3969399639c339ed,0xb9e5b9bab98db95f,0x385d389b38d83913,0xbab5ba8aba5eba2f,0x3665370537a1381d,0xbb55bb30bb08badd,0xbb0ebaa7ba2fb9a8,0xb78bb872b913b9a8,0xb67cb564b444b23e,0xbb50bb88bbb6bbd9,0xb867b7b7b693b564,0xbaaebb02bb4bbb88,0xb972b8ecb85db78b,0xb9dcba4fbab5bb0e,0xba56b9dcb956b8c4,0xb8e2b972b9f6ba6d
.quad 0x3bdb3bdd3be03be2,0x320d31db31aa3179,0x3b6e3b773b803b88,0x35f135c235933564,0x3abc3ad03ae33af6,0x38523832381237e3,0x39cb39ed3a0f3a2f,0x3984395f393a3913,0x2a482e4630b2323e,0x3bfe3bf63bea3bd9,0xb080ad7ea7da2648,0x3bec3bf83bff3bff,0xb534b444b2a1b0b2,0x3b913bb63bd43bea,0xb7f9b705b608b505,0x3af03b303b693b99
.quad 0x38a638d83909393a,0x3a833a5e3a373a0f,0x36aa373237b7381d,0x3b463b253b023add,0x33963475351d35c2,0x3bc63baf3b953b77,0x3c003c003c003c00,0,0xb93ab8c4b848b78b,0x3a0f3a6d3ac23b0e,0xba47b9dcb969b8ec,0x38f6397239e53a4f,0xbb1abac2ba5eb9ed,0x375e384838d8395f,0xbbabbb6ebb20bac2,0x348d35f137483848
.quad 0x3bdb3bdd3be03be2,0xb20db1dbb1aab179,0x3b6e3b773b803b88,0xb5f1b5c2b593b564,0x3abc3ad03ae33af6,0xb852b832b812b7e3,0x39cb39ed3a0f3a2f,0xb984b95fb93ab913,0x2a482e4630b2323e,0xbbfebbf6bbeabbd9,0xb080ad7ea7da2648,0xbbecbbf8bbffbbff,0xb534b444b2a1b0b2,0xbb91bbb6bbd4bbea,0xb7f9b705b608b505,0xbaf0bb30bb69bb99
.quad 0x38a638d83909393a,0xba83ba5eba37ba0f,0x36aa373237b7381d,0xbb46bb25bb02badd,0x33963475351d35c2,0xbbc6bbafbb95bb77,0xbbf6bbd9bba8bb64,0xae46b23eb4a5b61f,0xb93ab8c4b848b78b,0xba0fba6dbac2bb0e,0xba47b9dcb969b8ec,0xb8f6b972b9e5ba4f,0xbb1abac2ba5eb9ed,0xb75eb848b8d8b95f,0xbbabbb6ebb20bac2,0xb48db5f1b748b848
.quad 0x3c003c003c003c00,0,0x3aa73b643bd93c00,0x3872361f323e0000,0x361f39a83b643c00,0x3b6439a8361f0000,0xb23e361f3aa73c00,0x3bd93b6438720000,0xb9a8000039a83c00,0x39a83c0039a80000,0xbbd9b61f38723c00,0x323e3b643aa70000,0xbb64b9a8361f3c00,0xb61f39a83b640000,0xb872bb64323e3c00,0xbaa7361f3bd90000
.quad 0x8000bc0000003c00,0xbc0000003c000000,0x3872bb64b23e3c00,0xbaa7b61f3bd90000,0x3b64b9a8b61f3c00,0xb61fb9a83b640000,0x3bd9b61fb8723c00,0x323ebb643aa70000,0x39a88000b9a83c00,0x39a8bc0039a80000,0x323e361fbaa73c00,0x3bd9bb6438720000,0xb61f39a8bb643c00,0x3b64b9a8361f0000,0xbaa73b64bbd93c00,0x3872b61f323e0000
.quad 0xbc003c00bc003c00,0x800000000000,0xbaa73b64bbd93c00,0xb872361fb23e0000,0xb61f39a8bb643c00,0xbb6439a8b61f0000,0x323e361fbaa73c00,0xbbd93b64b8720000,0x39a80000b9a83c00,0xb9a83c00b9a80000,0x3bd9b61fb8723c00,0xb23e3b64baa70000,0x3b64b9a8b61f3c00,0x361f39a8bb640000,0x3872bb64b23e3c00,0x3aa7361fbbd90000
.quad 0xbc0080003c00,0x3c000000bc000000,0xb872bb64323e3c00,0x3aa7b61fbbd90000,0xbb64b9a8361f3c00,0x361fb9a8bb640000,0xbbd9b61f38723c00,0xb23ebb64baa70000,0xb9a8800039a83c00,0xb9a8bc00b9a80000,0xb23e361f3aa73c00,0xbbd9bb64b8720000,0x361f39a83b643c00,0xbb64b9a8b61f0000,0x3aa73b643bd93c00,0xb872b61fb23e0000
.quad 0x3c003c003c003c00,0,0x323e361f387239a8,0x3bd93b643aa739a8,0xbb64b9a8b61f0000,0x361f39a83b643c00,0xb872bb64bbd9b9a8,0xbaa7b61f323e39a8,0x39a88000b9a8bc00,0xb9a8bc00b9a80000,0x3aa73b64323eb9a8,0x3872b61fbbd9b9a8,0xb61f39a83b648000,0x3b6439a8b61fbc00,0xbbd9b61f3aa739a8,0xb23e3b643872b9a8
.quad 0x8000bc0000003c00,0xbc0000003c008000,0x3bd9b61fbaa739a8,0xb23ebb64387239a8,0x361f39a8bb640000,0x3b64b9a8b61f3c00,0xbaa73b64b23eb9a8,0x3872361fbbd939a8,0xb9a8000039a8bc00,0xb9a83c00b9a80000,0x3872bb643bd9b9a8,0xbaa7361f323eb9a8,0x3b64b9a8361f8000,0x361fb9a83b64bc00,0xb23e361fb87239a8,0x3bd9bb643aa7b9a8
.quad 0xbc003c00bc003c00,0x800000008000,0xb23e361fb87239a8,0xbbd93b64baa739a8,0x3b64b9a8361f0000,0xb61f39a8bb643c00,0x3872bb643bd9b9a8,0x3aa7b61fb23e39a8,0xb9a8800039a8bc00,0x39a8bc0039a80000,0xbaa73b64b23eb9a8,0xb872b61f3bd9b9a8,0x361f39a8bb648000,0xbb6439a8361fbc00,0x3bd9b61fbaa739a8,0x323e3b64b872b9a8
.quad 0x8000bc0080003c00,0x3c000000bc008000,0xbbd9b61f3aa739a8,0x323ebb64b87239a8,0xb61f39a83b648000,0xbb64b9a8361f3c00,0x3aa73b64323eb9a8,0xb872361f3bd939a8,0x39a88000b9a8bc00,0x39a83c0039a80000,0xb872bb64bbd9b9a8,0x3aa7361fb23eb9a8,0xbb64b9a8b61f8000,0xb61fb9a8bb64bc00,0x323e361f387239a8,0xbbd9bb64baa7b9a8
.quad 0x3c003c003c003c00,0,0xb872b61fb23e0000,0x3aa73b643bd93c00,0xb61fb9a8bb64bc00,0xbb64b9a8b61f0000,0x3bd93b6438728000,0x323eb61fbaa7bc00,0xb9a8000039a83c00,0x39a83c0039a88000,0xb23ebb64baa70000,0xbbd9b61f38723c00,0x3b6439a8b61fbc00,0x361fb9a8bb640000,0xbaa7361f3bd98000,0x38723b64b23ebc00
.quad 0x8000bc0000003c00,0xbc0000003c008000,0x3aa7361fbbd90000,0x3872bb64b23e3c00,0xbb6439a8361fbc00,0x361f39a8bb640000,0x323ebb643aa78000,0xbbd9361f3872bc00,0x39a88000b9a83c00,0x39a8bc0039a88000,0xbbd93b64b8728000,0x323e361fbaa73c00,0x361fb9a83b64bc00,0xbb6439a8b61f0000,0x3872b61f323e8000,0x3aa7bb643bd9bc00
.quad 0xbc003c00bc003c00,0x800000008000,0x3872b61f323e8000,0xbaa73b64bbd93c00,0x361fb9a83b64bc00,0x3b64b9a8361f0000,0xbbd93b64b8728000,0xb23eb61f3aa7bc00,0x39a88000b9a83c00,0xb9a83c00b9a88000,0x323ebb643aa78000,0x3bd9b61fb8723c00,0xbb6439a8361fbc00,0xb61fb9a83b640000,0x3aa7361fbbd98000,0xb8723b64323ebc00
.quad 0xbc0080003c00,0x3c000000bc008000,0xbaa7361f3bd98000,0xb872bb64323e3c00,0x3b6439a8b61fbc00,0xb61f39a83b648000,0xb23ebb64baa78000,0x3bd9361fb872bc00,0xb9a8800039a83c00,0xb9a8bc00b9a88000,0x3bd93b6438728000,0xb23e361f3aa73c00,0xb61fb9a8bb64bc00,0x3b6439a8361f0000,0xb872b61fb23e8000,0xbaa7bb64bbd9bc00
.quad 0x3c003c003c003c00,0,0xbbd9bb64baa7b9a8,0x323e361f387239a8,0x3b6439a8361f8000,0xb61fb9a8bb64bc00,0xbaa7b61f323e39a8,0x38723b643bd939a8,0x39a88000b9a8bc00,0xb9a8bc00b9a80000,0xb872361f3bd939a8,0x3aa73b64323eb9a8,0x361fb9a8bb640000,0xbb64b9a8361f3c00,0xb23e3b643872b9a8,0x3bd9361fbaa7b9a8
.quad 0x8000bc0080003c00,0xbc0000003c008000,0x323e3b64b872b9a8,0x3bd9b61fbaa739a8,0xb61fb9a83b648000,0xbb6439a8361fbc00,0x3872361fbbd939a8,0x3aa7bb64323e39a8,0xb9a8800039a8bc00,0xb9a83c00b9a80000,0x3aa7b61fb23e39a8,0x3872bb643bd9b9a8,0xbb6439a8b61f8000,0xb61f39a8bb643c00,0x3bd9bb643aa7b9a8,0x323eb61f3872b9a8
.quad 0xbc003c00bc003c00,0x800080008000,0x3bd9bb643aa7b9a8,0xb23e361fb87239a8,0xbb6439a8b61f8000,0x361fb9a83b64bc00,0x3aa7b61fb23e39a8,0xb8723b64bbd939a8,0xb9a8800039a8bc00,0x39a8bc0039a80000,0x3872361fbbd939a8,0xbaa73b64b23eb9a8,0xb61fb9a83b640000,0x3b64b9a8b61f3c00,0x323e3b64b872b9a8,0xbbd9361f3aa7b9a8
.quad 0xbc0000003c00,0x3c008000bc008000,0xb23e3b643872b9a8,0xbbd9b61f3aa739a8,0x361fb9a8bb648000,0x3b6439a8b61fbc00,0xb872361f3bd939a8,0xbaa7bb64b23e39a8,0x39a80000b9a8bc00,0x39a83c0039a88000,0xbaa7b61f323e39a8,0xb872bb64bbd9b9a8,0x3b6439a8361f0000,0x361f39a83b643c00,0xbbd9bb64baa7b9a8,0xb23eb61fb872b9a8
.quad 0x3c003c003c003c00,0,0xbaa7bb64bbd9bc00,0xb872b61fb23e0000,0x361f39a83b643c00,0x3b6439a8361f8000,0x323eb61fbaa7bc00,0xbbd9bb64b8720000,0xb9a8000039a83c00,0x39a83c0039a88000,0x3bd9361fb872bc00,0xb23ebb64baa70000,0xbb64b9a8361f3c00,0xb61f39a83b648000,0x38723b64b23ebc00,0x3aa7b61fbbd90000
.quad 0x8000bc0080003c00,0xbc0000003c008000,0xb8723b64323ebc00,0x3aa7361fbbd90000,0x3b64b9a8b61f3c00,0xb61fb9a83b648000,0xbbd9361f3872bc00,0xb23e3b64baa70000,0x39a88000b9a83c00,0x39a8bc0039a88000,0xb23eb61f3aa7bc00,0xbbd93b64b8728000,0xb61f39a8bb643c00,0x3b64b9a8361f8000,0x3aa7bb643bd9bc00,0xb872361fb23e0000
.quad 0xbc003c00bc003c00,0x800080008000,0x3aa7bb643bd9bc00,0x3872b61f323e8000,0xb61f39a8bb643c00,0xbb6439a8b61f8000,0xb23eb61f3aa7bc00,0x3bd9bb6438720000,0x39a80000b9a83c00,0xb9a83c00b9a88000,0xbbd9361f3872bc00,0x323ebb643aa78000,0x3b64b9a8b61f3c00,0x361f39a8bb648000,0xb8723b64323ebc00,0xbaa7b61f3bd90000
.quad 0xbc0000003c00,0x3c000000bc008000,0x38723b64b23ebc00,0xbaa7361f3bd98000,0xbb64b9a8361f3c00,0x361fb9a8bb640000,0x3bd9361fb872bc00,0x323e3b643aa70000,0xb9a8000039a83c00,0xb9a8bc00b9a88000,0x323eb61fbaa7bc00,0x3bd93b6438728000,0x361f39a83b643c00,0xbb64b9a8b61f8000,0xbaa7bb64bbd9bc00,0x3872361f323e0000
.quad 0x3c003c003c003c00,0,0xb23eb61fb872b9a8,0xbbd9bb64baa7b9a8,0xbb64b9a8b61f0000,0x361f39a83b643c00,0x38723b643bd939a8,0x3aa7361fb23eb9a8,0x39a88000b9a8bc00,0xb9a8bc00b9a80000,0xbaa7bb64b23e39a8,0xb872361f3bd939a8,0xb61f39a83b648000,0x3b6439a8b61fbc00,0x3bd9361fbaa7b9a8,0x323ebb64b87239a8
.quad 0x8000bc0080003c00,0xbc0000003c008000,0xbbd9361f3aa7b9a8,0x323e3b64b872b9a8,0x361f39a8bb648000,0x3b64b9a8b61f3c00,0x3aa7bb64323e39a8,0xb872b61f3bd9b9a8,0xb9a8000039a8bc00,0xb9a83c00b9a80000,0xb8723b64bbd939a8,0x3aa7b61fb23e39a8,0x3b64b9a8361f8000,0x361fb9a83b64bc00,0x323eb61f3872b9a8,0xbbd93b64baa739a8
.quad 0xbc003c00bc003c00,0x800080008000,0x323eb61f3872b9a8,0x3bd9bb643aa7b9a8,0x3b64b9a8361f0000,0xb61f39a8bb643c00,0xb8723b64bbd939a8,0xbaa7361f323eb9a8,0xb9a8800039a8bc00,0x39a8bc0039a88000,0x3aa7bb64323e39a8,0x3872361fbbd939a8,0x361f39a8bb640000,0xbb6439a8361fbc00,0xbbd9361f3aa7b9a8,0xb23ebb64387239a8
.quad 0xbc0000003c00,0x3c000000bc008000,0x3bd9361fbaa7b9a8,0xb23e3b643872b9a8,0xb61f39a83b640000,0xbb64b9a8361f3c00,0xbaa7bb64b23e39a8,0x3872b61fbbd9b9a8,0x39a80000b9a8bc00,0x39a83c0039a80000,0x38723b643bd939a8,0xbaa7b61f323e39a8,0xbb64b9a8b61f8000,0xb61fb9a8bb64bc00,0xb23eb61fb872b9a8,0x3bd93b643aa739a8
.quad 0x3c003c003c003c00,0,0x3872361f323e8000,0xbaa7bb64bbd9bc00,0xb61fb9a8bb64bc00,0xbb64b9a8b61f0000,0xbbd9bb64b8720000,0xb23e361f3aa73c00,0xb9a8800039a83c00,0x39a83c0039a88000,0x323e3b643aa78000,0x3bd9361fb872bc00,0x3b6439a8b61fbc00,0x361fb9a8bb640000,0x3aa7b61fbbd98000,0xb872bb64323e3c00
.quad 0x8000bc0080003c00,0xbc0080003c008000,0xbaa7b61f3bd98000,0xb8723b64323ebc00,0xbb6439a8361fbc00,0x361f39a8bb640000,0xb23e3b64baa70000,0x3bd9b61fb8723c00,0x39a80000b9a83c00,0x39a8bc0039a88000,0x3bd9bb6438728000,0xb23eb61f3aa7bc00,0x361fb9a83b64bc00,0xbb6439a8b61f8000,0xb872361fb23e0000,0xbaa73b64bbd93c00
.quad 0xbc003c00bc003c00,0x80008000,0xb872361fb23e8000,0x3aa7bb643bd9bc00,0x361fb9a83b64bc00,0x3b64b9a8361f0000,0x3bd9bb6438720000,0x323e361fbaa73c00,0x39a88000b9a83c00,0xb9a83c00b9a88000,0xb23e3b64baa70000,0xbbd9361f3872bc00,0xbb6439a8361fbc00,0xb61fb9a83b640000,0xbaa7b61f3bd90000,0x3872bb64b23e3c00
.quad 0xbc0080003c00,0x3c008000bc008000,0x3aa7b61fbbd98000,0x38723b64b23ebc00,0x3b6439a8b61fbc00,0xb61f39a83b640000,0x323e3b643aa70000,0xbbd9b61f38723c00,0xb9a8000039a83c00,0xb9a8bc00b9a80000,0xbbd9bb64b8728000,0x323eb61fbaa7bc00,0xb61fb9a8bb64bc00,0x3b6439a8361f0000,0x3872361f323e0000,0x3aa73b643bd93c00
.quad 0x3c003c003c003c00,0,0x3bd93b643aa739a8,0xb23eb61fb872b9a8,0x3b6439a8361f8000,0xb61fb9a8bb64bc00,0x3aa7361fb23eb9a8,0xb872bb64bbd9b9a8,0x39a88000b9a8bc00,0xb9a8bc00b9a80000,0x3872b61fbbd9b9a8,0xbaa7bb64b23e39a8,0x361fb9a8bb648000,0xbb64b9a8361f3c00,0x323ebb64b87239a8,0xbbd9b61f3aa739a8
.quad 0x8000bc0080003c00,0xbc0000003c008000,0xb23ebb64387239a8,0xbbd9361f3aa7b9a8,0xb61fb9a83b648000,0xbb6439a8361fbc00,0xb872b61f3bd9b9a8,0xbaa73b64b23eb9a8,0xb9a8000039a8bc00,0xb9a83c00b9a88000,0xbaa7361f323eb9a8,0xb8723b64bbd939a8,0xbb6439a8b61f0000,0xb61f39a8bb643c00,0xbbd93b64baa739a8,0xb23e361fb87239a8
.quad 0xbc003c00bc003c00,0x800080008000,0xbbd93b64baa739a8,0x323eb61f3872b9a8,0xbb6439a8b61f0000,0x361fb9a83b64bc00,0xbaa7361f323eb9a8,0x3872bb643bd9b9a8,0xb9a8800039a8bc00,0x39a8bc0039a80000,0xb872b61f3bd9b9a8,0x3aa7bb64323e39a8,0xb61fb9a83b640000,0x3b64b9a8b61f3c00,0xb23ebb64387239a8,0x3bd9b61fbaa739a8
.quad 0xbc0080003c00,0x3c000000bc000000,0x323ebb64b87239a8,0x3bd9361fbaa7b9a8,0x361fb9a8bb648000,0x3b6439a8b61fbc00,0x3872b61fbbd9b9a8,0x3aa73b64323eb9a8,0x39a80000b9a8bc00,0x39a83c0039a80000,0x3aa7361fb23eb9a8,0x38723b643bd939a8,0x3b6439a8361f8000,0x361f39a83b643c00,0x3bd93b643aa739a8,0x323e361f387239a8
.quad 0xf7000000f2c0,0xf92e0000f70e,0xf4e00000f2d0,0xf4ee0000f2de,0xf4f00000f2e0,0xf4fe0000f2ee,0xf5000000f2f0,0xf50e0000f2fe,0xf5100000f300,0xf51e0000f30e,0xf5200000f310,0xf52e0000f31e,0xf5300000f320,0xf53e0000f32e,0xf5400000f330,0xf54e0000f33e
.quad 0xf5500000f340,0xf55e0000f34e,0xf5600000f350,0xf56e0000f35e,0xf5700000f360,0xf57e0000f36e,0xf5800000f370,0xf58e0000f37e,0xf5900000f380,0xf59e0000f38e,0xf5a00000f390,0xf5ae0000f39e,0xf5b00000f3a0,0xf5be0000f3ae,0xf5c00000f3b0,0xf5ce0000f3be
.quad 0xf4d00000f910,0xf4de0000f6e0,0xf7f00000fa00,0xf91e0000f7fe,0xf7e00000f9f0,0xfa0e0000f7ee,0xf7d00000f9e0,0xf9fe0000f7de,0xf7c00000f9d0,0xf9ee0000f7ce,0xf7b00000f9c0,0xf9de0000f7be,0xf7a00000f9b0,0xf9ce0000f7ae,0xf7900000f9a0,0xf9be0000f79e
.quad 0xf7800000f990,0xf9ae0000f78e,0xf7700000f980,0xf99e0000f77e,0xf7600000f970,0xf98e0000f76e,0xf7500000f960,0xf97e0000f75e,0xf7400000f950,0xf96e0000f74e,0xf7300000f940,0xf95e0000f73e,0xf7200000f930,0xf94e0000f72e,0xf7100000f920,0xf93e0000f71e
.quad 0xf8000000f3c0,0xf80e0000f3ce,0xf5e00000f3d0,0xf5ee0000f3de,0xf5f00000f3e0,0xf5fe0000f3ee,0xf6000000f3f0,0xf60e0000f3fe,0xf6100000f400,0xf61e0000f40e,0xf6200000f410,0xf62e0000f41e,0xf6300000f420,0xf63e0000f42e,0xf6400000f430,0xf64e0000f43e
.quad 0xf6500000f440,0xf65e0000f44e,0xf6600000f450,0xf66e0000f45e,0xf6700000f460,0xf67e0000f46e,0xf6800000f470,0xf68e0000f47e,0xf6900000f480,0xf69e0000f48e,0xf6a00000f490,0xf6ae0000f49e,0xf6b00000f4a0,0xf6be0000f4ae,0xf6c00000f4b0,0xf6ce0000f4be
.quad 0xf5d00000fa10,0xf5de0000fa1e,0xf8f00000fb00,0xf8fe0000fb0e,0xf8e00000faf0,0xf8ee0000fafe,0xf8d00000fae0,0xf8de0000faee,0xf8c00000fad0,0xf8ce0000fade,0xf8b00000fac0,0xf8be0000face,0xf8a00000fab0,0xf8ae0000fabe,0xf8900000faa0,0xf89e0000faae
.quad 0xf8800000fa90,0xf88e0000fa9e,0xf8700000fa80,0xf87e0000fa8e,0xf8600000fa70,0xf86e0000fa7e,0xf8500000fa60,0xf85e0000fa6e,0xf8400000fa50,0xf84e0000fa5e,0xf8300000fa40,0xf83e0000fa4e,0xf8200000fa30,0xf82e0000fa3e,0xf8100000fa20,0xf81e0000fa2e
.quad 0xc00000000000,0,0xc01000000010,0x8000000010,0xc02000000020,0x1000000020,0xc03000000030,0x9000000030,0xc04000000040,0x800000040,0xc05000000050,0x8800000050,0xc06000000060,0x1800000060,0xc07000000070,0x9800000070
.quad 0xc08000000080,0x14000000080,0xc09000000090,0x1c000000090,0xc0a0000000a0,0x150000000a0,0xc0b0000000b0,0x1d0000000b0,0xc0c0000000c0,0x148000000c0,0xc0d0000000d0,0x1c8000000d0,0xc0e0000000e0,0x158000000e0,0xc0f0000000f0,0x1d8000000f0
.quad 0x800000004000,0x2000000140,0x801000004010,0xa000000150,0x802000004020,0x3000000160,0x803000004030,0xb000000170,0x804000004040,0x2800000100,0x805000004050,0xa800000110,0x806000004060,0x3800000120,0x807000004070,0xb800000130
.quad 0x808000004080,0x160000001c0,0x809000004090,0x1e0000001d0,0x80a0000040a0,0x170000001e0,0x80b0000040b0,0x1f0000001f0,0x80c0000040c0,0x16800000180,0x80d0000040d0,0x1e800000190,0x80e0000040e0,0x178000001a0,0x80f0000040f0,0x1f8000001b0
.quad 0x400000008000,0x40000000200,0x401000008010,0x48000000210,0x402000008020,0x41000000220,0x403000008030,0x49000000230,0x404000008040,0x40800000240,0x405000008050,0x48800000250,0x406000008060,0x41800000260,0x407000008070,0x49800000270
.quad 0x408000008080,0x54000000280,0x409000008090,0x5c000000290,0x40a0000080a0,0x550000002a0,0x40b0000080b0,0x5d0000002b0,0x40c0000080c0,0x548000002c0,0x40d0000080d0,0x5c8000002d0,0x40e0000080e0,0x558000002e0,0x40f0000080f0,0x5d8000002f0
.quad 0xc000,0x42000000340,0x100000c010,0x4a000000350,0x200000c020,0x43000000360,0x300000c030,0x4b000000370,0x400000c040,0x42800000300,0x500000c050,0x4a800000310,0x600000c060,0x43800000320,0x700000c070,0x4b800000330
.quad 0x800000c080,0x560000003c0,0x900000c090,0x5e0000003d0,0xa00000c0a0,0x570000003e0,0xb00000c0b0,0x5f0000003f0,0xc00000c0c0,0x56800000380,0xd00000c0d0,0x5e800000390,0xe00000c0e0,0x578000003a0,0xf00000c0f0,0x5f8000003b0
.quad 0,0x8000000000,0x9000000000,0x11000000010,0x12000000000,0x1a000000020,0x1b000000000,0x23000000030,0x24000000000,0x2c000000040,0x2d000000000,0x35000000050,0x36000000000,0x3e000000060,0x3f000000000,0x47000000070
.quad 0x48000000000,0x50000000090,0x51000000000,0x590000000a0,0x5a000000000,0x620000000b0,0x63000000000,0x6b0000000c0,0x6c000000000,0x740000000d0,0x75000000000,0x7d0000000e0,0x7e000000000,0x860000000f0,0x87000000000,0x8f000000100
.quad 0x90000000000,0x98000000120,0x99000000000,0xa1000000130,0xa2000000000,0xaa000000140,0xab000000000,0xb3000000150,0xb4000000000,0xbc000000160,0xbd000000000,0xc5000000170,0xc6000000000,0xce000000180,0xcf000000000,0xd7000000190
.quad 0xd8000000000,0xe00000001b0,0xe1000000000,0xe90000001c0,0xea000000000,0xf20000001d0,0xf3000000000,0xfb0000001e0,0xfc000000000,0x1040000001f0,0x105000000000,0x10d000000200,0x10e000000000,0x116000000210,0x117000000000,0x11f000000220
.quad 0x4000000010,0x8000000240,0xd000000010,0x11000000250,0x16000000010,0x1a000000260,0x1f000000010,0x23000000270,0x28000000010,0x2c000000280,0x31000000010,0x35000000290,0x3a000000010,0x3e0000002a0,0x43000000010,0x470000002b0
.quad 0x4c000000010,0x500000002d0,0x55000000010,0x590000002e0,0x5e000000010,0x620000002f0,0x67000000010,0x6b000000300,0x70000000010,0x74000000310,0x79000000010,0x7d000000320,0x82000000010,0x86000000330,0x8b000000010,0x8f000000340
.quad 0x94000000010,0x98000000360,0x9d000000010,0xa1000000370,0xa6000000010,0xaa000000380,0xaf000000010,0xb3000000390,0xb8000000010,0xbc0000003a0,0xc1000000010,0xc50000003b0,0xca000000010,0xce0000003c0,0xd3000000010,0xd70000003d0
.quad 0xdc000000010,0xe00000003f0,0xe5000000010,0xe9000000400,0xee000000010,0xf2000000410,0xf7000000010,0xfb000000420,0x100000000010,0x104000000430,0x109000000010,0x10d000000440,0x112000000010,0x116000000450,0x11b000000010,0x11f000000460
.quad 0x7000000000,0x800000000000,0x7000000000,0xfe0000000200,0x7000000000,0xfc0000000400,0x7000000000,0xfa0000000600,0x7000000000,0xf80000000800,0x7000000000,0xf60000000a00,0x7000000000,0xf40000000c00,0x7000000000,0xf20000000e00
.quad 0x6000000010,0xf00000001000,0x6000000010,0xee0000001200,0x6000000010,0xec0000001400,0x6000000010,0xea0000001600,0x6000000010,0xe80000001800,0x6000000010,0xe60000001a00,0x6000000010,0xe40000001c00,0x6000000010,0xe20000001e00
.quad 0x5000000020,0xe00000002000,0x5000000020,0xde0000002200,0x5000000020,0xdc0000002400,0x5000000020,0xda0000002600,0x5000000020,0xd80000002800,0x5000000020,0xd60000002a00,0x5000000020,0xd40000002c00,0x5000000020,0xd20000002e00
.quad 0x4000000030,0xd00000003000,0x4000000030,0xce0000003200,0x4000000030,0xcc0000003400,0x4000000030,0xca0000003600,0x4000000030,0xc80000003800,0x4000000030,0xc60000003a00,0x4000000030,0xc40000003c00,0x4000000030,0xc20000003e00
.quad 0x3000000040,0xc00000004000,0x3000000040,0xbe0000004200,0x3000000040,0xbc0000004400,0x3000000040,0xba0000004600,0x3000000040,0xb80000004800,0x3000000040,0xb60000004a00,0x3000000040,0xb40000004c00,0x3000000040,0xb20000004e00
.quad 0x2000000050,0xb00000005000,0x2000000050,0xae0000005200,0x2000000050,0xac0000005400,0x2000000050,0xaa0000005600,0x2000000050,0xa80000005800,0x2000000050,0xa60000005a00,0x2000000050,0xa40000005c00,0x2000000050,0xa20000005e00
.quad 0x1000000060,0xa00000006000,0x1000000060,0x9e0000006200,0x1000000060,0x9c0000006400,0x1000000060,0x9a0000006600,0x1000000060,0x980000006800,0x1000000060,0x960000006a00,0x1000000060,0x940000006c00,0x1000000060,0x920000006e00
.quad 0x70,0x900000007000,0x70,0x8e0000007200,0x70,0x8c0000007400,0x70,0x8a0000007600,0x70,0x880000007800,0x70,0x860000007a00,0x70,0x840000007c00,0x70,0x820000007e00
.quad 0xf2c0,0,0x100000f4d0,0x10,0x100000f2c0,0x20,0x200000f4d0,0x30,0xf700,0x40,0x100000f910,0x50,0x100000f700,0x60,0x200000f910,0x70
.quad 0xfb40,0x80,0x100000fd50,0x90,0x100000fb40,0xa0,0x200000fd50,0xc2000000000000b0,0xff80,0xc0,0x1000010190,0xd0,0x100000ff80,0xe0,0x2000010190,0xf0
.quad 0x114c0,0x1000,0x10000116d0,0x1010,0x10000114c0,0x1020,0x20000116d0,0x1030,0x11900,0x1040,0x1000011b10,0x1050,0x1000011900,0x1060,0x2000011b10,0x1070
.quad 0x11d40,0x1080,0x1000011f50,0x1090,0x1000011d40,0x10a0,0x2000011f50,0x10b0,0x12180,0x10c0,0x1000012390,0x10d0,0x1000012180,0x10e0,0x2000012390,0x10f0
.quad 0xf2c0,0x2000,0x100000f4d0,0x2010,0x100000f2c0,0x2020,0x200000f4d0,0x2030,0xf700,0x2040,0x100000f910,0x2050,0x100000f700,0x2060,0x200000f910,0x2070
.quad 0xfb40,0x2080,0x100000fd50,0x2090,0x100000fb40,0x20a0,0x200000fd50,0xc2000000000020b0,0xff80,0x20c0,0x1000010190,0x20d0,0x100000ff80,0x20e0,0x2000010190,0x20f0
.quad 0xf2c0,0x3000,0x100000f4d0,0x3010,0x100000f2c0,0x3020,0x200000f4d0,0x3030,0xf700,0x3040,0x100000f910,0x3050,0x100000f700,0x3060,0x200000f910,0x3070
.quad 0xfb40,0x3080,0x100000fd50,0x3090,0x100000fb40,0x30a0,0x200000fd50,0x30b0,0xff80,0x30c0,0x1000010190,0x30d0,0x100000ff80,0x30e0,0x2000010190,0x30f0
.quad 0xf72e0000f2ee,0,0xf74e0000f30e,0x8,0xf76e0000f32e,0x10,0xf78e0000f34e,0x18,0xf7ae0000f36e,0x20,0xf7ce0000f38e,0x28,0xf7ee0000f3ae,0x30,0xf6e00000f6e0,0x38
.quad 0xf72e0000f2ee,0x40,0xf74e0000f30e,0x48,0xf76e0000f32e,0x50,0xf78e0000f34e,0x58,0xf7ae0000f36e,0x60,0xf7ce0000f38e,0x68,0xf7ee0000f3ae,0x70,0xf6e00000f6e0,0x78
.quad 0x1192e000114ee,0x80,0x1194e0001150e,0x88,0x1196e0001152e,0x90,0x1198e0001154e,0x98,0x119ae0001156e,0xa0,0x119ce0001158e,0xa8,0x119ee000115ae,0xb0,0x118e0000118e0,0xb8
.quad 0x1192e000114ee,0xc0,0x1194e0001150e,0xc8,0x1196e0001152e,0xd0,0x1198e0001154e,0xd8,0x119ae0001156e,0xe0,0x119ce0001158e,0xe8,0x119ee000115ae,0xf0,0x118e0000118e0,0xf8
.quad 0xf72e0000f2ee,0x100,0xf74e0000f30e,0x108,0xf76e0000f32e,0x110,0xf78e0000f34e,0x118,0xf7ae0000f36e,0x120,0xf7ce0000f38e,0x128,0xf7ee0000f3ae,0x130,0xf6e00000f6e0,0x138
.quad 0xf72e0000f2ee,0x140,0xf74e0000f30e,0x148,0xf76e0000f32e,0x150,0xf78e0000f34e,0x158,0xf7ae0000f36e,0x160,0xf7ce0000f38e,0x168,0xf7ee0000f3ae,0x170,0xf6e00000f6e0,0x178
.quad 0xf72e0000f2ee,0x180,0xf74e0000f30e,0x188,0xf76e0000f32e,0x190,0xf78e0000f34e,0x198,0xf7ae0000f36e,0x1a0,0xf7ce0000f38e,0x1a8,0xf7ee0000f3ae,0x1b0,0xf6e00000f6e0,0x1b8
.quad 0xf72e0000f2ee,0x1c0,0xf74e0000f30e,0x1c8,0xf76e0000f32e,0x1d0,0xf78e0000f34e,0x1d8,0xf7ae0000f36e,0x1e0,0xf7ce0000f38e,0x1e8,0xf7ee0000f3ae,0x1f0,0xf6e00000f6e0,0x1f8
.quad 0xf2c0,0,0x100000f4d0,0x10,0x100000f2c0,0x20,0x200000f4d0,0x30,0xf700,0x40,0x100000f910,0x50,0x100000f700,0x60,0x200000f910,0x70
.quad 0xfb40,0x80,0x100000fd50,0x90,0x100000fb40,0xa0,0x200000fd50,0xc2000000000000b0,0xff80,0xc0,0x1000010190,0xd0,0x100000ff80,0xe0,0x2000010190,0xf0
.quad 0x114c0,0x1000,0x10000116d0,0x1010,0x10000114c0,0x1020,0x20000116d0,0x1030,0x11900,0x1040,0x1000011b10,0x1050,0x1000011900,0x1060,0x2000011b10,0x1070
.quad 0x11d40,0x1080,0x1000011f50,0x1090,0x1000011d40,0x10a0,0x2000011f50,0x10b0,0x12180,0x10c0,0x1000012390,0x10d0,0x1000012180,0x10e0,0x2000012390,0x10f0
.quad 0xea40,0x2000,0x100000ec50,0x2010,0x100000ea40,0x2020,0x200000ec50,0x2030,0xee80,0x2040,0x100000f090,0x2050,0x100000ee80,0x2060,0x200000f090,0x2070
.quad 0xf2c0,0x2080,0x100000f4d0,0x2090,0x100000f2c0,0x20a0,0x200000f4d0,0xc2000000000020b0,0xf700,0x20c0,0x100000f910,0x20d0,0x100000f700,0x20e0,0x200000f910,0x20f0
.quad 0xf2c0,0x3000,0x100000f4d0,0x3010,0x100000f2c0,0x3020,0x200000f4d0,0x3030,0xf700,0x3040,0x100000f910,0x3050,0x100000f700,0x3060,0x200000f910,0x3070
.quad 0xfb40,0x3080,0x100000fd50,0x3090,0x100000fb40,0x30a0,0x200000fd50,0x30b0,0xff80,0x30c0,0x1000010190,0x30d0,0x100000ff80,0x30e0,0x2000010190,0x30f0
.quad 0xf72e0000f2ee,0,0xf74e0000f30e,0x8,0xf76e0000f32e,0x10,0xf78e0000f34e,0x18,0xf7ae0000f36e,0x20,0xf7ce0000f38e,0x28,0xf7ee0000f3ae,0x30,0xf6e00000f6e0,0x38
.quad 0xf72e0000f2ee,0x40,0xf74e0000f30e,0x48,0xf76e0000f32e,0x50,0xf78e0000f34e,0x58,0xf7ae0000f36e,0x60,0xf7ce0000f38e,0x68,0xf7ee0000f3ae,0x70,0xf6e00000f6e0,0x78
.quad 0x1192e000114ee,0x80,0x1194e0001150e,0x88,0x1196e0001152e,0x90,0x1198e0001154e,0x98,0x119ae0001156e,0xa0,0x119ce0001158e,0xa8,0x119ee000115ae,0xb0,0x118e0000118e0,0xb8
.quad 0x1192e000114ee,0xc0,0x1194e0001150e,0xc8,0x1196e0001152e,0xd0,0x1198e0001154e,0xd8,0x119ae0001156e,0xe0,0x119ce0001158e,0xe8,0x119ee000115ae,0xf0,0x118e0000118e0,0xf8
.quad 0xeeae0000ea6e,0x100,0xeece0000ea8e,0x108,0xeeee0000eaae,0x110,0xef0e0000eace,0x118,0xef2e0000eaee,0x120,0xef4e0000eb0e,0x128,0xef6e0000eb2e,0x130,0xee600000ee60,0x138
.quad 0xeeae0000ea6e,0x140,0xeece0000ea8e,0x148,0xeeee0000eaae,0x150,0xef0e0000eace,0x158,0xef2e0000eaee,0x160,0xef4e0000eb0e,0x168,0xef6e0000eb2e,0x170,0xee600000ee60,0x178
.quad 0xf72e0000f2ee,0x180,0xf74e0000f30e,0x188,0xf76e0000f32e,0x190,0xf78e0000f34e,0x198,0xf7ae0000f36e,0x1a0,0xf7ce0000f38e,0x1a8,0xf7ee0000f3ae,0x1b0,0xf6e00000f6e0,0x1b8
.quad 0xf72e0000f2ee,0x1c0,0xf74e0000f30e,0x1c8,0xf76e0000f32e,0x1d0,0xf78e0000f34e,0x1d8,0xf7ae0000f36e,0x1e0,0xf7ce0000f38e,0x1e8,0xf7ee0000f3ae,0x1f0,0xf6e00000f6e0,0x1f8
.quad 0x8000280028002800,0x8000280080002800,0x964827fea8002800,0x9cb227ea9a4627f6,0x9a4627f628002800,0xa0a527a89e3e27d9,0x9cb227eaa8002800,0xa2d7273ba0a527a8,0x9e3e27d928002800,0xa47226a7a21f2764,0x9fc627c3a8002800,0xa55f25eda38b270e,0xa0a527a828002800,0xa62f2513a47226a7,0xa1642788a8002800,0xa6dd241da513262f
.quad 0xa21f276428002800,0xa764221fa5a825a8,0xa2d7273ba8002800,0xa7c31fc6a62f2513,0xa38b270e28002800,0xa7f61a46a6a72472,0xa41d26dda8002800,0xa7fe9648a70e238b,0xa47226a728002800,0xa7d99e3ea764221f,0xa4c4266da8002800,0xa788a164a7a820a5,0xa513262f28002800,0xa70ea38ba7d91e3e,0xa55f25eda8002800,0xa66da4c4a7f61a46
.quad 0xa5a825a828002800,0xa5a8a5a8a8000000,0xa5ed255fa8002800,0xa4c4a66da7f69a46,0xa62f251328002800,0xa38ba70ea7d99e3e,0xa66d24c4a8002800,0xa164a788a7a8a0a5,0xa6a7247228002800,0x9e3ea7d9a764a21f,0xa6dd241da8002800,0x9648a7fea70ea38b,0xa70e238b28002800,0x1a46a7f6a6a7a472,0xa73b22d7a8002800,0x1fc6a7c3a62fa513
.quad 0xa764221f28002800,0x221fa764a5a8a5a8,0xa7882164a8002800,0x241da6dda513a62f,0xa7a820a528002800,0x2513a62fa472a6a7,0xa7c31fc6a8002800,0x25eda55fa38ba70e,0xa7d91e3e28002800,0x26a7a472a21fa764,0xa7ea1cb2a8002800,0x273ba2d7a0a5a7a8,0xa7f61a4628002800,0x27a8a0a59e3ea7d9,0xa7fe1648a8002800,0x27ea9cb29a46a7f6
.quad 0x8000280080002800,0x8000280080002800,0x9fc627c39e3e27d9,0xa1642788a0a527a8,0xa38b270ea21f2764,0xa513262fa47226a7,0xa55f25eda47226a7,0xa6dd241da62f2513,0xa6a72472a5a825a8,0xa7d91e3ea764221f,0xa7882164a6a72472,0xa7ea9cb2a7f61a46,0xa7f61a46a764221f,0xa70ea38ba7d99e3e,0xa7ea9cb2a7d91e3e,0xa55fa5eda70ea38b
.quad 0xa764a21fa8000000,0xa21fa764a5a8a5a8,0xa66da4c4a7d99e3e,0x9648a7fea38ba70e,0xa513a62fa764a21f,0x20a5a7a89e3ea7d9,0xa2d7a73ba6a7a472,0x24c4a66d1a46a7f6,0x9e3ea7d9a5a8a5a8,0x26a7a472221fa764,0x1648a7fea472a6a7,0x27c39fc62513a62f,0x20a5a7a8a21fa764,0x27f61a4626a7a472,0x241da6dd9e3ea7d9,0x273b22d727a8a0a5
.quad 0x25a8a5a88000a800,0x25a825a828008000,0x26dda41d1e3ea7d9,0x22d7273b27a820a5,0x27a8a0a5221fa764,0x1a4627f626a72472,0x27fe96482472a6a7,0x9fc627c32513262f,0x27d91e3e25a8a5a8,0xa47226a7221f2764,0x273b22d726a7a472,0xa66d24c41a4627f6,0x262f25132764a21f,0xa7a820a59e3e27d9,0x24c4266d27d99e3e,0xa7fe9648a38b270e
.quad 0x221f276428008000,0xa764a21fa5a825a8,0x1cb227ea27d91e3e,0xa5eda55fa70e238b,0x9a4627f62764221f,0xa38ba70ea7d91e3e,0xa164278826a72472,0x9cb2a7eaa7f69a46,0xa47226a725a825a8,0x1e3ea7d9a764a21f,0xa5ed255f247226a7,0x241da6dda62fa513,0xa70e238b221f2764,0x262fa513a472a6a7,0xa7c31fc61e3e27d9,0x2788a164a0a5a7a8
.quad 0x8000280080002800,0x8000280080002800,0xa2d7273ba21f2764,0xa41d26dda38b270e,0xa62f2513a5a825a8,0xa70e238ba6a72472,0xa7c31fc6a764221f,0xa7fe9648a7f61a46,0xa7d99e3ea8000000,0xa6a7a472a764a21f,0xa66da4c4a764a21f,0xa2d7a73ba513a62f,0xa38ba70ea5a8a5a8,0x1a46a7f69e3ea7d9,0x9648a7fea21fa764,0x24c4a66d20a5a7a8
.quad 0x221fa7648000a800,0x2764a21f25a8a5a8,0x25eda55f221fa764,0x27ea1cb227a8a0a5,0x27a8a0a525a8a5a8,0x262f251327d91e3e,0x27ea1cb22764a21f,0x21642788262f2513,0x26a7247228008000,0x9e3e27d9221f2764,0x241d26dd2764221f,0xa55f25ed9a4627f6,0x1a4627f625a825a8,0xa7a820a5a47226a7,0xa1642788221f2764,0xa7c39fc6a70e238b
.quad 0xa5a825a800002800,0xa5a8a5a8a8000000,0xa7882164a21f2764,0x9fc6a7c3a70ea38b,0xa7f69a46a5a825a8,0x20a5a7a8a472a6a7,0xa6dda41da764221f,0x25eda55f9a46a7f6,0xa472a6a7a8000000,0x27d99e3e221fa764,0x9cb2a7eaa764a21f,0x27882164262fa513,0x20a5a7a8a5a8a5a8,0x2513262f27d99e3e,0x255fa5eda21fa764,0x1cb227ea27a820a5
.quad 0x2764a21f8000a800,0xa21f276425a825a8,0x27fe1648221fa764,0xa66d24c420a527a8,0x270e238b25a8a5a8,0xa7f61a469e3e27d9,0x24c4266d2764a21f,0xa73ba2d7a513262f,0x1e3e27d928008000,0xa472a6a7a764221f,0x9fc627c32764221f,0x9648a7fea7f69a46,0xa513262f25a825a8,0x238ba70ea6a7a472,0xa73b22d7221f2764,0x26dda41da38ba70e
.quad 0x8000280080002800,0x8000280080002800,0xa4c4266da47226a7,0xa55f25eda513262f,0xa7a820a5a764221f,0xa7f61a46a7d91e3e,0xa788a164a7d99e3e,0xa66da4c4a70ea38b,0xa472a6a7a5a8a5a8,0x9e3ea7d9a21fa764,0x1648a7fe9e3ea7d9,0x241da6dd20a5a7a8,0x2513a62f221fa764,0x27a8a0a526a7a472,0x27c39fc626a7a472,0x273b22d727f61a46
.quad 0x2764221f28008000,0x221f276425a825a8,0x241d26dd26a72472,0xa16427881a4627f6,0x9a4627f6221f2764,0xa70e238ba47226a7,0xa55f25ed9e3e27d9,0xa7c39fc6a7a820a5,0xa7d91e3ea5a825a8,0xa472a6a7a764a21f,0xa73ba2d7a7d91e3e,0x1cb2a7eaa38ba70e,0xa38ba70ea764a21f,0x262fa5131e3ea7d9,0x1cb2a7eaa472a6a7,0x27fe1648262fa513
.quad 0x25a8a5a88000a800,0x25a825a828008000,0x27ea9cb22472a6a7,0x164827fe262f2513,0x270e238b2764a21f,0xa513262f1e3e27d9,0x22d7273b27d91e3e,0xa7ea1cb2a38b270e,0x9e3e27d925a825a8,0xa6a7a472a764221f,0xa5ed255f1e3e27d9,0x9fc6a7c3a7a8a0a5,0xa7f61a46a21f2764,0x238ba70ea472a6a7,0xa6dda41da6a72472,0x2788a1641a46a7f6
.quad 0xa21fa764a8000000,0x2764221f25a8a5a8,0x1fc6a7c3a6a7a472,0x22d7273b27f69a46,0x262fa513a21fa764,0xa0a527a826a72472,0x27fe96481e3ea7d9,0xa6dd241d20a527a8,0x26a7247225a8a5a8,0xa7d99e3ea21f2764,0x2164278827d99e3e,0xa4c4a66da70e238b,0xa0a527a82764221f,0x1a46a7f6a7d99e3e,0xa66d24c4247226a7,0x25eda55fa513a62f
.quad 0x8000280080002800,0x8000280080002800,0xa5ed255fa5a825a8,0xa66d24c4a62f2513,0xa7f69a46a8000000,0xa7a8a0a5a7d99e3e,0xa4c4a66da5a8a5a8,0xa164a788a38ba70e,0x1e3ea7d98000a800,0x2472a6a7221fa764,0x26dda41d25a8a5a8,0x27fe964827a8a0a5,0x27a820a528008000,0x2513262f26a72472,0x22d7273b25a825a8,0x9fc627c31a4627f6
.quad 0xa21f276400002800,0xa764221fa5a825a8,0xa7882164a5a825a8,0xa6dda41da7f69a46,0xa70ea38ba8000000,0x9a46a7f6a472a6a7,0x9fc6a7c3a5a8a5a8,0x25eda55f20a5a7a8,0x2472a6a78000a800,0x27d91e3e2764a21f,0x27ea9cb225a8a5a8,0x22d7273b270e238b,0x262f251328008000,0xa38b270e1e3e27d9,0x164827fe25a825a8,0xa7ea1cb2a513262f
.quad 0xa5a825a800002800,0xa5a8a5a8a8000000,0xa7fe9648a5a825a8,0x1cb2a7eaa513a62f,0xa513a62fa8000000,0x270ea38b1e3ea7d9,0x1cb2a7eaa5a8a5a8,0x273b22d7270ea38b,0x26a7a4728000a800,0x1e3e27d92764221f,0x27c31fc625a8a5a8,0xa55f25ed20a527a8,0x238b270e28008000,0xa7f69a46a47226a7,0xa164278825a825a8,0xa41da6dda7f61a46
.quad 0xa764221f00002800,0x221fa764a5a8a5a8,0xa73ba2d7a5a825a8,0x27c39fc61a46a7f6,0xa0a5a7a8a8008000,0x262f251326a7a472,0x241da6dda5a8a5a8,0x964827fe27a820a5,0x27d99e3e8000a800,0xa6a72472221f2764,0x266d24c425a8a5a8,0xa788a164a38b270e,0x1a4627f628008000,0xa0a5a7a8a7d91e3e,0xa55f25ed25a825a8,0x24c4a66da62fa513
.quad 0x8000280080002800,0x8000280080002800,0xa6dd241da6a72472,0xa73b22d7a70e238b,0xa70ea38ba764a21f,0xa62fa513a6a7a472,0x9648a7fe9e3ea7d9,0x1fc6a7c31a46a7f6,0x26a7a47225a8a5a8,0x27d99e3e2764a21f,0x273b22d727d91e3e,0x24c4266d262f2513,0x1a4627f6221f2764,0xa38b270e9e3e27d9,0xa66d24c4a47226a7,0xa7fe9648a7a820a5
.quad 0xa764a21fa8000000,0xa21fa764a5a8a5a8,0x9cb2a7eaa472a6a7,0x255fa5ed20a5a7a8,0x262fa513221fa764,0x27a820a527d99e3e,0x2788216427d99e3e,0x1cb227ea2513262f,0x1e3e27d925a825a8,0xa6a72472a21f2764,0xa5ed255f9e3e27d9,0xa6dda41da7f61a46,0xa7a8a0a5a764221f,0x1a46a7f6a472a6a7,0x9fc6a7c3a6a7a472,0x2788a164238ba70e
.quad 0x25a8a5a88000a800,0x25a825a828008000,0x27c31fc626a7a472,0xa1642788238b270e,0x20a527a82764221f,0xa7f61a46a47226a7,0xa55f25ed1e3e27d9,0xa41da6dda7f69a46,0xa7d99e3ea5a825a8,0x2472a6a7a21fa764,0xa164a788a7d99e3e,0x27ea1cb22513a62f,0x2513a62fa21fa764,0x20a527a827d91e3e,0x27ea1cb22472a6a7,0xa5ed255f20a527a8
.quad 0x221f276428008000,0xa764a21fa5a825a8,0xa4c4266d247226a7,0x9648a7fea7a8a0a5,0xa7f69a46a21f2764,0x270ea38b9e3ea7d9,0xa2d7a73ba7d91e3e,0x266d24c4262fa513,0x2472a6a7a5a8a5a8,0x9e3e27d92764221f,0x27fe16481e3ea7d9,0xa7c31fc61a4627f6,0x238b270e2764a21f,0xa513a62fa6a72472,0xa41d26dd26a72472,0x22d7a73ba70ea38b
.quad 0x8000280080002800,0x8000280080002800,0xa7882164a764221f,0xa7c31fc6a7a820a5,0xa513a62fa5a8a5a8,0xa38ba70ea472a6a7,0x241da6dd221fa764,0x25eda55f2513a62f,0x27d91e3e28008000,0x26a724722764221f,0x1cb227ea221f2764,0xa16427889a4627f6,0xa70e238ba5a825a8,0xa7f69a46a7d91e3e,0xa5eda55fa764a21f,0x9cb2a7eaa38ba70e
.quad 0x221fa7648000a800,0x2764a21f25a8a5a8,0x27fe16482764a21f,0x24c4266d270e238b,0x20a527a825a825a8,0xa513262f9e3e27d9,0xa66d24c4a21f2764,0xa73ba2d7a7f61a46,0xa6a7a472a8000000,0x1e3ea7d9a21fa764,0x1fc6a7c3a21fa764,0x27fe9648262fa513,0x27f69a4625a8a5a8,0x20a527a826a72472,0x22d7273b2764221f,0xa6dd241da0a527a8
.quad 0xa5a825a800002800,0xa5a8a5a8a8008000,0xa73ba2d7a764221f,0x241da6dda0a5a7a8,0x1a46a7f6a5a8a5a8,0x27a820a526a7a472,0x27c39fc6221fa764,0x964827fe262f2513,0x247226a728008000,0xa7d91e3ea21f2764,0xa4c4266d221f2764,0xa2d7a73ba7f69a46,0xa7a8a0a5a5a825a8,0x262fa5139e3ea7d9,0x9648a7fea764a21f,0x266d24c4270ea38b
.quad 0x2764a21f8000a800,0xa21f276425a825a8,0x255f25ed2764a21f,0xa7ea9cb2a38b270e,0xa38b270e25a825a8,0x9a46a7f6a7d99e3e,0xa7ea9cb2a21f2764,0x2788a1649a46a7f6,0x9e3ea7d9a8008000,0x247226a72764a21f,0x26dda41da21fa764,0xa55f25ed2513262f,0x262f251325a8a5a8,0xa70ea38ba47226a7,0xa16427882764221f,0x1fc6a7c3a7a8a0a5
.quad 0x8000280080002800,0x8000280080002800,0xa7ea1cb2a7d91e3e,0xa7fe1648a7f61a46,0xa0a5a7a8a21fa764,0x9a46a7f69e3ea7d9,0x273ba2d726a7a472,0x27ea9cb227a8a0a5,0x247226a725a825a8,0x1e3e27d9221f2764,0xa5ed255fa47226a7,0xa7c31fc6a70e238b,0xa62fa513a764a21f,0xa0a5a7a8a472a6a7,0x241da6dd1e3ea7d9,0x2788a164262fa513
.quad 0x2764221f28008000,0x221f276425a825a8,0x9fc627c31e3e27d9,0xa73b22d7a513262f,0xa7f69a46a764221f,0xa38ba70ea6a7a472,0x9648a7fea472a6a7,0x26dda41d238ba70e,0x27d99e3e25a8a5a8,0x247226a72764221f,0x2164278826a72472,0xa66d24c4a0a527a8,0xa70e238ba21f2764,0xa513a62fa7d99e3e,0xa4c4a66da7d99e3e,0x25eda55f1a46a7f6
.quad 0x25a8a5a88000a800,0x25a825a828008000,0x266d24c427d99e3e,0xa55f25ed1a4627f6,0xa38b270e221f2764,0xa62fa513a7d91e3e,0xa788a164a6a72472,0x24c4a66da0a5a7a8,0x1e3ea7d9a5a8a5a8,0x26a724722764a21f,0x27fe16482472a6a7,0xa41d26dd238b270e,0x1a4627f62764221f,0xa70ea38ba6a72472,0xa7c31fc69e3e27d9,0x22d7a73ba513a62f
.quad 0xa21fa764a8008000,0x2764221f25a8a5a8,0x26dda41d9e3ea7d9,0xa1642788262f2513,0x2513262f2764a21f,0xa7a8a0a5a47226a7,0xa55f25ed247226a7,0x1fc6a7c3a70ea38b,0xa6a7a472a5a825a8,0x27d91e3e221fa764,0x22d7a73ba6a7a472,0x9cb227ea27a820a5,0x27a820a5221fa764,0xa7f69a469e3e27d9,0x9cb227ea27d91e3e,0x1648a7fea7f69a46
.quad 0x8000280080002800,0x8000280080002800,0xa7fe9648a8000000,0xa7ea9cb2a7f69a46,0x1a46a7f68000a800,0x20a5a7a81e3ea7d9,0x27ea1cb228008000,0x273b22d727a820a5,0x9e3e27d900002800,0xa47226a7a21f2764,0xa7c39fc6a8000000,0xa5eda55fa70ea38b,0x20a5a7a88000a800,0x262fa5132472a6a7,0x2788216428008000,0x241d26dd262f2513
.quad 0xa21f276400002800,0xa764221fa5a825a8,0xa73ba2d7a8000000,0x9fc6a7c3a513a62f,0x238ba70e8000a800,0x27f69a4626a7a472,0x26dd241d28008000,0x964827fe238b270e,0xa47226a700002800,0xa7d99e3ea764221f,0xa66da4c4a8008000,0x2164a788a0a5a7a8,0x2513a62f8000a800,0x270e238b27d99e3e,0x25ed255f28008000,0xa4c4266d1a4627f6
.quad 0xa5a825a800002800,0xa5a8a5a8a8008000,0xa55fa5eda8008000,0x266da4c41a46a7f6,0x262fa5138000a800,0x238b270e27d91e3e,0x24c4266d28008000,0xa7882164a0a527a8,0xa6a7247200002800,0x9e3ea7d9a764a21f,0xa41da6dda8008000,0x27fe9648238ba70e,0x270ea38b8000a800,0x9a4627f626a72472,0x22d7273b28008000,0xa7c39fc6a513262f
.quad 0xa764221f00002800,0x221fa764a5a8a5a8,0xa164a788a8008000,0x26dd241d262fa513,0x27a8a0a50000a800,0xa513262f247226a7,0x1fc627c328008000,0xa55fa5eda70e238b,0xa7d91e3e00002800,0x26a7a472a21fa764,0x9cb2a7eaa8008000,0x22d7273b27a8a0a5,0x27f69a468000a800,0xa7a820a51e3e27d9,0x164827fe28008000,0x9cb2a7eaa7f61a46
.quad 0x8000280080002800,0x8000280080002800,0xa7c39fc6a7d99e3e,0xa788a164a7a8a0a5,0x238ba70e221fa764,0x2513a62f2472a6a7,0x25ed255f26a72472,0x241d26dd2513262f,0xa6a72472a5a825a8,0xa7d91e3ea764221f,0xa164a788a472a6a7,0x1cb2a7ea9a46a7f6,0x27f69a462764a21f,0x270e238b27d91e3e,0x9cb227ea1e3e27d9,0xa5ed255fa38b270e
.quad 0xa764a21fa8000000,0xa21fa764a5a8a5a8,0x24c4a66d1e3ea7d9,0x27fe9648270ea38b,0x2513262f2764221f,0xa0a527a81e3e27d9,0xa73b22d7a47226a7,0xa66da4c4a7f69a46,0x9e3ea7d9a5a8a5a8,0x26a7a472221fa764,0x27fe164826a7a472,0x1fc627c3262f2513,0xa0a527a8221f2764,0xa7f69a46a6a72472,0xa6dda41da7d91e3e,0x22d7a73ba0a5a7a8
.quad 0x25a8a5a88000a800,0x25a825a828008000,0x241d26dd27d91e3e,0xa73b22d7a0a527a8,0xa7a820a5a21f2764,0x9a46a7f6a6a7a472,0x9648a7fea6a7a472,0x27c31fc6262fa513,0x27d91e3e25a8a5a8,0xa47226a7221f2764,0xa2d7273b247226a7,0xa4c4a66da7f61a46,0xa62fa513a764221f,0x27a8a0a51e3ea7d9,0x266da4c49e3ea7d9,0x964827fe270e238b
.quad 0x221f276428008000,0xa764a21fa5a825a8,0xa7ea1cb29e3e27d9,0x255fa5eda38ba70e,0x1a46a7f6a764a21f,0x238b270e27d99e3e,0x278821642472a6a7,0xa7ea1cb29a4627f6,0xa47226a725a825a8,0x1e3ea7d9a764a21f,0xa55fa5eda6a72472,0x26dd241d2513a62f,0x270ea38ba21fa764,0xa62f2513247226a7,0x1fc627c327d99e3e,0xa164a788a7a820a5
.quad 0x8000280080002800,0x8000280080002800,0xa73ba2d7a764a21f,0xa6dda41da70ea38b,0x262fa51325a8a5a8,0x270ea38b26a7a472,0x1fc627c3221f2764,0x964827fe1a4627f6,0xa7d99e3ea8000000,0xa6a7a472a764a21f,0x24c4a66d221fa764,0x273ba2d7262fa513,0x238b270e25a825a8,0x9a4627f61e3e27d9,0xa7fe1648a764221f,0xa66da4c4a7a8a0a5
.quad 0x221fa7648000a800,0x2764a21f25a8a5a8,0x255f25ed2764221f,0x9cb227ea20a527a8,0xa7a820a5a5a825a8,0xa62fa513a7d99e3e,0x1cb2a7eaa21fa764,0x2788a1642513a62f,0x26a7247228008000,0x9e3e27d9221f2764,0xa6dd241da21f2764,0xa5eda55fa7f69a46,0x9a46a7f6a5a8a5a8,0x27a8a0a52472a6a7,0x278821642764a21f,0x9fc627c3238b270e
.quad 0xa5a825a800002800,0xa5a8a5a8a8008000,0xa164a788a764a21f,0x27c39fc6238ba70e,0x27f61a4625a8a5a8,0xa0a527a8247226a7,0xa41d26dd221f2764,0xa55fa5eda7f61a46,0xa472a6a7a8008000,0x27d99e3e221fa764,0x27ea9cb2221fa764,0xa16427882513262f,0xa0a527a825a825a8,0xa513a62fa7d91e3e,0xa5eda55fa764221f,0x27ea9cb220a5a7a8
.quad 0x2764a21f8000a800,0xa21f276425a825a8,0x964827fe2764221f,0xa4c4a66da7a820a5,0xa70ea38ba5a825a8,0x27f69a461e3ea7d9,0x266da4c4a21fa764,0xa2d7273b262f2513,0x1e3e27d928008000,0xa472a6a7a764221f,0xa7c39fc6a21f2764,0x27fe96481a46a7f6,0x2513a62fa5a8a5a8,0xa38b270e26a72472,0x22d7273b2764a21f,0xa41da6dda70e238b
.quad 0x8000280080002800,0x8000280080002800,0xa66da4c4a6a7a472,0xa5eda55fa62fa513,0x27a8a0a52764a21f,0x27f69a4627d99e3e,0xa16427889e3e27d9,0xa4c4266da38b270e,0xa472a6a7a5a8a5a8,0x9e3ea7d9a21fa764,0x27fe164827d99e3e,0x26dd241d27a820a5,0xa513262fa21f2764,0xa7a820a5a6a72472,0x9fc6a7c3a472a6a7,0x22d7a73b1a46a7f6
.quad 0x2764221f28008000,0x221f276425a825a8,0xa6dd241da47226a7,0xa788a164a7f61a46,0x1a46a7f6a21fa764,0x270ea38b2472a6a7,0x25ed255f27d91e3e,0x9fc627c320a527a8,0xa7d91e3ea5a825a8,0xa472a6a7a764a21f,0x22d7a73b9e3ea7d9,0x27ea1cb2270ea38b,0x238b270e2764221f,0xa62f25139e3e27d9,0xa7ea9cb2a6a72472,0x1648a7fea513a62f
.quad 0x25a8a5a88000a800,0x25a825a828008000,0x1cb227ea26a72472,0xa7fe1648a513262f,0xa70ea38ba764221f,0x2513a62f9e3ea7d9,0x273ba2d71e3ea7d9,0x1cb227ea270e238b,0x9e3e27d925a825a8,0xa6a7a472a764221f,0xa55fa5eda7d91e3e,0x27c39fc620a5a7a8,0x27f69a46221fa764,0xa38b270e247226a7,0xa41d26dd247226a7,0xa164a788a7f69a46
.quad 0xa21fa764a8000000,0x2764221f25a8a5a8,0x27c31fc62472a6a7,0xa73b22d71a4627f6,0xa62f2513221f2764,0x20a5a7a8a6a7a472,0x9648a7fea7d99e3e,0x241d26dd27a8a0a5,0x26a7247225a8a5a8,0xa7d99e3ea21f2764,0xa78821641e3e27d9,0x266da4c4a38ba70e,0x20a5a7a8a764a21f,0x9a4627f627d91e3e,0x24c4266d26a7a472,0xa55fa5eda62f2513
.quad 0x8000280080002800,0x8000280080002800,0xa55fa5eda5a8a5a8,0xa4c4a66da513a62f,0x27f61a4628008000,0x27a820a527d91e3e,0xa66d24c4a5a825a8,0xa7882164a70e238b,0x1e3ea7d98000a800,0x2472a6a7221fa764,0x241d26dd25a825a8,0x164827fe20a527a8,0xa7a8a0a5a8000000,0xa513a62fa6a7a472,0x273ba2d725a8a5a8,0x27c31fc627f69a46
.quad 0xa21f276400002800,0xa764221fa5a825a8,0xa164a788a5a8a5a8,0x241da6dd1a46a7f6,0x270e238b28008000,0x1a4627f6247226a7,0xa7c31fc6a5a825a8,0xa55fa5eda7a8a0a5,0x2472a6a78000a800,0x27d91e3e2764a21f,0x1cb227ea25a825a8,0xa73b22d7a38b270e,0xa62fa513a8008000,0x238ba70e9e3ea7d9,0x27fe964825a8a5a8,0x1cb227ea262f2513
.quad 0xa5a825a800002800,0xa5a8a5a8a8008000,0x1648a7fea5a8a5a8,0x27ea1cb2262fa513,0x2513262f28008000,0xa70e238b9e3e27d9,0xa7ea9cb2a5a825a8,0x22d7a73ba38ba70e,0x26a7a4728000a800,0x1e3e27d92764221f,0x9fc627c325a825a8,0xa5eda55fa7a820a5,0xa38ba70ea8000000,0x27f61a462472a6a7,0x2788216425a8a5a8,0xa6dd241d1a4627f6
.quad 0xa764221f00002800,0x221fa764a5a8a5a8,0x22d7a73ba5a8a5a8,0x1fc627c327f61a46,0x20a527a828000000,0xa62fa513a6a72472,0xa6dda41da5a825a8,0x27fe164820a5a7a8,0x27d99e3e0000a800,0xa6a72472221f2764,0xa4c4266d25a825a8,0x2164a788a70ea38b,0x9a46a7f6a8000000,0x20a527a827d99e3e,0x25ed255f25a8a5a8,0xa66da4c4a513262f
.quad 0x8000280080002800,0x8000280080002800,0xa41da6dda472a6a7,0xa2d7a73ba38ba70e,0x270e238b2764221f,0x262f251326a72472,0xa7fe1648a7d91e3e,0xa7c39fc6a7f69a46,0x26a7a47225a8a5a8,0x27d99e3e2764a21f,0xa2d7273b9e3e27d9,0xa66d24c4a513262f,0x9a46a7f6a21fa764,0x238ba70e1e3ea7d9,0x24c4266d26a72472,0x964827fe20a527a8
.quad 0xa764a21fa8008000,0xa21fa764a5a8a5a8,0x27ea9cb226a7a472,0x25ed255f27a820a5,0xa62f2513a21f2764,0xa7a8a0a5a7d91e3e,0x2164a7889e3ea7d9,0x27ea9cb2262fa513,0x1e3e27d925a825a8,0xa6a72472a21f2764,0xa55fa5eda7d99e3e,0x241da6dd9a46a7f6,0x27a820a52764a21f,0x9a4627f6247226a7,0xa7c31fc6a47226a7,0xa164a788a70ea38b
.quad 0x25a8a5a80000a800,0x25a825a828008000,0x9fc627c3247226a7,0xa788a164a70e238b,0xa0a5a7a8a764a21f,0x27f69a462472a6a7,0x25ed255f27d99e3e,0xa6dd241d9a4627f6,0xa7d99e3ea5a825a8,0x2472a6a7a21fa764,0x2788a1641e3ea7d9,0x9cb227ea262f2513,0xa513262f221f2764,0xa0a5a7a8a7d99e3e,0x1cb2a7eaa6a7a472,0x255f25ed27a8a0a5
.quad 0x221f276428008000,0xa764a21fa5a825a8,0xa66da4c4a6a72472,0x27fe964820a5a7a8,0x27f61a46221fa764,0xa70e238b1e3e27d9,0xa73b22d71e3e27d9,0x24c4a66da513a62f,0x2472a6a7a5a8a5a8,0x9e3e27d92764221f,0x964827fe27d91e3e,0x9fc6a7c3a7f61a46,0xa38ba70ea764221f,0x2513262f26a7a472,0x26dd241d2472a6a7,0xa73ba2d7a38b270e
.quad 0x8000280080002800,0x8000280080002800,0xa164a788a21fa764,0x9fc6a7c3a0a5a7a8,0x2513262f25a825a8,0x238b270e247226a7,0xa6dda41da764a21f,0xa55fa5eda62fa513,0x27d91e3e28008000,0x26a724722764221f,0xa7ea1cb2a764221f,0xa788a164a7f69a46,0x270ea38b25a8a5a8,0x27f61a4627d99e3e,0xa55f25eda21f2764,0xa7ea1cb2a70e238b
.quad 0x221fa7648000a800,0x2764a21f25a8a5a8,0x964827fe221f2764,0xa66d24c4a38b270e,0xa0a5a7a8a5a8a5a8,0x2513a62f1e3ea7d9,0x24c4266d2764221f,0xa2d7273b1a4627f6,0xa6a7a472a8008000,0x1e3ea7d9a21fa764,0x27c31fc62764a21f,0x164827fe2513262f,0xa7f61a46a5a825a8,0xa0a5a7a8a6a7a472,0x273ba2d7221fa764,0x241d26dd27a820a5
.quad 0xa5a825a800002800,0xa5a8a5a8a8008000,0x22d7a73ba21fa764,0x26dd241d27a8a0a5,0x9a4627f625a825a8,0xa7a8a0a5a6a72472,0x9fc6a7c3a764a21f,0x27fe16482513a62f,0x247226a728008000,0xa7d91e3ea21f2764,0xa66da4c4a764221f,0x273ba2d71a46a7f6,0x27a820a525a8a5a8,0xa62f25131e3e27d9,0xa7fe1648a21f2764,0x24c4a66da38ba70e
.quad 0x2764a21f0000a800,0xa21f276425a825a8,0xa5ed255f221f2764,0x1cb2a7eaa70ea38b,0x238ba70ea5a8a5a8,0x1a4627f627d91e3e,0x9cb227ea2764221f,0xa164a788a7f61a46,0x9e3ea7d9a8000000,0x247226a72764a21f,0x241d26dd2764a21f,0xa5eda55fa62f2513,0xa62fa513a5a825a8,0x270e238b2472a6a7,0x27882164221fa764,0xa7c39fc6a0a527a8
.quad 0x8000280080002800,0x8000280080002800,0x9cb2a7ea9e3ea7d9,0x9648a7fe9a46a7f6,0x20a527a8221f2764,0x1a4627f61e3e27d9,0xa2d7a73ba472a6a7,0x9cb2a7eaa0a5a7a8,0x247226a725a825a8,0x1e3e27d9221f2764,0xa55fa5eda6a7a472,0x9fc6a7c3a38ba70e,0x262f25132764221f,0x20a527a8247226a7,0xa6dda41da7d99e3e,0xa164a788a513a62f
.quad 0x2764221f28008000,0x221f276425a825a8,0xa7c39fc6a7d91e3e,0xa2d7a73ba62fa513,0x27f61a462764a21f,0x238b270e26a72472,0xa7fe1648a6a72472,0xa41da6dda70ea38b,0x27d99e3e25a8a5a8,0x247226a72764221f,0xa7882164a47226a7,0xa4c4a66da7a8a0a5,0x270ea38b221fa764,0x2513262f27d91e3e,0xa66d24c49e3e27d9,0xa55fa5eda7f69a46
.quad 0x25a8a5a88000a800,0x25a825a828008000,0xa4c4266d1e3e27d9,0xa5eda55fa7f61a46,0x238ba70ea21fa764,0x262f251327d99e3e,0xa1642788247226a7,0xa66da4c4a7a820a5,0x1e3ea7d9a5a8a5a8,0x26a724722764a21f,0x964827fe26a72472,0xa6dda41da70e238b,0x9a46a7f6a764a21f,0x270e238b26a7a472,0x1fc627c327d91e3e,0xa73ba2d7a62f2513
.quad 0xa21fa764a8000000,0x2764221f25a8a5a8,0x241d26dd27d99e3e,0xa788a164a513262f,0xa513a62fa764221f,0x27a820a52472a6a7,0x25ed255f26a7a472,0xa7c39fc6a38b270e,0xa6a7a472a5a825a8,0x27d91e3e221fa764,0x273b22d72472a6a7,0xa7ea9cb2a0a527a8,0xa7a8a0a5a21f2764,0x27f61a461e3ea7d9,0x27ea1cb21e3ea7d9,0xa7fe96489a4627f6
.quad 0xa800000028002800,0x280080008000a800,0xa7fe9648a8002800,0x27ea1cb21a46a7f6,0xa7f69a4628002800,0x27a820a51e3ea7d9,0xa7ea9cb2a8002800,0x273b22d720a5a7a8,0xa7d99e3e28002800,0x26a72472221fa764,0xa7c39fc6a8002800,0x25ed255f238ba70e,0xa7a8a0a528002800,0x2513262f2472a6a7,0xa788a164a8002800,0x241d26dd2513a62f
.quad 0xa764a21f28002800,0x221f276425a8a5a8,0xa73ba2d7a8002800,0x1fc627c3262fa513,0xa70ea38b28002800,0x1a4627f626a7a472,0xa6dda41da8002800,0x964827fe270ea38b,0xa6a7a47228002800,0x9e3e27d92764a21f,0xa66da4c4a8002800,0xa164278827a8a0a5,0xa62fa51328002800,0xa38b270e27d99e3e,0xa5eda55fa8002800,0xa4c4266d27f69a46
.quad 0xa5a8a5a828002800,0xa5a825a828008000,0xa55fa5eda8002800,0xa66d24c427f61a46,0xa513a62f28002800,0xa70e238b27d91e3e,0xa4c4a66da8002800,0xa788216427a820a5,0xa472a6a728002800,0xa7d91e3e2764221f,0xa41da6dda8002800,0xa7fe1648270e238b,0xa38ba70e28002800,0xa7f69a4626a72472,0xa2d7a73ba8002800,0xa7c39fc6262f2513
.quad 0xa21fa76428002800,0xa764a21f25a825a8,0xa164a788a8002800,0xa6dda41d2513262f,0xa0a5a7a828002800,0xa62fa513247226a7,0x9fc6a7c3a8002800,0xa55fa5ed238b270e,0x9e3ea7d928002800,0xa472a6a7221f2764,0x9cb2a7eaa8002800,0xa2d7a73b20a527a8,0x9a46a7f628002800,0xa0a5a7a81e3e27d9,0x9648a7fea8002800,0x9cb2a7ea1a4627f6
.quad 0xa800000000002800,0x280080008000a800,0xa7c39fc69e3e27d9,0x2788216420a5a7a8,0xa70ea38ba21f2764,0x262f25132472a6a7,0xa5eda55fa47226a7,0x241d26dd262fa513,0xa472a6a7a5a825a8,0x1e3e27d92764a21f,0xa164a788a6a72472,0x9cb227ea27f69a46,0x9a46a7f6a764221f,0xa38b270e27d91e3e,0x1cb2a7eaa7d91e3e,0xa5ed255f270e238b
.quad 0x221fa764a8000000,0xa764221f25a825a8,0x24c4a66da7d99e3e,0xa7fe1648238b270e,0x262fa513a764a21f,0xa7a8a0a51e3e27d9,0x273ba2d7a6a7a472,0xa66da4c49a4627f6,0x27d99e3ea5a8a5a8,0xa472a6a7a21f2764,0x27fe1648a472a6a7,0x9fc6a7c3a513262f,0x27a820a5a21fa764,0x1a46a7f6a6a72472,0x26dd241d9e3ea7d9,0x22d7a73ba7a820a5
.quad 0x25a825a88000a800,0x25a8a5a8a8000000,0x241d26dd1e3ea7d9,0x273ba2d7a7a8a0a5,0x20a527a8221fa764,0x27f69a46a6a7a472,0x164827fe2472a6a7,0x27c31fc6a513a62f,0x9e3e27d925a8a5a8,0x26a72472a21fa764,0xa2d7273b26a7a472,0x24c4266d9a46a7f6,0xa513262f2764a21f,0x20a527a81e3ea7d9,0xa66d24c427d99e3e,0x964827fe238ba70e
.quad 0xa764221f28008000,0xa21f276425a8a5a8,0xa7ea1cb227d91e3e,0xa55f25ed270ea38b,0xa7f69a462764221f,0xa70e238b27d99e3e,0xa788a16426a72472,0xa7ea1cb227f61a46,0xa6a7a47225a825a8,0xa7d99e3e2764221f,0xa55fa5ed247226a7,0xa6dda41d262f2513,0xa38ba70e221f2764,0xa513a62f247226a7,0x9fc6a7c31e3e27d9,0xa164a78820a527a8
.quad 0xa800000000002800,0x280080008000a800,0xa73ba2d7a21f2764,0x26dd241d238ba70e,0xa513a62fa5a825a8,0x238b270e26a7a472,0x9fc6a7c3a764221f,0x964827fe27f69a46,0x1e3ea7d9a8000000,0xa47226a72764221f,0x24c4a66da764a21f,0xa73b22d72513262f,0x270ea38ba5a8a5a8,0xa7f69a461e3e27d9,0x27fe9648a21fa764,0xa66da4c4a0a527a8
.quad 0x2764221f8000a800,0xa21fa764a5a825a8,0x255f25ed221fa764,0x1cb2a7eaa7a820a5,0x20a527a825a8a5a8,0x2513a62fa7d99e3e,0x9cb227ea2764a21f,0x2788a164a62fa513,0xa47226a728008000,0x27d91e3ea21fa764,0xa6dd241d2764221f,0x25ed255f1a46a7f6,0xa7f61a4625a825a8,0x20a527a82472a6a7,0xa788a164221f2764,0x9fc627c3270ea38b
.quad 0xa5a8a5a800002800,0xa5a825a828008000,0xa164a788a21f2764,0xa7c31fc6270e238b,0x1a46a7f6a5a825a8,0xa7a8a0a5247226a7,0x241da6dda764221f,0xa55fa5ed1a4627f6,0x26a7a472a8008000,0x9e3ea7d9a21f2764,0x27ea9cb2a764a21f,0x2164a788a62f2513,0x27a820a5a5a8a5a8,0x262fa513a7d91e3e,0x25ed255fa21fa764,0x27ea9cb2a7a8a0a5
.quad 0x221f27648000a800,0x2764221fa5a8a5a8,0x964827fe221fa764,0x24c4266da0a5a7a8,0xa38b270e25a8a5a8,0x1a4627f61e3ea7d9,0xa66d24c42764a21f,0xa2d7273b2513a62f,0xa7d91e3e28008000,0xa6a724722764a21f,0xa7c39fc62764221f,0xa7fe164827f61a46,0xa62fa51325a825a8,0xa70ea38b26a72472,0xa2d7a73b221f2764,0xa41da6dd238b270e
.quad 0xa800800000002800,0x280080008000a800,0xa66da4c4a47226a7,0x25ed255f2513a62f,0xa0a5a7a8a764221f,0x1a4627f627d99e3e,0x2164a788a7d99e3e,0xa4c4266d270e238b,0x26a7a472a5a8a5a8,0xa7d91e3e221f2764,0x27fe16489e3ea7d9,0xa6dda41da0a527a8,0x262f2513221fa764,0xa0a5a7a8a6a72472,0x1fc627c326a7a472,0x22d7a73ba7f69a46
.quad 0xa21f276428008000,0x2764a21fa5a8a5a8,0xa6dd241d26a72472,0x278821649a46a7f6,0xa7f69a46221f2764,0x238b270e2472a6a7,0xa5eda55f9e3e27d9,0x9fc627c327a8a0a5,0x9e3ea7d9a5a825a8,0xa6a724722764221f,0x22d7a73ba7d91e3e,0xa7ea9cb2238b270e,0x270ea38ba764a21f,0xa513a62f9e3e27d9,0x27ea1cb2a472a6a7,0x1648a7fea62f2513
.quad 0x25a825a88000a800,0x25a8a5a8a8008000,0x1cb227ea2472a6a7,0x27fe9648a62fa513,0xa38b270e2764a21f,0x262f25139e3ea7d9,0xa73b22d727d91e3e,0x1cb227ea238ba70e,0xa7d99e3e25a825a8,0xa47226a72764a21f,0xa55fa5ed1e3e27d9,0xa7c31fc627a820a5,0x9a46a7f6a21f2764,0xa70ea38b247226a7,0x241da6dda6a72472,0xa164a7889a4627f6
.quad 0x2764a21fa8008000,0x221fa764a5a825a8,0x27c31fc6a6a7a472,0x273ba2d7a7f61a46,0x2513262fa21fa764,0x27a820a5a6a7a472,0x164827fe1e3ea7d9,0x241d26dda0a5a7a8,0xa47226a725a8a5a8,0x9e3e27d9221fa764,0xa788216427d99e3e,0xa66d24c4270ea38b,0xa7a8a0a52764221f,0xa7f69a4627d91e3e,0xa4c4a66d247226a7,0xa55fa5ed2513262f
.quad 0xa800800000002800,0x280080008000a800,0xa55fa5eda5a825a8,0x24c4266d262fa513,0x1a46a7f6a8008000,0xa0a527a827d91e3e,0x266da4c4a5a8a5a8,0xa7882164238b270e,0x27d91e3e8000a800,0xa6a7a472a21f2764,0x241d26dd25a8a5a8,0x9648a7fea7a820a5,0xa0a527a828008000,0x262fa513a6a7a472,0xa73b22d725a825a8,0x27c31fc69a46a7f6
.quad 0xa764a21f00002800,0x221f276425a8a5a8,0xa164a788a5a825a8,0xa41d26dd27f61a46,0x238ba70ea8008000,0xa7f61a46247226a7,0x27c39fc6a5a8a5a8,0xa55fa5eda0a527a8,0x26a724728000a800,0x1e3ea7d9a764221f,0x1cb227ea25a8a5a8,0x273ba2d7a70ea38b,0xa513262f28008000,0x270e238b9e3ea7d9,0xa7fe164825a825a8,0x1cb227ea2513a62f
.quad 0xa5a8a5a800002800,0xa5a825a828008000,0x1648a7fea5a825a8,0xa7ea9cb22513262f,0x262fa513a8008000,0xa38ba70e9e3e27d9,0x27ea1cb2a5a8a5a8,0x22d7a73ba70e238b,0x247226a70000a800,0x27d99e3ea764a21f,0x9fc627c325a8a5a8,0x25ed255fa0a5a7a8,0xa70e238b28008000,0x9a4627f62472a6a7,0xa788a16425a825a8,0xa6dd241d27f69a46
.quad 0xa21fa76400002800,0xa764a21f25a825a8,0x22d7a73ba5a825a8,0x9fc6a7c39a4627f6,0x27a8a0a5a8008000,0x2513a62fa6a72472,0x26dd241da5a8a5a8,0x27fe1648a7a8a0a5,0x1e3e27d98000a800,0x247226a7a21fa764,0xa4c4266d25a8a5a8,0xa1642788238ba70e,0xa7f61a4628008000,0xa7a820a527d99e3e,0xa5eda55f25a825a8,0xa66da4c4262f2513
.quad 0xa800800000002800,0x280080008000a800,0xa41da6dda6a72472,0x22d7273b270ea38b,0x238ba70ea764a21f,0xa513262f26a72472,0x27fe96489e3ea7d9,0xa7c39fc69a4627f6,0x247226a725a8a5a8,0x9e3ea7d9a764221f,0xa2d7273b27d91e3e,0x266da4c4a62fa513,0xa7f61a46221f2764,0x270e238b1e3ea7d9,0xa4c4a66da47226a7,0x964827fe27a8a0a5
.quad 0x221fa764a8008000,0xa764221f25a825a8,0x27ea9cb2a472a6a7,0xa5eda55fa0a527a8,0x2513262f221fa764,0x20a5a7a8a7d91e3e,0xa164278827d99e3e,0x27ea9cb2a513a62f,0xa7d91e3e25a825a8,0x247226a7221fa764,0xa55fa5ed9e3e27d9,0xa41d26dd27f69a46,0x20a5a7a8a764221f,0xa7f69a46247226a7,0x27c39fc6a6a7a472,0xa164a788a38b270e
.quad 0x25a825a88000a800,0x25a8a5a8a8000000,0x9fc627c326a7a472,0x27882164a38ba70e,0xa7a820a52764221f,0x1a4627f62472a6a7,0xa5eda55f1e3e27d9,0xa6dd241d27f61a46,0x1e3ea7d9a5a825a8,0xa6a7a472221f2764,0x2788a164a7d99e3e,0x1cb2a7eaa513262f,0x262f2513a21fa764,0x27a8a0a5a7d99e3e,0x9cb227ea2472a6a7,0x255f25eda0a5a7a8
.quad 0xa764221f28008000,0xa21f276425a8a5a8,0xa66da4c4247226a7,0xa7fe164827a820a5,0x1a46a7f6a21f2764,0xa38ba70e1e3e27d9,0x273ba2d7a7d91e3e,0x24c4a66da62f2513,0x26a72472a5a8a5a8,0x27d91e3ea764a21f,0x964827fe1e3ea7d9,0x1fc627c39a46a7f6,0xa70e238b2764a21f,0xa62f251326a7a472,0xa6dda41d26a72472,0xa73ba2d7270e238b
.quad 0xa800800000002800,0x280080000000a800,0xa164a788a764221f,0x1fc627c327a8a0a5,0x262fa513a5a8a5a8,0xa70e238b247226a7,0x26dd241d221fa764,0xa55fa5eda513262f,0x9e3e27d928008000,0x2472a6a7a764a21f,0xa7ea1cb2221f2764,0x278821641a46a7f6,0xa38ba70ea5a825a8,0x9a4627f627d99e3e,0x255fa5eda764a21f,0xa7ea1cb2238b270e
.quad 0x2764221f8000a800,0xa21fa764a5a825a8,0x964827fe2764a21f,0x266da4c4a70ea38b,0xa7a820a525a825a8,0x262f25131e3ea7d9,0xa4c4a66da21f2764,0xa2d7273b27f69a46,0x2472a6a7a8000000,0xa7d99e3e221f2764,0x27c31fc6a21fa764,0x9648a7fea62f2513,0x1a4627f625a8a5a8,0x27a8a0a5a6a7a472,0xa73b22d72764221f,0x241d26dd20a5a7a8
.quad 0xa5a8a5a800002800,0xa5a825a828008000,0x22d7a73ba764221f,0xa6dda41d20a527a8,0x27f61a46a5a8a5a8,0x20a5a7a8a6a72472,0x1fc627c3221fa764,0x27fe1648a62fa513,0xa6a7247228000000,0x1e3e27d9221fa764,0xa66da4c4221f2764,0xa73b22d727f61a46,0x20a5a7a8a5a825a8,0xa513a62f1e3e27d9,0x27fe9648a764a21f,0x24c4a66da70e238b
.quad 0x221f27640000a800,0x2764221fa5a8a5a8,0xa5ed255f2764a21f,0x9cb227ea238ba70e,0xa70ea38b25a825a8,0xa7f61a4627d91e3e,0x1cb2a7eaa21f2764,0xa164a7881a4627f6,0x27d99e3ea8000000,0x26a7a472a764221f,0x241d26dda21fa764,0x25ed255fa513a62f,0xa513262f25a8a5a8,0xa38b270e2472a6a7,0xa788a1642764221f,0xa7c39fc627a820a5
.quad 0xa800800000002800,0x280080008000a800,0x9cb2a7eaa7d91e3e,0x164827fe27f69a46,0x27a8a0a5a21fa764,0xa7f61a461e3e27d9,0x22d7273b26a7a472,0x9cb2a7eaa7a820a5,0xa6a7247225a825a8,0x27d99e3ea21fa764,0xa55fa5eda47226a7,0x1fc627c3270ea38b,0x2513a62fa764a21f,0xa7a820a5247226a7,0x26dd241d1e3ea7d9,0xa164a788a62f2513
.quad 0xa21f276428008000,0x2764a21fa5a8a5a8,0xa7c39fc61e3e27d9,0x22d7273b2513a62f,0x1a46a7f6a764221f,0xa70e238b26a72472,0x27fe9648a472a6a7,0xa41da6dda38b270e,0x1e3e27d925a8a5a8,0x26a7a472a764a21f,0xa788216426a72472,0x24c4266d20a5a7a8,0xa38ba70ea21f2764,0xa62f251327d91e3e,0x266da4c4a7d99e3e,0xa55fa5ed9a4627f6
.quad 0x25a825a80000a800,0x25a8a5a8a8000000,0xa4c4266d27d99e3e,0x25ed255f9a46a7f6,0xa70ea38b221f2764,0xa513262f27d99e3e,0x2164a788a6a72472,0xa66da4c420a527a8,0x27d91e3ea5a8a5a8,0x2472a6a7a764221f,0x964827fe2472a6a7,0x26dd241da38ba70e,0xa7f61a462764221f,0xa38b270e26a7a472,0x9fc6a7c39e3e27d9,0xa73ba2d72513262f
.quad 0x2764a21fa8000000,0x221fa764a5a825a8,0x241d26dd9e3ea7d9,0x27882164a62fa513,0xa62f25132764a21f,0xa0a527a82472a6a7,0xa5eda55f247226a7,0xa7c39fc6270e238b,0x2472a6a7a5a825a8,0x1e3ea7d9a21f2764,0x273b22d7a6a7a472,0x27ea1cb2a7a8a0a5,0xa0a527a8221fa764,0x9a4627f61e3ea7d9,0xa7ea9cb227d91e3e,0xa7fe964827f61a46
.quad 0xa800000000002800,0x280080000000a800,0x1648a7fea8000000,0x9cb227ea27f61a46,0x27f61a460000a800,0xa7a8a0a59e3e27d9,0x9cb227ea28008000,0x22d7a73ba7a8a0a5,0xa7d99e3e00002800,0x26a72472221fa764,0x1fc6a7c3a8000000,0xa55f25ed270e238b,0x27a820a58000a800,0xa513a62fa47226a7,0xa164278828008000,0x26dda41da62fa513
.quad 0xa764a21f00002800,0x221f276425a8a5a8,0x22d7a73ba8000000,0xa7c31fc62513262f,0x270e238b0000a800,0x9a46a7f6a6a72472,0xa41d26dd28008000,0x27fe1648a38ba70e,0xa6a7a47200002800,0x9e3e27d92764a21f,0x24c4a66da8000000,0xa788a16420a527a8,0x262f25138000a800,0x238ba70ea7d91e3e,0xa55f25ed28000000,0x266d24c49a46a7f6
.quad 0xa5a8a5a800002800,0xa5a825a828008000,0x25eda55fa8000000,0xa4c4a66d9a4627f6,0x2513262f0000a800,0x270ea38ba7d99e3e,0xa66d24c428008000,0x2164278820a5a7a8,0xa472a6a780002800,0xa7d91e3e2764221f,0x26dda41da8000000,0x9648a7fea38b270e,0x238b270e8000a800,0x27f61a46a6a7a472,0xa73b22d728000000,0x9fc627c32513a62f
.quad 0xa21fa76400002800,0xa764a21f25a825a8,0x2788a164a8000000,0x241da6dda62f2513,0x20a527a80000a800,0x262f2513a472a6a7,0xa7c31fc628008000,0xa5ed255f270ea38b,0x9e3ea7d900002800,0xa472a6a7221f2764,0x27ea9cb2a8000000,0x273ba2d7a7a820a5,0x1a4627f68000a800,0x20a527a89e3ea7d9,0xa7fe164828000000,0xa7ea1cb227f69a46
.quad 0xa800000000002800,0x280080008000a800,0x1fc6a7c3a7d99e3e,0xa164278827a820a5,0x270e238b221fa764,0xa62fa513a47226a7,0xa55f25ed26a72472,0x26dda41da513a62f,0xa472a6a7a5a825a8,0x1e3e27d92764a21f,0x2788a164a472a6a7,0xa7ea9cb21a4627f6,0x1a4627f62764a21f,0x238ba70ea7d99e3e,0xa7ea9cb21e3e27d9,0x255f25ed238ba70e
.quad 0x221fa764a8000000,0xa764221f25a825a8,0x266d24c41e3ea7d9,0x9648a7fea70e238b,0xa62f25132764221f,0x27a820a59e3ea7d9,0xa2d7a73ba47226a7,0xa4c4266d27f61a46,0x27d99e3ea5a8a5a8,0xa472a6a7a21f2764,0x964827fe26a7a472,0x27c39fc6a62fa513,0xa7a8a0a5221f2764,0x9a4627f626a7a472,0x241da6dda7d91e3e,0xa73ba2d720a527a8
.quad 0x25a825a88000a800,0x25a8a5a8a8000000,0xa6dd241d27d91e3e,0x22d7273b20a5a7a8,0xa0a5a7a8a21f2764,0xa7f61a4626a72472,0x27fe9648a6a7a472,0x1fc6a7c3a62f2513,0x9e3e27d925a8a5a8,0x26a72472a21fa764,0xa73ba2d7247226a7,0xa66d24c427f69a46,0x2513a62fa764221f,0xa0a5a7a89e3e27d9,0x24c4266d9e3ea7d9,0x27fe1648a70ea38b
.quad 0xa764221f28000000,0xa21f276425a8a5a8,0x9cb2a7ea9e3e27d9,0xa5eda55f238b270e,0x27f61a46a764a21f,0x270ea38ba7d91e3e,0xa16427882472a6a7,0x1cb227ea1a46a7f6,0xa6a7a47225a825a8,0xa7d99e3e2764221f,0x25eda55fa6a72472,0x241da6dda513262f,0x238b270ea21fa764,0x2513262fa472a6a7,0xa7c31fc627d99e3e,0xa788216427a8a0a5
.quad 0xa800000000002800,0x280080000000a800,0x22d7a73ba764a21f,0xa41d26dd270e238b,0x2513262f25a8a5a8,0xa38ba70ea6a72472,0xa7c31fc6221f2764,0x27fe16489a46a7f6,0x1e3ea7d9a8000000,0xa47226a72764221f,0x266d24c4221fa764,0xa2d7a73ba62f2513,0xa70e238b25a825a8,0x27f61a469e3ea7d9,0x9648a7fea764221f,0xa4c4266d27a820a5
.quad 0x2764221f0000a800,0xa21fa764a5a825a8,0xa5ed255f2764221f,0x27ea1cb2a0a5a7a8,0xa0a5a7a8a5a825a8,0xa513262f27d91e3e,0x27ea1cb2a21fa764,0xa164a788a513262f,0xa47226a728008000,0x27d91e3ea21fa764,0xa41da6dda21f2764,0xa55f25ed27f61a46,0x27f69a46a5a8a5a8,0xa0a5a7a8a47226a7,0xa16427882764a21f,0x27c31fc6a38ba70e
.quad 0xa5a8a5a800002800,0xa5a825a828000000,0x2788a164a764a21f,0x9fc6a7c3a38b270e,0x9a4627f625a8a5a8,0x27a820a5a472a6a7,0xa6dda41d221f2764,0xa5ed255f27f69a46,0x26a7a472a8008000,0x9e3ea7d9a21f2764,0x1cb227ea221fa764,0x27882164a513a62f,0xa7a8a0a525a825a8,0xa62f251327d99e3e,0x255fa5eda764221f,0x9cb2a7eaa0a527a8
.quad 0x221f27648000a800,0x2764221fa5a8a5a8,0xa7fe96482764221f,0xa66d24c427a8a0a5,0x238ba70ea5a825a8,0x9a46a7f69e3e27d9,0x24c4266da21fa764,0x273b22d7a62fa513,0xa7d91e3e28008000,0xa6a724722764a21f,0x1fc6a7c3a21f2764,0x9648a7fe9a4627f6,0x262f2513a5a8a5a8,0x270e238ba6a7a472,0xa73b22d72764a21f,0xa6dd241d270ea38b
.quad 0xa800000000002800,0x280000008000a800,0x24c4a66da6a7a472,0xa55f25ed262f2513,0x20a527a82764a21f,0x9a46a7f6a7d91e3e,0xa788a1649e3e27d9,0x266d24c4238ba70e,0x26a7a472a5a8a5a8,0xa7d91e3e221f2764,0x964827fe27d99e3e,0x241da6dda7a8a0a5,0xa62fa513a21f2764,0x20a527a826a7a472,0x27c39fc6a472a6a7,0xa73ba2d79a4627f6
.quad 0xa21f276428000000,0x2764a21fa5a8a5a8,0xa41da6dda47226a7,0xa164278827f69a46,0x27f61a46a21fa764,0xa38ba70ea47226a7,0xa55f25ed27d91e3e,0x27c31fc6a0a5a7a8,0x9e3ea7d9a5a825a8,0xa6a724722764221f,0x273b22d79e3ea7d9,0x1cb2a7eaa70e238b,0xa70e238b2764221f,0x2513262f1e3ea7d9,0x1cb2a7eaa6a72472,0xa7fe96482513262f
.quad 0x25a825a88000a800,0x25a8a5a8a8000000,0xa7ea1cb226a72472,0x164827fe2513a62f,0x238ba70ea764221f,0xa62fa5131e3e27d9,0x22d7273b1e3ea7d9,0x27ea9cb2a70ea38b,0xa7d99e3e25a825a8,0xa47226a72764a21f,0x25eda55fa7d91e3e,0x9fc6a7c3a0a527a8,0x1a4627f6221fa764,0x270e238ba472a6a7,0xa6dda41d247226a7,0xa788216427f61a46
.quad 0x2764a21fa8000000,0x221fa764a5a825a8,0x9fc627c32472a6a7,0x22d7273b9a46a7f6,0xa513a62f221f2764,0xa7a8a0a526a72472,0x27fe9648a7d99e3e,0x26dda41da7a820a5,0xa47226a725a8a5a8,0x9e3e27d9221fa764,0xa164a7881e3e27d9,0xa4c4a66d238b270e,0x27a820a5a764a21f,0x27f61a46a7d99e3e,0xa66d24c426a7a472,0xa5ed255f262fa513
.quad 0xa800000000002800,0x280080000000a800,0x25eda55fa5a8a5a8,0xa66d24c42513262f,0x9a4627f628000000,0x20a5a7a8a7d99e3e,0xa4c4a66da5a825a8,0x21642788270ea38b,0x27d91e3e8000a800,0xa6a7a472a21f2764,0xa6dd241d25a825a8,0x27fe9648a0a5a7a8,0x20a5a7a8a8000000,0xa62f251326a72472,0x22d7273b25a8a5a8,0x1fc6a7c3a7f61a46
.quad 0xa764a21f00002800,0x221f276425a8a5a8,0x2788a164a5a8a5a8,0xa6dda41d9a4627f6,0xa38b270e28000000,0x27f69a46a472a6a7,0x9fc6a7c3a5a825a8,0xa5ed255f27a820a5,0x26a724728000a800,0x1e3ea7d9a764221f,0xa7ea1cb225a825a8,0x22d7273b238ba70e,0x2513a62fa8000000,0xa70ea38b1e3e27d9,0x164827fe25a8a5a8,0x27ea9cb2a62fa513
.quad 0xa5a8a5a800002800,0xa5a825a828008000,0x27fe1648a5a8a5a8,0x1cb2a7eaa62f2513,0xa62f251328008000,0x238b270e1e3ea7d9,0x1cb2a7eaa5a825a8,0xa73ba2d7238b270e,0x247226a70000a800,0x27d99e3ea764a21f,0xa7c39fc625a825a8,0xa55f25ed27a8a0a5,0x270ea38ba8000000,0x1a46a7f6a47226a7,0xa164278825a8a5a8,0x241d26dd9a46a7f6
.quad 0xa21fa76480002800,0xa764a21f25a825a8,0x273b22d7a5a8a5a8,0x27c39fc6a7f69a46,0xa7a820a528008000,0xa513262f26a7a472,0x241da6dda5a825a8,0x1648a7fea0a527a8,0x1e3e27d98000a800,0x247226a7a21fa764,0xa66da4c425a825a8,0xa788a164270e238b,0x27f69a46a8000000,0x27a8a0a5a7d91e3e,0xa55f25ed25a8a5a8,0xa4c4266d2513a62f
.quad 0xa800000080002800,0x280000008000a800,0x26dda41da472a6a7,0xa73b22d7238b270e,0xa38b270e2764221f,0x2513a62fa6a7a472,0x9648a7fea7d91e3e,0x9fc627c327f61a46,0x247226a725a8a5a8,0x9e3ea7d9a764221f,0xa73ba2d79e3e27d9,0x24c4266d2513a62f,0x27f69a46a21fa764,0xa70ea38b9e3e27d9,0xa66d24c426a72472,0x27fe1648a0a5a7a8
.quad 0x221fa764a8000000,0xa764221f25a825a8,0x1cb227ea26a7a472,0x255fa5eda7a8a0a5,0xa513a62fa21f2764,0xa0a527a827d99e3e,0x278821649e3ea7d9,0x9cb2a7eaa62f2513,0xa7d91e3e25a825a8,0x247226a7221fa764,0x25eda55fa7d99e3e,0xa6dda41d1a4627f6,0xa0a527a82764a21f,0x27f61a46a472a6a7,0x9fc6a7c3a47226a7,0xa7882164270e238b
.quad 0x25a825a88000a800,0x25a8a5a8a8000000,0xa7c39fc6247226a7,0xa1642788270ea38b,0x27a8a0a5a764a21f,0x9a46a7f6a47226a7,0xa55f25ed27d99e3e,0x241d26dd1a46a7f6,0x1e3ea7d9a5a825a8,0xa6a7a472221f2764,0x216427881e3ea7d9,0x27ea1cb2a62fa513,0xa62fa513221f2764,0xa7a820a527d91e3e,0x27ea1cb2a6a7a472,0x25eda55fa7a820a5
.quad 0xa764221f28008000,0xa21f276425a8a5a8,0x24c4a66da6a72472,0x9648a7fea0a527a8,0x9a4627f6221fa764,0x238b270e9e3ea7d9,0xa2d7a73b1e3e27d9,0xa66da4c42513262f,0x26a72472a5a8a5a8,0x27d91e3ea764a21f,0xa7fe964827d91e3e,0xa7c31fc627f69a46,0x270ea38ba764221f,0x262fa513a6a72472,0xa41d26dd2472a6a7,0xa2d7273b238ba70e
.quad 0xa800000000002800,0x280080000000a800,0x2788a164a21fa764,0xa7c31fc620a527a8,0xa62f251325a825a8,0x270ea38ba472a6a7,0x241da6dda764a21f,0xa5ed255f262f2513,0x9e3e27d928000000,0x2472a6a7a764a21f,0x9cb2a7eaa764221f,0xa164278827f61a46,0x238b270e25a8a5a8,0x1a46a7f6a7d91e3e,0xa5eda55fa21f2764,0x1cb227ea270ea38b
.quad 0x2764221f8000a800,0xa21fa764a5a825a8,0xa7fe9648221f2764,0x24c4266d238ba70e,0x27a8a0a5a5a8a5a8,0xa62fa5139e3e27d9,0xa66d24c42764221f,0x273b22d79a46a7f6,0x2472a6a7a8000000,0xa7d99e3e221f2764,0x9fc627c32764a21f,0x27fe9648a513a62f,0x9a46a7f6a5a825a8,0xa7a820a526a72472,0x22d7273b221fa764,0x26dda41da7a8a0a5
.quad 0xa5a8a5a880002800,0xa5a825a828008000,0x273b22d7a21fa764,0x241da6dda7a820a5,0xa7f69a4625a825a8,0xa0a527a826a7a472,0x27c39fc6a764a21f,0x1648a7fea513262f,0xa6a7247228000000,0x1e3e27d9221fa764,0x24c4a66da764221f,0xa2d7a73b9a4627f6,0xa0a527a825a8a5a8,0x2513262f9e3ea7d9,0x9648a7fea21f2764,0xa66da4c4238b270e
.quad 0x221f27648000a800,0x2764221fa5a8a5a8,0xa55fa5ed221f2764,0xa7ea9cb2270e238b,0x270e238ba5a8a5a8,0x27f69a46a7d99e3e,0xa7ea9cb22764221f,0xa788216427f69a46,0x27d99e3ea8000000,0x26a7a472a764221f,0xa6dd241d2764a21f,0xa55f25ed262fa513,0x2513a62fa5a825a8,0x238ba70ea47226a7,0xa1642788221fa764,0x9fc627c320a5a7a8
.quad 0xa800000000002800,0x280000008000a800,0x27ea9cb29e3ea7d9,0xa7fe16481a4627f6,0xa7a820a5221f2764,0x27f69a469e3ea7d9,0x273ba2d7a472a6a7,0xa7ea1cb220a527a8,0xa6a7247225a825a8,0x27d99e3ea21fa764,0x25eda55fa6a7a472,0xa7c31fc6238b270e,0xa513262f2764221f,0x27a8a0a5a472a6a7,0x241da6dda7d99e3e,0xa78821642513262f
.quad 0xa21f276428008000,0x2764a21fa5a8a5a8,0x1fc6a7c3a7d91e3e,0xa73b22d7262f2513,0x9a4627f62764a21f,0x270ea38ba6a7a472,0x9648a7fea6a72472,0xa6dd241d270e238b,0x1e3e27d925a8a5a8,0x26a7a472a764a21f,0xa164a788a47226a7,0xa66d24c427a820a5,0x238b270e221fa764,0x262fa513a7d99e3e,0xa4c4a66d9e3e27d9,0xa5ed255f27f61a46
.quad 0x25a825a88000a800,0x25a8a5a8a8000000,0xa66da4c41e3e27d9,0xa55f25ed27f69a46,0x270e238ba21fa764,0x2513a62fa7d91e3e,0xa788a164247226a7,0xa4c4266d27a8a0a5,0x27d91e3ea5a8a5a8,0x2472a6a7a764221f,0xa7fe964826a72472,0xa41d26dd270ea38b,0x27f69a46a764a21f,0x238ba70ea6a72472,0xa7c31fc627d91e3e,0xa2d7273b262fa513
.quad 0x2764a21fa8008000,0x221fa764a5a825a8,0xa6dd241d27d99e3e,0xa16427882513a62f,0x262fa513a764221f,0x20a5a7a8a47226a7,0xa55f25ed26a7a472,0x9fc627c3238ba70e,0x2472a6a7a5a825a8,0x1e3ea7d9a21f2764,0xa2d7273b2472a6a7,0x9cb227ea20a5a7a8,0x20a5a7a8a21f2764,0x1a46a7f69e3e27d9,0x9cb227ea1e3ea7d9,0x964827fe1a46a7f6
.quad 0x8000a80028002800,0x8000a80000002800,0x1648a7fea8002800,0x1cb2a7ea9a4627f6,0x1a46a7f628002800,0x20a5a7a89e3e27d9,0x1cb2a7eaa8002800,0x22d7a73ba0a527a8,0x1e3ea7d928002800,0x2472a6a7a21f2764,0x1fc6a7c3a8002800,0x255fa5eda38b270e,0x20a5a7a828002800,0x262fa513a47226a7,0x2164a788a8002800,0x26dda41da513262f
.quad 0x221fa76428002800,0x2764a21fa5a825a8,0x22d7a73ba8002800,0x27c39fc6a62f2513,0x238ba70e28002800,0x27f69a46a6a72472,0x241da6dda8002800,0x27fe1648a70e238b,0x2472a6a728002800,0x27d91e3ea764221f,0x24c4a66da8002800,0x27882164a7a820a5,0x2513a62f28002800,0x270e238ba7d91e3e,0x255fa5eda8002800,0x266d24c4a7f61a46
.quad 0x25a8a5a828002800,0x25a825a8a8000000,0x25eda55fa8002800,0x24c4266da7f69a46,0x262fa51328002800,0x238b270ea7d99e3e,0x266da4c4a8002800,0x21642788a7a8a0a5,0x26a7a47228002800,0x1e3e27d9a764a21f,0x26dda41da8002800,0x164827fea70ea38b,0x270ea38b28002800,0x9a4627f6a6a7a472,0x273ba2d7a8002800,0x9fc627c3a62fa513
.quad 0x2764a21f28002800,0xa21f2764a5a8a5a8,0x2788a164a8002800,0xa41d26dda513a62f,0x27a8a0a528002800,0xa513262fa472a6a7,0x27c39fc6a8002800,0xa5ed255fa38ba70e,0x27d99e3e28002800,0xa6a72472a21fa764,0x27ea9cb2a8002800,0xa73b22d7a0a5a7a8,0x27f69a4628002800,0xa7a820a59e3ea7d9,0x27fe9648a8002800,0xa7ea1cb29a46a7f6
.quad 0x8000a80000002800,0x8000a80000002800,0x1fc6a7c39e3e27d9,0x2164a788a0a527a8,0x238ba70ea21f2764,0x2513a62fa47226a7,0x255fa5eda47226a7,0x26dda41da62f2513,0x26a7a472a5a825a8,0x27d99e3ea764221f,0x2788a164a6a72472,0x27ea1cb2a7f61a46,0x27f69a46a764221f,0x270e238ba7d99e3e,0x27ea1cb2a7d91e3e,0x255f25eda70ea38b
.quad 0x2764221fa8000000,0x221f2764a5a8a5a8,0x266d24c4a7d99e3e,0x164827fea38ba70e,0x2513262fa764a21f,0xa0a527a89e3ea7d9,0x22d7273ba6a7a472,0xa4c4266d1a46a7f6,0x1e3e27d9a5a8a5a8,0xa6a72472221fa764,0x964827fea472a6a7,0xa7c31fc62513a62f,0xa0a527a8a21fa764,0xa7f69a4626a7a472,0xa41d26dd9e3ea7d9,0xa73ba2d727a8a0a5
.quad 0xa5a825a88000a800,0xa5a8a5a828008000,0xa6dd241d1e3ea7d9,0xa2d7a73b27a820a5,0xa7a820a5221fa764,0x9a46a7f626a72472,0xa7fe16482472a6a7,0x1fc6a7c32513262f,0xa7d99e3e25a8a5a8,0x2472a6a7221f2764,0xa73ba2d726a7a472,0x266da4c41a4627f6,0xa62fa5132764a21f,0x27a8a0a59e3e27d9,0xa4c4a66d27d99e3e,0x27fe1648a38b270e
.quad 0xa21fa76428008000,0x2764221fa5a825a8,0x9cb2a7ea27d91e3e,0x25ed255fa70e238b,0x1a46a7f62764221f,0x238b270ea7d91e3e,0x2164a78826a72472,0x1cb227eaa7f69a46,0x2472a6a725a825a8,0x9e3e27d9a764a21f,0x25eda55f247226a7,0xa41d26dda62fa513,0x270ea38b221f2764,0xa62f2513a472a6a7,0x27c39fc61e3e27d9,0xa7882164a0a5a7a8
.quad 0x8000a80000002800,0x8000a80000002800,0x22d7a73ba21f2764,0x241da6dda38b270e,0x262fa513a5a825a8,0x270ea38ba6a72472,0x27c39fc6a764221f,0x27fe1648a7f61a46,0x27d91e3ea8008000,0x26a72472a764a21f,0x266d24c4a764a21f,0x22d7273ba513a62f,0x238b270ea5a8a5a8,0x9a4627f69e3ea7d9,0x164827fea21fa764,0xa4c4266d20a5a7a8
.quad 0xa21f27648000a800,0xa764221f25a8a5a8,0xa5ed255f221fa764,0xa7ea9cb227a8a0a5,0xa7a820a525a8a5a8,0xa62fa51327d91e3e,0xa7ea9cb22764a21f,0xa164a788262f2513,0xa6a7a47228008000,0x1e3ea7d9221f2764,0xa41da6dd2764221f,0x255fa5ed9a4627f6,0x9a46a7f625a825a8,0x27a8a0a5a47226a7,0x2164a788221f2764,0x27c31fc6a70e238b
.quad 0x25a8a5a800002800,0x25a825a8a8008000,0x2788a164a21f2764,0x1fc627c3a70ea38b,0x27f61a46a5a825a8,0xa0a527a8a472a6a7,0x26dd241da764221f,0xa5ed255f9a46a7f6,0x247226a7a8008000,0xa7d91e3e221fa764,0x1cb227eaa764a21f,0xa788a164262fa513,0xa0a527a8a5a8a5a8,0xa513a62f27d99e3e,0xa55f25eda21fa764,0x9cb2a7ea27a820a5
.quad 0xa764221f8000a800,0x221fa76425a825a8,0xa7fe9648221fa764,0x266da4c420a527a8,0xa70ea38b25a8a5a8,0x27f69a469e3e27d9,0xa4c4a66d2764a21f,0x273b22d7a513262f,0x9e3ea7d928008000,0x247226a7a764221f,0x1fc6a7c32764221f,0x164827fea7f69a46,0x2513a62f25a825a8,0xa38b270ea6a7a472,0x273ba2d7221f2764,0xa6dd241da38ba70e
.quad 0xa80000002800,0x8000a80000002800,0x24c4a66da47226a7,0x255fa5eda513262f,0x27a8a0a5a764221f,0x27f69a46a7d91e3e,0x27882164a7d99e3e,0x266d24c4a70ea38b,0x247226a7a5a8a5a8,0x1e3e27d9a21fa764,0x964827fe9e3ea7d9,0xa41d26dd20a5a7a8,0xa513262f221fa764,0xa7a820a526a7a472,0xa7c31fc626a7a472,0xa73ba2d727f61a46
.quad 0xa764a21f28008000,0xa21fa76425a825a8,0xa41da6dd26a72472,0x2164a7881a4627f6,0x1a46a7f6221f2764,0x270ea38ba47226a7,0x255fa5ed9e3e27d9,0x27c31fc6a7a820a5,0x27d99e3ea5a825a8,0x247226a7a764a21f,0x273b22d7a7d91e3e,0x9cb227eaa38ba70e,0x238b270ea764a21f,0xa62f25131e3ea7d9,0x9cb227eaa472a6a7,0xa7fe9648262fa513
.quad 0xa5a825a88000a800,0xa5a8a5a828008000,0xa7ea1cb22472a6a7,0x9648a7fe262f2513,0xa70ea38b2764a21f,0x2513a62f1e3e27d9,0xa2d7a73b27d91e3e,0x27ea9cb2a38b270e,0x1e3ea7d925a825a8,0x26a72472a764221f,0x25eda55f1e3e27d9,0x1fc627c3a7a8a0a5,0x27f69a46a21f2764,0xa38b270ea472a6a7,0x26dd241da6a72472,0xa78821641a46a7f6
.quad 0x221f2764a8000000,0xa764a21f25a8a5a8,0x9fc627c3a6a7a472,0xa2d7a73b27f69a46,0xa62f2513a21fa764,0x20a5a7a826a72472,0xa7fe16481e3ea7d9,0x26dda41d20a527a8,0xa6a7a47225a8a5a8,0x27d91e3ea21f2764,0xa164a78827d99e3e,0x24c4266da70e238b,0x20a5a7a82764221f,0x9a4627f6a7d99e3e,0x266da4c4247226a7,0xa5ed255fa513a62f
.quad 0xa80000002800,0x8000a80000002800,0x25eda55fa5a825a8,0x266da4c4a62f2513,0x27f61a46a8000000,0x27a820a5a7d99e3e,0x24c4266da5a8a5a8,0x21642788a38ba70e,0x9e3e27d90000a800,0xa47226a7221fa764,0xa6dd241d25a8a5a8,0xa7fe164827a8a0a5,0xa7a8a0a528008000,0xa513a62f26a72472,0xa2d7a73b25a825a8,0x1fc6a7c31a4627f6
.quad 0x221fa76400002800,0x2764a21fa5a825a8,0x2788a164a5a825a8,0x26dd241da7f69a46,0x270e238ba8000000,0x1a4627f6a472a6a7,0x1fc627c3a5a8a5a8,0xa5ed255f20a5a7a8,0xa47226a78000a800,0xa7d99e3e2764a21f,0xa7ea1cb225a8a5a8,0xa2d7a73b270e238b,0xa62fa51328008000,0x238ba70e1e3e27d9,0x9648a7fe25a825a8,0x27ea9cb2a513262f
.quad 0x25a8a5a800002800,0x25a825a8a8000000,0x27fe1648a5a825a8,0x9cb227eaa513a62f,0x2513262fa8000000,0xa70e238b1e3ea7d9,0x9cb227eaa5a8a5a8,0xa73ba2d7270ea38b,0xa6a724720000a800,0x9e3ea7d92764221f,0xa7c39fc625a8a5a8,0x255fa5ed20a527a8,0xa38ba70e28008000,0x27f61a46a47226a7,0x2164a78825a825a8,0x241d26dda7f61a46
.quad 0x2764a21f00002800,0xa21f2764a5a8a5a8,0x273b22d7a5a825a8,0xa7c31fc61a46a7f6,0x20a527a8a8000000,0xa62fa51326a7a472,0xa41d26dda5a8a5a8,0x1648a7fe27a820a5,0xa7d91e3e8000a800,0x26a7a472221f2764,0xa66da4c425a8a5a8,0x27882164a38b270e,0x9a46a7f628000000,0x20a527a8a7d91e3e,0x255fa5ed25a825a8,0xa4c4266da62fa513
.quad 0xa80000002800,0x8000a80000002800,0x26dda41da6a72472,0x273ba2d7a70e238b,0x270e238ba764a21f,0x262f2513a6a7a472,0x164827fe9e3ea7d9,0x9fc627c31a46a7f6,0xa6a7247225a8a5a8,0xa7d91e3e2764a21f,0xa73ba2d727d91e3e,0xa4c4a66d262f2513,0x9a46a7f6221f2764,0x238ba70e9e3e27d9,0x266da4c4a47226a7,0x27fe1648a7a820a5
.quad 0x2764221fa8000000,0x221f2764a5a8a5a8,0x1cb227eaa472a6a7,0xa55f25ed20a5a7a8,0xa62f2513221fa764,0xa7a8a0a527d99e3e,0xa788a16427d99e3e,0x9cb2a7ea2513262f,0x9e3ea7d925a825a8,0x26a7a472a21f2764,0x25eda55f9e3e27d9,0x26dd241da7f61a46,0x27a820a5a764221f,0x9a4627f6a472a6a7,0x1fc627c3a6a7a472,0xa7882164238ba70e
.quad 0xa5a825a80000a800,0xa5a8a5a828000000,0xa7c39fc626a7a472,0x2164a788238b270e,0xa0a5a7a82764221f,0x27f69a46a47226a7,0x255fa5ed1e3e27d9,0x241d26dda7f69a46,0x27d91e3ea5a825a8,0xa47226a7a21fa764,0x21642788a7d99e3e,0xa7ea9cb22513a62f,0xa513262fa21fa764,0xa0a5a7a827d91e3e,0xa7ea9cb22472a6a7,0x25eda55f20a527a8
.quad 0xa21fa76428008000,0x2764221fa5a825a8,0x24c4a66d247226a7,0x164827fea7a8a0a5,0x27f61a46a21f2764,0xa70e238b9e3ea7d9,0x22d7273ba7d91e3e,0xa66da4c4262fa513,0xa47226a7a5a8a5a8,0x1e3ea7d92764221f,0xa7fe96481e3ea7d9,0x27c39fc61a4627f6,0xa38ba70e2764a21f,0x2513262fa6a72472,0x241da6dd26a72472,0xa2d7273ba70ea38b
.quad 0xa80000002800,0x8000a80080002800,0x2788a164a764221f,0x27c39fc6a7a820a5,0x2513262fa5a8a5a8,0x238b270ea472a6a7,0xa41d26dd221fa764,0xa5ed255f2513a62f,0xa7d99e3e28000000,0xa6a7a4722764221f,0x9cb2a7ea221f2764,0x2164a7889a4627f6,0x270ea38ba5a825a8,0x27f61a46a7d91e3e,0x25ed255fa764a21f,0x1cb227eaa38ba70e
.quad 0xa21f27648000a800,0xa764221f25a8a5a8,0xa7fe96482764a21f,0xa4c4a66d270e238b,0xa0a5a7a825a825a8,0x2513a62f9e3e27d9,0x266da4c4a21f2764,0x273b22d7a7f61a46,0x26a72472a8000000,0x9e3e27d9a21fa764,0x9fc627c3a21fa764,0xa7fe1648262fa513,0xa7f61a4625a8a5a8,0xa0a5a7a826a72472,0xa2d7a73b2764221f,0x26dda41da0a527a8
.quad 0x25a8a5a800002800,0x25a825a8a8000000,0x273b22d7a764221f,0xa41d26dda0a5a7a8,0x9a4627f6a5a8a5a8,0xa7a8a0a526a7a472,0xa7c31fc6221fa764,0x1648a7fe262f2513,0xa472a6a728000000,0x27d99e3ea21f2764,0x24c4a66d221f2764,0x22d7273ba7f69a46,0x27a820a5a5a825a8,0xa62f25139e3ea7d9,0x164827fea764a21f,0xa66da4c4270ea38b
.quad 0xa764221f8000a800,0x221fa76425a825a8,0xa55fa5ed2764a21f,0x27ea1cb2a38b270e,0x238ba70e25a825a8,0x1a4627f6a7d99e3e,0x27ea1cb2a21f2764,0xa78821649a46a7f6,0x1e3e27d9a8000000,0xa472a6a72764a21f,0xa6dd241da21fa764,0x255fa5ed2513262f,0xa62fa51325a8a5a8,0x270e238ba47226a7,0x2164a7882764221f,0x9fc627c3a7a8a0a5
.quad 0xa80000002800,0x8000a80000002800,0x27ea9cb2a7d91e3e,0x27fe9648a7f61a46,0x20a527a8a21fa764,0x1a4627f69e3ea7d9,0xa73b22d726a7a472,0xa7ea1cb227a8a0a5,0xa472a6a725a825a8,0x9e3ea7d9221f2764,0x25eda55fa47226a7,0x27c39fc6a70e238b,0x262f2513a764a21f,0x20a527a8a472a6a7,0xa41d26dd1e3ea7d9,0xa7882164262fa513
.quad 0xa764a21f28000000,0xa21fa76425a825a8,0x1fc6a7c31e3e27d9,0x273ba2d7a513262f,0x27f61a46a764221f,0x238b270ea6a7a472,0x164827fea472a6a7,0xa6dd241d238ba70e,0xa7d91e3e25a8a5a8,0xa472a6a72764221f,0xa164a78826a72472,0x266da4c4a0a527a8,0x270ea38ba21f2764,0x2513262fa7d99e3e,0x24c4266da7d99e3e,0xa5ed255f1a46a7f6
.quad 0xa5a825a88000a800,0xa5a8a5a828008000,0xa66da4c427d99e3e,0x255fa5ed1a4627f6,0x238ba70e221f2764,0x262f2513a7d91e3e,0x27882164a6a72472,0xa4c4266da0a5a7a8,0x9e3e27d9a5a8a5a8,0xa6a7a4722764a21f,0xa7fe96482472a6a7,0x241da6dd238b270e,0x9a46a7f62764221f,0x270e238ba6a72472,0x27c39fc69e3e27d9,0xa2d7273ba513a62f
.quad 0x221f2764a8000000,0xa764a21f25a8a5a8,0xa6dd241d9e3ea7d9,0x2164a788262f2513,0xa513a62f2764a21f,0x27a820a5a47226a7,0x255fa5ed247226a7,0x9fc627c3a70ea38b,0x26a72472a5a825a8,0xa7d99e3e221fa764,0xa2d7273ba6a7a472,0x1cb2a7ea27a820a5,0xa7a8a0a5221fa764,0x27f61a469e3e27d9,0x1cb2a7ea27d91e3e,0x964827fea7f69a46
.quad 0x8000a80000002800,0x8000a80080002800,0x27fe1648a8000000,0x27ea1cb2a7f69a46,0x9a4627f68000a800,0xa0a527a81e3ea7d9,0xa7ea9cb228008000,0xa73ba2d727a820a5,0x1e3ea7d980002800,0x2472a6a7a21f2764,0x27c31fc6a8000000,0x25ed255fa70ea38b,0xa0a527a88000a800,0xa62f25132472a6a7,0xa788a16428000000,0xa41da6dd262f2513
.quad 0x221fa76400002800,0x2764a21fa5a825a8,0x273b22d7a8000000,0x1fc627c3a513a62f,0xa38b270e8000a800,0xa7f61a4626a7a472,0xa6dda41d28008000,0x1648a7fe238b270e,0x2472a6a700002800,0x27d91e3ea764221f,0x266d24c4a8000000,0xa1642788a0a5a7a8,0xa513262f8000a800,0xa70ea38b27d99e3e,0xa5eda55f28000000,0x24c4a66d1a4627f6
.quad 0x25a8a5a800002800,0x25a825a8a8000000,0x255f25eda8000000,0xa66d24c41a46a7f6,0xa62f25138000a800,0xa38ba70e27d91e3e,0xa4c4a66d28000000,0x2788a164a0a527a8,0x26a7a47280002800,0x1e3e27d9a764a21f,0x241d26dda8000000,0xa7fe1648238ba70e,0xa70e238b8000a800,0x1a46a7f626a72472,0xa2d7a73b28008000,0x27c31fc6a513262f
.quad 0x2764a21f00002800,0xa21f2764a5a8a5a8,0x21642788a8008000,0xa6dda41d262fa513,0xa7a820a58000a800,0x2513a62f247226a7,0x9fc6a7c328008000,0x255f25eda70e238b,0x27d99e3e00002800,0xa6a72472a21fa764,0x1cb227eaa8000000,0xa2d7a73b27a8a0a5,0xa7f61a460000a800,0x27a8a0a51e3e27d9,0x9648a7fe28008000,0x1cb227eaa7f61a46
.quad 0x8000a80000002800,0x8000a80000002800,0x27c31fc6a7d99e3e,0x27882164a7a8a0a5,0xa38b270e221fa764,0xa513262f2472a6a7,0xa5eda55f26a72472,0xa41da6dd2513262f,0x26a7a472a5a825a8,0x27d99e3ea764221f,0x21642788a472a6a7,0x9cb227ea9a46a7f6,0xa7f61a462764a21f,0xa70ea38b27d91e3e,0x1cb2a7ea1e3e27d9,0x25eda55fa38b270e
.quad 0x2764221fa8000000,0x221f2764a5a8a5a8,0xa4c4266d1e3ea7d9,0xa7fe1648270ea38b,0xa513a62f2764221f,0x20a5a7a81e3e27d9,0x273ba2d7a47226a7,0x266d24c4a7f69a46,0x1e3e27d9a5a8a5a8,0xa6a72472221fa764,0xa7fe964826a7a472,0x9fc6a7c3262f2513,0x20a5a7a8221f2764,0x27f61a46a6a72472,0x26dd241da7d91e3e,0xa2d7273ba0a5a7a8
.quad 0xa5a825a88000a800,0xa5a8a5a828008000,0xa41da6dd27d91e3e,0x273ba2d7a0a527a8,0x27a8a0a5a21f2764,0x1a4627f6a6a7a472,0x164827fea6a7a472,0xa7c39fc6262fa513,0xa7d99e3e25a8a5a8,0x2472a6a7221f2764,0x22d7a73b247226a7,0x24c4266da7f61a46,0x262f2513a764221f,0xa7a820a51e3ea7d9,0xa66d24c49e3ea7d9,0x1648a7fe270e238b
.quad 0xa21fa76428008000,0x2764221fa5a825a8,0x27ea9cb29e3e27d9,0xa55f25eda38ba70e,0x9a4627f6a764a21f,0xa38ba70e27d99e3e,0xa788a1642472a6a7,0x27ea9cb29a4627f6,0x2472a6a725a825a8,0x9e3e27d9a764a21f,0x255f25eda6a72472,0xa6dda41d2513a62f,0xa70e238ba21fa764,0x262fa513247226a7,0x9fc6a7c327d99e3e,0x21642788a7a820a5
.quad 0x8000a80000002800,0x8000a80080002800,0x273b22d7a764a21f,0x26dd241da70ea38b,0xa62f251325a8a5a8,0xa70e238b26a7a472,0x9fc6a7c3221f2764,0x1648a7fe1a4627f6,0x27d91e3ea8000000,0x26a72472a764a21f,0xa4c4266d221fa764,0xa73b22d7262fa513,0xa38ba70e25a825a8,0x1a46a7f61e3e27d9,0x27fe9648a764221f,0x266d24c4a7a8a0a5
.quad 0xa21f27648000a800,0xa764221f25a8a5a8,0xa55fa5ed2764221f,0x1cb2a7ea20a527a8,0x27a8a0a5a5a825a8,0x262f2513a7d99e3e,0x9cb227eaa21fa764,0xa78821642513a62f,0xa6a7a47228008000,0x1e3ea7d9221f2764,0x26dda41da21f2764,0x25ed255fa7f69a46,0x1a4627f6a5a8a5a8,0xa7a820a52472a6a7,0xa788a1642764a21f,0x1fc6a7c3238b270e
.quad 0x25a8a5a880002800,0x25a825a8a8008000,0x21642788a764a21f,0xa7c31fc6238ba70e,0xa7f69a4625a8a5a8,0x20a5a7a8247226a7,0x241da6dd221f2764,0x255f25eda7f61a46,0x247226a7a8008000,0xa7d91e3e221fa764,0xa7ea1cb2221fa764,0x2164a7882513262f,0x20a5a7a825a825a8,0x2513262fa7d91e3e,0x25ed255fa764221f,0xa7ea1cb220a5a7a8
.quad 0xa764221f8000a800,0x221fa76425a825a8,0x1648a7fe2764221f,0x24c4266da7a820a5,0x270e238ba5a825a8,0xa7f61a461e3ea7d9,0xa66d24c4a21fa764,0x22d7a73b262f2513,0x9e3ea7d928008000,0x247226a7a764221f,0x27c31fc6a21f2764,0xa7fe16481a46a7f6,0xa513262fa5a8a5a8,0x238ba70e26a72472,0xa2d7a73b2764a21f,0x241d26dda70e238b
.quad 0x8000a80000002800,0xa80000002800,0x266d24c4a6a7a472,0x25ed255fa62fa513,0xa7a820a52764a21f,0xa7f61a4627d99e3e,0x2164a7889e3e27d9,0x24c4a66da38b270e,0x247226a7a5a8a5a8,0x1e3e27d9a21fa764,0xa7fe964827d99e3e,0xa6dda41d27a820a5,0x2513a62fa21f2764,0x27a8a0a5a6a72472,0x1fc627c3a472a6a7,0xa2d7273b1a46a7f6
.quad 0xa764a21f28000000,0xa21fa76425a825a8,0x26dda41da47226a7,0x27882164a7f61a46,0x9a4627f6a21fa764,0xa70e238b2472a6a7,0xa5eda55f27d91e3e,0x1fc6a7c320a527a8,0x27d99e3ea5a825a8,0x247226a7a764a21f,0xa2d7273b9e3ea7d9,0xa7ea9cb2270ea38b,0xa38ba70e2764221f,0x262fa5139e3e27d9,0x27ea1cb2a6a72472,0x964827fea513a62f
.quad 0xa5a825a80000a800,0xa5a8a5a828000000,0x9cb2a7ea26a72472,0x27fe9648a513262f,0x270e238ba764221f,0xa513262f9e3ea7d9,0xa73b22d71e3ea7d9,0x9cb2a7ea270e238b,0x1e3ea7d925a825a8,0x26a72472a764221f,0x255f25eda7d91e3e,0xa7c31fc620a5a7a8,0xa7f61a46221fa764,0x238ba70e247226a7,0x241da6dd247226a7,0x21642788a7f69a46
.quad 0x221f2764a8000000,0xa764a21f25a8a5a8,0xa7c39fc62472a6a7,0x273ba2d71a4627f6,0x262fa513221f2764,0xa0a527a8a6a7a472,0x164827fea7d99e3e,0xa41da6dd27a8a0a5,0xa6a7a47225a8a5a8,0x27d91e3ea21f2764,0x2788a1641e3e27d9,0xa66d24c4a38ba70e,0xa0a527a8a764a21f,0x1a46a7f627d91e3e,0xa4c4a66d26a7a472,0x255f25eda62f2513
.quad 0x8000a80000002800,0x8000a80080002800,0x255f25eda5a8a5a8,0x24c4266da513a62f,0xa7f69a4628000000,0xa7a8a0a527d91e3e,0x266da4c4a5a825a8,0x2788a164a70e238b,0x9e3e27d90000a800,0xa47226a7221fa764,0xa41da6dd25a825a8,0x9648a7fe20a527a8,0x27a820a5a8008000,0x2513262fa6a7a472,0xa73b22d725a8a5a8,0xa7c39fc627f69a46
.quad 0x221fa76400002800,0x2764a21fa5a825a8,0x21642788a5a8a5a8,0xa41d26dd1a46a7f6,0xa70ea38b28008000,0x9a46a7f6247226a7,0x27c39fc6a5a825a8,0x255f25eda7a8a0a5,0xa47226a78000a800,0xa7d99e3e2764a21f,0x9cb2a7ea25a825a8,0x273ba2d7a38b270e,0x262f2513a8000000,0xa38b270e9e3ea7d9,0xa7fe164825a8a5a8,0x9cb2a7ea262f2513
.quad 0x25a8a5a800002800,0x25a825a8a8000000,0x964827fea5a8a5a8,0xa7ea9cb2262fa513,0xa513a62f28008000,0x270ea38b9e3e27d9,0x27ea1cb2a5a825a8,0xa2d7273ba38ba70e,0xa6a724720000a800,0x9e3ea7d92764221f,0x1fc6a7c325a825a8,0x25ed255fa7a820a5,0x238b270ea8000000,0xa7f69a462472a6a7,0xa788a16425a8a5a8,0x26dda41d1a4627f6
.quad 0x2764a21f00002800,0xa21f2764a5a8a5a8,0xa2d7273ba5a8a5a8,0x9fc6a7c327f61a46,0xa0a5a7a828000000,0x262f2513a6a72472,0x26dd241da5a825a8,0xa7fe964820a5a7a8,0xa7d91e3e8000a800,0x26a7a472221f2764,0x24c4a66d25a825a8,0xa1642788a70ea38b,0x1a4627f6a8008000,0xa0a5a7a827d99e3e,0xa5eda55f25a8a5a8,0x266d24c4a513262f
.quad 0x8000a80080002800,0xa80000002800,0x241d26dda472a6a7,0x22d7273ba38ba70e,0xa70ea38b2764221f,0xa62fa51326a72472,0x27fe9648a7d91e3e,0x27c31fc6a7f69a46,0xa6a7247225a8a5a8,0xa7d91e3e2764a21f,0x22d7a73b9e3e27d9,0x266da4c4a513262f,0x1a4627f6a21fa764,0xa38b270e1e3ea7d9,0xa4c4a66d26a72472,0x1648a7fe20a527a8
.quad 0x2764221fa8000000,0x221f2764a5a8a5a8,0xa7ea1cb226a7a472,0xa5eda55f27a820a5,0x262fa513a21f2764,0x27a820a5a7d91e3e,0xa16427889e3ea7d9,0xa7ea1cb2262fa513,0x9e3ea7d925a825a8,0x26a7a472a21f2764,0x255f25eda7d99e3e,0xa41d26dd9a46a7f6,0xa7a8a0a52764a21f,0x1a46a7f6247226a7,0x27c39fc6a47226a7,0x21642788a70ea38b
.quad 0xa5a825a88000a800,0xa5a8a5a828008000,0x1fc6a7c3247226a7,0x27882164a70e238b,0x20a527a8a764a21f,0xa7f61a462472a6a7,0xa5eda55f27d99e3e,0x26dda41d9a4627f6,0x27d91e3ea5a825a8,0xa47226a7a21fa764,0xa78821641e3ea7d9,0x1cb2a7ea262f2513,0x2513a62f221f2764,0x20a527a8a7d99e3e,0x9cb227eaa6a7a472,0xa55fa5ed27a8a0a5
.quad 0xa21fa76428008000,0x2764221fa5a825a8,0x266d24c4a6a72472,0xa7fe164820a5a7a8,0xa7f69a46221fa764,0x270ea38b1e3e27d9,0x273ba2d71e3e27d9,0xa4c4266da513a62f,0xa47226a7a5a8a5a8,0x1e3ea7d92764221f,0x1648a7fe27d91e3e,0x1fc627c3a7f61a46,0x238b270ea764221f,0xa513a62f26a7a472,0xa6dda41d2472a6a7,0x273b22d7a38b270e
.quad 0x8000a80000002800,0x8000a80080002800,0x21642788a21fa764,0x1fc627c3a0a5a7a8,0xa513a62f25a825a8,0xa38ba70e247226a7,0x26dd241da764a21f,0x255f25eda62fa513,0xa7d99e3e28000000,0xa6a7a4722764221f,0x27ea9cb2a764221f,0x27882164a7f69a46,0xa70e238b25a8a5a8,0xa7f69a4627d99e3e,0x255fa5eda21f2764,0x27ea9cb2a70e238b
.quad 0xa21f27640000a800,0xa764221f25a8a5a8,0x1648a7fe221f2764,0x266da4c4a38b270e,0x20a527a8a5a8a5a8,0xa513262f1e3ea7d9,0xa4c4a66d2764221f,0x22d7a73b1a4627f6,0x26a72472a8000000,0x9e3e27d9a21fa764,0xa7c39fc62764a21f,0x9648a7fe2513262f,0x27f69a46a5a825a8,0x20a527a8a6a7a472,0xa73b22d7221fa764,0xa41da6dd27a820a5
.quad 0x25a8a5a800002800,0x25a825a8a8000000,0xa2d7273ba21fa764,0xa6dda41d27a8a0a5,0x1a46a7f625a825a8,0x27a820a5a6a72472,0x1fc627c3a764a21f,0xa7fe96482513a62f,0xa472a6a728000000,0x27d99e3ea21f2764,0x266d24c4a764221f,0xa73b22d71a46a7f6,0xa7a8a0a525a8a5a8,0x262fa5131e3e27d9,0x27fe9648a21f2764,0xa4c4266da38ba70e
.quad 0xa764221f8000a800,0x221fa76425a825a8,0x25eda55f221f2764,0x9cb227eaa70ea38b,0xa38b270ea5a8a5a8,0x9a46a7f627d91e3e,0x1cb2a7ea2764221f,0x21642788a7f61a46,0x1e3e27d9a8000000,0xa472a6a72764a21f,0xa41da6dd2764a21f,0x25ed255fa62f2513,0x262f2513a5a825a8,0xa70ea38b2472a6a7,0xa788a164221fa764,0x27c31fc6a0a527a8
.quad 0x8000a80000002800,0xa80000002800,0x1cb227ea9e3ea7d9,0x164827fe9a46a7f6,0xa0a5a7a8221f2764,0x9a46a7f61e3e27d9,0x22d7273ba472a6a7,0x1cb227eaa0a5a7a8,0xa472a6a725a825a8,0x9e3ea7d9221f2764,0x255f25eda6a7a472,0x1fc627c3a38ba70e,0xa62fa5132764221f,0xa0a5a7a8247226a7,0x26dd241da7d99e3e,0x21642788a513a62f
.quad 0xa764a21f28008000,0xa21fa76425a825a8,0x27c31fc6a7d91e3e,0x22d7273ba62fa513,0xa7f69a462764a21f,0xa38ba70e26a72472,0x27fe9648a6a72472,0x241d26dda70ea38b,0xa7d91e3e25a8a5a8,0xa472a6a72764221f,0x2788a164a47226a7,0x24c4266da7a8a0a5,0xa70e238b221fa764,0xa513a62f27d91e3e,0x266da4c49e3e27d9,0x255f25eda7f69a46
.quad 0xa5a825a88000a800,0xa5a8a5a828008000,0x24c4a66d1e3e27d9,0x25ed255fa7f61a46,0xa38b270ea21fa764,0xa62fa51327d99e3e,0x2164a788247226a7,0x266d24c4a7a820a5,0x9e3e27d9a5a8a5a8,0xa6a7a4722764a21f,0x1648a7fe26a72472,0x26dd241da70e238b,0x1a4627f6a764a21f,0xa70ea38b26a7a472,0x9fc6a7c327d91e3e,0x273b22d7a62f2513
.quad 0x221f2764a8000000,0xa764a21f25a8a5a8,0xa41da6dd27d99e3e,0x27882164a513262f,0x2513262fa764221f,0xa7a8a0a52472a6a7,0xa5eda55f26a7a472,0x27c31fc6a38b270e,0x26a72472a5a825a8,0xa7d99e3e221fa764,0xa73ba2d72472a6a7,0x27ea1cb2a0a527a8,0x27a820a5a21f2764,0xa7f69a461e3ea7d9,0xa7ea9cb21e3ea7d9,0x27fe16489a4627f6
.quad 0x2800800028002800,0xa80000008000a800,0x27fe1648a8002800,0xa7ea9cb21a46a7f6,0x27f61a4628002800,0xa7a8a0a51e3ea7d9,0x27ea1cb2a8002800,0xa73ba2d720a5a7a8,0x27d91e3e28002800,0xa6a7a472221fa764,0x27c31fc6a8002800,0xa5eda55f238ba70e,0x27a820a528002800,0xa513a62f2472a6a7,0x27882164a8002800,0xa41da6dd2513a62f
.quad 0x2764221f28002800,0xa21fa76425a8a5a8,0x273b22d7a8002800,0x9fc6a7c3262fa513,0x270e238b28002800,0x9a46a7f626a7a472,0x26dd241da8002800,0x1648a7fe270ea38b,0x26a7247228002800,0x1e3ea7d92764a21f,0x266d24c4a8002800,0x2164a78827a8a0a5,0x262f251328002800,0x238ba70e27d99e3e,0x25ed255fa8002800,0x24c4a66d27f69a46
.quad 0x25a825a828002800,0x25a8a5a828008000,0x255f25eda8002800,0x266da4c427f61a46,0x2513262f28002800,0x270ea38b27d91e3e,0x24c4266da8002800,0x2788a16427a820a5,0x247226a728002800,0x27d99e3e2764221f,0x241d26dda8002800,0x27fe9648270e238b,0x238b270e28002800,0x27f61a4626a72472,0x22d7273ba8002800,0x27c31fc6262f2513
.quad 0x221f276428002800,0x2764221f25a825a8,0x21642788a8002800,0x26dd241d2513262f,0x20a527a828002800,0x262f2513247226a7,0x1fc627c3a8002800,0x255f25ed238b270e,0x1e3e27d928002800,0x247226a7221f2764,0x1cb227eaa8002800,0x22d7273b20a527a8,0x1a4627f628002800,0x20a527a81e3e27d9,0x164827fea8002800,0x1cb227ea1a4627f6
.quad 0x2800800000002800,0xa80080008000a800,0x27c31fc69e3e27d9,0xa788a16420a5a7a8,0x270e238ba21f2764,0xa62fa5132472a6a7,0x25ed255fa47226a7,0xa41da6dd262fa513,0x247226a7a5a825a8,0x9e3ea7d92764a21f,0x21642788a6a72472,0x1cb2a7ea27f69a46,0x1a4627f6a764221f,0x238ba70e27d91e3e,0x9cb227eaa7d91e3e,0x25eda55f270e238b
.quad 0xa21f2764a8008000,0x2764a21f25a825a8,0xa4c4266da7d99e3e,0x27fe9648238b270e,0xa62f2513a764a21f,0x27a820a51e3e27d9,0xa73b22d7a6a7a472,0x266d24c49a4627f6,0xa7d91e3ea5a8a5a8,0x247226a7a21f2764,0xa7fe9648a472a6a7,0x1fc627c3a513262f,0xa7a8a0a5a21fa764,0x9a4627f6a6a72472,0xa6dda41d9e3ea7d9,0xa2d7273ba7a820a5
.quad 0xa5a8a5a88000a800,0xa5a825a8a8008000,0xa41da6dd1e3ea7d9,0xa73b22d7a7a8a0a5,0xa0a5a7a8221fa764,0xa7f61a46a6a7a472,0x9648a7fe2472a6a7,0xa7c39fc6a513a62f,0x1e3ea7d925a8a5a8,0xa6a7a472a21fa764,0x22d7a73b26a7a472,0xa4c4a66d9a46a7f6,0x2513a62f2764a21f,0xa0a5a7a81e3ea7d9,0x266da4c427d99e3e,0x1648a7fe238ba70e
.quad 0x2764a21f28008000,0x221fa76425a8a5a8,0x27ea9cb227d91e3e,0x255fa5ed270ea38b,0x27f61a462764221f,0x270ea38b27d99e3e,0x2788216426a72472,0x27ea9cb227f61a46,0x26a7247225a825a8,0x27d91e3e2764221f,0x255f25ed247226a7,0x26dd241d262f2513,0x238b270e221f2764,0x2513262f247226a7,0x1fc627c31e3e27d9,0x2164278820a527a8
.quad 0x2800800000002800,0xa80000008000a800,0x273b22d7a21f2764,0xa6dda41d238ba70e,0x2513262fa5a825a8,0xa38ba70e26a7a472,0x1fc627c3a764221f,0x1648a7fe27f69a46,0x9e3e27d9a8008000,0x2472a6a72764221f,0xa4c4266da764a21f,0x273ba2d72513262f,0xa70e238ba5a8a5a8,0x27f61a461e3e27d9,0xa7fe1648a21fa764,0x266d24c4a0a527a8
.quad 0xa764a21f0000a800,0x221f2764a5a825a8,0xa55fa5ed221fa764,0x9cb227eaa7a820a5,0xa0a5a7a825a8a5a8,0xa513262fa7d99e3e,0x1cb2a7ea2764a21f,0xa7882164a62fa513,0x2472a6a728008000,0xa7d99e3ea21fa764,0x26dda41d2764221f,0xa5eda55f1a46a7f6,0x27f69a4625a825a8,0xa0a5a7a82472a6a7,0x27882164221f2764,0x1fc6a7c3270ea38b
.quad 0x25a825a800002800,0x25a8a5a828008000,0x21642788a21f2764,0x27c39fc6270e238b,0x9a4627f6a5a825a8,0x27a820a5247226a7,0xa41d26dda764221f,0x255f25ed1a4627f6,0xa6a72472a8008000,0x1e3e27d9a21f2764,0xa7ea1cb2a764a21f,0xa1642788a62f2513,0xa7a8a0a5a5a8a5a8,0xa62f2513a7d91e3e,0xa5eda55fa21fa764,0xa7ea1cb2a7a8a0a5
.quad 0xa21fa7648000a800,0xa764a21fa5a8a5a8,0x1648a7fe221fa764,0xa4c4a66da0a5a7a8,0x238ba70e25a8a5a8,0x9a46a7f61e3ea7d9,0x266da4c42764a21f,0x22d7a73b2513a62f,0x27d99e3e28008000,0x26a7a4722764a21f,0x27c31fc62764221f,0x27fe964827f61a46,0x262f251325a825a8,0x270e238b26a72472,0x22d7273b221f2764,0x241d26dd238b270e
.quad 0x2800800000002800,0xa80000000000a800,0x266d24c4a47226a7,0xa5eda55f2513a62f,0x20a527a8a764221f,0x9a46a7f627d99e3e,0xa1642788a7d99e3e,0x24c4a66d270e238b,0xa6a72472a5a8a5a8,0x27d99e3e221f2764,0xa7fe96489e3ea7d9,0x26dd241da0a527a8,0xa62fa513221fa764,0x20a527a8a6a72472,0x9fc6a7c326a7a472,0xa2d7273ba7f69a46
.quad 0x221fa76428000000,0xa764221fa5a8a5a8,0x26dda41d26a72472,0xa788a1649a46a7f6,0x27f61a46221f2764,0xa38ba70e2472a6a7,0x25ed255f9e3e27d9,0x1fc6a7c327a8a0a5,0x1e3e27d9a5a825a8,0x26a7a4722764221f,0xa2d7273ba7d91e3e,0x27ea1cb2238b270e,0xa70e238ba764a21f,0x2513262f9e3e27d9,0xa7ea9cb2a472a6a7,0x964827fea62f2513
.quad 0xa5a8a5a80000a800,0xa5a825a8a8000000,0x9cb2a7ea2472a6a7,0xa7fe1648a62fa513,0x238ba70e2764a21f,0xa62fa5139e3ea7d9,0x273ba2d727d91e3e,0x9cb2a7ea238ba70e,0x27d91e3e25a825a8,0x2472a6a72764a21f,0x255f25ed1e3e27d9,0x27c39fc627a820a5,0x1a4627f6a21f2764,0x270e238b247226a7,0xa41d26dda6a72472,0x216427889a4627f6
.quad 0xa764221fa8000000,0xa21f2764a5a825a8,0xa7c39fc6a6a7a472,0xa73b22d7a7f61a46,0xa513a62fa21fa764,0xa7a8a0a5a6a7a472,0x9648a7fe1e3ea7d9,0xa41da6dda0a5a7a8,0x2472a6a725a8a5a8,0x1e3ea7d9221fa764,0x2788a16427d99e3e,0x266da4c4270ea38b,0x27a820a52764221f,0x27f61a4627d91e3e,0x24c4266d247226a7,0x255f25ed2513262f
.quad 0x2800800000002800,0xa80000008000a800,0x255f25eda5a825a8,0xa4c4a66d262fa513,0x9a4627f6a8000000,0x20a5a7a827d91e3e,0xa66d24c4a5a8a5a8,0x2788a164238b270e,0xa7d99e3e0000a800,0x26a72472a21f2764,0xa41da6dd25a8a5a8,0x164827fea7a820a5,0x20a5a7a828008000,0xa62f2513a6a7a472,0x273ba2d725a825a8,0xa7c39fc69a46a7f6
.quad 0x2764221f80002800,0xa21fa76425a8a5a8,0x21642788a5a825a8,0x241da6dd27f61a46,0xa38b270ea8000000,0x27f69a46247226a7,0xa7c31fc6a5a8a5a8,0x255f25eda0a527a8,0xa6a7a4728000a800,0x9e3e27d9a764221f,0x9cb2a7ea25a8a5a8,0xa73b22d7a70ea38b,0x2513a62f28000000,0xa70ea38b9e3ea7d9,0x27fe964825a825a8,0x9cb2a7ea2513a62f
.quad 0x25a825a800002800,0x25a8a5a828000000,0x964827fea5a825a8,0x27ea1cb22513262f,0xa62f2513a8000000,0x238b270e9e3e27d9,0xa7ea9cb2a5a8a5a8,0xa2d7273ba70e238b,0xa472a6a70000a800,0xa7d91e3ea764a21f,0x1fc6a7c325a8a5a8,0xa5eda55fa0a5a7a8,0x270ea38b28008000,0x1a46a7f62472a6a7,0x2788216425a825a8,0x26dda41d27f69a46
.quad 0x221f276400002800,0x2764221f25a825a8,0xa2d7273ba5a825a8,0x1fc627c39a4627f6,0xa7a820a5a8000000,0xa513262fa6a72472,0xa6dda41da5a8a5a8,0xa7fe9648a7a8a0a5,0x9e3ea7d98000a800,0xa472a6a7a21fa764,0x24c4a66d25a8a5a8,0x2164a788238ba70e,0x27f69a4628000000,0x27a8a0a527d99e3e,0x25ed255f25a825a8,0x266d24c4262f2513
.quad 0x2800000000002800,0xa80000008000a800,0x241d26dda6a72472,0xa2d7a73b270ea38b,0xa38b270ea764a21f,0x2513a62f26a72472,0xa7fe16489e3ea7d9,0x27c31fc69a4627f6,0xa472a6a725a8a5a8,0x1e3e27d9a764221f,0x22d7a73b27d91e3e,0xa66d24c4a62fa513,0x27f69a46221f2764,0xa70ea38b1e3ea7d9,0x24c4266da47226a7,0x1648a7fe27a8a0a5
.quad 0xa21f2764a8008000,0x2764a21f25a825a8,0xa7ea1cb2a472a6a7,0x25ed255fa0a527a8,0xa513a62f221fa764,0xa0a527a8a7d91e3e,0x2164a78827d99e3e,0xa7ea1cb2a513a62f,0x27d99e3e25a825a8,0xa472a6a7221fa764,0x255f25ed9e3e27d9,0x241da6dd27f69a46,0xa0a527a8a764221f,0x27f61a46247226a7,0xa7c31fc6a6a7a472,0x21642788a38b270e
.quad 0xa5a8a5a88000a800,0xa5a825a8a8000000,0x1fc6a7c326a7a472,0xa788a164a38ba70e,0x27a8a0a52764221f,0x9a46a7f62472a6a7,0x25ed255f1e3e27d9,0x26dda41d27f61a46,0x9e3e27d9a5a825a8,0x26a72472221f2764,0xa7882164a7d99e3e,0x9cb227eaa513262f,0xa62fa513a21fa764,0xa7a820a5a7d99e3e,0x1cb2a7ea2472a6a7,0xa55fa5eda0a5a7a8
.quad 0x2764a21f28008000,0x221fa76425a8a5a8,0x266d24c4247226a7,0x27fe964827a820a5,0x9a4627f6a21f2764,0x238b270e1e3e27d9,0xa73b22d7a7d91e3e,0xa4c4266da62f2513,0xa6a7a472a5a8a5a8,0xa7d99e3ea764a21f,0x1648a7fe1e3ea7d9,0x9fc6a7c39a46a7f6,0x270ea38b2764a21f,0x262fa51326a7a472,0x26dd241d26a72472,0x273b22d7270e238b
.quad 0x2800800000002800,0xa80000008000a800,0x21642788a764221f,0x9fc6a7c327a8a0a5,0xa62f2513a5a8a5a8,0x270ea38b247226a7,0xa6dda41d221fa764,0x255f25eda513262f,0x1e3ea7d928008000,0xa47226a7a764a21f,0x27ea9cb2221f2764,0xa788a1641a46a7f6,0x238b270ea5a825a8,0x1a46a7f627d99e3e,0xa55f25eda764a21f,0x27ea9cb2238b270e
.quad 0xa764a21f0000a800,0x221f2764a5a825a8,0x1648a7fe2764a21f,0xa66d24c4a70ea38b,0x27a8a0a525a825a8,0xa62fa5131e3ea7d9,0x24c4266da21f2764,0x22d7a73b27f69a46,0xa47226a7a8000000,0x27d91e3e221f2764,0xa7c39fc6a21fa764,0x164827fea62f2513,0x9a46a7f625a8a5a8,0xa7a820a5a6a7a472,0x273ba2d72764221f,0xa41da6dd20a5a7a8
.quad 0x25a825a880002800,0x25a8a5a828008000,0xa2d7273ba764221f,0x26dd241d20a527a8,0xa7f69a46a5a8a5a8,0xa0a527a8a6a72472,0x9fc6a7c3221fa764,0xa7fe9648a62fa513,0x26a7a47228008000,0x9e3ea7d9221fa764,0x266d24c4221f2764,0x273ba2d727f61a46,0xa0a527a8a5a825a8,0x2513262f1e3e27d9,0xa7fe1648a764a21f,0xa4c4266da70e238b
.quad 0xa21fa7648000a800,0xa764a21fa5a8a5a8,0x25eda55f2764a21f,0x1cb2a7ea238ba70e,0x270e238b25a825a8,0x27f69a4627d91e3e,0x9cb227eaa21f2764,0x216427881a4627f6,0xa7d91e3ea8000000,0xa6a72472a764221f,0xa41da6dda21fa764,0xa5eda55fa513a62f,0x2513a62f25a8a5a8,0x238ba70e2472a6a7,0x278821642764221f,0x27c31fc627a820a5
.quad 0x2800800080002800,0xa80000008000a800,0x1cb227eaa7d91e3e,0x9648a7fe27f69a46,0xa7a820a5a21fa764,0x27f69a461e3e27d9,0xa2d7a73b26a7a472,0x1cb227eaa7a820a5,0x26a7a47225a825a8,0xa7d91e3ea21fa764,0x255f25eda47226a7,0x9fc6a7c3270ea38b,0xa513262fa764a21f,0x27a8a0a5247226a7,0xa6dda41d1e3ea7d9,0x21642788a62f2513
.quad 0x221fa76428000000,0xa764221fa5a8a5a8,0x27c31fc61e3e27d9,0xa2d7a73b2513a62f,0x9a4627f6a764221f,0x270ea38b26a72472,0xa7fe1648a472a6a7,0x241d26dda38b270e,0x9e3ea7d925a8a5a8,0xa6a72472a764a21f,0x2788a16426a72472,0xa4c4a66d20a5a7a8,0x238b270ea21f2764,0x262fa51327d91e3e,0xa66d24c4a7d99e3e,0x255f25ed9a4627f6
.quad 0xa5a8a5a88000a800,0xa5a825a8a8008000,0x24c4a66d27d99e3e,0xa5eda55f9a46a7f6,0x270e238b221f2764,0x2513a62f27d99e3e,0xa1642788a6a72472,0x266d24c420a527a8,0xa7d99e3ea5a8a5a8,0xa47226a7a764221f,0x1648a7fe2472a6a7,0xa6dda41da38ba70e,0x27f69a462764221f,0x238ba70e26a7a472,0x1fc627c39e3e27d9,0x273b22d72513262f
.quad 0xa764221fa8000000,0xa21f2764a5a825a8,0xa41da6dd9e3ea7d9,0xa788a164a62fa513,0x262fa5132764a21f,0x20a5a7a82472a6a7,0x25ed255f247226a7,0x27c31fc6270e238b,0xa47226a7a5a825a8,0x9e3e27d9a21f2764,0xa73ba2d7a6a7a472,0xa7ea9cb2a7a8a0a5,0x20a5a7a8221fa764,0x1a46a7f61e3ea7d9,0x27ea1cb227d91e3e,0x27fe164827f61a46
.quad 0x2800000000002800,0xa80080008000a800,0x964827fea8000000,0x1cb2a7ea27f61a46,0xa7f69a468000a800,0x27a820a59e3e27d9,0x1cb2a7ea28000000,0xa2d7273ba7a8a0a5,0x27d91e3e80002800,0xa6a7a472221fa764,0x9fc627c3a8000000,0x255fa5ed270e238b,0xa7a8a0a58000a800,0x2513262fa47226a7,0x2164a78828008000,0xa6dd241da62fa513
.quad 0x2764221f80002800,0xa21fa76425a8a5a8,0xa2d7273ba8008000,0x27c39fc62513262f,0xa70ea38b8000a800,0x1a4627f6a6a72472,0x241da6dd28008000,0xa7fe9648a38ba70e,0x26a7247200002800,0x1e3ea7d92764a21f,0xa4c4266da8000000,0x2788216420a527a8,0xa62fa5130000a800,0xa38b270ea7d91e3e,0x255fa5ed28008000,0xa66da4c49a46a7f6
.quad 0x25a825a800002800,0x25a8a5a828008000,0xa5ed255fa8000000,0x24c4266d9a4627f6,0xa513a62f8000a800,0xa70e238ba7d99e3e,0x266da4c428000000,0xa164a78820a5a7a8,0x247226a780002800,0x27d99e3e2764221f,0xa6dd241da8000000,0x164827fea38b270e,0xa38ba70e8000a800,0xa7f69a46a6a7a472,0x273ba2d728008000,0x1fc6a7c32513a62f
.quad 0x221f276400002800,0x2764221f25a825a8,0xa7882164a8008000,0xa41d26dda62f2513,0xa0a5a7a88000a800,0xa62fa513a472a6a7,0x27c39fc628008000,0x25eda55f270ea38b,0x1e3e27d900002800,0x247226a7221f2764,0xa7ea1cb2a8000000,0xa73b22d7a7a820a5,0x9a46a7f60000a800,0xa0a5a7a89e3ea7d9,0x27fe964828008000,0x27ea9cb227f69a46
.quad 0x2800800000002800,0xa80000008000a800,0x9fc627c3a7d99e3e,0x2164a78827a820a5,0xa70ea38b221fa764,0x262f2513a47226a7,0x255fa5ed26a72472,0xa6dd241da513a62f,0x247226a7a5a825a8,0x9e3ea7d92764a21f,0xa7882164a472a6a7,0x27ea1cb21a4627f6,0x9a46a7f62764a21f,0xa38b270ea7d99e3e,0x27ea1cb21e3e27d9,0xa55fa5ed238ba70e
.quad 0xa21f2764a8000000,0x2764a21f25a825a8,0xa66da4c41e3ea7d9,0x164827fea70e238b,0x262fa5132764221f,0xa7a8a0a59e3ea7d9,0x22d7273ba47226a7,0x24c4a66d27f61a46,0xa7d91e3ea5a8a5a8,0x247226a7a21f2764,0x1648a7fe26a7a472,0xa7c31fc6a62fa513,0x27a820a5221f2764,0x1a46a7f626a7a472,0xa41d26dda7d91e3e,0x273b22d720a527a8
.quad 0xa5a8a5a80000a800,0xa5a825a8a8000000,0x26dda41d27d91e3e,0xa2d7a73b20a5a7a8,0x20a527a8a21f2764,0x27f69a4626a72472,0xa7fe1648a6a7a472,0x9fc627c3a62f2513,0x1e3ea7d925a8a5a8,0xa6a7a472a21fa764,0x273b22d7247226a7,0x266da4c427f69a46,0xa513262fa764221f,0x20a527a89e3e27d9,0xa4c4a66d9e3ea7d9,0xa7fe9648a70ea38b
.quad 0x2764a21f28008000,0x221fa76425a8a5a8,0x1cb227ea9e3e27d9,0x25ed255f238b270e,0xa7f69a46a764a21f,0xa70e238ba7d91e3e,0x2164a7882472a6a7,0x9cb2a7ea1a46a7f6,0x26a7247225a825a8,0x27d91e3e2764221f,0xa5ed255fa6a72472,0xa41d26dda513262f,0xa38ba70ea21fa764,0xa513a62fa472a6a7,0x27c39fc627d99e3e,0x2788a16427a8a0a5
.quad 0x2800800000002800,0xa80000000000a800,0xa2d7273ba764a21f,0x241da6dd270e238b,0xa513a62f25a8a5a8,0x238b270ea6a72472,0x27c39fc6221f2764,0xa7fe96489a46a7f6,0x9e3e27d9a8008000,0x2472a6a72764221f,0xa66da4c4221fa764,0x22d7273ba62f2513,0x270ea38b25a825a8,0xa7f69a469e3ea7d9,0x164827fea764221f,0x24c4a66d27a820a5
.quad 0xa764a21f0000a800,0x221f2764a5a825a8,0x25eda55f2764221f,0xa7ea9cb2a0a5a7a8,0x20a527a8a5a825a8,0x2513a62f27d91e3e,0xa7ea9cb2a21fa764,0x21642788a513262f,0x2472a6a728008000,0xa7d99e3ea21fa764,0x241d26dda21f2764,0x255fa5ed27f61a46,0xa7f61a46a5a8a5a8,0x20a527a8a47226a7,0x2164a7882764a21f,0xa7c39fc6a38ba70e
.quad 0x25a825a800002800,0x25a8a5a828000000,0xa7882164a764a21f,0x1fc627c3a38b270e,0x1a46a7f625a8a5a8,0xa7a8a0a5a472a6a7,0x26dd241d221f2764,0x25eda55f27f69a46,0xa6a72472a8008000,0x1e3e27d9a21f2764,0x9cb2a7ea221fa764,0xa788a164a513a62f,0x27a820a525a825a8,0x262fa51327d99e3e,0xa55f25eda764221f,0x1cb227eaa0a527a8
.quad 0xa21fa7648000a800,0xa764a21fa5a8a5a8,0x27fe16482764221f,0x266da4c427a8a0a5,0xa38b270ea5a825a8,0x1a4627f69e3e27d9,0xa4c4a66da21fa764,0xa73ba2d7a62fa513,0x27d99e3e28008000,0x26a7a4722764a21f,0x9fc627c3a21f2764,0x164827fe9a4627f6,0xa62fa513a5a8a5a8,0xa70ea38ba6a7a472,0x273ba2d72764a21f,0x26dda41d270ea38b
.quad 0x2800800000002800,0xa80000008000a800,0xa4c4266da6a7a472,0x255fa5ed262f2513,0xa0a5a7a82764a21f,0x1a4627f6a7d91e3e,0x278821649e3e27d9,0xa66da4c4238ba70e,0xa6a72472a5a8a5a8,0x27d99e3e221f2764,0x1648a7fe27d99e3e,0xa41d26dda7a8a0a5,0x262f2513a21f2764,0xa0a5a7a826a7a472,0xa7c31fc6a472a6a7,0x273b22d79a4627f6
.quad 0x221fa76428000000,0xa764221fa5a8a5a8,0x241d26dda47226a7,0x2164a78827f69a46,0xa7f69a46a21fa764,0x238b270ea47226a7,0x255fa5ed27d91e3e,0xa7c39fc6a0a5a7a8,0x1e3e27d9a5a825a8,0x26a7a4722764221f,0xa73ba2d79e3ea7d9,0x9cb227eaa70e238b,0x270ea38b2764221f,0xa513a62f1e3ea7d9,0x9cb227eaa6a72472,0x27fe16482513262f
.quad 0xa5a8a5a88000a800,0xa5a825a8a8000000,0x27ea9cb226a72472,0x9648a7fe2513a62f,0xa38b270ea764221f,0x262f25131e3e27d9,0xa2d7a73b1e3ea7d9,0xa7ea1cb2a70ea38b,0x27d91e3e25a825a8,0x2472a6a72764a21f,0xa5ed255fa7d91e3e,0x1fc627c3a0a527a8,0x9a46a7f6221fa764,0xa70ea38ba472a6a7,0x26dd241d247226a7,0x2788a16427f61a46
.quad 0xa764221fa8000000,0xa21f2764a5a825a8,0x1fc6a7c32472a6a7,0xa2d7a73b9a46a7f6,0x2513262f221f2764,0x27a820a526a72472,0xa7fe1648a7d99e3e,0xa6dd241da7a820a5,0x2472a6a725a8a5a8,0x1e3ea7d9221fa764,0x216427881e3e27d9,0x24c4266d238b270e,0xa7a8a0a5a764a21f,0xa7f69a46a7d99e3e,0x266da4c426a7a472,0x25eda55f262fa513
.quad 0x2800000000002800,0xa80000008000a800,0xa5ed255fa5a8a5a8,0x266da4c42513262f,0x1a46a7f628008000,0xa0a527a8a7d99e3e,0x24c4266da5a825a8,0xa164a788270ea38b,0xa7d99e3e8000a800,0x26a72472a21f2764,0x26dda41d25a825a8,0xa7fe1648a0a5a7a8,0xa0a527a8a8000000,0x262fa51326a72472,0xa2d7a73b25a8a5a8,0x9fc627c3a7f61a46
.quad 0x2764221f80002800,0xa21fa76425a8a5a8,0xa7882164a5a8a5a8,0x26dd241d9a4627f6,0x238ba70e28008000,0xa7f61a46a472a6a7,0x1fc627c3a5a825a8,0x25eda55f27a820a5,0xa6a7a4728000a800,0x9e3e27d9a764221f,0x27ea9cb225a825a8,0xa2d7a73b238ba70e,0xa513262fa8008000,0x270e238b1e3e27d9,0x9648a7fe25a8a5a8,0xa7ea1cb2a62fa513
.quad 0x25a825a880002800,0x25a8a5a828008000,0xa7fe9648a5a8a5a8,0x9cb227eaa62f2513,0x262fa51328008000,0xa38ba70e1e3ea7d9,0x9cb227eaa5a825a8,0x273b22d7238b270e,0xa472a6a78000a800,0xa7d91e3ea764a21f,0x27c31fc625a825a8,0x255fa5ed27a8a0a5,0xa70e238ba8008000,0x9a4627f6a47226a7,0x2164a78825a8a5a8,0xa41da6dd9a46a7f6
.quad 0x221f276400002800,0x2764221f25a825a8,0xa73ba2d7a5a8a5a8,0xa7c31fc6a7f69a46,0x27a8a0a528008000,0x2513a62f26a7a472,0xa41d26dda5a825a8,0x964827fea0a527a8,0x9e3ea7d98000a800,0xa472a6a7a21fa764,0x266d24c425a825a8,0x27882164270e238b,0xa7f61a46a8008000,0xa7a820a5a7d91e3e,0x255fa5ed25a8a5a8,0x24c4a66d2513a62f
.quad 0x2800800000002800,0xa80000008000a800,0xa6dd241da472a6a7,0x273ba2d7238b270e,0x238ba70e2764221f,0xa513262fa6a7a472,0x164827fea7d91e3e,0x1fc6a7c327f61a46,0xa472a6a725a8a5a8,0x1e3e27d9a764221f,0x273b22d79e3e27d9,0xa4c4a66d2513a62f,0xa7f61a46a21fa764,0x270e238b9e3e27d9,0x266da4c426a72472,0xa7fe9648a0a5a7a8
.quad 0xa21f2764a8000000,0x2764a21f25a825a8,0x9cb2a7ea26a7a472,0xa55f25eda7a8a0a5,0x2513262fa21f2764,0x20a5a7a827d99e3e,0xa788a1649e3ea7d9,0x1cb227eaa62f2513,0x27d99e3e25a825a8,0xa472a6a7221fa764,0xa5ed255fa7d99e3e,0x26dd241d1a4627f6,0x20a5a7a82764a21f,0xa7f69a46a472a6a7,0x1fc627c3a47226a7,0x2788a164270e238b
.quad 0xa5a8a5a88000a800,0xa5a825a8a8008000,0x27c31fc6247226a7,0x2164a788270ea38b,0xa7a820a5a764a21f,0x1a4627f6a47226a7,0x255fa5ed27d99e3e,0xa41da6dd1a46a7f6,0x9e3e27d9a5a825a8,0x26a72472221f2764,0xa164a7881e3ea7d9,0xa7ea9cb2a62fa513,0x262f2513221f2764,0x27a8a0a527d91e3e,0xa7ea9cb2a6a7a472,0xa5ed255fa7a820a5
.quad 0x2764a21f28008000,0x221fa76425a8a5a8,0xa4c4266da6a72472,0x164827fea0a527a8,0x1a46a7f6221fa764,0xa38ba70e9e3ea7d9,0x22d7273b1e3e27d9,0x266d24c42513262f,0xa6a7a472a5a8a5a8,0xa7d99e3ea764a21f,0x27fe164827d91e3e,0x27c39fc627f69a46,0xa70e238ba764221f,0xa62f2513a6a72472,0x241da6dd2472a6a7,0x22d7a73b238ba70e
.quad 0x2800800080002800,0xa80080008000a800,0xa7882164a21fa764,0x27c39fc620a527a8,0x262fa51325a825a8,0xa70e238ba472a6a7,0xa41d26dda764a21f,0x25eda55f262f2513,0x1e3ea7d928000000,0xa47226a7a764a21f,0x1cb227eaa764221f,0x2164a78827f61a46,0xa38ba70e25a8a5a8,0x9a4627f6a7d91e3e,0x25ed255fa21f2764,0x9cb2a7ea270ea38b
.quad 0xa764a21f0000a800,0x221f2764a5a825a8,0x27fe1648221f2764,0xa4c4a66d238ba70e,0xa7a820a5a5a8a5a8,0x262f25139e3e27d9,0x266da4c42764221f,0xa73ba2d79a46a7f6,0xa47226a7a8000000,0x27d91e3e221f2764,0x1fc6a7c32764a21f,0xa7fe1648a513a62f,0x1a4627f6a5a825a8,0x27a8a0a526a72472,0xa2d7a73b221fa764,0xa6dd241da7a8a0a5
.quad 0x25a825a800002800,0x25a8a5a828008000,0xa73ba2d7a21fa764,0xa41d26dda7a820a5,0x27f61a4625a825a8,0x20a5a7a826a7a472,0xa7c31fc6a764a21f,0x964827fea513262f,0x26a7a47228008000,0x9e3ea7d9221fa764,0xa4c4266da764221f,0x22d7273b9a4627f6,0x20a5a7a825a8a5a8,0xa513a62f9e3ea7d9,0x164827fea21f2764,0x266d24c4238b270e
.quad 0xa21fa7648000a800,0xa764a21fa5a8a5a8,0x255f25ed221f2764,0x27ea1cb2270e238b,0xa70ea38ba5a8a5a8,0xa7f61a46a7d99e3e,0x27ea1cb22764221f,0x2788a16427f69a46,0xa7d91e3ea8000000,0xa6a72472a764221f,0x26dda41d2764a21f,0x255fa5ed262fa513,0xa513262fa5a825a8,0xa38b270ea47226a7,0x2164a788221fa764,0x1fc6a7c320a5a7a8
.quad 0x2800800000002800,0xa80080008000a800,0xa7ea1cb29e3ea7d9,0x27fe96481a4627f6,0x27a8a0a5221f2764,0xa7f61a469e3ea7d9,0xa73b22d7a472a6a7,0x27ea9cb220a527a8,0x26a7a47225a825a8,0xa7d91e3ea21fa764,0xa5ed255fa6a7a472,0x27c39fc6238b270e,0x2513a62f2764221f,0xa7a820a5a472a6a7,0xa41d26dda7d99e3e,0x2788a1642513262f
.quad 0x221fa76428000000,0xa764221fa5a8a5a8,0x9fc627c3a7d91e3e,0x273ba2d7262f2513,0x1a46a7f62764a21f,0xa70e238ba6a7a472,0x164827fea6a72472,0x26dda41d270e238b,0x9e3ea7d925a8a5a8,0xa6a72472a764a21f,0x21642788a47226a7,0x266da4c427a820a5,0xa38ba70e221fa764,0xa62f2513a7d99e3e,0x24c4266d9e3e27d9,0x25eda55f27f61a46
.quad 0xa5a8a5a80000a800,0xa5a825a8a8000000,0x266d24c41e3e27d9,0x255fa5ed27f69a46,0xa70ea38ba21fa764,0xa513262fa7d91e3e,0x27882164247226a7,0x24c4a66d27a8a0a5,0xa7d99e3ea5a8a5a8,0xa47226a7a764221f,0x27fe164826a72472,0x241da6dd270ea38b,0xa7f61a46a764a21f,0xa38b270ea6a72472,0x27c39fc627d91e3e,0x22d7a73b262fa513
.quad 0xa764221fa8000000,0xa21f2764a5a825a8,0x26dda41d27d99e3e,0x2164a7882513a62f,0xa62f2513a764221f,0xa0a527a8a47226a7,0x255fa5ed26a7a472,0x1fc6a7c3238ba70e,0xa47226a7a5a825a8,0x9e3e27d9a21f2764,0x22d7a73b2472a6a7,0x1cb2a7ea20a5a7a8,0xa0a527a8a21f2764,0x9a4627f69e3e27d9,0x1cb2a7ea1e3ea7d9,0x1648a7fe1a46a7f6
.quad 0x924827ffa8002800,0x98b527fa964827fe,0x98b527fa28002800,0x9f0327ce9cb227ea,0x9bd627f1a8002800,0xa1c227779fc627c3,0x9d7927e228002800,0xa3e326f6a1642788,0x9f0327cea8002800,0xa4ec264fa2d7273b,0xa04427b628002800,0xa5cb2584a41d26dd,0xa1052799a8002800,0xa68a249ba4c4266d,0xa1c2277728002800,0xa7252332a55f25ed
.quad 0xa27c2750a8002800,0xa7992105a5ed255f,0xa332272528002800,0xa7e21d79a66d24c4,0xa3e326f6a8002800,0xa7ff1248a6dd241d,0xa44826c228002800,0xa7f19bd6a73b22d7,0xa49b268aa8002800,0xa7b6a044a7882164,0xa4ec264f28002800,0xa750a27ca7c31fc6,0xa53a260fa8002800,0xa6c2a448a7ea1cb2,0xa58425cb28002800,0xa60fa53aa7fe1648
.quad 0xa5cb2584a8002800,0xa53aa60fa7fe9648,0xa60f253a28002800,0xa448a6c2a7ea9cb2,0xa64f24eca8002800,0xa27ca750a7c39fc6,0xa68a249b28002800,0xa044a7b6a788a164,0xa6c22448a8002800,0x9bd6a7f1a73ba2d7,0xa6f623e328002800,0x1248a7ffa6dda41d,0xa7252332a8002800,0x1d79a7e2a66da4c4,0xa750227c28002800,0x2105a799a5eda55f
.quad 0xa77721c2a8002800,0x2332a725a55fa5ed,0xa799210528002800,0x249ba68aa4c4a66d,0xa7b62044a8002800,0x2584a5cba41da6dd,0xa7ce1f0328002800,0x264fa4eca2d7a73b,0xa7e21d79a8002800,0x26f6a3e3a164a788,0xa7f11bd628002800,0x2777a1c29fc6a7c3,0xa7fa18b5a8002800,0x27ce9f039cb2a7ea,0xa7ff124828002800,0x27fa98b59648a7fe
.quad 0x9bd627f19a4627f6,0x9d7927e29cb227ea,0xa1c22777a0a527a8,0xa3e326f6a2d7273b,0xa49b268aa38b270e,0xa60f253aa55f25ed,0xa60f253aa513262f,0xa77721c2a6dd241d,0xa7252332a62f2513,0xa7ff1248a7c31fc6,0xa7ce1f03a70e238b,0xa799a105a7fe9648,0xa7ff9248a7a820a5,0xa64fa4eca788a164,0xa7b6a044a7f61a46,0xa448a6c2a66da4c4
.quad 0xa6f6a3e3a7f69a46,0x9f03a7cea4c4a66d,0xa5cba584a7a8a0a5,0x1bd6a7f1a164a788,0xa448a6c2a70ea38b,0x2332a7259648a7fe,0xa105a799a62fa513,0x25cba5841fc6a7c3,0x98b5a7faa513a62f,0x2750a27c241da6dd,0x1d79a7e2a38ba70e,0x27fa98b525eda55f,0x227ca750a0a5a7a8,0x27b62044273ba2d7,0x24eca64f9a46a7f6,0x268a249b27ea9cb2
.quad 0x264fa4ec1a46a7f6,0x249b268a27ea1cb2,0x2750a27c20a5a7a8,0x204427b6273b22d7,0x27e29d79238ba70e,0x98b527fa25ed255f,0x27fa18b52513a62f,0xa27c2750241d26dd,0x27992105262fa513,0xa58425cb1fc627c3,0x26c22448270ea38b,0xa7252332964827fe,0x258425cb27a8a0a5,0xa7f11bd6a1642788,0x23e326f627f69a46,0xa7ce9f03a4c4266d
.quad 0x204427b627f61a46,0xa6c2a448a66d24c4,0x124827ff27a820a5,0xa4eca64fa7882164,0x9f0327ce270e238b,0xa105a799a7fe1648,0xa3322725262f2513,0x1248a7ffa7c39fc6,0xa53a260f2513262f,0x21c2a777a6dda41d,0xa68a249b238b270e,0x253aa60fa55fa5ed,0xa77721c220a527a8,0x26f6a3e3a2d7a73b,0xa7f11bd61a4627f6,0x27e29d799cb2a7ea
.quad 0x9f0327ce9e3e27d9,0xa04427b69fc627c3,0xa4ec264fa47226a7,0xa5cb2584a55f25ed,0xa7252332a6a72472,0xa7ce1f03a7882164,0xa7ff1248a7d91e3e,0xa799a105a7ea9cb2,0xa750a27ca7d99e3e,0xa53aa60fa66da4c4,0xa53aa60fa6a7a472,0x9d79a7e2a2d7a73b,0xa044a7b6a472a6a7,0x21c2a7771648a7fe,0x1d79a7e29e3ea7d9,0x264fa4ec241da6dd
.quad 0x249ba68a1e3ea7d9,0x27f19bd626dda41d,0x26f6a3e32472a6a7,0x2750227c27fe9648,0x27fa98b526a7a472,0x249b268a273b22d7,0x277721c227d99e3e,0x18b527fa24c4266d,0x258425cb27d91e3e,0xa33227251cb227ea,0x2105279926a72472,0xa6c22448a1642788,0x9bd627f1247226a7,0xa7ff1248a5ed255f,0xa44826c21e3e27d9,0xa6f6a3e3a7c31fc6
.quad 0xa6c224489e3e27d9,0xa3e3a6f6a7c39fc6,0xa7f11bd6a47226a7,0x1248a7ffa5eda55f,0xa799a105a6a72472,0x2448a6c2a164a788,0xa5cba584a7d91e3e,0x2725a3321cb2a7ea,0xa1c2a777a7d99e3e,0x27fa18b524c4a66d,0x18b5a7faa6a7a472,0x268a249b273ba2d7,0x23e3a6f6a472a6a7,0x227c275027fe1648,0x268aa49b9e3ea7d9,0x9bd627f126dd241d
.quad 0x27e29d791e3ea7d9,0xa4ec264f241d26dd,0x27b620442472a6a7,0xa77721c2164827fe,0x260f253a26a7a472,0xa7e29d79a2d7273b,0x227c275027d99e3e,0xa60fa53aa66d24c4,0x924827ff27d91e3e,0xa105a799a7ea1cb2,0xa332272526a72472,0x1f03a7cea788a164,0xa64f24ec247226a7,0x2584a5cba55fa5ed,0xa7ce1f031e3e27d9,0x27b6a0449fc6a7c3
.quad 0xa1052799a0a527a8,0xa1c22777a1642788,0xa68a249ba62f2513,0xa7252332a6dd241d,0xa7ff9248a7f61a46,0xa7b6a044a7ea9cb2,0xa64fa4eca70ea38b,0xa448a6c2a55fa5ed,0xa044a7b6a38ba70e,0x1d79a7e29648a7fe,0x21c2a7771a46a7f6,0x264fa4ec24c4a66d,0x26c2a4482513a62f,0x27fa18b527c39fc6,0x27fa18b527a8a0a5,0x258425cb273b22d7
.quad 0x260f253a27a820a5,0x124827ff22d7273b,0x1f0327ce2513262f,0xa53a260f9fc627c3,0xa27c27501a4627f6,0xa7f11bd6a66d24c4,0xa6f623e3a38b270e,0xa68aa49ba7fe9648,0xa7f19bd6a70e238b,0x9f03a7cea5eda55f,0xa5cba584a7f69a46,0x23e3a6f69cb2a7ea,0x9d79a7e2a62fa513,0x2799a105241da6dd,0x2332a725a0a5a7a8,0x2750227c2788a164
.quad 0x2725a33220a5a7a8,0x227c275027882164,0x27e21d79262fa513,0xa1052799241d26dd,0x258425cb27f69a46,0xa6f623e39cb227ea,0x1bd627f1270e238b,0xa7ce9f03a5ed255f,0xa3e326f6238b270e,0xa49ba68aa7fe1648,0xa750227c9a4627f6,0x1bd6a7f1a66da4c4,0xa7ce9f03a513262f,0x260fa53a9fc6a7c3,0xa53aa60fa7a820a5,0x27ff124822d7a73b
.quad 0x98b5a7faa7a8a0a5,0x25cb2584273ba2d7,0x2448a6c2a513a62f,0x18b527fa27c31fc6,0x2777a1c29a46a7f6,0xa4ec264f24c4266d,0x27b62044238ba70e,0xa7e21d79964827fe,0x24ec264f270ea38b,0xa6c2a448a55f25ed,0x124827ff27f61a46,0xa044a7b6a7ea1cb2,0xa49b268a262f2513,0x2332a725a6dda41d,0xa799210520a527a8,0x2777a1c2a164a788
.quad 0xa27c2750a21f2764,0xa3322725a2d7273b,0xa7992105a764221f,0xa7e21d79a7c31fc6,0xa6f6a3e3a764a21f,0xa5cba584a66da4c4,0x9f03a7cea21fa764,0x1bd6a7f19648a7fe,0x249ba68a221fa764,0x26f6a3e325eda55f,0x27f19bd62764a21f,0x2750227c27ea1cb2,0x260f253a2764221f,0x1f0327ce241d26dd,0x124827ff221f2764,0xa53a260fa1642788
.quad 0xa5cb2584a21f2764,0xa7fa98b5a7882164,0xa7fa98b5a764221f,0xa448a6c2a6dda41d,0xa4eca64fa764a21f,0x21c2a7779cb2a7ea,0x1d79a7e2a21fa764,0x27b6a044255fa5ed,0x26c2a448221fa764,0x264f24ec27fe1648,0x27b620442764a21f,0x924827ff24c4266d,0x233227252764221f,0xa68a249b9fc627c3,0xa1c22777221f2764,0xa799a105a73b22d7
.quad 0xa77721c2a21f2764,0xa105a799a73ba2d7,0xa725a332a764221f,0x249ba68a9fc6a7c3,0xa044a7b6a764a21f,0x27ff924824c4a66d,0x2448a6c2a21fa764,0x24ec264f27fe9648,0x27e29d79221fa764,0xa04427b6255f25ed,0x264f24ec2764a21f,0xa77721c29cb227ea,0x18b527fa2764221f,0xa6c2a448a6dd241d,0xa58425cb221f2764,0x98b5a7faa788a164
.quad 0xa7ff9248a21f2764,0x260fa53aa164a788,0xa53aa60fa764221f,0x27ce1f03241da6dd,0x1bd6a7f1a764a21f,0x227c275027ea9cb2,0x268aa49ba21fa764,0xa3e326f625ed255f,0x27ce1f03221fa764,0xa7f11bd6964827fe,0x23e326f62764a21f,0xa584a5cba66d24c4,0xa10527992764221f,0x1d79a7e2a7c39fc6,0xa750227c221f2764,0x2725a332a2d7a73b
.quad 0xa3e326f6a38b270e,0xa44826c2a41d26dd,0xa7ff1248a7f61a46,0xa7f19bd6a7fe9648,0xa448a6c2a513a62f,0xa105a799a2d7a73b,0x2332a72520a5a7a8,0x25cba58424c4a66d,0x27fa98b527a8a0a5,0x277721c227ea1cb2,0x249b268a262f2513,0x18b527fa21642788,0xa27c27509a4627f6,0xa6f623e3a55f25ed,0xa7f11bd6a70e238b,0xa68aa49ba7c39fc6
.quad 0xa4eca64fa70ea38b,0x1d79a7e29fc6a7c3,0x21c2a7779a46a7f6,0x27b6a04425eda55f,0x27e29d79262fa513,0x253a260f27882164,0x253a260f27a820a5,0xa27c27501cb227ea,0xa105279920a527a8,0xa7ff1248a66d24c4,0xa7ce1f03a513262f,0xa332a725a73ba2d7,0xa584a5cba7f69a46,0x24eca64f9648a7fe,0x2044a7b6a38ba70e,0x27ce1f0326dda41d
.quad 0x27b6a044238ba70e,0x1f0327ce26dd241d,0x25cb258427f69a46,0xa64f24ec964827fe,0x9f0327ce2513262f,0xa725a332a73b22d7,0xa7992105a0a527a8,0x1248a7ffa66da4c4,0xa60fa53aa7a820a5,0x2750a27c1cb2a7ea,0x1d79a7e2a62fa513,0x260f253a2788a164,0x2777a1c21a46a7f6,0xa04427b625ed255f,0x264f24ec270ea38b,0xa7e21d799fc627c3
.quad 0x9bd627f1270e238b,0xa49ba68aa7c31fc6,0xa750227c1a4627f6,0x23e3a6f6a55fa5ed,0xa68aa49ba62f2513,0x27fa18b52164a788,0x18b5a7faa7a8a0a5,0x21c2277727ea9cb2,0x2725a332a0a5a7a8,0xa58425cb24c4266d,0x26c224482513a62f,0xa799a105a2d7273b,0x924827ff27f61a46,0x9bd6a7f1a7fe1648,0xa6f623e3238b270e,0x26c2a448a41da6dd
.quad 0xa49b268aa47226a7,0xa4ec264fa4c4266d,0xa7b6a044a7d99e3e,0xa750a27ca788a164,0x98b5a7fa9e3ea7d9,0x1d79a7e21648a7fe,0x2750a27c26a7a472,0x27fa98b527c39fc6,0x258425cb26a72472,0x21052799241d26dd,0xa33227259e3e27d9,0xa6c22448a55f25ed,0xa7f19bd6a7d91e3e,0xa5cba584a73ba2d7,0x9f03a7cea472a6a7,0x23e3a6f61cb2a7ea
.quad 0x26c2a4482472a6a7,0x27b6204427ea9cb2,0x264f24ec27d91e3e,0x924827ff22d7273b,0xa10527991e3e27d9,0xa7ce1f03a5ed255f,0xa7ff1248a6a72472,0xa332a725a6dda41d,0xa1c2a777a6a7a472,0x260fa53a1fc6a7c3,0x260fa53a1e3ea7d9,0x268a249b27fe9648,0x26f623e327d99e3e,0xa1c2277721642788,0x9d7927e2247226a7,0xa7f19bd6a66d24c4
.quad 0xa7e21d79a47226a7,0x9bd6a7f1a66da4c4,0xa3e3a6f6a7d99e3e,0x2777a1c22164a788,0x253aa60f9e3ea7d9,0x249b268a27fe1648,0x277721c226a7a472,0xa53a260f1fc627c3,0x924827ff26a72472,0xa725a332a6dd241d,0xa79921059e3e27d9,0x1f03a7cea5eda55f,0xa4eca64fa7d91e3e,0x27ff924822d7a73b,0x2448a6c2a472a6a7,0x204427b627ea1cb2
.quad 0x27ce1f032472a6a7,0xa6f623e31cb227ea,0x1bd627f127d91e3e,0xa584a5cba73b22d7,0xa72523321e3e27d9,0x2448a6c2a55fa5ed,0xa5cba584a6a72472,0x27992105241da6dd,0x227ca750a6a7a472,0x98b527fa27c31fc6,0x27fa18b51e3ea7d9,0xa7e21d79164827fe,0x204427b627d99e3e,0xa27ca750a7882164,0xa68a249b247226a7,0x264fa4eca4c4a66d
.quad 0xa53a260fa513262f,0xa58425cba55f25ed,0xa6c2a448a70ea38b,0xa60fa53aa66da4c4,0x227ca75020a5a7a8,0x24eca64f241da6dd,0x27b6204427f61a46,0x268a249b273b22d7,0x9bd627f11a4627f6,0xa44826c2a1642788,0xa7ff1248a7a820a5,0xa6f6a3e3a7c39fc6,0x9d79a7e2a38ba70e,0x2332a7251cb2a7ea,0x2799a105262fa513,0x2750227c27fe1648
.quad 0x23322725262f2513,0xa1c22777164827fe,0xa68a249ba38b270e,0xa799a105a7ea1cb2,0xa584a5cba7a8a0a5,0x2044a7b69fc6a7c3,0x24eca64f1a46a7f6,0x27ce1f032788a164,0x26f623e327f69a46,0x9d7927e222d7273b,0xa1c2277720a527a8,0xa7f19bd6a6dd241d,0xa7ce9f03a70e238b,0x18b5a7faa4c4a66d,0x18b5a7faa513a62f,0x27ff124825eda55f
.quad 0x27fa98b52513a62f,0x124827ff25ed255f,0x1f0327ce270e238b,0xa7fa18b5a4c4266d,0xa77721c2a0a527a8,0x9bd6a7f1a6dda41d,0xa3e3a6f6a7f69a46,0x27e29d7922d7a73b,0x264fa4ec9a46a7f6,0x1f0327ce27882164,0x25cb258427a8a0a5,0xa7b620449fc627c3,0xa49b268a238b270e,0xa105a799a7ea9cb2,0xa725a332a62f2513,0x2777a1c21648a7fe
.quad 0x2105a799a62fa513,0x227c275027fe9648,0x27e21d79238ba70e,0xa72523321cb227ea,0x924827ff27a820a5,0xa3e3a6f6a7c31fc6,0xa7f11bd69a4627f6,0x26c2a448a164a788,0xa044a7b6a7f61a46,0x249b268a273ba2d7,0x2750a27ca0a5a7a8,0xa64f24ec241d26dd,0x244826c2270ea38b,0xa53aa60fa66d24c4,0xa60f253a2513262f,0x25cba584a55fa5ed
.quad 0xa5cb2584a5a825a8,0xa60f253aa5ed255f,0xa53aa60fa5a8a5a8,0xa448a6c2a4c4a66d,0x264fa4ec25a8a5a8,0x2750a27c26dda41d,0x249b268a25a825a8,0x204427b622d7273b,0xa6c22448a5a825a8,0xa7f11bd6a7882164,0xa3e3a6f6a5a8a5a8,0x1248a7ff9fc6a7c3,0x2725a33225a8a5a8,0x27e21d7927ea9cb2,0x227c275025a825a8,0xa1052799164827fe
.quad 0xa77721c2a5a825a8,0xa725a332a7fe9648,0xa105a799a5a8a5a8,0x249ba68a1cb2a7ea,0x27b6a04425a8a5a8,0x25cb258427c31fc6,0x1f0327ce25a825a8,0xa64f24eca1642788,0xa7e21d79a5a825a8,0xa3e3a6f6a73ba2d7,0x9bd6a7f1a5a8a5a8,0x2777a1c2241da6dd,0x27fa98b525a8a5a8,0x1f0327ce266d24c4,0x124827ff25a825a8,0xa7fa18b5a55f25ed
.quad 0xa7ff9248a5a825a8,0x18b5a7faa55fa5ed,0x18b5a7faa5a8a5a8,0x27ce1f03266da4c4,0x27f11bd625a8a5a8,0xa1c22777241d26dd,0x9d7927e225a825a8,0xa6f6a3e3a73b22d7,0xa7ce9f03a5a825a8,0x24eca64fa164a788,0x2044a7b6a5a8a5a8,0x258425cb27c39fc6,0x2799210525a8a5a8,0xa68a249b1cb227ea,0xa1c2277725a825a8,0xa332a725a7fe1648
.quad 0xa750a27ca5a825a8,0x2799a1051648a7fe,0x2332a725a5a8a5a8,0x1d7927e227ea1cb2,0x26f623e325a8a5a8,0xa7ff12489fc627c3,0xa44826c225a825a8,0x1bd6a7f1a788a164,0xa68aa49ba5a825a8,0x27b6204422d7a73b,0x24eca64fa5a8a5a8,0xa27c275026dd241d,0x260f253a25a8a5a8,0xa6c2a448a4c4266d,0xa58425cb25a825a8,0x253aa60fa5eda55f
.quad 0xa64f24eca62f2513,0xa68a249ba66d24c4,0xa27ca750a38ba70e,0xa044a7b6a164a788,0x27e29d7927a8a0a5,0x27fa18b527fe9648,0x98b527fa1a4627f6,0xa27c27509fc627c3,0xa799a105a7f69a46,0xa5cba584a6dda41d,0x2448a6c220a5a7a8,0x2725a33225eda55f,0x258425cb270e238b,0x1bd627f122d7273b,0xa6f623e3a513262f,0xa7ce9f03a7ea1cb2
.quad 0xa044a7b6a513a62f,0x2448a6c21cb2a7ea,0x27ff9248270ea38b,0x24ec264f273b22d7,0x9f0327ce20a527a8,0xa7992105a55f25ed,0xa725a332a7f61a46,0x1248a7ffa41da6dd,0x253aa60f1a46a7f6,0x277721c227c39fc6,0x249b268a27a820a5,0xa53a260f964827fe,0xa77721c2a38b270e,0xa3e3a6f6a788a164,0x9bd6a7f1a62fa513,0x27e29d7924c4a66d
.quad 0x27f11bd6262fa513,0x9d7927e224c4266d,0xa1c22777238b270e,0xa6f6a3e3a7882164,0xa68aa49ba7a820a5,0x260fa53a9648a7fe,0x260fa53a9a46a7f6,0x21c2277727c31fc6,0x2332272527f61a46,0xa7ff1248a41d26dd,0xa7ce1f03a0a527a8,0x2105a799a55fa5ed,0x1248a7ffa70ea38b,0x264f24ec273ba2d7,0x27b620442513a62f,0xa6c224481cb227ea
.quad 0xa3e326f62513262f,0x9f03a7cea7ea9cb2,0xa5cba584a70e238b,0x27f11bd622d7a73b,0x26c2a448a0a5a7a8,0xa332272525ed255f,0x2105279927f69a46,0xa584a5cba6dd241d,0xa7fa18b59a4627f6,0x2750a27c9fc6a7c3,0x1d79a7e2a7a8a0a5,0x18b527fa27fe1648,0x2750227c238ba70e,0xa7b6a044a1642788,0xa4ec264f262f2513,0x249ba68aa66da4c4
.quad 0xa6c22448a6a72472,0xa6f623e3a6dd241d,0x9bd6a7f19e3ea7d9,0x1248a7ff9648a7fe,0x2799210527d91e3e,0x26c22448273b22d7,0xa58425cba47226a7,0xa7252332a66d24c4,0xa1c2a777a472a6a7,0x18b5a7fa9cb2a7ea,0x27fa18b527d99e3e,0x268a249b27882164,0xa3e326f69e3e27d9,0xa750227ca5ed255f,0xa49ba68aa6a7a472,0x1bd6a7f19fc6a7c3
.quad 0x27e29d7926a7a472,0x264f24ec27c31fc6,0xa04427b61e3e27d9,0xa77721c2a55f25ed,0xa60fa53aa7d99e3e,0x1d79a7e2a164a788,0x2750a27c2472a6a7,0x260f253a27ea1cb2,0x924827ff247226a7,0xa7992105a4c4266d,0xa725a332a7d91e3e,0x1f03a7cea2d7a73b,0x264fa4ec1e3ea7d9,0x25cb258427fe1648,0x1f0327ce26a72472,0xa7b62044a41d26dd
.quad 0xa7ce9f03a6a72472,0x2044a7b6a41da6dd,0x24eca64f9e3ea7d9,0x258425cb27fe9648,0x2332272527d91e3e,0xa7ce1f03a2d7273b,0xa7ff1248a47226a7,0x2105a799a4c4a66d,0x227ca750a472a6a7,0x253a260f27ea9cb2,0x253a260f27d99e3e,0xa7e21d79a1642788,0xa7b620449e3e27d9,0x21c2a777a55fa5ed,0x1d79a7e2a6a7a472,0x24ec264f27c39fc6
.quad 0x268a249b26a7a472,0xa7f11bd69fc627c3,0xa6f623e31e3e27d9,0x227ca750a5eda55f,0x98b5a7faa7d99e3e,0x249b268a2788a164,0x277721c22472a6a7,0xa7fa18b59cb227ea,0xa5cb2584247226a7,0x2332a725a66da4c4,0xa105a799a7d91e3e,0x244826c2273ba2d7,0x27f11bd61e3ea7d9,0xa7ff1248964827fe,0xa44826c226a72472,0x23e3a6f6a6dda41d
.quad 0xa7252332a70e238b,0xa750227ca73b22d7,0x1d79a7e21a46a7f6,0x2105a7991fc6a7c3,0x258425cb262f2513,0x23e326f624c4266d,0xa7f11bd6a7a820a5,0xa7ce9f03a7fe9648,0x23e3a6f620a5a7a8,0x268aa49b255fa5ed,0x227c27502513262f,0x9bd627f11cb227ea,0xa7ce9f03a7f61a46,0xa53aa60fa6dda41d,0x260fa53a238ba70e,0x27ff12482788a164
.quad 0x18b527fa238b270e,0xa58425cba1642788,0xa6c2a448a7f69a46,0x98b5a7faa41da6dd,0x2777a1c22513a62f,0x264f24ec27ea1cb2,0xa04427b620a527a8,0xa7e21d79a5ed255f,0xa4eca64fa7a8a0a5,0x2448a6c29648a7fe,0x27ff9248262fa513,0x204427b6266d24c4,0xa49b268a1a4627f6,0xa725a332a7c31fc6,0xa105a799a70ea38b,0x2777a1c222d7a73b
.quad 0x27992105270ea38b,0xa1c2277722d7273b,0xa68a249b9a4627f6,0xa332a725a7c39fc6,0x1248a7ffa62fa513,0x27b62044266da4c4,0x264f24ec27a8a0a5,0xa6c22448964827fe,0xa7b62044a0a527a8,0x1d79a7e2a5eda55f,0x21c2a777a513a62f,0x24ec264f27ea9cb2,0x244826c227f69a46,0xa7fa98b5a41d26dd,0xa7fa98b5a38b270e,0x25cba584a164a788
.quad 0x253aa60fa38ba70e,0x124827ff27882164,0x1f0327ce27f61a46,0xa60fa53aa6dd241d,0xa750a27ca513262f,0x27f19bd61cb2a7ea,0x26f6a3e3a0a5a7a8,0xa49b268a255f25ed,0x9bd627f127a820a5,0x9f03a7cea7fe1648,0xa5cba584a62f2513,0x26f623e324c4a66d,0x27e29d799a46a7f6,0xa79921051fc627c3,0xa3322725270e238b,0x227ca750a73ba2d7
.quad 0xa77721c2a764221f,0xa7992105a7882164,0x2332a725221fa764,0x249ba68a241da6dd,0x204427b6221f2764,0x124827ff1cb227ea,0xa6c2a448a764a21f,0xa4eca64fa5eda55f,0x27e29d792764a21f,0x27b6204427fe1648,0xa4ec264fa21f2764,0xa77721c2a66d24c4,0x98b5a7faa21fa764,0x2448a6c21fc6a7c3,0x25cb25842764221f,0x18b527fa22d7273b
.quad 0xa7ff9248a764221f,0xa53aa60fa73ba2d7,0x260fa53a221fa764,0x27ce1f0327c39fc6,0x9bd627f1221f2764,0xa750227ca4c4266d,0xa49ba68aa764a21f,0x23e3a6f69648a7fe,0x27ce1f032764a21f,0x1bd627f1255f25ed,0xa6f623e3a21f2764,0xa584a5cba7ea9cb2,0x2105a799a21fa764,0x27e21d7926dda41d,0x227c27502764221f,0xa7252332a1642788
.quad 0xa750a27ca764221f,0x2332a725a164a788,0x2799a105221fa764,0x1d7927e226dd241d,0xa3e326f6221f2764,0xa5cba584a7ea1cb2,0x9f03a7cea764a21f,0x27f11bd6255fa5ed,0x268a249b2764a21f,0xa6f623e3964827fe,0xa7f11bd6a21f2764,0x227ca750a4c4a66d,0x253aa60fa21fa764,0x1f0327ce27c31fc6,0x124827ff2764221f,0xa60fa53aa73b22d7
.quad 0xa584a5cba764221f,0x27fa18b522d7a73b,0x27fa18b5221fa764,0xa6c224481fc627c3,0xa64f24ec221f2764,0x21c2a777a66da4c4,0x1d79a7e2a764a21f,0x204427b627fe9648,0x244826c22764a21f,0xa64fa4eca5ed255f,0xa7b6a044a21f2764,0x27ff12481cb2a7ea,0x2725a332a21fa764,0xa68a249b241d26dd,0xa1c227772764221f,0x2105a799a788a164
.quad 0xa7b62044a7a820a5,0xa7ce1f03a7c31fc6,0x2584a5cb2513a62f,0x264fa4ec25eda55f,0x9f0327ce9a4627f6,0xa3322725a1642788,0xa105a799a38ba70e,0x1248a7ff9cb2a7ea,0x260f253a270e238b,0x227c275024c4266d,0xa7e29d79a7f61a46,0xa60fa53aa73ba2d7,0x2777a1c2262fa513,0x27b6204427fe9648,0xa4ec264fa0a527a8,0xa7e21d79a6dd241d
.quad 0x1bd6a7f1a0a5a7a8,0x268aa49b241da6dd,0x227c2750262f2513,0xa3e326f6964827fe,0xa68aa49ba7f69a46,0x18b5a7faa2d7a73b,0x27fa18b5270ea38b,0x21c22777266d24c4,0xa7252332a38b270e,0xa5cba584a7ea9cb2,0x2448a6c29a46a7f6,0x279921052788a164,0x924827ff2513262f,0xa7f11bd6a55f25ed,0xa3e3a6f6a7a8a0a5,0x26c2a4481fc6a7c3
.quad 0x26f623e327a8a0a5,0xa44826c21fc627c3,0xa7ff1248a513262f,0x1bd6a7f1a55fa5ed,0x26c2a4481a46a7f6,0x2105279927882164,0xa3322725238b270e,0xa584a5cba7ea1cb2,0x98b5a7faa70ea38b,0x277721c2266da4c4,0x249b268a27f69a46,0xa7fa18b5a2d7273b,0xa750a27ca62f2513,0x26f6a3e39648a7fe,0x27f19bd620a5a7a8,0xa49b268a241d26dd
.quad 0xa64f24ec20a527a8,0x1d79a7e2a6dda41d,0x21c2a777a62fa513,0x204427b627fe1648,0x1d7927e227f61a46,0xa53aa60fa73b22d7,0xa53aa60fa70e238b,0x2750227c24c4a66d,0x27992105238ba70e,0xa7ff12489cb227ea,0xa7ce1f031a4627f6,0x2725a332a164a788,0x25cba584a513a62f,0xa4ec264f25ed255f,0xa04427b627a820a5,0x1f03a7cea7c39fc6
.quad 0xa7e21d79a7d91e3e,0xa7f11bd6a7ea1cb2,0x26f6a3e326a7a472,0x2777a1c2273ba2d7,0xa53a260fa47226a7,0xa68a249ba5ed255f,0x21c2a7771e3ea7d9,0x253aa60f241da6dd,0x924827ff1e3e27d9,0xa33227259fc627c3,0xa105a799a472a6a7,0x1f03a7ce9648a7fe,0x24ec264f26a72472,0x124827ff21642788,0xa6c2a448a7d99e3e,0xa044a7b6a4c4a66d
.quad 0x27ce1f0327d99e3e,0x23e326f6266d24c4,0xa7f11bd6a6a72472,0xa584a5cba788a164,0x2725a3322472a6a7,0x26c2244827fe1648,0xa58425cb9e3e27d9,0xa799a105a7c31fc6,0x227ca7509e3ea7d9,0x27fa18b526dda41d,0x98b527fa247226a7,0xa7e21d79a55f25ed,0xa044a7b6a6a7a472,0x2750a27c22d7a73b,0x249b268a27d91e3e,0xa64f24ec9cb227ea
.quad 0xa68aa49ba7d91e3e,0x24eca64f9cb2a7ea,0x27b6204426a7a472,0xa27c275022d7273b,0xa7fa18b5a47226a7,0x1d79a7e2a55fa5ed,0x2750a27c1e3ea7d9,0x18b527fa26dd241d,0xa5cb25841e3e27d9,0xa105a799a7c39fc6,0x2332a725a472a6a7,0x244826c227fe9648,0x9bd627f126a72472,0xa5cba584a7882164,0x9f03a7cea7d99e3e,0x26f623e3266da4c4
.quad 0x244826c227d99e3e,0xa7b6a044a4c4266d,0xa64fa4eca6a72472,0x27ff12482164a788,0x279921052472a6a7,0xa7ce1f03964827fe,0xa7ff12489e3e27d9,0x2725a3329fc6a7c3,0x2777a1c29e3ea7d9,0xa60f253a241d26dd,0xa60f253a247226a7,0x249ba68aa5eda55f,0x23e3a6f6a6a7a472,0xa1c22777273b22d7,0x9d7927e227d91e3e,0x1bd6a7f1a7ea9cb2
.quad 0xa7fa18b5a7f61a46,0xa7ff1248a7fe1648,0x27ce9f0327a8a0a5,0x27fa98b527ea9cb2,0xa77721c2a70e238b,0xa7f11bd6a7c31fc6,0x26f6a3e3262fa513,0x27e29d792788a164,0xa64f24eca513262f,0xa7ce1f03a73b22d7,0x2584a5cb238ba70e,0x27b6a04426dda41d,0xa49b268aa0a527a8,0xa7992105a66d24c4,0x2332a7251a46a7f6,0x2777a1c225eda55f
.quad 0xa10527991a4627f6,0xa750227ca55f25ed,0x1d79a7e2a0a5a7a8,0x2725a33224c4a66d,0x924827ff238b270e,0xa6f623e3a41d26dd,0x9bd6a7f1a513a62f,0x26c2a44822d7a73b,0x204427b6262f2513,0xa68a249ba1642788,0xa27ca750a70ea38b,0x264fa4ec1fc6a7c3,0x244826c227a820a5,0xa60f253a9cb227ea,0xa53aa60fa7f69a46,0x25cba5841648a7fe
.quad 0x260f253a27f69a46,0xa58425cb164827fe,0xa6c2a448a7a820a5,0x253aa60f9cb2a7ea,0x2750227c270ea38b,0xa4ec264f1fc627c3,0xa7b6a044a62f2513,0x249ba68aa164a788,0x27f11bd62513a62f,0xa44826c222d7273b,0xa7ff1248a38b270e,0x23e3a6f6a41da6dd,0x27e29d7920a5a7a8,0xa332272524c4266d,0xa79921059a4627f6,0x227ca750a55fa5ed
.quad 0x2725a3329a46a7f6,0xa1c2277725ed255f,0xa68a249b20a527a8,0x2105a799a66da4c4,0x25cba584a38ba70e,0xa04427b626dd241d,0xa4ec264f2513262f,0x1f03a7cea73ba2d7,0x23e3a6f6a62fa513,0x9d7927e227882164,0xa1c22777270e238b,0x1bd6a7f1a7c39fc6,0x1f03a7cea7a8a0a5,0x98b527fa27ea1cb2,0x98b527fa27f61a46,0x1248a7ffa7fe9648
.quad 0xa7ff9248a8002800,0x27fa18b51648a7fe,0xa7fa98b528002800,0x27ce1f031cb2a7ea,0xa7f19bd6a8002800,0x277721c21fc6a7c3,0xa7e29d7928002800,0x26f623e32164a788,0xa7ce9f03a8002800,0x264f24ec22d7a73b,0xa7b6a04428002800,0x258425cb241da6dd,0xa799a105a8002800,0x249b268a24c4a66d,0xa777a1c228002800,0x23322725255fa5ed
.quad 0xa750a27ca8002800,0x2105279925eda55f,0xa725a33228002800,0x1d7927e2266da4c4,0xa6f6a3e3a8002800,0x124827ff26dda41d,0xa6c2a44828002800,0x9bd627f1273ba2d7,0xa68aa49ba8002800,0xa04427b62788a164,0xa64fa4ec28002800,0xa27c275027c39fc6,0xa60fa53aa8002800,0xa44826c227ea9cb2,0xa5cba58428002800,0xa53a260f27fe9648
.quad 0xa584a5cba8002800,0xa60f253a27fe1648,0xa53aa60f28002800,0xa6c2244827ea1cb2,0xa4eca64fa8002800,0xa750227c27c31fc6,0xa49ba68a28002800,0xa7b6204427882164,0xa448a6c2a8002800,0xa7f11bd6273b22d7,0xa3e3a6f628002800,0xa7ff924826dd241d,0xa332a725a8002800,0xa7e29d79266d24c4,0xa27ca75028002800,0xa799a10525ed255f
.quad 0xa1c2a777a8002800,0xa725a332255f25ed,0xa105a79928002800,0xa68aa49b24c4266d,0xa044a7b6a8002800,0xa5cba584241d26dd,0x9f03a7ce28002800,0xa4eca64f22d7273b,0x9d79a7e2a8002800,0xa3e3a6f621642788,0x9bd6a7f128002800,0xa1c2a7771fc627c3,0x98b5a7faa8002800,0x9f03a7ce1cb227ea,0x9248a7ff28002800,0x98b5a7fa164827fe
.quad 0xa7f19bd69a4627f6,0x27e21d791cb2a7ea,0xa777a1c2a0a527a8,0x26f623e322d7a73b,0xa68aa49ba38b270e,0x253a260f255fa5ed,0xa53aa60fa513262f,0x21c2277726dda41d,0xa332a725a62f2513,0x124827ff27c39fc6,0x9f03a7cea70e238b,0xa105279927fe1648,0x1248a7ffa7a820a5,0xa4ec264f27882164,0x2044a7b6a7f61a46,0xa6c22448266d24c4
.quad 0x23e3a6f6a7f69a46,0xa7ce1f0324c4266d,0x2584a5cba7a8a0a5,0xa7f19bd621642788,0x26c2a448a70ea38b,0xa725a332164827fe,0x2799a105a62fa513,0xa584a5cb9fc627c3,0x27fa98b5a513a62f,0xa27ca750a41d26dd,0x27e21d79a38ba70e,0x98b5a7faa5ed255f,0x2750227ca0a5a7a8,0x2044a7b6a73b22d7,0x264f24ec9a46a7f6,0x249ba68aa7ea1cb2
.quad 0x24ec264f1a46a7f6,0x268aa49ba7ea9cb2,0x227c275020a5a7a8,0x27b6a044a73ba2d7,0x1d7927e2238ba70e,0x27fa18b5a5eda55f,0x98b527fa2513a62f,0x2750227ca41da6dd,0xa1052799262fa513,0x25cb25849fc6a7c3,0xa44826c2270ea38b,0x233227251648a7fe,0xa5cb258427a8a0a5,0x1bd627f12164a788,0xa6f623e327f69a46,0x9f0327ce24c4a66d
.quad 0xa7b6204427f61a46,0xa44826c2266da4c4,0xa7ff124827a820a5,0xa64f24ec2788a164,0xa7ce9f03270e238b,0xa799210527fe9648,0xa725a332262f2513,0xa7ff924827c31fc6,0xa60fa53a2513262f,0xa777a1c226dd241d,0xa49ba68a238b270e,0xa60fa53a255f25ed,0xa1c2a77720a527a8,0xa3e3a6f622d7273b,0x9bd6a7f11a4627f6,0x9d79a7e21cb227ea
.quad 0xa7ce9f039e3e27d9,0x27b620441fc6a7c3,0xa64fa4eca47226a7,0x258425cb255fa5ed,0xa332a725a6a72472,0x1f0327ce2788a164,0x9248a7ffa7d91e3e,0xa105279927ea1cb2,0x227ca750a7d99e3e,0xa60f253a266d24c4,0x260fa53aa6a7a472,0xa7e21d7922d7273b,0x27b6a044a472a6a7,0xa777a1c2964827fe,0x27e21d799e3ea7d9,0xa4eca64fa41d26dd
.quad 0x268a249b1e3ea7d9,0x9bd6a7f1a6dd241d,0x23e326f62472a6a7,0x227ca750a7fe1648,0x18b527fa26a7a472,0x268aa49ba73ba2d7,0xa1c2277727d99e3e,0x27fa98b5a4c4a66d,0xa5cb258427d91e3e,0x272523329cb2a7ea,0xa799210526a72472,0x244826c22164a788,0xa7f19bd6247226a7,0x124827ff25eda55f,0xa6c2a4481e3e27d9,0xa3e326f627c39fc6
.quad 0xa448a6c29e3e27d9,0xa6f623e327c31fc6,0x9bd6a7f1a47226a7,0xa7ff924825ed255f,0x2105a799a6a72472,0xa6c2a44821642788,0x2584a5cba7d91e3e,0xa332a7259cb227ea,0x2777a1c2a7d99e3e,0x18b5a7faa4c4266d,0x27fa18b5a6a7a472,0x249ba68aa73b22d7,0x26f623e3a472a6a7,0x2750a27ca7fe9648,0x249b268a9e3ea7d9,0x27f11bd6a6dda41d
.quad 0x1d7927e21e3ea7d9,0x264f24eca41da6dd,0xa04427b62472a6a7,0x21c227779648a7fe,0xa53a260f26a7a472,0x9d7927e222d7a73b,0xa750227c27d99e3e,0xa53a260f266da4c4,0xa7ff924827d91e3e,0xa799210527ea9cb2,0xa725a33226a72472,0xa7ce9f0327882164,0xa4eca64f247226a7,0xa5cba584255f25ed,0x9f03a7ce1e3e27d9,0xa044a7b61fc627c3
.quad 0xa799a105a0a527a8,0x277721c22164a788,0xa49ba68aa62f2513,0x2332272526dda41d,0x1248a7ffa7f61a46,0xa04427b627ea1cb2,0x24eca64fa70ea38b,0xa6c22448255f25ed,0x27b6a044a38ba70e,0xa7e29d79164827fe,0x277721c21a46a7f6,0xa4eca64fa4c4266d,0x244826c22513a62f,0x18b5a7faa7c31fc6,0x98b527fa27a8a0a5,0x25cba584a73ba2d7
.quad 0xa53a260f27a820a5,0x27ff9248a2d7a73b,0xa7ce1f032513262f,0x260f253a1fc6a7c3,0xa750a27c1a4627f6,0x1bd627f1266da4c4,0xa3e3a6f6a38b270e,0xa49b268a27fe1648,0x1bd6a7f1a70e238b,0xa7ce1f0325ed255f,0x2584a5cba7f69a46,0xa6f6a3e31cb227ea,0x27e29d79a62fa513,0xa105a799a41d26dd,0x27252332a0a5a7a8,0x227ca750a7882164
.quad 0x2332272520a5a7a8,0x2750a27ca788a164,0x9d7927e2262fa513,0x27992105a41da6dd,0xa5cb258427f69a46,0x23e326f61cb2a7ea,0xa7f11bd6270e238b,0x9f0327ce25eda55f,0xa6f6a3e3238b270e,0xa68a249b27fe9648,0xa27ca7509a4627f6,0xa7f19bd6266d24c4,0x1f03a7cea513262f,0xa53aa60f1fc627c3,0x260fa53aa7a820a5,0x1248a7ffa2d7273b
.quad 0x27fa98b5a7a8a0a5,0x2584a5cba73b22d7,0x26c22448a513a62f,0x27fa98b5a7c39fc6,0x21c227779a46a7f6,0x264f24eca4c4a66d,0xa04427b6238ba70e,0x1d7927e21648a7fe,0xa64f24ec270ea38b,0xa44826c2255fa5ed,0xa7ff124827f61a46,0xa7b6204427ea9cb2,0xa68aa49b262f2513,0xa725a33226dd241d,0xa105a79920a527a8,0xa1c2a77721642788
.quad 0xa750a27ca21f2764,0x2725233222d7a73b,0xa105a799a764221f,0x1d7927e227c39fc6,0x23e3a6f6a764a21f,0xa58425cb266d24c4,0x27ce9f03a21fa764,0xa7f19bd6164827fe,0x268a249b221fa764,0xa3e3a6f6a5ed255f,0x1bd627f12764a21f,0x227ca750a7ea9cb2,0xa53a260f2764221f,0x27ce9f03a41da6dd,0xa7ff1248221f2764,0x260f253a2164a788
.quad 0xa584a5cba21f2764,0x98b527fa2788a164,0x18b5a7faa764221f,0xa6c2244826dd241d,0x264fa4eca764a21f,0xa777a1c21cb227ea,0x27e21d79a21fa764,0xa044a7b6a55f25ed,0x244826c2221fa764,0x24eca64fa7fe9648,0xa04427b62764a21f,0x27ff1248a4c4a66d,0xa72523322764221f,0x249b268a1fc6a7c3,0xa777a1c2221f2764,0xa1052799273ba2d7
.quad 0xa1c2a777a21f2764,0xa7992105273b22d7,0x2332a725a764221f,0xa68aa49b1fc627c3,0x27b6a044a764a21f,0x9248a7ffa4c4266d,0x26c22448a21fa764,0x264fa4eca7fe1648,0x1d7927e2221fa764,0x27b62044a55fa5ed,0xa4ec264f2764a21f,0x21c227771cb2a7ea,0xa7fa18b52764221f,0xa44826c226dda41d,0xa5cba584221f2764,0xa7fa18b527882164
.quad 0x1248a7ffa21f2764,0xa53aa60f21642788,0x260fa53aa764221f,0x1f03a7cea41d26dd,0x27f11bd6a764a21f,0x2750a27ca7ea1cb2,0x249b268aa21fa764,0x26f623e3a5eda55f,0x9f0327ce221fa764,0x1bd627f11648a7fe,0xa6f623e32764a21f,0xa5cb2584266da4c4,0xa799a1052764221f,0xa7e29d7927c31fc6,0xa27ca750221f2764,0xa332a72522d7273b
.quad 0xa6f6a3e3a38b270e,0x26c22448241da6dd,0x9248a7ffa7f61a46,0x9bd627f127fe1648,0x26c2a448a513a62f,0xa799210522d7273b,0x2725233220a5a7a8,0xa584a5cba4c4266d,0x18b527fa27a8a0a5,0x21c2a777a7ea9cb2,0xa68a249b262f2513,0x27fa98b5a164a788,0xa750a27c9a4627f6,0x23e326f6255fa5ed,0x9bd6a7f1a70e238b,0xa49b268a27c31fc6
.quad 0x264fa4eca70ea38b,0xa7e29d791fc627c3,0x277721c29a46a7f6,0xa044a7b6a5ed255f,0x1d7927e2262fa513,0x260fa53aa788a164,0xa60f253a27a820a5,0x2750227c9cb2a7ea,0xa799a10520a527a8,0x124827ff266da4c4,0x9f03a7cea513262f,0xa7252332273b22d7,0x25cba584a7f69a46,0xa64fa4ec164827fe,0x27b62044a38ba70e,0x1f03a7cea6dd241d
.quad 0x204427b6238ba70e,0x27ce9f03a6dda41d,0xa58425cb27f69a46,0x24ec264f1648a7fe,0xa7ce9f032513262f,0xa3322725273ba2d7,0xa105a799a0a527a8,0xa7ff9248266d24c4,0x253aa60fa7a820a5,0xa27ca7509cb227ea,0x27e21d79a62fa513,0x253aa60fa7882164,0x21c227771a46a7f6,0x27b62044a5eda55f,0xa4ec264f270ea38b,0x1d7927e21fc6a7c3
.quad 0xa7f19bd6270e238b,0xa68a249b27c39fc6,0xa27ca7501a4627f6,0xa6f6a3e3255f25ed,0x249ba68aa62f2513,0x18b5a7faa1642788,0x27fa18b5a7a8a0a5,0x2777a1c2a7ea1cb2,0x23322725a0a5a7a8,0x25cb2584a4c4a66d,0xa44826c22513a62f,0xa105279922d7a73b,0xa7ff924827f61a46,0xa7f11bd627fe9648,0xa3e3a6f6238b270e,0xa448a6c2241d26dd
.quad 0xa68aa49ba47226a7,0x264f24ec24c4a66d,0x2044a7b6a7d99e3e,0xa27c275027882164,0x27fa98b59e3ea7d9,0xa7e29d79964827fe,0x227c275026a7a472,0x98b5a7faa7c31fc6,0xa5cb258426a72472,0x2799a105a41da6dd,0xa725a3329e3e27d9,0x244826c2255fa5ed,0x1bd6a7f1a7d91e3e,0xa58425cb273b22d7,0x27ce9f03a472a6a7,0xa6f6a3e39cb227ea
.quad 0x244826c22472a6a7,0x2044a7b6a7ea1cb2,0xa4ec264f27d91e3e,0x27ff1248a2d7a73b,0xa799a1051e3e27d9,0x1f0327ce25eda55f,0x9248a7ffa6a72472,0xa725233226dd241d,0x2777a1c2a6a7a472,0xa53aa60f9fc627c3,0x253a260f1e3ea7d9,0x249ba68aa7fe1648,0xa3e326f627d99e3e,0x277721c2a164a788,0xa7e29d79247226a7,0x9bd627f1266da4c4
.quad 0x9d79a7e2a47226a7,0xa7f11bd6266d24c4,0x26f6a3e3a7d99e3e,0xa1c2a777a1642788,0x260f253a9e3ea7d9,0x268aa49ba7fe9648,0xa1c2277726a7a472,0x260f253a9fc6a7c3,0xa7ff924826a72472,0xa332272526dda41d,0xa105a7999e3e27d9,0xa7ce9f0325ed255f,0x264fa4eca7d91e3e,0x9248a7ffa2d7273b,0x26c22448a472a6a7,0x27b6a044a7ea9cb2
.quad 0x9f0327ce2472a6a7,0x23e326f69cb2a7ea,0xa7f11bd627d91e3e,0xa5cb2584273ba2d7,0xa332a7251e3e27d9,0xa6c2a448255f25ed,0x2584a5cba6a72472,0x2105a799a41d26dd,0x2750227ca6a7a472,0x27fa18b5a7c39fc6,0x98b527fa1e3ea7d9,0x1d7927e29648a7fe,0xa7b6204427d99e3e,0xa750227c2788a164,0xa49ba68a247226a7,0xa4eca64f24c4266d
.quad 0xa60fa53aa513262f,0x25cb2584255fa5ed,0x2448a6c2a70ea38b,0xa53a260f266d24c4,0x2750227c20a5a7a8,0xa64fa4eca41d26dd,0xa04427b627f61a46,0x249ba68aa73ba2d7,0xa7f19bd61a4627f6,0x26c224482164a788,0x9248a7ffa7a820a5,0xa3e326f627c31fc6,0x27e29d79a38ba70e,0xa725a3329cb227ea,0x21052799262fa513,0x227ca750a7fe9648
.quad 0xa7252332262f2513,0x277721c29648a7fe,0xa49ba68aa38b270e,0xa105279927ea9cb2,0x25cba584a7a8a0a5,0xa7b6a0441fc627c3,0x264f24ec1a46a7f6,0x1f03a7cea7882164,0xa3e326f627f69a46,0x27e21d79a2d7a73b,0xa777a1c220a527a8,0x9bd627f126dda41d,0x1f03a7cea70e238b,0xa7fa98b524c4266d,0x27fa18b5a513a62f,0x1248a7ffa5ed255f
.quad 0x18b527fa2513a62f,0x27ff9248a5eda55f,0xa7ce1f03270e238b,0x18b527fa24c4a66d,0xa1c2a777a0a527a8,0xa7f11bd626dd241d,0x26f6a3e3a7f69a46,0x9d79a7e2a2d7273b,0x24ec264f9a46a7f6,0x27ce9f03a788a164,0xa58425cb27a8a0a5,0x204427b61fc6a7c3,0xa68aa49b238b270e,0xa799210527ea1cb2,0x2332a725a62f2513,0xa1c2a777964827fe
.quad 0x27992105a62fa513,0x2750a27ca7fe1648,0x9d7927e2238ba70e,0x233227259cb2a7ea,0xa7ff924827a820a5,0xa6f623e327c39fc6,0x9bd6a7f19a4627f6,0xa448a6c221642788,0x27b6a044a7f61a46,0x268aa49ba73b22d7,0x227c2750a0a5a7a8,0x24ec264fa41da6dd,0xa6c22448270ea38b,0xa60f253a266da4c4,0xa53aa60f2513262f,0xa584a5cb255f25ed
.quad 0xa584a5cba5a825a8,0x253a260f25eda55f,0x260fa53aa5a8a5a8,0xa6c2244824c4266d,0x24ec264f25a8a5a8,0xa27ca750a6dd241d,0xa68a249b25a825a8,0x27b6a044a2d7a73b,0xa448a6c2a5a825a8,0x1bd627f12788a164,0x26f6a3e3a5a8a5a8,0xa7ff92481fc627c3,0x2332272525a8a5a8,0x1d79a7e2a7ea1cb2,0xa750227c25a825a8,0x279921059648a7fe
.quad 0xa1c2a777a5a825a8,0xa332272527fe1648,0x2799a105a5a8a5a8,0xa68aa49b9cb227ea,0x204427b625a8a5a8,0x2584a5cba7c39fc6,0xa7ce1f0325a825a8,0x24ec264f2164a788,0x9d79a7e2a5a825a8,0xa6f623e3273b22d7,0x27f19bd6a5a8a5a8,0xa1c2a777a41d26dd,0x18b527fa25a8a5a8,0x27ce9f03a66da4c4,0xa7ff124825a825a8,0x18b527fa255fa5ed
.quad 0x1248a7ffa5a825a8,0xa7fa98b5255f25ed,0x27fa18b5a5a8a5a8,0x1f03a7cea66d24c4,0x9bd627f125a8a5a8,0x277721c2a41da6dd,0xa7e29d7925a825a8,0xa3e326f6273ba2d7,0x1f03a7cea5a825a8,0xa64fa4ec21642788,0x27b62044a5a8a5a8,0x25cba584a7c31fc6,0xa105279925a8a5a8,0x249b268a9cb2a7ea,0xa777a1c225a825a8,0xa725233227fe9648
.quad 0x227ca750a5a825a8,0xa105a799964827fe,0x27252332a5a8a5a8,0x27e29d79a7ea9cb2,0xa3e326f625a8a5a8,0x124827ff1fc6a7c3,0xa6c2a44825a825a8,0xa7f19bd627882164,0x249ba68aa5a825a8,0x2044a7b6a2d7273b,0x264f24eca5a8a5a8,0x2750227ca6dda41d,0xa53a260f25a8a5a8,0xa44826c224c4a66d,0xa5cba58425a825a8,0xa60fa53a25ed255f
.quad 0xa4eca64fa62f2513,0x249b268a266da4c4,0x2750a27ca38ba70e,0xa7b6204421642788,0x1d7927e227a8a0a5,0x18b5a7faa7fe1648,0xa7fa98b51a4627f6,0x2750227c1fc6a7c3,0x2105a799a7f69a46,0xa58425cb26dd241d,0x26c2244820a5a7a8,0xa332a725a5ed255f,0xa5cb2584270e238b,0x27f19bd6a2d7a73b,0xa3e3a6f6a513262f,0x9f0327ce27ea9cb2
.quad 0x27b6a044a513a62f,0xa6c2a4489cb227ea,0x124827ff270ea38b,0x264fa4eca73ba2d7,0xa7ce9f0320a527a8,0x21052799255fa5ed,0x2332a725a7f61a46,0xa7ff9248241d26dd,0x260f253a1a46a7f6,0x21c2a777a7c31fc6,0xa68a249b27a820a5,0x260f253a1648a7fe,0xa1c2a777a38b270e,0xa6f623e327882164,0x27f19bd6a62fa513,0x9d79a7e2a4c4266d
.quad 0x9bd627f1262fa513,0x27e21d79a4c4a66d,0xa777a1c2238b270e,0xa3e326f62788a164,0x249ba68aa7a820a5,0xa53aa60f164827fe,0x253a260f9a46a7f6,0x2777a1c2a7c39fc6,0xa725233227f61a46,0x124827ff241da6dd,0x9f03a7cea0a527a8,0xa799a105255f25ed,0x27ff1248a70ea38b,0x24eca64fa73b22d7,0xa04427b62513a62f,0x244826c29cb2a7ea
.quad 0xa6f6a3e32513262f,0xa7ce1f0327ea1cb2,0x2584a5cba70e238b,0x1bd6a7f1a2d7273b,0x244826c2a0a5a7a8,0x27252332a5eda55f,0xa799210527f69a46,0xa5cb258426dda41d,0x98b5a7fa9a4627f6,0xa27ca7501fc627c3,0x27e21d79a7a8a0a5,0x27fa98b5a7fe9648,0xa27c2750238ba70e,0xa04427b62164a788,0xa64fa4ec262f2513,0xa68aa49b266d24c4
.quad 0xa448a6c2a6a72472,0x23e326f626dda41d,0x27f19bd69e3ea7d9,0xa7ff9248164827fe,0xa105279927d91e3e,0x2448a6c2a73ba2d7,0xa5cba584a47226a7,0x23322725266da4c4,0x2777a1c2a472a6a7,0xa7fa98b51cb227ea,0x98b527fa27d99e3e,0x249ba68aa788a164,0xa6f6a3e39e3e27d9,0x227c275025eda55f,0x268aa49ba6a7a472,0xa7f19bd61fc627c3
.quad 0x1d7927e226a7a472,0x24eca64fa7c39fc6,0xa7b6a0441e3e27d9,0x21c22777255fa5ed,0x253aa60fa7d99e3e,0xa7e29d7921642788,0x227c27502472a6a7,0x253aa60fa7ea9cb2,0xa7ff9248247226a7,0x2105279924c4a66d,0x2332a725a7d91e3e,0xa7ce9f0322d7273b,0x24ec264f1e3ea7d9,0x2584a5cba7fe9648,0xa7ce1f0326a72472,0x204427b6241da6dd
.quad 0x1f03a7cea6a72472,0xa7b6a044241d26dd,0x264f24ec9e3ea7d9,0x25cba584a7fe1648,0xa725233227d91e3e,0x1f0327ce22d7a73b,0x9248a7ffa47226a7,0xa799a10524c4266d,0x2750227ca472a6a7,0x260fa53aa7ea1cb2,0xa60f253a27d99e3e,0x1d7927e22164a788,0xa044a7b69e3e27d9,0xa777a1c2255f25ed,0x27e21d79a6a7a472,0x264fa4eca7c31fc6
.quad 0xa49b268a26a7a472,0x1bd627f11fc6a7c3,0xa3e3a6f61e3e27d9,0xa750a27c25ed255f,0x27fa98b5a7d99e3e,0x268aa49ba7882164,0xa1c227772472a6a7,0x18b527fa1cb2a7ea,0xa584a5cb247226a7,0xa725a332266d24c4,0x2799a105a7d91e3e,0x26c2a448a73b22d7,0x9bd627f11e3ea7d9,0x124827ff1648a7fe,0xa6c2a44826a72472,0xa6f6a3e326dd241d
.quad 0xa332a725a70e238b,0x227c2750273ba2d7,0x27e21d791a46a7f6,0xa799a1059fc627c3,0xa5cb2584262f2513,0x26f6a3e3a4c4a66d,0x9bd6a7f1a7a820a5,0x9f0327ce27fe1648,0x26f623e320a5a7a8,0xa49ba68aa55f25ed,0xa750227c2513262f,0x27f11bd69cb2a7ea,0x1f03a7cea7f61a46,0xa60f253a26dd241d,0x253a260f238ba70e,0x1248a7ffa7882164
.quad 0xa7fa18b5238b270e,0x25cb25842164a788,0x2448a6c2a7f69a46,0xa7fa18b5241d26dd,0x21c227772513a62f,0x24eca64fa7ea9cb2,0xa7b6a04420a527a8,0x1d7927e225eda55f,0x264fa4eca7a8a0a5,0xa6c2a448164827fe,0x124827ff262fa513,0x27b6a044a66da4c4,0xa68aa49b1a4627f6,0xa332272527c39fc6,0x2799a105a70ea38b,0xa1c2a777a2d7273b
.quad 0xa1052799270ea38b,0x277721c2a2d7a73b,0xa49ba68a9a4627f6,0xa725233227c31fc6,0x27ff1248a62fa513,0x2044a7b6a66d24c4,0xa4ec264f27a8a0a5,0x244826c21648a7fe,0xa044a7b6a0a527a8,0xa7e29d7925ed255f,0x277721c2a513a62f,0x264fa4eca7ea1cb2,0xa6c2244827f69a46,0x98b527fa241da6dd,0x18b5a7faa38b270e,0xa584a5cb21642788
.quad 0x260f253aa38ba70e,0x27ff9248a788a164,0xa7ce1f0327f61a46,0xa53a260f26dda41d,0x227ca750a513262f,0x9bd6a7f19cb227ea,0x23e326f6a0a5a7a8,0x268a249ba55fa5ed,0xa7f19bd627a820a5,0xa7ce1f0327fe9648,0x2584a5cba62f2513,0x23e3a6f6a4c4266d,0x1d7927e29a46a7f6,0x210527999fc6a7c3,0xa725a332270e238b,0xa750a27c273b22d7
.quad 0xa1c2a777a764221f,0x210527992788a164,0x27252332221fa764,0xa68aa49ba41d26dd,0xa7b62044221f2764,0x27ff92489cb2a7ea,0x2448a6c2a764a21f,0xa64f24ec25ed255f,0x1d7927e22764a21f,0x2044a7b6a7fe9648,0xa64fa4eca21f2764,0x21c22777266da4c4,0x27fa98b5a21fa764,0xa6c2a4489fc627c3,0xa58425cb2764221f,0x27fa98b5a2d7a73b
.quad 0x1248a7ffa764221f,0xa60f253a273b22d7,0x253a260f221fa764,0x1f03a7cea7c31fc6,0xa7f19bd6221f2764,0x227c275024c4a66d,0x268aa49ba764a21f,0xa6f6a3e3164827fe,0x9f0327ce2764a21f,0x27f19bd6a55fa5ed,0xa3e3a6f6a21f2764,0xa5cb258427ea1cb2,0x27992105a21fa764,0x1d79a7e2a6dd241d,0xa750227c2764221f,0x233227252164a788
.quad 0x227ca750a764221f,0xa725a33221642788,0x21052799221fa764,0x27e29d79a6dda41d,0xa6f6a3e3221f2764,0xa58425cb27ea9cb2,0x27ce9f03a764a21f,0x1bd6a7f1a55f25ed,0xa49b268a2764a21f,0x23e326f61648a7fe,0x9bd6a7f1a21f2764,0xa750a27c24c4266d,0x260f253aa21fa764,0x27ce9f03a7c39fc6,0xa7ff12482764221f,0xa53a260f273ba2d7
.quad 0x25cba584a764221f,0x18b5a7faa2d7273b,0x98b527fa221fa764,0x244826c29fc6a7c3,0xa4eca64f221f2764,0xa777a1c2266d24c4,0x27e21d79a764a21f,0x27b6a044a7fe1648,0xa6c224482764a21f,0xa4ec264f25eda55f,0x2044a7b6a21f2764,0x1248a7ff9cb227ea,0x23322725a21fa764,0x249b268aa41da6dd,0xa777a1c22764221f,0xa799a10527882164
.quad 0xa044a7b6a7a820a5,0x1f0327ce27c39fc6,0x25cb25842513a62f,0xa4eca64fa5ed255f,0xa7ce9f039a4627f6,0x272523322164a788,0x2799a105a38ba70e,0xa7ff92481cb227ea,0xa53a260f270e238b,0x2750a27ca4c4a66d,0x1d79a7e2a7f61a46,0xa53a260f273b22d7,0x21c22777262fa513,0x2044a7b6a7fe1648,0xa64fa4eca0a527a8,0x1d7927e226dda41d
.quad 0x27f11bd6a0a5a7a8,0xa49ba68aa41d26dd,0xa750227c262f2513,0x26f623e31648a7fe,0x249ba68aa7f69a46,0xa7fa98b522d7273b,0x98b527fa270ea38b,0x2777a1c2a66da4c4,0xa332a725a38b270e,0xa58425cb27ea1cb2,0x26c224489a46a7f6,0x2105a799a7882164,0xa7ff92482513262f,0x1bd627f1255fa5ed,0x26f6a3e3a7a8a0a5,0xa448a6c29fc627c3
.quad 0xa3e326f627a8a0a5,0x26c224489fc6a7c3,0x9248a7ffa513262f,0xa7f19bd6255f25ed,0x244826c21a46a7f6,0x2799a105a788a164,0xa725a332238b270e,0xa5cb258427ea9cb2,0x27fa98b5a70ea38b,0x21c2a777a66d24c4,0xa68a249b27f69a46,0x18b527fa22d7a73b,0x227ca750a62f2513,0xa3e3a6f6164827fe,0x1bd627f120a5a7a8,0x268a249ba41da6dd
.quad 0xa4eca64f20a527a8,0xa7e29d7926dd241d,0x277721c2a62fa513,0x27b6a044a7fe9648,0xa7e21d7927f61a46,0xa60f253a273ba2d7,0x260fa53aa70e238b,0x227ca750a4c4266d,0xa1052799238ba70e,0x124827ff1cb2a7ea,0x9f03a7ce1a4627f6,0xa332a72521642788,0x258425cba513a62f,0x264f24eca5eda55f,0xa7b6a04427a820a5,0xa7ce9f0327c31fc6
.quad 0x9d79a7e2a7d91e3e,0x1bd627f127ea9cb2,0x23e326f626a7a472,0xa1c2a777a73b22d7,0xa60fa53aa47226a7,0x249b268a25eda55f,0x277721c21e3ea7d9,0xa60fa53aa41d26dd,0xa7ff92481e3e27d9,0x272523321fc6a7c3,0x2799a105a472a6a7,0xa7ce9f03164827fe,0xa64f24ec26a72472,0x27ff9248a164a788,0x2448a6c2a7d99e3e,0xa7b6204424c4266d
.quad 0x9f0327ce27d99e3e,0x26f6a3e3a66da4c4,0x9bd6a7f1a6a72472,0xa5cb258427882164,0x233227252472a6a7,0x2448a6c2a7fe9648,0xa5cba5849e3e27d9,0xa105279927c39fc6,0x2750227c9e3ea7d9,0x18b5a7faa6dd241d,0xa7fa98b5247226a7,0x1d7927e2255fa5ed,0x27b6a044a6a7a472,0xa27ca750a2d7273b,0xa68a249b27d91e3e,0x24ec264f1cb2a7ea
.quad 0x249ba68aa7d91e3e,0xa64fa4ec1cb227ea,0xa04427b626a7a472,0x2750227ca2d7a73b,0x98b5a7faa47226a7,0xa7e29d79255f25ed,0x227c27501e3ea7d9,0x27fa98b5a6dda41d,0xa584a5cb1e3e27d9,0xa799210527c31fc6,0x27252332a472a6a7,0x26c2a448a7fe1648,0xa7f19bd626a72472,0xa58425cb2788a164,0x27ce9f03a7d99e3e,0x23e3a6f6a66d24c4
.quad 0xa6c2244827d99e3e,0xa04427b624c4a66d,0x24eca64fa6a72472,0x1248a7ffa1642788,0xa10527992472a6a7,0x1f0327ce1648a7fe,0x9248a7ff9e3e27d9,0xa332a7251fc627c3,0x21c227779e3ea7d9,0x253a260fa41da6dd,0xa53aa60f247226a7,0xa68aa49b25ed255f,0x26f623e3a6a7a472,0x277721c2a73ba2d7,0xa7e29d7927d91e3e,0xa7f19bd627ea1cb2
.quad 0x98b5a7faa7f61a46,0x124827ff27fe9648,0x1f0327ce27a8a0a5,0x98b5a7faa7ea1cb2,0xa1c2a777a70e238b,0x1bd627f127c39fc6,0x23e326f6262fa513,0x9d79a7e2a7882164,0xa4eca64fa513262f,0x1f0327ce273ba2d7,0x25cb2584238ba70e,0xa044a7b6a6dd241d,0xa68aa49ba0a527a8,0x21052799266da4c4,0x272523321a46a7f6,0xa1c2a777a5ed255f
.quad 0xa799a1051a4627f6,0x227c2750255fa5ed,0x27e21d79a0a5a7a8,0xa332a725a4c4266d,0xa7ff9248238b270e,0x23e326f6241da6dd,0x27f19bd6a513a62f,0xa448a6c2a2d7273b,0xa7b62044262f2513,0x249b268a2164a788,0x2750a27ca70ea38b,0xa4eca64f9fc627c3,0xa6c2244827a820a5,0x253a260f1cb2a7ea,0x260fa53aa7f69a46,0xa584a5cb964827fe
.quad 0xa53a260f27f69a46,0x25cb25849648a7fe,0x2448a6c2a7a820a5,0xa60fa53a1cb227ea,0xa27c2750270ea38b,0x264f24ec9fc6a7c3,0x2044a7b6a62f2513,0xa68aa49b21642788,0x9bd627f12513a62f,0x26c22448a2d7a73b,0x9248a7ffa38b270e,0xa6f6a3e3241d26dd,0x1d7927e220a5a7a8,0x27252332a4c4a66d,0xa105a7999a4627f6,0xa750a27c255f25ed
.quad 0x233227259a46a7f6,0x277721c2a5eda55f,0xa49ba68a20a527a8,0xa799a105266d24c4,0x258425cba38ba70e,0x27b62044a6dda41d,0xa64fa4ec2513262f,0xa7ce9f03273b22d7,0x26f623e3a62fa513,0x27e21d79a788a164,0xa777a1c2270e238b,0xa7f19bd627c31fc6,0x27ce1f03a7a8a0a5,0x27fa18b5a7ea9cb2,0xa7fa98b527f61a46,0xa7ff924827fe1648
.quad 0x1248a7ffa8002800,0x18b5a7fa964827fe,0x18b5a7fa28002800,0x1f03a7ce9cb227ea,0x1bd6a7f1a8002800,0x21c2a7779fc627c3,0x1d79a7e228002800,0x23e3a6f6a1642788,0x1f03a7cea8002800,0x24eca64fa2d7273b,0x2044a7b628002800,0x25cba584a41d26dd,0x2105a799a8002800,0x268aa49ba4c4266d,0x21c2a77728002800,0x2725a332a55f25ed
.quad 0x227ca750a8002800,0x2799a105a5ed255f,0x2332a72528002800,0x27e29d79a66d24c4,0x23e3a6f6a8002800,0x27ff9248a6dd241d,0x2448a6c228002800,0x27f11bd6a73b22d7,0x249ba68aa8002800,0x27b62044a7882164,0x24eca64f28002800,0x2750227ca7c31fc6,0x253aa60fa8002800,0x26c22448a7ea1cb2,0x2584a5cb28002800,0x260f253aa7fe1648
.quad 0x25cba584a8002800,0x253a260fa7fe9648,0x260fa53a28002800,0x244826c2a7ea9cb2,0x264fa4eca8002800,0x227c2750a7c39fc6,0x268aa49b28002800,0x204427b6a788a164,0x26c2a448a8002800,0x1bd627f1a73ba2d7,0x26f6a3e328002800,0x924827ffa6dda41d,0x2725a332a8002800,0x9d7927e2a66da4c4,0x2750a27c28002800,0xa1052799a5eda55f
.quad 0x2777a1c2a8002800,0xa3322725a55fa5ed,0x2799a10528002800,0xa49b268aa4c4a66d,0x27b6a044a8002800,0xa58425cba41da6dd,0x27ce9f0328002800,0xa64f24eca2d7a73b,0x27e29d79a8002800,0xa6f623e3a164a788,0x27f19bd628002800,0xa77721c29fc6a7c3,0x27fa98b5a8002800,0xa7ce1f039cb2a7ea,0x27ff924828002800,0xa7fa18b59648a7fe
.quad 0x1bd6a7f19a4627f6,0x1d79a7e29cb227ea,0x21c2a777a0a527a8,0x23e3a6f6a2d7273b,0x249ba68aa38b270e,0x260fa53aa55f25ed,0x260fa53aa513262f,0x2777a1c2a6dd241d,0x2725a332a62f2513,0x27ff9248a7c31fc6,0x27ce9f03a70e238b,0x27992105a7fe9648,0x27ff1248a7a820a5,0x264f24eca788a164,0x27b62044a7f61a46,0x244826c2a66da4c4
.quad 0x26f623e3a7f69a46,0x1f0327cea4c4a66d,0x25cb2584a7a8a0a5,0x9bd627f1a164a788,0x244826c2a70ea38b,0xa33227259648a7fe,0x21052799a62fa513,0xa5cb25841fc6a7c3,0x18b527faa513a62f,0xa750227c241da6dd,0x9d7927e2a38ba70e,0xa7fa18b525eda55f,0xa27c2750a0a5a7a8,0xa7b6a044273ba2d7,0xa4ec264f9a46a7f6,0xa68aa49b27ea9cb2
.quad 0xa64f24ec1a46a7f6,0xa49ba68a27ea1cb2,0xa750227c20a5a7a8,0xa044a7b6273b22d7,0xa7e21d79238ba70e,0x18b5a7fa25ed255f,0xa7fa98b52513a62f,0x227ca750241d26dd,0xa799a105262fa513,0x2584a5cb1fc627c3,0xa6c2a448270ea38b,0x2725a332964827fe,0xa584a5cb27a8a0a5,0x27f19bd6a1642788,0xa3e3a6f627f69a46,0x27ce1f03a4c4266d
.quad 0xa044a7b627f61a46,0x26c22448a66d24c4,0x9248a7ff27a820a5,0x24ec264fa7882164,0x1f03a7ce270e238b,0x21052799a7fe1648,0x2332a725262f2513,0x924827ffa7c39fc6,0x253aa60f2513262f,0xa1c22777a6dda41d,0x268aa49b238b270e,0xa53a260fa55fa5ed,0x2777a1c220a527a8,0xa6f623e3a2d7a73b,0x27f19bd61a4627f6,0xa7e21d799cb2a7ea
.quad 0x1f03a7ce9e3e27d9,0x2044a7b69fc627c3,0x24eca64fa47226a7,0x25cba584a55f25ed,0x2725a332a6a72472,0x27ce9f03a7882164,0x27ff9248a7d91e3e,0x27992105a7ea9cb2,0x2750227ca7d99e3e,0x253a260fa66da4c4,0x253a260fa6a7a472,0x1d7927e2a2d7a73b,0x204427b6a472a6a7,0xa1c227771648a7fe,0x9d7927e29e3ea7d9,0xa64f24ec241da6dd
.quad 0xa49b268a1e3ea7d9,0xa7f11bd626dda41d,0xa6f623e32472a6a7,0xa750a27c27fe9648,0xa7fa18b526a7a472,0xa49ba68a273b22d7,0xa777a1c227d99e3e,0x98b5a7fa24c4266d,0xa584a5cb27d91e3e,0x2332a7251cb227ea,0xa105a79926a72472,0x26c2a448a1642788,0x1bd6a7f1247226a7,0x27ff9248a5ed255f,0x2448a6c21e3e27d9,0x26f623e3a7c31fc6
.quad 0x26c2a4489e3e27d9,0x23e326f6a7c39fc6,0x27f19bd6a47226a7,0x924827ffa5eda55f,0x27992105a6a72472,0xa44826c2a164a788,0x25cb2584a7d91e3e,0xa72523321cb2a7ea,0x21c22777a7d99e3e,0xa7fa98b524c4a66d,0x98b527faa6a7a472,0xa68aa49b273ba2d7,0xa3e326f6a472a6a7,0xa27ca75027fe1648,0xa68a249b9e3ea7d9,0x1bd6a7f126dd241d
.quad 0xa7e21d791e3ea7d9,0x24eca64f241d26dd,0xa7b6a0442472a6a7,0x2777a1c2164827fe,0xa60fa53a26a7a472,0x27e21d79a2d7273b,0xa27ca75027d99e3e,0x260f253aa66d24c4,0x1248a7ff27d91e3e,0x21052799a7ea1cb2,0x2332a72526a72472,0x9f0327cea788a164,0x264fa4ec247226a7,0xa58425cba55fa5ed,0x27ce9f031e3e27d9,0xa7b620449fc6a7c3
.quad 0x2105a799a0a527a8,0x21c2a777a1642788,0x268aa49ba62f2513,0x2725a332a6dd241d,0x27ff1248a7f61a46,0x27b62044a7ea9cb2,0x264f24eca70ea38b,0x244826c2a55fa5ed,0x204427b6a38ba70e,0x9d7927e29648a7fe,0xa1c227771a46a7f6,0xa64f24ec24c4a66d,0xa6c224482513a62f,0xa7fa98b527c39fc6,0xa7fa98b527a8a0a5,0xa584a5cb273b22d7
.quad 0xa60fa53a27a820a5,0x9248a7ff22d7273b,0x9f03a7ce2513262f,0x253aa60f9fc627c3,0x227ca7501a4627f6,0x27f19bd6a66d24c4,0x26f6a3e3a38b270e,0x268a249ba7fe9648,0x27f11bd6a70e238b,0x1f0327cea5eda55f,0x25cb2584a7f69a46,0xa3e326f69cb2a7ea,0x1d7927e2a62fa513,0xa7992105241da6dd,0xa3322725a0a5a7a8,0xa750a27c2788a164
.quad 0xa725233220a5a7a8,0xa27ca75027882164,0xa7e29d79262fa513,0x2105a799241d26dd,0xa584a5cb27f69a46,0x26f6a3e39cb227ea,0x9bd6a7f1270e238b,0x27ce1f03a5ed255f,0x23e3a6f6238b270e,0x249b268aa7fe1648,0x2750a27c9a4627f6,0x9bd627f1a66da4c4,0x27ce1f03a513262f,0xa60f253a9fc6a7c3,0x253a260fa7a820a5,0xa7ff924822d7a73b
.quad 0x18b527faa7a8a0a5,0xa5cba584273ba2d7,0xa44826c2a513a62f,0x98b5a7fa27c31fc6,0xa77721c29a46a7f6,0x24eca64f24c4266d,0xa7b6a044238ba70e,0x27e29d79964827fe,0xa4eca64f270ea38b,0x26c22448a55f25ed,0x9248a7ff27f61a46,0x204427b6a7ea1cb2,0x249ba68a262f2513,0xa3322725a6dda41d,0x2799a10520a527a8,0xa77721c2a164a788
.quad 0x227ca750a21f2764,0x2332a725a2d7273b,0x2799a105a764221f,0x27e29d79a7c31fc6,0x26f623e3a764a21f,0x25cb2584a66da4c4,0x1f0327cea21fa764,0x9bd627f19648a7fe,0xa49b268a221fa764,0xa6f623e325eda55f,0xa7f11bd62764a21f,0xa750a27c27ea1cb2,0xa60fa53a2764221f,0x9f03a7ce241d26dd,0x9248a7ff221f2764,0x253aa60fa1642788
.quad 0x25cba584a21f2764,0x27fa18b5a7882164,0x27fa18b5a764221f,0x244826c2a6dda41d,0x24ec264fa764a21f,0xa1c227779cb2a7ea,0x9d7927e2a21fa764,0xa7b62044255fa5ed,0xa6c22448221fa764,0xa64fa4ec27fe1648,0xa7b6a0442764a21f,0x1248a7ff24c4266d,0xa332a7252764221f,0x268aa49b9fc627c3,0x21c2a777221f2764,0x27992105a73b22d7
.quad 0x2777a1c2a21f2764,0x21052799a73ba2d7,0x27252332a764221f,0xa49b268a9fc6a7c3,0x204427b6a764a21f,0xa7ff124824c4a66d,0xa44826c2a21fa764,0xa4eca64f27fe9648,0xa7e21d79221fa764,0x2044a7b6255f25ed,0xa64fa4ec2764a21f,0x2777a1c29cb227ea,0x98b5a7fa2764221f,0x26c22448a6dd241d,0x2584a5cb221f2764,0x18b527faa788a164
.quad 0x27ff1248a21f2764,0xa60f253aa164a788,0x253a260fa764221f,0xa7ce9f03241da6dd,0x9bd627f1a764a21f,0xa27ca75027ea9cb2,0xa68a249ba21fa764,0x23e3a6f625ed255f,0xa7ce9f03221fa764,0x27f19bd6964827fe,0xa3e3a6f62764a21f,0x258425cba66d24c4,0x2105a7992764221f,0x9d7927e2a7c39fc6,0x2750a27c221f2764,0xa7252332a2d7a73b
.quad 0x23e3a6f6a38b270e,0x2448a6c2a41d26dd,0x27ff9248a7f61a46,0x27f11bd6a7fe9648,0x244826c2a513a62f,0x21052799a2d7a73b,0xa332272520a5a7a8,0xa5cb258424c4a66d,0xa7fa18b527a8a0a5,0xa777a1c227ea1cb2,0xa49ba68a262f2513,0x98b5a7fa21642788,0x227ca7509a4627f6,0x26f6a3e3a55f25ed,0x27f19bd6a70e238b,0x268a249ba7c39fc6
.quad 0x24ec264fa70ea38b,0x9d7927e29fc6a7c3,0xa1c227779a46a7f6,0xa7b6204425eda55f,0xa7e21d79262fa513,0xa53aa60f27882164,0xa53aa60f27a820a5,0x227ca7501cb227ea,0x2105a79920a527a8,0x27ff9248a66d24c4,0x27ce9f03a513262f,0x23322725a73ba2d7,0x258425cba7f69a46,0xa4ec264f9648a7fe,0xa04427b6a38ba70e,0xa7ce9f0326dda41d
.quad 0xa7b62044238ba70e,0x9f03a7ce26dd241d,0xa5cba58427f69a46,0x264fa4ec964827fe,0x1f03a7ce2513262f,0x27252332a73b22d7,0x2799a105a0a527a8,0x924827ffa66da4c4,0x260f253aa7a820a5,0xa750227c1cb2a7ea,0x9d7927e2a62fa513,0xa60fa53a2788a164,0xa77721c21a46a7f6,0x2044a7b625ed255f,0xa64fa4ec270ea38b,0x27e29d799fc627c3
.quad 0x1bd6a7f1270e238b,0x249b268aa7c31fc6,0x2750a27c1a4627f6,0xa3e326f6a55fa5ed,0x268a249ba62f2513,0xa7fa98b52164a788,0x98b527faa7a8a0a5,0xa1c2a77727ea9cb2,0xa7252332a0a5a7a8,0x2584a5cb24c4266d,0xa6c2a4482513a62f,0x27992105a2d7273b,0x1248a7ff27f61a46,0x1bd627f1a7fe1648,0x26f6a3e3238b270e,0xa6c22448a41da6dd
.quad 0x249ba68aa47226a7,0x24eca64fa4c4266d,0x27b62044a7d99e3e,0x2750227ca788a164,0x18b527fa9e3ea7d9,0x9d7927e21648a7fe,0xa750227c26a7a472,0xa7fa18b527c39fc6,0xa584a5cb26a72472,0xa105a799241d26dd,0x2332a7259e3e27d9,0x26c2a448a55f25ed,0x27f11bd6a7d91e3e,0x25cb2584a73ba2d7,0x1f0327cea472a6a7,0xa3e326f61cb2a7ea
.quad 0xa6c224482472a6a7,0xa7b6a04427ea9cb2,0xa64fa4ec27d91e3e,0x1248a7ff22d7273b,0x2105a7991e3e27d9,0x27ce9f03a5ed255f,0x27ff9248a6a72472,0x23322725a6dda41d,0x21c22777a6a7a472,0xa60f253a1fc6a7c3,0xa60f253a1e3ea7d9,0xa68aa49b27fe9648,0xa6f6a3e327d99e3e,0x21c2a77721642788,0x1d79a7e2247226a7,0x27f11bd6a66d24c4
.quad 0x27e29d79a47226a7,0x1bd627f1a66da4c4,0x23e326f6a7d99e3e,0xa77721c22164a788,0xa53a260f9e3ea7d9,0xa49ba68a27fe1648,0xa777a1c226a7a472,0x253aa60f1fc627c3,0x1248a7ff26a72472,0x27252332a6dd241d,0x2799a1059e3e27d9,0x9f0327cea5eda55f,0x24ec264fa7d91e3e,0xa7ff124822d7a73b,0xa44826c2a472a6a7,0xa044a7b627ea1cb2
.quad 0xa7ce9f032472a6a7,0x26f6a3e31cb227ea,0x9bd6a7f127d91e3e,0x258425cba73b22d7,0x2725a3321e3e27d9,0xa44826c2a55fa5ed,0x25cb2584a6a72472,0xa799a105241da6dd,0xa27c2750a6a7a472,0x18b5a7fa27c31fc6,0xa7fa98b51e3ea7d9,0x27e29d79164827fe,0xa044a7b627d99e3e,0x227c2750a7882164,0x268aa49b247226a7,0xa64f24eca4c4a66d
.quad 0x253aa60fa513262f,0x2584a5cba55f25ed,0x26c22448a70ea38b,0x260f253aa66da4c4,0xa27c275020a5a7a8,0xa4ec264f241da6dd,0xa7b6a04427f61a46,0xa68aa49b273b22d7,0x1bd6a7f11a4627f6,0x2448a6c2a1642788,0x27ff9248a7a820a5,0x26f623e3a7c39fc6,0x1d7927e2a38ba70e,0xa33227251cb2a7ea,0xa7992105262fa513,0xa750a27c27fe1648
.quad 0xa332a725262f2513,0x21c2a777164827fe,0x268aa49ba38b270e,0x27992105a7ea1cb2,0x258425cba7a8a0a5,0xa04427b69fc6a7c3,0xa4ec264f1a46a7f6,0xa7ce9f032788a164,0xa6f6a3e327f69a46,0x1d79a7e222d7273b,0x21c2a77720a527a8,0x27f11bd6a6dd241d,0x27ce1f03a70e238b,0x98b527faa4c4a66d,0x98b527faa513a62f,0xa7ff924825eda55f
.quad 0xa7fa18b52513a62f,0x9248a7ff25ed255f,0x9f03a7ce270e238b,0x27fa98b5a4c4266d,0x2777a1c2a0a527a8,0x1bd627f1a6dda41d,0x23e326f6a7f69a46,0xa7e21d7922d7a73b,0xa64f24ec9a46a7f6,0x9f03a7ce27882164,0xa5cba58427a8a0a5,0x27b6a0449fc627c3,0x249ba68a238b270e,0x21052799a7ea9cb2,0x27252332a62f2513,0xa77721c21648a7fe
.quad 0xa1052799a62fa513,0xa27ca75027fe9648,0xa7e29d79238ba70e,0x2725a3321cb227ea,0x1248a7ff27a820a5,0x23e326f6a7c31fc6,0x27f19bd69a4627f6,0xa6c22448a164a788,0x204427b6a7f61a46,0xa49ba68a273ba2d7,0xa750227ca0a5a7a8,0x264fa4ec241d26dd,0xa448a6c2270ea38b,0x253a260fa66d24c4,0x260fa53a2513262f,0xa5cb2584a55fa5ed
.quad 0x25cba584a5a825a8,0x260fa53aa5ed255f,0x253a260fa5a8a5a8,0x244826c2a4c4a66d,0xa64f24ec25a8a5a8,0xa750227c26dda41d,0xa49ba68a25a825a8,0xa044a7b622d7273b,0x26c2a448a5a825a8,0x27f19bd6a7882164,0x23e326f6a5a8a5a8,0x924827ff9fc6a7c3,0xa725233225a8a5a8,0xa7e29d7927ea9cb2,0xa27ca75025a825a8,0x2105a799164827fe
.quad 0x2777a1c2a5a825a8,0x27252332a7fe9648,0x21052799a5a8a5a8,0xa49b268a1cb2a7ea,0xa7b6204425a8a5a8,0xa5cba58427c31fc6,0x9f03a7ce25a825a8,0x264fa4eca1642788,0x27e29d79a5a825a8,0x23e326f6a73ba2d7,0x1bd627f1a5a8a5a8,0xa77721c2241da6dd,0xa7fa18b525a8a5a8,0x9f03a7ce266d24c4,0x9248a7ff25a825a8,0x27fa98b5a55f25ed
.quad 0x27ff1248a5a825a8,0x98b527faa55fa5ed,0x98b527faa5a8a5a8,0xa7ce9f03266da4c4,0xa7f19bd625a8a5a8,0x21c2a777241d26dd,0x1d79a7e225a825a8,0x26f623e3a73b22d7,0x27ce1f03a5a825a8,0xa4ec264fa164a788,0xa04427b6a5a8a5a8,0xa584a5cb27c39fc6,0xa799a10525a8a5a8,0x268aa49b1cb227ea,0x21c2a77725a825a8,0x23322725a7fe1648
.quad 0x2750227ca5a825a8,0xa79921051648a7fe,0xa3322725a5a8a5a8,0x9d79a7e227ea1cb2,0xa6f6a3e325a8a5a8,0x27ff92489fc627c3,0x2448a6c225a825a8,0x9bd627f1a788a164,0x268a249ba5a825a8,0xa7b6a04422d7a73b,0xa4ec264fa5a8a5a8,0x227ca75026dd241d,0xa60fa53a25a8a5a8,0x26c22448a4c4266d,0x2584a5cb25a825a8,0xa53a260fa5eda55f
.quad 0x264fa4eca62f2513,0x268aa49ba66d24c4,0x227c2750a38ba70e,0x204427b6a164a788,0xa7e21d7927a8a0a5,0xa7fa98b527fe9648,0x18b5a7fa1a4627f6,0x227ca7509fc627c3,0x27992105a7f69a46,0x25cb2584a6dda41d,0xa44826c220a5a7a8,0xa725233225eda55f,0xa584a5cb270e238b,0x9bd6a7f122d7273b,0x26f6a3e3a513262f,0x27ce1f03a7ea1cb2
.quad 0x204427b6a513a62f,0xa44826c21cb2a7ea,0xa7ff1248270ea38b,0xa4eca64f273b22d7,0x1f03a7ce20a527a8,0x2799a105a55f25ed,0x27252332a7f61a46,0x924827ffa41da6dd,0xa53a260f1a46a7f6,0xa777a1c227c39fc6,0xa49ba68a27a820a5,0x253aa60f964827fe,0x2777a1c2a38b270e,0x23e326f6a788a164,0x1bd627f1a62fa513,0xa7e21d7924c4a66d
.quad 0xa7f19bd6262fa513,0x1d79a7e224c4266d,0x21c2a777238b270e,0x26f623e3a7882164,0x268a249ba7a820a5,0xa60f253a9648a7fe,0xa60f253a9a46a7f6,0xa1c2a77727c31fc6,0xa332a72527f61a46,0x27ff9248a41d26dd,0x27ce9f03a0a527a8,0xa1052799a55fa5ed,0x924827ffa70ea38b,0xa64fa4ec273ba2d7,0xa7b6a0442513a62f,0x26c2a4481cb227ea
.quad 0x23e3a6f62513262f,0x1f0327cea7ea9cb2,0x25cb2584a70e238b,0xa7f19bd622d7a73b,0xa6c22448a0a5a7a8,0x2332a72525ed255f,0xa105a79927f69a46,0x258425cba6dd241d,0x27fa98b59a4627f6,0xa750227c9fc6a7c3,0x9d7927e2a7a8a0a5,0x98b5a7fa27fe1648,0xa750a27c238ba70e,0x27b62044a1642788,0x24eca64f262f2513,0xa49b268aa66da4c4
.quad 0x26c2a448a6a72472,0x26f6a3e3a6dd241d,0x1bd627f19e3ea7d9,0x924827ff9648a7fe,0xa799a10527d91e3e,0xa6c2a448273b22d7,0x2584a5cba47226a7,0x2725a332a66d24c4,0x21c22777a472a6a7,0x98b527fa9cb2a7ea,0xa7fa98b527d99e3e,0xa68aa49b27882164,0x23e3a6f69e3e27d9,0x2750a27ca5ed255f,0x249b268aa6a7a472,0x9bd627f19fc6a7c3
.quad 0xa7e21d7926a7a472,0xa64fa4ec27c31fc6,0x2044a7b61e3e27d9,0x2777a1c2a55f25ed,0x260f253aa7d99e3e,0x9d7927e2a164a788,0xa750227c2472a6a7,0xa60fa53a27ea1cb2,0x1248a7ff247226a7,0x2799a105a4c4266d,0x27252332a7d91e3e,0x9f0327cea2d7a73b,0xa64f24ec1e3ea7d9,0xa5cba58427fe1648,0x9f03a7ce26a72472,0x27b6a044a41d26dd
.quad 0x27ce1f03a6a72472,0xa04427b6a41da6dd,0xa4ec264f9e3ea7d9,0xa584a5cb27fe9648,0xa332a72527d91e3e,0x27ce9f03a2d7273b,0x27ff9248a47226a7,0xa1052799a4c4a66d,0xa27c2750a472a6a7,0xa53aa60f27ea9cb2,0xa53aa60f27d99e3e,0x27e29d79a1642788,0x27b6a0449e3e27d9,0xa1c22777a55fa5ed,0x9d7927e2a6a7a472,0xa4eca64f27c39fc6
.quad 0xa68aa49b26a7a472,0x27f19bd69fc627c3,0x26f6a3e31e3e27d9,0xa27c2750a5eda55f,0x18b527faa7d99e3e,0xa49ba68a2788a164,0xa777a1c22472a6a7,0x27fa98b59cb227ea,0x25cba584247226a7,0xa3322725a66da4c4,0x21052799a7d91e3e,0xa448a6c2273ba2d7,0xa7f19bd61e3ea7d9,0x27ff9248964827fe,0x2448a6c226a72472,0xa3e326f6a6dda41d
.quad 0x2725a332a70e238b,0x2750a27ca73b22d7,0x9d7927e21a46a7f6,0xa10527991fc6a7c3,0xa584a5cb262f2513,0xa3e3a6f624c4266d,0x27f19bd6a7a820a5,0x27ce1f03a7fe9648,0xa3e326f620a5a7a8,0xa68a249b255fa5ed,0xa27ca7502513262f,0x1bd6a7f11cb227ea,0x27ce1f03a7f61a46,0x253a260fa6dda41d,0xa60f253a238ba70e,0xa7ff92482788a164
.quad 0x98b5a7fa238b270e,0x2584a5cba1642788,0x26c22448a7f69a46,0x18b527faa41da6dd,0xa77721c22513a62f,0xa64fa4ec27ea1cb2,0x2044a7b620a527a8,0x27e29d79a5ed255f,0x24ec264fa7a8a0a5,0xa44826c29648a7fe,0xa7ff1248262fa513,0xa044a7b6266d24c4,0x249ba68a1a4627f6,0x27252332a7c31fc6,0x21052799a70ea38b,0xa77721c222d7a73b
.quad 0xa799a105270ea38b,0x21c2a77722d7273b,0x268aa49b9a4627f6,0x23322725a7c39fc6,0x924827ffa62fa513,0xa7b6a044266da4c4,0xa64fa4ec27a8a0a5,0x26c2a448964827fe,0x27b6a044a0a527a8,0x9d7927e2a5eda55f,0xa1c22777a513a62f,0xa4eca64f27ea9cb2,0xa448a6c227f69a46,0x27fa18b5a41d26dd,0x27fa18b5a38b270e,0xa5cb2584a164a788
.quad 0xa53a260fa38ba70e,0x9248a7ff27882164,0x9f03a7ce27f61a46,0x260f253aa6dd241d,0x2750227ca513262f,0xa7f11bd61cb2a7ea,0xa6f623e3a0a5a7a8,0x249ba68a255f25ed,0x1bd6a7f127a820a5,0x1f0327cea7fe1648,0x25cb2584a62f2513,0xa6f6a3e324c4a66d,0xa7e21d799a46a7f6,0x2799a1051fc627c3,0x2332a725270e238b,0xa27c2750a73ba2d7
.quad 0x2777a1c2a764221f,0x2799a105a7882164,0xa3322725221fa764,0xa49b268a241da6dd,0xa044a7b6221f2764,0x9248a7ff1cb227ea,0x26c22448a764a21f,0x24ec264fa5eda55f,0xa7e21d792764a21f,0xa7b6a04427fe1648,0x24eca64fa21f2764,0x2777a1c2a66d24c4,0x18b527faa21fa764,0xa44826c21fc6a7c3,0xa5cba5842764221f,0x98b5a7fa22d7273b
.quad 0x27ff1248a764221f,0x253a260fa73ba2d7,0xa60f253a221fa764,0xa7ce9f0327c39fc6,0x1bd6a7f1221f2764,0x2750a27ca4c4266d,0x249b268aa764a21f,0xa3e326f69648a7fe,0xa7ce9f032764a21f,0x9bd6a7f1255f25ed,0x26f6a3e3a21f2764,0x258425cba7ea9cb2,0xa1052799a21fa764,0xa7e29d7926dda41d,0xa27ca7502764221f,0x2725a332a1642788
.quad 0x2750227ca764221f,0xa3322725a164a788,0xa7992105221fa764,0x9d79a7e226dd241d,0x23e3a6f6221f2764,0x25cb2584a7ea1cb2,0x1f0327cea764a21f,0xa7f19bd6255fa5ed,0xa68aa49b2764a21f,0x26f6a3e3964827fe,0x27f19bd6a21f2764,0xa27c2750a4c4a66d,0xa53a260fa21fa764,0x9f03a7ce27c31fc6,0x9248a7ff2764221f,0x260f253aa73b22d7
.quad 0x258425cba764221f,0xa7fa98b522d7a73b,0xa7fa98b5221fa764,0x26c2a4481fc627c3,0x264fa4ec221f2764,0xa1c22777a66da4c4,0x9d7927e2a764a21f,0xa044a7b627fe9648,0xa448a6c22764a21f,0x264f24eca5ed255f,0x27b62044a21f2764,0xa7ff92481cb2a7ea,0xa7252332a21fa764,0x268aa49b241d26dd,0x21c2a7772764221f,0xa1052799a788a164
.quad 0x27b6a044a7a820a5,0x27ce9f03a7c31fc6,0xa58425cb2513a62f,0xa64f24ec25eda55f,0x1f03a7ce9a4627f6,0x2332a725a1642788,0x21052799a38ba70e,0x924827ff9cb2a7ea,0xa60fa53a270e238b,0xa27ca75024c4266d,0x27e21d79a7f61a46,0x260f253aa73ba2d7,0xa77721c2262fa513,0xa7b6a04427fe9648,0x24eca64fa0a527a8,0x27e29d79a6dd241d
.quad 0x9bd627f1a0a5a7a8,0xa68a249b241da6dd,0xa27ca750262f2513,0x23e3a6f6964827fe,0x268a249ba7f69a46,0x98b527faa2d7a73b,0xa7fa98b5270ea38b,0xa1c2a777266d24c4,0x2725a332a38b270e,0x25cb2584a7ea9cb2,0xa44826c29a46a7f6,0xa799a1052788a164,0x1248a7ff2513262f,0x27f19bd6a55f25ed,0x23e326f6a7a8a0a5,0xa6c224481fc6a7c3
.quad 0xa6f6a3e327a8a0a5,0x2448a6c21fc627c3,0x27ff9248a513262f,0x9bd627f1a55fa5ed,0xa6c224481a46a7f6,0xa105a79927882164,0x2332a725238b270e,0x258425cba7ea1cb2,0x18b527faa70ea38b,0xa777a1c2266da4c4,0xa49ba68a27f69a46,0x27fa98b5a2d7273b,0x2750227ca62f2513,0xa6f623e39648a7fe,0xa7f11bd620a5a7a8,0x249ba68a241d26dd
.quad 0x264fa4ec20a527a8,0x9d7927e2a6dda41d,0xa1c22777a62fa513,0xa044a7b627fe1648,0x9d79a7e227f61a46,0x253a260fa73b22d7,0x253a260fa70e238b,0xa750a27c24c4a66d,0xa799a105238ba70e,0x27ff92489cb227ea,0x27ce9f031a4627f6,0xa7252332a164a788,0xa5cb2584a513a62f,0x24eca64f25ed255f,0x2044a7b627a820a5,0x9f0327cea7c39fc6
.quad 0x27e29d79a7d91e3e,0x27f19bd6a7ea1cb2,0xa6f623e326a7a472,0xa77721c2273ba2d7,0x253aa60fa47226a7,0x268aa49ba5ed255f,0xa1c227771e3ea7d9,0xa53a260f241da6dd,0x1248a7ff1e3e27d9,0x2332a7259fc627c3,0x21052799a472a6a7,0x9f0327ce9648a7fe,0xa4eca64f26a72472,0x9248a7ff21642788,0x26c22448a7d99e3e,0x204427b6a4c4a66d
.quad 0xa7ce9f0327d99e3e,0xa3e3a6f6266d24c4,0x27f19bd6a6a72472,0x258425cba788a164,0xa72523322472a6a7,0xa6c2a44827fe1648,0x2584a5cb9e3e27d9,0x27992105a7c31fc6,0xa27c27509e3ea7d9,0xa7fa98b526dda41d,0x18b5a7fa247226a7,0x27e29d79a55f25ed,0x204427b6a6a7a472,0xa750227c22d7a73b,0xa49ba68a27d91e3e,0x264fa4ec9cb227ea
.quad 0x268a249ba7d91e3e,0xa4ec264f9cb2a7ea,0xa7b6a04426a7a472,0x227ca75022d7273b,0x27fa98b5a47226a7,0x9d7927e2a55fa5ed,0xa750227c1e3ea7d9,0x98b5a7fa26dd241d,0x25cba5841e3e27d9,0x21052799a7c39fc6,0xa3322725a472a6a7,0xa448a6c227fe9648,0x1bd6a7f126a72472,0x25cb2584a7882164,0x1f0327cea7d99e3e,0xa6f6a3e3266da4c4
.quad 0xa448a6c227d99e3e,0x27b62044a4c4266d,0x264f24eca6a72472,0xa7ff92482164a788,0xa799a1052472a6a7,0x27ce9f03964827fe,0x27ff92489e3e27d9,0xa72523329fc6a7c3,0xa77721c29e3ea7d9,0x260fa53a241d26dd,0x260fa53a247226a7,0xa49b268aa5eda55f,0xa3e326f6a6a7a472,0x21c2a777273b22d7,0x1d79a7e227d91e3e,0x9bd627f1a7ea9cb2
.quad 0x27fa98b5a7f61a46,0x27ff9248a7fe1648,0xa7ce1f0327a8a0a5,0xa7fa18b527ea9cb2,0x2777a1c2a70e238b,0x27f19bd6a7c31fc6,0xa6f623e3262fa513,0xa7e21d792788a164,0x264fa4eca513262f,0x27ce9f03a73b22d7,0xa58425cb238ba70e,0xa7b6204426dda41d,0x249ba68aa0a527a8,0x2799a105a66d24c4,0xa33227251a46a7f6,0xa77721c225eda55f
.quad 0x2105a7991a4627f6,0x2750a27ca55f25ed,0x9d7927e2a0a5a7a8,0xa725233224c4a66d,0x1248a7ff238b270e,0x26f6a3e3a41d26dd,0x1bd627f1a513a62f,0xa6c2244822d7a73b,0xa044a7b6262f2513,0x268aa49ba1642788,0x227c2750a70ea38b,0xa64f24ec1fc6a7c3,0xa448a6c227a820a5,0x260fa53a9cb227ea,0x253a260fa7f69a46,0xa5cb25841648a7fe
.quad 0xa60fa53a27f69a46,0x2584a5cb164827fe,0x26c22448a7a820a5,0xa53a260f9cb2a7ea,0xa750a27c270ea38b,0x24eca64f1fc627c3,0x27b62044a62f2513,0xa49b268aa164a788,0xa7f19bd62513a62f,0x2448a6c222d7273b,0x27ff9248a38b270e,0xa3e326f6a41da6dd,0xa7e21d7920a5a7a8,0x2332a72524c4266d,0x2799a1059a4627f6,0xa27c2750a55fa5ed
.quad 0xa72523329a46a7f6,0x21c2a77725ed255f,0x268aa49b20a527a8,0xa1052799a66da4c4,0xa5cb2584a38ba70e,0x2044a7b626dd241d,0x24eca64f2513262f,0x9f0327cea73ba2d7,0xa3e326f6a62fa513,0x1d79a7e227882164,0x21c2a777270e238b,0x9bd627f1a7c39fc6,0x9f0327cea7a8a0a5,0x18b5a7fa27ea1cb2,0x18b5a7fa27f61a46,0x924827ffa7fe9648
.quad 0x27ff1248a8002800,0xa7fa98b51648a7fe,0x27fa18b528002800,0xa7ce9f031cb2a7ea,0x27f11bd6a8002800,0xa777a1c21fc6a7c3,0x27e21d7928002800,0xa6f6a3e32164a788,0x27ce1f03a8002800,0xa64fa4ec22d7a73b,0x27b6204428002800,0xa584a5cb241da6dd,0x27992105a8002800,0xa49ba68a24c4a66d,0x277721c228002800,0xa332a725255fa5ed
.quad 0x2750227ca8002800,0xa105a79925eda55f,0x2725233228002800,0x9d79a7e2266da4c4,0x26f623e3a8002800,0x9248a7ff26dda41d,0x26c2244828002800,0x1bd6a7f1273ba2d7,0x268a249ba8002800,0x2044a7b62788a164,0x264f24ec28002800,0x227ca75027c39fc6,0x260f253aa8002800,0x2448a6c227ea9cb2,0x25cb258428002800,0x253aa60f27fe9648
.quad 0x258425cba8002800,0x260fa53a27fe1648,0x253a260f28002800,0x26c2a44827ea1cb2,0x24ec264fa8002800,0x2750a27c27c31fc6,0x249b268a28002800,0x27b6a04427882164,0x244826c2a8002800,0x27f19bd6273b22d7,0x23e326f628002800,0x27ff124826dd241d,0x23322725a8002800,0x27e21d79266d24c4,0x227c275028002800,0x2799210525ed255f
.quad 0x21c22777a8002800,0x27252332255f25ed,0x2105279928002800,0x268a249b24c4266d,0x204427b6a8002800,0x25cb2584241d26dd,0x1f0327ce28002800,0x24ec264f22d7273b,0x1d7927e2a8002800,0x23e326f621642788,0x1bd627f128002800,0x21c227771fc627c3,0x18b527faa8002800,0x1f0327ce1cb227ea,0x124827ff28002800,0x18b527fa164827fe
.quad 0x27f11bd69a4627f6,0xa7e29d791cb2a7ea,0x277721c2a0a527a8,0xa6f6a3e322d7a73b,0x268a249ba38b270e,0xa53aa60f255fa5ed,0x253a260fa513262f,0xa1c2a77726dda41d,0x23322725a62f2513,0x9248a7ff27c39fc6,0x1f0327cea70e238b,0x2105a79927fe1648,0x924827ffa7a820a5,0x24eca64f27882164,0xa04427b6a7f61a46,0x26c2a448266d24c4
.quad 0xa3e326f6a7f69a46,0x27ce9f0324c4266d,0xa58425cba7a8a0a5,0x27f11bd621642788,0xa6c22448a70ea38b,0x27252332164827fe,0xa7992105a62fa513,0x258425cb9fc627c3,0xa7fa18b5a513a62f,0x227c2750a41d26dd,0xa7e29d79a38ba70e,0x18b527faa5ed255f,0xa750a27ca0a5a7a8,0xa04427b6a73b22d7,0xa64fa4ec9a46a7f6,0xa49b268aa7ea1cb2
.quad 0xa4eca64f1a46a7f6,0xa68a249ba7ea9cb2,0xa27ca75020a5a7a8,0xa7b62044a73ba2d7,0x9d79a7e2238ba70e,0xa7fa98b5a5eda55f,0x18b5a7fa2513a62f,0xa750a27ca41da6dd,0x2105a799262fa513,0xa5cba5849fc6a7c3,0x2448a6c2270ea38b,0xa332a7251648a7fe,0x25cba58427a8a0a5,0x9bd6a7f12164a788,0x26f6a3e327f69a46,0x1f03a7ce24c4a66d
.quad 0x27b6a04427f61a46,0x2448a6c2266da4c4,0x27ff924827a820a5,0x264fa4ec2788a164,0x27ce1f03270e238b,0x2799a10527fe9648,0x27252332262f2513,0x27ff124827c31fc6,0x260f253a2513262f,0x277721c226dd241d,0x249b268a238b270e,0x260f253a255f25ed,0x21c2277720a527a8,0x23e326f622d7273b,0x1bd627f11a4627f6,0x1d7927e21cb227ea
.quad 0x27ce1f039e3e27d9,0xa7b6a0441fc6a7c3,0x264f24eca47226a7,0xa584a5cb255fa5ed,0x23322725a6a72472,0x9f03a7ce2788a164,0x124827ffa7d91e3e,0x2105a79927ea1cb2,0xa27c2750a7d99e3e,0x260fa53a266d24c4,0xa60f253aa6a7a472,0x27e29d7922d7273b,0xa7b62044a472a6a7,0x277721c2964827fe,0xa7e29d799e3ea7d9,0x24ec264fa41d26dd
.quad 0xa68aa49b1e3ea7d9,0x1bd627f1a6dd241d,0xa3e3a6f62472a6a7,0xa27c2750a7fe1648,0x98b5a7fa26a7a472,0xa68a249ba73ba2d7,0x21c2a77727d99e3e,0xa7fa18b5a4c4a66d,0x25cba58427d91e3e,0xa725a3329cb2a7ea,0x2799a10526a72472,0xa448a6c22164a788,0x27f11bd6247226a7,0x9248a7ff25eda55f,0x26c224481e3e27d9,0x23e3a6f627c39fc6
.quad 0x244826c29e3e27d9,0x26f6a3e327c31fc6,0x1bd627f1a47226a7,0x27ff124825ed255f,0xa1052799a6a72472,0x26c2244821642788,0xa58425cba7d91e3e,0x233227259cb227ea,0xa77721c2a7d99e3e,0x98b527faa4c4266d,0xa7fa98b5a6a7a472,0xa49b268aa73b22d7,0xa6f6a3e3a472a6a7,0xa750227ca7fe9648,0xa49ba68a9e3ea7d9,0xa7f19bd6a6dda41d
.quad 0x9d79a7e21e3ea7d9,0xa64fa4eca41da6dd,0x2044a7b62472a6a7,0xa1c2a7779648a7fe,0x253aa60f26a7a472,0x1d79a7e222d7a73b,0x2750a27c27d99e3e,0x253aa60f266da4c4,0x27ff124827d91e3e,0x2799a10527ea9cb2,0x2725233226a72472,0x27ce1f0327882164,0x24ec264f247226a7,0x25cb2584255f25ed,0x1f0327ce1e3e27d9,0x204427b61fc627c3
.quad 0x27992105a0a527a8,0xa777a1c22164a788,0x249b268aa62f2513,0xa332a72526dda41d,0x924827ffa7f61a46,0x2044a7b627ea1cb2,0xa4ec264fa70ea38b,0x26c2a448255f25ed,0xa7b62044a38ba70e,0x27e21d79164827fe,0xa777a1c21a46a7f6,0x24ec264fa4c4266d,0xa448a6c22513a62f,0x98b527faa7c31fc6,0x18b5a7fa27a8a0a5,0xa5cb2584a73ba2d7
.quad 0x253aa60f27a820a5,0xa7ff1248a2d7a73b,0x27ce9f032513262f,0xa60fa53a1fc6a7c3,0x2750227c1a4627f6,0x9bd6a7f1266da4c4,0x23e326f6a38b270e,0x249ba68a27fe1648,0x9bd627f1a70e238b,0x27ce9f0325ed255f,0xa58425cba7f69a46,0x26f623e31cb227ea,0xa7e21d79a62fa513,0x21052799a41d26dd,0xa725a332a0a5a7a8,0xa27c2750a7882164
.quad 0xa332a72520a5a7a8,0xa750227ca788a164,0x1d79a7e2262fa513,0xa799a105a41da6dd,0x25cba58427f69a46,0xa3e3a6f61cb2a7ea,0x27f19bd6270e238b,0x1f03a7ce25eda55f,0x26f623e3238b270e,0x268aa49b27fe9648,0x227c27509a4627f6,0x27f11bd6266d24c4,0x9f0327cea513262f,0x253a260f1fc627c3,0xa60f253aa7a820a5,0x924827ffa2d7273b
.quad 0xa7fa18b5a7a8a0a5,0xa58425cba73b22d7,0xa6c2a448a513a62f,0xa7fa18b5a7c39fc6,0xa1c2a7779a46a7f6,0xa64fa4eca4c4a66d,0x2044a7b6238ba70e,0x9d79a7e21648a7fe,0x264fa4ec270ea38b,0x2448a6c2255fa5ed,0x27ff924827f61a46,0x27b6a04427ea9cb2,0x268a249b262f2513,0x2725233226dd241d,0x2105279920a527a8,0x21c2277721642788
.quad 0x2750227ca21f2764,0xa725a33222d7a73b,0x21052799a764221f,0x9d79a7e227c39fc6,0xa3e326f6a764a21f,0x2584a5cb266d24c4,0xa7ce1f03a21fa764,0x27f11bd6164827fe,0xa68aa49b221fa764,0x23e326f6a5ed255f,0x9bd6a7f12764a21f,0xa27c2750a7ea9cb2,0x253aa60f2764221f,0xa7ce1f03a41da6dd,0x27ff9248221f2764,0xa60fa53a2164a788
.quad 0x258425cba21f2764,0x18b5a7fa2788a164,0x98b527faa764221f,0x26c2a44826dd241d,0xa64f24eca764a21f,0x277721c21cb227ea,0xa7e29d79a21fa764,0x204427b6a55f25ed,0xa448a6c2221fa764,0xa4ec264fa7fe9648,0x2044a7b62764a21f,0xa7ff9248a4c4a66d,0x2725a3322764221f,0xa49ba68a1fc6a7c3,0x277721c2221f2764,0x2105a799273ba2d7
.quad 0x21c22777a21f2764,0x2799a105273b22d7,0xa3322725a764221f,0x268a249b1fc627c3,0xa7b62044a764a21f,0x124827ffa4c4266d,0xa6c2a448a21fa764,0xa64f24eca7fe1648,0x9d79a7e2221fa764,0xa7b6a044a55fa5ed,0x24eca64f2764a21f,0xa1c2a7771cb2a7ea,0x27fa98b52764221f,0x2448a6c226dda41d,0x25cb2584221f2764,0x27fa98b527882164
.quad 0x924827ffa21f2764,0x253a260f21642788,0xa60f253aa764221f,0x9f0327cea41d26dd,0xa7f19bd6a764a21f,0xa750227ca7ea1cb2,0xa49ba68aa21fa764,0xa6f6a3e3a5eda55f,0x1f03a7ce221fa764,0x9bd6a7f11648a7fe,0x26f6a3e32764a21f,0x25cba584266da4c4,0x279921052764221f,0x27e21d7927c31fc6,0x227c2750221f2764,0x2332272522d7273b
.quad 0x26f623e3a38b270e,0xa6c2a448241da6dd,0x124827ffa7f61a46,0x1bd6a7f127fe1648,0xa6c22448a513a62f,0x2799a10522d7273b,0xa725a33220a5a7a8,0x258425cba4c4266d,0x98b5a7fa27a8a0a5,0xa1c22777a7ea9cb2,0x268aa49b262f2513,0xa7fa18b5a164a788,0x2750227c9a4627f6,0xa3e3a6f6255fa5ed,0x1bd627f1a70e238b,0x249ba68a27c31fc6
.quad 0xa64f24eca70ea38b,0x27e21d791fc627c3,0xa777a1c29a46a7f6,0x204427b6a5ed255f,0x9d79a7e2262fa513,0xa60f253aa788a164,0x260fa53a27a820a5,0xa750a27c9cb2a7ea,0x2799210520a527a8,0x9248a7ff266da4c4,0x1f0327cea513262f,0x2725a332273b22d7,0xa5cb2584a7f69a46,0x264f24ec164827fe,0xa7b6a044a38ba70e,0x9f0327cea6dd241d
.quad 0xa044a7b6238ba70e,0xa7ce1f03a6dda41d,0x2584a5cb27f69a46,0xa4eca64f1648a7fe,0x27ce1f032513262f,0x2332a725273ba2d7,0x21052799a0a527a8,0x27ff1248266d24c4,0xa53a260fa7a820a5,0x227c27509cb227ea,0xa7e29d79a62fa513,0xa53a260fa7882164,0xa1c2a7771a46a7f6,0xa7b6a044a5eda55f,0x24eca64f270ea38b,0x9d79a7e21fc6a7c3
.quad 0x27f11bd6270e238b,0x268aa49b27c39fc6,0x227c27501a4627f6,0x26f623e3255f25ed,0xa49b268aa62f2513,0x98b527faa1642788,0xa7fa98b5a7a8a0a5,0xa77721c2a7ea1cb2,0xa332a725a0a5a7a8,0xa5cba584a4c4a66d,0x2448a6c22513a62f,0x2105a79922d7a73b,0x27ff124827f61a46,0x27f19bd627fe9648,0x23e326f6238b270e,0x244826c2241d26dd
.quad 0x268a249ba47226a7,0xa64fa4ec24c4a66d,0xa04427b6a7d99e3e,0x227ca75027882164,0xa7fa18b59e3ea7d9,0x27e21d79964827fe,0xa27ca75026a7a472,0x18b527faa7c31fc6,0x25cba58426a72472,0xa7992105a41da6dd,0x272523329e3e27d9,0xa448a6c2255fa5ed,0x9bd627f1a7d91e3e,0x2584a5cb273b22d7,0xa7ce1f03a472a6a7,0x26f623e39cb227ea
.quad 0xa448a6c22472a6a7,0xa04427b6a7ea1cb2,0x24eca64f27d91e3e,0xa7ff9248a2d7a73b,0x279921051e3e27d9,0x9f03a7ce25eda55f,0x124827ffa6a72472,0x2725a33226dd241d,0xa77721c2a6a7a472,0x253a260f9fc627c3,0xa53aa60f1e3ea7d9,0xa49b268aa7fe1648,0x23e3a6f627d99e3e,0xa777a1c2a164a788,0x27e21d79247226a7,0x1bd6a7f1266da4c4
.quad 0x1d7927e2a47226a7,0x27f19bd6266d24c4,0xa6f623e3a7d99e3e,0x21c22777a1642788,0xa60fa53a9e3ea7d9,0xa68a249ba7fe9648,0x21c2a77726a7a472,0xa60fa53a9fc6a7c3,0x27ff124826a72472,0x2332a72526dda41d,0x210527999e3e27d9,0x27ce1f0325ed255f,0xa64f24eca7d91e3e,0x124827ffa2d7273b,0xa6c2a448a472a6a7,0xa7b62044a7ea9cb2
.quad 0x1f03a7ce2472a6a7,0xa3e3a6f69cb2a7ea,0x27f19bd627d91e3e,0x25cba584273ba2d7,0x233227251e3e27d9,0x26c22448255f25ed,0xa58425cba6a72472,0xa1052799a41d26dd,0xa750a27ca6a7a472,0xa7fa98b5a7c39fc6,0x18b5a7fa1e3ea7d9,0x9d79a7e29648a7fe,0x27b6a04427d99e3e,0x2750a27c2788a164,0x249b268a247226a7,0x24ec264f24c4266d
.quad 0x260f253aa513262f,0xa5cba584255fa5ed,0xa44826c2a70ea38b,0x253aa60f266d24c4,0xa750a27c20a5a7a8,0x264f24eca41d26dd,0x2044a7b627f61a46,0xa49b268aa73ba2d7,0x27f11bd61a4627f6,0xa6c2a4482164a788,0x124827ffa7a820a5,0x23e3a6f627c31fc6,0xa7e21d79a38ba70e,0x272523329cb227ea,0xa105a799262fa513,0xa27c2750a7fe9648
.quad 0x2725a332262f2513,0xa777a1c29648a7fe,0x249b268aa38b270e,0x2105a79927ea9cb2,0xa5cb2584a7a8a0a5,0x27b620441fc627c3,0xa64fa4ec1a46a7f6,0x9f0327cea7882164,0x23e3a6f627f69a46,0xa7e29d79a2d7a73b,0x277721c220a527a8,0x1bd6a7f126dda41d,0x9f0327cea70e238b,0x27fa18b524c4266d,0xa7fa98b5a513a62f,0x924827ffa5ed255f
.quad 0x98b5a7fa2513a62f,0xa7ff1248a5eda55f,0x27ce9f03270e238b,0x98b5a7fa24c4a66d,0x21c22777a0a527a8,0x27f19bd626dd241d,0xa6f623e3a7f69a46,0x1d7927e2a2d7273b,0xa4eca64f9a46a7f6,0xa7ce1f03a788a164,0x2584a5cb27a8a0a5,0xa044a7b61fc6a7c3,0x268a249b238b270e,0x2799a10527ea1cb2,0xa3322725a62f2513,0x21c22777964827fe
.quad 0xa799a105a62fa513,0xa750227ca7fe1648,0x1d79a7e2238ba70e,0xa332a7259cb2a7ea,0x27ff124827a820a5,0x26f6a3e327c39fc6,0x1bd627f19a4627f6,0x244826c221642788,0xa7b62044a7f61a46,0xa68a249ba73b22d7,0xa27ca750a0a5a7a8,0xa4eca64fa41da6dd,0x26c2a448270ea38b,0x260fa53a266da4c4,0x253a260f2513262f,0x258425cb255f25ed
.quad 0x258425cba5a825a8,0xa53aa60f25eda55f,0xa60f253aa5a8a5a8,0x26c2a44824c4266d,0xa4eca64f25a8a5a8,0x227c2750a6dd241d,0x268aa49b25a825a8,0xa7b62044a2d7a73b,0x244826c2a5a825a8,0x9bd6a7f12788a164,0xa6f623e3a5a8a5a8,0x27ff12481fc627c3,0xa332a72525a8a5a8,0x9d7927e2a7ea1cb2,0x2750a27c25a825a8,0xa799a1059648a7fe
.quad 0x21c22777a5a825a8,0x2332a72527fe1648,0xa7992105a5a8a5a8,0x268a249b9cb227ea,0xa044a7b625a8a5a8,0xa58425cba7c39fc6,0x27ce9f0325a825a8,0xa4eca64f2164a788,0x1d7927e2a5a825a8,0x26f6a3e3273b22d7,0xa7f11bd6a5a8a5a8,0x21c22777a41d26dd,0x98b5a7fa25a8a5a8,0xa7ce1f03a66da4c4,0x27ff924825a825a8,0x98b5a7fa255fa5ed
.quad 0x924827ffa5a825a8,0x27fa18b5255f25ed,0xa7fa98b5a5a8a5a8,0x9f0327cea66d24c4,0x1bd6a7f125a8a5a8,0xa777a1c2a41da6dd,0x27e21d7925a825a8,0x23e3a6f6273ba2d7,0x9f0327cea5a825a8,0x264f24ec21642788,0xa7b6a044a5a8a5a8,0xa5cb2584a7c31fc6,0x2105a79925a8a5a8,0xa49ba68a9cb2a7ea,0x277721c225a825a8,0x2725a33227fe9648
.quad 0xa27c2750a5a825a8,0x21052799964827fe,0xa725a332a5a8a5a8,0xa7e21d79a7ea9cb2,0x23e3a6f625a8a5a8,0x9248a7ff1fc6a7c3,0x26c2244825a825a8,0x27f11bd627882164,0xa49b268aa5a825a8,0xa04427b6a2d7273b,0xa64fa4eca5a8a5a8,0xa750a27ca6dda41d,0x253aa60f25a8a5a8,0x2448a6c224c4a66d,0x25cb258425a825a8,0x260f253a25ed255f
.quad 0x24ec264fa62f2513,0xa49ba68a266da4c4,0xa750227ca38ba70e,0x27b6a04421642788,0x9d79a7e227a8a0a5,0x98b527faa7fe1648,0x27fa18b51a4627f6,0xa750a27c1fc6a7c3,0xa1052799a7f69a46,0x2584a5cb26dd241d,0xa6c2a44820a5a7a8,0x23322725a5ed255f,0x25cba584270e238b,0xa7f11bd6a2d7a73b,0x23e326f6a513262f,0x1f03a7ce27ea9cb2
.quad 0xa7b62044a513a62f,0x26c224489cb227ea,0x9248a7ff270ea38b,0xa64f24eca73ba2d7,0x27ce1f0320a527a8,0xa105a799255fa5ed,0xa3322725a7f61a46,0x27ff1248241d26dd,0xa60fa53a1a46a7f6,0xa1c22777a7c31fc6,0x268aa49b27a820a5,0xa60fa53a1648a7fe,0x21c22777a38b270e,0x26f6a3e327882164,0xa7f11bd6a62fa513,0x1d7927e2a4c4266d
.quad 0x1bd6a7f1262fa513,0xa7e29d79a4c4a66d,0x277721c2238b270e,0x23e3a6f62788a164,0xa49b268aa7a820a5,0x253a260f164827fe,0xa53aa60f9a46a7f6,0xa77721c2a7c39fc6,0x2725a33227f61a46,0x9248a7ff241da6dd,0x1f0327cea0a527a8,0x27992105255f25ed,0xa7ff9248a70ea38b,0xa4ec264fa73b22d7,0x2044a7b62513a62f,0xa448a6c29cb2a7ea
.quad 0x26f623e32513262f,0x27ce9f0327ea1cb2,0xa58425cba70e238b,0x9bd627f1a2d7273b,0xa448a6c2a0a5a7a8,0xa725a332a5eda55f,0x2799a10527f69a46,0x25cba58426dda41d,0x18b527fa9a4627f6,0x227c27501fc627c3,0xa7e29d79a7a8a0a5,0xa7fa18b5a7fe9648,0x227ca750238ba70e,0x2044a7b62164a788,0x264f24ec262f2513,0x268a249b266d24c4
.quad 0x244826c2a6a72472,0xa3e3a6f626dda41d,0xa7f11bd69e3ea7d9,0x27ff1248164827fe,0x2105a79927d91e3e,0xa44826c2a73ba2d7,0x25cb2584a47226a7,0xa332a725266da4c4,0xa77721c2a472a6a7,0x27fa18b51cb227ea,0x18b5a7fa27d99e3e,0xa49b268aa788a164,0x26f623e39e3e27d9,0xa27ca75025eda55f,0xa68a249ba6a7a472,0x27f11bd61fc627c3
.quad 0x9d79a7e226a7a472,0xa4ec264fa7c39fc6,0x27b620441e3e27d9,0xa1c2a777255fa5ed,0xa53a260fa7d99e3e,0x27e21d7921642788,0xa27ca7502472a6a7,0xa53a260fa7ea9cb2,0x27ff1248247226a7,0xa105a79924c4a66d,0xa3322725a7d91e3e,0x27ce1f0322d7273b,0xa4eca64f1e3ea7d9,0xa58425cba7fe9648,0x27ce9f0326a72472,0xa044a7b6241da6dd
.quad 0x9f0327cea6a72472,0x27b62044241d26dd,0xa64fa4ec9e3ea7d9,0xa5cb2584a7fe1648,0x2725a33227d91e3e,0x9f03a7ce22d7a73b,0x124827ffa47226a7,0x2799210524c4266d,0xa750a27ca472a6a7,0xa60f253aa7ea1cb2,0x260fa53a27d99e3e,0x9d79a7e22164a788,0x204427b69e3e27d9,0x277721c2255f25ed,0xa7e29d79a6a7a472,0xa64f24eca7c31fc6
.quad 0x249ba68a26a7a472,0x9bd6a7f11fc6a7c3,0x23e326f61e3e27d9,0x2750227c25ed255f,0xa7fa18b5a7d99e3e,0xa68a249ba7882164,0x21c2a7772472a6a7,0x98b5a7fa1cb2a7ea,0x258425cb247226a7,0x27252332266d24c4,0xa7992105a7d91e3e,0xa6c22448a73b22d7,0x1bd6a7f11e3ea7d9,0x9248a7ff1648a7fe,0x26c2244826a72472,0x26f623e326dd241d
.quad 0x23322725a70e238b,0xa27ca750273ba2d7,0xa7e29d791a46a7f6,0x279921059fc627c3,0x25cba584262f2513,0xa6f623e3a4c4a66d,0x1bd627f1a7a820a5,0x1f03a7ce27fe1648,0xa6f6a3e320a5a7a8,0x249b268aa55f25ed,0x2750a27c2513262f,0xa7f19bd69cb2a7ea,0x9f0327cea7f61a46,0x260fa53a26dd241d,0xa53aa60f238ba70e,0x924827ffa7882164
.quad 0x27fa98b5238b270e,0xa5cba5842164a788,0xa44826c2a7f69a46,0x27fa98b5241d26dd,0xa1c2a7772513a62f,0xa4ec264fa7ea9cb2,0x27b6204420a527a8,0x9d79a7e225eda55f,0xa64f24eca7a8a0a5,0x26c22448164827fe,0x9248a7ff262fa513,0xa7b62044a66da4c4,0x268a249b1a4627f6,0x2332a72527c39fc6,0xa7992105a70ea38b,0x21c22777a2d7273b
.quad 0x2105a799270ea38b,0xa777a1c2a2d7a73b,0x249b268a9a4627f6,0x2725a33227c31fc6,0xa7ff9248a62fa513,0xa04427b6a66d24c4,0x24eca64f27a8a0a5,0xa448a6c21648a7fe,0x204427b6a0a527a8,0x27e21d7925ed255f,0xa777a1c2a513a62f,0xa64f24eca7ea1cb2,0x26c2a44827f69a46,0x18b5a7fa241da6dd,0x98b527faa38b270e,0x258425cb21642788
.quad 0xa60fa53aa38ba70e,0xa7ff1248a788a164,0x27ce9f0327f61a46,0x253aa60f26dda41d,0xa27c2750a513262f,0x1bd627f19cb227ea,0xa3e3a6f6a0a5a7a8,0xa68aa49ba55fa5ed,0x27f11bd627a820a5,0x27ce9f0327fe9648,0xa58425cba62f2513,0xa3e326f6a4c4266d,0x9d79a7e29a46a7f6,0xa105a7999fc6a7c3,0x27252332270e238b,0x2750227c273b22d7
.quad 0x21c22777a764221f,0xa105a7992788a164,0xa725a332221fa764,0x268a249ba41d26dd,0x27b6a044221f2764,0xa7ff12489cb2a7ea,0xa44826c2a764a21f,0x264fa4ec25ed255f,0x9d79a7e22764a21f,0xa04427b6a7fe9648,0x264f24eca21f2764,0xa1c2a777266da4c4,0xa7fa18b5a21fa764,0x26c224489fc627c3,0x2584a5cb2764221f,0xa7fa18b5a2d7a73b
.quad 0x924827ffa764221f,0x260fa53a273b22d7,0xa53aa60f221fa764,0x9f0327cea7c31fc6,0x27f11bd6221f2764,0xa27ca75024c4a66d,0xa68a249ba764a21f,0x26f623e3164827fe,0x1f03a7ce2764a21f,0xa7f11bd6a55fa5ed,0x23e326f6a21f2764,0x25cba58427ea1cb2,0xa799a105a21fa764,0x9d7927e2a6dd241d,0x2750a27c2764221f,0xa332a7252164a788
.quad 0xa27c2750a764221f,0x2725233221642788,0xa105a799221fa764,0xa7e21d79a6dda41d,0x26f623e3221f2764,0x2584a5cb27ea9cb2,0xa7ce1f03a764a21f,0x9bd627f1a55f25ed,0x249ba68a2764a21f,0xa3e3a6f61648a7fe,0x1bd627f1a21f2764,0x2750227c24c4266d,0xa60fa53aa21fa764,0xa7ce1f03a7c39fc6,0x27ff92482764221f,0x253aa60f273ba2d7
.quad 0xa5cb2584a764221f,0x98b527faa2d7273b,0x18b5a7fa221fa764,0xa448a6c29fc6a7c3,0x24ec264f221f2764,0x277721c2266d24c4,0xa7e29d79a764a21f,0xa7b62044a7fe1648,0x26c2a4482764a21f,0x24eca64f25eda55f,0xa04427b6a21f2764,0x924827ff9cb227ea,0xa332a725a21fa764,0xa49ba68aa41da6dd,0x277721c22764221f,0x2799210527882164
.quad 0x204427b6a7a820a5,0x9f03a7ce27c39fc6,0xa5cba5842513a62f,0x24ec264fa5ed255f,0x27ce1f039a4627f6,0xa725a3322164a788,0xa7992105a38ba70e,0x27ff12481cb227ea,0x253aa60f270e238b,0xa750227ca4c4a66d,0x9d7927e2a7f61a46,0x253aa60f273b22d7,0xa1c2a777262fa513,0xa04427b6a7fe1648,0x264f24eca0a527a8,0x9d79a7e226dda41d
.quad 0xa7f19bd6a0a5a7a8,0x249b268aa41d26dd,0x2750a27c262f2513,0xa6f6a3e31648a7fe,0xa49b268aa7f69a46,0x27fa18b522d7273b,0x18b5a7fa270ea38b,0xa77721c2a66da4c4,0x23322725a38b270e,0x2584a5cb27ea1cb2,0xa6c2a4489a46a7f6,0xa1052799a7882164,0x27ff12482513262f,0x9bd6a7f1255fa5ed,0xa6f623e3a7a8a0a5,0x244826c29fc627c3
.quad 0x23e3a6f627a8a0a5,0xa6c2a4489fc6a7c3,0x124827ffa513262f,0x27f11bd6255f25ed,0xa448a6c21a46a7f6,0xa7992105a788a164,0x27252332238b270e,0x25cba58427ea9cb2,0xa7fa18b5a70ea38b,0xa1c22777a66d24c4,0x268aa49b27f69a46,0x98b5a7fa22d7a73b,0xa27c2750a62f2513,0x23e326f6164827fe,0x9bd6a7f120a5a7a8,0xa68aa49ba41da6dd
.quad 0x24ec264f20a527a8,0x27e21d7926dd241d,0xa777a1c2a62fa513,0xa7b62044a7fe9648,0x27e29d7927f61a46,0x260fa53a273ba2d7,0xa60f253aa70e238b,0xa27c2750a4c4266d,0x2105a799238ba70e,0x9248a7ff1cb2a7ea,0x1f0327ce1a4627f6,0x2332272521642788,0xa584a5cba513a62f,0xa64fa4eca5eda55f,0x27b6204427a820a5,0x27ce1f0327c31fc6
.quad 0x1d7927e2a7d91e3e,0x9bd6a7f127ea9cb2,0xa3e3a6f626a7a472,0x21c22777a73b22d7,0x260f253aa47226a7,0xa49ba68a25eda55f,0xa777a1c21e3ea7d9,0x260f253aa41d26dd,0x27ff12481e3e27d9,0xa725a3321fc6a7c3,0xa7992105a472a6a7,0x27ce1f03164827fe,0x264fa4ec26a72472,0xa7ff1248a164a788,0xa44826c2a7d99e3e,0x27b6a04424c4266d
.quad 0x1f03a7ce27d99e3e,0xa6f623e3a66da4c4,0x1bd627f1a6a72472,0x25cba58427882164,0xa332a7252472a6a7,0xa44826c2a7fe9648,0x25cb25849e3e27d9,0x2105a79927c39fc6,0xa750a27c9e3ea7d9,0x98b527faa6dd241d,0x27fa18b5247226a7,0x9d79a7e2255fa5ed,0xa7b62044a6a7a472,0x227c2750a2d7273b,0x268aa49b27d91e3e,0xa4eca64f1cb2a7ea
.quad 0xa49b268aa7d91e3e,0x264f24ec1cb227ea,0x2044a7b626a7a472,0xa750a27ca2d7a73b,0x18b527faa47226a7,0x27e21d79255f25ed,0xa27ca7501e3ea7d9,0xa7fa18b5a6dda41d,0x258425cb1e3e27d9,0x2799a10527c31fc6,0xa725a332a472a6a7,0xa6c22448a7fe1648,0x27f11bd626a72472,0x2584a5cb2788a164,0xa7ce1f03a7d99e3e,0xa3e326f6a66d24c4
.quad 0x26c2a44827d99e3e,0x2044a7b624c4a66d,0xa4ec264fa6a72472,0x924827ffa1642788,0x2105a7992472a6a7,0x9f03a7ce1648a7fe,0x124827ff9e3e27d9,0x233227251fc627c3,0xa1c2a7779e3ea7d9,0xa53aa60fa41da6dd,0x253a260f247226a7,0x268a249b25ed255f,0xa6f6a3e3a6a7a472,0xa777a1c2a73ba2d7,0x27e21d7927d91e3e,0x27f11bd627ea1cb2
.quad 0x18b527faa7f61a46,0x9248a7ff27fe9648,0x9f03a7ce27a8a0a5,0x18b527faa7ea1cb2,0x21c22777a70e238b,0x9bd6a7f127c39fc6,0xa3e3a6f6262fa513,0x1d7927e2a7882164,0x24ec264fa513262f,0x9f03a7ce273ba2d7,0xa5cba584238ba70e,0x204427b6a6dd241d,0x268a249ba0a527a8,0xa105a799266da4c4,0xa725a3321a46a7f6,0x21c22777a5ed255f
.quad 0x279921051a4627f6,0xa27ca750255fa5ed,0xa7e29d79a0a5a7a8,0x23322725a4c4266d,0x27ff1248238b270e,0xa3e3a6f6241da6dd,0xa7f11bd6a513a62f,0x244826c2a2d7273b,0x27b6a044262f2513,0xa49ba68a2164a788,0xa750227ca70ea38b,0x24ec264f9fc627c3,0x26c2a44827a820a5,0xa53aa60f1cb2a7ea,0xa60f253aa7f69a46,0x258425cb964827fe
.quad 0x253aa60f27f69a46,0xa5cba5849648a7fe,0xa44826c2a7a820a5,0x260f253a1cb227ea,0x227ca750270ea38b,0xa64fa4ec9fc6a7c3,0xa04427b6a62f2513,0x268a249b21642788,0x1bd6a7f12513a62f,0xa6c2a448a2d7a73b,0x124827ffa38b270e,0x26f623e3241d26dd,0x9d79a7e220a5a7a8,0xa725a332a4c4a66d,0x210527999a4627f6,0x2750227c255f25ed
.quad 0xa332a7259a46a7f6,0xa777a1c2a5eda55f,0x249b268a20a527a8,0x27992105266d24c4,0xa584a5cba38ba70e,0xa7b6a044a6dda41d,0x264f24ec2513262f,0x27ce1f03273b22d7,0xa6f6a3e3a62fa513,0xa7e29d79a788a164,0x277721c2270e238b,0x27f11bd627c31fc6,0xa7ce9f03a7a8a0a5,0xa7fa98b5a7ea9cb2,0x27fa18b527f61a46,0x27ff124827fe1648
.quad 0x3400340034003400,0x3400340034003400,0,0,0x35a8000034003400,0xb5a83400b400,0,0,0x3400b40034003400,0xb4003400b400b400,0,0,0xb5a834003400,0x35a80000b4003400,0,0
.quad 0xb400b40034003400,0xb400b40034003400,0,0,0xb5a8800034003400,0x800035a83400b400,0,0,0xb400340034003400,0x3400b400b400b400,0,0,0x800035a834003400,0xb5a88000b4003400,0,0
.quad 0,0,0x3400340034003400,0x3400340034003400,0,0,0x353ab054353a3054,0xb054b53a3054b53a,0,0,0xb5a835a80000,0x800035a8b5a88000,0,0,0xb53ab054353ab054,0x3054b53a3054353a
.quad 0,0,0xb40034003400b400,0xb40034003400b400,0,0,0x3054353a3054b53a,0x353ab054b53ab054,0,0,0x35a800000000b5a8,0xb5a88000800035a8,0,0,0x3054b53ab054b53a,0x353a3054353ab054
.quad 0x34003400,0,0,0,0xb400b400,0,0,0,0x34003400,0,0,0,0xb400b400,0,0,0
.quad 0x34003400,0,0,0,0xb400b400,0,0,0,0x34003400,0,0,0,0xb400b400,0,0,0
.quad 0,0,0,0,0,0,0,0,0,0,0,0,0,0,0,0
.quad 0,0,0,0,0,0,0,0,0,0,0,0,0,0,0,0
.quad 0x3400340034003400,0x3400340034003400,0xb4003400b4003400,0xb4003400b4003400,0x35a89471340333fa,0x9471b5a833fab403,0x147135a8b3fa3403,0x35a89471340333fa,0x33f3b406340633f3,0xb3f33406b406b3f3,0x340633f3b3f33406,0xb406b3f333f3b406,0x9aaab5a8340933ed,0x35a89aaab3ed3409,0x35a89aaab3ed3409,0x1aaa35a8b409b3ed
.quad 0xb40cb3e7340c33e7,0xb40cb3e7340c33e7,0x33e7b40cb3e7340c,0x33e7b40cb3e7340c,0xb5a81d8e341033e0,0x1d8e35a833e0b410,0x9d8eb5a8b3e03410,0xb5a81d8e341033e0,0xb3da3413341333da,0x33dab413b413b3da,0xb413b3dab3da3413,0x341333da33dab413,0x1fc635a8341633d4,0xb5a81fc6b3d43416,0xb5a81fc6b3d43416,0x9fc6b5a8b416b3d4
.quad 0x3400340034003400,0x3400340034003400,0xb4003400b4003400,0xb4003400b4003400,0xb5a81471b403b3fa,0x147135a8b3fa3403,0x9471b5a833fab403,0xb5a81471b403b3fa,0x33f3b406340633f3,0xb3f33406b406b3f3,0x340633f3b3f33406,0xb406b3f333f3b406,0x1aaa35a8b409b3ed,0xb5a81aaa33edb409,0xb5a81aaa33edb409,0x9aaab5a8340933ed
.quad 0xb40cb3e7340c33e7,0xb40cb3e7340c33e7,0x33e7b40cb3e7340c,0x33e7b40cb3e7340c,0x35a89d8eb410b3e0,0x9d8eb5a8b3e03410,0x1d8e35a833e0b410,0x35a89d8eb410b3e0,0xb3da3413341333da,0x33dab413b413b3da,0xb413b3dab3da3413,0x341333da33dab413,0x9fc6b5a8b416b3d4,0x35a89fc633d4b416,0x35a89fc633d4b416,0x1fc635a8341633d4
.quad 0,0,0,0,0,0,0,0,0,0,0,0,0,0,0,0
.quad 0,0,0,0,0,0,0,0,0,0,0,0,0,0,0,0
.quad 0,0,0,0,0,0,0,0,0,0,0,0,0,0,0,0
.quad 0,0,0,0,0,0,0,0,0,0,0,0,0,0,0,0
.quad 0x3400340034003400,0x3400340034003400,0xb4003400b4003400,0xb4003400b4003400,0x35a89871340633f3,0x9871b5a833f3b406,0x187135a8b3f33406,0x35a89871340633f3,0x33e7b40c340c33e7,0xb3e7340cb40cb3e7,0x340c33e7b3e7340c,0xb40cb3e733e7b40c,0x9eaab5a8341333da,0x35a89eaab3da3413,0x35a89eaab3da3413,0x1eaa35a8b413b3da
.quad 0xb419b3cd341933cd,0xb419b3cd341933cd,0x33cdb419b3cd3419,0x33cdb419b3cd3419,0xb5a7218d341f33c0,0x218d35a733c0b41f,0xa18db5a7b3c0341f,0xb5a7218d341f33c0,0xb3b33425342533b3,0x33b3b425b425b3b3,0xb425b3b3b3b33425,0x342533b333b3b425,0x23c635a7342b33a6,0xb5a723c6b3a6342b,0xb5a723c6b3a6342b,0xa3c6b5a7b42bb3a6
.quad 0x3400340034003400,0x3400340034003400,0xb4003400b4003400,0xb4003400b4003400,0xb5a81871b406b3f3,0x187135a8b3f33406,0x9871b5a833f3b406,0xb5a81871b406b3f3,0x33e7b40c340c33e7,0xb3e7340cb40cb3e7,0x340c33e7b3e7340c,0xb40cb3e733e7b40c,0x1eaa35a8b413b3da,0xb5a81eaa33dab413,0xb5a81eaa33dab413,0x9eaab5a8341333da
.quad 0xb419b3cd341933cd,0xb419b3cd341933cd,0x33cdb419b3cd3419,0x33cdb419b3cd3419,0x35a7a18db41fb3c0,0xa18db5a7b3c0341f,0x218d35a733c0b41f,0x35a7a18db41fb3c0,0xb3b33425342533b3,0x33b3b425b425b3b3,0xb425b3b3b3b33425,0x342533b333b3b425,0xa3c6b5a7b42bb3a6,0x35a7a3c633a6b42b,0x35a7a3c633a6b42b,0x23c635a7342b33a6
.quad 0,0,0,0,0,0,0,0,0,0,0,0,0,0,0,0
.quad 0,0,0,0,0,0,0,0,0,0,0,0,0,0,0,0
.quad 0,0,0,0,0,0,0,0,0,0,0,0,0,0,0,0
.quad 0,0,0,0,0,0,0,0,0,0,0,0,0,0,0,0
.quad 0x3400340034003400,0x3400340034003400,0xb4003400b4003400,0xb4003400b4003400,0x35a89aaa340933ed,0x9aaab5a833edb409,0x1aaa35a8b3ed3409,0x35a89aaa340933ed,0x33dab413341333da,0xb3da3413b413b3da,0x341333dab3da3413,0xb413b3da33dab413,0xa0ffb5a8341c33c7,0x35a8a0ffb3c7341c,0x35a8a0ffb3c7341c,0x20ff35a8b41cb3c7
.quad 0xb425b3b3342533b3,0xb425b3b3342533b3,0x33b3b425b3b33425,0x33b3b425b3b33425,0xb5a7242a342e33a0,0x242a35a733a0b42e,0xa42ab5a7b3a0342e,0xb5a7242a342e33a0,0xb38c34373437338c,0x338cb437b437b38c,0xb437b38cb38c3437,0x3437338c338cb437,0x25d435a534403378,0xb5a525d4b3783440,0xb5a525d4b3783440,0xa5d4b5a5b440b378
.quad 0x3400340034003400,0x3400340034003400,0xb4003400b4003400,0xb4003400b4003400,0xb5a81aaab409b3ed,0x1aaa35a8b3ed3409,0x9aaab5a833edb409,0xb5a81aaab409b3ed,0x33dab413341333da,0xb3da3413b413b3da,0x341333dab3da3413,0xb413b3da33dab413,0x20ff35a8b41cb3c7,0xb5a820ff33c7b41c,0xb5a820ff33c7b41c,0xa0ffb5a8341c33c7
.quad 0xb425b3b3342533b3,0xb425b3b3342533b3,0x33b3b425b3b33425,0x33b3b425b3b33425,0x35a7a42ab42eb3a0,0xa42ab5a7b3a0342e,0x242a35a733a0b42e,0x35a7a42ab42eb3a0,0xb38c34373437338c,0x338cb437b437b38c,0xb437b38cb38c3437,0x3437338c338cb437,0xa5d4b5a5b440b378,0x35a5a5d43378b440,0x35a5a5d43378b440,0x25d435a534403378
.quad 0,0,0,0,0,0,0,0,0,0,0,0,0,0,0,0
.quad 0,0,0,0,0,0,0,0,0,0,0,0,0,0,0,0
.quad 0,0,0,0,0,0,0,0,0,0,0,0,0,0,0,0
.quad 0,0,0,0,0,0,0,0,0,0,0,0,0,0,0,0
.quad 0x3400340034003400,0x3400340034003400,0xb4003400b4003400,0xb4003400b4003400,0x35a89c71340c33e7,0x9c71b5a833e7b40c,0x1c7135a8b3e7340c,0x35a89c71340c33e7,0x33cdb419341933cd,0xb3cd3419b419b3cd,0x341933cdb3cd3419,0xb419b3cd33cdb419,0xa2aab5a7342533b3,0x35a7a2aab3b33425,0x35a7a2aab3b33425,0x22aa35a7b425b3b3
.quad 0xb431b39934313399,0xb431b39934313399,0x3399b431b3993431,0x3399b431b3993431,0xb5a5258d343d337f,0x258d35a5337fb43d,0xa58db5a5b37f343d,0xb5a5258d343d337f,0xb364344934493364,0x3364b449b449b364,0xb449b364b3643449,0x344933643364b449,0x27c435a334543349,0xb5a327c4b3493454,0xb5a327c4b3493454,0xa7c4b5a3b454b349
.quad 0x3400340034003400,0x3400340034003400,0xb4003400b4003400,0xb4003400b4003400,0xb5a81c71b40cb3e7,0x1c7135a8b3e7340c,0x9c71b5a833e7b40c,0xb5a81c71b40cb3e7,0x33cdb419341933cd,0xb3cd3419b419b3cd,0x341933cdb3cd3419,0xb419b3cd33cdb419,0x22aa35a7b425b3b3,0xb5a722aa33b3b425,0xb5a722aa33b3b425,0xa2aab5a7342533b3
.quad 0xb431b39934313399,0xb431b39934313399,0x3399b431b3993431,0x3399b431b3993431,0x35a5a58db43db37f,0xa58db5a5b37f343d,0x258d35a5337fb43d,0x35a5a58db43db37f,0xb364344934493364,0x3364b449b449b364,0xb449b364b3643449,0x344933643364b449,0xa7c4b5a3b454b349,0x35a3a7c43349b454,0x35a3a7c43349b454,0x27c435a334543349
.quad 0,0,0,0,0,0,0,0,0,0,0,0,0,0,0,0
.quad 0,0,0,0,0,0,0,0,0,0,0,0,0,0,0,0
.quad 0,0,0,0,0,0,0,0,0,0,0,0,0,0,0,0
.quad 0,0,0,0,0,0,0,0,0,0,0,0,0,0,0,0
.quad 0x3400340034003400,0x3400340034003400,0xb4003400b4003400,0xb4003400b4003400,0x35a89d8e341033e0,0x9d8eb5a833e0b410,0x1d8e35a8b3e03410,0x35a89d8e341033e0,0x33c0b41f341f33c0,0xb3c0341fb41fb3c0,0x341f33c0b3c0341f,0xb41fb3c033c0b41f,0xa42ab5a7342e33a0,0x35a7a42ab3a0342e,0x35a7a42ab3a0342e,0x242a35a7b42eb3a0
.quad 0xb43db37f343d337f,0xb43db37f343d337f,0x337fb43db37f343d,0x337fb43db37f343d,0xb5a426ef344b335d,0x26ef35a4335db44b,0xa6efb5a4b35d344b,0xb5a426ef344b335d,0xb33b345a345a333b,0x333bb45ab45ab33b,0xb45ab33bb33b345a,0x345a333b333bb45a,0x28da35a034683319,0xb5a028dab3193468,0xb5a028dab3193468,0xa8dab5a0b468b319
.quad 0x3400340034003400,0x3400340034003400,0xb4003400b4003400,0xb4003400b4003400,0xb5a81d8eb410b3e0,0x1d8e35a8b3e03410,0x9d8eb5a833e0b410,0xb5a81d8eb410b3e0,0x33c0b41f341f33c0,0xb3c0341fb41fb3c0,0x341f33c0b3c0341f,0xb41fb3c033c0b41f,0x242a35a7b42eb3a0,0xb5a7242a33a0b42e,0xb5a7242a33a0b42e,0xa42ab5a7342e33a0
.quad 0xb43db37f343d337f,0xb43db37f343d337f,0x337fb43db37f343d,0x337fb43db37f343d,0x35a4a6efb44bb35d,0xa6efb5a4b35d344b,0x26ef35a4335db44b,0x35a4a6efb44bb35d,0xb33b345a345a333b,0x333bb45ab45ab33b,0xb45ab33bb33b345a,0x345a333b333bb45a,0xa8dab5a0b468b319,0x35a0a8da3319b468,0x35a0a8da3319b468,0x28da35a034683319
.quad 0,0,0,0,0,0,0,0,0,0,0,0,0,0,0,0
.quad 0,0,0,0,0,0,0,0,0,0,0,0,0,0,0,0
.quad 0,0,0,0,0,0,0,0,0,0,0,0,0,0,0,0
.quad 0,0,0,0,0,0,0,0,0,0,0,0,0,0,0,0
.quad 0x3400340034003400,0x3400340034003400,0xb4003400b4003400,0xb4003400b4003400,0x35a89eaa341333da,0x9eaab5a833dab413,0x1eaa35a8b3da3413,0x35a89eaa341333da,0x33b3b425342533b3,0xb3b33425b425b3b3,0x342533b3b3b33425,0xb425b3b333b3b425,0xa4ffb5a63437338c,0x35a6a4ffb38c3437,0x35a6a4ffb38c3437,0x24ff35a6b437b38c
.quad 0xb449b36434493364,0xb449b36434493364,0x3364b449b3643449,0x3364b449b3643449,0xb5a22829345a333b,0x282935a2333bb45a,0xa829b5a2b33b345a,0xb5a22829345a333b,0xb312346b346b3312,0x3312b46bb46bb312,0xb46bb312b312346b,0x346b33123312b46b,0x29d1359c347b32e8,0xb59c29d1b2e8347b,0xb59c29d1b2e8347b,0xa9d1b59cb47bb2e8
.quad 0x3400340034003400,0x3400340034003400,0xb4003400b4003400,0xb4003400b4003400,0xb5a81eaab413b3da,0x1eaa35a8b3da3413,0x9eaab5a833dab413,0xb5a81eaab413b3da,0x33b3b425342533b3,0xb3b33425b425b3b3,0x342533b3b3b33425,0xb425b3b333b3b425,0x24ff35a6b437b38c,0xb5a624ff338cb437,0xb5a624ff338cb437,0xa4ffb5a63437338c
.quad 0xb449b36434493364,0xb449b36434493364,0x3364b449b3643449,0x3364b449b3643449,0x35a2a829b45ab33b,0xa829b5a2b33b345a,0x282935a2333bb45a,0x35a2a829b45ab33b,0xb312346b346b3312,0x3312b46bb46bb312,0xb46bb312b312346b,0x346b33123312b46b,0xa9d1b59cb47bb2e8,0x359ca9d132e8b47b,0x359ca9d132e8b47b,0x29d1359c347b32e8
.quad 0,0,0,0,0,0,0,0,0,0,0,0,0,0,0,0
.quad 0,0,0,0,0,0,0,0,0,0,0,0,0,0,0,0
.quad 0,0,0,0,0,0,0,0,0,0,0,0,0,0,0,0
.quad 0,0,0,0,0,0,0,0,0,0,0,0,0,0,0,0
.quad 0x3400340034003400,0x3400340034003400,0xb4003400b4003400,0xb4003400b4003400,0x35a89fc6341633d4,0x9fc6b5a833d4b416,0x1fc635a8b3d43416,0x35a89fc6341633d4,0x33a6b42b342b33a6,0xb3a6342bb42bb3a6,0x342b33a6b3a6342b,0xb42bb3a633a6b42b,0xa5d4b5a534403378,0x35a5a5d4b3783440,0x35a5a5d4b3783440,0x25d435a5b440b378
.quad 0xb454b34934543349,0xb454b34934543349,0x3349b454b3493454,0x3349b454b3493454,0xb5a028da34683319,0x28da35a03319b468,0xa8dab5a0b3193468,0xb5a028da34683319,0xb2e8347b347b32e8,0x32e8b47bb47bb2e8,0xb47bb2e8b2e8347b,0x347b32e832e8b47b,0x2ac73598348e32b6,0xb5982ac7b2b6348e,0xb5982ac7b2b6348e,0xaac7b598b48eb2b6
.quad 0x3400340034003400,0x3400340034003400,0xb4003400b4003400,0xb4003400b4003400,0xb5a81fc6b416b3d4,0x1fc635a8b3d43416,0x9fc6b5a833d4b416,0xb5a81fc6b416b3d4,0x33a6b42b342b33a6,0xb3a6342bb42bb3a6,0x342b33a6b3a6342b,0xb42bb3a633a6b42b,0x25d435a5b440b378,0xb5a525d43378b440,0xb5a525d43378b440,0xa5d4b5a534403378
.quad 0xb454b34934543349,0xb454b34934543349,0x3349b454b3493454,0x3349b454b3493454,0x35a0a8dab468b319,0xa8dab5a0b3193468,0x28da35a03319b468,0x35a0a8dab468b319,0xb2e8347b347b32e8,0x32e8b47bb47bb2e8,0xb47bb2e8b2e8347b,0x347b32e832e8b47b,0xaac7b598b48eb2b6,0x3598aac732b6b48e,0x3598aac732b6b48e,0x2ac73598348e32b6
.quad 0,0,0,0,0,0,0,0,0,0,0,0,0,0,0,0
.quad 0,0,0,0,0,0,0,0,0,0,0,0,0,0,0,0
.quad 0,0,0,0,0,0,0,0,0,0,0,0,0,0,0,0
.quad 0,0,0,0,0,0,0,0,0,0,0,0,0,0,0,0
.quad 0x3400340034003400,0x3400340034003400,0xb4003400b4003400,0xb4003400b4003400,0x35a8a071341933cd,0xa071b5a833cdb419,0x207135a8b3cd3419,0x35a8a071341933cd,0x3399b43134313399,0xb3993431b431b399,0x34313399b3993431,0xb431b3993399b431,0xa6a9b5a434493364,0x35a4a6a9b3643449,0x35a4a6a9b3643449,0x26a935a4b449b364
.quad 0xb45fb32d345f332d,0xb45fb32d345f332d,0x332db45fb32d345f,0x332db45fb32d345f,0xb59d298a347632f6,0x298a359d32f6b476,0xa98ab59db2f63476,0xb59d298a347632f6,0xb2bd348b348b32bd,0x32bdb48bb48bb2bd,0xb48bb2bdb2bd348b,0x348b32bd32bdb48b,0x2bbd359334a03284,0xb5932bbdb28434a0,0xb5932bbdb28434a0,0xabbdb593b4a0b284
.quad 0x3400340034003400,0x3400340034003400,0xb4003400b4003400,0xb4003400b4003400,0xb5a82071b419b3cd,0x207135a8b3cd3419,0xa071b5a833cdb419,0xb5a82071b419b3cd,0x3399b43134313399,0xb3993431b431b399,0x34313399b3993431,0xb431b3993399b431,0x26a935a4b449b364,0xb5a426a93364b449,0xb5a426a93364b449,0xa6a9b5a434493364
.quad 0xb45fb32d345f332d,0xb45fb32d345f332d,0x332db45fb32d345f,0x332db45fb32d345f,0x359da98ab476b2f6,0xa98ab59db2f63476,0x298a359d32f6b476,0x359da98ab476b2f6,0xb2bd348b348b32bd,0x32bdb48bb48bb2bd,0xb48bb2bdb2bd348b,0x348b32bd32bdb48b,0xabbdb593b4a0b284,0x3593abbd3284b4a0,0x3593abbd3284b4a0,0x2bbd359334a03284
.quad 0,0,0,0,0,0,0,0,0,0,0,0,0,0,0,0
.quad 0,0,0,0,0,0,0,0,0,0,0,0,0,0,0,0
.quad 0,0,0,0,0,0,0,0,0,0,0,0,0,0,0,0
.quad 0,0,0,0,0,0,0,0,0,0,0,0,0,0,0,0
.quad 0x3400340034003400,0x3400340034003400,0xb4003400b4003400,0xb4003400b4003400,0x35a8a0ff341c33c7,0xa0ffb5a833c7b41c,0x20ff35a8b3c7341c,0x35a8a0ff341c33c7,0x338cb4373437338c,0xb38c3437b437b38c,0x3437338cb38c3437,0xb437b38c338cb437,0xa77db5a334513350,0x35a3a77db3503451,0x35a3a77db3503451,0x277d35a3b451b350
.quad 0xb46bb312346b3312,0xb46bb312346b3312,0x3312b46bb312346b,0x3312b46bb312346b,0xb59a2a3a348332d3,0x2a3a359a32d3b483,0xaa3ab59ab2d33483,0xb59a2a3a348332d3,0xb292349b349b3292,0x3292b49bb49bb292,0xb49bb292b292349b,0x349b32923292b49b,0x2c59358d34b23250,0xb58d2c59b25034b2,0xb58d2c59b25034b2,0xac59b58db4b2b250
.quad 0x3400340034003400,0x3400340034003400,0xb4003400b4003400,0xb4003400b4003400,0xb5a820ffb41cb3c7,0x20ff35a8b3c7341c,0xa0ffb5a833c7b41c,0xb5a820ffb41cb3c7,0x338cb4373437338c,0xb38c3437b437b38c,0x3437338cb38c3437,0xb437b38c338cb437,0x277d35a3b451b350,0xb5a3277d3350b451,0xb5a3277d3350b451,0xa77db5a334513350
.quad 0xb46bb312346b3312,0xb46bb312346b3312,0x3312b46bb312346b,0x3312b46bb312346b,0x359aaa3ab483b2d3,0xaa3ab59ab2d33483,0x2a3a359a32d3b483,0x359aaa3ab483b2d3,0xb292349b349b3292,0x3292b49bb49bb292,0xb49bb292b292349b,0x349b32923292b49b,0xac59b58db4b2b250,0x358dac593250b4b2,0x358dac593250b4b2,0x2c59358d34b23250
.quad 0,0,0,0,0,0,0,0,0,0,0,0,0,0,0,0
.quad 0,0,0,0,0,0,0,0,0,0,0,0,0,0,0,0
.quad 0,0,0,0,0,0,0,0,0,0,0,0,0,0,0,0
.quad 0,0,0,0,0,0,0,0,0,0,0,0,0,0,0,0
.quad 0x3400340034003400,0x3400340034003400,0xb4003400b4003400,0xb4003400b4003400,0x35a7a18d341f33c0,0xa18db5a733c0b41f,0x218d35a7b3c0341f,0x35a7a18d341f33c0,0x337fb43d343d337f,0xb37f343db43db37f,0x343d337fb37f343d,0xb43db37f337fb43d,0xa829b5a2345a333b,0x35a2a829b33b345a,0x35a2a829b33b345a,0x282935a2b45ab33b
.quad 0xb476b2f6347632f6,0xb476b2f6347632f6,0x32f6b476b2f63476,0x32f6b476b2f63476,0xb5972aea349032af,0x2aea359732afb490,0xaaeab597b2af3490,0xb5972aea349032af,0xb26734aa34aa3267,0x3267b4aab4aab267,0xb4aab267b26734aa,0x34aa32673267b4aa,0x2cd2358734c3321d,0xb5872cd2b21d34c3,0xb5872cd2b21d34c3,0xacd2b587b4c3b21d
.quad 0x3400340034003400,0x3400340034003400,0xb4003400b4003400,0xb4003400b4003400,0xb5a7218db41fb3c0,0x218d35a7b3c0341f,0xa18db5a733c0b41f,0xb5a7218db41fb3c0,0x337fb43d343d337f,0xb37f343db43db37f,0x343d337fb37f343d,0xb43db37f337fb43d,0x282935a2b45ab33b,0xb5a22829333bb45a,0xb5a22829333bb45a,0xa829b5a2345a333b
.quad 0xb476b2f6347632f6,0xb476b2f6347632f6,0x32f6b476b2f63476,0x32f6b476b2f63476,0x3597aaeab490b2af,0xaaeab597b2af3490,0x2aea359732afb490,0x3597aaeab490b2af,0xb26734aa34aa3267,0x3267b4aab4aab267,0xb4aab267b26734aa,0x34aa32673267b4aa,0xacd2b587b4c3b21d,0x3587acd2321db4c3,0x3587acd2321db4c3,0x2cd2358734c3321d
.quad 0,0,0,0,0,0,0,0,0,0,0,0,0,0,0,0
.quad 0,0,0,0,0,0,0,0,0,0,0,0,0,0,0,0
.quad 0,0,0,0,0,0,0,0,0,0,0,0,0,0,0,0
.quad 0,0,0,0,0,0,0,0,0,0,0,0,0,0,0,0
.quad 0x3400340034003400,0x3400340034003400,0xb4003400b4003400,0xb4003400b4003400,0x35a7a21c342233ba,0xa21cb5a733bab422,0x221c35a7b3ba3422,0x35a7a21c342233ba,0x3371b44334433371,0xb3713443b443b371,0x34433371b3713443,0xb443b3713371b443,0xa893b5a134623327,0x35a1a893b3273462,0x35a1a893b3273462,0x289335a1b462b327
.quad 0xb480b2da348032da,0xb480b2da348032da,0x32dab480b2da3480,0x32dab480b2da3480,0xb5942b9a349d328b,0x2b9a3594328bb49d,0xab9ab594b28b349d,0xb5942b9a349d328b,0xb23a34b934b9323a,0x323ab4b9b4b9b23a,0xb4b9b23ab23a34b9,0x34b9323a323ab4b9,0x2d4c358034d331e8,0xb5802d4cb1e834d3,0xb5802d4cb1e834d3,0xad4cb580b4d3b1e8
.quad 0x3400340034003400,0x3400340034003400,0xb4003400b4003400,0xb4003400b4003400,0xb5a7221cb422b3ba,0x221c35a7b3ba3422,0xa21cb5a733bab422,0xb5a7221cb422b3ba,0x3371b44334433371,0xb3713443b443b371,0x34433371b3713443,0xb443b3713371b443,0x289335a1b462b327,0xb5a128933327b462,0xb5a128933327b462,0xa893b5a134623327
.quad 0xb480b2da348032da,0xb480b2da348032da,0x32dab480b2da3480,0x32dab480b2da3480,0x3594ab9ab49db28b,0xab9ab594b28b349d,0x2b9a3594328bb49d,0x3594ab9ab49db28b,0xb23a34b934b9323a,0x323ab4b9b4b9b23a,0xb4b9b23ab23a34b9,0x34b9323a323ab4b9,0xad4cb580b4d3b1e8,0x3580ad4c31e8b4d3,0x3580ad4c31e8b4d3,0x2d4c358034d331e8
.quad 0,0,0,0,0,0,0,0,0,0,0,0,0,0,0,0
.quad 0,0,0,0,0,0,0,0,0,0,0,0,0,0,0,0
.quad 0,0,0,0,0,0,0,0,0,0,0,0,0,0,0,0
.quad 0,0,0,0,0,0,0,0,0,0,0,0,0,0,0,0
.quad 0x3400340034003400,0x3400340034003400,0xb4003400b4003400,0xb4003400b4003400,0x35a7a2aa342533b3,0xa2aab5a733b3b425,0x22aa35a7b3b33425,0x35a7a2aa342533b3,0x3364b44934493364,0xb3643449b449b364,0x34493364b3643449,0xb449b3643364b449,0xa8fdb59f346b3312,0x359fa8fdb312346b,0x359fa8fdb312346b,0x28fd359fb46bb312
.quad 0xb48bb2bd348b32bd,0xb48bb2bd348b32bd,0x32bdb48bb2bd348b,0x32bdb48bb2bd348b,0xb5902c2434aa3267,0x2c2435903267b4aa,0xac24b590b26734aa,0xb5902c2434aa3267,0xb20e34c734c7320e,0x320eb4c7b4c7b20e,0xb4c7b20eb20e34c7,0x34c7320e320eb4c7,0x2dc4357834e331b2,0xb5782dc4b1b234e3,0xb5782dc4b1b234e3,0xadc4b578b4e3b1b2
.quad 0x3400340034003400,0x3400340034003400,0xb4003400b4003400,0xb4003400b4003400,0xb5a722aab425b3b3,0x22aa35a7b3b33425,0xa2aab5a733b3b425,0xb5a722aab425b3b3,0x3364b44934493364,0xb3643449b449b364,0x34493364b3643449,0xb449b3643364b449,0x28fd359fb46bb312,0xb59f28fd3312b46b,0xb59f28fd3312b46b,0xa8fdb59f346b3312
.quad 0xb48bb2bd348b32bd,0xb48bb2bd348b32bd,0x32bdb48bb2bd348b,0x32bdb48bb2bd348b,0x3590ac24b4aab267,0xac24b590b26734aa,0x2c2435903267b4aa,0x3590ac24b4aab267,0xb20e34c734c7320e,0x320eb4c7b4c7b20e,0xb4c7b20eb20e34c7,0x34c7320e320eb4c7,0xadc4b578b4e3b1b2,0x3578adc431b2b4e3,0x3578adc431b2b4e3,0x2dc4357834e331b2
.quad 0,0,0,0,0,0,0,0,0,0,0,0,0,0,0,0
.quad 0,0,0,0,0,0,0,0,0,0,0,0,0,0,0,0
.quad 0,0,0,0,0,0,0,0,0,0,0,0,0,0,0,0
.quad 0,0,0,0,0,0,0,0,0,0,0,0,0,0,0,0
.quad 0x3400340034003400,0x3400340034003400,0xb4003400b4003400,0xb4003400b4003400,0x35a7a338342833ad,0xa338b5a733adb428,0x233835a7b3ad3428,0x35a7a338342833ad,0x3356b44e344e3356,0xb356344eb44eb356,0x344e3356b356344e,0xb44eb3563356b44e,0xa967b59e347332fd,0x359ea967b2fd3473,0x359ea967b2fd3473,0x2967359eb473b2fd
.quad 0xb496b2a1349632a1,0xb496b2a1349632a1,0x32a1b496b2a13496,0x32a1b496b2a13496,0xb58b2c7c34b73242,0x2c7c358b3242b4b7,0xac7cb58bb24234b7,0xb58b2c7c34b73242,0xb1e034d634d631e0,0x31e0b4d6b4d6b1e0,0xb4d6b1e0b1e034d6,0x34d631e031e0b4d6,0x2e3c357034f3317c,0xb5702e3cb17c34f3,0xb5702e3cb17c34f3,0xae3cb570b4f3b17c
.quad 0x3400340034003400,0x3400340034003400,0xb4003400b4003400,0xb4003400b4003400,0xb5a72338b428b3ad,0x233835a7b3ad3428,0xa338b5a733adb428,0xb5a72338b428b3ad,0x3356b44e344e3356,0xb356344eb44eb356,0x344e3356b356344e,0xb44eb3563356b44e,0x2967359eb473b2fd,0xb59e296732fdb473,0xb59e296732fdb473,0xa967b59e347332fd
.quad 0xb496b2a1349632a1,0xb496b2a1349632a1,0x32a1b496b2a13496,0x32a1b496b2a13496,0x358bac7cb4b7b242,0xac7cb58bb24234b7,0x2c7c358b3242b4b7,0x358bac7cb4b7b242,0xb1e034d634d631e0,0x31e0b4d6b4d6b1e0,0xb4d6b1e0b1e034d6,0x34d631e031e0b4d6,0xae3cb570b4f3b17c,0x3570ae3c317cb4f3,0x3570ae3c317cb4f3,0x2e3c357034f3317c
.quad 0,0,0,0,0,0,0,0,0,0,0,0,0,0,0,0
.quad 0,0,0,0,0,0,0,0,0,0,0,0,0,0,0,0
.quad 0,0,0,0,0,0,0,0,0,0,0,0,0,0,0,0
.quad 0,0,0,0,0,0,0,0,0,0,0,0,0,0,0,0
.quad 0x3400340034003400,0x3400340034003400,0xb4003400b4003400,0xb4003400b4003400,0x35a7a3c6342b33a6,0xa3c6b5a733a6b42b,0x23c635a7b3a6342b,0x35a7a3c6342b33a6,0x3349b45434543349,0xb3493454b454b349,0x34543349b3493454,0xb454b3493349b454,0xa9d1b59c347b32e8,0x359ca9d1b2e8347b,0x359ca9d1b2e8347b,0x29d1359cb47bb2e8
.quad 0xb4a0b28434a03284,0xb4a0b28434a03284,0x3284b4a0b28434a0,0x3284b4a0b28434a0,0xb5872cd234c3321d,0x2cd23587321db4c3,0xacd2b587b21d34c3,0xb5872cd234c3321d,0xb1b234e334e331b2,0x31b2b4e3b4e3b1b2,0xb4e3b1b2b1b234e3,0x34e331b231b2b4e3,0x2eb3356735013146,0xb5672eb3b1463501,0xb5672eb3b1463501,0xaeb3b567b501b146
.quad 0x3400340034003400,0x3400340034003400,0xb4003400b4003400,0xb4003400b4003400,0xb5a723c6b42bb3a6,0x23c635a7b3a6342b,0xa3c6b5a733a6b42b,0xb5a723c6b42bb3a6,0x3349b45434543349,0xb3493454b454b349,0x34543349b3493454,0xb454b3493349b454,0x29d1359cb47bb2e8,0xb59c29d132e8b47b,0xb59c29d132e8b47b,0xa9d1b59c347b32e8
.quad 0xb4a0b28434a03284,0xb4a0b28434a03284,0x3284b4a0b28434a0,0x3284b4a0b28434a0,0x3587acd2b4c3b21d,0xacd2b587b21d34c3,0x2cd23587321db4c3,0x3587acd2b4c3b21d,0xb1b234e334e331b2,0x31b2b4e3b4e3b1b2,0xb4e3b1b2b1b234e3,0x34e331b231b2b4e3,0xaeb3b567b501b146,0x3567aeb33146b501,0x3567aeb33146b501,0x2eb3356735013146
.quad 0,0,0,0,0,0,0,0,0,0,0,0,0,0,0,0
.quad 0,0,0,0,0,0,0,0,0,0,0,0,0,0,0,0
.quad 0,0,0,0,0,0,0,0,0,0,0,0,0,0,0,0
.quad 0,0,0,0,0,0,0,0,0,0,0,0,0,0,0,0
.quad 0x3400340034003400,0x3400340034003400,0xb4003400b4003400,0xb4003400b4003400,0x35a7a42a342e33a0,0xa42ab5a733a0b42e,0x242a35a7b3a0342e,0x35a7a42a342e33a0,0x333bb45a345a333b,0xb33b345ab45ab33b,0x345a333bb33b345a,0xb45ab33b333bb45a,0xaa3ab59a348332d3,0x359aaa3ab2d33483,0x359aaa3ab2d33483,0x2a3a359ab483b2d3
.quad 0xb4aab26734aa3267,0xb4aab26734aa3267,0x3267b4aab26734aa,0x3267b4aab26734aa,0xb5822d2934cf31f7,0x2d29358231f7b4cf,0xad29b582b1f734cf,0xb5822d2934cf31f7,0xb18434f034f03184,0x3184b4f0b4f0b184,0xb4f0b184b18434f0,0x34f031843184b4f0,0x2f2a355e3510310e,0xb55e2f2ab10e3510,0xb55e2f2ab10e3510,0xaf2ab55eb510b10e
.quad 0x3400340034003400,0x3400340034003400,0xb4003400b4003400,0xb4003400b4003400,0xb5a7242ab42eb3a0,0x242a35a7b3a0342e,0xa42ab5a733a0b42e,0xb5a7242ab42eb3a0,0x333bb45a345a333b,0xb33b345ab45ab33b,0x345a333bb33b345a,0xb45ab33b333bb45a,0x2a3a359ab483b2d3,0xb59a2a3a32d3b483,0xb59a2a3a32d3b483,0xaa3ab59a348332d3
.quad 0xb4aab26734aa3267,0xb4aab26734aa3267,0x3267b4aab26734aa,0x3267b4aab26734aa,0x3582ad29b4cfb1f7,0xad29b582b1f734cf,0x2d29358231f7b4cf,0x3582ad29b4cfb1f7,0xb18434f034f03184,0x3184b4f0b4f0b184,0xb4f0b184b18434f0,0x34f031843184b4f0,0xaf2ab55eb510b10e,0x355eaf2a310eb510,0x355eaf2a310eb510,0x2f2a355e3510310e
.quad 0,0,0,0,0,0,0,0,0,0,0,0,0,0,0,0
.quad 0,0,0,0,0,0,0,0,0,0,0,0,0,0,0,0
.quad 0,0,0,0,0,0,0,0,0,0,0,0,0,0,0,0
.quad 0,0,0,0,0,0,0,0,0,0,0,0,0,0,0,0
.quad 0x3400340034003400,0x3400340034003400,0xb4003400b4003400,0xb4003400b4003400,0x35a6a47134313399,0xa471b5a63399b431,0x247135a6b3993431,0x35a6a47134313399,0x332db45f345f332d,0xb32d345fb45fb32d,0x345f332db32d345f,0xb45fb32d332db45f,0xaaa4b598348b32bd,0x3598aaa4b2bd348b,0x3598aaa4b2bd348b,0x2aa43598b48bb2bd
.quad 0xb4b4b24934b43249,0xb4b4b24934b43249,0x3249b4b4b24934b4,0x3249b4b4b24934b4,0xb57d2d7f34da31d1,0x2d7f357d31d1b4da,0xad7fb57db1d134da,0xb57d2d7f34da31d1,0xb15534fd34fd3155,0x3155b4fdb4fdb155,0xb4fdb155b15534fd,0x34fd31553155b4fd,0x2f9f3554351d30d6,0xb5542f9fb0d6351d,0xb5542f9fb0d6351d,0xaf9fb554b51db0d6
.quad 0x3400340034003400,0x3400340034003400,0xb4003400b4003400,0xb4003400b4003400,0xb5a62471b431b399,0x247135a6b3993431,0xa471b5a63399b431,0xb5a62471b431b399,0x332db45f345f332d,0xb32d345fb45fb32d,0x345f332db32d345f,0xb45fb32d332db45f,0x2aa43598b48bb2bd,0xb5982aa432bdb48b,0xb5982aa432bdb48b,0xaaa4b598348b32bd
.quad 0xb4b4b24934b43249,0xb4b4b24934b43249,0x3249b4b4b24934b4,0x3249b4b4b24934b4,0x357dad7fb4dab1d1,0xad7fb57db1d134da,0x2d7f357d31d1b4da,0x357dad7fb4dab1d1,0xb15534fd34fd3155,0x3155b4fdb4fdb155,0xb4fdb155b15534fd,0x34fd31553155b4fd,0xaf9fb554b51db0d6,0x3554af9f30d6b51d,0x3554af9f30d6b51d,0x2f9f3554351d30d6
.quad 0,0,0,0,0,0,0,0,0,0,0,0,0,0,0,0
.quad 0,0,0,0,0,0,0,0,0,0,0,0,0,0,0,0
.quad 0,0,0,0,0,0,0,0,0,0,0,0,0,0,0,0
.quad 0,0,0,0,0,0,0,0,0,0,0,0,0,0,0,0
.quad 0x3400340034003400,0x3400340034003400,0xb4003400b4003400,0xb4003400b4003400,0x35a6a4b834343392,0xa4b8b5a63392b434,0x24b835a6b3923434,0x35a6a4b834343392,0x3320b46534653320,0xb3203465b465b320,0x34653320b3203465,0xb465b3203320b465,0xab0db596349332a8,0x3596ab0db2a83493,0x3596ab0db2a83493,0x2b0d3596b493b2a8
.quad 0xb4beb22b34be322b,0xb4beb22b34be322b,0x322bb4beb22b34be,0x322bb4beb22b34be,0xb5772dd634e531ab,0x2dd6357731abb4e5,0xadd6b577b1ab34e5,0xb5772dd634e531ab,0xb126350a350a3126,0x3126b50ab50ab126,0xb50ab126b126350a,0x350a31263126b50a,0x300a3549352a309e,0xb549300ab09e352a,0xb549300ab09e352a,0xb00ab549b52ab09e
.quad 0x3400340034003400,0x3400340034003400,0xb4003400b4003400,0xb4003400b4003400,0xb5a624b8b434b392,0x24b835a6b3923434,0xa4b8b5a63392b434,0xb5a624b8b434b392,0x3320b46534653320,0xb3203465b465b320,0x34653320b3203465,0xb465b3203320b465,0x2b0d3596b493b2a8,0xb5962b0d32a8b493,0xb5962b0d32a8b493,0xab0db596349332a8
.quad 0xb4beb22b34be322b,0xb4beb22b34be322b,0x322bb4beb22b34be,0x322bb4beb22b34be,0x3577add6b4e5b1ab,0xadd6b577b1ab34e5,0x2dd6357731abb4e5,0x3577add6b4e5b1ab,0xb126350a350a3126,0x3126b50ab50ab126,0xb50ab126b126350a,0x350a31263126b50a,0xb00ab549b52ab09e,0x3549b00a309eb52a,0x3549b00a309eb52a,0x300a3549352a309e
.quad 0,0,0,0,0,0,0,0,0,0,0,0,0,0,0,0
.quad 0,0,0,0,0,0,0,0,0,0,0,0,0,0,0,0
.quad 0,0,0,0,0,0,0,0,0,0,0,0,0,0,0,0
.quad 0,0,0,0,0,0,0,0,0,0,0,0,0,0,0,0
.quad 0x3400340034003400,0x3400340034003400,0xb4003400b4003400,0xb4003400b4003400,0x35a6a4ff3437338c,0xa4ffb5a6338cb437,0x24ff35a6b38c3437,0x35a6a4ff3437338c,0x3312b46b346b3312,0xb312346bb46bb312,0x346b3312b312346b,0xb46bb3123312b46b,0xab77b594349b3292,0x3594ab77b292349b,0x3594ab77b292349b,0x2b773594b49bb292
.quad 0xb4c7b20e34c7320e,0xb4c7b20e34c7320e,0x320eb4c7b20e34c7,0x320eb4c7b20e34c7,0xb5712e2b34f03184,0x2e2b35713184b4f0,0xae2bb571b18434f0,0xb5712e2b34f03184,0xb0f63515351530f6,0x30f6b515b515b0f6,0xb515b0f6b0f63515,0x351530f630f6b515,0x3044353d35363065,0xb53d3044b0653536,0xb53d3044b0653536,0xb044b53db536b065
.quad 0x3400340034003400,0x3400340034003400,0xb4003400b4003400,0xb4003400b4003400,0xb5a624ffb437b38c,0x24ff35a6b38c3437,0xa4ffb5a6338cb437,0xb5a624ffb437b38c,0x3312b46b346b3312,0xb312346bb46bb312,0x346b3312b312346b,0xb46bb3123312b46b,0x2b773594b49bb292,0xb5942b773292b49b,0xb5942b773292b49b,0xab77b594349b3292
.quad 0xb4c7b20e34c7320e,0xb4c7b20e34c7320e,0x320eb4c7b20e34c7,0x320eb4c7b20e34c7,0x3571ae2bb4f0b184,0xae2bb571b18434f0,0x2e2b35713184b4f0,0x3571ae2bb4f0b184,0xb0f63515351530f6,0x30f6b515b515b0f6,0xb515b0f6b0f63515,0x351530f630f6b515,0xb044b53db536b065,0x353db0443065b536,0x353db0443065b536,0x3044353d35363065
.quad 0,0,0,0,0,0,0,0,0,0,0,0,0,0,0,0
.quad 0,0,0,0,0,0,0,0,0,0,0,0,0,0,0,0
.quad 0,0,0,0,0,0,0,0,0,0,0,0,0,0,0,0
.quad 0,0,0,0,0,0,0,0,0,0,0,0,0,0,0,0
.quad 0x3400340034003400,0x3400340034003400,0xb4003400b4003400,0xb4003400b4003400,0x35a6a546343a3385,0xa546b5a63385b43a,0x254635a6b385343a,0x35a6a546343a3385,0x3304b47034703304,0xb3043470b470b304,0x34703304b3043470,0xb470b3043304b470,0xabe0b59234a3327c,0x3592abe0b27c34a3,0x3592abe0b27c34a3,0x2be03592b4a3b27c
.quad 0xb4d1b1ef34d131ef,0xb4d1b1ef34d131ef,0x31efb4d1b1ef34d1,0x31efb4d1b1ef34d1,0xb56b2e8034fb315d,0x2e80356b315db4fb,0xae80b56bb15d34fb,0xb56b2e8034fb315d,0xb0c63521352130c6,0x30c6b521b521b0c6,0xb521b0c6b0c63521,0x352130c630c6b521,0x307d35313542302b,0xb531307db02b3542,0xb531307db02b3542,0xb07db531b542b02b
.quad 0x3400340034003400,0x3400340034003400,0xb4003400b4003400,0xb4003400b4003400,0xb5a62546b43ab385,0x254635a6b385343a,0xa546b5a63385b43a,0xb5a62546b43ab385,0x3304b47034703304,0xb3043470b470b304,0x34703304b3043470,0xb470b3043304b470,0x2be03592b4a3b27c,0xb5922be0327cb4a3,0xb5922be0327cb4a3,0xabe0b59234a3327c
.quad 0xb4d1b1ef34d131ef,0xb4d1b1ef34d131ef,0x31efb4d1b1ef34d1,0x31efb4d1b1ef34d1,0x356bae80b4fbb15d,0xae80b56bb15d34fb,0x2e80356b315db4fb,0x356bae80b4fbb15d,0xb0c63521352130c6,0x30c6b521b521b0c6,0xb521b0c6b0c63521,0x352130c630c6b521,0xb07db531b542b02b,0x3531b07d302bb542,0x3531b07d302bb542,0x307d35313542302b
.quad 0,0,0,0,0,0,0,0,0,0,0,0,0,0,0,0
.quad 0,0,0,0,0,0,0,0,0,0,0,0,0,0,0,0
.quad 0,0,0,0,0,0,0,0,0,0,0,0,0,0,0,0
.quad 0,0,0,0,0,0,0,0,0,0,0,0,0,0,0,0
.quad 0x3400340034003400,0x3400340034003400,0xb4003400b4003400,0xb4003400b4003400,0x35a5a58d343d337f,0xa58db5a5337fb43d,0x258d35a5b37f343d,0x35a5a58d343d337f,0x32f6b476347632f6,0xb2f63476b476b2f6,0x347632f6b2f63476,0xb476b2f632f6b476,0xac24b59034aa3267,0x3590ac24b26734aa,0x3590ac24b26734aa,0x2c243590b4aab267
.quad 0xb4dab1d134da31d1,0xb4dab1d134da31d1,0x31d1b4dab1d134da,0x31d1b4dab1d134da,0xb5652ed535053136,0x2ed535653136b505,0xaed5b565b1363505,0xb5652ed535053136,0xb096352c352c3096,0x3096b52cb52cb096,0xb52cb096b096352c,0x352c30963096b52c,0x30b63525354d2fe2,0xb52530b6afe2354d,0xb52530b6afe2354d,0xb0b6b525b54dafe2
.quad 0x3400340034003400,0x3400340034003400,0xb4003400b4003400,0xb4003400b4003400,0xb5a5258db43db37f,0x258d35a5b37f343d,0xa58db5a5337fb43d,0xb5a5258db43db37f,0x32f6b476347632f6,0xb2f63476b476b2f6,0x347632f6b2f63476,0xb476b2f632f6b476,0x2c243590b4aab267,0xb5902c243267b4aa,0xb5902c243267b4aa,0xac24b59034aa3267
.quad 0xb4dab1d134da31d1,0xb4dab1d134da31d1,0x31d1b4dab1d134da,0x31d1b4dab1d134da,0x3565aed5b505b136,0xaed5b565b1363505,0x2ed535653136b505,0x3565aed5b505b136,0xb096352c352c3096,0x3096b52cb52cb096,0xb52cb096b096352c,0x352c30963096b52c,0xb0b6b525b54dafe2,0x3525b0b62fe2b54d,0x3525b0b62fe2b54d,0x30b63525354d2fe2
.quad 0,0,0,0,0,0,0,0,0,0,0,0,0,0,0,0
.quad 0,0,0,0,0,0,0,0,0,0,0,0,0,0,0,0
.quad 0,0,0,0,0,0,0,0,0,0,0,0,0,0,0,0
.quad 0,0,0,0,0,0,0,0,0,0,0,0,0,0,0,0
.quad 0x3400340034003400,0x3400340034003400,0xb4003400b4003400,0xb4003400b4003400,0x35a5a5d434403378,0xa5d4b5a53378b440,0x25d435a5b3783440,0x35a5a5d434403378,0x32e8b47b347b32e8,0xb2e8347bb47bb2e8,0x347b32e8b2e8347b,0xb47bb2e832e8b47b,0xac59b58d34b23250,0x358dac59b25034b2,0x358dac59b25034b2,0x2c59358db4b2b250
.quad 0xb4e3b1b234e331b2,0xb4e3b1b234e331b2,0x31b2b4e3b1b234e3,0x31b2b4e3b1b234e3,0xb55e2f2a3510310e,0x2f2a355e310eb510,0xaf2ab55eb10e3510,0xb55e2f2a3510310e,0xb065353635363065,0x3065b536b536b065,0xb536b065b0653536,0x353630653065b536,0x30ee351735582f6d,0xb51730eeaf6d3558,0xb51730eeaf6d3558,0xb0eeb517b558af6d
.quad 0x3400340034003400,0x3400340034003400,0xb4003400b4003400,0xb4003400b4003400,0xb5a525d4b440b378,0x25d435a5b3783440,0xa5d4b5a53378b440,0xb5a525d4b440b378,0x32e8b47b347b32e8,0xb2e8347bb47bb2e8,0x347b32e8b2e8347b,0xb47bb2e832e8b47b,0x2c59358db4b2b250,0xb58d2c593250b4b2,0xb58d2c593250b4b2,0xac59b58d34b23250
.quad 0xb4e3b1b234e331b2,0xb4e3b1b234e331b2,0x31b2b4e3b1b234e3,0x31b2b4e3b1b234e3,0x355eaf2ab510b10e,0xaf2ab55eb10e3510,0x2f2a355e310eb510,0x355eaf2ab510b10e,0xb065353635363065,0x3065b536b536b065,0xb536b065b0653536,0x353630653065b536,0xb0eeb517b558af6d,0x3517b0ee2f6db558,0x3517b0ee2f6db558,0x30ee351735582f6d
.quad 0,0,0,0,0,0,0,0,0,0,0,0,0,0,0,0
.quad 0,0,0,0,0,0,0,0,0,0,0,0,0,0,0,0
.quad 0,0,0,0,0,0,0,0,0,0,0,0,0,0,0,0
.quad 0,0,0,0,0,0,0,0,0,0,0,0,0,0,0,0
.quad 0x3400340034003400,0x3400340034003400,0xb4003400b4003400,0xb4003400b4003400,0x35a5a61b34433371,0xa61bb5a53371b443,0x261b35a5b3713443,0x35a5a61b34433371,0x32dab480348032da,0xb2da3480b480b2da,0x348032dab2da3480,0xb480b2da32dab480,0xac8db58b34b9323a,0x358bac8db23a34b9,0x358bac8db23a34b9,0x2c8d358bb4b9b23a
.quad 0xb4ecb19434ec3194,0xb4ecb19434ec3194,0x3194b4ecb19434ec,0x3194b4ecb19434ec,0xb5562f7e351930e6,0x2f7e355630e6b519,0xaf7eb556b0e63519,0xb5562f7e351930e6,0xb033354135413033,0x3033b541b541b033,0xb541b033b0333541,0x354130333033b541,0x3126350a35622ef7,0xb50a3126aef73562,0xb50a3126aef73562,0xb126b50ab562aef7
.quad 0x3400340034003400,0x3400340034003400,0xb4003400b4003400,0xb4003400b4003400,0xb5a5261bb443b371,0x261b35a5b3713443,0xa61bb5a53371b443,0xb5a5261bb443b371,0x32dab480348032da,0xb2da3480b480b2da,0x348032dab2da3480,0xb480b2da32dab480,0x2c8d358bb4b9b23a,0xb58b2c8d323ab4b9,0xb58b2c8d323ab4b9,0xac8db58b34b9323a
.quad 0xb4ecb19434ec3194,0xb4ecb19434ec3194,0x3194b4ecb19434ec,0x3194b4ecb19434ec,0x3556af7eb519b0e6,0xaf7eb556b0e63519,0x2f7e355630e6b519,0x3556af7eb519b0e6,0xb033354135413033,0x3033b541b541b033,0xb541b033b0333541,0x354130333033b541,0xb126b50ab562aef7,0x350ab1262ef7b562,0x350ab1262ef7b562,0x3126350a35622ef7
.quad 0,0,0,0,0,0,0,0,0,0,0,0,0,0,0,0
.quad 0,0,0,0,0,0,0,0,0,0,0,0,0,0,0,0
.quad 0,0,0,0,0,0,0,0,0,0,0,0,0,0,0,0
.quad 0,0,0,0,0,0,0,0,0,0,0,0,0,0,0,0
.quad 0x3400340034003400,0x3400340034003400,0xb4003400b4003400,0xb4003400b4003400,0x35a5a6623446336b,0xa662b5a5336bb446,0x266235a5b36b3446,0x35a5a6623446336b,0x32ccb486348632cc,0xb2cc3486b486b2cc,0x348632ccb2cc3486,0xb486b2cc32ccb486,0xacc1b58834c03224,0x3588acc1b22434c0,0x3588acc1b22434c0,0x2cc13588b4c0b224
.quad 0xb4f5b17534f53175,0xb4f5b17534f53175,0x3175b4f5b17534f5,0x3175b4f5b17534f5,0xb54f2fd2352330be,0x2fd2354f30beb523,0xafd2b54fb0be3523,0xb54f2fd2352330be,0xb002354a354a3002,0x3002b54ab54ab002,0xb54ab002b002354a,0x354a30023002b54a,0x315d34fb356b2e80,0xb4fb315dae80356b,0xb4fb315dae80356b,0xb15db4fbb56bae80
.quad 0x3400340034003400,0x3400340034003400,0xb4003400b4003400,0xb4003400b4003400,0xb5a52662b446b36b,0x266235a5b36b3446,0xa662b5a5336bb446,0xb5a52662b446b36b,0x32ccb486348632cc,0xb2cc3486b486b2cc,0x348632ccb2cc3486,0xb486b2cc32ccb486,0x2cc13588b4c0b224,0xb5882cc13224b4c0,0xb5882cc13224b4c0,0xacc1b58834c03224
.quad 0xb4f5b17534f53175,0xb4f5b17534f53175,0x3175b4f5b17534f5,0x3175b4f5b17534f5,0x354fafd2b523b0be,0xafd2b54fb0be3523,0x2fd2354f30beb523,0x354fafd2b523b0be,0xb002354a354a3002,0x3002b54ab54ab002,0xb54ab002b002354a,0x354a30023002b54a,0xb15db4fbb56bae80,0x34fbb15d2e80b56b,0x34fbb15d2e80b56b,0x315d34fb356b2e80
.quad 0,0,0,0,0,0,0,0,0,0,0,0,0,0,0,0
.quad 0,0,0,0,0,0,0,0,0,0,0,0,0,0,0,0
.quad 0,0,0,0,0,0,0,0,0,0,0,0,0,0,0,0
.quad 0,0,0,0,0,0,0,0,0,0,0,0,0,0,0,0
.quad 0x3400340034003400,0x3400340034003400,0xb4003400b4003400,0xb4003400b4003400,0x35a4a6a934493364,0xa6a9b5a43364b449,0x26a935a4b3643449,0x35a4a6a934493364,0x32bdb48b348b32bd,0xb2bd348bb48bb2bd,0x348b32bdb2bd348b,0xb48bb2bd32bdb48b,0xacf5b58534c7320e,0x3585acf5b20e34c7,0x3585acf5b20e34c7,0x2cf53585b4c7b20e
.quad 0xb4fdb15534fd3155,0xb4fdb15534fd3155,0x3155b4fdb15534fd,0x3155b4fdb15534fd,0xb5473012352c3096,0x301235473096b52c,0xb012b547b096352c,0xb5473012352c3096,0xaf9f355435542f9f,0x2f9fb554b554af9f,0xb554af9faf9f3554,0x35542f9f2f9fb554,0x319434ec35742e09,0xb4ec3194ae093574,0xb4ec3194ae093574,0xb194b4ecb574ae09
.quad 0x3400340034003400,0x3400340034003400,0xb4003400b4003400,0xb4003400b4003400,0xb5a426a9b449b364,0x26a935a4b3643449,0xa6a9b5a43364b449,0xb5a426a9b449b364,0x32bdb48b348b32bd,0xb2bd348bb48bb2bd,0x348b32bdb2bd348b,0xb48bb2bd32bdb48b,0x2cf53585b4c7b20e,0xb5852cf5320eb4c7,0xb5852cf5320eb4c7,0xacf5b58534c7320e
.quad 0xb4fdb15534fd3155,0xb4fdb15534fd3155,0x3155b4fdb15534fd,0x3155b4fdb15534fd,0x3547b012b52cb096,0xb012b547b096352c,0x301235473096b52c,0x3547b012b52cb096,0xaf9f355435542f9f,0x2f9fb554b554af9f,0xb554af9faf9f3554,0x35542f9f2f9fb554,0xb194b4ecb574ae09,0x34ecb1942e09b574,0x34ecb1942e09b574,0x319434ec35742e09
.quad 0,0,0,0,0,0,0,0,0,0,0,0,0,0,0,0
.quad 0,0,0,0,0,0,0,0,0,0,0,0,0,0,0,0
.quad 0,0,0,0,0,0,0,0,0,0,0,0,0,0,0,0
.quad 0,0,0,0,0,0,0,0,0,0,0,0,0,0,0,0
.quad 0x3400340034003400,0x3400340034003400,0xb4003400b4003400,0xb4003400b4003400,0x35a4a6ef344b335d,0xa6efb5a4335db44b,0x26ef35a4b35d344b,0x35a4a6ef344b335d,0x32afb490349032af,0xb2af3490b490b2af,0x349032afb2af3490,0xb490b2af32afb490,0xad29b58234cf31f7,0x3582ad29b1f734cf,0x3582ad29b1f734cf,0x2d293582b4cfb1f7
.quad 0xb505b13635053136,0xb505b13635053136,0x3136b505b1363505,0x3136b505b1363505,0xb53f303c3535306d,0x303c353f306db535,0xb03cb53fb06d3535,0xb53f303c3535306d,0xaf3b355c355c2f3b,0x2f3bb55cb55caf3b,0xb55caf3baf3b355c,0x355c2f3b2f3bb55c,0x31c934dc357c2d91,0xb4dc31c9ad91357c,0xb4dc31c9ad91357c,0xb1c9b4dcb57cad91
.quad 0x3400340034003400,0x3400340034003400,0xb4003400b4003400,0xb4003400b4003400,0xb5a426efb44bb35d,0x26ef35a4b35d344b,0xa6efb5a4335db44b,0xb5a426efb44bb35d,0x32afb490349032af,0xb2af3490b490b2af,0x349032afb2af3490,0xb490b2af32afb490,0x2d293582b4cfb1f7,0xb5822d2931f7b4cf,0xb5822d2931f7b4cf,0xad29b58234cf31f7
.quad 0xb505b13635053136,0xb505b13635053136,0x3136b505b1363505,0x3136b505b1363505,0x353fb03cb535b06d,0xb03cb53fb06d3535,0x303c353f306db535,0x353fb03cb535b06d,0xaf3b355c355c2f3b,0x2f3bb55cb55caf3b,0xb55caf3baf3b355c,0x355c2f3b2f3bb55c,0xb1c9b4dcb57cad91,0x34dcb1c92d91b57c,0x34dcb1c92d91b57c,0x31c934dc357c2d91
.quad 0,0,0,0,0,0,0,0,0,0,0,0,0,0,0,0
.quad 0,0,0,0,0,0,0,0,0,0,0,0,0,0,0,0
.quad 0,0,0,0,0,0,0,0,0,0,0,0,0,0,0,0
.quad 0,0,0,0,0,0,0,0,0,0,0,0,0,0,0,0
.quad 0x3400340034003400,0x3400340034003400,0xb4003400b4003400,0xb4003400b4003400,0x35a4a736344e3356,0xa736b5a43356b44e,0x273635a4b356344e,0x35a4a736344e3356,0x32a1b496349632a1,0xb2a13496b496b2a1,0x349632a1b2a13496,0xb496b2a132a1b496,0xad5db57f34d631e0,0x357fad5db1e034d6,0x357fad5db1e034d6,0x2d5d357fb4d6b1e0
.quad 0xb50eb116350e3116,0xb50eb116350e3116,0x3116b50eb116350e,0x3116b50eb116350e,0xb5363065353d3044,0x306535363044b53d,0xb065b536b044353d,0xb5363065353d3044,0xaed5356535652ed5,0x2ed5b565b565aed5,0xb565aed5aed53565,0x35652ed52ed5b565,0x31fe34cc35832d18,0xb4cc31fead183583,0xb4cc31fead183583,0xb1feb4ccb583ad18
.quad 0x3400340034003400,0x3400340034003400,0xb4003400b4003400,0xb4003400b4003400,0xb5a42736b44eb356,0x273635a4b356344e,0xa736b5a43356b44e,0xb5a42736b44eb356,0x32a1b496349632a1,0xb2a13496b496b2a1,0x349632a1b2a13496,0xb496b2a132a1b496,0x2d5d357fb4d6b1e0,0xb57f2d5d31e0b4d6,0xb57f2d5d31e0b4d6,0xad5db57f34d631e0
.quad 0xb50eb116350e3116,0xb50eb116350e3116,0x3116b50eb116350e,0x3116b50eb116350e,0x3536b065b53db044,0xb065b536b044353d,0x306535363044b53d,0x3536b065b53db044,0xaed5356535652ed5,0x2ed5b565b565aed5,0xb565aed5aed53565,0x35652ed52ed5b565,0xb1feb4ccb583ad18,0x34ccb1fe2d18b583,0x34ccb1fe2d18b583,0x31fe34cc35832d18
.quad 0,0,0,0,0,0,0,0,0,0,0,0,0,0,0,0
.quad 0,0,0,0,0,0,0,0,0,0,0,0,0,0,0,0
.quad 0,0,0,0,0,0,0,0,0,0,0,0,0,0,0,0
.quad 0,0,0,0,0,0,0,0,0,0,0,0,0,0,0,0
.quad 0x3400340034003400,0x3400340034003400,0xb4003400b4003400,0xb4003400b4003400,0x35a3a77d34513350,0xa77db5a33350b451,0x277d35a3b3503451,0x35a3a77d34513350,0x3292b49b349b3292,0xb292349bb49bb292,0x349b3292b292349b,0xb49bb2923292b49b,0xad91b57c34dc31c9,0x357cad91b1c934dc,0x357cad91b1c934dc,0x2d91357cb4dcb1c9
.quad 0xb515b0f6351530f6,0xb515b0f6351530f6,0x30f6b515b0f63515,0x30f6b515b0f63515,0xb52e308e3546301b,0x308e352e301bb546,0xb08eb52eb01b3546,0xb52e308e3546301b,0xae6f356c356c2e6f,0x2e6fb56cb56cae6f,0xb56cae6fae6f356c,0x356c2e6f2e6fb56c,0x323334bb358a2c9e,0xb4bb3233ac9e358a,0xb4bb3233ac9e358a,0xb233b4bbb58aac9e
.quad 0x3400340034003400,0x3400340034003400,0xb4003400b4003400,0xb4003400b4003400,0xb5a3277db451b350,0x277d35a3b3503451,0xa77db5a33350b451,0xb5a3277db451b350,0x3292b49b349b3292,0xb292349bb49bb292,0x349b3292b292349b,0xb49bb2923292b49b,0x2d91357cb4dcb1c9,0xb57c2d9131c9b4dc,0xb57c2d9131c9b4dc,0xad91b57c34dc31c9
.quad 0xb515b0f6351530f6,0xb515b0f6351530f6,0x30f6b515b0f63515,0x30f6b515b0f63515,0x352eb08eb546b01b,0xb08eb52eb01b3546,0x308e352e301bb546,0x352eb08eb546b01b,0xae6f356c356c2e6f,0x2e6fb56cb56cae6f,0xb56cae6fae6f356c,0x356c2e6f2e6fb56c,0xb233b4bbb58aac9e,0x34bbb2332c9eb58a,0x34bbb2332c9eb58a,0x323334bb358a2c9e
.quad 0,0,0,0,0,0,0,0,0,0,0,0,0,0,0,0
.quad 0,0,0,0,0,0,0,0,0,0,0,0,0,0,0,0
.quad 0,0,0,0,0,0,0,0,0,0,0,0,0,0,0,0
.quad 0,0,0,0,0,0,0,0,0,0,0,0,0,0,0,0
.quad 0x3400340034003400,0x3400340034003400,0xb4003400b4003400,0xb4003400b4003400,0x35a3a7c434543349,0xa7c4b5a33349b454,0x27c435a3b3493454,0x35a3a7c434543349,0x3284b4a034a03284,0xb28434a0b4a0b284,0x34a03284b28434a0,0xb4a0b2843284b4a0,0xadc4b57834e331b2,0x3578adc4b1b234e3,0x3578adc4b1b234e3,0x2dc43578b4e3b1b2
.quad 0xb51db0d6351d30d6,0xb51db0d6351d30d6,0x30d6b51db0d6351d,0x30d6b51db0d6351d,0xb52530b6354d2fe2,0x30b635252fe2b54d,0xb0b6b525afe2354d,0xb52530b6354d2fe2,0xae09357435742e09,0x2e09b574b574ae09,0xb574ae09ae093574,0x35742e092e09b574,0x326734aa35902c24,0xb4aa3267ac243590,0xb4aa3267ac243590,0xb267b4aab590ac24
.quad 0x3400340034003400,0x3400340034003400,0xb4003400b4003400,0xb4003400b4003400,0xb5a327c4b454b349,0x27c435a3b3493454,0xa7c4b5a33349b454,0xb5a327c4b454b349,0x3284b4a034a03284,0xb28434a0b4a0b284,0x34a03284b28434a0,0xb4a0b2843284b4a0,0x2dc43578b4e3b1b2,0xb5782dc431b2b4e3,0xb5782dc431b2b4e3,0xadc4b57834e331b2
.quad 0xb51db0d6351d30d6,0xb51db0d6351d30d6,0x30d6b51db0d6351d,0x30d6b51db0d6351d,0x3525b0b6b54dafe2,0xb0b6b525afe2354d,0x30b635252fe2b54d,0x3525b0b6b54dafe2,0xae09357435742e09,0x2e09b574b574ae09,0xb574ae09ae093574,0x35742e092e09b574,0xb267b4aab590ac24,0x34aab2672c24b590,0x34aab2672c24b590,0x326734aa35902c24
.quad 0,0,0,0,0,0,0,0,0,0,0,0,0,0,0,0
.quad 0,0,0,0,0,0,0,0,0,0,0,0,0,0,0,0
.quad 0,0,0,0,0,0,0,0,0,0,0,0,0,0,0,0
.quad 0,0,0,0,0,0,0,0,0,0,0,0,0,0,0,0
.quad 0x3400340034003400,0x3400340034003400,0xb4003400b4003400,0xb4003400b4003400,0x35a2a80534573342,0xa805b5a23342b457,0x280535a2b3423457,0x35a2a80534573342,0x3275b4a534a53275,0xb27534a5b4a5b275,0x34a53275b27534a5,0xb4a5b2753275b4a5,0xadf8b57534ea319b,0x3575adf8b19b34ea,0x3575adf8b19b34ea,0x2df83575b4eab19b
.quad 0xb525b0b6352530b6,0xb525b0b6352530b6,0x30b6b525b0b63525,0x30b6b525b0b63525,0xb51b30de35552f8f,0x30de351b2f8fb555,0xb0deb51baf8f3555,0xb51b30de35552f8f,0xada2357b357b2da2,0x2da2b57bb57bada2,0xb57bada2ada2357b,0x357b2da22da2b57b,0x3299349835952b53,0xb4983299ab533595,0xb4983299ab533595,0xb299b498b595ab53
.quad 0x3400340034003400,0x3400340034003400,0xb4003400b4003400,0xb4003400b4003400,0xb5a22805b457b342,0x280535a2b3423457,0xa805b5a23342b457,0xb5a22805b457b342,0x3275b4a534a53275,0xb27534a5b4a5b275,0x34a53275b27534a5,0xb4a5b2753275b4a5,0x2df83575b4eab19b,0xb5752df8319bb4ea,0xb5752df8319bb4ea,0xadf8b57534ea319b
.quad 0xb525b0b6352530b6,0xb525b0b6352530b6,0x30b6b525b0b63525,0x30b6b525b0b63525,0x351bb0deb555af8f,0xb0deb51baf8f3555,0x30de351b2f8fb555,0x351bb0deb555af8f,0xada2357b357b2da2,0x2da2b57bb57bada2,0xb57bada2ada2357b,0x357b2da22da2b57b,0xb299b498b595ab53,0x3498b2992b53b595,0x3498b2992b53b595,0x3299349835952b53
.quad 0,0,0,0,0,0,0,0,0,0,0,0,0,0,0,0
.quad 0,0,0,0,0,0,0,0,0,0,0,0,0,0,0,0
.quad 0,0,0,0,0,0,0,0,0,0,0,0,0,0,0,0
.quad 0,0,0,0,0,0,0,0,0,0,0,0,0,0,0,0
.quad 0x3400340034003400,0x3400340034003400,0xb4003400b4003400,0xb4003400b4003400,0x35a2a829345a333b,0xa829b5a2333bb45a,0x282935a2b33b345a,0x35a2a829345a333b,0x3267b4aa34aa3267,0xb26734aab4aab267,0x34aa3267b26734aa,0xb4aab2673267b4aa,0xae2bb57134f03184,0x3571ae2bb18434f0,0x3571ae2bb18434f0,0x2e2b3571b4f0b184
.quad 0xb52cb096352c3096,0xb52cb096352c3096,0x3096b52cb096352c,0x3096b52cb096352c,0xb5113106355c2f3b,0x310635112f3bb55c,0xb106b511af3b355c,0xb5113106355c2f3b,0xad3a358135812d3a,0x2d3ab581b581ad3a,0xb581ad3aad3a3581,0x35812d3a2d3ab581,0x32cc3486359a2a5e,0xb48632ccaa5e359a,0xb48632ccaa5e359a,0xb2ccb486b59aaa5e
.quad 0x3400340034003400,0x3400340034003400,0xb4003400b4003400,0xb4003400b4003400,0xb5a22829b45ab33b,0x282935a2b33b345a,0xa829b5a2333bb45a,0xb5a22829b45ab33b,0x3267b4aa34aa3267,0xb26734aab4aab267,0x34aa3267b26734aa,0xb4aab2673267b4aa,0x2e2b3571b4f0b184,0xb5712e2b3184b4f0,0xb5712e2b3184b4f0,0xae2bb57134f03184
.quad 0xb52cb096352c3096,0xb52cb096352c3096,0x3096b52cb096352c,0x3096b52cb096352c,0x3511b106b55caf3b,0xb106b511af3b355c,0x310635112f3bb55c,0x3511b106b55caf3b,0xad3a358135812d3a,0x2d3ab581b581ad3a,0xb581ad3aad3a3581,0x35812d3a2d3ab581,0xb2ccb486b59aaa5e,0x3486b2cc2a5eb59a,0x3486b2cc2a5eb59a,0x32cc3486359a2a5e
.quad 0,0,0,0,0,0,0,0,0,0,0,0,0,0,0,0
.quad 0,0,0,0,0,0,0,0,0,0,0,0,0,0,0,0
.quad 0,0,0,0,0,0,0,0,0,0,0,0,0,0,0,0
.quad 0,0,0,0,0,0,0,0,0,0,0,0,0,0,0,0
.quad 0x3400340034003400,0x3400340034003400,0xb4003400b4003400,0xb4003400b4003400,0x35a2a84c345d3334,0xa84cb5a23334b45d,0x284c35a2b334345d,0x35a2a84c345d3334,0x3258b4af34af3258,0xb25834afb4afb258,0x34af3258b25834af,0xb4afb2583258b4af,0xae5eb56e34f7316d,0x356eae5eb16d34f7,0x356eae5eb16d34f7,0x2e5e356eb4f7b16d
.quad 0xb533b07535333075,0xb533b07535333075,0x3075b533b0753533,0x3075b533b0753533,0xb507312e35632ee6,0x312e35072ee6b563,0xb12eb507aee63563,0xb507312e35632ee6,0xacd2358735872cd2,0x2cd2b587b587acd2,0xb587acd2acd23587,0x35872cd22cd2b587,0x32fd3473359e2967,0xb47332fda967359e,0xb47332fda967359e,0xb2fdb473b59ea967
.quad 0x3400340034003400,0x3400340034003400,0xb4003400b4003400,0xb4003400b4003400,0xb5a2284cb45db334,0x284c35a2b334345d,0xa84cb5a23334b45d,0xb5a2284cb45db334,0x3258b4af34af3258,0xb25834afb4afb258,0x34af3258b25834af,0xb4afb2583258b4af,0x2e5e356eb4f7b16d,0xb56e2e5e316db4f7,0xb56e2e5e316db4f7,0xae5eb56e34f7316d
.quad 0xb533b07535333075,0xb533b07535333075,0x3075b533b0753533,0x3075b533b0753533,0x3507b12eb563aee6,0xb12eb507aee63563,0x312e35072ee6b563,0x3507b12eb563aee6,0xacd2358735872cd2,0x2cd2b587b587acd2,0xb587acd2acd23587,0x35872cd22cd2b587,0xb2fdb473b59ea967,0x3473b2fd2967b59e,0x3473b2fd2967b59e,0x32fd3473359e2967
.quad 0,0,0,0,0,0,0,0,0,0,0,0,0,0,0,0
.quad 0,0,0,0,0,0,0,0,0,0,0,0,0,0,0,0
.quad 0,0,0,0,0,0,0,0,0,0,0,0,0,0,0,0
.quad 0,0,0,0,0,0,0,0,0,0,0,0,0,0,0,0
.quad 0x3400340034003400,0x3400340034003400,0xb4003400b4003400,0xb4003400b4003400,0x35a1a870345f332d,0xa870b5a1332db45f,0x287035a1b32d345f,0x35a1a870345f332d,0x3249b4b434b43249,0xb24934b4b4b4b249,0x34b43249b24934b4,0xb4b4b2493249b4b4,0xae92b56a34fd3155,0x356aae92b15534fd,0x356aae92b15534fd,0x2e92356ab4fdb155
.quad 0xb53ab054353a3054,0xb53ab054353a3054,0x3054b53ab054353a,0x3054b53ab054353a,0xb4fd3155356a2e92,0x315534fd2e92b56a,0xb155b4fdae92356a,0xb4fd3155356a2e92,0xac6a358c358c2c6a,0x2c6ab58cb58cac6a,0xb58cac6aac6a358c,0x358c2c6a2c6ab58c,0x332d345f35a12870,0xb45f332da87035a1,0xb45f332da87035a1,0xb32db45fb5a1a870
.quad 0x3400340034003400,0x3400340034003400,0xb4003400b4003400,0xb4003400b4003400,0xb5a12870b45fb32d,0x287035a1b32d345f,0xa870b5a1332db45f,0xb5a12870b45fb32d,0x3249b4b434b43249,0xb24934b4b4b4b249,0x34b43249b24934b4,0xb4b4b2493249b4b4,0x2e92356ab4fdb155,0xb56a2e923155b4fd,0xb56a2e923155b4fd,0xae92b56a34fd3155
.quad 0xb53ab054353a3054,0xb53ab054353a3054,0x3054b53ab054353a,0x3054b53ab054353a,0x34fdb155b56aae92,0xb155b4fdae92356a,0x315534fd2e92b56a,0x34fdb155b56aae92,0xac6a358c358c2c6a,0x2c6ab58cb58cac6a,0xb58cac6aac6a358c,0x358c2c6a2c6ab58c,0xb32db45fb5a1a870,0x345fb32d2870b5a1,0x345fb32d2870b5a1,0x332d345f35a12870
.quad 0,0,0,0,0,0,0,0,0,0,0,0,0,0,0,0
.quad 0,0,0,0,0,0,0,0,0,0,0,0,0,0,0,0
.quad 0,0,0,0,0,0,0,0,0,0,0,0,0,0,0,0
.quad 0,0,0,0,0,0,0,0,0,0,0,0,0,0,0,0
.quad 0x3400340034003400,0x3400340034003400,0xb4003400b4003400,0xb4003400b4003400,0x35a1a89334623327,0xa893b5a13327b462,0x289335a1b3273462,0x35a1a89334623327,0x323ab4b934b9323a,0xb23a34b9b4b9b23a,0x34b9323ab23a34b9,0xb4b9b23a323ab4b9,0xaec4b5663503313e,0x3566aec4b13e3503,0x3566aec4b13e3503,0x2ec43566b503b13e
.quad 0xb541b03335413033,0xb541b03335413033,0x3033b541b0333541,0x3033b541b0333541,0xb4f3317c35702e3c,0x317c34f32e3cb570,0xb17cb4f3ae3c3570,0xb4f3317c35702e3c,0xac01359135912c01,0x2c01b591b591ac01,0xb591ac01ac013591,0x35912c012c01b591,0x335d344b35a426ef,0xb44b335da6ef35a4,0xb44b335da6ef35a4,0xb35db44bb5a4a6ef
.quad 0x3400340034003400,0x3400340034003400,0xb4003400b4003400,0xb4003400b4003400,0xb5a12893b462b327,0x289335a1b3273462,0xa893b5a13327b462,0xb5a12893b462b327,0x323ab4b934b9323a,0xb23a34b9b4b9b23a,0x34b9323ab23a34b9,0xb4b9b23a323ab4b9,0x2ec43566b503b13e,0xb5662ec4313eb503,0xb5662ec4313eb503,0xaec4b5663503313e
.quad 0xb541b03335413033,0xb541b03335413033,0x3033b541b0333541,0x3033b541b0333541,0x34f3b17cb570ae3c,0xb17cb4f3ae3c3570,0x317c34f32e3cb570,0x34f3b17cb570ae3c,0xac01359135912c01,0x2c01b591b591ac01,0xb591ac01ac013591,0x35912c012c01b591,0xb35db44bb5a4a6ef,0x344bb35d26efb5a4,0x344bb35d26efb5a4,0x335d344b35a426ef
.quad 0,0,0,0,0,0,0,0,0,0,0,0,0,0,0,0
.quad 0,0,0,0,0,0,0,0,0,0,0,0,0,0,0,0
.quad 0,0,0,0,0,0,0,0,0,0,0,0,0,0,0,0
.quad 0,0,0,0,0,0,0,0,0,0,0,0,0,0,0,0
.quad 0x3400340034003400,0x3400340034003400,0xb4003400b4003400,0xb4003400b4003400,0x35a0a8b634653320,0xa8b6b5a03320b465,0x28b635a0b3203465,0x35a0a8b634653320,0x322bb4be34be322b,0xb22b34beb4beb22b,0x34be322bb22b34be,0xb4beb22b322bb4be,0xaef7b562350a3126,0x3562aef7b126350a,0x3562aef7b126350a,0x2ef73562b50ab126
.quad 0xb547b01235473012,0xb547b01235473012,0x3012b547b0123547,0x3012b547b0123547,0xb4e831a335762de7,0x31a334e82de7b576,0xb1a3b4e8ade73576,0xb4e831a335762de7,0xab30359635962b30,0x2b30b596b596ab30,0xb596ab30ab303596,0x35962b302b30b596,0x338c343735a624ff,0xb437338ca4ff35a6,0xb437338ca4ff35a6,0xb38cb437b5a6a4ff
.quad 0x3400340034003400,0x3400340034003400,0xb4003400b4003400,0xb4003400b4003400,0xb5a028b6b465b320,0x28b635a0b3203465,0xa8b6b5a03320b465,0xb5a028b6b465b320,0x322bb4be34be322b,0xb22b34beb4beb22b,0x34be322bb22b34be,0xb4beb22b322bb4be,0x2ef73562b50ab126,0xb5622ef73126b50a,0xb5622ef73126b50a,0xaef7b562350a3126
.quad 0xb547b01235473012,0xb547b01235473012,0x3012b547b0123547,0x3012b547b0123547,0x34e8b1a3b576ade7,0xb1a3b4e8ade73576,0x31a334e82de7b576,0x34e8b1a3b576ade7,0xab30359635962b30,0x2b30b596b596ab30,0xb596ab30ab303596,0x35962b302b30b596,0xb38cb437b5a6a4ff,0x3437b38c24ffb5a6,0x3437b38c24ffb5a6,0x338c343735a624ff
.quad 0,0,0,0,0,0,0,0,0,0,0,0,0,0,0,0
.quad 0,0,0,0,0,0,0,0,0,0,0,0,0,0,0,0
.quad 0,0,0,0,0,0,0,0,0,0,0,0,0,0,0,0
.quad 0,0,0,0,0,0,0,0,0,0,0,0,0,0,0,0
.quad 0x3400340034003400,0x3400340034003400,0xb4003400b4003400,0xb4003400b4003400,0x35a0a8da34683319,0xa8dab5a03319b468,0x28da35a0b3193468,0x35a0a8da34683319,0x321db4c334c3321d,0xb21d34c3b4c3b21d,0x34c3321db21d34c3,0xb4c3b21d321db4c3,0xaf2ab55e3510310e,0x355eaf2ab10e3510,0x355eaf2ab10e3510,0x2f2a355eb510b10e
.quad 0xb54dafe2354d2fe2,0xb54dafe2354d2fe2,0x2fe2b54dafe2354d,0x2fe2b54dafe2354d,0xb4dc31c9357c2d91,0x31c934dc2d91b57c,0xb1c9b4dcad91357c,0xb4dc31c9357c2d91,0xaa5e359a359a2a5e,0x2a5eb59ab59aaa5e,0xb59aaa5eaa5e359a,0x359a2a5e2a5eb59a,0x33ba342235a7221c,0xb42233baa21c35a7,0xb42233baa21c35a7,0xb3bab422b5a7a21c
.quad 0x3400340034003400,0x3400340034003400,0xb4003400b4003400,0xb4003400b4003400,0xb5a028dab468b319,0x28da35a0b3193468,0xa8dab5a03319b468,0xb5a028dab468b319,0x321db4c334c3321d,0xb21d34c3b4c3b21d,0x34c3321db21d34c3,0xb4c3b21d321db4c3,0x2f2a355eb510b10e,0xb55e2f2a310eb510,0xb55e2f2a310eb510,0xaf2ab55e3510310e
.quad 0xb54dafe2354d2fe2,0xb54dafe2354d2fe2,0x2fe2b54dafe2354d,0x2fe2b54dafe2354d,0x34dcb1c9b57cad91,0xb1c9b4dcad91357c,0x31c934dc2d91b57c,0x34dcb1c9b57cad91,0xaa5e359a359a2a5e,0x2a5eb59ab59aaa5e,0xb59aaa5eaa5e359a,0x359a2a5e2a5eb59a,0xb3bab422b5a7a21c,0x3422b3ba221cb5a7,0x3422b3ba221cb5a7,0x33ba342235a7221c
.quad 0,0,0,0,0,0,0,0,0,0,0,0,0,0,0,0
.quad 0,0,0,0,0,0,0,0,0,0,0,0,0,0,0,0
.quad 0,0,0,0,0,0,0,0,0,0,0,0,0,0,0,0
.quad 0,0,0,0,0,0,0,0,0,0,0,0,0,0,0,0
.quad 0x3400340034003400,0x3400340034003400,0xb4003400b4003400,0xb4003400b4003400,0x359fa8fd346b3312,0xa8fdb59f3312b46b,0x28fd359fb312346b,0x359fa8fd346b3312,0x320eb4c734c7320e,0xb20e34c7b4c7b20e,0x34c7320eb20e34c7,0xb4c7b20e320eb4c7,0xaf5cb559351530f6,0x3559af5cb0f63515,0x3559af5cb0f63515,0x2f5c3559b515b0f6
.quad 0xb554af9f35542f9f,0xb554af9f35542f9f,0x2f9fb554af9f3554,0x2f9fb554af9f3554,0xb4d131ef35812d3a,0x31ef34d12d3ab581,0xb1efb4d1ad3a3581,0xb4d131ef35812d3a,0xa98a359d359d298a,0x298ab59db59da98a,0xb59da98aa98a359d,0x359d298a298ab59d,0x33e7340c35a81c71,0xb40c33e79c7135a8,0xb40c33e79c7135a8,0xb3e7b40cb5a89c71
.quad 0x3400340034003400,0x3400340034003400,0xb4003400b4003400,0xb4003400b4003400,0xb59f28fdb46bb312,0x28fd359fb312346b,0xa8fdb59f3312b46b,0xb59f28fdb46bb312,0x320eb4c734c7320e,0xb20e34c7b4c7b20e,0x34c7320eb20e34c7,0xb4c7b20e320eb4c7,0x2f5c3559b515b0f6,0xb5592f5c30f6b515,0xb5592f5c30f6b515,0xaf5cb559351530f6
.quad 0xb554af9f35542f9f,0xb554af9f35542f9f,0x2f9fb554af9f3554,0x2f9fb554af9f3554,0x34d1b1efb581ad3a,0xb1efb4d1ad3a3581,0x31ef34d12d3ab581,0x34d1b1efb581ad3a,0xa98a359d359d298a,0x298ab59db59da98a,0xb59da98aa98a359d,0x359d298a298ab59d,0xb3e7b40cb5a89c71,0x340cb3e71c71b5a8,0x340cb3e71c71b5a8,0x33e7340c35a81c71
.quad 0,0,0,0,0,0,0,0,0,0,0,0,0,0,0,0
.quad 0,0,0,0,0,0,0,0,0,0,0,0,0,0,0,0
.quad 0,0,0,0,0,0,0,0,0,0,0,0,0,0,0,0
.quad 0,0,0,0,0,0,0,0,0,0,0,0,0,0,0,0
.quad 0x3400340034003400,0x3400340034003400,0xb4003400b4003400,0xb4003400b4003400,0x359fa920346d330b,0xa920b59f330bb46d,0x2920359fb30b346d,0x359fa920346d330b,0x31feb4cc34cc31fe,0xb1fe34ccb4ccb1fe,0x34cc31feb1fe34cc,0xb4ccb1fe31feb4cc,0xaf8fb555351b30de,0x3555af8fb0de351b,0x3555af8fb0de351b,0x2f8f3555b51bb0de
.quad 0xb559af5c35592f5c,0xb559af5c35592f5c,0x2f5cb559af5c3559,0x2f5cb559af5c3559,0xb4c5321535862ce4,0x321534c52ce4b586,0xb215b4c5ace43586,0xb4c5321535862ce4,0xa8b635a035a028b6,0x28b6b5a0b5a0a8b6,0xb5a0a8b6a8b635a0,0x35a028b628b6b5a0,0x340933ed35a89aaa,0xb3ed34091aaa35a8,0xb3ed34091aaa35a8,0xb409b3edb5a81aaa
.quad 0x3400340034003400,0x3400340034003400,0xb4003400b4003400,0xb4003400b4003400,0xb59f2920b46db30b,0x2920359fb30b346d,0xa920b59f330bb46d,0xb59f2920b46db30b,0x31feb4cc34cc31fe,0xb1fe34ccb4ccb1fe,0x34cc31feb1fe34cc,0xb4ccb1fe31feb4cc,0x2f8f3555b51bb0de,0xb5552f8f30deb51b,0xb5552f8f30deb51b,0xaf8fb555351b30de
.quad 0xb559af5c35592f5c,0xb559af5c35592f5c,0x2f5cb559af5c3559,0x2f5cb559af5c3559,0x34c5b215b586ace4,0xb215b4c5ace43586,0x321534c52ce4b586,0x34c5b215b586ace4,0xa8b635a035a028b6,0x28b6b5a0b5a0a8b6,0xb5a0a8b6a8b635a0,0x35a028b628b6b5a0,0xb409b3edb5a81aaa,0x33edb4099aaab5a8,0x33edb4099aaab5a8,0x340933ed35a89aaa
.quad 0,0,0,0,0,0,0,0,0,0,0,0,0,0,0,0
.quad 0,0,0,0,0,0,0,0,0,0,0,0,0,0,0,0
.quad 0,0,0,0,0,0,0,0,0,0,0,0,0,0,0,0
.quad 0,0,0,0,0,0,0,0,0,0,0,0,0,0,0,0
.quad 0x3400340034003400,0x3400340034003400,0xb4003400b4003400,0xb4003400b4003400,0x359ea94434703304,0xa944b59e3304b470,0x2944359eb3043470,0x359ea94434703304,0x31efb4d134d131ef,0xb1ef34d1b4d1b1ef,0x34d131efb1ef34d1,0xb4d1b1ef31efb4d1,0xafc1b550352130c6,0x3550afc1b0c63521,0x3550afc1b0c63521,0x2fc13550b521b0c6
.quad 0xb55faf19355f2f19,0xb55faf19355f2f19,0x2f19b55faf19355f,0x2f19b55faf19355f,0xb4b9323a358b2c8d,0x323a34b92c8db58b,0xb23ab4b9ac8d358b,0xb4b9323a358b2c8d,0xa7c435a335a327c4,0x27c4b5a3b5a3a7c4,0xb5a3a7c4a7c435a3,0x35a327c427c4b5a3,0x341f33c035a7a18d,0xb3c0341f218d35a7,0xb3c0341f218d35a7,0xb41fb3c0b5a7218d
.quad 0x3400340034003400,0x3400340034003400,0xb4003400b4003400,0xb4003400b4003400,0xb59e2944b470b304,0x2944359eb3043470,0xa944b59e3304b470,0xb59e2944b470b304,0x31efb4d134d131ef,0xb1ef34d1b4d1b1ef,0x34d131efb1ef34d1,0xb4d1b1ef31efb4d1,0x2fc13550b521b0c6,0xb5502fc130c6b521,0xb5502fc130c6b521,0xafc1b550352130c6
.quad 0xb55faf19355f2f19,0xb55faf19355f2f19,0x2f19b55faf19355f,0x2f19b55faf19355f,0x34b9b23ab58bac8d,0xb23ab4b9ac8d358b,0x323a34b92c8db58b,0x34b9b23ab58bac8d,0xa7c435a335a327c4,0x27c4b5a3b5a3a7c4,0xb5a3a7c4a7c435a3,0x35a327c427c4b5a3,0xb41fb3c0b5a7218d,0x33c0b41fa18db5a7,0x33c0b41fa18db5a7,0x341f33c035a7a18d
.quad 0,0,0,0,0,0,0,0,0,0,0,0,0,0,0,0
.quad 0,0,0,0,0,0,0,0,0,0,0,0,0,0,0,0
.quad 0,0,0,0,0,0,0,0,0,0,0,0,0,0,0,0
.quad 0,0,0,0,0,0,0,0,0,0,0,0,0,0,0,0
.quad 0x3400340034003400,0x3400340034003400,0xb4003400b4003400,0xb4003400b4003400,0x359ea967347332fd,0xa967b59e32fdb473,0x2967359eb2fd3473,0x359ea967347332fd,0x31e0b4d634d631e0,0xb1e034d6b4d6b1e0,0x34d631e0b1e034d6,0xb4d6b1e031e0b4d6,0xaff3b54c352630ae,0x354caff3b0ae3526,0x354caff3b0ae3526,0x2ff3354cb526b0ae
.quad 0xb565aed535652ed5,0xb565aed535652ed5,0x2ed5b565aed53565,0x2ed5b565aed53565,0xb4ad325f358f2c36,0x325f34ad2c36b58f,0xb25fb4adac36358f,0xb4ad325f358f2c36,0xa61b35a535a5261b,0x261bb5a5b5a5a61b,0xb5a5a61ba61b35a5,0x35a5261b261bb5a5,0x3434339235a6a4b8,0xb392343424b835a6,0xb392343424b835a6,0xb434b392b5a624b8
.quad 0x3400340034003400,0x3400340034003400,0xb4003400b4003400,0xb4003400b4003400,0xb59e2967b473b2fd,0x2967359eb2fd3473,0xa967b59e32fdb473,0xb59e2967b473b2fd,0x31e0b4d634d631e0,0xb1e034d6b4d6b1e0,0x34d631e0b1e034d6,0xb4d6b1e031e0b4d6,0x2ff3354cb526b0ae,0xb54c2ff330aeb526,0xb54c2ff330aeb526,0xaff3b54c352630ae
.quad 0xb565aed535652ed5,0xb565aed535652ed5,0x2ed5b565aed53565,0x2ed5b565aed53565,0x34adb25fb58fac36,0xb25fb4adac36358f,0x325f34ad2c36b58f,0x34adb25fb58fac36,0xa61b35a535a5261b,0x261bb5a5b5a5a61b,0xb5a5a61ba61b35a5,0x35a5261b261bb5a5,0xb434b392b5a624b8,0x3392b434a4b8b5a6,0x3392b434a4b8b5a6,0x3434339235a6a4b8
.quad 0,0,0,0,0,0,0,0,0,0,0,0,0,0,0,0
.quad 0,0,0,0,0,0,0,0,0,0,0,0,0,0,0,0
.quad 0,0,0,0,0,0,0,0,0,0,0,0,0,0,0,0
.quad 0,0,0,0,0,0,0,0,0,0,0,0,0,0,0,0
.quad 0x3400340034003400,0x3400340034003400,0xb4003400b4003400,0xb4003400b4003400,0x359da98a347632f6,0xa98ab59d32f6b476,0x298a359db2f63476,0x359da98a347632f6,0x31d1b4da34da31d1,0xb1d134dab4dab1d1,0x34da31d1b1d134da,0xb4dab1d131d1b4da,0xb012b547352c3096,0x3547b012b096352c,0x3547b012b096352c,0x30123547b52cb096
.quad 0xb56aae92356a2e92,0xb56aae92356a2e92,0x2e92b56aae92356a,0x2e92b56aae92356a,0xb4a0328435932bbd,0x328434a02bbdb593,0xb284b4a0abbd3593,0xb4a0328435932bbd,0xa47135a635a62471,0x2471b5a6b5a6a471,0xb5a6a471a47135a6,0x35a624712471b5a6,0x3449336435a4a6a9,0xb364344926a935a4,0xb364344926a935a4,0xb449b364b5a426a9
.quad 0x3400340034003400,0x3400340034003400,0xb4003400b4003400,0xb4003400b4003400,0xb59d298ab476b2f6,0x298a359db2f63476,0xa98ab59d32f6b476,0xb59d298ab476b2f6,0x31d1b4da34da31d1,0xb1d134dab4dab1d1,0x34da31d1b1d134da,0xb4dab1d131d1b4da,0x30123547b52cb096,0xb54730123096b52c,0xb54730123096b52c,0xb012b547352c3096
.quad 0xb56aae92356a2e92,0xb56aae92356a2e92,0x2e92b56aae92356a,0x2e92b56aae92356a,0x34a0b284b593abbd,0xb284b4a0abbd3593,0x328434a02bbdb593,0x34a0b284b593abbd,0xa47135a635a62471,0x2471b5a6b5a6a471,0xb5a6a471a47135a6,0x35a624712471b5a6,0xb449b364b5a426a9,0x3364b449a6a9b5a4,0x3364b449a6a9b5a4,0x3449336435a4a6a9
.quad 0,0,0,0,0,0,0,0,0,0,0,0,0,0,0,0
.quad 0,0,0,0,0,0,0,0,0,0,0,0,0,0,0,0
.quad 0,0,0,0,0,0,0,0,0,0,0,0,0,0,0,0
.quad 0,0,0,0,0,0,0,0,0,0,0,0,0,0,0,0
.quad 0x3400340034003400,0x3400340034003400,0xb4003400b4003400,0xb4003400b4003400,0x359da9ad347832ef,0xa9adb59d32efb478,0x29ad359db2ef3478,0x359da9ad347832ef,0x31c2b4df34df31c2,0xb1c234dfb4dfb1c2,0x34df31c2b1c234df,0xb4dfb1c231c2b4df,0xb02bb5423531307d,0x3542b02bb07d3531,0x3542b02bb07d3531,0x302b3542b531b07d
.quad 0xb56fae4d356f2e4d,0xb56fae4d356f2e4d,0x2e4db56fae4d356f,0x2e4db56fae4d356f,0xb49332a835962b0d,0x32a834932b0db596,0xb2a8b493ab0d3596,0xb49332a835962b0d,0xa18d35a735a7218d,0x218db5a7b5a7a18d,0xb5a7a18da18d35a7,0x35a7218d218db5a7,0x345d333435a2a84c,0xb334345d284c35a2,0xb334345d284c35a2,0xb45db334b5a2284c
.quad 0x3400340034003400,0x3400340034003400,0xb4003400b4003400,0xb4003400b4003400,0xb59d29adb478b2ef,0x29ad359db2ef3478,0xa9adb59d32efb478,0xb59d29adb478b2ef,0x31c2b4df34df31c2,0xb1c234dfb4dfb1c2,0x34df31c2b1c234df,0xb4dfb1c231c2b4df,0x302b3542b531b07d,0xb542302b307db531,0xb542302b307db531,0xb02bb5423531307d
.quad 0xb56fae4d356f2e4d,0xb56fae4d356f2e4d,0x2e4db56fae4d356f,0x2e4db56fae4d356f,0x3493b2a8b596ab0d,0xb2a8b493ab0d3596,0x32a834932b0db596,0x3493b2a8b596ab0d,0xa18d35a735a7218d,0x218db5a7b5a7a18d,0xb5a7a18da18d35a7,0x35a7218d218db5a7,0xb45db334b5a2284c,0x3334b45da84cb5a2,0x3334b45da84cb5a2,0x345d333435a2a84c
.quad 0,0,0,0,0,0,0,0,0,0,0,0,0,0,0,0
.quad 0,0,0,0,0,0,0,0,0,0,0,0,0,0,0,0
.quad 0,0,0,0,0,0,0,0,0,0,0,0,0,0,0,0
.quad 0,0,0,0,0,0,0,0,0,0,0,0,0,0,0,0
.quad 0x3400340034003400,0x3400340034003400,0xb4003400b4003400,0xb4003400b4003400,0x359ca9d1347b32e8,0xa9d1b59c32e8b47b,0x29d1359cb2e8347b,0x359ca9d1347b32e8,0x31b2b4e334e331b2,0xb1b234e3b4e3b1b2,0x34e331b2b1b234e3,0xb4e3b1b231b2b4e3,0xb044b53d35363065,0x353db044b0653536,0x353db044b0653536,0x3044353db536b065
.quad 0xb574ae0935742e09,0xb574ae0935742e09,0x2e09b574ae093574,0x2e09b574ae093574,0xb48632cc359a2a5e,0x32cc34862a5eb59a,0xb2ccb486aa5e359a,0xb48632cc359a2a5e,0x9c7135a835a81c71,0x1c71b5a8b5a89c71,0xb5a89c719c7135a8,0x35a81c711c71b5a8,0x34703304359ea944,0xb30434702944359e,0xb30434702944359e,0xb470b304b59e2944
.quad 0x3400340034003400,0x3400340034003400,0xb4003400b4003400,0xb4003400b4003400,0xb59c29d1b47bb2e8,0x29d1359cb2e8347b,0xa9d1b59c32e8b47b,0xb59c29d1b47bb2e8,0x31b2b4e334e331b2,0xb1b234e3b4e3b1b2,0x34e331b2b1b234e3,0xb4e3b1b231b2b4e3,0x3044353db536b065,0xb53d30443065b536,0xb53d30443065b536,0xb044b53d35363065
.quad 0xb574ae0935742e09,0xb574ae0935742e09,0x2e09b574ae093574,0x2e09b574ae093574,0x3486b2ccb59aaa5e,0xb2ccb486aa5e359a,0x32cc34862a5eb59a,0x3486b2ccb59aaa5e,0x9c7135a835a81c71,0x1c71b5a8b5a89c71,0xb5a89c719c7135a8,0x35a81c711c71b5a8,0xb470b304b59e2944,0x3304b470a944b59e,0x3304b470a944b59e,0x34703304359ea944
.quad 0,0,0,0,0,0,0,0,0,0,0,0,0,0,0,0
.quad 0,0,0,0,0,0,0,0,0,0,0,0,0,0,0,0
.quad 0,0,0,0,0,0,0,0,0,0,0,0,0,0,0,0
.quad 0,0,0,0,0,0,0,0,0,0,0,0,0,0,0,0
.quad 0x3400340034003400,0x3400340034003400,0xb4003400b4003400,0xb4003400b4003400,0x359ca9f4347e32e1,0xa9f4b59c32e1b47e,0x29f4359cb2e1347e,0x359ca9f4347e32e1,0x31a3b4e834e831a3,0xb1a334e8b4e8b1a3,0x34e831a3b1a334e8,0xb4e8b1a331a3b4e8,0xb05db538353c304c,0x3538b05db04c353c,0x3538b05db04c353c,0x305d3538b53cb04c
.quad 0xb578adc435782dc4,0xb578adc435782dc4,0x2dc4b578adc43578,0x2dc4b578adc43578,0xb47832ef359d29ad,0x32ef347829adb59d,0xb2efb478a9ad359d,0xb47832ef359d29ad,0x187135a835a89871,0x9871b5a8b5a81871,0xb5a81871187135a8,0x35a898719871b5a8,0x348332d3359aaa3a,0xb2d334832a3a359a,0xb2d334832a3a359a,0xb483b2d3b59a2a3a
.quad 0x3400340034003400,0x3400340034003400,0xb4003400b4003400,0xb4003400b4003400,0xb59c29f4b47eb2e1,0x29f4359cb2e1347e,0xa9f4b59c32e1b47e,0xb59c29f4b47eb2e1,0x31a3b4e834e831a3,0xb1a334e8b4e8b1a3,0x34e831a3b1a334e8,0xb4e8b1a331a3b4e8,0x305d3538b53cb04c,0xb538305d304cb53c,0xb538305d304cb53c,0xb05db538353c304c
.quad 0xb578adc435782dc4,0xb578adc435782dc4,0x2dc4b578adc43578,0x2dc4b578adc43578,0x3478b2efb59da9ad,0xb2efb478a9ad359d,0x32ef347829adb59d,0x3478b2efb59da9ad,0x187135a835a89871,0x9871b5a8b5a81871,0xb5a81871187135a8,0x35a898719871b5a8,0xb483b2d3b59a2a3a,0x32d3b483aa3ab59a,0x32d3b483aa3ab59a,0x348332d3359aaa3a
.quad 0,0,0,0,0,0,0,0,0,0,0,0,0,0,0,0
.quad 0,0,0,0,0,0,0,0,0,0,0,0,0,0,0,0
.quad 0,0,0,0,0,0,0,0,0,0,0,0,0,0,0,0
.quad 0,0,0,0,0,0,0,0,0,0,0,0,0,0,0,0
.quad 0x3400340034003400,0x3400340034003400,0xb4003400b4003400,0xb4003400b4003400,0x359baa17348032da,0xaa17b59b32dab480,0x2a17359bb2da3480,0x359baa17348032da,0x3194b4ec34ec3194,0xb19434ecb4ecb194,0x34ec3194b19434ec,0xb4ecb1943194b4ec,0xb075b53335413033,0x3533b075b0333541,0x3533b075b0333541,0x30753533b541b033
.quad 0xb57dad7f357d2d7f,0xb57dad7f357d2d7f,0x2d7fb57dad7f357d,0x2d7fb57dad7f357d,0xb46b3312359f28fd,0x3312346b28fdb59f,0xb312b46ba8fd359f,0xb46b3312359f28fd,0x207135a835a8a071,0xa071b5a8b5a82071,0xb5a82071207135a8,0x35a8a071a071b5a8,0x349632a13596ab30,0xb2a134962b303596,0xb2a134962b303596,0xb496b2a1b5962b30
.quad 0x3400340034003400,0x3400340034003400,0xb4003400b4003400,0xb4003400b4003400,0xb59b2a17b480b2da,0x2a17359bb2da3480,0xaa17b59b32dab480,0xb59b2a17b480b2da,0x3194b4ec34ec3194,0xb19434ecb4ecb194,0x34ec3194b19434ec,0xb4ecb1943194b4ec,0x30753533b541b033,0xb53330753033b541,0xb53330753033b541,0xb075b53335413033
.quad 0xb57dad7f357d2d7f,0xb57dad7f357d2d7f,0x2d7fb57dad7f357d,0x2d7fb57dad7f357d,0x346bb312b59fa8fd,0xb312b46ba8fd359f,0x3312346b28fdb59f,0x346bb312b59fa8fd,0x207135a835a8a071,0xa071b5a8b5a82071,0xb5a82071207135a8,0x35a8a071a071b5a8,0xb496b2a1b5962b30,0x32a1b496ab30b596,0x32a1b496ab30b596,0x349632a13596ab30
.quad 0,0,0,0,0,0,0,0,0,0,0,0,0,0,0,0
.quad 0,0,0,0,0,0,0,0,0,0,0,0,0,0,0,0
.quad 0,0,0,0,0,0,0,0,0,0,0,0,0,0,0,0
.quad 0,0,0,0,0,0,0,0,0,0,0,0,0,0,0,0
.quad 0x3400340034003400,0x3400340034003400,0xb4003400b4003400,0xb4003400b4003400,0x359aaa3a348332d3,0xaa3ab59a32d3b483,0x2a3a359ab2d33483,0x359aaa3a348332d3,0x3184b4f034f03184,0xb18434f0b4f0b184,0x34f03184b18434f0,0xb4f0b1843184b4f0,0xb08eb52e3546301b,0x352eb08eb01b3546,0x352eb08eb01b3546,0x308e352eb546b01b
.quad 0xb581ad3a35812d3a,0xb581ad3a35812d3a,0x2d3ab581ad3a3581,0x2d3ab581ad3a3581,0xb45d333435a2284c,0x3334345d284cb5a2,0xb334b45da84c35a2,0xb45d333435a2284c,0x23c635a735a7a3c6,0xa3c6b5a7b5a723c6,0xb5a723c623c635a7,0x35a7a3c6a3c6b5a7,0x34a8326e3590ac13,0xb26e34a82c133590,0xb26e34a82c133590,0xb4a8b26eb5902c13
.quad 0x3400340034003400,0x3400340034003400,0xb4003400b4003400,0xb4003400b4003400,0xb59a2a3ab483b2d3,0x2a3a359ab2d33483,0xaa3ab59a32d3b483,0xb59a2a3ab483b2d3,0x3184b4f034f03184,0xb18434f0b4f0b184,0x34f03184b18434f0,0xb4f0b1843184b4f0,0x308e352eb546b01b,0xb52e308e301bb546,0xb52e308e301bb546,0xb08eb52e3546301b
.quad 0xb581ad3a35812d3a,0xb581ad3a35812d3a,0x2d3ab581ad3a3581,0x2d3ab581ad3a3581,0x345db334b5a2a84c,0xb334b45da84c35a2,0x3334345d284cb5a2,0x345db334b5a2a84c,0x23c635a735a7a3c6,0xa3c6b5a7b5a723c6,0xb5a723c623c635a7,0x35a7a3c6a3c6b5a7,0xb4a8b26eb5902c13,0x326eb4a8ac13b590,0x326eb4a8ac13b590,0x34a8326e3590ac13
.quad 0,0,0,0,0,0,0,0,0,0,0,0,0,0,0,0
.quad 0,0,0,0,0,0,0,0,0,0,0,0,0,0,0,0
.quad 0,0,0,0,0,0,0,0,0,0,0,0,0,0,0,0
.quad 0,0,0,0,0,0,0,0,0,0,0,0,0,0,0,0
.quad 0x3400340034003400,0x3400340034003400,0xb4003400b4003400,0xb4003400b4003400,0x359aaa5e348632cc,0xaa5eb59a32ccb486,0x2a5e359ab2cc3486,0x359aaa5e348632cc,0x3175b4f534f53175,0xb17534f5b4f5b175,0x34f53175b17534f5,0xb4f5b1753175b4f5,0xb0a6b528354a3002,0x3528b0a6b002354a,0x3528b0a6b002354a,0x30a63528b54ab002
.quad 0xb585acf535852cf5,0xb585acf535852cf5,0x2cf5b585acf53585,0x2cf5b585acf53585,0xb44e335635a42736,0x3356344e2736b5a4,0xb356b44ea73635a4,0xb44e335635a42736,0x258d35a535a5a58d,0xa58db5a5b5a5258d,0xb5a5258d258d35a5,0x35a5a58da58db5a5,0x34b9323a358bac8d,0xb23a34b92c8d358b,0xb23a34b92c8d358b,0xb4b9b23ab58b2c8d
.quad 0x3400340034003400,0x3400340034003400,0xb4003400b4003400,0xb4003400b4003400,0xb59a2a5eb486b2cc,0x2a5e359ab2cc3486,0xaa5eb59a32ccb486,0xb59a2a5eb486b2cc,0x3175b4f534f53175,0xb17534f5b4f5b175,0x34f53175b17534f5,0xb4f5b1753175b4f5,0x30a63528b54ab002,0xb52830a63002b54a,0xb52830a63002b54a,0xb0a6b528354a3002
.quad 0xb585acf535852cf5,0xb585acf535852cf5,0x2cf5b585acf53585,0x2cf5b585acf53585,0x344eb356b5a4a736,0xb356b44ea73635a4,0x3356344e2736b5a4,0x344eb356b5a4a736,0x258d35a535a5a58d,0xa58db5a5b5a5258d,0xb5a5258d258d35a5,0x35a5a58da58db5a5,0xb4b9b23ab58b2c8d,0x323ab4b9ac8db58b,0x323ab4b9ac8db58b,0x34b9323a358bac8d
.quad 0,0,0,0,0,0,0,0,0,0,0,0,0,0,0,0
.quad 0,0,0,0,0,0,0,0,0,0,0,0,0,0,0,0
.quad 0,0,0,0,0,0,0,0,0,0,0,0,0,0,0,0
.quad 0,0,0,0,0,0,0,0,0,0,0,0,0,0,0,0
.quad 0x3400340034003400,0x3400340034003400,0xb4003400b4003400,0xb4003400b4003400,0x3599aa81348932c4,0xaa81b59932c4b489,0x2a813599b2c43489,0x3599aa81348932c4,0x3165b4f934f93165,0xb16534f9b4f9b165,0x34f93165b16534f9,0xb4f9b1653165b4f9,0xb0beb523354f2fd2,0x3523b0beafd2354f,0x3523b0beafd2354f,0x30be3523b54fafd2
.quad 0xb589acb035892cb0,0xb589acb035892cb0,0x2cb0b589acb03589,0x2cb0b589acb03589,0xb440337835a525d4,0x3378344025d4b5a5,0xb378b440a5d435a5,0xb440337835a525d4,0x273635a435a4a736,0xa736b5a4b5a42736,0xb5a42736273635a4,0x35a4a736a736b5a4,0x34ca32063584ad07,0xb20634ca2d073584,0xb20634ca2d073584,0xb4cab206b5842d07
.quad 0x3400340034003400,0x3400340034003400,0xb4003400b4003400,0xb4003400b4003400,0xb5992a81b489b2c4,0x2a813599b2c43489,0xaa81b59932c4b489,0xb5992a81b489b2c4,0x3165b4f934f93165,0xb16534f9b4f9b165,0x34f93165b16534f9,0xb4f9b1653165b4f9,0x30be3523b54fafd2,0xb52330be2fd2b54f,0xb52330be2fd2b54f,0xb0beb523354f2fd2
.quad 0xb589acb035892cb0,0xb589acb035892cb0,0x2cb0b589acb03589,0x2cb0b589acb03589,0x3440b378b5a5a5d4,0xb378b440a5d435a5,0x3378344025d4b5a5,0x3440b378b5a5a5d4,0x273635a435a4a736,0xa736b5a4b5a42736,0xb5a42736273635a4,0x35a4a736a736b5a4,0xb4cab206b5842d07,0x3206b4caad07b584,0x3206b4caad07b584,0x34ca32063584ad07
.quad 0,0,0,0,0,0,0,0,0,0,0,0,0,0,0,0
.quad 0,0,0,0,0,0,0,0,0,0,0,0,0,0,0,0
.quad 0,0,0,0,0,0,0,0,0,0,0,0,0,0,0,0
.quad 0,0,0,0,0,0,0,0,0,0,0,0,0,0,0,0
.quad 0x3400340034003400,0x3400340034003400,0xb4003400b4003400,0xb4003400b4003400,0x3598aaa4348b32bd,0xaaa4b59832bdb48b,0x2aa43598b2bd348b,0x3598aaa4348b32bd,0x3155b4fd34fd3155,0xb15534fdb4fdb155,0x34fd3155b15534fd,0xb4fdb1553155b4fd,0xb0d6b51d35542f9f,0x351db0d6af9f3554,0x351db0d6af9f3554,0x30d6351db554af9f
.quad 0xb58cac6a358c2c6a,0xb58cac6a358c2c6a,0x2c6ab58cac6a358c,0x2c6ab58cac6a358c,0xb431339935a62471,0x339934312471b5a6,0xb399b431a47135a6,0xb431339935a62471,0x287035a135a1a870,0xa870b5a1b5a12870,0xb5a12870287035a1,0x35a1a870a870b5a1,0x34da31d1357dad7f,0xb1d134da2d7f357d,0xb1d134da2d7f357d,0xb4dab1d1b57d2d7f
.quad 0x3400340034003400,0x3400340034003400,0xb4003400b4003400,0xb4003400b4003400,0xb5982aa4b48bb2bd,0x2aa43598b2bd348b,0xaaa4b59832bdb48b,0xb5982aa4b48bb2bd,0x3155b4fd34fd3155,0xb15534fdb4fdb155,0x34fd3155b15534fd,0xb4fdb1553155b4fd,0x30d6351db554af9f,0xb51d30d62f9fb554,0xb51d30d62f9fb554,0xb0d6b51d35542f9f
.quad 0xb58cac6a358c2c6a,0xb58cac6a358c2c6a,0x2c6ab58cac6a358c,0x2c6ab58cac6a358c,0x3431b399b5a6a471,0xb399b431a47135a6,0x339934312471b5a6,0x3431b399b5a6a471,0x287035a135a1a870,0xa870b5a1b5a12870,0xb5a12870287035a1,0x35a1a870a870b5a1,0xb4dab1d1b57d2d7f,0x31d1b4daad7fb57d,0x31d1b4daad7fb57d,0x34da31d1357dad7f
.quad 0,0,0,0,0,0,0,0,0,0,0,0,0,0,0,0
.quad 0,0,0,0,0,0,0,0,0,0,0,0,0,0,0,0
.quad 0,0,0,0,0,0,0,0,0,0,0,0,0,0,0,0
.quad 0,0,0,0,0,0,0,0,0,0,0,0,0,0,0,0
.quad 0x3400340034003400,0x3400340034003400,0xb4003400b4003400,0xb4003400b4003400,0x3598aac7348e32b6,0xaac7b59832b6b48e,0x2ac73598b2b6348e,0x3598aac7348e32b6,0x3146b50135013146,0xb1463501b501b146,0x35013146b1463501,0xb501b1463146b501,0xb0eeb51735582f6d,0x3517b0eeaf6d3558,0x3517b0eeaf6d3558,0x30ee3517b558af6d
.quad 0xb590ac2435902c24,0xb590ac2435902c24,0x2c24b590ac243590,0x2c24b590ac243590,0xb42233ba35a7221c,0x33ba3422221cb5a7,0xb3bab422a21c35a7,0xb42233ba35a7221c,0x2944359e359ea944,0xa944b59eb59e2944,0xb59e29442944359e,0x359ea944a944b59e,0x34ea319b3575adf8,0xb19b34ea2df83575,0xb19b34ea2df83575,0xb4eab19bb5752df8
.quad 0x3400340034003400,0x3400340034003400,0xb4003400b4003400,0xb4003400b4003400,0xb5982ac7b48eb2b6,0x2ac73598b2b6348e,0xaac7b59832b6b48e,0xb5982ac7b48eb2b6,0x3146b50135013146,0xb1463501b501b146,0x35013146b1463501,0xb501b1463146b501,0x30ee3517b558af6d,0xb51730ee2f6db558,0xb51730ee2f6db558,0xb0eeb51735582f6d
.quad 0xb590ac2435902c24,0xb590ac2435902c24,0x2c24b590ac243590,0x2c24b590ac243590,0x3422b3bab5a7a21c,0xb3bab422a21c35a7,0x33ba3422221cb5a7,0x3422b3bab5a7a21c,0x2944359e359ea944,0xa944b59eb59e2944,0xb59e29442944359e,0x359ea944a944b59e,0xb4eab19bb5752df8,0x319bb4eaadf8b575,0x319bb4eaadf8b575,0x34ea319b3575adf8
.quad 0,0,0,0,0,0,0,0,0,0,0,0,0,0,0,0
.quad 0,0,0,0,0,0,0,0,0,0,0,0,0,0,0,0
.quad 0,0,0,0,0,0,0,0,0,0,0,0,0,0,0,0
.quad 0,0,0,0,0,0,0,0,0,0,0,0,0,0,0,0
.quad 0x3400340034003400,0x3400340034003400,0xb4003400b4003400,0xb4003400b4003400,0x3597aaea349032af,0xaaeab59732afb490,0x2aea3597b2af3490,0x3597aaea349032af,0x3136b50535053136,0xb1363505b505b136,0x35053136b1363505,0xb505b1363136b505,0xb106b511355c2f3b,0x3511b106af3b355c,0x3511b106af3b355c,0x31063511b55caf3b
.quad 0xb593abbd35932bbd,0xb593abbd35932bbd,0x2bbdb593abbd3593,0x2bbdb593abbd3593,0xb41333da35a81eaa,0x33da34131eaab5a8,0xb3dab4139eaa35a8,0xb41333da35a81eaa,0x2a17359b359baa17,0xaa17b59bb59b2a17,0xb59b2a172a17359b,0x359baa17aa17b59b,0x34f93165356cae6f,0xb16534f92e6f356c,0xb16534f92e6f356c,0xb4f9b165b56c2e6f
.quad 0x3400340034003400,0x3400340034003400,0xb4003400b4003400,0xb4003400b4003400,0xb5972aeab490b2af,0x2aea3597b2af3490,0xaaeab59732afb490,0xb5972aeab490b2af,0x3136b50535053136,0xb1363505b505b136,0x35053136b1363505,0xb505b1363136b505,0x31063511b55caf3b,0xb51131062f3bb55c,0xb51131062f3bb55c,0xb106b511355c2f3b
.quad 0xb593abbd35932bbd,0xb593abbd35932bbd,0x2bbdb593abbd3593,0x2bbdb593abbd3593,0x3413b3dab5a89eaa,0xb3dab4139eaa35a8,0x33da34131eaab5a8,0x3413b3dab5a89eaa,0x2a17359b359baa17,0xaa17b59bb59b2a17,0xb59b2a172a17359b,0x359baa17aa17b59b,0xb4f9b165b56c2e6f,0x3165b4f9ae6fb56c,0x3165b4f9ae6fb56c,0x34f93165356cae6f
.quad 0,0,0,0,0,0,0,0,0,0,0,0,0,0,0,0
.quad 0,0,0,0,0,0,0,0,0,0,0,0,0,0,0,0
.quad 0,0,0,0,0,0,0,0,0,0,0,0,0,0,0,0
.quad 0,0,0,0,0,0,0,0,0,0,0,0,0,0,0,0
.quad 0x3400340034003400,0x3400340034003400,0xb4003400b4003400,0xb4003400b4003400,0x3596ab0d349332a8,0xab0db59632a8b493,0x2b0d3596b2a83493,0x3596ab0d349332a8,0x3126b50a350a3126,0xb126350ab50ab126,0x350a3126b126350a,0xb50ab1263126b50a,0xb11eb50c35602f08,0x350cb11eaf083560,0x350cb11eaf083560,0x311e350cb560af08
.quad 0xb596ab3035962b30,0xb596ab3035962b30,0x2b30b596ab303596,0x2b30b596ab303596,0xb40333fa35a81471,0x33fa34031471b5a8,0xb3fab403947135a8,0xb40333fa35a81471,0x2aea35973597aaea,0xaaeab597b5972aea,0xb5972aea2aea3597,0x3597aaeaaaeab597,0x3507312e3563aee6,0xb12e35072ee63563,0xb12e35072ee63563,0xb507b12eb5632ee6
.quad 0x3400340034003400,0x3400340034003400,0xb4003400b4003400,0xb4003400b4003400,0xb5962b0db493b2a8,0x2b0d3596b2a83493,0xab0db59632a8b493,0xb5962b0db493b2a8,0x3126b50a350a3126,0xb126350ab50ab126,0x350a3126b126350a,0xb50ab1263126b50a,0x311e350cb560af08,0xb50c311e2f08b560,0xb50c311e2f08b560,0xb11eb50c35602f08
.quad 0xb596ab3035962b30,0xb596ab3035962b30,0x2b30b596ab303596,0x2b30b596ab303596,0x3403b3fab5a89471,0xb3fab403947135a8,0x33fa34031471b5a8,0x3403b3fab5a89471,0x2aea35973597aaea,0xaaeab597b5972aea,0xb5972aea2aea3597,0x3597aaeaaaeab597,0xb507b12eb5632ee6,0x312eb507aee6b563,0x312eb507aee6b563,0x3507312e3563aee6
.quad 0,0,0,0,0,0,0,0,0,0,0,0,0,0,0,0
.quad 0,0,0,0,0,0,0,0,0,0,0,0,0,0,0,0
.quad 0,0,0,0,0,0,0,0,0,0,0,0,0,0,0,0
.quad 0,0,0,0,0,0,0,0,0,0,0,0,0,0,0,0
.quad 0x3400340034003400,0x3400340034003400,0xb4003400b4003400,0xb4003400b4003400,0x3596ab30349632a1,0xab30b59632a1b496,0x2b303596b2a13496,0x3596ab30349632a1,0x3116b50e350e3116,0xb116350eb50eb116,0x350e3116b116350e,0xb50eb1163116b50e,0xb136b50535652ed5,0x3505b136aed53565,0x3505b136aed53565,0x31363505b565aed5
.quad 0xb598aaa435982aa4,0xb598aaa435982aa4,0x2aa4b598aaa43598,0x2aa4b598aaa43598,0xb3e7340c35a89c71,0x340c33e79c71b5a8,0xb40cb3e71c7135a8,0xb3e7340c35a89c71,0x2bbd35933593abbd,0xabbdb593b5932bbd,0xb5932bbd2bbd3593,0x3593abbdabbdb593,0x351530f63559af5c,0xb0f635152f5c3559,0xb0f635152f5c3559,0xb515b0f6b5592f5c
.quad 0x3400340034003400,0x3400340034003400,0xb4003400b4003400,0xb4003400b4003400,0xb5962b30b496b2a1,0x2b303596b2a13496,0xab30b59632a1b496,0xb5962b30b496b2a1,0x3116b50e350e3116,0xb116350eb50eb116,0x350e3116b116350e,0xb50eb1163116b50e,0x31363505b565aed5,0xb50531362ed5b565,0xb50531362ed5b565,0xb136b50535652ed5
.quad 0xb598aaa435982aa4,0xb598aaa435982aa4,0x2aa4b598aaa43598,0x2aa4b598aaa43598,0x33e7b40cb5a81c71,0xb40cb3e71c7135a8,0x340c33e79c71b5a8,0x33e7b40cb5a81c71,0x2bbd35933593abbd,0xabbdb593b5932bbd,0xb5932bbd2bbd3593,0x3593abbdabbdb593,0xb515b0f6b5592f5c,0x30f6b515af5cb559,0x30f6b515af5cb559,0x351530f63559af5c
.quad 0,0,0,0,0,0,0,0,0,0,0,0,0,0,0,0
.quad 0,0,0,0,0,0,0,0,0,0,0,0,0,0,0,0
.quad 0,0,0,0,0,0,0,0,0,0,0,0,0,0,0,0
.quad 0,0,0,0,0,0,0,0,0,0,0,0,0,0,0,0
.quad 0x3400340034003400,0x3400340034003400,0xb4003400b4003400,0xb4003400b4003400,0x3595ab5334983299,0xab53b5953299b498,0x2b533595b2993498,0x3595ab5334983299,0x3106b51135113106,0xb1063511b511b106,0x35113106b1063511,0xb511b1063106b511,0xb14db4ff35692ea3,0x34ffb14daea33569,0x34ffb14daea33569,0x314d34ffb569aea3
.quad 0xb59baa17359b2a17,0xb59baa17359b2a17,0x2a17b59baa17359b,0x2a17b59baa17359b,0xb3c7341c35a8a0ff,0x341c33c7a0ffb5a8,0xb41cb3c720ff35a8,0xb3c7341c35a8a0ff,0x2c47358e358eac47,0xac47b58eb58e2c47,0xb58e2c472c47358e,0x358eac47ac47b58e,0x352330be354fafd2,0xb0be35232fd2354f,0xb0be35232fd2354f,0xb523b0beb54f2fd2
.quad 0x3400340034003400,0x3400340034003400,0xb4003400b4003400,0xb4003400b4003400,0xb5952b53b498b299,0x2b533595b2993498,0xab53b5953299b498,0xb5952b53b498b299,0x3106b51135113106,0xb1063511b511b106,0x35113106b1063511,0xb511b1063106b511,0x314d34ffb569aea3,0xb4ff314d2ea3b569,0xb4ff314d2ea3b569,0xb14db4ff35692ea3
.quad 0xb59baa17359b2a17,0xb59baa17359b2a17,0x2a17b59baa17359b,0x2a17b59baa17359b,0x33c7b41cb5a820ff,0xb41cb3c720ff35a8,0x341c33c7a0ffb5a8,0x33c7b41cb5a820ff,0x2c47358e358eac47,0xac47b58eb58e2c47,0xb58e2c472c47358e,0x358eac47ac47b58e,0xb523b0beb54f2fd2,0x30beb523afd2b54f,0x30beb523afd2b54f,0x352330be354fafd2
.quad 0,0,0,0,0,0,0,0,0,0,0,0,0,0,0,0
.quad 0,0,0,0,0,0,0,0,0,0,0,0,0,0,0,0
.quad 0,0,0,0,0,0,0,0,0,0,0,0,0,0,0,0
.quad 0,0,0,0,0,0,0,0,0,0,0,0,0,0,0,0
.quad 0x3400340034003400,0x3400340034003400,0xb4003400b4003400,0xb4003400b4003400,0x3594ab77349b3292,0xab77b5943292b49b,0x2b773594b292349b,0x3594ab77349b3292,0x30f6b515351530f6,0xb0f63515b515b0f6,0x351530f6b0f63515,0xb515b0f630f6b515,0xb165b4f9356c2e6f,0x34f9b165ae6f356c,0x34f9b165ae6f356c,0x316534f9b56cae6f
.quad 0xb59da98a359d298a,0xb59da98a359d298a,0x298ab59da98a359d,0x298ab59da98a359d,0xb3a6342b35a7a3c6,0x342b33a6a3c6b5a7,0xb42bb3a623c635a7,0xb3a6342b35a7a3c6,0x2cb035893589acb0,0xacb0b589b5892cb0,0xb5892cb02cb03589,0x3589acb0acb0b589,0x352f30853544b023,0xb085352f30233544,0xb085352f30233544,0xb52fb085b5443023
.quad 0x3400340034003400,0x3400340034003400,0xb4003400b4003400,0xb4003400b4003400,0xb5942b77b49bb292,0x2b773594b292349b,0xab77b5943292b49b,0xb5942b77b49bb292,0x30f6b515351530f6,0xb0f63515b515b0f6,0x351530f6b0f63515,0xb515b0f630f6b515,0x316534f9b56cae6f,0xb4f931652e6fb56c,0xb4f931652e6fb56c,0xb165b4f9356c2e6f
.quad 0xb59da98a359d298a,0xb59da98a359d298a,0x298ab59da98a359d,0x298ab59da98a359d,0x33a6b42bb5a723c6,0xb42bb3a623c635a7,0x342b33a6a3c6b5a7,0x33a6b42bb5a723c6,0x2cb035893589acb0,0xacb0b589b5892cb0,0xb5892cb02cb03589,0x3589acb0acb0b589,0xb52fb085b5443023,0x3085b52fb023b544,0x3085b52fb023b544,0x352f30853544b023
.quad 0,0,0,0,0,0,0,0,0,0,0,0,0,0,0,0
.quad 0,0,0,0,0,0,0,0,0,0,0,0,0,0,0,0
.quad 0,0,0,0,0,0,0,0,0,0,0,0,0,0,0,0
.quad 0,0,0,0,0,0,0,0,0,0,0,0,0,0,0,0
.quad 0x3400340034003400,0x3400340034003400,0xb4003400b4003400,0xb4003400b4003400,0x3594ab9a349d328b,0xab9ab594328bb49d,0x2b9a3594b28b349d,0x3594ab9a349d328b,0x30e6b519351930e6,0xb0e63519b519b0e6,0x351930e6b0e63519,0xb519b0e630e6b519,0xb17cb4f335702e3c,0x34f3b17cae3c3570,0x34f3b17cae3c3570,0x317c34f3b570ae3c
.quad 0xb59fa8fd359f28fd,0xb59fa8fd359f28fd,0x28fdb59fa8fd359f,0x28fdb59fa8fd359f,0xb385343a35a6a546,0x343a3385a546b5a6,0xb43ab385254635a6,0xb385343a35a6a546,0x2d1835833583ad18,0xad18b583b5832d18,0xb5832d182d183583,0x3583ad18ad18b583,0x353c304c3538b05d,0xb04c353c305d3538,0xb04c353c305d3538,0xb53cb04cb538305d
.quad 0x3400340034003400,0x3400340034003400,0xb4003400b4003400,0xb4003400b4003400,0xb5942b9ab49db28b,0x2b9a3594b28b349d,0xab9ab594328bb49d,0xb5942b9ab49db28b,0x30e6b519351930e6,0xb0e63519b519b0e6,0x351930e6b0e63519,0xb519b0e630e6b519,0x317c34f3b570ae3c,0xb4f3317c2e3cb570,0xb4f3317c2e3cb570,0xb17cb4f335702e3c
.quad 0xb59fa8fd359f28fd,0xb59fa8fd359f28fd,0x28fdb59fa8fd359f,0x28fdb59fa8fd359f,0x3385b43ab5a62546,0xb43ab385254635a6,0x343a3385a546b5a6,0x3385b43ab5a62546,0x2d1835833583ad18,0xad18b583b5832d18,0xb5832d182d183583,0x3583ad18ad18b583,0xb53cb04cb538305d,0x304cb53cb05db538,0x304cb53cb05db538,0x353c304c3538b05d
.quad 0,0,0,0,0,0,0,0,0,0,0,0,0,0,0,0
.quad 0,0,0,0,0,0,0,0,0,0,0,0,0,0,0,0
.quad 0,0,0,0,0,0,0,0,0,0,0,0,0,0,0,0
.quad 0,0,0,0,0,0,0,0,0,0,0,0,0,0,0,0
.quad 0x3400340034003400,0x3400340034003400,0xb4003400b4003400,0xb4003400b4003400,0x3593abbd34a03284,0xabbdb5933284b4a0,0x2bbd3593b28434a0,0x3593abbd34a03284,0x30d6b51d351d30d6,0xb0d6351db51db0d6,0x351d30d6b0d6351d,0xb51db0d630d6b51d,0xb194b4ec35742e09,0x34ecb194ae093574,0x34ecb194ae093574,0x319434ecb574ae09
.quad 0xb5a1a87035a12870,0xb5a1a87035a12870,0x2870b5a1a87035a1,0x2870b5a1a87035a1,0xb364344935a4a6a9,0x34493364a6a9b5a4,0xb449b36426a935a4,0xb364344935a4a6a9,0x2d7f357d357dad7f,0xad7fb57db57d2d7f,0xb57d2d7f2d7f357d,0x357dad7fad7fb57d,0x35473012352cb096,0xb01235473096352c,0xb01235473096352c,0xb547b012b52c3096
.quad 0x3400340034003400,0x3400340034003400,0xb4003400b4003400,0xb4003400b4003400,0xb5932bbdb4a0b284,0x2bbd3593b28434a0,0xabbdb5933284b4a0,0xb5932bbdb4a0b284,0x30d6b51d351d30d6,0xb0d6351db51db0d6,0x351d30d6b0d6351d,0xb51db0d630d6b51d,0x319434ecb574ae09,0xb4ec31942e09b574,0xb4ec31942e09b574,0xb194b4ec35742e09
.quad 0xb5a1a87035a12870,0xb5a1a87035a12870,0x2870b5a1a87035a1,0x2870b5a1a87035a1,0x3364b449b5a426a9,0xb449b36426a935a4,0x34493364a6a9b5a4,0x3364b449b5a426a9,0x2d7f357d357dad7f,0xad7fb57db57d2d7f,0xb57d2d7f2d7f357d,0x357dad7fad7fb57d,0xb547b012b52c3096,0x3012b547b096b52c,0x3012b547b096b52c,0x35473012352cb096
.quad 0,0,0,0,0,0,0,0,0,0,0,0,0,0,0,0
.quad 0,0,0,0,0,0,0,0,0,0,0,0,0,0,0,0
.quad 0,0,0,0,0,0,0,0,0,0,0,0,0,0,0,0
.quad 0,0,0,0,0,0,0,0,0,0,0,0,0,0,0,0
.quad 0x3400340034003400,0x3400340034003400,0xb4003400b4003400,0xb4003400b4003400,0x3592abe034a3327c,0xabe0b592327cb4a3,0x2be03592b27c34a3,0x3592abe034a3327c,0x30c6b521352130c6,0xb0c63521b521b0c6,0x352130c6b0c63521,0xb521b0c630c6b521,0xb1abb4e535772dd6,0x34e5b1abadd63577,0x34e5b1abadd63577,0x31ab34e5b577add6
.quad 0xb5a3a7c435a327c4,0xb5a3a7c435a327c4,0x27c4b5a3a7c435a3,0x27c4b5a3a7c435a3,0xb342345735a2a805,0x34573342a805b5a2,0xb457b342280535a2,0xb342345735a2a805,0x2de735763576ade7,0xade7b576b5762de7,0xb5762de72de73576,0x3576ade7ade7b576,0x35522fb0351fb0ce,0xafb0355230ce351f,0xafb0355230ce351f,0xb552afb0b51f30ce
.quad 0x3400340034003400,0x3400340034003400,0xb4003400b4003400,0xb4003400b4003400,0xb5922be0b4a3b27c,0x2be03592b27c34a3,0xabe0b592327cb4a3,0xb5922be0b4a3b27c,0x30c6b521352130c6,0xb0c63521b521b0c6,0x352130c6b0c63521,0xb521b0c630c6b521,0x31ab34e5b577add6,0xb4e531ab2dd6b577,0xb4e531ab2dd6b577,0xb1abb4e535772dd6
.quad 0xb5a3a7c435a327c4,0xb5a3a7c435a327c4,0x27c4b5a3a7c435a3,0x27c4b5a3a7c435a3,0x3342b457b5a22805,0xb457b342280535a2,0x34573342a805b5a2,0x3342b457b5a22805,0x2de735763576ade7,0xade7b576b5762de7,0xb5762de72de73576,0x3576ade7ade7b576,0xb552afb0b51f30ce,0x2fb0b552b0ceb51f,0x2fb0b552b0ceb51f,0x35522fb0351fb0ce
.quad 0,0,0,0,0,0,0,0,0,0,0,0,0,0,0,0
.quad 0,0,0,0,0,0,0,0,0,0,0,0,0,0,0,0
.quad 0,0,0,0,0,0,0,0,0,0,0,0,0,0,0,0
.quad 0,0,0,0,0,0,0,0,0,0,0,0,0,0,0,0
.quad 0x3400340034003400,0x3400340034003400,0xb4003400b4003400,0xb4003400b4003400,0x3591ac0134a53275,0xac01b5913275b4a5,0x2c013591b27534a5,0x3591ac0134a53275,0x30b6b525352530b6,0xb0b63525b525b0b6,0x352530b6b0b63525,0xb525b0b630b6b525,0xb1c2b4df357b2da2,0x34dfb1c2ada2357b,0x34dfb1c2ada2357b,0x31c234dfb57bada2
.quad 0xb5a4a6a935a426a9,0xb5a4a6a935a426a9,0x26a9b5a4a6a935a4,0x26a9b5a4a6a935a4,0xb320346535a0a8b6,0x34653320a8b6b5a0,0xb465b32028b635a0,0xb320346535a0a8b6,0x2e4d356f356fae4d,0xae4db56fb56f2e4d,0xb56f2e4d2e4d356f,0x356fae4dae4db56f,0x355c2f3b3511b106,0xaf3b355c31063511,0xaf3b355c31063511,0xb55caf3bb5113106
.quad 0x3400340034003400,0x3400340034003400,0xb4003400b4003400,0xb4003400b4003400,0xb5912c01b4a5b275,0x2c013591b27534a5,0xac01b5913275b4a5,0xb5912c01b4a5b275,0x30b6b525352530b6,0xb0b63525b525b0b6,0x352530b6b0b63525,0xb525b0b630b6b525,0x31c234dfb57bada2,0xb4df31c22da2b57b,0xb4df31c22da2b57b,0xb1c2b4df357b2da2
.quad 0xb5a4a6a935a426a9,0xb5a4a6a935a426a9,0x26a9b5a4a6a935a4,0x26a9b5a4a6a935a4,0x3320b465b5a028b6,0xb465b32028b635a0,0x34653320a8b6b5a0,0x3320b465b5a028b6,0x2e4d356f356fae4d,0xae4db56fb56f2e4d,0xb56f2e4d2e4d356f,0x356fae4dae4db56f,0xb55caf3bb5113106,0x2f3bb55cb106b511,0x2f3bb55cb106b511,0x355c2f3b3511b106
.quad 0,0,0,0,0,0,0,0,0,0,0,0,0,0,0,0
.quad 0,0,0,0,0,0,0,0,0,0,0,0,0,0,0,0
.quad 0,0,0,0,0,0,0,0,0,0,0,0,0,0,0,0
.quad 0,0,0,0,0,0,0,0,0,0,0,0,0,0,0,0
.quad 0x3400340034003400,0x3400340034003400,0xb4003400b4003400,0xb4003400b4003400,0x3590ac1334a8326e,0xac13b590326eb4a8,0x2c133590b26e34a8,0x3590ac1334a8326e,0x30a6b528352830a6,0xb0a63528b528b0a6,0x352830a6b0a63528,0xb528b0a630a6b528,0xb1d9b4d8357e2d6e,0x34d8b1d9ad6e357e,0x34d8b1d9ad6e357e,0x31d934d8b57ead6e
.quad 0xb5a5a58d35a5258d,0xb5a5a58d35a5258d,0x258db5a5a58d35a5,0x258db5a5a58d35a5,0xb2fd3473359ea967,0x347332fda967b59e,0xb473b2fd2967359e,0xb2fd3473359ea967,0x2eb335673567aeb3,0xaeb3b567b5672eb3,0xb5672eb32eb33567,0x3567aeb3aeb3b567,0x35662ec43503b13e,0xaec43566313e3503,0xaec43566313e3503,0xb566aec4b503313e
.quad 0x3400340034003400,0x3400340034003400,0xb4003400b4003400,0xb4003400b4003400,0xb5902c13b4a8b26e,0x2c133590b26e34a8,0xac13b590326eb4a8,0xb5902c13b4a8b26e,0x30a6b528352830a6,0xb0a63528b528b0a6,0x352830a6b0a63528,0xb528b0a630a6b528,0x31d934d8b57ead6e,0xb4d831d92d6eb57e,0xb4d831d92d6eb57e,0xb1d9b4d8357e2d6e
.quad 0xb5a5a58d35a5258d,0xb5a5a58d35a5258d,0x258db5a5a58d35a5,0x258db5a5a58d35a5,0x32fdb473b59e2967,0xb473b2fd2967359e,0x347332fda967b59e,0x32fdb473b59e2967,0x2eb335673567aeb3,0xaeb3b567b5672eb3,0xb5672eb32eb33567,0x3567aeb3aeb3b567,0xb566aec4b503313e,0x2ec4b566b13eb503,0x2ec4b566b13eb503,0x35662ec43503b13e
.quad 0,0,0,0,0,0,0,0,0,0,0,0,0,0,0,0
.quad 0,0,0,0,0,0,0,0,0,0,0,0,0,0,0,0
.quad 0,0,0,0,0,0,0,0,0,0,0,0,0,0,0,0
.quad 0,0,0,0,0,0,0,0,0,0,0,0,0,0,0,0
.quad 0x3400340034003400,0x3400340034003400,0xb4003400b4003400,0xb4003400b4003400,0x3590ac2434aa3267,0xac24b5903267b4aa,0x2c243590b26734aa,0x3590ac2434aa3267,0x3096b52c352c3096,0xb096352cb52cb096,0x352c3096b096352c,0xb52cb0963096b52c,0xb1efb4d135812d3a,0x34d1b1efad3a3581,0x34d1b1efad3a3581,0x31ef34d1b581ad3a
.quad 0xb5a6a47135a62471,0xb5a6a47135a62471,0x2471b5a6a47135a6,0x2471b5a6a47135a6,0xb2da3480359baa17,0x348032daaa17b59b,0xb480b2da2a17359b,0xb2da3480359baa17,0x2f19355f355faf19,0xaf19b55fb55f2f19,0xb55f2f192f19355f,0x355faf19af19b55f,0x356f2e4d34f5b175,0xae4d356f317534f5,0xae4d356f317534f5,0xb56fae4db4f53175
.quad 0x3400340034003400,0x3400340034003400,0xb4003400b4003400,0xb4003400b4003400,0xb5902c24b4aab267,0x2c243590b26734aa,0xac24b5903267b4aa,0xb5902c24b4aab267,0x3096b52c352c3096,0xb096352cb52cb096,0x352c3096b096352c,0xb52cb0963096b52c,0x31ef34d1b581ad3a,0xb4d131ef2d3ab581,0xb4d131ef2d3ab581,0xb1efb4d135812d3a
.quad 0xb5a6a47135a62471,0xb5a6a47135a62471,0x2471b5a6a47135a6,0x2471b5a6a47135a6,0x32dab480b59b2a17,0xb480b2da2a17359b,0x348032daaa17b59b,0x32dab480b59b2a17,0x2f19355f355faf19,0xaf19b55fb55f2f19,0xb55f2f192f19355f,0x355faf19af19b55f,0xb56fae4db4f53175,0x2e4db56fb175b4f5,0x2e4db56fb175b4f5,0x356f2e4d34f5b175
.quad 0,0,0,0,0,0,0,0,0,0,0,0,0,0,0,0
.quad 0,0,0,0,0,0,0,0,0,0,0,0,0,0,0,0
.quad 0,0,0,0,0,0,0,0,0,0,0,0,0,0,0,0
.quad 0,0,0,0,0,0,0,0,0,0,0,0,0,0,0,0
.quad 0x3400340034003400,0x3400340034003400,0xb4003400b4003400,0xb4003400b4003400,0x358fac3634ad325f,0xac36b58f325fb4ad,0x2c36358fb25f34ad,0x358fac3634ad325f,0x3085b52f352f3085,0xb085352fb52fb085,0x352f3085b085352f,0xb52fb0853085b52f,0xb206b4ca35842d07,0x34cab206ad073584,0x34cab206ad073584,0x320634cab584ad07
.quad 0xb5a7a2aa35a722aa,0xb5a7a2aa35a722aa,0x22aab5a7a2aa35a7,0x22aab5a7a2aa35a7,0xb2b6348e3598aac7,0x348e32b6aac7b598,0xb48eb2b62ac73598,0xb2b6348e3598aac7,0x2f7e35563556af7e,0xaf7eb556b5562f7e,0xb5562f7e2f7e3556,0x3556af7eaf7eb556,0x35772dd634e5b1ab,0xadd6357731ab34e5,0xadd6357731ab34e5,0xb577add6b4e531ab
.quad 0x3400340034003400,0x3400340034003400,0xb4003400b4003400,0xb4003400b4003400,0xb58f2c36b4adb25f,0x2c36358fb25f34ad,0xac36b58f325fb4ad,0xb58f2c36b4adb25f,0x3085b52f352f3085,0xb085352fb52fb085,0x352f3085b085352f,0xb52fb0853085b52f,0x320634cab584ad07,0xb4ca32062d07b584,0xb4ca32062d07b584,0xb206b4ca35842d07
.quad 0xb5a7a2aa35a722aa,0xb5a7a2aa35a722aa,0x22aab5a7a2aa35a7,0x22aab5a7a2aa35a7,0x32b6b48eb5982ac7,0xb48eb2b62ac73598,0x348e32b6aac7b598,0x32b6b48eb5982ac7,0x2f7e35563556af7e,0xaf7eb556b5562f7e,0xb5562f7e2f7e3556,0x3556af7eaf7eb556,0xb577add6b4e531ab,0x2dd6b577b1abb4e5,0x2dd6b577b1abb4e5,0x35772dd634e5b1ab
.quad 0,0,0,0,0,0,0,0,0,0,0,0,0,0,0,0
.quad 0,0,0,0,0,0,0,0,0,0,0,0,0,0,0,0
.quad 0,0,0,0,0,0,0,0,0,0,0,0,0,0,0,0
.quad 0,0,0,0,0,0,0,0,0,0,0,0,0,0,0,0
.quad 0x3400340034003400,0x3400340034003400,0xb4003400b4003400,0xb4003400b4003400,0x358eac4734af3258,0xac47b58e3258b4af,0x2c47358eb25834af,0x358eac4734af3258,0x3075b53335333075,0xb0753533b533b075,0x35333075b0753533,0xb533b0753075b533,0xb21db4c335872cd2,0x34c3b21dacd23587,0x34c3b21dacd23587,0x321d34c3b587acd2
.quad 0xb5a8a07135a82071,0xb5a8a07135a82071,0x2071b5a8a07135a8,0x2071b5a8a07135a8,0xb292349b3594ab77,0x349b3292ab77b594,0xb49bb2922b773594,0xb292349b3594ab77,0x2fe2354d354dafe2,0xafe2b54db54d2fe2,0xb54d2fe22fe2354d,0x354dafe2afe2b54d,0x357f2d5d34d6b1e0,0xad5d357f31e034d6,0xad5d357f31e034d6,0xb57fad5db4d631e0
.quad 0x3400340034003400,0x3400340034003400,0xb4003400b4003400,0xb4003400b4003400,0xb58e2c47b4afb258,0x2c47358eb25834af,0xac47b58e3258b4af,0xb58e2c47b4afb258,0x3075b53335333075,0xb0753533b533b075,0x35333075b0753533,0xb533b0753075b533,0x321d34c3b587acd2,0xb4c3321d2cd2b587,0xb4c3321d2cd2b587,0xb21db4c335872cd2
.quad 0xb5a8a07135a82071,0xb5a8a07135a82071,0x2071b5a8a07135a8,0x2071b5a8a07135a8,0x3292b49bb5942b77,0xb49bb2922b773594,0x349b3292ab77b594,0x3292b49bb5942b77,0x2fe2354d354dafe2,0xafe2b54db54d2fe2,0xb54d2fe22fe2354d,0x354dafe2afe2b54d,0xb57fad5db4d631e0,0x2d5db57fb1e0b4d6,0x2d5db57fb1e0b4d6,0x357f2d5d34d6b1e0
.quad 0,0,0,0,0,0,0,0,0,0,0,0,0,0,0,0
.quad 0,0,0,0,0,0,0,0,0,0,0,0,0,0,0,0
.quad 0,0,0,0,0,0,0,0,0,0,0,0,0,0,0,0
.quad 0,0,0,0,0,0,0,0,0,0,0,0,0,0,0,0
.quad 0x3400340034003400,0x3400340034003400,0xb4003400b4003400,0xb4003400b4003400,0x358dac5934b23250,0xac59b58d3250b4b2,0x2c59358db25034b2,0x358dac5934b23250,0x3065b53635363065,0xb0653536b536b065,0x35363065b0653536,0xb536b0653065b536,0xb233b4bb358a2c9e,0x34bbb233ac9e358a,0x34bbb233ac9e358a,0x323334bbb58aac9e
.quad 0xb5a89c7135a81c71,0xb5a89c7135a81c71,0x1c71b5a89c7135a8,0x1c71b5a89c7135a8,0xb26e34a83590ac13,0x34a8326eac13b590,0xb4a8b26e2c133590,0xb26e34a83590ac13,0x302335443544b023,0xb023b544b5443023,0xb544302330233544,0x3544b023b023b544,0x35862ce434c5b215,0xace43586321534c5,0xace43586321534c5,0xb586ace4b4c53215
.quad 0x3400340034003400,0x3400340034003400,0xb4003400b4003400,0xb4003400b4003400,0xb58d2c59b4b2b250,0x2c59358db25034b2,0xac59b58d3250b4b2,0xb58d2c59b4b2b250,0x3065b53635363065,0xb0653536b536b065,0x35363065b0653536,0xb536b0653065b536,0x323334bbb58aac9e,0xb4bb32332c9eb58a,0xb4bb32332c9eb58a,0xb233b4bb358a2c9e
.quad 0xb5a89c7135a81c71,0xb5a89c7135a81c71,0x1c71b5a89c7135a8,0x1c71b5a89c7135a8,0x326eb4a8b5902c13,0xb4a8b26e2c133590,0x34a8326eac13b590,0x326eb4a8b5902c13,0x302335443544b023,0xb023b544b5443023,0xb544302330233544,0x3544b023b023b544,0xb586ace4b4c53215,0x2ce4b586b215b4c5,0x2ce4b586b215b4c5,0x35862ce434c5b215
.quad 0,0,0,0,0,0,0,0,0,0,0,0,0,0,0,0
.quad 0,0,0,0,0,0,0,0,0,0,0,0,0,0,0,0
.quad 0,0,0,0,0,0,0,0,0,0,0,0,0,0,0,0
.quad 0,0,0,0,0,0,0,0,0,0,0,0,0,0,0,0
.quad 0x3400340034003400,0x3400340034003400,0xb4003400b4003400,0xb4003400b4003400,0x358cac6a34b43249,0xac6ab58c3249b4b4,0x2c6a358cb24934b4,0x358cac6a34b43249,0x3054b53a353a3054,0xb054353ab53ab054,0x353a3054b054353a,0xb53ab0543054b53a,0xb249b4b4358c2c6a,0x34b4b249ac6a358c,0x34b4b249ac6a358c,0x324934b4b58cac6a
.quad 0xb5a8800035a80000,0xb5a8800035a80000,0xb5a8000035a8,0xb5a8800035a8,0xb24934b4358cac6a,0x34b43249ac6ab58c,0xb4b4b2492c6a358c,0xb24934b4358cac6a,0x3054353a353ab054,0xb054b53ab53a3054,0xb53a30543054353a,0x353ab054b054b53a,0x358c2c6a34b4b249,0xac6a358c324934b4,0xac6a358c324934b4,0xb58cac6ab4b43249
.quad 0x3400340034003400,0x3400340034003400,0xb4003400b4003400,0xb4003400b4003400,0xb58c2c6ab4b4b249,0x2c6a358cb24934b4,0xac6ab58c3249b4b4,0xb58c2c6ab4b4b249,0x3054b53a353a3054,0xb054353ab53ab054,0x353a3054b054353a,0xb53ab0543054b53a,0x324934b4b58cac6a,0xb4b432492c6ab58c,0xb4b432492c6ab58c,0xb249b4b4358c2c6a
.quad 0xb5a8800035a80000,0xb5a8800035a88000,0xb5a8800035a8,0xb5a8800035a8,0x3249b4b4b58c2c6a,0xb4b4b2492c6a358c,0x34b43249ac6ab58c,0x3249b4b4b58c2c6a,0x3054353a353ab054,0xb054b53ab53a3054,0xb53a30543054353a,0x353ab054b054b53a,0xb58cac6ab4b43249,0x2c6ab58cb249b4b4,0x2c6ab58cb249b4b4,0x358c2c6a34b4b249
.quad 0,0,0,0,0,0,0,0,0,0,0,0,0,0,0,0
.quad 0,0,0,0,0,0,0,0,0,0,0,0,0,0,0,0
.quad 0,0,0,0,0,0,0,0,0,0,0,0,0,0,0,0
.quad 0,0,0,0,0,0,0,0,0,0,0,0,0,0,0,0
.quad 0x3400340034003400,0x3400340034003400,0xb4003400b4003400,0xb4003400b4003400,0x358bac7c34b73242,0xac7cb58b3242b4b7,0x2c7c358bb24234b7,0x358bac7c34b73242,0x3044b53d353d3044,0xb044353db53db044,0x353d3044b044353d,0xb53db0443044b53d,0xb25fb4ad358f2c36,0x34adb25fac36358f,0x34adb25fac36358f,0x325f34adb58fac36
.quad 0xb5a81c7135a89c71,0xb5a81c7135a89c71,0x9c71b5a81c7135a8,0x9c71b5a81c7135a8,0xb22434c03588acc1,0x34c03224acc1b588,0xb4c0b2242cc13588,0xb22434c03588acc1,0x3085352f352fb085,0xb085b52fb52f3085,0xb52f30853085352f,0x352fb085b085b52f,0x35922be034a3b27c,0xabe03592327c34a3,0xabe03592327c34a3,0xb592abe0b4a3327c
.quad 0x3400340034003400,0x3400340034003400,0xb4003400b4003400,0xb4003400b4003400,0xb58b2c7cb4b7b242,0x2c7c358bb24234b7,0xac7cb58b3242b4b7,0xb58b2c7cb4b7b242,0x3044b53d353d3044,0xb044353db53db044,0x353d3044b044353d,0xb53db0443044b53d,0x325f34adb58fac36,0xb4ad325f2c36b58f,0xb4ad325f2c36b58f,0xb25fb4ad358f2c36
.quad 0xb5a81c7135a89c71,0xb5a81c7135a89c71,0x9c71b5a81c7135a8,0x9c71b5a81c7135a8,0x3224b4c0b5882cc1,0xb4c0b2242cc13588,0x34c03224acc1b588,0x3224b4c0b5882cc1,0x3085352f352fb085,0xb085b52fb52f3085,0xb52f30853085352f,0x352fb085b085b52f,0xb592abe0b4a3327c,0x2be0b592b27cb4a3,0x2be0b592b27cb4a3,0x35922be034a3b27c
.quad 0,0,0,0,0,0,0,0,0,0,0,0,0,0,0,0
.quad 0,0,0,0,0,0,0,0,0,0,0,0,0,0,0,0
.quad 0,0,0,0,0,0,0,0,0,0,0,0,0,0,0,0
.quad 0,0,0,0,0,0,0,0,0,0,0,0,0,0,0,0
.quad 0x3400340034003400,0x3400340034003400,0xb4003400b4003400,0xb4003400b4003400,0x358bac8d34b9323a,0xac8db58b323ab4b9,0x2c8d358bb23a34b9,0x358bac8d34b9323a,0x3033b54135413033,0xb0333541b541b033,0x35413033b0333541,0xb541b0333033b541,0xb275b4a535912c01,0x34a5b275ac013591,0x34a5b275ac013591,0x327534a5b591ac01
.quad 0xb5a8207135a8a071,0xb5a8207135a8a071,0xa071b5a8207135a8,0xa071b5a8207135a8,0xb1fe34cc3583ad18,0x34cc31fead18b583,0xb4ccb1fe2d183583,0xb1fe34cc3583ad18,0x30b635253525b0b6,0xb0b6b525b52530b6,0xb52530b630b63525,0x3525b0b6b0b6b525,0x35972aea3490b2af,0xaaea359732af3490,0xaaea359732af3490,0xb597aaeab49032af
.quad 0x3400340034003400,0x3400340034003400,0xb4003400b4003400,0xb4003400b4003400,0xb58b2c8db4b9b23a,0x2c8d358bb23a34b9,0xac8db58b323ab4b9,0xb58b2c8db4b9b23a,0x3033b54135413033,0xb0333541b541b033,0x35413033b0333541,0xb541b0333033b541,0x327534a5b591ac01,0xb4a532752c01b591,0xb4a532752c01b591,0xb275b4a535912c01
.quad 0xb5a8207135a8a071,0xb5a8207135a8a071,0xa071b5a8207135a8,0xa071b5a8207135a8,0x31feb4ccb5832d18,0xb4ccb1fe2d183583,0x34cc31fead18b583,0x31feb4ccb5832d18,0x30b635253525b0b6,0xb0b6b525b52530b6,0xb52530b630b63525,0x3525b0b6b0b6b525,0xb597aaeab49032af,0x2aeab597b2afb490,0x2aeab597b2afb490,0x35972aea3490b2af
.quad 0,0,0,0,0,0,0,0,0,0,0,0,0,0,0,0
.quad 0,0,0,0,0,0,0,0,0,0,0,0,0,0,0,0
.quad 0,0,0,0,0,0,0,0,0,0,0,0,0,0,0,0
.quad 0,0,0,0,0,0,0,0,0,0,0,0,0,0,0,0
.quad 0x3400340034003400,0x3400340034003400,0xb4003400b4003400,0xb4003400b4003400,0x358aac9e34bb3233,0xac9eb58a3233b4bb,0x2c9e358ab23334bb,0x358aac9e34bb3233,0x3023b54435443023,0xb0233544b544b023,0x35443023b0233544,0xb544b0233023b544,0xb28bb49d35942b9a,0x349db28bab9a3594,0x349db28bab9a3594,0x328b349db594ab9a
.quad 0xb5a722aa35a7a2aa,0xb5a722aa35a7a2aa,0xa2aab5a722aa35a7,0xa2aab5a722aa35a7,0xb1d934d8357ead6e,0x34d831d9ad6eb57e,0xb4d8b1d92d6e357e,0xb1d934d8357ead6e,0x30e635193519b0e6,0xb0e6b519b51930e6,0xb51930e630e63519,0x3519b0e6b0e6b519,0x359c29f4347eb2e1,0xa9f4359c32e1347e,0xa9f4359c32e1347e,0xb59ca9f4b47e32e1
.quad 0x3400340034003400,0x3400340034003400,0xb4003400b4003400,0xb4003400b4003400,0xb58a2c9eb4bbb233,0x2c9e358ab23334bb,0xac9eb58a3233b4bb,0xb58a2c9eb4bbb233,0x3023b54435443023,0xb0233544b544b023,0x35443023b0233544,0xb544b0233023b544,0x328b349db594ab9a,0xb49d328b2b9ab594,0xb49d328b2b9ab594,0xb28bb49d35942b9a
.quad 0xb5a722aa35a7a2aa,0xb5a722aa35a7a2aa,0xa2aab5a722aa35a7,0xa2aab5a722aa35a7,0x31d9b4d8b57e2d6e,0xb4d8b1d92d6e357e,0x34d831d9ad6eb57e,0x31d9b4d8b57e2d6e,0x30e635193519b0e6,0xb0e6b519b51930e6,0xb51930e630e63519,0x3519b0e6b0e6b519,0xb59ca9f4b47e32e1,0x29f4b59cb2e1b47e,0x29f4b59cb2e1b47e,0x359c29f4347eb2e1
.quad 0,0,0,0,0,0,0,0,0,0,0,0,0,0,0,0
.quad 0,0,0,0,0,0,0,0,0,0,0,0,0,0,0,0
.quad 0,0,0,0,0,0,0,0,0,0,0,0,0,0,0,0
.quad 0,0,0,0,0,0,0,0,0,0,0,0,0,0,0,0
.quad 0x3400340034003400,0x3400340034003400,0xb4003400b4003400,0xb4003400b4003400,0x3589acb034be322b,0xacb0b589322bb4be,0x2cb03589b22b34be,0x3589acb034be322b,0x3012b54735473012,0xb0123547b547b012,0x35473012b0123547,0xb547b0123012b547,0xb2a1b49635962b30,0x3496b2a1ab303596,0x3496b2a1ab303596,0x32a13496b596ab30
.quad 0xb5a6247135a6a471,0xb5a6247135a6a471,0xa471b5a6247135a6,0xa471b5a6247135a6,0xb1b234e33578adc4,0x34e331b2adc4b578,0xb4e3b1b22dc43578,0xb1b234e33578adc4,0x3116350e350eb116,0xb116b50eb50e3116,0xb50e31163116350e,0x350eb116b116b50e,0x359f28fd346bb312,0xa8fd359f3312346b,0xa8fd359f3312346b,0xb59fa8fdb46b3312
.quad 0x3400340034003400,0x3400340034003400,0xb4003400b4003400,0xb4003400b4003400,0xb5892cb0b4beb22b,0x2cb03589b22b34be,0xacb0b589322bb4be,0xb5892cb0b4beb22b,0x3012b54735473012,0xb0123547b547b012,0x35473012b0123547,0xb547b0123012b547,0x32a13496b596ab30,0xb49632a12b30b596,0xb49632a12b30b596,0xb2a1b49635962b30
.quad 0xb5a6247135a6a471,0xb5a6247135a6a471,0xa471b5a6247135a6,0xa471b5a6247135a6,0x31b2b4e3b5782dc4,0xb4e3b1b22dc43578,0x34e331b2adc4b578,0x31b2b4e3b5782dc4,0x3116350e350eb116,0xb116b50eb50e3116,0xb50e31163116350e,0x350eb116b116b50e,0xb59fa8fdb46b3312,0x28fdb59fb312b46b,0x28fdb59fb312b46b,0x359f28fd346bb312
.quad 0,0,0,0,0,0,0,0,0,0,0,0,0,0,0,0
.quad 0,0,0,0,0,0,0,0,0,0,0,0,0,0,0,0
.quad 0,0,0,0,0,0,0,0,0,0,0,0,0,0,0,0
.quad 0,0,0,0,0,0,0,0,0,0,0,0,0,0,0,0
.quad 0x3400340034003400,0x3400340034003400,0xb4003400b4003400,0xb4003400b4003400,0x3588acc134c03224,0xacc1b5883224b4c0,0x2cc13588b22434c0,0x3588acc134c03224,0x3002b54a354a3002,0xb002354ab54ab002,0x354a3002b002354a,0xb54ab0023002b54a,0xb2b6b48e35982ac7,0x348eb2b6aac73598,0x348eb2b6aac73598,0x32b6348eb598aac7
.quad 0xb5a5258d35a5a58d,0xb5a5258d35a5a58d,0xa58db5a5258d35a5,0xa58db5a5258d35a5,0xb18c34ee3573ae1a,0x34ee318cae1ab573,0xb4eeb18c2e1a3573,0xb18c34ee3573ae1a,0x314635013501b146,0xb146b501b5013146,0xb501314631463501,0x3501b146b146b501,0x35a228053457b342,0xa80535a233423457,0xa80535a233423457,0xb5a2a805b4573342
.quad 0x3400340034003400,0x3400340034003400,0xb4003400b4003400,0xb4003400b4003400,0xb5882cc1b4c0b224,0x2cc13588b22434c0,0xacc1b5883224b4c0,0xb5882cc1b4c0b224,0x3002b54a354a3002,0xb002354ab54ab002,0x354a3002b002354a,0xb54ab0023002b54a,0x32b6348eb598aac7,0xb48e32b62ac7b598,0xb48e32b62ac7b598,0xb2b6b48e35982ac7
.quad 0xb5a5258d35a5a58d,0xb5a5258d35a5a58d,0xa58db5a5258d35a5,0xa58db5a5258d35a5,0x318cb4eeb5732e1a,0xb4eeb18c2e1a3573,0x34ee318cae1ab573,0x318cb4eeb5732e1a,0x314635013501b146,0xb146b501b5013146,0xb501314631463501,0x3501b146b146b501,0xb5a2a805b4573342,0x2805b5a2b342b457,0x2805b5a2b342b457,0x35a228053457b342
.quad 0,0,0,0,0,0,0,0,0,0,0,0,0,0,0,0
.quad 0,0,0,0,0,0,0,0,0,0,0,0,0,0,0,0
.quad 0,0,0,0,0,0,0,0,0,0,0,0,0,0,0,0
.quad 0,0,0,0,0,0,0,0,0,0,0,0,0,0,0,0
.quad 0x3400340034003400,0x3400340034003400,0xb4003400b4003400,0xb4003400b4003400,0x3587acd234c3321d,0xacd2b587321db4c3,0x2cd23587b21d34c3,0x3587acd234c3321d,0x2fe2b54d354d2fe2,0xafe2354db54dafe2,0x354d2fe2afe2354d,0xb54dafe22fe2b54d,0xb2ccb486359a2a5e,0x3486b2ccaa5e359a,0x3486b2ccaa5e359a,0x32cc3486b59aaa5e
.quad 0xb5a426a935a4a6a9,0xb5a426a935a4a6a9,0xa6a9b5a426a935a4,0xa6a9b5a426a935a4,0xb16534f9356cae6f,0x34f93165ae6fb56c,0xb4f9b1652e6f356c,0xb16534f9356cae6f,0x317534f534f5b175,0xb175b4f5b4f53175,0xb4f53175317534f5,0x34f5b175b175b4f5,0x35a5261b3443b371,0xa61b35a533713443,0xa61b35a533713443,0xb5a5a61bb4433371
.quad 0x3400340034003400,0x3400340034003400,0xb4003400b4003400,0xb4003400b4003400,0xb5872cd2b4c3b21d,0x2cd23587b21d34c3,0xacd2b587321db4c3,0xb5872cd2b4c3b21d,0x2fe2b54d354d2fe2,0xafe2354db54dafe2,0x354d2fe2afe2354d,0xb54dafe22fe2b54d,0x32cc3486b59aaa5e,0xb48632cc2a5eb59a,0xb48632cc2a5eb59a,0xb2ccb486359a2a5e
.quad 0xb5a426a935a4a6a9,0xb5a426a935a4a6a9,0xa6a9b5a426a935a4,0xa6a9b5a426a935a4,0x3165b4f9b56c2e6f,0xb4f9b1652e6f356c,0x34f93165ae6fb56c,0x3165b4f9b56c2e6f,0x317534f534f5b175,0xb175b4f5b4f53175,0xb4f53175317534f5,0x34f5b175b175b4f5,0xb5a5a61bb4433371,0x261bb5a5b371b443,0x261bb5a5b371b443,0x35a5261b3443b371
.quad 0,0,0,0,0,0,0,0,0,0,0,0,0,0,0,0
.quad 0,0,0,0,0,0,0,0,0,0,0,0,0,0,0,0
.quad 0,0,0,0,0,0,0,0,0,0,0,0,0,0,0,0
.quad 0,0,0,0,0,0,0,0,0,0,0,0,0,0,0,0
.quad 0x3400340034003400,0x3400340034003400,0xb4003400b4003400,0xb4003400b4003400,0x3586ace434c53215,0xace4b5863215b4c5,0x2ce43586b21534c5,0x3586ace434c53215,0x2fc1b55035502fc1,0xafc13550b550afc1,0x35502fc1afc13550,0xb550afc12fc1b550,0xb2e1b47e359c29f4,0x347eb2e1a9f4359c,0x347eb2e1a9f4359c,0x32e1347eb59ca9f4
.quad 0xb5a327c435a3a7c4,0xb5a327c435a3a7c4,0xa7c4b5a327c435a3,0xa7c4b5a327c435a3,0xb13e35033566aec4,0x3503313eaec4b566,0xb503b13e2ec43566,0xb13e35033566aec4,0x31a334e834e8b1a3,0xb1a3b4e8b4e831a3,0xb4e831a331a334e8,0x34e8b1a3b1a3b4e8,0x35a7242a342eb3a0,0xa42a35a733a0342e,0xa42a35a733a0342e,0xb5a7a42ab42e33a0
.quad 0x3400340034003400,0x3400340034003400,0xb4003400b4003400,0xb4003400b4003400,0xb5862ce4b4c5b215,0x2ce43586b21534c5,0xace4b5863215b4c5,0xb5862ce4b4c5b215,0x2fc1b55035502fc1,0xafc13550b550afc1,0x35502fc1afc13550,0xb550afc12fc1b550,0x32e1347eb59ca9f4,0xb47e32e129f4b59c,0xb47e32e129f4b59c,0xb2e1b47e359c29f4
.quad 0xb5a327c435a3a7c4,0xb5a327c435a3a7c4,0xa7c4b5a327c435a3,0xa7c4b5a327c435a3,0x313eb503b5662ec4,0xb503b13e2ec43566,0x3503313eaec4b566,0x313eb503b5662ec4,0x31a334e834e8b1a3,0xb1a3b4e8b4e831a3,0xb4e831a331a334e8,0x34e8b1a3b1a3b4e8,0xb5a7a42ab42e33a0,0x242ab5a7b3a0b42e,0x242ab5a7b3a0b42e,0x35a7242a342eb3a0
.quad 0,0,0,0,0,0,0,0,0,0,0,0,0,0,0,0
.quad 0,0,0,0,0,0,0,0,0,0,0,0,0,0,0,0
.quad 0,0,0,0,0,0,0,0,0,0,0,0,0,0,0,0
.quad 0,0,0,0,0,0,0,0,0,0,0,0,0,0,0,0
.quad 0x3400340034003400,0x3400340034003400,0xb4003400b4003400,0xb4003400b4003400,0x3585acf534c7320e,0xacf5b585320eb4c7,0x2cf53585b20e34c7,0x3585acf534c7320e,0x2f9fb55435542f9f,0xaf9f3554b554af9f,0x35542f9faf9f3554,0xb554af9f2f9fb554,0xb2f6b476359d298a,0x3476b2f6a98a359d,0x3476b2f6a98a359d,0x32f63476b59da98a
.quad 0xb5a1287035a1a870,0xb5a1287035a1a870,0xa870b5a1287035a1,0xa870b5a1287035a1,0xb116350e355faf19,0x350e3116af19b55f,0xb50eb1162f19355f,0xb116350e355faf19,0x31d134da34dab1d1,0xb1d1b4dab4da31d1,0xb4da31d131d134da,0x34dab1d1b1d1b4da,0x35a820713419b3cd,0xa07135a833cd3419,0xa07135a833cd3419,0xb5a8a071b41933cd
.quad 0x3400340034003400,0x3400340034003400,0xb4003400b4003400,0xb4003400b4003400,0xb5852cf5b4c7b20e,0x2cf53585b20e34c7,0xacf5b585320eb4c7,0xb5852cf5b4c7b20e,0x2f9fb55435542f9f,0xaf9f3554b554af9f,0x35542f9faf9f3554,0xb554af9f2f9fb554,0x32f63476b59da98a,0xb47632f6298ab59d,0xb47632f6298ab59d,0xb2f6b476359d298a
.quad 0xb5a1287035a1a870,0xb5a1287035a1a870,0xa870b5a1287035a1,0xa870b5a1287035a1,0x3116b50eb55f2f19,0xb50eb1162f19355f,0x350e3116af19b55f,0x3116b50eb55f2f19,0x31d134da34dab1d1,0xb1d1b4dab4da31d1,0xb4da31d131d134da,0x34dab1d1b1d1b4da,0xb5a8a071b41933cd,0x2071b5a8b3cdb419,0x2071b5a8b3cdb419,0x35a820713419b3cd
.quad 0,0,0,0,0,0,0,0,0,0,0,0,0,0,0,0
.quad 0,0,0,0,0,0,0,0,0,0,0,0,0,0,0,0
.quad 0,0,0,0,0,0,0,0,0,0,0,0,0,0,0,0
.quad 0,0,0,0,0,0,0,0,0,0,0,0,0,0,0,0
.quad 0x3400340034003400,0x3400340034003400,0xb4003400b4003400,0xb4003400b4003400,0x3584ad0734ca3206,0xad07b5843206b4ca,0x2d073584b20634ca,0x3584ad0734ca3206,0x2f7eb55635562f7e,0xaf7e3556b556af7e,0x35562f7eaf7e3556,0xb556af7e2f7eb556,0xb30bb46d359f2920,0x346db30ba920359f,0x346db30ba920359f,0x330b346db59fa920
.quad 0xb59f28fd359fa8fd,0xb59f28fd359fa8fd,0xa8fdb59f28fd359f,0xa8fdb59f28fd359f,0xb0ee35173558af6d,0x351730eeaf6db558,0xb517b0ee2f6d3558,0xb0ee35173558af6d,0x31fe34cc34ccb1fe,0xb1feb4ccb4cc31fe,0xb4cc31fe31fe34cc,0x34ccb1feb1feb4cc,0x35a814713403b3fa,0x947135a833fa3403,0x947135a833fa3403,0xb5a89471b40333fa
.quad 0x3400340034003400,0x3400340034003400,0xb4003400b4003400,0xb4003400b4003400,0xb5842d07b4cab206,0x2d073584b20634ca,0xad07b5843206b4ca,0xb5842d07b4cab206,0x2f7eb55635562f7e,0xaf7e3556b556af7e,0x35562f7eaf7e3556,0xb556af7e2f7eb556,0x330b346db59fa920,0xb46d330b2920b59f,0xb46d330b2920b59f,0xb30bb46d359f2920
.quad 0xb59f28fd359fa8fd,0xb59f28fd359fa8fd,0xa8fdb59f28fd359f,0xa8fdb59f28fd359f,0x30eeb517b5582f6d,0xb517b0ee2f6d3558,0x351730eeaf6db558,0x30eeb517b5582f6d,0x31fe34cc34ccb1fe,0xb1feb4ccb4cc31fe,0xb4cc31fe31fe34cc,0x34ccb1feb1feb4cc,0xb5a89471b40333fa,0x1471b5a8b3fab403,0x1471b5a8b3fab403,0x35a814713403b3fa
.quad 0,0,0,0,0,0,0,0,0,0,0,0,0,0,0,0
.quad 0,0,0,0,0,0,0,0,0,0,0,0,0,0,0,0
.quad 0,0,0,0,0,0,0,0,0,0,0,0,0,0,0,0
.quad 0,0,0,0,0,0,0,0,0,0,0,0,0,0,0,0
.quad 0x3400340034003400,0x3400340034003400,0xb4003400b4003400,0xb4003400b4003400,0x3583ad1834cc31fe,0xad18b58331feb4cc,0x2d183583b1fe34cc,0x3583ad1834cc31fe,0x2f5cb55935592f5c,0xaf5c3559b559af5c,0x35592f5caf5c3559,0xb559af5c2f5cb559,0xb320b46535a028b6,0x3465b320a8b635a0,0x3465b320a8b635a0,0x33203465b5a0a8b6
.quad 0xb59d298a359da98a,0xb59d298a359da98a,0xa98ab59d298a359d,0xa98ab59d298a359d,0xb0c635213550afc1,0x352130c6afc1b550,0xb521b0c62fc13550,0xb0c635213550afc1,0x322b34be34beb22b,0xb22bb4beb4be322b,0xb4be322b322b34be,0x34beb22bb22bb4be,0x35a89eaa33dab413,0x1eaa35a8341333da,0x1eaa35a8341333da,0xb5a81eaab3da3413
.quad 0x3400340034003400,0x3400340034003400,0xb4003400b4003400,0xb4003400b4003400,0xb5832d18b4ccb1fe,0x2d183583b1fe34cc,0xad18b58331feb4cc,0xb5832d18b4ccb1fe,0x2f5cb55935592f5c,0xaf5c3559b559af5c,0x35592f5caf5c3559,0xb559af5c2f5cb559,0x33203465b5a0a8b6,0xb465332028b6b5a0,0xb465332028b6b5a0,0xb320b46535a028b6
.quad 0xb59d298a359da98a,0xb59d298a359da98a,0xa98ab59d298a359d,0xa98ab59d298a359d,0x30c6b521b5502fc1,0xb521b0c62fc13550,0x352130c6afc1b550,0x30c6b521b5502fc1,0x322b34be34beb22b,0xb22bb4beb4be322b,0xb4be322b322b34be,0x34beb22bb22bb4be,0xb5a81eaab3da3413,0x9eaab5a8b413b3da,0x9eaab5a8b413b3da,0x35a89eaa33dab413
.quad 0,0,0,0,0,0,0,0,0,0,0,0,0,0,0,0
.quad 0,0,0,0,0,0,0,0,0,0,0,0,0,0,0,0
.quad 0,0,0,0,0,0,0,0,0,0,0,0,0,0,0,0
.quad 0,0,0,0,0,0,0,0,0,0,0,0,0,0,0,0
.quad 0x3400340034003400,0x3400340034003400,0xb4003400b4003400,0xb4003400b4003400,0x3582ad2934cf31f7,0xad29b58231f7b4cf,0x2d293582b1f734cf,0x3582ad2934cf31f7,0x2f3bb55c355c2f3b,0xaf3b355cb55caf3b,0x355c2f3baf3b355c,0xb55caf3b2f3bb55c,0xb334b45d35a2284c,0x345db334a84c35a2,0x345db334a84c35a2,0x3334345db5a2a84c
.quad 0xb59b2a17359baa17,0xb59b2a17359baa17,0xaa17b59b2a17359b,0xaa17b59b2a17359b,0xb09e352a3549b00a,0x352a309eb00ab549,0xb52ab09e300a3549,0xb09e352a3549b00a,0x325834af34afb258,0xb258b4afb4af3258,0xb4af3258325834af,0x34afb258b258b4af,0x35a7a33833adb428,0x233835a7342833ad,0x233835a7342833ad,0xb5a72338b3ad3428
.quad 0x3400340034003400,0x3400340034003400,0xb4003400b4003400,0xb4003400b4003400,0xb5822d29b4cfb1f7,0x2d293582b1f734cf,0xad29b58231f7b4cf,0xb5822d29b4cfb1f7,0x2f3bb55c355c2f3b,0xaf3b355cb55caf3b,0x355c2f3baf3b355c,0xb55caf3b2f3bb55c,0x3334345db5a2a84c,0xb45d3334284cb5a2,0xb45d3334284cb5a2,0xb334b45d35a2284c
.quad 0xb59b2a17359baa17,0xb59b2a17359baa17,0xaa17b59b2a17359b,0xaa17b59b2a17359b,0x309eb52ab549300a,0xb52ab09e300a3549,0x352a309eb00ab549,0x309eb52ab549300a,0x325834af34afb258,0xb258b4afb4af3258,0xb4af3258325834af,0x34afb258b258b4af,0xb5a72338b3ad3428,0xa338b5a7b428b3ad,0xa338b5a7b428b3ad,0x35a7a33833adb428
.quad 0,0,0,0,0,0,0,0,0,0,0,0,0,0,0,0
.quad 0,0,0,0,0,0,0,0,0,0,0,0,0,0,0,0
.quad 0,0,0,0,0,0,0,0,0,0,0,0,0,0,0,0
.quad 0,0,0,0,0,0,0,0,0,0,0,0,0,0,0,0
.quad 0x3400340034003400,0x3400340034003400,0xb4003400b4003400,0xb4003400b4003400,0x3581ad3a34d131ef,0xad3ab58131efb4d1,0x2d3a3581b1ef34d1,0x3581ad3a34d131ef,0x2f19b55f355f2f19,0xaf19355fb55faf19,0x355f2f19af19355f,0xb55faf192f19b55f,0xb349b45435a327c4,0x3454b349a7c435a3,0x3454b349a7c435a3,0x33493454b5a3a7c4
.quad 0xb5982aa43598aaa4,0xb5982aa43598aaa4,0xaaa4b5982aa43598,0xaaa4b5982aa43598,0xb07535333541b033,0x35333075b033b541,0xb533b07530333541,0xb07535333541b033,0x328434a034a0b284,0xb284b4a0b4a03284,0xb4a03284328434a0,0x34a0b284b284b4a0,0x35a5a58d337fb43d,0x258d35a5343d337f,0x258d35a5343d337f,0xb5a5258db37f343d
.quad 0x3400340034003400,0x3400340034003400,0xb4003400b4003400,0xb4003400b4003400,0xb5812d3ab4d1b1ef,0x2d3a3581b1ef34d1,0xad3ab58131efb4d1,0xb5812d3ab4d1b1ef,0x2f19b55f355f2f19,0xaf19355fb55faf19,0x355f2f19af19355f,0xb55faf192f19b55f,0x33493454b5a3a7c4,0xb454334927c4b5a3,0xb454334927c4b5a3,0xb349b45435a327c4
.quad 0xb5982aa43598aaa4,0xb5982aa43598aaa4,0xaaa4b5982aa43598,0xaaa4b5982aa43598,0x3075b533b5413033,0xb533b07530333541,0x35333075b033b541,0x3075b533b5413033,0x328434a034a0b284,0xb284b4a0b4a03284,0xb4a03284328434a0,0x34a0b284b284b4a0,0xb5a5258db37f343d,0xa58db5a5b43db37f,0xa58db5a5b43db37f,0x35a5a58d337fb43d
.quad 0,0,0,0,0,0,0,0,0,0,0,0,0,0,0,0
.quad 0,0,0,0,0,0,0,0,0,0,0,0,0,0,0,0
.quad 0,0,0,0,0,0,0,0,0,0,0,0,0,0,0,0
.quad 0,0,0,0,0,0,0,0,0,0,0,0,0,0,0,0
.quad 0x3400340034003400,0x3400340034003400,0xb4003400b4003400,0xb4003400b4003400,0x3580ad4c34d331e8,0xad4cb58031e8b4d3,0x2d4c3580b1e834d3,0x3580ad4c34d331e8,0x2ef7b56235622ef7,0xaef73562b562aef7,0x35622ef7aef73562,0xb562aef72ef7b562,0xb35db44b35a426ef,0x344bb35da6ef35a4,0x344bb35da6ef35a4,0x335d344bb5a4a6ef
.quad 0xb5962b303596ab30,0xb5962b303596ab30,0xab30b5962b303596,0xab30b5962b303596,0xb04c353c3538b05d,0x353c304cb05db538,0xb53cb04c305d3538,0xb04c353c3538b05d,0x32af34903490b2af,0xb2afb490b49032af,0xb49032af32af3490,0x3490b2afb2afb490,0x35a3a77d3350b451,0x277d35a334513350,0x277d35a334513350,0xb5a3277db3503451
.quad 0x3400340034003400,0x3400340034003400,0xb4003400b4003400,0xb4003400b4003400,0xb5802d4cb4d3b1e8,0x2d4c3580b1e834d3,0xad4cb58031e8b4d3,0xb5802d4cb4d3b1e8,0x2ef7b56235622ef7,0xaef73562b562aef7,0x35622ef7aef73562,0xb562aef72ef7b562,0x335d344bb5a4a6ef,0xb44b335d26efb5a4,0xb44b335d26efb5a4,0xb35db44b35a426ef
.quad 0xb5962b303596ab30,0xb5962b303596ab30,0xab30b5962b303596,0xab30b5962b303596,0x304cb53cb538305d,0xb53cb04c305d3538,0x353c304cb05db538,0x304cb53cb538305d,0x32af34903490b2af,0xb2afb490b49032af,0xb49032af32af3490,0x3490b2afb2afb490,0xb5a3277db3503451,0xa77db5a3b451b350,0xa77db5a3b451b350,0x35a3a77d3350b451
.quad 0,0,0,0,0,0,0,0,0,0,0,0,0,0,0,0
.quad 0,0,0,0,0,0,0,0,0,0,0,0,0,0,0,0
.quad 0,0,0,0,0,0,0,0,0,0,0,0,0,0,0,0
.quad 0,0,0,0,0,0,0,0,0,0,0,0,0,0,0,0
.quad 0x3400340034003400,0x3400340034003400,0xb4003400b4003400,0xb4003400b4003400,0x357fad5d34d631e0,0xad5db57f31e0b4d6,0x2d5d357fb1e034d6,0x357fad5d34d631e0,0x2ed5b56535652ed5,0xaed53565b565aed5,0x35652ed5aed53565,0xb565aed52ed5b565,0xb371b44335a5261b,0x3443b371a61b35a5,0x3443b371a61b35a5,0x33713443b5a5a61b
.quad 0xb5932bbd3593abbd,0xb5932bbd3593abbd,0xabbdb5932bbd3593,0xabbdb5932bbd3593,0xb0233544352fb085,0x35443023b085b52f,0xb544b0233085352f,0xb0233544352fb085,0x32da34803480b2da,0xb2dab480b48032da,0xb48032da32da3480,0x3480b2dab2dab480,0x35a0a8b63320b465,0x28b635a034653320,0x28b635a034653320,0xb5a028b6b3203465
.quad 0x3400340034003400,0x3400340034003400,0xb4003400b4003400,0xb4003400b4003400,0xb57f2d5db4d6b1e0,0x2d5d357fb1e034d6,0xad5db57f31e0b4d6,0xb57f2d5db4d6b1e0,0x2ed5b56535652ed5,0xaed53565b565aed5,0x35652ed5aed53565,0xb565aed52ed5b565,0x33713443b5a5a61b,0xb4433371261bb5a5,0xb4433371261bb5a5,0xb371b44335a5261b
.quad 0xb5932bbd3593abbd,0xb5932bbd3593abbd,0xabbdb5932bbd3593,0xabbdb5932bbd3593,0x3023b544b52f3085,0xb544b0233085352f,0x35443023b085b52f,0x3023b544b52f3085,0x32da34803480b2da,0xb2dab480b48032da,0xb48032da32da3480,0x3480b2dab2dab480,0xb5a028b6b3203465,0xa8b6b5a0b465b320,0xa8b6b5a0b465b320,0x35a0a8b63320b465
.quad 0,0,0,0,0,0,0,0,0,0,0,0,0,0,0,0
.quad 0,0,0,0,0,0,0,0,0,0,0,0,0,0,0,0
.quad 0,0,0,0,0,0,0,0,0,0,0,0,0,0,0,0
.quad 0,0,0,0,0,0,0,0,0,0,0,0,0,0,0,0
.quad 0x3400340034003400,0x3400340034003400,0xb4003400b4003400,0xb4003400b4003400,0x357ead6e34d831d9,0xad6eb57e31d9b4d8,0x2d6e357eb1d934d8,0x357ead6e34d831d9,0x2eb3b56735672eb3,0xaeb33567b567aeb3,0x35672eb3aeb33567,0xb567aeb32eb3b567,0xb385b43a35a62546,0x343ab385a54635a6,0x343ab385a54635a6,0x3385343ab5a6a546
.quad 0xb5902c243590ac24,0xb5902c243590ac24,0xac24b5902c243590,0xac24b5902c243590,0xaff3354c3526b0ae,0x354c2ff3b0aeb526,0xb54caff330ae3526,0xaff3354c3526b0ae,0x330434703470b304,0xb304b470b4703304,0xb470330433043470,0x3470b304b304b470,0x359da9ad32efb478,0x29ad359d347832ef,0x29ad359d347832ef,0xb59d29adb2ef3478
.quad 0x3400340034003400,0x3400340034003400,0xb4003400b4003400,0xb4003400b4003400,0xb57e2d6eb4d8b1d9,0x2d6e357eb1d934d8,0xad6eb57e31d9b4d8,0xb57e2d6eb4d8b1d9,0x2eb3b56735672eb3,0xaeb33567b567aeb3,0x35672eb3aeb33567,0xb567aeb32eb3b567,0x3385343ab5a6a546,0xb43a33852546b5a6,0xb43a33852546b5a6,0xb385b43a35a62546
.quad 0xb5902c243590ac24,0xb5902c243590ac24,0xac24b5902c243590,0xac24b5902c243590,0x2ff3b54cb52630ae,0xb54caff330ae3526,0x354c2ff3b0aeb526,0x2ff3b54cb52630ae,0x330434703470b304,0xb304b470b4703304,0xb470330433043470,0x3470b304b304b470,0xb59d29adb2ef3478,0xa9adb59db478b2ef,0xa9adb59db478b2ef,0x359da9ad32efb478
.quad 0,0,0,0,0,0,0,0,0,0,0,0,0,0,0,0
.quad 0,0,0,0,0,0,0,0,0,0,0,0,0,0,0,0
.quad 0,0,0,0,0,0,0,0,0,0,0,0,0,0,0,0
.quad 0,0,0,0,0,0,0,0,0,0,0,0,0,0,0,0
.quad 0x3400340034003400,0x3400340034003400,0xb4003400b4003400,0xb4003400b4003400,0x357dad7f34da31d1,0xad7fb57d31d1b4da,0x2d7f357db1d134da,0x357dad7f34da31d1,0x2e92b56a356a2e92,0xae92356ab56aae92,0x356a2e92ae92356a,0xb56aae922e92b56a,0xb399b43135a62471,0x3431b399a47135a6,0x3431b399a47135a6,0x33993431b5a6a471
.quad 0xb58c2c6a358cac6a,0xb58c2c6a358cac6a,0xac6ab58c2c6a358c,0xac6ab58c2c6a358c,0xaf9f3554351db0d6,0x35542f9fb0d6b51d,0xb554af9f30d6351d,0xaf9f3554351db0d6,0x332d345f345fb32d,0xb32db45fb45f332d,0xb45f332d332d345f,0x345fb32db32db45f,0x3598aaa432bdb48b,0x2aa43598348b32bd,0x2aa43598348b32bd,0xb5982aa4b2bd348b
.quad 0x3400340034003400,0x3400340034003400,0xb4003400b4003400,0xb4003400b4003400,0xb57d2d7fb4dab1d1,0x2d7f357db1d134da,0xad7fb57d31d1b4da,0xb57d2d7fb4dab1d1,0x2e92b56a356a2e92,0xae92356ab56aae92,0x356a2e92ae92356a,0xb56aae922e92b56a,0x33993431b5a6a471,0xb43133992471b5a6,0xb43133992471b5a6,0xb399b43135a62471
.quad 0xb58c2c6a358cac6a,0xb58c2c6a358cac6a,0xac6ab58c2c6a358c,0xac6ab58c2c6a358c,0x2f9fb554b51d30d6,0xb554af9f30d6351d,0x35542f9fb0d6b51d,0x2f9fb554b51d30d6,0x332d345f345fb32d,0xb32db45fb45f332d,0xb45f332d332d345f,0x345fb32db32db45f,0xb5982aa4b2bd348b,0xaaa4b598b48bb2bd,0xaaa4b598b48bb2bd,0x3598aaa432bdb48b
.quad 0,0,0,0,0,0,0,0,0,0,0,0,0,0,0,0
.quad 0,0,0,0,0,0,0,0,0,0,0,0,0,0,0,0
.quad 0,0,0,0,0,0,0,0,0,0,0,0,0,0,0,0
.quad 0,0,0,0,0,0,0,0,0,0,0,0,0,0,0,0
.quad 0x3400340034003400,0x3400340034003400,0xb4003400b4003400,0xb4003400b4003400,0x357cad9134dc31c9,0xad91b57c31c9b4dc,0x2d91357cb1c934dc,0x357cad9134dc31c9,0x2e6fb56c356c2e6f,0xae6f356cb56cae6f,0x356c2e6fae6f356c,0xb56cae6f2e6fb56c,0xb3adb42835a72338,0x3428b3ada33835a7,0x3428b3ada33835a7,0x33ad3428b5a7a338
.quad 0xb5892cb03589acb0,0xb5892cb03589acb0,0xacb0b5892cb03589,0xacb0b5892cb03589,0xaf4c355b3513b0fe,0x355b2f4cb0feb513,0xb55baf4c30fe3513,0xaf4c355b3513b0fe,0x3356344e344eb356,0xb356b44eb44e3356,0xb44e33563356344e,0x344eb356b356b44e,0x3594ab9a328bb49d,0x2b9a3594349d328b,0x2b9a3594349d328b,0xb5942b9ab28b349d
.quad 0x3400340034003400,0x3400340034003400,0xb4003400b4003400,0xb4003400b4003400,0xb57c2d91b4dcb1c9,0x2d91357cb1c934dc,0xad91b57c31c9b4dc,0xb57c2d91b4dcb1c9,0x2e6fb56c356c2e6f,0xae6f356cb56cae6f,0x356c2e6fae6f356c,0xb56cae6f2e6fb56c,0x33ad3428b5a7a338,0xb42833ad2338b5a7,0xb42833ad2338b5a7,0xb3adb42835a72338
.quad 0xb5892cb03589acb0,0xb5892cb03589acb0,0xacb0b5892cb03589,0xacb0b5892cb03589,0x2f4cb55bb51330fe,0xb55baf4c30fe3513,0x355b2f4cb0feb513,0x2f4cb55bb51330fe,0x3356344e344eb356,0xb356b44eb44e3356,0xb44e33563356344e,0x344eb356b356b44e,0xb5942b9ab28b349d,0xab9ab594b49db28b,0xab9ab594b49db28b,0x3594ab9a328bb49d
.quad 0,0,0,0,0,0,0,0,0,0,0,0,0,0,0,0
.quad 0,0,0,0,0,0,0,0,0,0,0,0,0,0,0,0
.quad 0,0,0,0,0,0,0,0,0,0,0,0,0,0,0,0
.quad 0,0,0,0,0,0,0,0,0,0,0,0,0,0,0,0
.quad 0x3400340034003400,0x3400340034003400,0xb4003400b4003400,0xb4003400b4003400,0x357bada234df31c2,0xada2b57b31c2b4df,0x2da2357bb1c234df,0x357bada234df31c2,0x2e4db56f356f2e4d,0xae4d356fb56fae4d,0x356f2e4dae4d356f,0xb56fae4d2e4db56f,0xb3c0b41f35a7218d,0x341fb3c0a18d35a7,0x341fb3c0a18d35a7,0x33c0341fb5a7a18d
.quad 0xb5852cf53585acf5,0xb5852cf53585acf5,0xacf5b5852cf53585,0xacf5b5852cf53585,0xaef73562350ab126,0x35622ef7b126b50a,0xb562aef73126350a,0xaef73562350ab126,0x337f343d343db37f,0xb37fb43db43d337f,0xb43d337f337f343d,0x343db37fb37fb43d,0x358eac473258b4af,0x2c47358e34af3258,0x2c47358e34af3258,0xb58e2c47b25834af
.quad 0x3400340034003400,0x3400340034003400,0xb4003400b4003400,0xb4003400b4003400,0xb57b2da2b4dfb1c2,0x2da2357bb1c234df,0xada2b57b31c2b4df,0xb57b2da2b4dfb1c2,0x2e4db56f356f2e4d,0xae4d356fb56fae4d,0x356f2e4dae4d356f,0xb56fae4d2e4db56f,0x33c0341fb5a7a18d,0xb41f33c0218db5a7,0xb41f33c0218db5a7,0xb3c0b41f35a7218d
.quad 0xb5852cf53585acf5,0xb5852cf53585acf5,0xacf5b5852cf53585,0xacf5b5852cf53585,0x2ef7b562b50a3126,0xb562aef73126350a,0x35622ef7b126b50a,0x2ef7b562b50a3126,0x337f343d343db37f,0xb37fb43db43d337f,0xb43d337f337f343d,0x343db37fb37fb43d,0xb58e2c47b25834af,0xac47b58eb4afb258,0xac47b58eb4afb258,0x358eac473258b4af
.quad 0,0,0,0,0,0,0,0,0,0,0,0,0,0,0,0
.quad 0,0,0,0,0,0,0,0,0,0,0,0,0,0,0,0
.quad 0,0,0,0,0,0,0,0,0,0,0,0,0,0,0,0
.quad 0,0,0,0,0,0,0,0,0,0,0,0,0,0,0,0
.quad 0x3400340034003400,0x3400340034003400,0xb4003400b4003400,0xb4003400b4003400,0x3579adb334e131ba,0xadb3b57931bab4e1,0x2db33579b1ba34e1,0x3579adb334e131ba,0x2e2bb57135712e2b,0xae2b3571b571ae2b,0x35712e2bae2b3571,0xb571ae2b2e2bb571,0xb3d4b41635a81fc6,0x3416b3d49fc635a8,0x3416b3d49fc635a8,0x33d43416b5a89fc6
.quad 0xb5812d3a3581ad3a,0xb5812d3a3581ad3a,0xad3ab5812d3a3581,0xad3ab5812d3a3581,0xaea3356934ffb14d,0x35692ea3b14db4ff,0xb569aea3314d34ff,0xaea3356934ffb14d,0x33a6342b342bb3a6,0xb3a6b42bb42b33a6,0xb42b33a633a6342b,0x342bb3a6b3a6b42b,0x3588acc13224b4c0,0x2cc1358834c03224,0x2cc1358834c03224,0xb5882cc1b22434c0
.quad 0x3400340034003400,0x3400340034003400,0xb4003400b4003400,0xb4003400b4003400,0xb5792db3b4e1b1ba,0x2db33579b1ba34e1,0xadb3b57931bab4e1,0xb5792db3b4e1b1ba,0x2e2bb57135712e2b,0xae2b3571b571ae2b,0x35712e2bae2b3571,0xb571ae2b2e2bb571,0x33d43416b5a89fc6,0xb41633d41fc6b5a8,0xb41633d41fc6b5a8,0xb3d4b41635a81fc6
.quad 0xb5812d3a3581ad3a,0xb5812d3a3581ad3a,0xad3ab5812d3a3581,0xad3ab5812d3a3581,0x2ea3b569b4ff314d,0xb569aea3314d34ff,0x35692ea3b14db4ff,0x2ea3b569b4ff314d,0x33a6342b342bb3a6,0xb3a6b42bb42b33a6,0xb42b33a633a6342b,0x342bb3a6b3a6b42b,0xb5882cc1b22434c0,0xacc1b588b4c0b224,0xacc1b588b4c0b224,0x3588acc13224b4c0
.quad 0,0,0,0,0,0,0,0,0,0,0,0,0,0,0,0
.quad 0,0,0,0,0,0,0,0,0,0,0,0,0,0,0,0
.quad 0,0,0,0,0,0,0,0,0,0,0,0,0,0,0,0
.quad 0,0,0,0,0,0,0,0,0,0,0,0,0,0,0,0
.quad 0x3400340034003400,0x3400340034003400,0xb4003400b4003400,0xb4003400b4003400,0x3578adc434e331b2,0xadc4b57831b2b4e3,0x2dc43578b1b234e3,0x3578adc434e331b2,0x2e09b57435742e09,0xae093574b574ae09,0x35742e09ae093574,0xb574ae092e09b574,0xb3e7b40c35a81c71,0x340cb3e79c7135a8,0x340cb3e79c7135a8,0x33e7340cb5a89c71
.quad 0xb57d2d7f357dad7f,0xb57d2d7f357dad7f,0xad7fb57d2d7f357d,0xad7fb57d2d7f357d,0xae4d356f34f5b175,0x356f2e4db175b4f5,0xb56fae4d317534f5,0xae4d356f34f5b175,0x33cd34193419b3cd,0xb3cdb419b41933cd,0xb41933cd33cd3419,0x3419b3cdb3cdb419,0x3581ad3a31efb4d1,0x2d3a358134d131ef,0x2d3a358134d131ef,0xb5812d3ab1ef34d1
.quad 0x3400340034003400,0x3400340034003400,0xb4003400b4003400,0xb4003400b4003400,0xb5782dc4b4e3b1b2,0x2dc43578b1b234e3,0xadc4b57831b2b4e3,0xb5782dc4b4e3b1b2,0x2e09b57435742e09,0xae093574b574ae09,0x35742e09ae093574,0xb574ae092e09b574,0x33e7340cb5a89c71,0xb40c33e71c71b5a8,0xb40c33e71c71b5a8,0xb3e7b40c35a81c71
.quad 0xb57d2d7f357dad7f,0xb57d2d7f357dad7f,0xad7fb57d2d7f357d,0xad7fb57d2d7f357d,0x2e4db56fb4f53175,0xb56fae4d317534f5,0x356f2e4db175b4f5,0x2e4db56fb4f53175,0x33cd34193419b3cd,0xb3cdb419b41933cd,0xb41933cd33cd3419,0x3419b3cdb3cdb419,0xb5812d3ab1ef34d1,0xad3ab581b4d1b1ef,0xad3ab581b4d1b1ef,0x3581ad3a31efb4d1
.quad 0,0,0,0,0,0,0,0,0,0,0,0,0,0,0,0
.quad 0,0,0,0,0,0,0,0,0,0,0,0,0,0,0,0
.quad 0,0,0,0,0,0,0,0,0,0,0,0,0,0,0,0
.quad 0,0,0,0,0,0,0,0,0,0,0,0,0,0,0,0
.quad 0x3400340034003400,0x3400340034003400,0xb4003400b4003400,0xb4003400b4003400,0x3577add634e531ab,0xadd6b57731abb4e5,0x2dd63577b1ab34e5,0x3577add634e531ab,0x2de7b57635762de7,0xade73576b576ade7,0x35762de7ade73576,0xb576ade72de7b576,0xb3fab40335a81471,0x3403b3fa947135a8,0x3403b3fa947135a8,0x33fa3403b5a89471
.quad 0xb5782dc43578adc4,0xb5782dc43578adc4,0xadc4b5782dc43578,0xadc4b5782dc43578,0xadf8357534eab19b,0x35752df8b19bb4ea,0xb575adf8319b34ea,0xadf8357534eab19b,0x33f334063406b3f3,0xb3f3b406b40633f3,0xb40633f333f33406,0x3406b3f3b3f3b406,0x3579adb331bab4e1,0x2db3357934e131ba,0x2db3357934e131ba,0xb5792db3b1ba34e1
.quad 0x3400340034003400,0x3400340034003400,0xb4003400b4003400,0xb4003400b4003400,0xb5772dd6b4e5b1ab,0x2dd63577b1ab34e5,0xadd6b57731abb4e5,0xb5772dd6b4e5b1ab,0x2de7b57635762de7,0xade73576b576ade7,0x35762de7ade73576,0xb576ade72de7b576,0x33fa3403b5a89471,0xb40333fa1471b5a8,0xb40333fa1471b5a8,0xb3fab40335a81471
.quad 0xb5782dc43578adc4,0xb5782dc43578adc4,0xadc4b5782dc43578,0xadc4b5782dc43578,0x2df8b575b4ea319b,0xb575adf8319b34ea,0x35752df8b19bb4ea,0x2df8b575b4ea319b,0x33f334063406b3f3,0xb3f3b406b40633f3,0xb40633f333f33406,0x3406b3f3b3f3b406,0xb5792db3b1ba34e1,0xadb3b579b4e1b1ba,0xadb3b579b4e1b1ba,0x3579adb331bab4e1
.quad 0,0,0,0,0,0,0,0,0,0,0,0,0,0,0,0
.quad 0,0,0,0,0,0,0,0,0,0,0,0,0,0,0,0
.quad 0,0,0,0,0,0,0,0,0,0,0,0,0,0,0,0
.quad 0,0,0,0,0,0,0,0,0,0,0,0,0,0,0,0
.quad 0x3400340034003400,0x3400340034003400,0xb4003400b4003400,0xb4003400b4003400,0x3576ade734e831a3,0xade7b57631a3b4e8,0x2de73576b1a334e8,0x3576ade734e831a3,0x2dc4b57835782dc4,0xadc43578b578adc4,0x35782dc4adc43578,0xb578adc42dc4b578,0xb406b3f335a89871,0x33f3b406187135a8,0x33f3b406187135a8,0x340633f3b5a81871
.quad 0xb5742e093574ae09,0xb5742e093574ae09,0xae09b5742e093574,0xae09b5742e093574,0xada2357b34dfb1c2,0x357b2da2b1c2b4df,0xb57bada231c234df,0xada2357b34dfb1c2,0x340c33e733e7b40c,0xb40cb3e7b3e7340c,0xb3e7340c340c33e7,0x33e7b40cb40cb3e7,0x3571ae2b3184b4f0,0x2e2b357134f03184,0x2e2b357134f03184,0xb5712e2bb18434f0
.quad 0x3400340034003400,0x3400340034003400,0xb4003400b4003400,0xb4003400b4003400,0xb5762de7b4e8b1a3,0x2de73576b1a334e8,0xade7b57631a3b4e8,0xb5762de7b4e8b1a3,0x2dc4b57835782dc4,0xadc43578b578adc4,0x35782dc4adc43578,0xb578adc42dc4b578,0x340633f3b5a81871,0xb3f334069871b5a8,0xb3f334069871b5a8,0xb406b3f335a89871
.quad 0xb5742e093574ae09,0xb5742e093574ae09,0xae09b5742e093574,0xae09b5742e093574,0x2da2b57bb4df31c2,0xb57bada231c234df,0x357b2da2b1c2b4df,0x2da2b57bb4df31c2,0x340c33e733e7b40c,0xb40cb3e7b3e7340c,0xb3e7340c340c33e7,0x33e7b40cb40cb3e7,0xb5712e2bb18434f0,0xae2bb571b4f0b184,0xae2bb571b4f0b184,0x3571ae2b3184b4f0
.quad 0,0,0,0,0,0,0,0,0,0,0,0,0,0,0,0
.quad 0,0,0,0,0,0,0,0,0,0,0,0,0,0,0,0
.quad 0,0,0,0,0,0,0,0,0,0,0,0,0,0,0,0
.quad 0,0,0,0,0,0,0,0,0,0,0,0,0,0,0,0
.quad 0x3400340034003400,0x3400340034003400,0xb4003400b4003400,0xb4003400b4003400,0x3575adf834ea319b,0xadf8b575319bb4ea,0x2df83575b19b34ea,0x3575adf834ea319b,0x2da2b57b357b2da2,0xada2357bb57bada2,0x357b2da2ada2357b,0xb57bada22da2b57b,0xb410b3e035a89d8e,0x33e0b4101d8e35a8,0x33e0b4101d8e35a8,0x341033e0b5a81d8e
.quad 0xb56f2e4d356fae4d,0xb56f2e4d356fae4d,0xae4db56f2e4d356f,0xae4db56f2e4d356f,0xad4c358034d3b1e8,0x35802d4cb1e8b4d3,0xb580ad4c31e834d3,0xad4c358034d3b1e8,0x341f33c033c0b41f,0xb41fb3c0b3c0341f,0xb3c0341f341f33c0,0x33c0b41fb41fb3c0,0x3569aea3314db4ff,0x2ea3356934ff314d,0x2ea3356934ff314d,0xb5692ea3b14d34ff
.quad 0x3400340034003400,0x3400340034003400,0xb4003400b4003400,0xb4003400b4003400,0xb5752df8b4eab19b,0x2df83575b19b34ea,0xadf8b575319bb4ea,0xb5752df8b4eab19b,0x2da2b57b357b2da2,0xada2357bb57bada2,0x357b2da2ada2357b,0xb57bada22da2b57b,0x341033e0b5a81d8e,0xb3e034109d8eb5a8,0xb3e034109d8eb5a8,0xb410b3e035a89d8e
.quad 0xb56f2e4d356fae4d,0xb56f2e4d356fae4d,0xae4db56f2e4d356f,0xae4db56f2e4d356f,0x2d4cb580b4d331e8,0xb580ad4c31e834d3,0x35802d4cb1e8b4d3,0x2d4cb580b4d331e8,0x341f33c033c0b41f,0xb41fb3c0b3c0341f,0xb3c0341f341f33c0,0x33c0b41fb41fb3c0,0xb5692ea3b14d34ff,0xaea3b569b4ffb14d,0xaea3b569b4ffb14d,0x3569aea3314db4ff
.quad 0,0,0,0,0,0,0,0,0,0,0,0,0,0,0,0
.quad 0,0,0,0,0,0,0,0,0,0,0,0,0,0,0,0
.quad 0,0,0,0,0,0,0,0,0,0,0,0,0,0,0,0
.quad 0,0,0,0,0,0,0,0,0,0,0,0,0,0,0,0
.quad 0x3400340034003400,0x3400340034003400,0xb4003400b4003400,0xb4003400b4003400,0x3574ae0934ec3194,0xae09b5743194b4ec,0x2e093574b19434ec,0x3574ae0934ec3194,0x2d7fb57d357d2d7f,0xad7f357db57dad7f,0x357d2d7fad7f357d,0xb57dad7f2d7fb57d,0xb419b3cd35a8a071,0x33cdb419207135a8,0x33cdb419207135a8,0x341933cdb5a82071
.quad 0xb56a2e92356aae92,0xb56a2e92356aae92,0xae92b56a2e92356a,0xae92b56a2e92356a,0xacf5358534c7b20e,0x35852cf5b20eb4c7,0xb585acf5320e34c7,0xacf5358534c7b20e,0x343133993399b431,0xb431b399b3993431,0xb399343134313399,0x3399b431b431b399,0x355faf193116b50e,0x2f19355f350e3116,0x2f19355f350e3116,0xb55f2f19b116350e
.quad 0x3400340034003400,0x3400340034003400,0xb4003400b4003400,0xb4003400b4003400,0xb5742e09b4ecb194,0x2e093574b19434ec,0xae09b5743194b4ec,0xb5742e09b4ecb194,0x2d7fb57d357d2d7f,0xad7f357db57dad7f,0x357d2d7fad7f357d,0xb57dad7f2d7fb57d,0x341933cdb5a82071,0xb3cd3419a071b5a8,0xb3cd3419a071b5a8,0xb419b3cd35a8a071
.quad 0xb56a2e92356aae92,0xb56a2e92356aae92,0xae92b56a2e92356a,0xae92b56a2e92356a,0x2cf5b585b4c7320e,0xb585acf5320e34c7,0x35852cf5b20eb4c7,0x2cf5b585b4c7320e,0x343133993399b431,0xb431b399b3993431,0xb399343134313399,0x3399b431b431b399,0xb55f2f19b116350e,0xaf19b55fb50eb116,0xaf19b55fb50eb116,0x355faf193116b50e
.quad 0,0,0,0,0,0,0,0,0,0,0,0,0,0,0,0
.quad 0,0,0,0,0,0,0,0,0,0,0,0,0,0,0,0
.quad 0,0,0,0,0,0,0,0,0,0,0,0,0,0,0,0
.quad 0,0,0,0,0,0,0,0,0,0,0,0,0,0,0,0
.quad 0x3400340034003400,0x3400340034003400,0xb4003400b4003400,0xb4003400b4003400,0x3573ae1a34ee318c,0xae1ab573318cb4ee,0x2e1a3573b18c34ee,0x3573ae1a34ee318c,0x2d5db57f357f2d5d,0xad5d357fb57fad5d,0x357f2d5dad5d357f,0xb57fad5d2d5db57f,0xb422b3ba35a7a21c,0x33bab422221c35a7,0x33bab422221c35a7,0x342233bab5a7221c
.quad 0xb5652ed53565aed5,0xb5652ed53565aed5,0xaed5b5652ed53565,0xaed5b5652ed53565,0xac9e358a34bbb233,0x358a2c9eb233b4bb,0xb58aac9e323334bb,0xac9e358a34bbb233,0x344333713371b443,0xb443b371b3713443,0xb371344334433371,0x3371b443b443b371,0x3555af8f30deb51b,0x2f8f3555351b30de,0x2f8f3555351b30de,0xb5552f8fb0de351b
.quad 0x3400340034003400,0x3400340034003400,0xb4003400b4003400,0xb4003400b4003400,0xb5732e1ab4eeb18c,0x2e1a3573b18c34ee,0xae1ab573318cb4ee,0xb5732e1ab4eeb18c,0x2d5db57f357f2d5d,0xad5d357fb57fad5d,0x357f2d5dad5d357f,0xb57fad5d2d5db57f,0x342233bab5a7221c,0xb3ba3422a21cb5a7,0xb3ba3422a21cb5a7,0xb422b3ba35a7a21c
.quad 0xb5652ed53565aed5,0xb5652ed53565aed5,0xaed5b5652ed53565,0xaed5b5652ed53565,0x2c9eb58ab4bb3233,0xb58aac9e323334bb,0x358a2c9eb233b4bb,0x2c9eb58ab4bb3233,0x344333713371b443,0xb443b371b3713443,0xb371344334433371,0x3371b443b443b371,0xb5552f8fb0de351b,0xaf8fb555b51bb0de,0xaf8fb555b51bb0de,0x3555af8f30deb51b
.quad 0,0,0,0,0,0,0,0,0,0,0,0,0,0,0,0
.quad 0,0,0,0,0,0,0,0,0,0,0,0,0,0,0,0
.quad 0,0,0,0,0,0,0,0,0,0,0,0,0,0,0,0
.quad 0,0,0,0,0,0,0,0,0,0,0,0,0,0,0,0
.quad 0x3400340034003400,0x3400340034003400,0xb4003400b4003400,0xb4003400b4003400,0x3571ae2b34f03184,0xae2bb5713184b4f0,0x2e2b3571b18434f0,0x3571ae2b34f03184,0x2d3ab58135812d3a,0xad3a3581b581ad3a,0x35812d3aad3a3581,0xb581ad3a2d3ab581,0xb42bb3a635a7a3c6,0x33a6b42b23c635a7,0x33a6b42b23c635a7,0x342b33a6b5a723c6
.quad 0xb55f2f19355faf19,0xb55f2f19355faf19,0xaf19b55f2f19355f,0xaf19b55f2f19355f,0xac47358e34afb258,0x358e2c47b258b4af,0xb58eac47325834af,0xac47358e34afb258,0x345433493349b454,0xb454b349b3493454,0xb349345434543349,0x3349b454b454b349,0x354ab00230a6b528,0x3002354a352830a6,0x3002354a352830a6,0xb54a3002b0a63528
.quad 0x3400340034003400,0x3400340034003400,0xb4003400b4003400,0xb4003400b4003400,0xb5712e2bb4f0b184,0x2e2b3571b18434f0,0xae2bb5713184b4f0,0xb5712e2bb4f0b184,0x2d3ab58135812d3a,0xad3a3581b581ad3a,0x35812d3aad3a3581,0xb581ad3a2d3ab581,0x342b33a6b5a723c6,0xb3a6342ba3c6b5a7,0xb3a6342ba3c6b5a7,0xb42bb3a635a7a3c6
.quad 0xb55f2f19355faf19,0xb55f2f19355faf19,0xaf19b55f2f19355f,0xaf19b55f2f19355f,0x2c47b58eb4af3258,0xb58eac47325834af,0x358e2c47b258b4af,0x2c47b58eb4af3258,0x345433493349b454,0xb454b349b3493454,0xb349345434543349,0x3349b454b454b349,0xb54a3002b0a63528,0xb002b54ab528b0a6,0xb002b54ab528b0a6,0x354ab00230a6b528
.quad 0,0,0,0,0,0,0,0,0,0,0,0,0,0,0,0
.quad 0,0,0,0,0,0,0,0,0,0,0,0,0,0,0,0
.quad 0,0,0,0,0,0,0,0,0,0,0,0,0,0,0,0
.quad 0,0,0,0,0,0,0,0,0,0,0,0,0,0,0,0
.quad 0x3400340034003400,0x3400340034003400,0xb4003400b4003400,0xb4003400b4003400,0x3570ae3c34f3317c,0xae3cb570317cb4f3,0x2e3c3570b17c34f3,0x3570ae3c34f3317c,0x2d18b58335832d18,0xad183583b583ad18,0x35832d18ad183583,0xb583ad182d18b583,0xb434b39235a6a4b8,0x3392b43424b835a6,0x3392b43424b835a6,0x34343392b5a624b8
.quad 0xb5592f5c3559af5c,0xb5592f5c3559af5c,0xaf5cb5592f5c3559,0xaf5cb5592f5c3559,0xabe0359234a3b27c,0x35922be0b27cb4a3,0xb592abe0327c34a3,0xabe0359234a3b27c,0x346533203320b465,0xb465b320b3203465,0xb320346534653320,0x3320b465b465b320,0x353fb03c306db535,0x303c353f3535306d,0x303c353f3535306d,0xb53f303cb06d3535
.quad 0x3400340034003400,0x3400340034003400,0xb4003400b4003400,0xb4003400b4003400,0xb5702e3cb4f3b17c,0x2e3c3570b17c34f3,0xae3cb570317cb4f3,0xb5702e3cb4f3b17c,0x2d18b58335832d18,0xad183583b583ad18,0x35832d18ad183583,0xb583ad182d18b583,0x34343392b5a624b8,0xb3923434a4b8b5a6,0xb3923434a4b8b5a6,0xb434b39235a6a4b8
.quad 0xb5592f5c3559af5c,0xb5592f5c3559af5c,0xaf5cb5592f5c3559,0xaf5cb5592f5c3559,0x2be0b592b4a3327c,0xb592abe0327c34a3,0x35922be0b27cb4a3,0x2be0b592b4a3327c,0x346533203320b465,0xb465b320b3203465,0xb320346534653320,0x3320b465b465b320,0xb53f303cb06d3535,0xb03cb53fb535b06d,0xb03cb53fb535b06d,0x353fb03c306db535
.quad 0,0,0,0,0,0,0,0,0,0,0,0,0,0,0,0
.quad 0,0,0,0,0,0,0,0,0,0,0,0,0,0,0,0
.quad 0,0,0,0,0,0,0,0,0,0,0,0,0,0,0,0
.quad 0,0,0,0,0,0,0,0,0,0,0,0,0,0,0,0
.quad 0x3400340034003400,0x3400340034003400,0xb4003400b4003400,0xb4003400b4003400,0x356fae4d34f53175,0xae4db56f3175b4f5,0x2e4d356fb17534f5,0x356fae4d34f53175,0x2cf5b58535852cf5,0xacf53585b585acf5,0x35852cf5acf53585,0xb585acf52cf5b585,0xb43db37f35a5a58d,0x337fb43d258d35a5,0x337fb43d258d35a5,0x343d337fb5a5258d
.quad 0xb5542f9f3554af9f,0xb5542f9f3554af9f,0xaf9fb5542f9f3554,0xaf9fb5542f9f3554,0xab3035963496b2a1,0x35962b30b2a1b496,0xb596ab3032a13496,0xab3035963496b2a1,0x347632f632f6b476,0xb476b2f6b2f63476,0xb2f63476347632f6,0x32f6b476b476b2f6,0x3533b0753033b541,0x3075353335413033,0x3075353335413033,0xb5333075b0333541
.quad 0x3400340034003400,0x3400340034003400,0xb4003400b4003400,0xb4003400b4003400,0xb56f2e4db4f5b175,0x2e4d356fb17534f5,0xae4db56f3175b4f5,0xb56f2e4db4f5b175,0x2cf5b58535852cf5,0xacf53585b585acf5,0x35852cf5acf53585,0xb585acf52cf5b585,0x343d337fb5a5258d,0xb37f343da58db5a5,0xb37f343da58db5a5,0xb43db37f35a5a58d
.quad 0xb5542f9f3554af9f,0xb5542f9f3554af9f,0xaf9fb5542f9f3554,0xaf9fb5542f9f3554,0x2b30b596b49632a1,0xb596ab3032a13496,0x35962b30b2a1b496,0x2b30b596b49632a1,0x347632f632f6b476,0xb476b2f6b2f63476,0xb2f63476347632f6,0x32f6b476b476b2f6,0xb5333075b0333541,0xb075b533b541b033,0xb075b533b541b033,0x3533b0753033b541
.quad 0,0,0,0,0,0,0,0,0,0,0,0,0,0,0,0
.quad 0,0,0,0,0,0,0,0,0,0,0,0,0,0,0,0
.quad 0,0,0,0,0,0,0,0,0,0,0,0,0,0,0,0
.quad 0,0,0,0,0,0,0,0,0,0,0,0,0,0,0,0
.quad 0x3400340034003400,0x3400340034003400,0xb4003400b4003400,0xb4003400b4003400,0x356eae5e34f7316d,0xae5eb56e316db4f7,0x2e5e356eb16d34f7,0x356eae5e34f7316d,0x2cd2b58735872cd2,0xacd23587b587acd2,0x35872cd2acd23587,0xb587acd22cd2b587,0xb446b36b35a5a662,0x336bb446266235a5,0x336bb446266235a5,0x3446336bb5a52662
.quad 0xb54d2fe2354dafe2,0xb54d2fe2354dafe2,0xafe2b54d2fe2354d,0xafe2b54d2fe2354d,0xaa8135993489b2c4,0x35992a81b2c4b489,0xb599aa8132c43489,0xaa8135993489b2c4,0x348632cc32ccb486,0xb486b2ccb2cc3486,0xb2cc3486348632cc,0x32ccb486b486b2cc,0x3526b0ae2ff3b54c,0x30ae3526354c2ff3,0x30ae3526354c2ff3,0xb52630aeaff3354c
.quad 0x3400340034003400,0x3400340034003400,0xb4003400b4003400,0xb4003400b4003400,0xb56e2e5eb4f7b16d,0x2e5e356eb16d34f7,0xae5eb56e316db4f7,0xb56e2e5eb4f7b16d,0x2cd2b58735872cd2,0xacd23587b587acd2,0x35872cd2acd23587,0xb587acd22cd2b587,0x3446336bb5a52662,0xb36b3446a662b5a5,0xb36b3446a662b5a5,0xb446b36b35a5a662
.quad 0xb54d2fe2354dafe2,0xb54d2fe2354dafe2,0xafe2b54d2fe2354d,0xafe2b54d2fe2354d,0x2a81b599b48932c4,0xb599aa8132c43489,0x35992a81b2c4b489,0x2a81b599b48932c4,0x348632cc32ccb486,0xb486b2ccb2cc3486,0xb2cc3486348632cc,0x32ccb486b486b2cc,0xb52630aeaff3354c,0xb0aeb526b54caff3,0xb0aeb526b54caff3,0x3526b0ae2ff3b54c
.quad 0,0,0,0,0,0,0,0,0,0,0,0,0,0,0,0
.quad 0,0,0,0,0,0,0,0,0,0,0,0,0,0,0,0
.quad 0,0,0,0,0,0,0,0,0,0,0,0,0,0,0,0
.quad 0,0,0,0,0,0,0,0,0,0,0,0,0,0,0,0
.quad 0x3400340034003400,0x3400340034003400,0xb4003400b4003400,0xb4003400b4003400,0x356cae6f34f93165,0xae6fb56c3165b4f9,0x2e6f356cb16534f9,0x356cae6f34f93165,0x2cb0b58935892cb0,0xacb03589b589acb0,0x35892cb0acb03589,0xb589acb02cb0b589,0xb44eb35635a4a736,0x3356b44e273635a4,0x3356b44e273635a4,0x344e3356b5a42736
.quad 0xb54730123547b012,0xb54730123547b012,0xb012b54730123547,0xb012b54730123547,0xa9d1359c347bb2e8,0x359c29d1b2e8b47b,0xb59ca9d132e8347b,0xa9d1359c347bb2e8,0x349632a132a1b496,0xb496b2a1b2a13496,0xb2a13496349632a1,0x32a1b496b496b2a1,0x3519b0e62f7eb556,0x30e6351935562f7e,0x30e6351935562f7e,0xb51930e6af7e3556
.quad 0x3400340034003400,0x3400340034003400,0xb4003400b4003400,0xb4003400b4003400,0xb56c2e6fb4f9b165,0x2e6f356cb16534f9,0xae6fb56c3165b4f9,0xb56c2e6fb4f9b165,0x2cb0b58935892cb0,0xacb03589b589acb0,0x35892cb0acb03589,0xb589acb02cb0b589,0x344e3356b5a42736,0xb356344ea736b5a4,0xb356344ea736b5a4,0xb44eb35635a4a736
.quad 0xb54730123547b012,0xb54730123547b012,0xb012b54730123547,0xb012b54730123547,0x29d1b59cb47b32e8,0xb59ca9d132e8347b,0x359c29d1b2e8b47b,0x29d1b59cb47b32e8,0x349632a132a1b496,0xb496b2a1b2a13496,0xb2a13496349632a1,0x32a1b496b496b2a1,0xb51930e6af7e3556,0xb0e6b519b556af7e,0xb0e6b519b556af7e,0x3519b0e62f7eb556
.quad 0,0,0,0,0,0,0,0,0,0,0,0,0,0,0,0
.quad 0,0,0,0,0,0,0,0,0,0,0,0,0,0,0,0
.quad 0,0,0,0,0,0,0,0,0,0,0,0,0,0,0,0
.quad 0,0,0,0,0,0,0,0,0,0,0,0,0,0,0,0
.quad 0x3400340034003400,0x3400340034003400,0xb4003400b4003400,0xb4003400b4003400,0x356bae8034fb315d,0xae80b56b315db4fb,0x2e80356bb15d34fb,0x356bae8034fb315d,0x2c8db58b358b2c8d,0xac8d358bb58bac8d,0x358b2c8dac8d358b,0xb58bac8d2c8db58b,0xb457b34235a2a805,0x3342b457280535a2,0x3342b457280535a2,0x34573342b5a22805
.quad 0xb54130333541b033,0xb54130333541b033,0xb033b54130333541,0xb033b54130333541,0xa920359f346db30b,0x359f2920b30bb46d,0xb59fa920330b346d,0xa920359f346db30b,0x34a532753275b4a5,0xb4a5b275b27534a5,0xb27534a534a53275,0x3275b4a5b4a5b275,0x350cb11e2f08b560,0x311e350c35602f08,0x311e350c35602f08,0xb50c311eaf083560
.quad 0x3400340034003400,0x3400340034003400,0xb4003400b4003400,0xb4003400b4003400,0xb56b2e80b4fbb15d,0x2e80356bb15d34fb,0xae80b56b315db4fb,0xb56b2e80b4fbb15d,0x2c8db58b358b2c8d,0xac8d358bb58bac8d,0x358b2c8dac8d358b,0xb58bac8d2c8db58b,0x34573342b5a22805,0xb3423457a805b5a2,0xb3423457a805b5a2,0xb457b34235a2a805
.quad 0xb54130333541b033,0xb54130333541b033,0xb033b54130333541,0xb033b54130333541,0x2920b59fb46d330b,0xb59fa920330b346d,0x359f2920b30bb46d,0x2920b59fb46d330b,0x34a532753275b4a5,0xb4a5b275b27534a5,0xb27534a534a53275,0x3275b4a5b4a5b275,0xb50c311eaf083560,0xb11eb50cb560af08,0xb11eb50cb560af08,0x350cb11e2f08b560
.quad 0,0,0,0,0,0,0,0,0,0,0,0,0,0,0,0
.quad 0,0,0,0,0,0,0,0,0,0,0,0,0,0,0,0
.quad 0,0,0,0,0,0,0,0,0,0,0,0,0,0,0,0
.quad 0,0,0,0,0,0,0,0,0,0,0,0,0,0,0,0
.quad 0x3400340034003400,0x3400340034003400,0xb4003400b4003400,0xb4003400b4003400,0x356aae9234fd3155,0xae92b56a3155b4fd,0x2e92356ab15534fd,0x356aae9234fd3155,0x2c6ab58c358c2c6a,0xac6a358cb58cac6a,0x358c2c6aac6a358c,0xb58cac6a2c6ab58c,0xb45fb32d35a1a870,0x332db45f287035a1,0x332db45f287035a1,0x345f332db5a12870
.quad 0xb53a3054353ab054,0xb53a3054353ab054,0xb054b53a3054353a,0xb054b53a3054353a,0xa87035a1345fb32d,0x35a12870b32db45f,0xb5a1a870332d345f,0xa87035a1345fb32d,0x34b432493249b4b4,0xb4b4b249b24934b4,0xb24934b434b43249,0x3249b4b4b4b4b249,0x34fdb1552e92b56a,0x315534fd356a2e92,0x315534fd356a2e92,0xb4fd3155ae92356a
.quad 0x3400340034003400,0x3400340034003400,0xb4003400b4003400,0xb4003400b4003400,0xb56a2e92b4fdb155,0x2e92356ab15534fd,0xae92b56a3155b4fd,0xb56a2e92b4fdb155,0x2c6ab58c358c2c6a,0xac6a358cb58cac6a,0x358c2c6aac6a358c,0xb58cac6a2c6ab58c,0x345f332db5a12870,0xb32d345fa870b5a1,0xb32d345fa870b5a1,0xb45fb32d35a1a870
.quad 0xb53a3054353ab054,0xb53a3054353ab054,0xb054b53a3054353a,0xb054b53a3054353a,0x2870b5a1b45f332d,0xb5a1a870332d345f,0x35a12870b32db45f,0x2870b5a1b45f332d,0x34b432493249b4b4,0xb4b4b249b24934b4,0xb24934b434b43249,0x3249b4b4b4b4b249,0xb4fd3155ae92356a,0xb155b4fdb56aae92,0xb155b4fdb56aae92,0x34fdb1552e92b56a
.quad 0,0,0,0,0,0,0,0,0,0,0,0,0,0,0,0
.quad 0,0,0,0,0,0,0,0,0,0,0,0,0,0,0,0
.quad 0,0,0,0,0,0,0,0,0,0,0,0,0,0,0,0
.quad 0,0,0,0,0,0,0,0,0,0,0,0,0,0,0,0
.quad 0x3400340034003400,0x3400340034003400,0xb4003400b4003400,0xb4003400b4003400,0x3569aea334ff314d,0xaea3b569314db4ff,0x2ea33569b14d34ff,0x3569aea334ff314d,0x2c47b58e358e2c47,0xac47358eb58eac47,0x358e2c47ac47358e,0xb58eac472c47b58e,0xb468b31935a0a8da,0x3319b46828da35a0,0x3319b46828da35a0,0x34683319b5a028da
.quad 0xb53330753533b075,0xb53330753533b075,0xb075b53330753533,0xb075b53330753533,0xa77d35a33451b350,0x35a3277db350b451,0xb5a3a77d33503451,0xa77d35a33451b350,0x34c3321d321db4c3,0xb4c3b21db21d34c3,0xb21d34c334c3321d,0x321db4c3b4c3b21d,0x34eeb18c2e1ab573,0x318c34ee35732e1a,0x318c34ee35732e1a,0xb4ee318cae1a3573
.quad 0x3400340034003400,0x3400340034003400,0xb4003400b4003400,0xb4003400b4003400,0xb5692ea3b4ffb14d,0x2ea33569b14d34ff,0xaea3b569314db4ff,0xb5692ea3b4ffb14d,0x2c47b58e358e2c47,0xac47358eb58eac47,0x358e2c47ac47358e,0xb58eac472c47b58e,0x34683319b5a028da,0xb3193468a8dab5a0,0xb3193468a8dab5a0,0xb468b31935a0a8da
.quad 0xb53330753533b075,0xb53330753533b075,0xb075b53330753533,0xb075b53330753533,0x277db5a3b4513350,0xb5a3a77d33503451,0x35a3277db350b451,0x277db5a3b4513350,0x34c3321d321db4c3,0xb4c3b21db21d34c3,0xb21d34c334c3321d,0x321db4c3b4c3b21d,0xb4ee318cae1a3573,0xb18cb4eeb573ae1a,0xb18cb4eeb573ae1a,0x34eeb18c2e1ab573
.quad 0,0,0,0,0,0,0,0,0,0,0,0,0,0,0,0
.quad 0,0,0,0,0,0,0,0,0,0,0,0,0,0,0,0
.quad 0,0,0,0,0,0,0,0,0,0,0,0,0,0,0,0
.quad 0,0,0,0,0,0,0,0,0,0,0,0,0,0,0,0
.quad 0x3400340034003400,0x3400340034003400,0xb4003400b4003400,0xb4003400b4003400,0x3567aeb335013146,0xaeb3b5673146b501,0x2eb33567b1463501,0x3567aeb335013146,0x2c24b59035902c24,0xac243590b590ac24,0x35902c24ac243590,0xb590ac242c24b590,0xb470b304359ea944,0x3304b4702944359e,0x3304b4702944359e,0x34703304b59e2944
.quad 0xb52c3096352cb096,0xb52c3096352cb096,0xb096b52c3096352c,0xb096b52c3096352c,0xa61b35a53443b371,0x35a5261bb371b443,0xb5a5a61b33713443,0xa61b35a53443b371,0x34d131ef31efb4d1,0xb4d1b1efb1ef34d1,0xb1ef34d134d131ef,0x31efb4d1b4d1b1ef,0x34dfb1c22da2b57b,0x31c234df357b2da2,0x31c234df357b2da2,0xb4df31c2ada2357b
.quad 0x3400340034003400,0x3400340034003400,0xb4003400b4003400,0xb4003400b4003400,0xb5672eb3b501b146,0x2eb33567b1463501,0xaeb3b5673146b501,0xb5672eb3b501b146,0x2c24b59035902c24,0xac243590b590ac24,0x35902c24ac243590,0xb590ac242c24b590,0x34703304b59e2944,0xb3043470a944b59e,0xb3043470a944b59e,0xb470b304359ea944
.quad 0xb52c3096352cb096,0xb52c3096352cb096,0xb096b52c3096352c,0xb096b52c3096352c,0x261bb5a5b4433371,0xb5a5a61b33713443,0x35a5261bb371b443,0x261bb5a5b4433371,0x34d131ef31efb4d1,0xb4d1b1efb1ef34d1,0xb1ef34d134d131ef,0x31efb4d1b4d1b1ef,0xb4df31c2ada2357b,0xb1c2b4dfb57bada2,0xb1c2b4dfb57bada2,0x34dfb1c22da2b57b
.quad 0,0,0,0,0,0,0,0,0,0,0,0,0,0,0,0
.quad 0,0,0,0,0,0,0,0,0,0,0,0,0,0,0,0
.quad 0,0,0,0,0,0,0,0,0,0,0,0,0,0,0,0
.quad 0,0,0,0,0,0,0,0,0,0,0,0,0,0,0,0
.quad 0x3400340034003400,0x3400340034003400,0xb4003400b4003400,0xb4003400b4003400,0x3566aec43503313e,0xaec4b566313eb503,0x2ec43566b13e3503,0x3566aec43503313e,0x2c01b59135912c01,0xac013591b591ac01,0x35912c01ac013591,0xb591ac012c01b591,0xb478b2ef359da9ad,0x32efb47829ad359d,0x32efb47829ad359d,0x347832efb59d29ad
.quad 0xb52530b63525b0b6,0xb52530b63525b0b6,0xb0b6b52530b63525,0xb0b6b52530b63525,0xa4b835a63434b392,0x35a624b8b392b434,0xb5a6a4b833923434,0xa4b835a63434b392,0x34df31c231c2b4df,0xb4dfb1c2b1c234df,0xb1c234df34df31c2,0x31c2b4dfb4dfb1c2,0x34cfb1f72d29b582,0x31f734cf35822d29,0x31f734cf35822d29,0xb4cf31f7ad293582
.quad 0x3400340034003400,0x3400340034003400,0xb4003400b4003400,0xb4003400b4003400,0xb5662ec4b503b13e,0x2ec43566b13e3503,0xaec4b566313eb503,0xb5662ec4b503b13e,0x2c01b59135912c01,0xac013591b591ac01,0x35912c01ac013591,0xb591ac012c01b591,0x347832efb59d29ad,0xb2ef3478a9adb59d,0xb2ef3478a9adb59d,0xb478b2ef359da9ad
.quad 0xb52530b63525b0b6,0xb52530b63525b0b6,0xb0b6b52530b63525,0xb0b6b52530b63525,0x24b8b5a6b4343392,0xb5a6a4b833923434,0x35a624b8b392b434,0x24b8b5a6b4343392,0x34df31c231c2b4df,0xb4dfb1c2b1c234df,0xb1c234df34df31c2,0x31c2b4dfb4dfb1c2,0xb4cf31f7ad293582,0xb1f7b4cfb582ad29,0xb1f7b4cfb582ad29,0x34cfb1f72d29b582
.quad 0,0,0,0,0,0,0,0,0,0,0,0,0,0,0,0
.quad 0,0,0,0,0,0,0,0,0,0,0,0,0,0,0,0
.quad 0,0,0,0,0,0,0,0,0,0,0,0,0,0,0,0
.quad 0,0,0,0,0,0,0,0,0,0,0,0,0,0,0,0
.quad 0x3400340034003400,0x3400340034003400,0xb4003400b4003400,0xb4003400b4003400,0x3565aed535053136,0xaed5b5653136b505,0x2ed53565b1363505,0x3565aed535053136,0x2bbdb59335932bbd,0xabbd3593b593abbd,0x35932bbdabbd3593,0xb593abbd2bbdb593,0xb480b2da359baa17,0x32dab4802a17359b,0x32dab4802a17359b,0x348032dab59b2a17
.quad 0xb51d30d6351db0d6,0xb51d30d6351db0d6,0xb0d6b51d30d6351d,0xb0d6b51d30d6351d,0xa2aa35a73425b3b3,0x35a722aab3b3b425,0xb5a7a2aa33b33425,0xa2aa35a73425b3b3,0x34ec31943194b4ec,0xb4ecb194b19434ec,0xb19434ec34ec3194,0x3194b4ecb4ecb194,0x34beb22b2cb0b589,0x322b34be35892cb0,0x322b34be35892cb0,0xb4be322bacb03589
.quad 0x3400340034003400,0x3400340034003400,0xb4003400b4003400,0xb4003400b4003400,0xb5652ed5b505b136,0x2ed53565b1363505,0xaed5b5653136b505,0xb5652ed5b505b136,0x2bbdb59335932bbd,0xabbd3593b593abbd,0x35932bbdabbd3593,0xb593abbd2bbdb593,0x348032dab59b2a17,0xb2da3480aa17b59b,0xb2da3480aa17b59b,0xb480b2da359baa17
.quad 0xb51d30d6351db0d6,0xb51d30d6351db0d6,0xb0d6b51d30d6351d,0xb0d6b51d30d6351d,0x22aab5a7b42533b3,0xb5a7a2aa33b33425,0x35a722aab3b3b425,0x22aab5a7b42533b3,0x34ec31943194b4ec,0xb4ecb194b19434ec,0xb19434ec34ec3194,0x3194b4ecb4ecb194,0xb4be322bacb03589,0xb22bb4beb589acb0,0xb22bb4beb589acb0,0x34beb22b2cb0b589
.quad 0,0,0,0,0,0,0,0,0,0,0,0,0,0,0,0
.quad 0,0,0,0,0,0,0,0,0,0,0,0,0,0,0,0
.quad 0,0,0,0,0,0,0,0,0,0,0,0,0,0,0,0
.quad 0,0,0,0,0,0,0,0,0,0,0,0,0,0,0,0
.quad 0x3400340034003400,0x3400340034003400,0xb4003400b4003400,0xb4003400b4003400,0x3563aee63507312e,0xaee6b563312eb507,0x2ee63563b12e3507,0x3563aee63507312e,0x2b77b59435942b77,0xab773594b594ab77,0x35942b77ab773594,0xb594ab772b77b594,0xb489b2c43599aa81,0x32c4b4892a813599,0x32c4b4892a813599,0x348932c4b5992a81
.quad 0xb51530f63515b0f6,0xb51530f63515b0f6,0xb0f6b51530f63515,0xb0f6b51530f63515,0x9fc635a83416b3d4,0x35a81fc6b3d4b416,0xb5a89fc633d43416,0x9fc635a83416b3d4,0x34f931653165b4f9,0xb4f9b165b16534f9,0xb16534f934f93165,0x3165b4f9b4f9b165,0x34adb25f2c36b58f,0x325f34ad358f2c36,0x325f34ad358f2c36,0xb4ad325fac36358f
.quad 0x3400340034003400,0x3400340034003400,0xb4003400b4003400,0xb4003400b4003400,0xb5632ee6b507b12e,0x2ee63563b12e3507,0xaee6b563312eb507,0xb5632ee6b507b12e,0x2b77b59435942b77,0xab773594b594ab77,0x35942b77ab773594,0xb594ab772b77b594,0x348932c4b5992a81,0xb2c43489aa81b599,0xb2c43489aa81b599,0xb489b2c43599aa81
.quad 0xb51530f63515b0f6,0xb51530f63515b0f6,0xb0f6b51530f63515,0xb0f6b51530f63515,0x1fc6b5a8b41633d4,0xb5a89fc633d43416,0x35a81fc6b3d4b416,0x1fc6b5a8b41633d4,0x34f931653165b4f9,0xb4f9b165b16534f9,0xb16534f934f93165,0x3165b4f9b4f9b165,0xb4ad325fac36358f,0xb25fb4adb58fac36,0xb25fb4adb58fac36,0x34adb25f2c36b58f
.quad 0,0,0,0,0,0,0,0,0,0,0,0,0,0,0,0
.quad 0,0,0,0,0,0,0,0,0,0,0,0,0,0,0,0
.quad 0,0,0,0,0,0,0,0,0,0,0,0,0,0,0,0
.quad 0,0,0,0,0,0,0,0,0,0,0,0,0,0,0,0
.quad 0x3400340034003400,0x3400340034003400,0xb4003400b4003400,0xb4003400b4003400,0x3562aef7350a3126,0xaef7b5623126b50a,0x2ef73562b126350a,0x3562aef7350a3126,0x2b30b59635962b30,0xab303596b596ab30,0x35962b30ab303596,0xb596ab302b30b596,0xb490b2af3597aaea,0x32afb4902aea3597,0x32afb4902aea3597,0x349032afb5972aea
.quad 0xb50e3116350eb116,0xb50e3116350eb116,0xb116b50e3116350e,0xb116b50e3116350e,0x987135a83406b3f3,0x35a81871b3f3b406,0xb5a8987133f33406,0x987135a83406b3f3,0x350531363136b505,0xb505b136b1363505,0xb136350535053136,0x3136b505b505b136,0x349bb2922b77b594,0x3292349b35942b77,0x3292349b35942b77,0xb49b3292ab773594
.quad 0x3400340034003400,0x3400340034003400,0xb4003400b4003400,0xb4003400b4003400,0xb5622ef7b50ab126,0x2ef73562b126350a,0xaef7b5623126b50a,0xb5622ef7b50ab126,0x2b30b59635962b30,0xab303596b596ab30,0x35962b30ab303596,0xb596ab302b30b596,0x349032afb5972aea,0xb2af3490aaeab597,0xb2af3490aaeab597,0xb490b2af3597aaea
.quad 0xb50e3116350eb116,0xb50e3116350eb116,0xb116b50e3116350e,0xb116b50e3116350e,0x1871b5a8b40633f3,0xb5a8987133f33406,0x35a81871b3f3b406,0x1871b5a8b40633f3,0x350531363136b505,0xb505b136b1363505,0xb136350535053136,0x3136b505b505b136,0xb49b3292ab773594,0xb292b49bb594ab77,0xb292b49bb594ab77,0x349bb2922b77b594
.quad 0,0,0,0,0,0,0,0,0,0,0,0,0,0,0,0
.quad 0,0,0,0,0,0,0,0,0,0,0,0,0,0,0,0
.quad 0,0,0,0,0,0,0,0,0,0,0,0,0,0,0,0
.quad 0,0,0,0,0,0,0,0,0,0,0,0,0,0,0,0
.quad 0x3400340034003400,0x3400340034003400,0xb4003400b4003400,0xb4003400b4003400,0x3560af08350c311e,0xaf08b560311eb50c,0x2f083560b11e350c,0x3560af08350c311e,0x2aeab59735972aea,0xaaea3597b597aaea,0x35972aeaaaea3597,0xb597aaea2aeab597,0xb498b2993595ab53,0x3299b4982b533595,0x3299b4982b533595,0x34983299b5952b53
.quad 0xb50531363505b136,0xb50531363505b136,0xb136b50531363505,0xb136b50531363505,0x1aaa35a833edb409,0x35a89aaab409b3ed,0xb5a81aaa340933ed,0x1aaa35a833edb409,0x351131063106b511,0xb511b106b1063511,0xb106351135113106,0x3106b511b511b106,0x3489b2c42a81b599,0x32c4348935992a81,0x32c4348935992a81,0xb48932c4aa813599
.quad 0x3400340034003400,0x3400340034003400,0xb4003400b4003400,0xb4003400b4003400,0xb5602f08b50cb11e,0x2f083560b11e350c,0xaf08b560311eb50c,0xb5602f08b50cb11e,0x2aeab59735972aea,0xaaea3597b597aaea,0x35972aeaaaea3597,0xb597aaea2aeab597,0x34983299b5952b53,0xb2993498ab53b595,0xb2993498ab53b595,0xb498b2993595ab53
.quad 0xb50531363505b136,0xb50531363505b136,0xb136b50531363505,0xb136b50531363505,0x9aaab5a8b3ed3409,0xb5a81aaa340933ed,0x35a89aaab409b3ed,0x9aaab5a8b3ed3409,0x351131063106b511,0xb511b106b1063511,0xb106351135113106,0x3106b511b511b106,0xb48932c4aa813599,0xb2c4b489b599aa81,0xb2c4b489b599aa81,0x3489b2c42a81b599
.quad 0,0,0,0,0,0,0,0,0,0,0,0,0,0,0,0
.quad 0,0,0,0,0,0,0,0,0,0,0,0,0,0,0,0
.quad 0,0,0,0,0,0,0,0,0,0,0,0,0,0,0,0
.quad 0,0,0,0,0,0,0,0,0,0,0,0,0,0,0,0
.quad 0x3400340034003400,0x3400340034003400,0xb4003400b4003400,0xb4003400b4003400,0x355faf19350e3116,0xaf19b55f3116b50e,0x2f19355fb116350e,0x355faf19350e3116,0x2aa4b59835982aa4,0xaaa43598b598aaa4,0x35982aa4aaa43598,0xb598aaa42aa4b598,0xb4a0b2843593abbd,0x3284b4a02bbd3593,0x3284b4a02bbd3593,0x34a03284b5932bbd
.quad 0xb4fd315534fdb155,0xb4fd315534fdb155,0xb155b4fd315534fd,0xb155b4fd315534fd,0x207135a833cdb419,0x35a8a071b419b3cd,0xb5a82071341933cd,0x207135a833cdb419,0x351d30d630d6b51d,0xb51db0d6b0d6351d,0xb0d6351d351d30d6,0x30d6b51db51db0d6,0x3476b2f6298ab59d,0x32f63476359d298a,0x32f63476359d298a,0xb47632f6a98a359d
.quad 0x3400340034003400,0x3400340034003400,0xb4003400b4003400,0xb4003400b4003400,0xb55f2f19b50eb116,0x2f19355fb116350e,0xaf19b55f3116b50e,0xb55f2f19b50eb116,0x2aa4b59835982aa4,0xaaa43598b598aaa4,0x35982aa4aaa43598,0xb598aaa42aa4b598,0x34a03284b5932bbd,0xb28434a0abbdb593,0xb28434a0abbdb593,0xb4a0b2843593abbd
.quad 0xb4fd315534fdb155,0xb4fd315534fdb155,0xb155b4fd315534fd,0xb155b4fd315534fd,0xa071b5a8b3cd3419,0xb5a82071341933cd,0x35a8a071b419b3cd,0xa071b5a8b3cd3419,0x351d30d630d6b51d,0xb51db0d6b0d6351d,0xb0d6351d351d30d6,0x30d6b51db51db0d6,0xb47632f6a98a359d,0xb2f6b476b59da98a,0xb2f6b476b59da98a,0x3476b2f6298ab59d
.quad 0,0,0,0,0,0,0,0,0,0,0,0,0,0,0,0
.quad 0,0,0,0,0,0,0,0,0,0,0,0,0,0,0,0
.quad 0,0,0,0,0,0,0,0,0,0,0,0,0,0,0,0
.quad 0,0,0,0,0,0,0,0,0,0,0,0,0,0,0,0
.quad 0x3400340034003400,0x3400340034003400,0xb4003400b4003400,0xb4003400b4003400,0x355eaf2a3510310e,0xaf2ab55e310eb510,0x2f2a355eb10e3510,0x355eaf2a3510310e,0x2a5eb59a359a2a5e,0xaa5e359ab59aaa5e,0x359a2a5eaa5e359a,0xb59aaa5e2a5eb59a,0xb4a8b26e3590ac13,0x326eb4a82c133590,0x326eb4a82c133590,0x34a8326eb5902c13
.quad 0xb4f5317534f5b175,0xb4f5317534f5b175,0xb175b4f5317534f5,0xb175b4f5317534f5,0x233835a733adb428,0x35a7a338b428b3ad,0xb5a72338342833ad,0x233835a733adb428,0x352830a630a6b528,0xb528b0a6b0a63528,0xb0a63528352830a6,0x30a6b528b528b0a6,0x3462b3272893b5a1,0x3327346235a12893,0x3327346235a12893,0xb4623327a89335a1
.quad 0x3400340034003400,0x3400340034003400,0xb4003400b4003400,0xb4003400b4003400,0xb55e2f2ab510b10e,0x2f2a355eb10e3510,0xaf2ab55e310eb510,0xb55e2f2ab510b10e,0x2a5eb59a359a2a5e,0xaa5e359ab59aaa5e,0x359a2a5eaa5e359a,0xb59aaa5e2a5eb59a,0x34a8326eb5902c13,0xb26e34a8ac13b590,0xb26e34a8ac13b590,0xb4a8b26e3590ac13
.quad 0xb4f5317534f5b175,0xb4f5317534f5b175,0xb175b4f5317534f5,0xb175b4f5317534f5,0xa338b5a7b3ad3428,0xb5a72338342833ad,0x35a7a338b428b3ad,0xa338b5a7b3ad3428,0x352830a630a6b528,0xb528b0a6b0a63528,0xb0a63528352830a6,0x30a6b528b528b0a6,0xb4623327a89335a1,0xb327b462b5a1a893,0xb327b462b5a1a893,0x3462b3272893b5a1
.quad 0,0,0,0,0,0,0,0,0,0,0,0,0,0,0,0
.quad 0,0,0,0,0,0,0,0,0,0,0,0,0,0,0,0
.quad 0,0,0,0,0,0,0,0,0,0,0,0,0,0,0,0
.quad 0,0,0,0,0,0,0,0,0,0,0,0,0,0,0,0
.quad 0x3400340034003400,0x3400340034003400,0xb4003400b4003400,0xb4003400b4003400,0x355caf3b35113106,0xaf3bb55c3106b511,0x2f3b355cb1063511,0x355caf3b35113106,0x2a17b59b359b2a17,0xaa17359bb59baa17,0x359b2a17aa17359b,0xb59baa172a17b59b,0xb4afb258358eac47,0x3258b4af2c47358e,0x3258b4af2c47358e,0x34af3258b58e2c47
.quad 0xb4ec319434ecb194,0xb4ec319434ecb194,0xb194b4ec319434ec,0xb194b4ec319434ec,0x24ff35a6338cb437,0x35a6a4ffb437b38c,0xb5a624ff3437338c,0x24ff35a6338cb437,0x353330753075b533,0xb533b075b0753533,0xb075353335333075,0x3075b533b533b075,0x344eb3562736b5a4,0x3356344e35a42736,0x3356344e35a42736,0xb44e3356a73635a4
.quad 0x3400340034003400,0x3400340034003400,0xb4003400b4003400,0xb4003400b4003400,0xb55c2f3bb511b106,0x2f3b355cb1063511,0xaf3bb55c3106b511,0xb55c2f3bb511b106,0x2a17b59b359b2a17,0xaa17359bb59baa17,0x359b2a17aa17359b,0xb59baa172a17b59b,0x34af3258b58e2c47,0xb25834afac47b58e,0xb25834afac47b58e,0xb4afb258358eac47
.quad 0xb4ec319434ecb194,0xb4ec319434ecb194,0xb194b4ec319434ec,0xb194b4ec319434ec,0xa4ffb5a6b38c3437,0xb5a624ff3437338c,0x35a6a4ffb437b38c,0xa4ffb5a6b38c3437,0x353330753075b533,0xb533b075b0753533,0xb075353335333075,0x3075b533b533b075,0xb44e3356a73635a4,0xb356b44eb5a4a736,0xb356b44eb5a4a736,0x344eb3562736b5a4
.quad 0,0,0,0,0,0,0,0,0,0,0,0,0,0,0,0
.quad 0,0,0,0,0,0,0,0,0,0,0,0,0,0,0,0
.quad 0,0,0,0,0,0,0,0,0,0,0,0,0,0,0,0
.quad 0,0,0,0,0,0,0,0,0,0,0,0,0,0,0,0
.quad 0x3400340034003400,0x3400340034003400,0xb4003400b4003400,0xb4003400b4003400,0x355baf4c351330fe,0xaf4cb55b30feb513,0x2f4c355bb0fe3513,0x355baf4c351330fe,0x29d1b59c359c29d1,0xa9d1359cb59ca9d1,0x359c29d1a9d1359c,0xb59ca9d129d1b59c,0xb4b7b242358bac7c,0x3242b4b72c7c358b,0x3242b4b72c7c358b,0x34b73242b58b2c7c
.quad 0xb4e331b234e3b1b2,0xb4e331b234e3b1b2,0xb1b2b4e331b234e3,0xb1b2b4e331b234e3,0x266235a5336bb446,0x35a5a662b446b36b,0xb5a526623446336b,0x266235a5336bb446,0x353d30443044b53d,0xb53db044b044353d,0xb044353d353d3044,0x3044b53db53db044,0x343ab3852546b5a6,0x3385343a35a62546,0x3385343a35a62546,0xb43a3385a54635a6
.quad 0x3400340034003400,0x3400340034003400,0xb4003400b4003400,0xb4003400b4003400,0xb55b2f4cb513b0fe,0x2f4c355bb0fe3513,0xaf4cb55b30feb513,0xb55b2f4cb513b0fe,0x29d1b59c359c29d1,0xa9d1359cb59ca9d1,0x359c29d1a9d1359c,0xb59ca9d129d1b59c,0x34b73242b58b2c7c,0xb24234b7ac7cb58b,0xb24234b7ac7cb58b,0xb4b7b242358bac7c
.quad 0xb4e331b234e3b1b2,0xb4e331b234e3b1b2,0xb1b2b4e331b234e3,0xb1b2b4e331b234e3,0xa662b5a5b36b3446,0xb5a526623446336b,0x35a5a662b446b36b,0xa662b5a5b36b3446,0x353d30443044b53d,0xb53db044b044353d,0xb044353d353d3044,0x3044b53db53db044,0xb43a3385a54635a6,0xb385b43ab5a6a546,0xb385b43ab5a6a546,0x343ab3852546b5a6
.quad 0,0,0,0,0,0,0,0,0,0,0,0,0,0,0,0
.quad 0,0,0,0,0,0,0,0,0,0,0,0,0,0,0,0
.quad 0,0,0,0,0,0,0,0,0,0,0,0,0,0,0,0
.quad 0,0,0,0,0,0,0,0,0,0,0,0,0,0,0,0
.quad 0x3400340034003400,0x3400340034003400,0xb4003400b4003400,0xb4003400b4003400,0x3559af5c351530f6,0xaf5cb55930f6b515,0x2f5c3559b0f63515,0x3559af5c351530f6,0x298ab59d359d298a,0xa98a359db59da98a,0x359d298aa98a359d,0xb59da98a298ab59d,0xb4beb22b3589acb0,0x322bb4be2cb03589,0x322bb4be2cb03589,0x34be322bb5892cb0
.quad 0xb4da31d134dab1d1,0xb4da31d134dab1d1,0xb1d1b4da31d134da,0xb1d1b4da31d134da,0x27c435a33349b454,0x35a3a7c4b454b349,0xb5a327c434543349,0x27c435a33349b454,0x354730123012b547,0xb547b012b0123547,0xb012354735473012,0x3012b547b547b012,0x3425b3b322aab5a7,0x33b3342535a722aa,0x33b3342535a722aa,0xb42533b3a2aa35a7
.quad 0x3400340034003400,0x3400340034003400,0xb4003400b4003400,0xb4003400b4003400,0xb5592f5cb515b0f6,0x2f5c3559b0f63515,0xaf5cb55930f6b515,0xb5592f5cb515b0f6,0x298ab59d359d298a,0xa98a359db59da98a,0x359d298aa98a359d,0xb59da98a298ab59d,0x34be322bb5892cb0,0xb22b34beacb0b589,0xb22b34beacb0b589,0xb4beb22b3589acb0
.quad 0xb4da31d134dab1d1,0xb4da31d134dab1d1,0xb1d1b4da31d134da,0xb1d1b4da31d134da,0xa7c4b5a3b3493454,0xb5a327c434543349,0x35a3a7c4b454b349,0xa7c4b5a3b3493454,0x354730123012b547,0xb547b012b0123547,0xb012354735473012,0x3012b547b547b012,0xb42533b3a2aa35a7,0xb3b3b425b5a7a2aa,0xb3b3b425b5a7a2aa,0x3425b3b322aab5a7
.quad 0,0,0,0,0,0,0,0,0,0,0,0,0,0,0,0
.quad 0,0,0,0,0,0,0,0,0,0,0,0,0,0,0,0
.quad 0,0,0,0,0,0,0,0,0,0,0,0,0,0,0,0
.quad 0,0,0,0,0,0,0,0,0,0,0,0,0,0,0,0
.quad 0x3400340034003400,0x3400340034003400,0xb4003400b4003400,0xb4003400b4003400,0x3558af6d351730ee,0xaf6db55830eeb517,0x2f6d3558b0ee3517,0x3558af6d351730ee,0x2944b59e359e2944,0xa944359eb59ea944,0x359e2944a944359e,0xb59ea9442944b59e,0xb4c5b2153586ace4,0x3215b4c52ce43586,0x3215b4c52ce43586,0x34c53215b5862ce4
.quad 0xb4d131ef34d1b1ef,0xb4d131ef34d1b1ef,0xb1efb4d131ef34d1,0xb1efb4d131ef34d1,0x289335a13327b462,0x35a1a893b462b327,0xb5a1289334623327,0x289335a13327b462,0x35502fc12fc1b550,0xb550afc1afc13550,0xafc1355035502fc1,0x2fc1b550b550afc1,0x3410b3e01d8eb5a8,0x33e0341035a81d8e,0x33e0341035a81d8e,0xb41033e09d8e35a8
.quad 0x3400340034003400,0x3400340034003400,0xb4003400b4003400,0xb4003400b4003400,0xb5582f6db517b0ee,0x2f6d3558b0ee3517,0xaf6db55830eeb517,0xb5582f6db517b0ee,0x2944b59e359e2944,0xa944359eb59ea944,0x359e2944a944359e,0xb59ea9442944b59e,0x34c53215b5862ce4,0xb21534c5ace4b586,0xb21534c5ace4b586,0xb4c5b2153586ace4
.quad 0xb4d131ef34d1b1ef,0xb4d131ef34d1b1ef,0xb1efb4d131ef34d1,0xb1efb4d131ef34d1,0xa893b5a1b3273462,0xb5a1289334623327,0x35a1a893b462b327,0xa893b5a1b3273462,0x35502fc12fc1b550,0xb550afc1afc13550,0xafc1355035502fc1,0x2fc1b550b550afc1,0xb41033e09d8e35a8,0xb3e0b410b5a89d8e,0xb3e0b410b5a89d8e,0x3410b3e01d8eb5a8
.quad 0,0,0,0,0,0,0,0,0,0,0,0,0,0,0,0
.quad 0,0,0,0,0,0,0,0,0,0,0,0,0,0,0,0
.quad 0,0,0,0,0,0,0,0,0,0,0,0,0,0,0,0
.quad 0,0,0,0,0,0,0,0,0,0,0,0,0,0,0,0
.quad 0x3400340034003400,0x3400340034003400,0xb4003400b4003400,0xb4003400b4003400,0x3556af7e351930e6,0xaf7eb55630e6b519,0x2f7e3556b0e63519,0x3556af7e351930e6,0x28fdb59f359f28fd,0xa8fd359fb59fa8fd,0x359f28fda8fd359f,0xb59fa8fd28fdb59f,0xb4ccb1fe3583ad18,0x31feb4cc2d183583,0x31feb4cc2d183583,0x34cc31feb5832d18
.quad 0xb4c7320e34c7b20e,0xb4c7320e34c7b20e,0xb20eb4c7320e34c7,0xb20eb4c7320e34c7,0x2944359e3304b470,0x359ea944b470b304,0xb59e294434703304,0x2944359e3304b470,0x35592f5c2f5cb559,0xb559af5caf5c3559,0xaf5c355935592f5c,0x2f5cb559b559af5c,0x33f3b4069871b5a8,0x340633f335a89871,0x340633f335a89871,0xb3f33406187135a8
.quad 0x3400340034003400,0x3400340034003400,0xb4003400b4003400,0xb4003400b4003400,0xb5562f7eb519b0e6,0x2f7e3556b0e63519,0xaf7eb55630e6b519,0xb5562f7eb519b0e6,0x28fdb59f359f28fd,0xa8fd359fb59fa8fd,0x359f28fda8fd359f,0xb59fa8fd28fdb59f,0x34cc31feb5832d18,0xb1fe34ccad18b583,0xb1fe34ccad18b583,0xb4ccb1fe3583ad18
.quad 0xb4c7320e34c7b20e,0xb4c7320e34c7b20e,0xb20eb4c7320e34c7,0xb20eb4c7320e34c7,0xa944b59eb3043470,0xb59e294434703304,0x359ea944b470b304,0xa944b59eb3043470,0x35592f5c2f5cb559,0xb559af5caf5c3559,0xaf5c355935592f5c,0x2f5cb559b559af5c,0xb3f33406187135a8,0xb406b3f3b5a81871,0xb406b3f3b5a81871,0x33f3b4069871b5a8
.quad 0,0,0,0,0,0,0,0,0,0,0,0,0,0,0,0
.quad 0,0,0,0,0,0,0,0,0,0,0,0,0,0,0,0
.quad 0,0,0,0,0,0,0,0,0,0,0,0,0,0,0,0
.quad 0,0,0,0,0,0,0,0,0,0,0,0,0,0,0,0
.quad 0x3400340034003400,0x3400340034003400,0xb4003400b4003400,0xb4003400b4003400,0x3555af8f351b30de,0xaf8fb55530deb51b,0x2f8f3555b0de351b,0x3555af8f351b30de,0x28b6b5a035a028b6,0xa8b635a0b5a0a8b6,0x35a028b6a8b635a0,0xb5a0a8b628b6b5a0,0xb4d3b1e83580ad4c,0x31e8b4d32d4c3580,0x31e8b4d32d4c3580,0x34d331e8b5802d4c
.quad 0xb4be322b34beb22b,0xb4be322b34beb22b,0xb22bb4be322b34be,0xb22bb4be322b34be,0x29f4359c32e1b47e,0x359ca9f4b47eb2e1,0xb59c29f4347e32e1,0x29f4359c32e1b47e,0x35622ef72ef7b562,0xb562aef7aef73562,0xaef7356235622ef7,0x2ef7b562b562aef7,0x33c7b41ca0ffb5a8,0x341c33c735a8a0ff,0x341c33c735a8a0ff,0xb3c7341c20ff35a8
.quad 0x3400340034003400,0x3400340034003400,0xb4003400b4003400,0xb4003400b4003400,0xb5552f8fb51bb0de,0x2f8f3555b0de351b,0xaf8fb55530deb51b,0xb5552f8fb51bb0de,0x28b6b5a035a028b6,0xa8b635a0b5a0a8b6,0x35a028b6a8b635a0,0xb5a0a8b628b6b5a0,0x34d331e8b5802d4c,0xb1e834d3ad4cb580,0xb1e834d3ad4cb580,0xb4d3b1e83580ad4c
.quad 0xb4be322b34beb22b,0xb4be322b34beb22b,0xb22bb4be322b34be,0xb22bb4be322b34be,0xa9f4b59cb2e1347e,0xb59c29f4347e32e1,0x359ca9f4b47eb2e1,0xa9f4b59cb2e1347e,0x35622ef72ef7b562,0xb562aef7aef73562,0xaef7356235622ef7,0x2ef7b562b562aef7,0xb3c7341c20ff35a8,0xb41cb3c7b5a820ff,0xb41cb3c7b5a820ff,0x33c7b41ca0ffb5a8
.quad 0,0,0,0,0,0,0,0,0,0,0,0,0,0,0,0
.quad 0,0,0,0,0,0,0,0,0,0,0,0,0,0,0,0
.quad 0,0,0,0,0,0,0,0,0,0,0,0,0,0,0,0
.quad 0,0,0,0,0,0,0,0,0,0,0,0,0,0,0,0
.quad 0x3400340034003400,0x3400340034003400,0xb4003400b4003400,0xb4003400b4003400,0x3554af9f351d30d6,0xaf9fb55430d6b51d,0x2f9f3554b0d6351d,0x3554af9f351d30d6,0x2870b5a135a12870,0xa87035a1b5a1a870,0x35a12870a87035a1,0xb5a1a8702870b5a1,0xb4dab1d1357dad7f,0x31d1b4da2d7f357d,0x31d1b4da2d7f357d,0x34da31d1b57d2d7f
.quad 0xb4b4324934b4b249,0xb4b4324934b4b249,0xb249b4b4324934b4,0xb249b4b4324934b4,0x2aa4359832bdb48b,0x3598aaa4b48bb2bd,0xb5982aa4348b32bd,0x2aa4359832bdb48b,0x356a2e922e92b56a,0xb56aae92ae92356a,0xae92356a356a2e92,0x2e92b56ab56aae92,0x3399b431a471b5a6,0x3431339935a6a471,0x3431339935a6a471,0xb3993431247135a6
.quad 0x3400340034003400,0x3400340034003400,0xb4003400b4003400,0xb4003400b4003400,0xb5542f9fb51db0d6,0x2f9f3554b0d6351d,0xaf9fb55430d6b51d,0xb5542f9fb51db0d6,0x2870b5a135a12870,0xa87035a1b5a1a870,0x35a12870a87035a1,0xb5a1a8702870b5a1,0x34da31d1b57d2d7f,0xb1d134daad7fb57d,0xb1d134daad7fb57d,0xb4dab1d1357dad7f
.quad 0xb4b4324934b4b249,0xb4b4324934b4b249,0xb249b4b4324934b4,0xb249b4b4324934b4,0xaaa4b598b2bd348b,0xb5982aa4348b32bd,0x3598aaa4b48bb2bd,0xaaa4b598b2bd348b,0x356a2e922e92b56a,0xb56aae92ae92356a,0xae92356a356a2e92,0x2e92b56ab56aae92,0xb3993431247135a6,0xb431b399b5a62471,0xb431b399b5a62471,0x3399b431a471b5a6
.quad 0,0,0,0,0,0,0,0,0,0,0,0,0,0,0,0
.quad 0,0,0,0,0,0,0,0,0,0,0,0,0,0,0,0
.quad 0,0,0,0,0,0,0,0,0,0,0,0,0,0,0,0
.quad 0,0,0,0,0,0,0,0,0,0,0,0,0,0,0,0
.quad 0x3400340034003400,0x3400340034003400,0xb4003400b4003400,0xb4003400b4003400,0x3552afb0351f30ce,0xafb0b55230ceb51f,0x2fb03552b0ce351f,0x3552afb0351f30ce,0x2829b5a235a22829,0xa82935a2b5a2a829,0x35a22829a82935a2,0xb5a2a8292829b5a2,0xb4e1b1ba3579adb3,0x31bab4e12db33579,0x31bab4e12db33579,0x34e131bab5792db3
.quad 0xb4aa326734aab267,0xb4aa326734aab267,0xb267b4aa326734aa,0xb267b4aa326734aa,0x2b5335953299b498,0x3595ab53b498b299,0xb5952b5334983299,0x2b5335953299b498,0x35712e2b2e2bb571,0xb571ae2bae2b3571,0xae2b357135712e2b,0x2e2bb571b571ae2b,0x336bb446a662b5a5,0x3446336b35a5a662,0x3446336b35a5a662,0xb36b3446266235a5
.quad 0x3400340034003400,0x3400340034003400,0xb4003400b4003400,0xb4003400b4003400,0xb5522fb0b51fb0ce,0x2fb03552b0ce351f,0xafb0b55230ceb51f,0xb5522fb0b51fb0ce,0x2829b5a235a22829,0xa82935a2b5a2a829,0x35a22829a82935a2,0xb5a2a8292829b5a2,0x34e131bab5792db3,0xb1ba34e1adb3b579,0xb1ba34e1adb3b579,0xb4e1b1ba3579adb3
.quad 0xb4aa326734aab267,0xb4aa326734aab267,0xb267b4aa326734aa,0xb267b4aa326734aa,0xab53b595b2993498,0xb5952b5334983299,0x3595ab53b498b299,0xab53b595b2993498,0x35712e2b2e2bb571,0xb571ae2bae2b3571,0xae2b357135712e2b,0x2e2bb571b571ae2b,0xb36b3446266235a5,0xb446b36bb5a52662,0xb446b36bb5a52662,0x336bb446a662b5a5
.quad 0,0,0,0,0,0,0,0,0,0,0,0,0,0,0,0
.quad 0,0,0,0,0,0,0,0,0,0,0,0,0,0,0,0
.quad 0,0,0,0,0,0,0,0,0,0,0,0,0,0,0,0
.quad 0,0,0,0,0,0,0,0,0,0,0,0,0,0,0,0
.quad 0x3400340034003400,0x3400340034003400,0xb4003400b4003400,0xb4003400b4003400,0x3550afc1352130c6,0xafc1b55030c6b521,0x2fc13550b0c63521,0x3550afc1352130c6,0x27c4b5a335a327c4,0xa7c435a3b5a3a7c4,0x35a327c4a7c435a3,0xb5a3a7c427c4b5a3,0xb4e8b1a33576ade7,0x31a3b4e82de73576,0x31a3b4e82de73576,0x34e831a3b5762de7
.quad 0xb4a0328434a0b284,0xb4a0328434a0b284,0xb284b4a0328434a0,0xb284b4a0328434a0,0x2c0135913275b4a5,0x3591ac01b4a5b275,0xb5912c0134a53275,0x2c0135913275b4a5,0x35782dc42dc4b578,0xb578adc4adc43578,0xadc4357835782dc4,0x2dc4b578b578adc4,0x333bb45aa829b5a2,0x345a333b35a2a829,0x345a333b35a2a829,0xb33b345a282935a2
.quad 0x3400340034003400,0x3400340034003400,0xb4003400b4003400,0xb4003400b4003400,0xb5502fc1b521b0c6,0x2fc13550b0c63521,0xafc1b55030c6b521,0xb5502fc1b521b0c6,0x27c4b5a335a327c4,0xa7c435a3b5a3a7c4,0x35a327c4a7c435a3,0xb5a3a7c427c4b5a3,0x34e831a3b5762de7,0xb1a334e8ade7b576,0xb1a334e8ade7b576,0xb4e8b1a33576ade7
.quad 0xb4a0328434a0b284,0xb4a0328434a0b284,0xb284b4a0328434a0,0xb284b4a0328434a0,0xac01b591b27534a5,0xb5912c0134a53275,0x3591ac01b4a5b275,0xac01b591b27534a5,0x35782dc42dc4b578,0xb578adc4adc43578,0xadc4357835782dc4,0x2dc4b578b578adc4,0xb33b345a282935a2,0xb45ab33bb5a22829,0xb45ab33bb5a22829,0x333bb45aa829b5a2
.quad 0,0,0,0,0,0,0,0,0,0,0,0,0,0,0,0
.quad 0,0,0,0,0,0,0,0,0,0,0,0,0,0,0,0
.quad 0,0,0,0,0,0,0,0,0,0,0,0,0,0,0,0
.quad 0,0,0,0,0,0,0,0,0,0,0,0,0,0,0,0
.quad 0x3400340034003400,0x3400340034003400,0xb4003400b4003400,0xb4003400b4003400,0x354fafd2352330be,0xafd2b54f30beb523,0x2fd2354fb0be3523,0x354fafd2352330be,0x2736b5a435a42736,0xa73635a4b5a4a736,0x35a42736a73635a4,0xb5a4a7362736b5a4,0xb4eeb18c3573ae1a,0x318cb4ee2e1a3573,0x318cb4ee2e1a3573,0x34ee318cb5732e1a
.quad 0xb49632a13496b2a1,0xb49632a13496b2a1,0xb2a1b49632a13496,0xb2a1b49632a13496,0x2c59358d3250b4b2,0x358dac59b4b2b250,0xb58d2c5934b23250,0x2c59358d3250b4b2,0x357f2d5d2d5db57f,0xb57fad5dad5d357f,0xad5d357f357f2d5d,0x2d5db57fb57fad5d,0x330bb46da920b59f,0x346d330b359fa920,0x346d330b359fa920,0xb30b346d2920359f
.quad 0x3400340034003400,0x3400340034003400,0xb4003400b4003400,0xb4003400b4003400,0xb54f2fd2b523b0be,0x2fd2354fb0be3523,0xafd2b54f30beb523,0xb54f2fd2b523b0be,0x2736b5a435a42736,0xa73635a4b5a4a736,0x35a42736a73635a4,0xb5a4a7362736b5a4,0x34ee318cb5732e1a,0xb18c34eeae1ab573,0xb18c34eeae1ab573,0xb4eeb18c3573ae1a
.quad 0xb49632a13496b2a1,0xb49632a13496b2a1,0xb2a1b49632a13496,0xb2a1b49632a13496,0xac59b58db25034b2,0xb58d2c5934b23250,0x358dac59b4b2b250,0xac59b58db25034b2,0x357f2d5d2d5db57f,0xb57fad5dad5d357f,0xad5d357f357f2d5d,0x2d5db57fb57fad5d,0xb30b346d2920359f,0xb46db30bb59f2920,0xb46db30bb59f2920,0x330bb46da920b59f
.quad 0,0,0,0,0,0,0,0,0,0,0,0,0,0,0,0
.quad 0,0,0,0,0,0,0,0,0,0,0,0,0,0,0,0
.quad 0,0,0,0,0,0,0,0,0,0,0,0,0,0,0,0
.quad 0,0,0,0,0,0,0,0,0,0,0,0,0,0,0,0
.quad 0x3400340034003400,0x3400340034003400,0xb4003400b4003400,0xb4003400b4003400,0x354dafe2352530b6,0xafe2b54d30b6b525,0x2fe2354db0b63525,0x354dafe2352530b6,0x26a9b5a435a426a9,0xa6a935a4b5a4a6a9,0x35a426a9a6a935a4,0xb5a4a6a926a9b5a4,0xb4f5b175356fae4d,0x3175b4f52e4d356f,0x3175b4f52e4d356f,0x34f53175b56f2e4d
.quad 0xb48b32bd348bb2bd,0xb48b32bd348bb2bd,0xb2bdb48b32bd348b,0xb2bdb48b32bd348b,0x2cb03589322bb4be,0x3589acb0b4beb22b,0xb5892cb034be322b,0x2cb03589322bb4be,0x35852cf52cf5b585,0xb585acf5acf53585,0xacf5358535852cf5,0x2cf5b585b585acf5,0x32dab480aa17b59b,0x348032da359baa17,0x348032da359baa17,0xb2da34802a17359b
.quad 0x3400340034003400,0x3400340034003400,0xb4003400b4003400,0xb4003400b4003400,0xb54d2fe2b525b0b6,0x2fe2354db0b63525,0xafe2b54d30b6b525,0xb54d2fe2b525b0b6,0x26a9b5a435a426a9,0xa6a935a4b5a4a6a9,0x35a426a9a6a935a4,0xb5a4a6a926a9b5a4,0x34f53175b56f2e4d,0xb17534f5ae4db56f,0xb17534f5ae4db56f,0xb4f5b175356fae4d
.quad 0xb48b32bd348bb2bd,0xb48b32bd348bb2bd,0xb2bdb48b32bd348b,0xb2bdb48b32bd348b,0xacb0b589b22b34be,0xb5892cb034be322b,0x3589acb0b4beb22b,0xacb0b589b22b34be,0x35852cf52cf5b585,0xb585acf5acf53585,0xacf5358535852cf5,0x2cf5b585b585acf5,0xb2da34802a17359b,0xb480b2dab59b2a17,0xb480b2dab59b2a17,0x32dab480aa17b59b
.quad 0,0,0,0,0,0,0,0,0,0,0,0,0,0,0,0
.quad 0,0,0,0,0,0,0,0,0,0,0,0,0,0,0,0
.quad 0,0,0,0,0,0,0,0,0,0,0,0,0,0,0,0
.quad 0,0,0,0,0,0,0,0,0,0,0,0,0,0,0,0
.quad 0x3400340034003400,0x3400340034003400,0xb4003400b4003400,0xb4003400b4003400,0x354caff3352630ae,0xaff3b54c30aeb526,0x2ff3354cb0ae3526,0x354caff3352630ae,0x261bb5a535a5261b,0xa61b35a5b5a5a61b,0x35a5261ba61b35a5,0xb5a5a61b261bb5a5,0xb4fbb15d356bae80,0x315db4fb2e80356b,0x315db4fb2e80356b,0x34fb315db56b2e80
.quad 0xb48032da3480b2da,0xb48032da3480b2da,0xb2dab48032da3480,0xb2dab48032da3480,0x2d0735843206b4ca,0x3584ad07b4cab206,0xb5842d0734ca3206,0x2d0735843206b4ca,0x358b2c8d2c8db58b,0xb58bac8dac8d358b,0xac8d358b358b2c8d,0x2c8db58bb58bac8d,0x32a8b493ab0db596,0x349332a83596ab0d,0x349332a83596ab0d,0xb2a834932b0d3596
.quad 0x3400340034003400,0x3400340034003400,0xb4003400b4003400,0xb4003400b4003400,0xb54c2ff3b526b0ae,0x2ff3354cb0ae3526,0xaff3b54c30aeb526,0xb54c2ff3b526b0ae,0x261bb5a535a5261b,0xa61b35a5b5a5a61b,0x35a5261ba61b35a5,0xb5a5a61b261bb5a5,0x34fb315db56b2e80,0xb15d34fbae80b56b,0xb15d34fbae80b56b,0xb4fbb15d356bae80
.quad 0xb48032da3480b2da,0xb48032da3480b2da,0xb2dab48032da3480,0xb2dab48032da3480,0xad07b584b20634ca,0xb5842d0734ca3206,0x3584ad07b4cab206,0xad07b584b20634ca,0x358b2c8d2c8db58b,0xb58bac8dac8d358b,0xac8d358b358b2c8d,0x2c8db58bb58bac8d,0xb2a834932b0d3596,0xb493b2a8b5962b0d,0xb493b2a8b5962b0d,0x32a8b493ab0db596
.quad 0,0,0,0,0,0,0,0,0,0,0,0,0,0,0,0
.quad 0,0,0,0,0,0,0,0,0,0,0,0,0,0,0,0
.quad 0,0,0,0,0,0,0,0,0,0,0,0,0,0,0,0
.quad 0,0,0,0,0,0,0,0,0,0,0,0,0,0,0,0
.quad 0x3400340034003400,0x3400340034003400,0xb4003400b4003400,0xb4003400b4003400,0x354ab002352830a6,0xb002b54a30a6b528,0x3002354ab0a63528,0x354ab002352830a6,0x258db5a535a5258d,0xa58d35a5b5a5a58d,0x35a5258da58d35a5,0xb5a5a58d258db5a5,0xb501b1463567aeb3,0x3146b5012eb33567,0x3146b5012eb33567,0x35013146b5672eb3
.quad 0xb47632f63476b2f6,0xb47632f63476b2f6,0xb2f6b47632f63476,0xb2f6b47632f63476,0x2d5d357f31e0b4d6,0x357fad5db4d6b1e0,0xb57f2d5d34d631e0,0x2d5d357f31e0b4d6,0x35902c242c24b590,0xb590ac24ac243590,0xac24359035902c24,0x2c24b590b590ac24,0x3275b4a5ac01b591,0x34a532753591ac01,0x34a532753591ac01,0xb27534a52c013591
.quad 0x3400340034003400,0x3400340034003400,0xb4003400b4003400,0xb4003400b4003400,0xb54a3002b528b0a6,0x3002354ab0a63528,0xb002b54a30a6b528,0xb54a3002b528b0a6,0x258db5a535a5258d,0xa58d35a5b5a5a58d,0x35a5258da58d35a5,0xb5a5a58d258db5a5,0x35013146b5672eb3,0xb1463501aeb3b567,0xb1463501aeb3b567,0xb501b1463567aeb3
.quad 0xb47632f63476b2f6,0xb47632f63476b2f6,0xb2f6b47632f63476,0xb2f6b47632f63476,0xad5db57fb1e034d6,0xb57f2d5d34d631e0,0x357fad5db4d6b1e0,0xad5db57fb1e034d6,0x35902c242c24b590,0xb590ac24ac243590,0xac24359035902c24,0x2c24b590b590ac24,0xb27534a52c013591,0xb4a5b275b5912c01,0xb4a5b275b5912c01,0x3275b4a5ac01b591
.quad 0,0,0,0,0,0,0,0,0,0,0,0,0,0,0,0
.quad 0,0,0,0,0,0,0,0,0,0,0,0,0,0,0,0
.quad 0,0,0,0,0,0,0,0,0,0,0,0,0,0,0,0
.quad 0,0,0,0,0,0,0,0,0,0,0,0,0,0,0,0
.quad 0x3400340034003400,0x3400340034003400,0xb4003400b4003400,0xb4003400b4003400,0x3549b00a352a309e,0xb00ab549309eb52a,0x300a3549b09e352a,0x3549b00a352a309e,0x24ffb5a635a624ff,0xa4ff35a6b5a6a4ff,0x35a624ffa4ff35a6,0xb5a6a4ff24ffb5a6,0xb507b12e3563aee6,0x312eb5072ee63563,0x312eb5072ee63563,0x3507312eb5632ee6
.quad 0xb46b3312346bb312,0xb46b3312346bb312,0xb312b46b3312346b,0xb312b46b3312346b,0x2db3357931bab4e1,0x3579adb3b4e1b1ba,0xb5792db334e131ba,0x2db3357931bab4e1,0x35942b772b77b594,0xb594ab77ab773594,0xab77359435942b77,0x2b77b594b594ab77,0x3242b4b7ac7cb58b,0x34b73242358bac7c,0x34b73242358bac7c,0xb24234b72c7c358b
.quad 0x3400340034003400,0x3400340034003400,0xb4003400b4003400,0xb4003400b4003400,0xb549300ab52ab09e,0x300a3549b09e352a,0xb00ab549309eb52a,0xb549300ab52ab09e,0x24ffb5a635a624ff,0xa4ff35a6b5a6a4ff,0x35a624ffa4ff35a6,0xb5a6a4ff24ffb5a6,0x3507312eb5632ee6,0xb12e3507aee6b563,0xb12e3507aee6b563,0xb507b12e3563aee6
.quad 0xb46b3312346bb312,0xb46b3312346bb312,0xb312b46b3312346b,0xb312b46b3312346b,0xadb3b579b1ba34e1,0xb5792db334e131ba,0x3579adb3b4e1b1ba,0xadb3b579b1ba34e1,0x35942b772b77b594,0xb594ab77ab773594,0xab77359435942b77,0x2b77b594b594ab77,0xb24234b72c7c358b,0xb4b7b242b58b2c7c,0xb4b7b242b58b2c7c,0x3242b4b7ac7cb58b
.quad 0,0,0,0,0,0,0,0,0,0,0,0,0,0,0,0
.quad 0,0,0,0,0,0,0,0,0,0,0,0,0,0,0,0
.quad 0,0,0,0,0,0,0,0,0,0,0,0,0,0,0,0
.quad 0,0,0,0,0,0,0,0,0,0,0,0,0,0,0,0
.quad 0x3400340034003400,0x3400340034003400,0xb4003400b4003400,0xb4003400b4003400,0x3547b012352c3096,0xb012b5473096b52c,0x30123547b096352c,0x3547b012352c3096,0x2471b5a635a62471,0xa47135a6b5a6a471,0x35a62471a47135a6,0xb5a6a4712471b5a6,0xb50eb116355faf19,0x3116b50e2f19355f,0x3116b50e2f19355f,0x350e3116b55f2f19
.quad 0xb45f332d345fb32d,0xb45f332d345fb32d,0xb32db45f332d345f,0xb32db45f332d345f,0x2e0935743194b4ec,0x3574ae09b4ecb194,0xb5742e0934ec3194,0x2e0935743194b4ec,0x35982aa42aa4b598,0xb598aaa4aaa43598,0xaaa4359835982aa4,0x2aa4b598b598aaa4,0x320eb4c7acf5b585,0x34c7320e3585acf5,0x34c7320e3585acf5,0xb20e34c72cf53585
.quad 0x3400340034003400,0x3400340034003400,0xb4003400b4003400,0xb4003400b4003400,0xb5473012b52cb096,0x30123547b096352c,0xb012b5473096b52c,0xb5473012b52cb096,0x2471b5a635a62471,0xa47135a6b5a6a471,0x35a62471a47135a6,0xb5a6a4712471b5a6,0x350e3116b55f2f19,0xb116350eaf19b55f,0xb116350eaf19b55f,0xb50eb116355faf19
.quad 0xb45f332d345fb32d,0xb45f332d345fb32d,0xb32db45f332d345f,0xb32db45f332d345f,0xae09b574b19434ec,0xb5742e0934ec3194,0x3574ae09b4ecb194,0xae09b574b19434ec,0x35982aa42aa4b598,0xb598aaa4aaa43598,0xaaa4359835982aa4,0x2aa4b598b598aaa4,0xb20e34c72cf53585,0xb4c7b20eb5852cf5,0xb4c7b20eb5852cf5,0x320eb4c7acf5b585
.quad 0,0,0,0,0,0,0,0,0,0,0,0,0,0,0,0
.quad 0,0,0,0,0,0,0,0,0,0,0,0,0,0,0,0
.quad 0,0,0,0,0,0,0,0,0,0,0,0,0,0,0,0
.quad 0,0,0,0,0,0,0,0,0,0,0,0,0,0,0,0
.quad 0x3400340034003400,0x3400340034003400,0xb4003400b4003400,0xb4003400b4003400,0x3546b01b352e308e,0xb01bb546308eb52e,0x301b3546b08e352e,0x3546b01b352e308e,0x23c6b5a735a723c6,0xa3c635a7b5a7a3c6,0x35a723c6a3c635a7,0xb5a7a3c623c6b5a7,0xb513b0fe355baf4c,0x30feb5132f4c355b,0x30feb5132f4c355b,0x351330feb55b2f4c
.quad 0xb45433493454b349,0xb45433493454b349,0xb349b45433493454,0xb349b45433493454,0x2e5e356e316db4f7,0x356eae5eb4f7b16d,0xb56e2e5e34f7316d,0x2e5e356e316db4f7,0x359c29d129d1b59c,0xb59ca9d1a9d1359c,0xa9d1359c359c29d1,0x29d1b59cb59ca9d1,0x31d9b4d8ad6eb57e,0x34d831d9357ead6e,0x34d831d9357ead6e,0xb1d934d82d6e357e
.quad 0x3400340034003400,0x3400340034003400,0xb4003400b4003400,0xb4003400b4003400,0xb546301bb52eb08e,0x301b3546b08e352e,0xb01bb546308eb52e,0xb546301bb52eb08e,0x23c6b5a735a723c6,0xa3c635a7b5a7a3c6,0x35a723c6a3c635a7,0xb5a7a3c623c6b5a7,0x351330feb55b2f4c,0xb0fe3513af4cb55b,0xb0fe3513af4cb55b,0xb513b0fe355baf4c
.quad 0xb45433493454b349,0xb45433493454b349,0xb349b45433493454,0xb349b45433493454,0xae5eb56eb16d34f7,0xb56e2e5e34f7316d,0x356eae5eb4f7b16d,0xae5eb56eb16d34f7,0x359c29d129d1b59c,0xb59ca9d1a9d1359c,0xa9d1359c359c29d1,0x29d1b59cb59ca9d1,0xb1d934d82d6e357e,0xb4d8b1d9b57e2d6e,0xb4d8b1d9b57e2d6e,0x31d9b4d8ad6eb57e
.quad 0,0,0,0,0,0,0,0,0,0,0,0,0,0,0,0
.quad 0,0,0,0,0,0,0,0,0,0,0,0,0,0,0,0
.quad 0,0,0,0,0,0,0,0,0,0,0,0,0,0,0,0
.quad 0,0,0,0,0,0,0,0,0,0,0,0,0,0,0,0
.quad 0x3400340034003400,0x3400340034003400,0xb4003400b4003400,0xb4003400b4003400,0x3544b023352f3085,0xb023b5443085b52f,0x30233544b085352f,0x3544b023352f3085,0x22aab5a735a722aa,0xa2aa35a7b5a7a2aa,0x35a722aaa2aa35a7,0xb5a7a2aa22aab5a7,0xb519b0e63556af7e,0x30e6b5192f7e3556,0x30e6b5192f7e3556,0x351930e6b5562f7e
.quad 0xb44933643449b364,0xb44933643449b364,0xb364b44933643449,0xb364b44933643449,0x2eb335673146b501,0x3567aeb3b501b146,0xb5672eb335013146,0x2eb335673146b501,0x359f28fd28fdb59f,0xb59fa8fda8fd359f,0xa8fd359f359f28fd,0x28fdb59fb59fa8fd,0x31a3b4e8ade7b576,0x34e831a33576ade7,0x34e831a33576ade7,0xb1a334e82de73576
.quad 0x3400340034003400,0x3400340034003400,0xb4003400b4003400,0xb4003400b4003400,0xb5443023b52fb085,0x30233544b085352f,0xb023b5443085b52f,0xb5443023b52fb085,0x22aab5a735a722aa,0xa2aa35a7b5a7a2aa,0x35a722aaa2aa35a7,0xb5a7a2aa22aab5a7,0x351930e6b5562f7e,0xb0e63519af7eb556,0xb0e63519af7eb556,0xb519b0e63556af7e
.quad 0xb44933643449b364,0xb44933643449b364,0xb364b44933643449,0xb364b44933643449,0xaeb3b567b1463501,0xb5672eb335013146,0x3567aeb3b501b146,0xaeb3b567b1463501,0x359f28fd28fdb59f,0xb59fa8fda8fd359f,0xa8fd359f359f28fd,0x28fdb59fb59fa8fd,0xb1a334e82de73576,0xb4e8b1a3b5762de7,0xb4e8b1a3b5762de7,0x31a3b4e8ade7b576
.quad 0,0,0,0,0,0,0,0,0,0,0,0,0,0,0,0
.quad 0,0,0,0,0,0,0,0,0,0,0,0,0,0,0,0
.quad 0,0,0,0,0,0,0,0,0,0,0,0,0,0,0,0
.quad 0,0,0,0,0,0,0,0,0,0,0,0,0,0,0,0
.quad 0x3400340034003400,0x3400340034003400,0xb4003400b4003400,0xb4003400b4003400,0x3542b02b3531307d,0xb02bb542307db531,0x302b3542b07d3531,0x3542b02b3531307d,0x218db5a735a7218d,0xa18d35a7b5a7a18d,0x35a7218da18d35a7,0xb5a7a18d218db5a7,0xb51fb0ce3552afb0,0x30ceb51f2fb03552,0x30ceb51f2fb03552,0x351f30ceb5522fb0
.quad 0xb43d337f343db37f,0xb43d337f343db37f,0xb37fb43d337f343d,0xb37fb43d337f343d,0x2f083560311eb50c,0x3560af08b50cb11e,0xb5602f08350c311e,0x2f083560311eb50c,0x35a228292829b5a2,0xb5a2a829a82935a2,0xa82935a235a22829,0x2829b5a2b5a2a829,0x316db4f7ae5eb56e,0x34f7316d356eae5e,0x34f7316d356eae5e,0xb16d34f72e5e356e
.quad 0x3400340034003400,0x3400340034003400,0xb4003400b4003400,0xb4003400b4003400,0xb542302bb531b07d,0x302b3542b07d3531,0xb02bb542307db531,0xb542302bb531b07d,0x218db5a735a7218d,0xa18d35a7b5a7a18d,0x35a7218da18d35a7,0xb5a7a18d218db5a7,0x351f30ceb5522fb0,0xb0ce351fafb0b552,0xb0ce351fafb0b552,0xb51fb0ce3552afb0
.quad 0xb43d337f343db37f,0xb43d337f343db37f,0xb37fb43d337f343d,0xb37fb43d337f343d,0xaf08b560b11e350c,0xb5602f08350c311e,0x3560af08b50cb11e,0xaf08b560b11e350c,0x35a228292829b5a2,0xb5a2a829a82935a2,0xa82935a235a22829,0x2829b5a2b5a2a829,0xb16d34f72e5e356e,0xb4f7b16db56e2e5e,0xb4f7b16db56e2e5e,0x316db4f7ae5eb56e
.quad 0,0,0,0,0,0,0,0,0,0,0,0,0,0,0,0
.quad 0,0,0,0,0,0,0,0,0,0,0,0,0,0,0,0
.quad 0,0,0,0,0,0,0,0,0,0,0,0,0,0,0,0
.quad 0,0,0,0,0,0,0,0,0,0,0,0,0,0,0,0
.quad 0x3400340034003400,0x3400340034003400,0xb4003400b4003400,0xb4003400b4003400,0x3541b03335333075,0xb033b5413075b533,0x30333541b0753533,0x3541b03335333075,0x2071b5a835a82071,0xa07135a8b5a8a071,0x35a82071a07135a8,0xb5a8a0712071b5a8,0xb525b0b6354dafe2,0x30b6b5252fe2354d,0x30b6b5252fe2354d,0x352530b6b54d2fe2
.quad 0xb43133993431b399,0xb43133993431b399,0xb399b43133993431,0xb399b43133993431,0x2f5c355930f6b515,0x3559af5cb515b0f6,0xb5592f5c351530f6,0x2f5c355930f6b515,0x35a426a926a9b5a4,0xb5a4a6a9a6a935a4,0xa6a935a435a426a9,0x26a9b5a4b5a4a6a9,0x3136b505aed5b565,0x350531363565aed5,0x350531363565aed5,0xb13635052ed53565
.quad 0x3400340034003400,0x3400340034003400,0xb4003400b4003400,0xb4003400b4003400,0xb5413033b533b075,0x30333541b0753533,0xb033b5413075b533,0xb5413033b533b075,0x2071b5a835a82071,0xa07135a8b5a8a071,0x35a82071a07135a8,0xb5a8a0712071b5a8,0x352530b6b54d2fe2,0xb0b63525afe2b54d,0xb0b63525afe2b54d,0xb525b0b6354dafe2
.quad 0xb43133993431b399,0xb43133993431b399,0xb399b43133993431,0xb399b43133993431,0xaf5cb559b0f63515,0xb5592f5c351530f6,0x3559af5cb515b0f6,0xaf5cb559b0f63515,0x35a426a926a9b5a4,0xb5a4a6a9a6a935a4,0xa6a935a435a426a9,0x26a9b5a4b5a4a6a9,0xb13635052ed53565,0xb505b136b5652ed5,0xb505b136b5652ed5,0x3136b505aed5b565
.quad 0,0,0,0,0,0,0,0,0,0,0,0,0,0,0,0
.quad 0,0,0,0,0,0,0,0,0,0,0,0,0,0,0,0
.quad 0,0,0,0,0,0,0,0,0,0,0,0,0,0,0,0
.quad 0,0,0,0,0,0,0,0,0,0,0,0,0,0,0,0
.quad 0x3400340034003400,0x3400340034003400,0xb4003400b4003400,0xb4003400b4003400,0x353fb03c3535306d,0xb03cb53f306db535,0x303c353fb06d3535,0x353fb03c3535306d,0x1eaab5a835a81eaa,0x9eaa35a8b5a89eaa,0x35a81eaa9eaa35a8,0xb5a89eaa1eaab5a8,0xb52ab09e3549b00a,0x309eb52a300a3549,0x309eb52a300a3549,0x352a309eb549300a
.quad 0xb42533b33425b3b3,0xb42533b33425b3b3,0xb3b3b42533b33425,0xb3b3b42533b33425,0x2fb0355230ceb51f,0x3552afb0b51fb0ce,0xb5522fb0351f30ce,0x2fb0355230ceb51f,0x35a624ff24ffb5a6,0xb5a6a4ffa4ff35a6,0xa4ff35a635a624ff,0x24ffb5a6b5a6a4ff,0x30feb513af4cb55b,0x351330fe355baf4c,0x351330fe355baf4c,0xb0fe35132f4c355b
.quad 0x3400340034003400,0x3400340034003400,0xb4003400b4003400,0xb4003400b4003400,0xb53f303cb535b06d,0x303c353fb06d3535,0xb03cb53f306db535,0xb53f303cb535b06d,0x1eaab5a835a81eaa,0x9eaa35a8b5a89eaa,0x35a81eaa9eaa35a8,0xb5a89eaa1eaab5a8,0x352a309eb549300a,0xb09e352ab00ab549,0xb09e352ab00ab549,0xb52ab09e3549b00a
.quad 0xb42533b33425b3b3,0xb42533b33425b3b3,0xb3b3b42533b33425,0xb3b3b42533b33425,0xafb0b552b0ce351f,0xb5522fb0351f30ce,0x3552afb0b51fb0ce,0xafb0b552b0ce351f,0x35a624ff24ffb5a6,0xb5a6a4ffa4ff35a6,0xa4ff35a635a624ff,0x24ffb5a6b5a6a4ff,0xb0fe35132f4c355b,0xb513b0feb55b2f4c,0xb513b0feb55b2f4c,0x30feb513af4cb55b
.quad 0,0,0,0,0,0,0,0,0,0,0,0,0,0,0,0
.quad 0,0,0,0,0,0,0,0,0,0,0,0,0,0,0,0
.quad 0,0,0,0,0,0,0,0,0,0,0,0,0,0,0,0
.quad 0,0,0,0,0,0,0,0,0,0,0,0,0,0,0,0
.quad 0x3400340034003400,0x3400340034003400,0xb4003400b4003400,0xb4003400b4003400,0x353db04435363065,0xb044b53d3065b536,0x3044353db0653536,0x353db04435363065,0x1c71b5a835a81c71,0x9c7135a8b5a89c71,0x35a81c719c7135a8,0xb5a89c711c71b5a8,0xb52fb0853544b023,0x3085b52f30233544,0x3085b52f30233544,0x352f3085b5443023
.quad 0xb41933cd3419b3cd,0xb41933cd3419b3cd,0xb3cdb41933cd3419,0xb3cdb41933cd3419,0x3002354a30a6b528,0x354ab002b528b0a6,0xb54a3002352830a6,0x3002354a30a6b528,0x35a722aa22aab5a7,0xb5a7a2aaa2aa35a7,0xa2aa35a735a722aa,0x22aab5a7b5a7a2aa,0x30c6b521afc1b550,0x352130c63550afc1,0x352130c63550afc1,0xb0c635212fc13550
.quad 0x3400340034003400,0x3400340034003400,0xb4003400b4003400,0xb4003400b4003400,0xb53d3044b536b065,0x3044353db0653536,0xb044b53d3065b536,0xb53d3044b536b065,0x1c71b5a835a81c71,0x9c7135a8b5a89c71,0x35a81c719c7135a8,0xb5a89c711c71b5a8,0x352f3085b5443023,0xb085352fb023b544,0xb085352fb023b544,0xb52fb0853544b023
.quad 0xb41933cd3419b3cd,0xb41933cd3419b3cd,0xb3cdb41933cd3419,0xb3cdb41933cd3419,0xb002b54ab0a63528,0xb54a3002352830a6,0x354ab002b528b0a6,0xb002b54ab0a63528,0x35a722aa22aab5a7,0xb5a7a2aaa2aa35a7,0xa2aa35a735a722aa,0x22aab5a7b5a7a2aa,0xb0c635212fc13550,0xb521b0c6b5502fc1,0xb521b0c6b5502fc1,0x30c6b521afc1b550
.quad 0,0,0,0,0,0,0,0,0,0,0,0,0,0,0,0
.quad 0,0,0,0,0,0,0,0,0,0,0,0,0,0,0,0
.quad 0,0,0,0,0,0,0,0,0,0,0,0,0,0,0,0
.quad 0,0,0,0,0,0,0,0,0,0,0,0,0,0,0,0
.quad 0x3400340034003400,0x3400340034003400,0xb4003400b4003400,0xb4003400b4003400,0x353cb04c3538305d,0xb04cb53c305db538,0x304c353cb05d3538,0x353cb04c3538305d,0x1871b5a835a81871,0x987135a8b5a89871,0x35a81871987135a8,0xb5a898711871b5a8,0xb535b06d353fb03c,0x306db535303c353f,0x306db535303c353f,0x3535306db53f303c
.quad 0xb40c33e7340cb3e7,0xb40c33e7340cb3e7,0xb3e7b40c33e7340c,0xb3e7b40c33e7340c,0x302b3542307db531,0x3542b02bb531b07d,0xb542302b3531307d,0x302b3542307db531,0x35a81eaa1eaab5a8,0xb5a89eaa9eaa35a8,0x9eaa35a835a81eaa,0x1eaab5a8b5a89eaa,0x308eb52eb01bb546,0x352e308e3546b01b,0x352e308e3546b01b,0xb08e352e301b3546
.quad 0x3400340034003400,0x3400340034003400,0xb4003400b4003400,0xb4003400b4003400,0xb53c304cb538b05d,0x304c353cb05d3538,0xb04cb53c305db538,0xb53c304cb538b05d,0x1871b5a835a81871,0x987135a8b5a89871,0x35a81871987135a8,0xb5a898711871b5a8,0x3535306db53f303c,0xb06d3535b03cb53f,0xb06d3535b03cb53f,0xb535b06d353fb03c
.quad 0xb40c33e7340cb3e7,0xb40c33e7340cb3e7,0xb3e7b40c33e7340c,0xb3e7b40c33e7340c,0xb02bb542b07d3531,0xb542302b3531307d,0x3542b02bb531b07d,0xb02bb542b07d3531,0x35a81eaa1eaab5a8,0xb5a89eaa9eaa35a8,0x9eaa35a835a81eaa,0x1eaab5a8b5a89eaa,0xb08e352e301b3546,0xb52eb08eb546301b,0xb52eb08eb546301b,0x308eb52eb01bb546
.quad 0,0,0,0,0,0,0,0,0,0,0,0,0,0,0,0
.quad 0,0,0,0,0,0,0,0,0,0,0,0,0,0,0,0
.quad 0,0,0,0,0,0,0,0,0,0,0,0,0,0,0,0
.quad 0,0,0,0,0,0,0,0,0,0,0,0,0,0,0,0
```
